```python
import torch

def _softmax(x, axis=-1):
    return torch.softmax(x, dim=axis)
def _gelu(x):
    return torch.nn.functional.gelu(x, approximate="tanh")
def _silu(x):
    return torch.nn.functional.silu(x)
def _sigmoid(x):
    return torch.sigmoid(x)
def _layernorm(x, axis=-1, eps=1e-5):
    m = x.mean(dim=axis, keepdim=True)
    v = x.var(dim=axis, keepdim=True, unbiased=False)
    return (x - m) / torch.sqrt(v + eps)
def _scatter_add(tgt, idx, src, axis=0):
    return tgt.clone().index_add_(axis, idx, src)
def _segment_sum(src, seg, n):
    out = torch.zeros((n,) + src.shape[1:], dtype=src.dtype)
    return out.index_add_(0, seg, src)
def _pad(x, pw):
    flat = tuple(v for pair in reversed(pw) for v in pair)
    return torch.nn.functional.pad(x, flat)

kernel_name = 'recurrent_scan__linear_attn_block__geglu_ffn__prompt'

def setup_inputs():

    _w = (lambda a: (lambda t: t.to(torch.bfloat16) if t.is_floating_point() else t)(torch.as_tensor(a)))
    def _A_setup():
        B, S, D = 1, 2048, 1024
        return {
            "x": _w((lambda *s: torch.randn(*s, dtype=torch.bfloat16) * 0.05)(B, S, D)),
            "wqkv": _w((lambda *s: torch.randn(*s, dtype=torch.bfloat16) * 0.05)(D, 3 * D)),
            "wo": _w((lambda *s: torch.randn(*s, dtype=torch.bfloat16) * 0.05)(D, D)),
        }
    _A_in = _A_setup()

    def _B_setup():
        B, S, D, F = 1, 2048, 1024, 3584
        return {
            "x": _w((lambda *s: torch.randn(*s, dtype=torch.bfloat16) * 0.05)(B, S, D)),
            "w_gate": _w((lambda *s: torch.randn(*s, dtype=torch.bfloat16) * 0.05)(D, F)),
            "w_up": _w((lambda *s: torch.randn(*s, dtype=torch.bfloat16) * 0.05)(D, F)),
            "w_down": _w((lambda *s: torch.randn(*s, dtype=torch.bfloat16) * 0.05)(F, D)),
        }
    _B_in = _B_setup()

    return {
        "A_x": _A_in["x"],
        "A_wqkv": _A_in["wqkv"],
        "A_wo": _A_in["wo"],
        "B_x": _B_in["x"],
        "B_w_gate": _B_in["w_gate"],
        "B_w_up": _B_in["w_up"],
        "B_w_down": _B_in["w_down"],
    }

def reference(A_x, A_wqkv, A_wo, B_x, B_w_gate, B_w_up, B_w_down):
    def _A_ref(x, wqkv, wo):
        B, S, D = x.shape
        H = 32; Dh = D // H
        qkv = (lambda x, *d: x.permute(*d))((x @ wqkv).reshape(B, S, 3, H, Dh), 2, 0, 3, 1, 4)
        q, k, v = qkv[0], qkv[1], qkv[2]
        phi = lambda t: torch.where(t > 0, t + 1, torch.exp(t)) + 1e-6
        pq, pk = phi(q), phi(k)
        kv = torch.einsum("bhsd,bhse->bhde", pk, v)
        z = torch.einsum("bhsd->bhd", pk)
        num = torch.einsum("bhqd,bhde->bhqe", pq, kv)
        den = torch.einsum("bhqd,bhd->bhq", pq, z)[..., None] + 1e-6
        o = num / den
        return (lambda x, *d: x.permute(*d))(o, 0, 2, 1, 3).reshape(B, S, D) @ wo

    def _B_ref(x, w_gate, w_up, w_down):
        return (_gelu(x @ w_gate) * (x @ w_up)) @ w_down

    x = A_x
    xn = _layernorm(x, axis=-1)
    s = _A_ref(xn, A_wqkv, A_wo)
    g = _silu(_B_ref(xn, B_w_gate, B_w_up, B_w_down))
    return x + s * g
```

```asm
; @launch grid=(256,1,1) block=(256,1,1) lds=163840
.amdgcn_target "amdgcn-amd-amdhsa--gfx950"
.text
.globl recurrent_scan__linear_attn_block__geglu_ffn__prompt_kernel
.p2align 8
.type recurrent_scan__linear_attn_block__geglu_ffn__prompt_kernel,@function
recurrent_scan__linear_attn_block__geglu_ffn__prompt_kernel:
 s_cmp_lt_u32 s2, 256
 s_cbranch_scc1 L_go
 s_endpgm
L_go:
 s_load_dwordx2 s[8:9], s[0:1], 0
 s_load_dwordx2 s[12:13], s[0:1], 8
 s_load_dwordx2 s[16:17], s[0:1], 32
 s_load_dwordx2 s[64:65], s[0:1], 40
 v_lshrrev_b32 v1, 6, v0
 v_and_b32 v2, 63, v0
 s_lshr_b32 s58, s2, 3
 s_lshr_b32 s6, s2, 2
 s_xor_b32 s6, s6, s2
 s_and_b32 s6, s6, 8
 s_mul_i32 s6, s6, 5
 s_xor_b32 s2, s2, s6
 s_bfe_u32 s6, s2, 0x20001
 s_and_b32 s7, s2, 1
 s_lshl2_add_u32 s6, s7, s6
 s_andn2_b32 s2, s2, 7
 s_or_b32 s2, s2, s6
 s_getpc_b64 s[72:73]
L_pc:
 v_min_u32 v3, 15, v2
 v_lshl_add_u32 v4, v1, 3, v3
 v_mov_b32 v5, v4
 s_lshl_b32 s6, s58, 5
 v_cmp_ne_u32 vcc, 0, v1
 s_bitcmp1_b32 s2, 5
 s_cselect_b32 s7, (L_tB-L_tA)/128, 0
 s_add_u32 s7, s7, (L_tA-L_pc)/128-8
 v_mov_b32 v6, s7
 v_add_u32 v5, s6, v5
 v_cndmask_b32 v6, 0, v6, vcc
 v_cmp_gt_u32 vcc, 8, v3
 v_add3_u32 v4, v4, v6, -8
    s_nop 0
 v_cndmask_b32 v4, v4, v5, vcc
 v_lshlrev_b32 v4, 7, v4
 v_min_u32 v4, L_cend-L_pc-4, v4
 global_load_dword v0, v4, s[72:73]
 v_readfirstlane_b32 s3, v1
 v_lshlrev_b32_e64 v1, 4, v2
 s_load_dwordx2 s[24:25], s[0:1], 72
 s_load_dwordx2 s[28:29], s[0:1], 48
 s_load_dwordx2 s[32:33], s[0:1], 16
 s_load_dwordx2 s[36:37], s[0:1], 56
 s_load_dwordx2 s[62:63], s[0:1], 64
 s_bfe_u32 s60, s2, 0x20001
 s_lshr_b32 s6, s2, 5
 s_lshl3_add_u32 s4, s60, s6
 s_and_b32 s23, s2, 1
 s_bfe_u32 s6, s2, 0x20003
 s_lshl2_add_u32 s5, s23, s6
 s_lshl_b32 s23, s23, 3
 s_lshr_b32 s52, s3, 1
 s_and_b32 s53, s3, 1
 s_cmp_eq_u32 s3, 0
 s_cbranch_scc1 L_pf0
 s_cmp_eq_u32 s3, 1
 s_cbranch_scc1 L_pf1
 s_mov_b32 s42, 7340032
 s_mov_b32 s59, 458752
 v_min_u32 v3, 27, v2
 v_cmp_le_u32 vcc, 14, v3
 s_lshl_b32 s6, s58, 1
 s_mul_i32 s7, s60, 1792
 v_cndmask_b32 v4, 0, 1, vcc
 v_mul_u32_u24 v5, 14, v4
 v_sub_u32 v5, v3, v5
 v_add_u32 v4, s6, v4
 v_lshl_add_u32 v5, v5, 7, s7
 s_movk_i32 s57, 7168
 v_mad_u32_u24 v32, v4, s57, v5
 s_waitcnt lgkmcnt(0)
 s_cmp_eq_u32 s3, 2
 s_cselect_b32 s40, s16, s64
 s_cselect_b32 s41, s17, s65
 s_branch L_pfd
L_pf1:
 s_mov_b32 s42, 6291456
 s_mov_b32 s59, 393216
 v_min_u32 v3, 23, v2
 v_cmp_le_u32 vcc, 12, v3
 s_lshl_b32 s6, s58, 1
 s_lshl_b32 s7, s60, 9
 v_cndmask_b32 v4, 0, 1, vcc
 v_mul_u32_u24 v5, 12, v4
 v_sub_u32 v5, v3, v5
 v_add_u32 v4, s6, v4
 v_lshrrev_b32 v6, 2, v5
 v_and_b32 v5, 3, v5
 v_lshl_add_u32 v5, v5, 7, s7
 v_lshl_add_u32 v5, v6, 11, v5
 s_movk_i32 s57, 6144
 v_mad_u32_u24 v32, v4, s57, v5
 s_waitcnt lgkmcnt(0)
 s_mov_b32 s40, s12
 s_mov_b32 s41, s13
 s_branch L_pfd
L_pf0:
 s_mov_b32 s42, 4194304
 s_mov_b32 s59, 128
 s_lshl2_add_u32 s6, s23, s58
 s_lshl_b32 s6, s6, 5
 v_min_u32 v4, 31, v2
 v_add_u32 v4, s6, v4
 v_lshlrev_b32 v32, 11, v4
 s_waitcnt lgkmcnt(0)
 s_mov_b32 s40, s8
 s_mov_b32 s41, s9
L_pfd:
 s_mov_b32 s43, 0x20000
 s_mul_i32 s58, s23, s59
 buffer_load_dword v0, v32, s[40:43], s58 offen
 s_add_u32 s58, s58, s59
 s_nop 0
 s_mov_b32 s18, 7340032
 s_mov_b32 s19, 0x20000
 s_mov_b32 s66, 7340032
 s_mov_b32 s67, 0x20000
 s_mov_b32 s10, 4194304
 s_mov_b32 s11, 0x20000
 s_mov_b32 s14, 6291456
 s_mov_b32 s15, 0x20000
 s_lshl_b32 s20, s23, 7
 s_mul_i32 s21, s23, 393216
 s_mul_i32 s22, s23, 458752
 s_lshl_b32 s54, s3, 13
 s_lshl_b32 s55, s3, 11
 s_add_u32 s55, s55, 32768
 s_lshl_b32 s56, s3, 10
 s_add_u32 s56, s56, 65536
 s_lshl_b32 s6, s5, 8
 s_lshl_b32 s7, s3, 6
 s_add_u32 s6, s6, s7
 v_lshrrev_b32 v3, 3, v2
 v_add_u32 v7, s6, v3
 v_lshlrev_b32 v7, 11, v7
 v_lshrrev_b32 v4, 4, v2
 v_and_b32 v5, 7, v2
 v_add_u32 v6, 0, v4
 v_xor_b32 v6, v6, v5
 v_lshl_add_u32 v6, v6, 4, v7
 v_add_u32_e64 v8, 0, v6
 v_add_u32 v10, 32768, v6
 v_add_u32 v12, 65536, v6
 v_add_u32 v14, 98304, v6
 v_add_u32 v6, 4, v4
 v_xor_b32 v6, v6, v5
 v_lshl_add_u32 v6, v6, 4, v7
 v_add_u32 v9, 16384, v6
 v_add_u32 v11, 49152, v6
 v_add_u32 v13, 81920, v6
 v_add_u32 v15, 114688, v6
 s_lshl_b32 s6, s52, 5
 s_lshl2_add_u32 s61, s53, s6
 v_and_b32 v3, 3, v3
 v_lshrrev_b32 v6, 5, v2
 v_lshl_add_u32 v3, v6, 3, v3
 v_add_u32 v3, s61, v3
 v_lshlrev_b32 v6, 1, v4
 v_xor_b32 v5, v5, v6
 v_lshlrev_b32 v5, 4, v5
 s_lshr_b32 s0, s4, 1
 s_and_b32 s1, s0, 1
 s_mul_i32 s6, s0, 448
 s_movk_i32 s57, 7168
 s_bitcmp1_b32 s2, 5
 s_cbranch_scc1 L_tB
 s_branch L_tA
L_tret:
 s_cmp_eq_u32 s100, 1
 s_cbranch_scc1 L_tr11
 s_branch L_tr01
 .p2align 12
L_tA:
 s_mul_i32 s7, s1, 320
 s_add_u32 s6, s6, s7
 v_add_u32 v6, s6, v5
 v_mad_u32_u24 v16, v3, s57, v6
 s_movk_i32 s57, 6144
 s_lshl_b32 s6, s0, 7
 v_add_u32 v17, 114688, v16
 v_add_u32_e64 v6, s6, v5
 v_mad_u32_u24 v18, v3, s57, v6
 s_branch L_tp_L_tA_0_o
L_tp_L_tA_0:
 s_nop 0
 s_branch L_tr00
 s_nop 0
L_tp_L_tA_0_o:
 v_add_u32 v19, 98304, v18
 v_add_u32 v20, 4096, v18
 v_add_u32 v21, 4096, v19
 s_add_u32 m0, s54, 0
    s_nop 0
 buffer_load_dwordx4 v8, s[8:11], s20 offen lds
 s_add_u32 m0, s54, 1024
    s_nop 0
 buffer_load_dwordx4 v9, s[8:11], s20 offen lds
 s_add_u32 m0, s54, 2048
    s_nop 0
 buffer_load_dwordx4 v10, s[8:11], s20 offen lds
 s_add_u32 m0, s54, 3072
    s_nop 0
 buffer_load_dwordx4 v11, s[8:11], s20 offen lds
 s_add_u32 m0, s54, 4096
    s_nop 0
 buffer_load_dwordx4 v12, s[8:11], s20 offen lds
 s_mov_b32 s26, 31457280
 s_mov_b32 s27, 0x20000
 s_mov_b32 s30, 7340032
 s_mov_b32 s31, 0x20000
 s_mov_b32 s34, 2097152
 s_mov_b32 s35, 0x20000
 s_mov_b32 s38, 4194304
 s_mov_b32 s39, 0x20000
 s_lshl2_add_u32 s6, s2, s3
 s_lshl_b32 s6, s6, 13
 s_add_u32 s6, s6, 20971520
 s_add_u32 s48, s24, s6
 s_addc_u32 s49, s25, 0
 s_mov_b32 s50, 4096
 s_mov_b32 s51, 0x20000
 s_mul_i32 s6, s2, 28672
 s_mul_i32 s7, s3, 9600
 s_add_u32 s6, s6, s7
 s_sub_u32 s7, 28672, s7
 s_min_u32 s7, s7, 9600
 s_lshl_b32 s0, s2, 13
 s_cmp_eq_u32 s3, 3
 s_cselect_b32 s6, s0, s6
 s_cselect_b32 s46, 8192, s7
 s_cselect_b32 s0, s32, s28
 s_cselect_b32 s1, s33, s29
 s_add_u32 s44, s0, s6
 s_addc_u32 s45, s1, 0
 s_mov_b32 s47, 0x20000
 v_and_b32 v3, 15, v2
 v_bfe_u32 v5, v3, 1, 3
 s_lshl_b32 s6, s53, 7
 v_add_u32 v7, s6, v3
 v_lshlrev_b32 v7, 7, v7
 v_add_u32 v6, 0, v4
 v_xor_b32 v6, v6, v5
 v_lshl_add_u32 v22, v6, 4, v7
 v_add_u32 v24, 73728, v22
 v_add_u32 v6, 4, v4
 v_xor_b32 v6, v6, v5
 v_lshl_add_u32 v23, v6, 4, v7
 v_add_u32 v25, 73728, v23
 s_mul_i32 s6, s3, 320
 v_lshl_add_u32 v5, v3, 6, s6
 v_lshl_add_u32 v5, v4, 4, v5
 v_cmp_gt_u32 vcc, 5, v3
 v_mov_b32 v6, 2146435072
 v_lshlrev_b32 v33, 7, v2
 v_cndmask_b32 v34, v6, v5, vcc
 v_cmp_gt_u32 vcc, 13, v2
 v_and_b32 v3, 3, v2
 v_lshlrev_b32 v3, 3, v3
 v_cndmask_b32 v33, v6, v33, vcc
 v_lshrrev_b32 v5, 2, v2
 v_add_u32 v3, 32768, v3
 v_lshl_add_u32 v6, v5, 7, v3
 v_bfe_u32 v7, v2, 3, 2
 s_lshl_b32 s6, s52, 1
 v_xor_b32 v7, s6, v7
 v_lshl_add_u32 v26, v7, 5, v6
 v_xor_b32_e64 v7, 1, v7
 v_lshl_add_u32 v28, v7, 5, v6
 v_add_u32 v27, 73728, v26
 v_add_u32 v29, 73728, v28
 s_bfe_u32 s68, s2, 0x20003
 s_lshl3_add_u32 s69, s4, s5
 s_mul_i32 s69, s69, 1280
 s_add_u32 s69, s69, 29360128
 s_mov_b32 s57, 0
 s_min_u32 s71, s68, 2
 s_add_u32 s71, s71, 9
 s_lshr_b32 s70, s71, 1
 s_lshl4_add_u32 s70, s3, s70
 s_and_b32 s71, s71, 1
 s_lshl3_add_u32 s70, s71, s70
 s_xor_b32 s71, s70, 8
 s_mov_b32 s60, 0
 s_mov_b32 s61, 1024
 s_lshl_b32 s0, s3, 12
 s_lshl_b32 s1, s2, 14
 s_add_u32 s1, s1, s0
 s_add_u32 s0, s0, 147456
 v_and_b32 v3, 15, v2
 v_cmp_eq_u32 vcc, 0, v3
 v_mov_b32 v3, 0x3f803f80
    s_nop 0
 v_cndmask_b32 v35, 0, v3, vcc
 v_mov_b64 v[4:5], -1
 v_mov_b64 v[6:7], -1
 s_mov_b32 s72, 0
L_cs0:
 s_cmp_eq_u32 s53, 0
 s_cbranch_scc0 L_cs0_1
 v_mfma_f32_16x16x32_bf16 v[40:43], a[64:67], v[44:47], v[40:43]
 v_mov_b32_dpp v36, v44 row_shr:1 row_mask:0xf bank_mask:0xf bound_ctrl:0
 v_mov_b32_dpp v37, v45 row_shr:1 row_mask:0xf bank_mask:0xf bound_ctrl:0
 v_mov_b64 v[38:39], v[36:37]
 v_mfma_f32_16x16x32_bf16 v[40:43], a[68:71], v[44:47], v[40:43]
    s_nop 0
 v_mfma_f32_16x16x32_bf16 v[40:43], a[72:75], v[36:39], v[40:43]
 v_mov_b32_dpp v44, v36 row_shr:1 row_mask:0xf bank_mask:0xf bound_ctrl:0
 v_mov_b32_dpp v45, v37 row_shr:1 row_mask:0xf bank_mask:0xf bound_ctrl:0
 v_mov_b64 v[46:47], v[44:45]
 v_mfma_f32_16x16x32_bf16 v[40:43], a[76:79], v[36:39], v[40:43]
    s_nop 0
 v_mfma_f32_16x16x32_bf16 v[40:43], a[80:83], v[44:47], v[40:43]
 v_mov_b32_dpp v36, v44 row_shr:1 row_mask:0xf bank_mask:0xf bound_ctrl:0
 v_mov_b32_dpp v37, v45 row_shr:1 row_mask:0xf bank_mask:0xf bound_ctrl:0
 v_mov_b64 v[38:39], v[36:37]
 v_mfma_f32_16x16x32_bf16 v[40:43], a[84:87], v[44:47], v[40:43]
    s_nop 0
 v_mfma_f32_16x16x32_bf16 v[40:43], a[88:91], v[36:39], v[40:43]
 v_mov_b32_dpp v44, v36 row_shr:1 row_mask:0xf bank_mask:0xf bound_ctrl:0
 v_mov_b32_dpp v45, v37 row_shr:1 row_mask:0xf bank_mask:0xf bound_ctrl:0
 v_mov_b64 v[46:47], v[44:45]
 v_mfma_f32_16x16x32_bf16 v[40:43], a[92:95], v[36:39], v[40:43]
    s_nop 0
 v_mfma_f32_16x16x32_bf16 v[40:43], a[96:99], v[44:47], v[40:43]
 s_cmp_eq_u32 s72, 3
 v_mfma_f32_16x16x32_bf16 v[40:43], a[100:103], v[44:47], v[40:43]
 s_cbranch_scc1 L_cs0_d3
 s_cmp_eq_u32 s72, 2
 s_cbranch_scc1 L_cs0_d2
 s_cmp_eq_u32 s72, 1
 s_cbranch_scc1 L_cs0_d1
 s_branch L_cs0_d0
L_cs0_1:
 v_mfma_f32_16x16x32_bf16 v[40:43], a[104:107], v[44:47], v[40:43]
 v_mov_b32_dpp v36, v44 row_shr:1 row_mask:0xf bank_mask:0xf bound_ctrl:0
 v_mov_b32_dpp v37, v45 row_shr:1 row_mask:0xf bank_mask:0xf bound_ctrl:0
 v_mov_b64 v[38:39], v[36:37]
 v_mfma_f32_16x16x32_bf16 v[40:43], a[108:111], v[44:47], v[40:43]
    s_nop 0
 v_mfma_f32_16x16x32_bf16 v[40:43], a[112:115], v[36:39], v[40:43]
 v_mov_b32_dpp v44, v36 row_shr:1 row_mask:0xf bank_mask:0xf bound_ctrl:0
 v_mov_b32_dpp v45, v37 row_shr:1 row_mask:0xf bank_mask:0xf bound_ctrl:0
 v_mov_b64 v[46:47], v[44:45]
 v_mfma_f32_16x16x32_bf16 v[40:43], a[116:119], v[36:39], v[40:43]
    s_nop 0
 v_mfma_f32_16x16x32_bf16 v[40:43], a[120:123], v[44:47], v[40:43]
 v_mov_b32_dpp v36, v44 row_shr:1 row_mask:0xf bank_mask:0xf bound_ctrl:0
 v_mov_b32_dpp v37, v45 row_shr:1 row_mask:0xf bank_mask:0xf bound_ctrl:0
 v_mov_b64 v[38:39], v[36:37]
 v_mfma_f32_16x16x32_bf16 v[40:43], a[124:127], v[44:47], v[40:43]
    s_nop 0
 v_mfma_f32_16x16x32_bf16 v[40:43], a[128:131], v[36:39], v[40:43]
 v_mov_b32_dpp v44, v36 row_shr:1 row_mask:0xf bank_mask:0xf bound_ctrl:0
 v_mov_b32_dpp v45, v37 row_shr:1 row_mask:0xf bank_mask:0xf bound_ctrl:0
 v_mov_b64 v[46:47], v[44:45]
 v_mfma_f32_16x16x32_bf16 v[40:43], a[132:135], v[36:39], v[40:43]
    s_nop 0
 v_mfma_f32_16x16x32_bf16 v[40:43], a[136:139], v[44:47], v[40:43]
 s_cmp_eq_u32 s72, 3
 v_mfma_f32_16x16x32_bf16 v[40:43], a[140:143], v[44:47], v[40:43]
 s_cbranch_scc1 L_cs0_d3
 s_cmp_eq_u32 s72, 2
 s_cbranch_scc1 L_cs0_d2
 s_cmp_eq_u32 s72, 1
 s_cbranch_scc1 L_cs0_d1
L_cs0_d0:
 s_cmp_eq_u32 s3, 0
 s_cbranch_scc1 L_tp_L_tA_1
 s_cmp_eq_u32 s3, 1
 s_cbranch_scc1 L_tp_L_tA_2
 s_cmp_eq_u32 s3, 2
 s_cbranch_scc1 L_tp_L_tA_3
 s_branch L_tp_L_tA_4
L_tr00:
 s_add_u32 m0, s54, 5120
    s_nop 0
 buffer_load_dwordx4 v13, s[8:11], s20 offen lds
 s_add_u32 m0, s54, 6144
    s_nop 0
 buffer_load_dwordx4 v14, s[8:11], s20 offen lds
 s_add_u32 m0, s54, 7168
    s_nop 0
 buffer_load_dwordx4 v15, s[8:11], s20 offen lds
 s_add_u32 m0, s55, 0
    s_nop 0
 buffer_load_dwordx4 v16, s[16:19], s22 offen lds
 s_add_u32 m0, s55, 1024
    s_nop 0
 buffer_load_dwordx4 v17, s[16:19], s22 offen lds
 s_add_u32 m0, s55, 8192
    s_nop 0
 buffer_load_dwordx4 v16, s[64:67], s22 offen lds
 s_add_u32 m0, s55, 9216
    s_nop 0
 buffer_load_dwordx4 v17, s[64:67], s22 offen lds
 s_add_u32 m0, s55, 16384
    s_nop 0
 buffer_load_dwordx4 v18, s[12:15], s21 offen lds
 s_add_u32 m0, s55, 17408
    s_nop 0
 buffer_load_dwordx4 v19, s[12:15], s21 offen lds
 s_add_u32 m0, s55, 22528
    s_nop 0
 buffer_load_dwordx4 v18, s[12:15], s21 offen offset:2048 lds
 s_add_u32 m0, s55, 23552
    s_nop 0
 buffer_load_dwordx4 v19, s[12:15], s21 offen offset:2048 lds
 s_add_u32 m0, s55, 32768
    s_nop 0
 buffer_load_dwordx4 v20, s[12:15], s21 offen lds
 s_add_u32 m0, s55, 33792
    s_nop 0
 buffer_load_dwordx4 v21, s[12:15], s21 offen lds
 v_mov_b64 v[40:41], 0
 v_mov_b64 v[42:43], 0
 s_barrier
 buffer_load_dword v0, v32, s[40:43], s58 offen
 s_add_u32 s23, s23, 1
 s_and_b32 s23, s23, 15
 s_mul_i32 s22, s23, 458752
 s_mul_i32 s21, s23, 393216
 s_lshl_b32 s20, s23, 7
 s_mov_b32 s100, 0
 s_bitcmp1_b32 s2, 2
 s_cselect_b32 s6, 2, 0
 s_cmp_lt_u32 s3, 2
 s_cselect_b32 s6, 0, s6
 s_add_u32 s6, s6, s3
 s_cmp_eq_u32 s6, 0
 s_cbranch_scc1 L_tp_L_tA_9
 s_cmp_eq_u32 s6, 1
 s_cbranch_scc1 L_tp_L_tA_10
 s_cmp_eq_u32 s6, 2
 s_cbranch_scc1 L_tp_L_tail0_0
 s_cmp_eq_u32 s6, 3
 s_cbranch_scc1 L_tp_L_tail0_1
 s_cmp_eq_u32 s6, 4
 s_cbranch_scc1 L_tp_L_tail1_0
 s_branch L_tp_L_tail1_1
L_tr01:
 s_waitcnt vmcnt(1)
 s_barrier
 s_nop 0
 ds_read_b128 a[0:3], v22 offset:0
 ds_read_b128 a[4:7], v23 offset:0
 ds_read_b64_tr_b16 a[64:65], v26 offset:0
 ds_read_b64_tr_b16 a[66:67], v26 offset:2048
 ds_read_b64_tr_b16 a[68:69], v26 offset:4096
 ds_read_b64_tr_b16 a[70:71], v26 offset:6144
 ds_read_b128 a[8:11], v22 offset:2048
 ds_read_b128 a[12:15], v23 offset:2048
 ds_read_b128 a[16:19], v22 offset:4096
 ds_read_b128 a[20:23], v23 offset:4096
 ds_read_b128 a[24:27], v22 offset:6144
 ds_read_b128 a[28:31], v23 offset:6144
 ds_read_b64_tr_b16 a[72:73], v26 offset:8192
 ds_read_b64_tr_b16 a[74:75], v26 offset:10240
 ds_read_b64_tr_b16 a[76:77], v26 offset:12288
 ds_read_b64_tr_b16 a[78:79], v26 offset:14336
 s_waitcnt lgkmcnt(4)
 v_mfma_f32_16x16x32_bf16 v[48:51], a[64:67], a[0:3], 0
 s_add_u32 s58, s23, 1
 ds_read_b64_tr_b16 a[80:81], v28 offset:0
 v_mfma_f32_16x16x32_bf16 v[48:51], a[68:71], a[4:7], v[48:51]
 s_and_b32 s58, s58, 15
 ds_read_b64_tr_b16 a[82:83], v28 offset:2048
 v_mfma_f32_16x16x32_bf16 v[52:55], a[68:71], a[12:15], 0
 s_mul_i32 s58, s58, s59
 ds_read_b64_tr_b16 a[84:85], v28 offset:4096
 v_mfma_f32_16x16x32_bf16 v[52:55], a[64:67], a[8:11], v[52:55]
 ds_read_b64_tr_b16 a[86:87], v28 offset:6144
 v_mfma_f32_16x16x32_bf16 v[56:59], a[64:67], a[16:19], 0
 ds_read_b128 a[32:35], v22 offset:8192
 v_mfma_f32_16x16x32_bf16 v[56:59], a[68:71], a[20:23], v[56:59]
 v_mfma_f32_16x16x32_bf16 v[60:63], a[68:71], a[28:31], 0
 v_mfma_f32_16x16x32_bf16 v[60:63], a[64:67], a[24:27], v[60:63]
 s_waitcnt lgkmcnt(5)
 v_mfma_f32_16x16x32_bf16 v[92:95], a[72:75], a[24:27], 0
 ds_read_b64_tr_b16 a[88:89], v28 offset:8192
 v_mfma_f32_16x16x32_bf16 v[92:95], a[76:79], a[28:31], v[92:95]
 ds_read_b64_tr_b16 a[90:91], v28 offset:10240
 v_mfma_f32_16x16x32_bf16 v[88:91], a[76:79], a[20:23], 0
 ds_read_b64_tr_b16 a[92:93], v28 offset:12288
 v_mfma_f32_16x16x32_bf16 v[88:91], a[72:75], a[16:19], v[88:91]
 ds_read_b64_tr_b16 a[94:95], v28 offset:14336
 v_mfma_f32_16x16x32_bf16 v[84:87], a[72:75], a[8:11], 0
 ds_read_b128 a[36:39], v23 offset:8192
 v_mfma_f32_16x16x32_bf16 v[84:87], a[76:79], a[12:15], v[84:87]
 v_mfma_f32_16x16x32_bf16 v[80:83], a[76:79], a[4:7], 0
 v_mfma_f32_16x16x32_bf16 v[80:83], a[72:75], a[0:3], v[80:83]
 s_add_u32 m0, s54, 73728
 s_waitcnt lgkmcnt(5)
 v_mfma_f32_16x16x32_bf16 v[112:115], a[80:83], a[0:3], 0
 buffer_load_dwordx4 v8, s[8:11], s20 offen lds
 ds_read_b64_tr_b16 a[96:97], v26 offset:16384
 v_mfma_f32_16x16x32_bf16 v[112:115], a[84:87], a[4:7], v[112:115]
 ds_read_b64_tr_b16 a[98:99], v26 offset:18432
 v_mfma_f32_16x16x32_bf16 v[116:119], a[84:87], a[12:15], 0
 s_add_u32 m0, s54, 74752
 ds_read_b64_tr_b16 a[100:101], v26 offset:20480
 v_mfma_f32_16x16x32_bf16 v[116:119], a[80:83], a[8:11], v[116:119]
 buffer_load_dwordx4 v9, s[8:11], s20 offen lds
 v_mfma_f32_16x16x32_bf16 v[120:123], a[80:83], a[16:19], 0
 ds_read_b64_tr_b16 a[102:103], v26 offset:22528
 v_mfma_f32_16x16x32_bf16 v[120:123], a[84:87], a[20:23], v[120:123]
 s_add_u32 m0, s54, 75776
 ds_read_b128 a[40:43], v22 offset:10240
 v_mfma_f32_16x16x32_bf16 v[124:127], a[84:87], a[28:31], 0
 buffer_load_dwordx4 v10, s[8:11], s20 offen lds
 v_mfma_f32_16x16x32_bf16 v[124:127], a[80:83], a[24:27], v[124:127]
 s_waitcnt lgkmcnt(5)
 v_mfma_f32_16x16x32_bf16 v[156:159], a[88:91], a[24:27], 0
 s_add_u32 m0, s54, 76800
 ds_read_b64_tr_b16 a[104:105], v28 offset:16384
 v_mfma_f32_16x16x32_bf16 v[156:159], a[92:95], a[28:31], v[156:159]
 buffer_load_dwordx4 v11, s[8:11], s20 offen lds
 v_mfma_f32_16x16x32_bf16 v[152:155], a[92:95], a[20:23], 0
 ds_read_b64_tr_b16 a[106:107], v28 offset:18432
 v_mfma_f32_16x16x32_bf16 v[152:155], a[88:91], a[16:19], v[152:155]
 s_add_u32 m0, s54, 77824
 ds_read_b64_tr_b16 a[108:109], v28 offset:20480
 v_mfma_f32_16x16x32_bf16 v[148:151], a[88:91], a[8:11], 0
 buffer_load_dwordx4 v12, s[8:11], s20 offen lds
 v_mfma_f32_16x16x32_bf16 v[148:151], a[92:95], a[12:15], v[148:151]
 ds_read_b64_tr_b16 a[110:111], v28 offset:22528
 v_mfma_f32_16x16x32_bf16 v[144:147], a[92:95], a[4:7], 0
 s_add_u32 m0, s54, 78848
 ds_read_b128 a[44:47], v23 offset:10240
 v_mfma_f32_16x16x32_bf16 v[144:147], a[88:91], a[0:3], v[144:147]
 s_waitcnt lgkmcnt(5)
 buffer_load_dwordx4 v13, s[8:11], s20 offen lds
 v_mfma_f32_16x16x32_bf16 v[176:179], a[96:99], a[0:3], 0
 ds_read_b64_tr_b16 a[112:113], v26 offset:24576
 v_mfma_f32_16x16x32_bf16 v[176:179], a[100:103], a[4:7], v[176:179]
 s_add_u32 m0, s54, 79872
 ds_read_b64_tr_b16 a[114:115], v26 offset:26624
 v_mfma_f32_16x16x32_bf16 v[180:183], a[100:103], a[12:15], 0
 buffer_load_dwordx4 v14, s[8:11], s20 offen lds
 v_mfma_f32_16x16x32_bf16 v[180:183], a[96:99], a[8:11], v[180:183]
 ds_read_b64_tr_b16 a[116:117], v26 offset:28672
 v_mfma_f32_16x16x32_bf16 v[184:187], a[96:99], a[16:19], 0
 s_add_u32 m0, s54, 80896
 ds_read_b64_tr_b16 a[118:119], v26 offset:30720
 v_mfma_f32_16x16x32_bf16 v[184:187], a[100:103], a[20:23], v[184:187]
 buffer_load_dwordx4 v15, s[8:11], s20 offen lds
 v_mfma_f32_16x16x32_bf16 v[188:191], a[100:103], a[28:31], 0
 ds_read_b128 a[48:51], v22 offset:12288
 v_mfma_f32_16x16x32_bf16 v[188:191], a[96:99], a[24:27], v[188:191]
 s_add_u32 m0, s55, 73728
 s_waitcnt lgkmcnt(5)
 v_mfma_f32_16x16x32_bf16 v[220:223], a[104:107], a[24:27], 0
 buffer_load_dwordx4 v16, s[16:19], s22 offen lds
 ds_read_b64_tr_b16 a[120:121], v28 offset:24576
 v_mfma_f32_16x16x32_bf16 v[220:223], a[108:111], a[28:31], v[220:223]
 ds_read_b64_tr_b16 a[122:123], v28 offset:26624
 v_mfma_f32_16x16x32_bf16 v[216:219], a[108:111], a[20:23], 0
 s_add_u32 m0, s55, 74752
 ds_read_b64_tr_b16 a[124:125], v28 offset:28672
 v_mfma_f32_16x16x32_bf16 v[216:219], a[104:107], a[16:19], v[216:219]
 buffer_load_dwordx4 v17, s[16:19], s22 offen lds
 v_mfma_f32_16x16x32_bf16 v[212:215], a[104:107], a[8:11], 0
 ds_read_b64_tr_b16 a[126:127], v28 offset:30720
 v_mfma_f32_16x16x32_bf16 v[212:215], a[108:111], a[12:15], v[212:215]
 s_add_u32 m0, s55, 81920
 ds_read_b128 a[52:55], v23 offset:12288
 v_mfma_f32_16x16x32_bf16 v[208:211], a[108:111], a[4:7], 0
 buffer_load_dwordx4 v16, s[64:67], s22 offen lds
 v_mfma_f32_16x16x32_bf16 v[208:211], a[104:107], a[0:3], v[208:211]
 s_waitcnt lgkmcnt(5)
 v_mfma_f32_16x16x32_bf16 v[240:243], a[0:3], a[112:115], 0
 s_add_u32 m0, s55, 82944
 ds_read_b64_tr_b16 a[128:129], v26 offset:32768
 v_mfma_f32_16x16x32_bf16 v[240:243], a[4:7], a[116:119], v[240:243]
 buffer_load_dwordx4 v17, s[64:67], s22 offen lds
 v_mfma_f32_16x16x32_bf16 v[244:247], a[12:15], a[116:119], 0
 ds_read_b64_tr_b16 a[130:131], v26 offset:34816
 v_mfma_f32_16x16x32_bf16 v[244:247], a[8:11], a[112:115], v[244:247]
 s_add_u32 m0, s55, 90112
 ds_read_b64_tr_b16 a[132:133], v26 offset:36864
 v_mfma_f32_16x16x32_bf16 v[248:251], a[16:19], a[112:115], 0
 buffer_load_dwordx4 v18, s[12:15], s21 offen lds
 v_mfma_f32_16x16x32_bf16 v[248:251], a[20:23], a[116:119], v[248:251]
 ds_read_b64_tr_b16 a[134:135], v26 offset:38912
 v_mfma_f32_16x16x32_bf16 v[252:255], a[28:31], a[116:119], 0
 s_add_u32 m0, s55, 91136
 ds_read_b128 a[56:59], v22 offset:14336
 v_mfma_f32_16x16x32_bf16 v[252:255], a[24:27], a[112:115], v[252:255]
 s_waitcnt lgkmcnt(5)
 buffer_load_dwordx4 v19, s[12:15], s21 offen lds
 v_mfma_f32_16x16x32_bf16 a[172:175], a[24:27], a[120:123], 0
 ds_read_b64_tr_b16 a[136:137], v28 offset:32768
 v_mfma_f32_16x16x32_bf16 a[172:175], a[28:31], a[124:127], a[172:175]
 s_add_u32 m0, s55, 96256
 ds_read_b64_tr_b16 a[138:139], v28 offset:34816
 v_mfma_f32_16x16x32_bf16 a[168:171], a[20:23], a[124:127], 0
 buffer_load_dwordx4 v18, s[12:15], s21 offen offset:2048 lds
 v_mfma_f32_16x16x32_bf16 a[168:171], a[16:19], a[120:123], a[168:171]
 ds_read_b64_tr_b16 a[140:141], v28 offset:36864
 v_mfma_f32_16x16x32_bf16 a[164:167], a[8:11], a[120:123], 0
 s_add_u32 m0, s55, 97280
 ds_read_b64_tr_b16 a[142:143], v28 offset:38912
 v_mfma_f32_16x16x32_bf16 a[164:167], a[12:15], a[124:127], a[164:167]
 buffer_load_dwordx4 v19, s[12:15], s21 offen offset:2048 lds
 v_mfma_f32_16x16x32_bf16 a[160:163], a[4:7], a[124:127], 0
 s_mov_b32 s72, 1
 ds_read_b128 a[60:63], v23 offset:14336
 v_mfma_f32_16x16x32_bf16 a[160:163], a[0:3], a[120:123], a[160:163]
 s_add_u32 m0, s55, 106496
 s_waitcnt lgkmcnt(5)
 v_mfma_f32_16x16x32_bf16 a[192:195], a[0:3], a[128:131], 0
 buffer_load_dwordx4 v20, s[12:15], s21 offen lds
 v_mfma_f32_16x16x32_bf16 a[192:195], a[4:7], a[132:135], a[192:195]
 v_mfma_f32_16x16x32_bf16 a[196:199], a[12:15], a[132:135], 0
 s_add_u32 m0, s55, 107520
 v_mov_b32 v44, v35
 v_mfma_f32_16x16x32_bf16 a[196:199], a[8:11], a[128:131], a[196:199]
 buffer_load_dwordx4 v21, s[12:15], s21 offen lds
 v_mfma_f32_16x16x32_bf16 a[200:203], a[16:19], a[128:131], 0
 s_add_u32 s23, s23, 1
 s_and_b32 s23, s23, 15
 s_mul_i32 s22, s23, 458752
 v_mov_b32 v45, v35
 v_mfma_f32_16x16x32_bf16 a[200:203], a[20:23], a[132:135], a[200:203]
 s_mul_i32 s21, s23, 393216
 s_lshl_b32 s20, s23, 7
 v_mfma_f32_16x16x32_bf16 a[204:207], a[28:31], a[132:135], 0
 v_mov_b32 v46, v35
 v_mfma_f32_16x16x32_bf16 a[204:207], a[24:27], a[128:131], a[204:207]
 s_waitcnt lgkmcnt(0)
 v_mfma_f32_16x16x32_bf16 a[236:239], a[24:27], a[136:139], 0
 buffer_load_dword v0, v32, s[40:43], s58 offen
 v_mov_b32 v47, v35
 v_mfma_f32_16x16x32_bf16 a[236:239], a[28:31], a[140:143], a[236:239]
 v_mfma_f32_16x16x32_bf16 a[232:235], a[20:23], a[140:143], 0
 v_mfma_f32_16x16x32_bf16 a[232:235], a[16:19], a[136:139], a[232:235]
 v_mfma_f32_16x16x32_bf16 a[228:231], a[8:11], a[136:139], 0
 v_mfma_f32_16x16x32_bf16 a[228:231], a[12:15], a[140:143], a[228:231]
 v_mfma_f32_16x16x32_bf16 a[224:227], a[4:7], a[140:143], 0
 s_cmp_eq_u32 s57, s68
 v_mfma_f32_16x16x32_bf16 a[224:227], a[0:3], a[136:139], a[224:227]
 s_cbranch_scc1 L_cs0
L_cs0_d1:
 v_mfma_f32_16x16x32_bf16 v[64:67], a[64:67], a[32:35], 0
 s_barrier
 v_mfma_f32_16x16x32_bf16 v[64:67], a[68:71], a[36:39], v[64:67]
 v_mfma_f32_16x16x32_bf16 v[68:71], a[68:71], a[44:47], 0
 v_mfma_f32_16x16x32_bf16 v[68:71], a[64:67], a[40:43], v[68:71]
 v_mfma_f32_16x16x32_bf16 v[72:75], a[64:67], a[48:51], 0
 v_mfma_f32_16x16x32_bf16 v[72:75], a[68:71], a[52:55], v[72:75]
 v_mfma_f32_16x16x32_bf16 v[76:79], a[68:71], a[60:63], 0
 v_mfma_f32_16x16x32_bf16 v[76:79], a[64:67], a[56:59], v[76:79]
 v_mfma_f32_16x16x32_bf16 v[108:111], a[72:75], a[56:59], 0
 v_mfma_f32_16x16x32_bf16 v[108:111], a[76:79], a[60:63], v[108:111]
 v_mfma_f32_16x16x32_bf16 v[104:107], a[76:79], a[52:55], 0
 v_mfma_f32_16x16x32_bf16 v[104:107], a[72:75], a[48:51], v[104:107]
 v_mfma_f32_16x16x32_bf16 v[100:103], a[72:75], a[40:43], 0
 v_mfma_f32_16x16x32_bf16 v[100:103], a[76:79], a[44:47], v[100:103]
 v_mfma_f32_16x16x32_bf16 v[96:99], a[76:79], a[36:39], 0
 v_mfma_f32_16x16x32_bf16 v[96:99], a[72:75], a[32:35], v[96:99]
 v_mfma_f32_16x16x32_bf16 v[128:131], a[80:83], a[32:35], 0
 v_mfma_f32_16x16x32_bf16 v[128:131], a[84:87], a[36:39], v[128:131]
 s_add_u32 m0, s54, 0
 v_mfma_f32_16x16x32_bf16 v[132:135], a[84:87], a[44:47], 0
 buffer_load_dwordx4 v8, s[8:11], s20 offen lds
 v_mfma_f32_16x16x32_bf16 v[132:135], a[80:83], a[40:43], v[132:135]
 v_mfma_f32_16x16x32_bf16 v[136:139], a[80:83], a[48:51], 0
 v_mfma_f32_16x16x32_bf16 v[136:139], a[84:87], a[52:55], v[136:139]
 v_mfma_f32_16x16x32_bf16 v[140:143], a[84:87], a[60:63], 0
 s_add_u32 m0, s54, 1024
 v_mfma_f32_16x16x32_bf16 v[140:143], a[80:83], a[56:59], v[140:143]
 buffer_load_dwordx4 v9, s[8:11], s20 offen lds
 v_mfma_f32_16x16x32_bf16 v[172:175], a[88:91], a[56:59], 0
 v_mfma_f32_16x16x32_bf16 v[172:175], a[92:95], a[60:63], v[172:175]
 v_mfma_f32_16x16x32_bf16 v[168:171], a[92:95], a[52:55], 0
 v_mfma_f32_16x16x32_bf16 v[168:171], a[88:91], a[48:51], v[168:171]
 s_add_u32 m0, s54, 2048
 v_mfma_f32_16x16x32_bf16 v[164:167], a[88:91], a[40:43], 0
 buffer_load_dwordx4 v10, s[8:11], s20 offen lds
 v_mfma_f32_16x16x32_bf16 v[164:167], a[92:95], a[44:47], v[164:167]
 v_mfma_f32_16x16x32_bf16 v[160:163], a[92:95], a[36:39], 0
 v_mfma_f32_16x16x32_bf16 v[160:163], a[88:91], a[32:35], v[160:163]
 v_mfma_f32_16x16x32_bf16 v[192:195], a[96:99], a[32:35], 0
 s_add_u32 m0, s54, 3072
 v_mfma_f32_16x16x32_bf16 v[192:195], a[100:103], a[36:39], v[192:195]
 buffer_load_dwordx4 v11, s[8:11], s20 offen lds
 v_mfma_f32_16x16x32_bf16 v[196:199], a[100:103], a[44:47], 0
 v_mfma_f32_16x16x32_bf16 v[196:199], a[96:99], a[40:43], v[196:199]
 v_mfma_f32_16x16x32_bf16 v[200:203], a[96:99], a[48:51], 0
 v_mfma_f32_16x16x32_bf16 v[200:203], a[100:103], a[52:55], v[200:203]
 s_add_u32 m0, s54, 4096
 v_mfma_f32_16x16x32_bf16 v[204:207], a[100:103], a[60:63], 0
 buffer_load_dwordx4 v12, s[8:11], s20 offen lds
 v_mfma_f32_16x16x32_bf16 v[204:207], a[96:99], a[56:59], v[204:207]
 v_mfma_f32_16x16x32_bf16 v[236:239], a[104:107], a[56:59], 0
 s_waitcnt vmcnt(6)
 s_barrier
 ds_read_b128 a[0:3], v24 offset:0
 ds_read_b128 a[4:7], v25 offset:0
 v_mfma_f32_16x16x32_bf16 v[236:239], a[108:111], a[60:63], v[236:239]
 ds_read_b128 a[8:11], v24 offset:2048
 v_mfma_f32_16x16x32_bf16 v[232:235], a[108:111], a[52:55], 0
 s_add_u32 m0, s54, 5120
 ds_read_b128 a[12:15], v25 offset:2048
 v_mfma_f32_16x16x32_bf16 v[232:235], a[104:107], a[48:51], v[232:235]
 buffer_load_dwordx4 v13, s[8:11], s20 offen lds
 ds_read_b128 a[16:19], v24 offset:4096
 v_mfma_f32_16x16x32_bf16 v[228:231], a[104:107], a[40:43], 0
 ds_read_b128 a[20:23], v25 offset:4096
 v_mfma_f32_16x16x32_bf16 v[228:231], a[108:111], a[44:47], v[228:231]
 ds_read_b128 a[24:27], v24 offset:6144
 v_mfma_f32_16x16x32_bf16 v[224:227], a[108:111], a[36:39], 0
 ds_read_b128 a[28:31], v25 offset:6144
 v_mfma_f32_16x16x32_bf16 v[224:227], a[104:107], a[32:35], v[224:227]
 s_add_u32 m0, s54, 6144
 ds_read_b64_tr_b16 a[64:65], v27 offset:0
 v_mfma_f32_16x16x32_bf16 a[144:147], a[32:35], a[112:115], 0
 buffer_load_dwordx4 v14, s[8:11], s20 offen lds
 ds_read_b64_tr_b16 a[66:67], v27 offset:2048
 v_mfma_f32_16x16x32_bf16 a[144:147], a[36:39], a[116:119], a[144:147]
 ds_read_b64_tr_b16 a[68:69], v27 offset:4096
 v_mfma_f32_16x16x32_bf16 a[148:151], a[44:47], a[116:119], 0
 ds_read_b64_tr_b16 a[70:71], v27 offset:6144
 ds_read_b64_tr_b16 a[72:73], v27 offset:8192
 v_mfma_f32_16x16x32_bf16 a[148:151], a[40:43], a[112:115], a[148:151]
 ds_read_b64_tr_b16 a[74:75], v27 offset:10240
 v_mfma_f32_16x16x32_bf16 a[152:155], a[48:51], a[112:115], 0
 s_add_u32 m0, s54, 7168
 ds_read_b64_tr_b16 a[76:77], v27 offset:12288
 v_mfma_f32_16x16x32_bf16 a[152:155], a[52:55], a[116:119], a[152:155]
 buffer_load_dwordx4 v15, s[8:11], s20 offen lds
 ds_read_b64_tr_b16 a[78:79], v27 offset:14336
 v_mfma_f32_16x16x32_bf16 a[156:159], a[60:63], a[116:119], 0
 ds_read_b64_tr_b16 a[80:81], v29 offset:0
 v_mfma_f32_16x16x32_bf16 a[156:159], a[56:59], a[112:115], a[156:159]
 ds_read_b64_tr_b16 a[82:83], v29 offset:2048
 v_mfma_f32_16x16x32_bf16 a[188:191], a[56:59], a[120:123], 0
 ds_read_b64_tr_b16 a[84:85], v29 offset:4096
 v_mfma_f32_16x16x32_bf16 a[188:191], a[60:63], a[124:127], a[188:191]
 s_add_u32 m0, s55, 0
 ds_read_b64_tr_b16 a[86:87], v29 offset:6144
 v_mfma_f32_16x16x32_bf16 a[184:187], a[52:55], a[124:127], 0
 buffer_load_dwordx4 v16, s[16:19], s22 offen lds
 ds_read_b64_tr_b16 a[88:89], v29 offset:8192
 v_mfma_f32_16x16x32_bf16 a[184:187], a[48:51], a[120:123], a[184:187]
 ds_read_b64_tr_b16 a[90:91], v29 offset:10240
 v_mfma_f32_16x16x32_bf16 a[180:183], a[40:43], a[120:123], 0
 ds_read_b64_tr_b16 a[92:93], v29 offset:12288
 ds_read_b64_tr_b16 a[94:95], v29 offset:14336
 v_mfma_f32_16x16x32_bf16 a[180:183], a[44:47], a[124:127], a[180:183]
 ds_read_b64_tr_b16 a[96:97], v27 offset:16384
 v_mfma_f32_16x16x32_bf16 a[176:179], a[36:39], a[124:127], 0
 s_add_u32 m0, s55, 1024
 ds_read_b64_tr_b16 a[98:99], v27 offset:18432
 v_mfma_f32_16x16x32_bf16 a[176:179], a[32:35], a[120:123], a[176:179]
 buffer_load_dwordx4 v17, s[16:19], s22 offen lds
 ds_read_b64_tr_b16 a[100:101], v27 offset:20480
 v_mfma_f32_16x16x32_bf16 a[208:211], a[32:35], a[128:131], 0
 ds_read_b64_tr_b16 a[102:103], v27 offset:22528
 v_mfma_f32_16x16x32_bf16 a[208:211], a[36:39], a[132:135], a[208:211]
 ds_read_b64_tr_b16 a[104:105], v29 offset:16384
 v_mfma_f32_16x16x32_bf16 a[212:215], a[44:47], a[132:135], 0
 ds_read_b64_tr_b16 a[106:107], v29 offset:18432
 v_mfma_f32_16x16x32_bf16 a[212:215], a[40:43], a[128:131], a[212:215]
 s_add_u32 m0, s55, 8192
 ds_read_b64_tr_b16 a[108:109], v29 offset:20480
 v_mfma_f32_16x16x32_bf16 a[216:219], a[48:51], a[128:131], 0
 buffer_load_dwordx4 v16, s[64:67], s22 offen lds
 ds_read_b64_tr_b16 a[110:111], v29 offset:22528
 v_mfma_f32_16x16x32_bf16 a[216:219], a[52:55], a[132:135], a[216:219]
 ds_read_b64_tr_b16 a[112:113], v27 offset:24576
 v_mfma_f32_16x16x32_bf16 a[220:223], a[60:63], a[132:135], 0
 ds_read_b64_tr_b16 a[114:115], v27 offset:26624
 ds_read_b64_tr_b16 a[116:117], v27 offset:28672
 v_mfma_f32_16x16x32_bf16 a[220:223], a[56:59], a[128:131], a[220:223]
 ds_read_b64_tr_b16 a[118:119], v27 offset:30720
 v_mfma_f32_16x16x32_bf16 a[252:255], a[56:59], a[136:139], 0
 s_add_u32 m0, s55, 9216
 ds_read_b64_tr_b16 a[120:121], v29 offset:24576
 v_mfma_f32_16x16x32_bf16 a[252:255], a[60:63], a[140:143], a[252:255]
 buffer_load_dwordx4 v17, s[64:67], s22 offen lds
 ds_read_b64_tr_b16 a[122:123], v29 offset:26624
 v_mfma_f32_16x16x32_bf16 a[248:251], a[52:55], a[140:143], 0
 ds_read_b64_tr_b16 a[124:125], v29 offset:28672
 v_mfma_f32_16x16x32_bf16 a[248:251], a[48:51], a[136:139], a[248:251]
 ds_read_b64_tr_b16 a[126:127], v29 offset:30720
 s_branch L_tp_L_tA_1_o
L_tp_L_tA_1:
 s_nop 0
 s_branch L_tp_L_tA_5
 s_nop 0
L_tp_L_tA_1_o:
 v_mfma_f32_16x16x32_bf16 a[244:247], a[40:43], a[136:139], 0
 ds_read_b64_tr_b16 a[128:129], v27 offset:32768
 v_mfma_f32_16x16x32_bf16 a[244:247], a[44:47], a[140:143], a[244:247]
 s_add_u32 m0, s55, 16384
 ds_read_b64_tr_b16 a[130:131], v27 offset:34816
 v_mfma_f32_16x16x32_bf16 a[240:243], a[36:39], a[140:143], 0
 buffer_load_dwordx4 v18, s[12:15], s21 offen lds
 ds_read_b64_tr_b16 a[132:133], v27 offset:36864
 v_mfma_f32_16x16x32_bf16 a[240:243], a[32:35], a[136:139], a[240:243]
 ds_read_b64_tr_b16 a[134:135], v27 offset:38912
 s_branch L_lam0
 .p2align 4
L_la0:
 s_waitcnt lgkmcnt(4)
 v_mfma_f32_16x16x32_bf16 v[48:51], a[64:67], a[0:3], v[48:51]
 s_add_u32 s58, s23, 1
 s_and_b32 s58, s58, 15
 s_mul_i32 s58, s58, s59
 v_mfma_f32_16x16x32_bf16 v[48:51], a[68:71], a[4:7], v[48:51]
 ds_read_b64_tr_b16 a[136:137], v28 offset:32768
 v_mfma_f32_16x16x32_bf16 v[52:55], a[68:71], a[12:15], v[52:55]
 s_add_u32 m0, s55, 91136
 v_mfma_f32_16x16x32_bf16 v[52:55], a[64:67], a[8:11], v[52:55]
 buffer_load_dwordx4 v19, s[12:15], s21 offen lds
 v_mfma_f32_16x16x32_bf16 v[56:59], a[64:67], a[16:19], v[56:59]
 ds_read_b64_tr_b16 a[138:139], v28 offset:34816
 v_mfma_f32_16x16x32_bf16 v[56:59], a[68:71], a[20:23], v[56:59]
 v_mfma_f32_16x16x32_bf16 v[60:63], a[68:71], a[28:31], v[60:63]
 v_mfma_f32_16x16x32_bf16 v[60:63], a[64:67], a[24:27], v[60:63]
 s_add_u32 m0, s55, 96256
 ds_read_b64_tr_b16 a[140:141], v28 offset:36864
 v_mfma_f32_16x16x32_bf16 v[92:95], a[72:75], a[24:27], v[92:95]
 buffer_load_dwordx4 v18, s[12:15], s21 offen offset:2048 lds
 v_mfma_f32_16x16x32_bf16 v[92:95], a[76:79], a[28:31], v[92:95]
 v_mfma_f32_16x16x32_bf16 v[88:91], a[76:79], a[20:23], v[88:91]
 ds_read_b64_tr_b16 a[142:143], v28 offset:38912
 v_mfma_f32_16x16x32_bf16 v[88:91], a[72:75], a[16:19], v[88:91]
 v_mfma_f32_16x16x32_bf16 v[84:87], a[72:75], a[8:11], v[84:87]
 s_add_u32 m0, s55, 97280
 v_mfma_f32_16x16x32_bf16 v[84:87], a[76:79], a[12:15], v[84:87]
 buffer_load_dwordx4 v19, s[12:15], s21 offen offset:2048 lds
 v_mfma_f32_16x16x32_bf16 v[80:83], a[76:79], a[4:7], v[80:83]
 ds_read_b128 a[32:35], v22 offset:8192
 v_mfma_f32_16x16x32_bf16 v[80:83], a[72:75], a[0:3], v[80:83]
 v_mfma_f32_16x16x32_bf16 v[112:115], a[80:83], a[0:3], v[112:115]
 ds_read_b128 a[36:39], v23 offset:8192
 v_mfma_f32_16x16x32_bf16 v[112:115], a[84:87], a[4:7], v[112:115]
 s_add_u32 m0, s55, 106496
 v_mfma_f32_16x16x32_bf16 v[116:119], a[84:87], a[12:15], v[116:119]
 buffer_load_dwordx4 v20, s[12:15], s21 offen lds
 v_mfma_f32_16x16x32_bf16 v[116:119], a[80:83], a[8:11], v[116:119]
 ds_read_b128 a[40:43], v22 offset:10240
 v_mfma_f32_16x16x32_bf16 v[120:123], a[80:83], a[16:19], v[120:123]
 v_mfma_f32_16x16x32_bf16 v[120:123], a[84:87], a[20:23], v[120:123]
 v_mfma_f32_16x16x32_bf16 v[124:127], a[84:87], a[28:31], v[124:127]
 s_add_u32 m0, s55, 107520
 ds_read_b128 a[44:47], v23 offset:10240
 v_mfma_f32_16x16x32_bf16 v[124:127], a[80:83], a[24:27], v[124:127]
 buffer_load_dwordx4 v21, s[12:15], s21 offen lds
 v_mfma_f32_16x16x32_bf16 v[156:159], a[88:91], a[24:27], v[156:159]
 v_mfma_f32_16x16x32_bf16 v[156:159], a[92:95], a[28:31], v[156:159]
 ds_read_b128 a[48:51], v22 offset:12288
 v_mfma_f32_16x16x32_bf16 v[152:155], a[92:95], a[20:23], v[152:155]
 v_mfma_f32_16x16x32_bf16 v[152:155], a[88:91], a[16:19], v[152:155]
 v_mfma_f32_16x16x32_bf16 v[148:151], a[88:91], a[8:11], v[148:151]
 ds_read_b128 a[52:55], v23 offset:12288
 v_mfma_f32_16x16x32_bf16 v[148:151], a[92:95], a[12:15], v[148:151]
 v_mfma_f32_16x16x32_bf16 v[144:147], a[92:95], a[4:7], v[144:147]
 v_mfma_f32_16x16x32_bf16 v[144:147], a[88:91], a[0:3], v[144:147]
 ds_read_b128 a[56:59], v22 offset:14336
 v_mfma_f32_16x16x32_bf16 v[176:179], a[96:99], a[0:3], v[176:179]
 v_mfma_f32_16x16x32_bf16 v[176:179], a[100:103], a[4:7], v[176:179]
 v_mfma_f32_16x16x32_bf16 v[180:183], a[100:103], a[12:15], v[180:183]
 ds_read_b128 a[60:63], v23 offset:14336
 v_mfma_f32_16x16x32_bf16 v[180:183], a[96:99], a[8:11], v[180:183]
 v_mfma_f32_16x16x32_bf16 v[184:187], a[96:99], a[16:19], v[184:187]
 v_mfma_f32_16x16x32_bf16 v[184:187], a[100:103], a[20:23], v[184:187]
 v_mfma_f32_16x16x32_bf16 v[188:191], a[100:103], a[28:31], v[188:191]
 v_mfma_f32_16x16x32_bf16 v[188:191], a[96:99], a[24:27], v[188:191]
 v_mfma_f32_16x16x32_bf16 v[220:223], a[104:107], a[24:27], v[220:223]
 v_mfma_f32_16x16x32_bf16 v[220:223], a[108:111], a[28:31], v[220:223]
 v_mfma_f32_16x16x32_bf16 v[216:219], a[108:111], a[20:23], v[216:219]
 v_mfma_f32_16x16x32_bf16 v[216:219], a[104:107], a[16:19], v[216:219]
 v_mfma_f32_16x16x32_bf16 v[212:215], a[104:107], a[8:11], v[212:215]
 buffer_load_dword v0, v32, s[40:43], s58 offen
 v_mfma_f32_16x16x32_bf16 v[212:215], a[108:111], a[12:15], v[212:215]
 v_mfma_f32_16x16x32_bf16 v[208:211], a[108:111], a[4:7], v[208:211]
 v_mfma_f32_16x16x32_bf16 v[208:211], a[104:107], a[0:3], v[208:211]
 buffer_store_dwordx4 v[4:7], v1, s[48:51], s61 offen sc1
 v_mfma_f32_16x16x32_bf16 v[240:243], a[0:3], a[112:115], v[240:243]
 s_add_u32 s61, s61, 1024
 v_mfma_f32_16x16x32_bf16 v[240:243], a[4:7], a[116:119], v[240:243]
 v_mfma_f32_16x16x32_bf16 v[244:247], a[12:15], a[116:119], v[244:247]
 v_mfma_f32_16x16x32_bf16 v[244:247], a[8:11], a[112:115], v[244:247]
 v_mfma_f32_16x16x32_bf16 v[248:251], a[16:19], a[112:115], v[248:251]
 v_mfma_f32_16x16x32_bf16 v[248:251], a[20:23], a[116:119], v[248:251]
 v_mfma_f32_16x16x32_bf16 v[252:255], a[28:31], a[116:119], v[252:255]
 v_mfma_f32_16x16x32_bf16 v[252:255], a[24:27], a[112:115], v[252:255]
 v_mfma_f32_16x16x32_bf16 a[172:175], a[24:27], a[120:123], a[172:175]
 v_mfma_f32_16x16x32_bf16 a[172:175], a[28:31], a[124:127], a[172:175]
 v_mfma_f32_16x16x32_bf16 a[168:171], a[20:23], a[124:127], a[168:171]
 v_mfma_f32_16x16x32_bf16 a[168:171], a[16:19], a[120:123], a[168:171]
 v_mfma_f32_16x16x32_bf16 a[164:167], a[8:11], a[120:123], a[164:167]
 v_mfma_f32_16x16x32_bf16 a[164:167], a[12:15], a[124:127], a[164:167]
 v_mfma_f32_16x16x32_bf16 a[160:163], a[4:7], a[124:127], a[160:163]
 s_mov_b32 s72, 2
 v_mfma_f32_16x16x32_bf16 a[160:163], a[0:3], a[120:123], a[160:163]
 s_waitcnt lgkmcnt(0)
 v_mfma_f32_16x16x32_bf16 a[192:195], a[0:3], a[128:131], a[192:195]
 s_add_u32 s23, s23, 1
 s_and_b32 s23, s23, 15
 s_mul_i32 s22, s23, 458752
 v_mfma_f32_16x16x32_bf16 a[192:195], a[4:7], a[132:135], a[192:195]
 s_mul_i32 s21, s23, 393216
 s_lshl_b32 s20, s23, 7
 v_mfma_f32_16x16x32_bf16 a[196:199], a[12:15], a[132:135], a[196:199]
 v_mov_b32 v44, v35
 v_mfma_f32_16x16x32_bf16 a[196:199], a[8:11], a[128:131], a[196:199]
 v_mfma_f32_16x16x32_bf16 a[200:203], a[16:19], a[128:131], a[200:203]
 v_mov_b32 v45, v35
 v_mfma_f32_16x16x32_bf16 a[200:203], a[20:23], a[132:135], a[200:203]
 v_mfma_f32_16x16x32_bf16 a[204:207], a[28:31], a[132:135], a[204:207]
 v_mov_b32 v46, v35
 v_mfma_f32_16x16x32_bf16 a[204:207], a[24:27], a[128:131], a[204:207]
 v_mfma_f32_16x16x32_bf16 a[236:239], a[24:27], a[136:139], a[236:239]
 v_mov_b32 v47, v35
 v_mfma_f32_16x16x32_bf16 a[236:239], a[28:31], a[140:143], a[236:239]
 v_mfma_f32_16x16x32_bf16 a[232:235], a[20:23], a[140:143], a[232:235]
 v_mfma_f32_16x16x32_bf16 a[232:235], a[16:19], a[136:139], a[232:235]
 v_mfma_f32_16x16x32_bf16 a[228:231], a[8:11], a[136:139], a[228:231]
 v_mfma_f32_16x16x32_bf16 a[228:231], a[12:15], a[140:143], a[228:231]
 v_mfma_f32_16x16x32_bf16 a[224:227], a[4:7], a[140:143], a[224:227]
 s_cmp_eq_u32 s57, s68
 v_mfma_f32_16x16x32_bf16 a[224:227], a[0:3], a[136:139], a[224:227]
 s_cbranch_scc1 L_cs0
L_cs0_d2:
 v_mfma_f32_16x16x32_bf16 v[64:67], a[64:67], a[32:35], v[64:67]
 s_waitcnt vmcnt(2)
 s_barrier
 v_mfma_f32_16x16x32_bf16 v[64:67], a[68:71], a[36:39], v[64:67]
 v_mfma_f32_16x16x32_bf16 v[68:71], a[68:71], a[44:47], v[68:71]
 v_mfma_f32_16x16x32_bf16 v[68:71], a[64:67], a[40:43], v[68:71]
 v_mfma_f32_16x16x32_bf16 v[72:75], a[64:67], a[48:51], v[72:75]
 ds_read_b128 a[0:3], v24 offset:0
 v_mfma_f32_16x16x32_bf16 v[72:75], a[68:71], a[52:55], v[72:75]
 v_mfma_f32_16x16x32_bf16 v[76:79], a[68:71], a[60:63], v[76:79]
 ds_read_b128 a[4:7], v25 offset:0
 v_mfma_f32_16x16x32_bf16 v[76:79], a[64:67], a[56:59], v[76:79]
 v_mfma_f32_16x16x32_bf16 v[108:111], a[72:75], a[56:59], v[108:111]
 v_mfma_f32_16x16x32_bf16 v[108:111], a[76:79], a[60:63], v[108:111]
 ds_read_b64_tr_b16 a[64:65], v27 offset:0
 v_mfma_f32_16x16x32_bf16 v[104:107], a[76:79], a[52:55], v[104:107]
 v_mfma_f32_16x16x32_bf16 v[104:107], a[72:75], a[48:51], v[104:107]
 ds_read_b64_tr_b16 a[66:67], v27 offset:2048
 v_mfma_f32_16x16x32_bf16 v[100:103], a[72:75], a[40:43], v[100:103]
 v_mfma_f32_16x16x32_bf16 v[100:103], a[76:79], a[44:47], v[100:103]
 ds_read_b64_tr_b16 a[68:69], v27 offset:4096
 v_mfma_f32_16x16x32_bf16 v[96:99], a[76:79], a[36:39], v[96:99]
 ds_read_b128 a[8:11], v24 offset:2048
 v_mfma_f32_16x16x32_bf16 v[96:99], a[72:75], a[32:35], v[96:99]
 ds_read_b64_tr_b16 a[70:71], v27 offset:6144
 v_mfma_f32_16x16x32_bf16 v[128:131], a[80:83], a[32:35], v[128:131]
 v_mfma_f32_16x16x32_bf16 v[128:131], a[84:87], a[36:39], v[128:131]
 s_add_u32 m0, s54, 0
 ds_read_b64_tr_b16 a[72:73], v27 offset:8192
 v_mfma_f32_16x16x32_bf16 v[132:135], a[84:87], a[44:47], v[132:135]
 buffer_load_dwordx4 v8, s[8:11], s20 offen lds
 v_mfma_f32_16x16x32_bf16 v[132:135], a[80:83], a[40:43], v[132:135]
 ds_read_b64_tr_b16 a[74:75], v27 offset:10240
 v_mfma_f32_16x16x32_bf16 v[136:139], a[80:83], a[48:51], v[136:139]
 v_mfma_f32_16x16x32_bf16 v[136:139], a[84:87], a[52:55], v[136:139]
 ds_read_b64_tr_b16 a[76:77], v27 offset:12288
 v_mfma_f32_16x16x32_bf16 v[140:143], a[84:87], a[60:63], v[140:143]
 s_add_u32 m0, s54, 1024
 ds_read_b128 a[12:15], v25 offset:2048
 v_mfma_f32_16x16x32_bf16 v[140:143], a[80:83], a[56:59], v[140:143]
 buffer_load_dwordx4 v9, s[8:11], s20 offen lds
 v_mfma_f32_16x16x32_bf16 v[172:175], a[88:91], a[56:59], v[172:175]
 ds_read_b64_tr_b16 a[78:79], v27 offset:14336
 v_mfma_f32_16x16x32_bf16 v[172:175], a[92:95], a[60:63], v[172:175]
 ds_read_b64_tr_b16 a[80:81], v29 offset:0
 v_mfma_f32_16x16x32_bf16 v[168:171], a[92:95], a[52:55], v[168:171]
 v_mfma_f32_16x16x32_bf16 v[168:171], a[88:91], a[48:51], v[168:171]
 s_add_u32 m0, s54, 2048
 ds_read_b64_tr_b16 a[82:83], v29 offset:2048
 v_mfma_f32_16x16x32_bf16 v[164:167], a[88:91], a[40:43], v[164:167]
 buffer_load_dwordx4 v10, s[8:11], s20 offen lds
 v_mfma_f32_16x16x32_bf16 v[164:167], a[92:95], a[44:47], v[164:167]
 ds_read_b64_tr_b16 a[84:85], v29 offset:4096
 v_mfma_f32_16x16x32_bf16 v[160:163], a[92:95], a[36:39], v[160:163]
 ds_read_b128 a[16:19], v24 offset:4096
 v_mfma_f32_16x16x32_bf16 v[160:163], a[88:91], a[32:35], v[160:163]
 ds_read_b64_tr_b16 a[86:87], v29 offset:6144
 v_mfma_f32_16x16x32_bf16 v[192:195], a[96:99], a[32:35], v[192:195]
 s_add_u32 m0, s54, 3072
 v_mfma_f32_16x16x32_bf16 v[192:195], a[100:103], a[36:39], v[192:195]
 buffer_load_dwordx4 v11, s[8:11], s20 offen lds
 v_mfma_f32_16x16x32_bf16 v[196:199], a[100:103], a[44:47], v[196:199]
 ds_read_b64_tr_b16 a[88:89], v29 offset:8192
 v_mfma_f32_16x16x32_bf16 v[196:199], a[96:99], a[40:43], v[196:199]
 ds_read_b64_tr_b16 a[90:91], v29 offset:10240
 v_mfma_f32_16x16x32_bf16 v[200:203], a[96:99], a[48:51], v[200:203]
 v_mfma_f32_16x16x32_bf16 v[200:203], a[100:103], a[52:55], v[200:203]
 s_add_u32 m0, s54, 4096
 ds_read_b64_tr_b16 a[92:93], v29 offset:12288
 v_mfma_f32_16x16x32_bf16 v[204:207], a[100:103], a[60:63], v[204:207]
 buffer_load_dwordx4 v12, s[8:11], s20 offen lds
 v_mfma_f32_16x16x32_bf16 v[204:207], a[96:99], a[56:59], v[204:207]
 ds_read_b64_tr_b16 a[94:95], v29 offset:14336
 v_mfma_f32_16x16x32_bf16 v[236:239], a[104:107], a[56:59], v[236:239]
 ds_read_b128 a[20:23], v25 offset:4096
 v_mfma_f32_16x16x32_bf16 v[236:239], a[108:111], a[60:63], v[236:239]
 ds_read_b64_tr_b16 a[96:97], v27 offset:16384
 v_mfma_f32_16x16x32_bf16 v[232:235], a[108:111], a[52:55], v[232:235]
 s_add_u32 m0, s54, 5120
 v_mfma_f32_16x16x32_bf16 v[232:235], a[104:107], a[48:51], v[232:235]
 buffer_load_dwordx4 v13, s[8:11], s20 offen lds
 v_mfma_f32_16x16x32_bf16 v[228:231], a[104:107], a[40:43], v[228:231]
 ds_read_b64_tr_b16 a[98:99], v27 offset:18432
 v_mfma_f32_16x16x32_bf16 v[228:231], a[108:111], a[44:47], v[228:231]
 ds_read_b64_tr_b16 a[100:101], v27 offset:20480
 v_mfma_f32_16x16x32_bf16 v[224:227], a[108:111], a[36:39], v[224:227]
 ds_read_b128 a[24:27], v24 offset:6144
 v_mfma_f32_16x16x32_bf16 v[224:227], a[104:107], a[32:35], v[224:227]
 s_add_u32 m0, s54, 6144
 ds_read_b64_tr_b16 a[102:103], v27 offset:22528
 v_mfma_f32_16x16x32_bf16 a[144:147], a[32:35], a[112:115], a[144:147]
 buffer_load_dwordx4 v14, s[8:11], s20 offen lds
 v_mfma_f32_16x16x32_bf16 a[144:147], a[36:39], a[116:119], a[144:147]
 ds_read_b64_tr_b16 a[104:105], v29 offset:16384
 v_mfma_f32_16x16x32_bf16 a[148:151], a[44:47], a[116:119], a[148:151]
 v_mfma_f32_16x16x32_bf16 a[148:151], a[40:43], a[112:115], a[148:151]
 ds_read_b64_tr_b16 a[106:107], v29 offset:18432
 v_mfma_f32_16x16x32_bf16 a[152:155], a[48:51], a[112:115], a[152:155]
 s_add_u32 m0, s54, 7168
 v_mfma_f32_16x16x32_bf16 a[152:155], a[52:55], a[116:119], a[152:155]
 buffer_load_dwordx4 v15, s[8:11], s20 offen lds
 v_mfma_f32_16x16x32_bf16 a[156:159], a[60:63], a[116:119], a[156:159]
 ds_read_b64_tr_b16 a[108:109], v29 offset:20480
 v_mfma_f32_16x16x32_bf16 a[156:159], a[56:59], a[112:115], a[156:159]
 ds_read_b64_tr_b16 a[110:111], v29 offset:22528
 v_mfma_f32_16x16x32_bf16 a[188:191], a[56:59], a[120:123], a[188:191]
 ds_read_b128 a[28:31], v25 offset:6144
 v_mfma_f32_16x16x32_bf16 a[188:191], a[60:63], a[124:127], a[188:191]
 s_add_u32 m0, s55, 0
 ds_read_b64_tr_b16 a[112:113], v27 offset:24576
 v_mfma_f32_16x16x32_bf16 a[184:187], a[52:55], a[124:127], a[184:187]
 buffer_load_dwordx4 v16, s[16:19], s22 offen lds
 v_mfma_f32_16x16x32_bf16 a[184:187], a[48:51], a[120:123], a[184:187]
 ds_read_b64_tr_b16 a[114:115], v27 offset:26624
 v_mfma_f32_16x16x32_bf16 a[180:183], a[40:43], a[120:123], a[180:183]
 v_mfma_f32_16x16x32_bf16 a[180:183], a[44:47], a[124:127], a[180:183]
 ds_read_b64_tr_b16 a[116:117], v27 offset:28672
 v_mfma_f32_16x16x32_bf16 a[176:179], a[36:39], a[124:127], a[176:179]
 s_add_u32 m0, s55, 1024
 v_mfma_f32_16x16x32_bf16 a[176:179], a[32:35], a[120:123], a[176:179]
 buffer_load_dwordx4 v17, s[16:19], s22 offen lds
 v_mfma_f32_16x16x32_bf16 a[208:211], a[32:35], a[128:131], a[208:211]
 ds_read_b64_tr_b16 a[118:119], v27 offset:30720
 v_mfma_f32_16x16x32_bf16 a[208:211], a[36:39], a[132:135], a[208:211]
 ds_read_b64_tr_b16 a[120:121], v29 offset:24576
 v_mfma_f32_16x16x32_bf16 a[212:215], a[44:47], a[132:135], a[212:215]
 v_mfma_f32_16x16x32_bf16 a[212:215], a[40:43], a[128:131], a[212:215]
 s_add_u32 m0, s55, 8192
 ds_read_b64_tr_b16 a[122:123], v29 offset:26624
 v_mfma_f32_16x16x32_bf16 a[216:219], a[48:51], a[128:131], a[216:219]
 buffer_load_dwordx4 v16, s[64:67], s22 offen lds
 v_mfma_f32_16x16x32_bf16 a[216:219], a[52:55], a[132:135], a[216:219]
 ds_read_b64_tr_b16 a[124:125], v29 offset:28672
 v_mfma_f32_16x16x32_bf16 a[220:223], a[60:63], a[132:135], a[220:223]
 v_mfma_f32_16x16x32_bf16 a[220:223], a[56:59], a[128:131], a[220:223]
 ds_read_b64_tr_b16 a[126:127], v29 offset:30720
 v_mfma_f32_16x16x32_bf16 a[252:255], a[56:59], a[136:139], a[252:255]
 s_add_u32 m0, s55, 9216
 v_mfma_f32_16x16x32_bf16 a[252:255], a[60:63], a[140:143], a[252:255]
 buffer_load_dwordx4 v17, s[64:67], s22 offen lds
 v_mfma_f32_16x16x32_bf16 a[248:251], a[52:55], a[140:143], a[248:251]
 ds_read_b64_tr_b16 a[128:129], v27 offset:32768
 v_mfma_f32_16x16x32_bf16 a[248:251], a[48:51], a[136:139], a[248:251]
 ds_read_b64_tr_b16 a[130:131], v27 offset:34816
 v_mfma_f32_16x16x32_bf16 a[244:247], a[40:43], a[136:139], a[244:247]
 v_mfma_f32_16x16x32_bf16 a[244:247], a[44:47], a[140:143], a[244:247]
 s_add_u32 m0, s55, 16384
 ds_read_b64_tr_b16 a[132:133], v27 offset:36864
 v_mfma_f32_16x16x32_bf16 a[240:243], a[36:39], a[140:143], a[240:243]
 buffer_load_dwordx4 v18, s[12:15], s21 offen lds
 v_mfma_f32_16x16x32_bf16 a[240:243], a[32:35], a[136:139], a[240:243]
 ds_read_b64_tr_b16 a[134:135], v27 offset:38912
L_lam0:
 s_waitcnt lgkmcnt(4)
 v_mfma_f32_16x16x32_bf16 v[48:51], a[64:67], a[0:3], v[48:51]
 s_add_u32 s58, s23, 1
 s_and_b32 s58, s58, 15
 s_branch L_tp_L_tA_2_o
L_tp_L_tA_2:
 s_nop 0
 s_branch L_tp_L_tA_6
 s_nop 0
L_tp_L_tA_2_o:
 s_mul_i32 s58, s58, s59
 v_mfma_f32_16x16x32_bf16 v[48:51], a[68:71], a[4:7], v[48:51]
 ds_read_b64_tr_b16 a[136:137], v29 offset:32768
 v_mfma_f32_16x16x32_bf16 v[52:55], a[68:71], a[12:15], v[52:55]
 s_add_u32 m0, s55, 17408
 v_mfma_f32_16x16x32_bf16 v[52:55], a[64:67], a[8:11], v[52:55]
 buffer_load_dwordx4 v19, s[12:15], s21 offen lds
 v_mfma_f32_16x16x32_bf16 v[56:59], a[64:67], a[16:19], v[56:59]
 ds_read_b64_tr_b16 a[138:139], v29 offset:34816
 v_mfma_f32_16x16x32_bf16 v[56:59], a[68:71], a[20:23], v[56:59]
 v_mfma_f32_16x16x32_bf16 v[60:63], a[68:71], a[28:31], v[60:63]
 v_mfma_f32_16x16x32_bf16 v[60:63], a[64:67], a[24:27], v[60:63]
 s_add_u32 m0, s55, 22528
 ds_read_b64_tr_b16 a[140:141], v29 offset:36864
 v_mfma_f32_16x16x32_bf16 v[92:95], a[72:75], a[24:27], v[92:95]
 buffer_load_dwordx4 v18, s[12:15], s21 offen offset:2048 lds
 v_mfma_f32_16x16x32_bf16 v[92:95], a[76:79], a[28:31], v[92:95]
 v_mfma_f32_16x16x32_bf16 v[88:91], a[76:79], a[20:23], v[88:91]
 ds_read_b64_tr_b16 a[142:143], v29 offset:38912
 v_mfma_f32_16x16x32_bf16 v[88:91], a[72:75], a[16:19], v[88:91]
 v_mfma_f32_16x16x32_bf16 v[84:87], a[72:75], a[8:11], v[84:87]
 s_add_u32 m0, s55, 23552
 v_mfma_f32_16x16x32_bf16 v[84:87], a[76:79], a[12:15], v[84:87]
 buffer_load_dwordx4 v19, s[12:15], s21 offen offset:2048 lds
 v_mfma_f32_16x16x32_bf16 v[80:83], a[76:79], a[4:7], v[80:83]
 ds_read_b128 a[32:35], v24 offset:8192
 v_mfma_f32_16x16x32_bf16 v[80:83], a[72:75], a[0:3], v[80:83]
 v_mfma_f32_16x16x32_bf16 v[112:115], a[80:83], a[0:3], v[112:115]
 ds_read_b128 a[36:39], v25 offset:8192
 v_mfma_f32_16x16x32_bf16 v[112:115], a[84:87], a[4:7], v[112:115]
 s_add_u32 m0, s55, 32768
 v_mfma_f32_16x16x32_bf16 v[116:119], a[84:87], a[12:15], v[116:119]
 buffer_load_dwordx4 v20, s[12:15], s21 offen lds
 v_mfma_f32_16x16x32_bf16 v[116:119], a[80:83], a[8:11], v[116:119]
 ds_read_b128 a[40:43], v24 offset:10240
 v_mfma_f32_16x16x32_bf16 v[120:123], a[80:83], a[16:19], v[120:123]
 v_mfma_f32_16x16x32_bf16 v[120:123], a[84:87], a[20:23], v[120:123]
 v_mfma_f32_16x16x32_bf16 v[124:127], a[84:87], a[28:31], v[124:127]
 s_add_u32 m0, s55, 33792
 ds_read_b128 a[44:47], v25 offset:10240
 v_mfma_f32_16x16x32_bf16 v[124:127], a[80:83], a[24:27], v[124:127]
 buffer_load_dwordx4 v21, s[12:15], s21 offen lds
 v_mfma_f32_16x16x32_bf16 v[156:159], a[88:91], a[24:27], v[156:159]
 v_mfma_f32_16x16x32_bf16 v[156:159], a[92:95], a[28:31], v[156:159]
 ds_read_b128 a[48:51], v24 offset:12288
 v_mfma_f32_16x16x32_bf16 v[152:155], a[92:95], a[20:23], v[152:155]
 v_mfma_f32_16x16x32_bf16 v[152:155], a[88:91], a[16:19], v[152:155]
 v_mfma_f32_16x16x32_bf16 v[148:151], a[88:91], a[8:11], v[148:151]
 ds_read_b128 a[52:55], v25 offset:12288
 v_mfma_f32_16x16x32_bf16 v[148:151], a[92:95], a[12:15], v[148:151]
 v_mfma_f32_16x16x32_bf16 v[144:147], a[92:95], a[4:7], v[144:147]
 v_mfma_f32_16x16x32_bf16 v[144:147], a[88:91], a[0:3], v[144:147]
 ds_read_b128 a[56:59], v24 offset:14336
 v_mfma_f32_16x16x32_bf16 v[176:179], a[96:99], a[0:3], v[176:179]
 v_mfma_f32_16x16x32_bf16 v[176:179], a[100:103], a[4:7], v[176:179]
 v_mfma_f32_16x16x32_bf16 v[180:183], a[100:103], a[12:15], v[180:183]
 ds_read_b128 a[60:63], v25 offset:14336
 v_mfma_f32_16x16x32_bf16 v[180:183], a[96:99], a[8:11], v[180:183]
 v_mfma_f32_16x16x32_bf16 v[184:187], a[96:99], a[16:19], v[184:187]
 v_mfma_f32_16x16x32_bf16 v[184:187], a[100:103], a[20:23], v[184:187]
 v_mfma_f32_16x16x32_bf16 v[188:191], a[100:103], a[28:31], v[188:191]
 v_mfma_f32_16x16x32_bf16 v[188:191], a[96:99], a[24:27], v[188:191]
 v_mfma_f32_16x16x32_bf16 v[220:223], a[104:107], a[24:27], v[220:223]
 v_mfma_f32_16x16x32_bf16 v[220:223], a[108:111], a[28:31], v[220:223]
 v_mfma_f32_16x16x32_bf16 v[216:219], a[108:111], a[20:23], v[216:219]
 v_mfma_f32_16x16x32_bf16 v[216:219], a[104:107], a[16:19], v[216:219]
 v_mfma_f32_16x16x32_bf16 v[212:215], a[104:107], a[8:11], v[212:215]
 buffer_load_dword v0, v32, s[40:43], s58 offen
 v_mfma_f32_16x16x32_bf16 v[212:215], a[108:111], a[12:15], v[212:215]
 s_mov_b32 m0, s0
 v_mfma_f32_16x16x32_bf16 v[208:211], a[108:111], a[4:7], v[208:211]
 buffer_load_dwordx4 v1, s[8:11], s1 offen lds
 v_mfma_f32_16x16x32_bf16 v[208:211], a[104:107], a[0:3], v[208:211]
 s_add_u32 s0, s0, 1024
 s_add_u32 s1, s1, 1024
 v_mfma_f32_16x16x32_bf16 v[240:243], a[0:3], a[112:115], v[240:243]
 v_mfma_f32_16x16x32_bf16 v[240:243], a[4:7], a[116:119], v[240:243]
 v_mfma_f32_16x16x32_bf16 v[244:247], a[12:15], a[116:119], v[244:247]
 v_mfma_f32_16x16x32_bf16 v[244:247], a[8:11], a[112:115], v[244:247]
 v_mfma_f32_16x16x32_bf16 v[248:251], a[16:19], a[112:115], v[248:251]
 v_mfma_f32_16x16x32_bf16 v[248:251], a[20:23], a[116:119], v[248:251]
 v_mfma_f32_16x16x32_bf16 v[252:255], a[28:31], a[116:119], v[252:255]
 v_mfma_f32_16x16x32_bf16 v[252:255], a[24:27], a[112:115], v[252:255]
 v_mfma_f32_16x16x32_bf16 a[172:175], a[24:27], a[120:123], a[172:175]
 v_mfma_f32_16x16x32_bf16 a[172:175], a[28:31], a[124:127], a[172:175]
 v_mfma_f32_16x16x32_bf16 a[168:171], a[20:23], a[124:127], a[168:171]
 v_mfma_f32_16x16x32_bf16 a[168:171], a[16:19], a[120:123], a[168:171]
 v_mfma_f32_16x16x32_bf16 a[164:167], a[8:11], a[120:123], a[164:167]
 v_mfma_f32_16x16x32_bf16 a[164:167], a[12:15], a[124:127], a[164:167]
 v_mfma_f32_16x16x32_bf16 a[160:163], a[4:7], a[124:127], a[160:163]
 s_mov_b32 s72, 3
 v_mfma_f32_16x16x32_bf16 a[160:163], a[0:3], a[120:123], a[160:163]
 s_waitcnt lgkmcnt(0)
 v_mfma_f32_16x16x32_bf16 a[192:195], a[0:3], a[128:131], a[192:195]
 s_add_u32 s23, s23, 1
 s_and_b32 s23, s23, 15
 s_mul_i32 s22, s23, 458752
 v_mfma_f32_16x16x32_bf16 a[192:195], a[4:7], a[132:135], a[192:195]
 s_mul_i32 s21, s23, 393216
 s_lshl_b32 s20, s23, 7
 v_mfma_f32_16x16x32_bf16 a[196:199], a[12:15], a[132:135], a[196:199]
 v_mov_b32 v44, v35
 v_mfma_f32_16x16x32_bf16 a[196:199], a[8:11], a[128:131], a[196:199]
 v_mfma_f32_16x16x32_bf16 a[200:203], a[16:19], a[128:131], a[200:203]
 v_mov_b32 v45, v35
 v_mfma_f32_16x16x32_bf16 a[200:203], a[20:23], a[132:135], a[200:203]
 v_mfma_f32_16x16x32_bf16 a[204:207], a[28:31], a[132:135], a[204:207]
 v_mov_b32 v46, v35
 v_mfma_f32_16x16x32_bf16 a[204:207], a[24:27], a[128:131], a[204:207]
 v_mfma_f32_16x16x32_bf16 a[236:239], a[24:27], a[136:139], a[236:239]
 v_mov_b32 v47, v35
 v_mfma_f32_16x16x32_bf16 a[236:239], a[28:31], a[140:143], a[236:239]
 v_mfma_f32_16x16x32_bf16 a[232:235], a[20:23], a[140:143], a[232:235]
 v_mfma_f32_16x16x32_bf16 a[232:235], a[16:19], a[136:139], a[232:235]
 v_mfma_f32_16x16x32_bf16 a[228:231], a[8:11], a[136:139], a[228:231]
 v_mfma_f32_16x16x32_bf16 a[228:231], a[12:15], a[140:143], a[228:231]
 v_mfma_f32_16x16x32_bf16 a[224:227], a[4:7], a[140:143], a[224:227]
 s_cmp_eq_u32 s57, s68
 v_mfma_f32_16x16x32_bf16 a[224:227], a[0:3], a[136:139], a[224:227]
 s_cbranch_scc1 L_cs0
L_cs0_d3:
 v_mfma_f32_16x16x32_bf16 v[64:67], a[64:67], a[32:35], v[64:67]
 s_waitcnt vmcnt(2)
 s_barrier
 v_mfma_f32_16x16x32_bf16 v[64:67], a[68:71], a[36:39], v[64:67]
 v_mfma_f32_16x16x32_bf16 v[68:71], a[68:71], a[44:47], v[68:71]
 v_mfma_f32_16x16x32_bf16 v[68:71], a[64:67], a[40:43], v[68:71]
 v_mfma_f32_16x16x32_bf16 v[72:75], a[64:67], a[48:51], v[72:75]
 ds_read_b128 a[0:3], v22 offset:0
 v_mfma_f32_16x16x32_bf16 v[72:75], a[68:71], a[52:55], v[72:75]
 v_mfma_f32_16x16x32_bf16 v[76:79], a[68:71], a[60:63], v[76:79]
 ds_read_b128 a[4:7], v23 offset:0
 v_mfma_f32_16x16x32_bf16 v[76:79], a[64:67], a[56:59], v[76:79]
 v_mfma_f32_16x16x32_bf16 v[108:111], a[72:75], a[56:59], v[108:111]
 v_mfma_f32_16x16x32_bf16 v[108:111], a[76:79], a[60:63], v[108:111]
 ds_read_b64_tr_b16 a[64:65], v26 offset:0
 v_mfma_f32_16x16x32_bf16 v[104:107], a[76:79], a[52:55], v[104:107]
 v_mfma_f32_16x16x32_bf16 v[104:107], a[72:75], a[48:51], v[104:107]
 ds_read_b64_tr_b16 a[66:67], v26 offset:2048
 v_mfma_f32_16x16x32_bf16 v[100:103], a[72:75], a[40:43], v[100:103]
 v_mfma_f32_16x16x32_bf16 v[100:103], a[76:79], a[44:47], v[100:103]
 ds_read_b64_tr_b16 a[68:69], v26 offset:4096
 v_mfma_f32_16x16x32_bf16 v[96:99], a[76:79], a[36:39], v[96:99]
 ds_read_b128 a[8:11], v22 offset:2048
 v_mfma_f32_16x16x32_bf16 v[96:99], a[72:75], a[32:35], v[96:99]
 ds_read_b64_tr_b16 a[70:71], v26 offset:6144
 v_mfma_f32_16x16x32_bf16 v[128:131], a[80:83], a[32:35], v[128:131]
 v_mfma_f32_16x16x32_bf16 v[128:131], a[84:87], a[36:39], v[128:131]
 s_add_u32 m0, s54, 73728
 ds_read_b64_tr_b16 a[72:73], v26 offset:8192
 v_mfma_f32_16x16x32_bf16 v[132:135], a[84:87], a[44:47], v[132:135]
 buffer_load_dwordx4 v8, s[8:11], s20 offen lds
 v_mfma_f32_16x16x32_bf16 v[132:135], a[80:83], a[40:43], v[132:135]
 ds_read_b64_tr_b16 a[74:75], v26 offset:10240
 v_mfma_f32_16x16x32_bf16 v[136:139], a[80:83], a[48:51], v[136:139]
 v_mfma_f32_16x16x32_bf16 v[136:139], a[84:87], a[52:55], v[136:139]
 ds_read_b64_tr_b16 a[76:77], v26 offset:12288
 v_mfma_f32_16x16x32_bf16 v[140:143], a[84:87], a[60:63], v[140:143]
 s_add_u32 m0, s54, 74752
 ds_read_b128 a[12:15], v23 offset:2048
 v_mfma_f32_16x16x32_bf16 v[140:143], a[80:83], a[56:59], v[140:143]
 buffer_load_dwordx4 v9, s[8:11], s20 offen lds
 v_mfma_f32_16x16x32_bf16 v[172:175], a[88:91], a[56:59], v[172:175]
 ds_read_b64_tr_b16 a[78:79], v26 offset:14336
 v_mfma_f32_16x16x32_bf16 v[172:175], a[92:95], a[60:63], v[172:175]
 ds_read_b64_tr_b16 a[80:81], v28 offset:0
 v_mfma_f32_16x16x32_bf16 v[168:171], a[92:95], a[52:55], v[168:171]
 v_mfma_f32_16x16x32_bf16 v[168:171], a[88:91], a[48:51], v[168:171]
 s_add_u32 m0, s54, 75776
 ds_read_b64_tr_b16 a[82:83], v28 offset:2048
 v_mfma_f32_16x16x32_bf16 v[164:167], a[88:91], a[40:43], v[164:167]
 buffer_load_dwordx4 v10, s[8:11], s20 offen lds
 v_mfma_f32_16x16x32_bf16 v[164:167], a[92:95], a[44:47], v[164:167]
 ds_read_b64_tr_b16 a[84:85], v28 offset:4096
 v_mfma_f32_16x16x32_bf16 v[160:163], a[92:95], a[36:39], v[160:163]
 ds_read_b128 a[16:19], v22 offset:4096
 v_mfma_f32_16x16x32_bf16 v[160:163], a[88:91], a[32:35], v[160:163]
 ds_read_b64_tr_b16 a[86:87], v28 offset:6144
 v_mfma_f32_16x16x32_bf16 v[192:195], a[96:99], a[32:35], v[192:195]
 s_add_u32 m0, s54, 76800
 v_mfma_f32_16x16x32_bf16 v[192:195], a[100:103], a[36:39], v[192:195]
 buffer_load_dwordx4 v11, s[8:11], s20 offen lds
 v_mfma_f32_16x16x32_bf16 v[196:199], a[100:103], a[44:47], v[196:199]
 ds_read_b64_tr_b16 a[88:89], v28 offset:8192
 v_mfma_f32_16x16x32_bf16 v[196:199], a[96:99], a[40:43], v[196:199]
 ds_read_b64_tr_b16 a[90:91], v28 offset:10240
 v_mfma_f32_16x16x32_bf16 v[200:203], a[96:99], a[48:51], v[200:203]
 v_mfma_f32_16x16x32_bf16 v[200:203], a[100:103], a[52:55], v[200:203]
 s_add_u32 m0, s54, 77824
 ds_read_b64_tr_b16 a[92:93], v28 offset:12288
 v_mfma_f32_16x16x32_bf16 v[204:207], a[100:103], a[60:63], v[204:207]
 buffer_load_dwordx4 v12, s[8:11], s20 offen lds
 v_mfma_f32_16x16x32_bf16 v[204:207], a[96:99], a[56:59], v[204:207]
 ds_read_b64_tr_b16 a[94:95], v28 offset:14336
 v_mfma_f32_16x16x32_bf16 v[236:239], a[104:107], a[56:59], v[236:239]
 ds_read_b128 a[20:23], v23 offset:4096
 v_mfma_f32_16x16x32_bf16 v[236:239], a[108:111], a[60:63], v[236:239]
 ds_read_b64_tr_b16 a[96:97], v26 offset:16384
 v_mfma_f32_16x16x32_bf16 v[232:235], a[108:111], a[52:55], v[232:235]
 s_add_u32 m0, s54, 78848
 v_mfma_f32_16x16x32_bf16 v[232:235], a[104:107], a[48:51], v[232:235]
 buffer_load_dwordx4 v13, s[8:11], s20 offen lds
 v_mfma_f32_16x16x32_bf16 v[228:231], a[104:107], a[40:43], v[228:231]
 ds_read_b64_tr_b16 a[98:99], v26 offset:18432
 v_mfma_f32_16x16x32_bf16 v[228:231], a[108:111], a[44:47], v[228:231]
 ds_read_b64_tr_b16 a[100:101], v26 offset:20480
 v_mfma_f32_16x16x32_bf16 v[224:227], a[108:111], a[36:39], v[224:227]
 ds_read_b128 a[24:27], v22 offset:6144
 v_mfma_f32_16x16x32_bf16 v[224:227], a[104:107], a[32:35], v[224:227]
 s_add_u32 m0, s54, 79872
 ds_read_b64_tr_b16 a[102:103], v26 offset:22528
 v_mfma_f32_16x16x32_bf16 a[144:147], a[32:35], a[112:115], a[144:147]
 buffer_load_dwordx4 v14, s[8:11], s20 offen lds
 v_mfma_f32_16x16x32_bf16 a[144:147], a[36:39], a[116:119], a[144:147]
 ds_read_b64_tr_b16 a[104:105], v28 offset:16384
 v_mfma_f32_16x16x32_bf16 a[148:151], a[44:47], a[116:119], a[148:151]
 v_mfma_f32_16x16x32_bf16 a[148:151], a[40:43], a[112:115], a[148:151]
 ds_read_b64_tr_b16 a[106:107], v28 offset:18432
 v_mfma_f32_16x16x32_bf16 a[152:155], a[48:51], a[112:115], a[152:155]
 s_add_u32 m0, s54, 80896
 v_mfma_f32_16x16x32_bf16 a[152:155], a[52:55], a[116:119], a[152:155]
 buffer_load_dwordx4 v15, s[8:11], s20 offen lds
 v_mfma_f32_16x16x32_bf16 a[156:159], a[60:63], a[116:119], a[156:159]
 ds_read_b64_tr_b16 a[108:109], v28 offset:20480
 v_mfma_f32_16x16x32_bf16 a[156:159], a[56:59], a[112:115], a[156:159]
 ds_read_b64_tr_b16 a[110:111], v28 offset:22528
 v_mfma_f32_16x16x32_bf16 a[188:191], a[56:59], a[120:123], a[188:191]
 ds_read_b128 a[28:31], v23 offset:6144
 v_mfma_f32_16x16x32_bf16 a[188:191], a[60:63], a[124:127], a[188:191]
 s_add_u32 m0, s55, 73728
 ds_read_b64_tr_b16 a[112:113], v26 offset:24576
 v_mfma_f32_16x16x32_bf16 a[184:187], a[52:55], a[124:127], a[184:187]
 buffer_load_dwordx4 v16, s[16:19], s22 offen lds
 v_mfma_f32_16x16x32_bf16 a[184:187], a[48:51], a[120:123], a[184:187]
 ds_read_b64_tr_b16 a[114:115], v26 offset:26624
 v_mfma_f32_16x16x32_bf16 a[180:183], a[40:43], a[120:123], a[180:183]
 v_mfma_f32_16x16x32_bf16 a[180:183], a[44:47], a[124:127], a[180:183]
 ds_read_b64_tr_b16 a[116:117], v26 offset:28672
 s_branch L_tp_L_tA_3_o
L_tp_L_tA_3:
 s_nop 0
 s_nop 0
 s_branch L_tp_L_tA_7
L_tp_L_tA_3_o:
 v_mfma_f32_16x16x32_bf16 a[176:179], a[36:39], a[124:127], a[176:179]
 s_add_u32 m0, s55, 74752
 v_mfma_f32_16x16x32_bf16 a[176:179], a[32:35], a[120:123], a[176:179]
 buffer_load_dwordx4 v17, s[16:19], s22 offen lds
 v_mfma_f32_16x16x32_bf16 a[208:211], a[32:35], a[128:131], a[208:211]
 ds_read_b64_tr_b16 a[118:119], v26 offset:30720
 v_mfma_f32_16x16x32_bf16 a[208:211], a[36:39], a[132:135], a[208:211]
 ds_read_b64_tr_b16 a[120:121], v28 offset:24576
 v_mfma_f32_16x16x32_bf16 a[212:215], a[44:47], a[132:135], a[212:215]
 v_mfma_f32_16x16x32_bf16 a[212:215], a[40:43], a[128:131], a[212:215]
 s_add_u32 m0, s55, 81920
 ds_read_b64_tr_b16 a[122:123], v28 offset:26624
 v_mfma_f32_16x16x32_bf16 a[216:219], a[48:51], a[128:131], a[216:219]
 buffer_load_dwordx4 v16, s[64:67], s22 offen lds
 v_mfma_f32_16x16x32_bf16 a[216:219], a[52:55], a[132:135], a[216:219]
 ds_read_b64_tr_b16 a[124:125], v28 offset:28672
 v_mfma_f32_16x16x32_bf16 a[220:223], a[60:63], a[132:135], a[220:223]
 v_mfma_f32_16x16x32_bf16 a[220:223], a[56:59], a[128:131], a[220:223]
 ds_read_b64_tr_b16 a[126:127], v28 offset:30720
 v_mfma_f32_16x16x32_bf16 a[252:255], a[56:59], a[136:139], a[252:255]
 s_add_u32 m0, s55, 82944
 v_mfma_f32_16x16x32_bf16 a[252:255], a[60:63], a[140:143], a[252:255]
 buffer_load_dwordx4 v17, s[64:67], s22 offen lds
 v_mfma_f32_16x16x32_bf16 a[248:251], a[52:55], a[140:143], a[248:251]
 ds_read_b64_tr_b16 a[128:129], v26 offset:32768
 v_mfma_f32_16x16x32_bf16 a[248:251], a[48:51], a[136:139], a[248:251]
 ds_read_b64_tr_b16 a[130:131], v26 offset:34816
 v_mfma_f32_16x16x32_bf16 a[244:247], a[40:43], a[136:139], a[244:247]
 s_add_u32 s57, s57, 1
 v_mfma_f32_16x16x32_bf16 a[244:247], a[44:47], a[140:143], a[244:247]
 s_add_u32 m0, s55, 90112
 ds_read_b64_tr_b16 a[132:133], v26 offset:36864
 v_mfma_f32_16x16x32_bf16 a[240:243], a[36:39], a[140:143], a[240:243]
 s_cmp_lt_u32 s57, 4
 buffer_load_dwordx4 v18, s[12:15], s21 offen lds
 v_mfma_f32_16x16x32_bf16 a[240:243], a[32:35], a[136:139], a[240:243]
 ds_read_b64_tr_b16 a[134:135], v26 offset:38912
 s_cbranch_scc1 L_la0
 s_sub_u32 s0, s0, 4096
 s_lshl2_add_u32 s61, s2, s3
 s_lshl_b32 s61, s61, 9
 s_add_u32 s61, s61, 30408704
 s_mov_b32 exec_hi, 0
 s_waitcnt vmcnt(13)
 buffer_store_dwordx4 v[4:7], v1, s[24:27], s61 offen sc1
 s_mov_b32 exec_hi, -1
 s_waitcnt lgkmcnt(4)
 buffer_store_dwordx4 v[40:43], v34, s[24:27], s69 offen sc1
 v_add_u32 v3, s0, v1
 v_mfma_f32_16x16x32_bf16 v[48:51], a[64:67], a[0:3], v[48:51]
 ds_read_b128 v[36:39], v3 offset:0
 v_mfma_f32_16x16x32_bf16 v[48:51], a[68:71], a[4:7], v[48:51]
 ds_read_b128 v[44:47], v3 offset:1024
 v_mfma_f32_16x16x32_bf16 v[52:55], a[68:71], a[12:15], v[52:55]
 s_add_u32 m0, s55, 91136
 ds_read_b128 v[40:43], v3 offset:2048
 v_mfma_f32_16x16x32_bf16 v[52:55], a[64:67], a[8:11], v[52:55]
 buffer_load_dwordx4 v19, s[12:15], s21 offen lds
 v_mfma_f32_16x16x32_bf16 v[56:59], a[64:67], a[16:19], v[56:59]
 s_mov_b32 s72, 1
 s_mov_b32 s73, 1
 v_mfma_f32_16x16x32_bf16 v[56:59], a[68:71], a[20:23], v[56:59]
 v_mfma_f32_16x16x32_bf16 v[60:63], a[68:71], a[28:31], v[60:63]
 v_mfma_f32_16x16x32_bf16 v[60:63], a[64:67], a[24:27], v[60:63]
 s_add_u32 m0, s55, 96256
 s_waitcnt lgkmcnt(0)
 v_lshlrev_b32 v34, 16, v36
 v_and_b32 v36, 0xffff0000, v36
 v_add_f32 v4, v34, v36
 v_mfma_f32_16x16x32_bf16 v[92:95], a[72:75], a[24:27], v[92:95]
 s_lshr_b32 s0, s2, 5
 buffer_load_dwordx4 v18, s[12:15], s21 offen offset:2048 lds
 v_mul_f32 v6, v34, v34
 v_mfma_f32_16x16x32_bf16 v[92:95], a[76:79], a[28:31], v[92:95]
 s_mul_i32 s0, s0, 6144
 ds_read_b64_tr_b16 a[136:137], v28 offset:32768
 v_fmac_f32 v6, v36, v36
 v_lshlrev_b32 v34, 16, v37
 v_mfma_f32_16x16x32_bf16 v[88:91], a[76:79], a[20:23], v[88:91]
 s_add_u32 s0, s0, 29884416
 ds_read_b64_tr_b16 a[138:139], v28 offset:34816
 v_and_b32 v37, 0xffff0000, v37
 v_mfma_f32_16x16x32_bf16 v[88:91], a[72:75], a[16:19], v[88:91]
 s_and_b32 s7, s2, 31
 s_lshl2_add_u32 s7, s7, s3
 s_lshl3_add_u32 s1, s7, s0
 v_add_f32 v4, v4, v34
 v_fmac_f32 v6, v34, v34
 v_add_f32 v4, v4, v37
 v_mfma_f32_16x16x32_bf16 v[84:87], a[72:75], a[8:11], v[84:87]
 s_add_u32 m0, s55, 97280
 ds_read_b64_tr_b16 a[140:141], v28 offset:36864
 v_fmac_f32 v6, v37, v37
 v_lshlrev_b32 v34, 16, v38
 v_mfma_f32_16x16x32_bf16 v[84:87], a[76:79], a[12:15], v[84:87]
 s_add_u32 s1, s1, 4096
 buffer_load_dwordx4 v19, s[12:15], s21 offen offset:2048 lds
 v_and_b32 v38, 0xffff0000, v38
 v_mfma_f32_16x16x32_bf16 v[80:83], a[76:79], a[4:7], v[80:83]
 s_lshl_b32 s7, s7, 5
 ds_read_b64_tr_b16 a[142:143], v28 offset:38912
 v_add_f32 v4, v4, v34
 v_fmac_f32 v6, v34, v34
 v_mfma_f32_16x16x32_bf16 v[80:83], a[72:75], a[0:3], v[80:83]
 s_add_u32 s0, s0, s7
 v_add_f32 v4, v4, v38
 v_fmac_f32 v6, v38, v38
 v_mfma_f32_16x16x32_bf16 v[112:115], a[80:83], a[0:3], v[112:115]
 ds_read_b128 a[32:35], v22 offset:8192
 v_lshlrev_b32 v34, 16, v39
 v_and_b32 v39, 0xffff0000, v39
 v_mfma_f32_16x16x32_bf16 v[112:115], a[84:87], a[4:7], v[112:115]
 s_add_u32 m0, s55, 106496
 v_add_f32 v4, v4, v34
 v_fmac_f32 v6, v34, v34
 v_mfma_f32_16x16x32_bf16 v[116:119], a[84:87], a[12:15], v[116:119]
 buffer_load_dwordx4 v20, s[12:15], s21 offen lds
 v_add_f32 v4, v4, v39
 v_fmac_f32 v6, v39, v39
 v_mfma_f32_16x16x32_bf16 v[116:119], a[80:83], a[8:11], v[116:119]
 ds_read_b128 a[36:39], v23 offset:8192
 ds_read_b128 v[36:39], v3 offset:3072
 v_mfma_f32_16x16x32_bf16 v[120:123], a[80:83], a[16:19], v[120:123]
 ds_read_b128 a[40:43], v22 offset:10240
 v_lshlrev_b32 v34, 16, v44
 v_and_b32 v44, 0xffff0000, v44
 v_mfma_f32_16x16x32_bf16 v[120:123], a[84:87], a[20:23], v[120:123]
 v_add_f32 v4, v4, v34
 v_fmac_f32 v6, v34, v34
 v_mfma_f32_16x16x32_bf16 v[124:127], a[84:87], a[28:31], v[124:127]
 s_add_u32 m0, s55, 107520
 ds_read_b128 a[44:47], v23 offset:10240
 v_add_f32 v4, v4, v44
 v_fmac_f32 v6, v44, v44
 v_mfma_f32_16x16x32_bf16 v[124:127], a[80:83], a[24:27], v[124:127]
 buffer_load_dwordx4 v21, s[12:15], s21 offen lds
 v_lshlrev_b32 v34, 16, v45
 v_mfma_f32_16x16x32_bf16 v[156:159], a[88:91], a[24:27], v[156:159]
 ds_read_b128 a[48:51], v22 offset:12288
 v_and_b32 v45, 0xffff0000, v45
 v_add_f32 v4, v4, v34
 v_mfma_f32_16x16x32_bf16 v[156:159], a[92:95], a[28:31], v[156:159]
 v_fmac_f32 v6, v34, v34
 v_add_f32 v4, v4, v45
 v_mfma_f32_16x16x32_bf16 v[152:155], a[92:95], a[20:23], v[152:155]
 ds_read_b128 a[52:55], v23 offset:12288
 v_fmac_f32 v6, v45, v45
 v_mfma_f32_16x16x32_bf16 v[152:155], a[88:91], a[16:19], v[152:155]
 v_lshlrev_b32 v34, 16, v46
 v_and_b32 v46, 0xffff0000, v46
 v_add_f32 v4, v4, v34
 v_mfma_f32_16x16x32_bf16 v[148:151], a[88:91], a[8:11], v[148:151]
 ds_read_b128 a[56:59], v22 offset:14336
 v_fmac_f32 v6, v34, v34
 v_mfma_f32_16x16x32_bf16 v[148:151], a[92:95], a[12:15], v[148:151]
 v_add_f32 v4, v4, v46
 v_fmac_f32 v6, v46, v46
 v_lshlrev_b32 v34, 16, v47
 v_mfma_f32_16x16x32_bf16 v[144:147], a[92:95], a[4:7], v[144:147]
 ds_read_b128 a[60:63], v23 offset:14336
 v_and_b32 v47, 0xffff0000, v47
 v_mfma_f32_16x16x32_bf16 v[144:147], a[88:91], a[0:3], v[144:147]
 v_add_f32 v4, v4, v34
 v_fmac_f32 v6, v34, v34
 v_add_f32 v4, v4, v47
 v_mfma_f32_16x16x32_bf16 v[176:179], a[96:99], a[0:3], v[176:179]
 v_fmac_f32 v6, v47, v47
 v_lshlrev_b32 v34, 16, v40
 v_mfma_f32_16x16x32_bf16 v[176:179], a[100:103], a[4:7], v[176:179]
 v_and_b32 v40, 0xffff0000, v40
 v_add_f32 v5, v34, v40
 v_mul_f32 v7, v34, v34
 v_mfma_f32_16x16x32_bf16 v[180:183], a[100:103], a[12:15], v[180:183]
 v_fmac_f32 v7, v40, v40
 v_lshlrev_b32 v34, 16, v41
 v_mfma_f32_16x16x32_bf16 v[180:183], a[96:99], a[8:11], v[180:183]
 v_and_b32 v41, 0xffff0000, v41
 v_add_f32 v5, v5, v34
 v_mfma_f32_16x16x32_bf16 v[184:187], a[96:99], a[16:19], v[184:187]
 v_fmac_f32 v7, v34, v34
 v_add_f32 v5, v5, v41
 v_fmac_f32 v7, v41, v41
 v_mfma_f32_16x16x32_bf16 v[184:187], a[100:103], a[20:23], v[184:187]
 v_lshlrev_b32 v34, 16, v42
 v_and_b32 v42, 0xffff0000, v42
 v_mfma_f32_16x16x32_bf16 v[188:191], a[100:103], a[28:31], v[188:191]
 v_add_f32 v5, v5, v34
 v_fmac_f32 v7, v34, v34
 v_add_f32 v5, v5, v42
 v_mfma_f32_16x16x32_bf16 v[188:191], a[96:99], a[24:27], v[188:191]
 v_fmac_f32 v7, v42, v42
 v_lshlrev_b32 v34, 16, v43
 v_mfma_f32_16x16x32_bf16 v[220:223], a[104:107], a[24:27], v[220:223]
 v_and_b32 v43, 0xffff0000, v43
 v_add_f32 v5, v5, v34
 v_fmac_f32 v7, v34, v34
 v_mfma_f32_16x16x32_bf16 v[220:223], a[108:111], a[28:31], v[220:223]
 v_add_f32 v5, v5, v43
 v_fmac_f32 v7, v43, v43
 v_mfma_f32_16x16x32_bf16 v[216:219], a[108:111], a[20:23], v[216:219]
 s_waitcnt lgkmcnt(0)
 v_lshlrev_b32 v34, 16, v36
 v_and_b32 v36, 0xffff0000, v36
 v_mfma_f32_16x16x32_bf16 v[216:219], a[104:107], a[16:19], v[216:219]
 v_add_f32 v5, v5, v34
 v_fmac_f32 v7, v34, v34
 v_add_f32 v5, v5, v36
 v_mfma_f32_16x16x32_bf16 v[212:215], a[104:107], a[8:11], v[212:215]
 v_fmac_f32 v7, v36, v36
 v_lshlrev_b32 v34, 16, v37
 v_mfma_f32_16x16x32_bf16 v[212:215], a[108:111], a[12:15], v[212:215]
 v_and_b32 v37, 0xffff0000, v37
 v_add_f32 v5, v5, v34
 v_mfma_f32_16x16x32_bf16 v[208:211], a[108:111], a[4:7], v[208:211]
 v_fmac_f32 v7, v34, v34
 v_add_f32 v5, v5, v37
 v_mfma_f32_16x16x32_bf16 v[208:211], a[104:107], a[0:3], v[208:211]
 buffer_load_dword v0, v33, s[44:47], s60 offen
 v_fmac_f32 v7, v37, v37
 v_lshlrev_b32 v34, 16, v38
 v_mfma_f32_16x16x32_bf16 v[240:243], a[0:3], a[112:115], v[240:243]
 s_add_u32 s60, s60, 1664
 v_and_b32 v38, 0xffff0000, v38
 v_add_f32 v5, v5, v34
 v_mfma_f32_16x16x32_bf16 v[240:243], a[4:7], a[116:119], v[240:243]
 v_fmac_f32 v7, v34, v34
 v_add_f32 v5, v5, v38
 v_mfma_f32_16x16x32_bf16 v[244:247], a[12:15], a[116:119], v[244:247]
 v_fmac_f32 v7, v38, v38
 v_lshlrev_b32 v34, 16, v39
 v_mfma_f32_16x16x32_bf16 v[244:247], a[8:11], a[112:115], v[244:247]
 v_and_b32 v39, 0xffff0000, v39
 v_add_f32 v5, v5, v34
 v_fmac_f32 v7, v34, v34
 v_mfma_f32_16x16x32_bf16 v[248:251], a[16:19], a[112:115], v[248:251]
 v_add_f32 v5, v5, v39
 v_fmac_f32 v7, v39, v39
 v_mfma_f32_16x16x32_bf16 v[248:251], a[20:23], a[116:119], v[248:251]
 v_lshrrev_b32 v46, 3, v2
 v_lshrrev_b32 v47, 1, v2
 v_mfma_f32_16x16x32_bf16 v[252:255], a[28:31], a[116:119], v[252:255]
 v_permlane32_swap_b32 v4, v5
 v_permlane32_swap_b32 v6, v7
 v_mfma_f32_16x16x32_bf16 v[252:255], a[24:27], a[112:115], v[252:255]
 v_add_f32 v4, v4, v5
 v_add_f32 v6, v6, v7
 v_mfma_f32_16x16x32_bf16 a[172:175], a[24:27], a[120:123], a[172:175]
 v_mov_b32 v45, 0x3a800000
 v_mfma_f32_16x16x32_bf16 a[172:175], a[28:31], a[124:127], a[172:175]
 v_permlane16_swap_b32 v4, v6
 v_add_f32 v4, v4, v6
 v_mfma_f32_16x16x32_bf16 a[168:171], a[20:23], a[124:127], a[168:171]
 s_nop 0
 v_add_f32_dpp v4, v4, v4 row_ror:8 row_mask:0xf bank_mask:0xf
 v_mfma_f32_16x16x32_bf16 a[168:171], a[16:19], a[120:123], a[168:171]
 s_nop 0
 v_add_f32_dpp v4, v4, v4 row_ror:4 row_mask:0xf bank_mask:0xf
 v_mfma_f32_16x16x32_bf16 a[164:167], a[8:11], a[120:123], a[164:167]
 s_nop 0
 v_add_f32_dpp v4, v4, v4 row_ror:2 row_mask:0xf bank_mask:0xf
 v_mfma_f32_16x16x32_bf16 a[164:167], a[12:15], a[124:127], a[164:167]
 s_nop 0
 v_add_f32_dpp v4, v4, v4 row_ror:1 row_mask:0xf bank_mask:0xf
 v_mfma_f32_16x16x32_bf16 a[160:163], a[4:7], a[124:127], a[160:163]
 v_mov_b32 v6, v4
 v_mfma_f32_16x16x32_bf16 a[160:163], a[0:3], a[120:123], a[160:163]
 s_waitcnt lgkmcnt(0)
 s_nop 0
 v_permlane16_swap_b32 v4, v6
 v_mul_f32 v36, 0xba800000, v4
 v_mfma_f32_16x16x32_bf16 a[192:195], a[0:3], a[128:131], a[192:195]
 s_add_u32 s23, s23, 1
 s_and_b32 s23, s23, 15
 s_mul_i32 s22, s23, 458752
 v_mul_f32 v44, v36, v36
 v_fma_f32 v44, v6, v45, -v44
 v_mfma_f32_16x16x32_bf16 a[192:195], a[4:7], a[132:135], a[192:195]
 s_mul_i32 s21, s23, 393216
 s_lshl_b32 s20, s23, 7
 v_max_f32 v44, 0, v44
 v_cvt_pk_bf16_f32 v44, v36, v44
 v_mfma_f32_16x16x32_bf16 a[196:199], a[12:15], a[132:135], a[196:199]
 v_lshlrev_b32 v36, 16, v44
 v_and_b32 v44, 0xffff0000, v44
 v_mfma_f32_16x16x32_bf16 a[196:199], a[8:11], a[128:131], a[196:199]
 v_add_f32 v44, 0x3727c5ac, v44
 v_cvt_pk_bf16_f32 v44, 0, v44
 v_mfma_f32_16x16x32_bf16 a[200:203], a[16:19], a[128:131], a[200:203]
 v_sqrt_f32 v44, v44
 v_mfma_f32_16x16x32_bf16 a[200:203], a[20:23], a[132:135], a[200:203]
 v_cvt_pk_bf16_f32 v44, 0, v44
 v_mul_f32 v39, v44, v44
 v_mfma_f32_16x16x32_bf16 a[204:207], a[28:31], a[132:135], a[204:207]
 v_rcp_f32 v44, v44
 v_mfma_f32_16x16x32_bf16 a[204:207], a[24:27], a[128:131], a[204:207]
 v_mul_f32 v37, 0xc0135761, v44
 v_mul_f32 v45, v44, v44
 v_mfma_f32_16x16x32_bf16 a[236:239], a[24:27], a[136:139], a[236:239]
 v_mul_f32 v38, 0x3d372713, v37
 v_mul_f32 v38, v38, v45
 v_mfma_f32_16x16x32_bf16 a[236:239], a[28:31], a[140:143], a[236:239]
 v_mov_b64 v[4:5], -1
 v_mov_b64 v[6:7], -1
 v_mfma_f32_16x16x32_bf16 a[232:235], a[20:23], a[140:143], a[232:235]
 s_mov_b64 exec, s[72:73]
 buffer_store_dwordx4 v[36:39], v47, s[24:27], s0 offen sc1
 s_mov_b64 exec, -1
 v_mfma_f32_16x16x32_bf16 a[232:235], a[16:19], a[136:139], a[232:235]
 v_mfma_f32_16x16x32_bf16 a[228:231], a[8:11], a[136:139], a[228:231]
 s_mov_b64 exec, s[72:73]
 buffer_store_dword v36, v46, s[24:27], s1 offen sc1
 s_mov_b64 exec, -1
 v_mfma_f32_16x16x32_bf16 a[228:231], a[12:15], a[140:143], a[228:231]
 v_mfma_f32_16x16x32_bf16 a[224:227], a[4:7], a[140:143], a[224:227]
 s_mov_b64 exec, s[72:73]
 buffer_store_dword v44, v46, s[24:27], s1 offen offset:1024 sc1
 s_mov_b64 exec, -1
 v_mfma_f32_16x16x32_bf16 a[224:227], a[0:3], a[136:139], a[224:227]
 v_mfma_f32_16x16x32_bf16 v[64:67], a[64:67], a[32:35], v[64:67]
 s_waitcnt vmcnt(4)
 s_barrier
 s_branch L_lbm0
 .p2align 4
L_lb0:
 s_waitcnt lgkmcnt(4)
 v_mfma_f32_16x16x32_bf16 v[48:51], a[64:67], a[0:3], v[48:51]
 v_mfma_f32_16x16x32_bf16 v[48:51], a[68:71], a[4:7], v[48:51]
 ds_read_b64_tr_b16 a[136:137], v28 offset:32768
 v_mfma_f32_16x16x32_bf16 v[52:55], a[68:71], a[12:15], v[52:55]
 v_mfma_f32_16x16x32_bf16 v[52:55], a[64:67], a[8:11], v[52:55]
 s_add_u32 m0, s55, 106496
 v_mfma_f32_16x16x32_bf16 v[56:59], a[64:67], a[16:19], v[56:59]
 buffer_load_dwordx4 v20, s[12:15], s21 offen lds
 v_mfma_f32_16x16x32_bf16 v[56:59], a[68:71], a[20:23], v[56:59]
 ds_read_b64_tr_b16 a[138:139], v28 offset:34816
 v_mfma_f32_16x16x32_bf16 v[60:63], a[68:71], a[28:31], v[60:63]
 v_mfma_f32_16x16x32_bf16 v[60:63], a[64:67], a[24:27], v[60:63]
 ds_read_b64_tr_b16 a[140:141], v28 offset:36864
 v_mfma_f32_16x16x32_bf16 v[92:95], a[72:75], a[24:27], v[92:95]
 s_add_u32 m0, s55, 107520
 v_mfma_f32_16x16x32_bf16 v[92:95], a[76:79], a[28:31], v[92:95]
 buffer_load_dwordx4 v21, s[12:15], s21 offen lds
 v_mfma_f32_16x16x32_bf16 v[88:91], a[76:79], a[20:23], v[88:91]
 ds_read_b64_tr_b16 a[142:143], v28 offset:38912
 v_mfma_f32_16x16x32_bf16 v[88:91], a[72:75], a[16:19], v[88:91]
 v_mfma_f32_16x16x32_bf16 v[84:87], a[72:75], a[8:11], v[84:87]
 v_mfma_f32_16x16x32_bf16 v[84:87], a[76:79], a[12:15], v[84:87]
 ds_read_b128 a[32:35], v22 offset:8192
 v_mfma_f32_16x16x32_bf16 v[80:83], a[76:79], a[4:7], v[80:83]
 v_mfma_f32_16x16x32_bf16 v[80:83], a[72:75], a[0:3], v[80:83]
 v_mfma_f32_16x16x32_bf16 v[112:115], a[80:83], a[0:3], v[112:115]
 ds_read_b128 a[36:39], v23 offset:8192
 v_mfma_f32_16x16x32_bf16 v[112:115], a[84:87], a[4:7], v[112:115]
 v_mfma_f32_16x16x32_bf16 v[116:119], a[84:87], a[12:15], v[116:119]
 v_mfma_f32_16x16x32_bf16 v[116:119], a[80:83], a[8:11], v[116:119]
 ds_read_b128 a[40:43], v22 offset:10240
 v_mfma_f32_16x16x32_bf16 v[120:123], a[80:83], a[16:19], v[120:123]
 v_mfma_f32_16x16x32_bf16 v[120:123], a[84:87], a[20:23], v[120:123]
 v_mfma_f32_16x16x32_bf16 v[124:127], a[84:87], a[28:31], v[124:127]
 ds_read_b128 a[44:47], v23 offset:10240
 v_mfma_f32_16x16x32_bf16 v[124:127], a[80:83], a[24:27], v[124:127]
 v_mfma_f32_16x16x32_bf16 v[156:159], a[88:91], a[24:27], v[156:159]
 v_mfma_f32_16x16x32_bf16 v[156:159], a[92:95], a[28:31], v[156:159]
 ds_read_b128 a[48:51], v22 offset:12288
 v_mfma_f32_16x16x32_bf16 v[152:155], a[92:95], a[20:23], v[152:155]
 v_mfma_f32_16x16x32_bf16 v[152:155], a[88:91], a[16:19], v[152:155]
 buffer_load_dword v0, v33, s[44:47], s60 offen
 v_mfma_f32_16x16x32_bf16 v[148:151], a[88:91], a[8:11], v[148:151]
 s_add_u32 s60, s60, 1664
 ds_read_b128 a[52:55], v23 offset:12288
 v_mfma_f32_16x16x32_bf16 v[148:151], a[92:95], a[12:15], v[148:151]
 v_mfma_f32_16x16x32_bf16 v[144:147], a[92:95], a[4:7], v[144:147]
 v_mfma_f32_16x16x32_bf16 v[144:147], a[88:91], a[0:3], v[144:147]
 ds_read_b128 a[56:59], v22 offset:14336
 v_mfma_f32_16x16x32_bf16 v[176:179], a[96:99], a[0:3], v[176:179]
 v_mfma_f32_16x16x32_bf16 v[176:179], a[100:103], a[4:7], v[176:179]
 v_mfma_f32_16x16x32_bf16 v[180:183], a[100:103], a[12:15], v[180:183]
 ds_read_b128 a[60:63], v23 offset:14336
 v_mfma_f32_16x16x32_bf16 v[180:183], a[96:99], a[8:11], v[180:183]
 v_mfma_f32_16x16x32_bf16 v[184:187], a[96:99], a[16:19], v[184:187]
 v_mfma_f32_16x16x32_bf16 v[184:187], a[100:103], a[20:23], v[184:187]
 v_mfma_f32_16x16x32_bf16 v[188:191], a[100:103], a[28:31], v[188:191]
 v_mfma_f32_16x16x32_bf16 v[188:191], a[96:99], a[24:27], v[188:191]
 v_mfma_f32_16x16x32_bf16 v[220:223], a[104:107], a[24:27], v[220:223]
 v_mfma_f32_16x16x32_bf16 v[220:223], a[108:111], a[28:31], v[220:223]
 v_mfma_f32_16x16x32_bf16 v[216:219], a[108:111], a[20:23], v[216:219]
 v_mfma_f32_16x16x32_bf16 v[216:219], a[104:107], a[16:19], v[216:219]
 v_mfma_f32_16x16x32_bf16 v[212:215], a[104:107], a[8:11], v[212:215]
 v_mfma_f32_16x16x32_bf16 v[212:215], a[108:111], a[12:15], v[212:215]
 v_mfma_f32_16x16x32_bf16 v[208:211], a[108:111], a[4:7], v[208:211]
 v_mfma_f32_16x16x32_bf16 v[208:211], a[104:107], a[0:3], v[208:211]
 v_mfma_f32_16x16x32_bf16 v[240:243], a[0:3], a[112:115], v[240:243]
 v_mfma_f32_16x16x32_bf16 v[240:243], a[4:7], a[116:119], v[240:243]
 v_mfma_f32_16x16x32_bf16 v[244:247], a[12:15], a[116:119], v[244:247]
 v_mfma_f32_16x16x32_bf16 v[244:247], a[8:11], a[112:115], v[244:247]
 v_mfma_f32_16x16x32_bf16 v[248:251], a[16:19], a[112:115], v[248:251]
 v_mfma_f32_16x16x32_bf16 v[248:251], a[20:23], a[116:119], v[248:251]
 v_mfma_f32_16x16x32_bf16 v[252:255], a[28:31], a[116:119], v[252:255]
 v_mfma_f32_16x16x32_bf16 v[252:255], a[24:27], a[112:115], v[252:255]
 v_mfma_f32_16x16x32_bf16 a[172:175], a[24:27], a[120:123], a[172:175]
 v_mfma_f32_16x16x32_bf16 a[172:175], a[28:31], a[124:127], a[172:175]
 v_mfma_f32_16x16x32_bf16 a[168:171], a[20:23], a[124:127], a[168:171]
 v_mfma_f32_16x16x32_bf16 a[168:171], a[16:19], a[120:123], a[168:171]
 v_mfma_f32_16x16x32_bf16 a[164:167], a[8:11], a[120:123], a[164:167]
 v_mfma_f32_16x16x32_bf16 a[164:167], a[12:15], a[124:127], a[164:167]
 v_mfma_f32_16x16x32_bf16 a[160:163], a[4:7], a[124:127], a[160:163]
 v_mfma_f32_16x16x32_bf16 a[160:163], a[0:3], a[120:123], a[160:163]
 s_waitcnt lgkmcnt(0)
 v_mfma_f32_16x16x32_bf16 a[192:195], a[0:3], a[128:131], a[192:195]
 s_add_u32 s23, s23, 1
 s_and_b32 s23, s23, 15
 s_mul_i32 s22, s23, 458752
 v_mfma_f32_16x16x32_bf16 a[192:195], a[4:7], a[132:135], a[192:195]
 s_mul_i32 s21, s23, 393216
 s_lshl_b32 s20, s23, 7
 v_mfma_f32_16x16x32_bf16 a[196:199], a[12:15], a[132:135], a[196:199]
 v_mfma_f32_16x16x32_bf16 a[196:199], a[8:11], a[128:131], a[196:199]
 v_mfma_f32_16x16x32_bf16 a[200:203], a[16:19], a[128:131], a[200:203]
 v_mfma_f32_16x16x32_bf16 a[200:203], a[20:23], a[132:135], a[200:203]
 v_mfma_f32_16x16x32_bf16 a[204:207], a[28:31], a[132:135], a[204:207]
 v_mfma_f32_16x16x32_bf16 a[204:207], a[24:27], a[128:131], a[204:207]
 v_mfma_f32_16x16x32_bf16 a[236:239], a[24:27], a[136:139], a[236:239]
 v_mfma_f32_16x16x32_bf16 a[236:239], a[28:31], a[140:143], a[236:239]
 v_mfma_f32_16x16x32_bf16 a[232:235], a[20:23], a[140:143], a[232:235]
 v_mfma_f32_16x16x32_bf16 a[232:235], a[16:19], a[136:139], a[232:235]
 v_mfma_f32_16x16x32_bf16 a[228:231], a[8:11], a[136:139], a[228:231]
 v_mfma_f32_16x16x32_bf16 a[228:231], a[12:15], a[140:143], a[228:231]
 v_mfma_f32_16x16x32_bf16 a[224:227], a[4:7], a[140:143], a[224:227]
 v_mfma_f32_16x16x32_bf16 a[224:227], a[0:3], a[136:139], a[224:227]
 v_mfma_f32_16x16x32_bf16 v[64:67], a[64:67], a[32:35], v[64:67]
 s_waitcnt vmcnt(1)
 s_barrier
L_lbm0:
 v_mfma_f32_16x16x32_bf16 v[64:67], a[68:71], a[36:39], v[64:67]
 s_cmp_eq_u32 s57, s70
 v_mfma_f32_16x16x32_bf16 v[68:71], a[68:71], a[44:47], v[68:71]
 s_cbranch_scc1 L_at00
L_at00_d:
 v_mfma_f32_16x16x32_bf16 v[68:71], a[64:67], a[40:43], v[68:71]
 s_add_u32 m0, s54, 0
 v_mfma_f32_16x16x32_bf16 v[72:75], a[64:67], a[48:51], v[72:75]
 buffer_load_dwordx4 v8, s[8:11], s20 offen lds
 s_branch L_tp_L_tA_4_o
L_tp_L_tA_4:
 s_nop 0
 s_branch L_tp_L_tA_8
 s_nop 0
L_tp_L_tA_4_o:
 v_mfma_f32_16x16x32_bf16 v[72:75], a[68:71], a[52:55], v[72:75]
 ds_read_b128 a[0:3], v24 offset:0
 v_mfma_f32_16x16x32_bf16 v[76:79], a[68:71], a[60:63], v[76:79]
 ds_read_b128 a[4:7], v25 offset:0
 v_mfma_f32_16x16x32_bf16 v[76:79], a[64:67], a[56:59], v[76:79]
 v_mfma_f32_16x16x32_bf16 v[108:111], a[72:75], a[56:59], v[108:111]
 s_add_u32 m0, s54, 1024
 v_mfma_f32_16x16x32_bf16 v[108:111], a[76:79], a[60:63], v[108:111]
 buffer_load_dwordx4 v9, s[8:11], s20 offen lds
 v_mfma_f32_16x16x32_bf16 v[104:107], a[76:79], a[52:55], v[104:107]
 ds_read_b64_tr_b16 a[64:65], v27 offset:0
 v_mfma_f32_16x16x32_bf16 v[104:107], a[72:75], a[48:51], v[104:107]
 ds_read_b64_tr_b16 a[66:67], v27 offset:2048
 v_mfma_f32_16x16x32_bf16 v[100:103], a[72:75], a[40:43], v[100:103]
 v_mfma_f32_16x16x32_bf16 v[100:103], a[76:79], a[44:47], v[100:103]
 s_add_u32 m0, s54, 2048
 ds_read_b64_tr_b16 a[68:69], v27 offset:4096
 v_mfma_f32_16x16x32_bf16 v[96:99], a[76:79], a[36:39], v[96:99]
 buffer_load_dwordx4 v10, s[8:11], s20 offen lds
 v_mfma_f32_16x16x32_bf16 v[96:99], a[72:75], a[32:35], v[96:99]
 ds_read_b64_tr_b16 a[70:71], v27 offset:6144
 v_mfma_f32_16x16x32_bf16 v[128:131], a[80:83], a[32:35], v[128:131]
 ds_read_b128 a[8:11], v24 offset:2048
 v_mfma_f32_16x16x32_bf16 v[128:131], a[84:87], a[36:39], v[128:131]
 ds_read_b64_tr_b16 a[72:73], v27 offset:8192
 v_mfma_f32_16x16x32_bf16 v[132:135], a[84:87], a[44:47], v[132:135]
 s_add_u32 m0, s54, 3072
 v_mfma_f32_16x16x32_bf16 v[132:135], a[80:83], a[40:43], v[132:135]
 buffer_load_dwordx4 v11, s[8:11], s20 offen lds
 v_mfma_f32_16x16x32_bf16 v[136:139], a[80:83], a[48:51], v[136:139]
 ds_read_b64_tr_b16 a[74:75], v27 offset:10240
 v_mfma_f32_16x16x32_bf16 v[136:139], a[84:87], a[52:55], v[136:139]
 ds_read_b64_tr_b16 a[76:77], v27 offset:12288
 v_mfma_f32_16x16x32_bf16 v[140:143], a[84:87], a[60:63], v[140:143]
 ds_read_b128 a[12:15], v25 offset:2048
 v_mfma_f32_16x16x32_bf16 v[140:143], a[80:83], a[56:59], v[140:143]
 s_add_u32 m0, s54, 4096
 ds_read_b64_tr_b16 a[78:79], v27 offset:14336
 v_mfma_f32_16x16x32_bf16 v[172:175], a[88:91], a[56:59], v[172:175]
 buffer_load_dwordx4 v12, s[8:11], s20 offen lds
 v_mfma_f32_16x16x32_bf16 v[172:175], a[92:95], a[60:63], v[172:175]
 ds_read_b64_tr_b16 a[80:81], v29 offset:0
 v_mfma_f32_16x16x32_bf16 v[168:171], a[92:95], a[52:55], v[168:171]
 v_mfma_f32_16x16x32_bf16 v[168:171], a[88:91], a[48:51], v[168:171]
 ds_read_b64_tr_b16 a[82:83], v29 offset:2048
 v_mfma_f32_16x16x32_bf16 v[164:167], a[88:91], a[40:43], v[164:167]
 s_add_u32 m0, s54, 5120
 v_mfma_f32_16x16x32_bf16 v[164:167], a[92:95], a[44:47], v[164:167]
 buffer_load_dwordx4 v13, s[8:11], s20 offen lds
 v_mfma_f32_16x16x32_bf16 v[160:163], a[92:95], a[36:39], v[160:163]
 ds_read_b64_tr_b16 a[84:85], v29 offset:4096
 v_mfma_f32_16x16x32_bf16 v[160:163], a[88:91], a[32:35], v[160:163]
 ds_read_b64_tr_b16 a[86:87], v29 offset:6144
 v_mfma_f32_16x16x32_bf16 v[192:195], a[96:99], a[32:35], v[192:195]
 ds_read_b128 a[16:19], v24 offset:4096
 v_mfma_f32_16x16x32_bf16 v[192:195], a[100:103], a[36:39], v[192:195]
 s_add_u32 m0, s54, 6144
 ds_read_b64_tr_b16 a[88:89], v29 offset:8192
 v_mfma_f32_16x16x32_bf16 v[196:199], a[100:103], a[44:47], v[196:199]
 buffer_load_dwordx4 v14, s[8:11], s20 offen lds
 v_mfma_f32_16x16x32_bf16 v[196:199], a[96:99], a[40:43], v[196:199]
 ds_read_b64_tr_b16 a[90:91], v29 offset:10240
 v_mfma_f32_16x16x32_bf16 v[200:203], a[96:99], a[48:51], v[200:203]
 v_mfma_f32_16x16x32_bf16 v[200:203], a[100:103], a[52:55], v[200:203]
 ds_read_b64_tr_b16 a[92:93], v29 offset:12288
 v_mfma_f32_16x16x32_bf16 v[204:207], a[100:103], a[60:63], v[204:207]
 s_add_u32 m0, s54, 7168
 ds_read_b128 a[20:23], v25 offset:4096
 v_mfma_f32_16x16x32_bf16 v[204:207], a[96:99], a[56:59], v[204:207]
 buffer_load_dwordx4 v15, s[8:11], s20 offen lds
 v_mfma_f32_16x16x32_bf16 v[236:239], a[104:107], a[56:59], v[236:239]
 ds_read_b64_tr_b16 a[94:95], v29 offset:14336
 v_mfma_f32_16x16x32_bf16 v[236:239], a[108:111], a[60:63], v[236:239]
 ds_read_b64_tr_b16 a[96:97], v27 offset:16384
 v_mfma_f32_16x16x32_bf16 v[232:235], a[108:111], a[52:55], v[232:235]
 v_mfma_f32_16x16x32_bf16 v[232:235], a[104:107], a[48:51], v[232:235]
 s_add_u32 m0, s55, 0
 ds_read_b64_tr_b16 a[98:99], v27 offset:18432
 v_mfma_f32_16x16x32_bf16 v[228:231], a[104:107], a[40:43], v[228:231]
 buffer_load_dwordx4 v16, s[16:19], s22 offen lds
 v_mfma_f32_16x16x32_bf16 v[228:231], a[108:111], a[44:47], v[228:231]
 ds_read_b64_tr_b16 a[100:101], v27 offset:20480
 v_mfma_f32_16x16x32_bf16 v[224:227], a[108:111], a[36:39], v[224:227]
 ds_read_b128 a[24:27], v24 offset:6144
 v_mfma_f32_16x16x32_bf16 v[224:227], a[104:107], a[32:35], v[224:227]
 ds_read_b64_tr_b16 a[102:103], v27 offset:22528
 v_mfma_f32_16x16x32_bf16 a[144:147], a[32:35], a[112:115], a[144:147]
 s_add_u32 m0, s55, 1024
 v_mfma_f32_16x16x32_bf16 a[144:147], a[36:39], a[116:119], a[144:147]
 buffer_load_dwordx4 v17, s[16:19], s22 offen lds
 v_mfma_f32_16x16x32_bf16 a[148:151], a[44:47], a[116:119], a[148:151]
 ds_read_b64_tr_b16 a[104:105], v29 offset:16384
 v_mfma_f32_16x16x32_bf16 a[148:151], a[40:43], a[112:115], a[148:151]
 ds_read_b64_tr_b16 a[106:107], v29 offset:18432
 v_mfma_f32_16x16x32_bf16 a[152:155], a[48:51], a[112:115], a[152:155]
 v_mfma_f32_16x16x32_bf16 a[152:155], a[52:55], a[116:119], a[152:155]
 s_add_u32 m0, s55, 8192
 ds_read_b64_tr_b16 a[108:109], v29 offset:20480
 v_mfma_f32_16x16x32_bf16 a[156:159], a[60:63], a[116:119], a[156:159]
 buffer_load_dwordx4 v16, s[64:67], s22 offen lds
 v_mfma_f32_16x16x32_bf16 a[156:159], a[56:59], a[112:115], a[156:159]
 ds_read_b64_tr_b16 a[110:111], v29 offset:22528
 v_mfma_f32_16x16x32_bf16 a[188:191], a[56:59], a[120:123], a[188:191]
 ds_read_b128 a[28:31], v25 offset:6144
 v_mfma_f32_16x16x32_bf16 a[188:191], a[60:63], a[124:127], a[188:191]
 ds_read_b64_tr_b16 a[112:113], v27 offset:24576
 v_mfma_f32_16x16x32_bf16 a[184:187], a[52:55], a[124:127], a[184:187]
 s_add_u32 m0, s55, 9216
 v_mfma_f32_16x16x32_bf16 a[184:187], a[48:51], a[120:123], a[184:187]
 buffer_load_dwordx4 v17, s[64:67], s22 offen lds
 v_mfma_f32_16x16x32_bf16 a[180:183], a[40:43], a[120:123], a[180:183]
 ds_read_b64_tr_b16 a[114:115], v27 offset:26624
 v_mfma_f32_16x16x32_bf16 a[180:183], a[44:47], a[124:127], a[180:183]
 ds_read_b64_tr_b16 a[116:117], v27 offset:28672
 v_mfma_f32_16x16x32_bf16 a[176:179], a[36:39], a[124:127], a[176:179]
 v_mfma_f32_16x16x32_bf16 a[176:179], a[32:35], a[120:123], a[176:179]
 s_add_u32 m0, s55, 16384
 ds_read_b64_tr_b16 a[118:119], v27 offset:30720
 v_mfma_f32_16x16x32_bf16 a[208:211], a[32:35], a[128:131], a[208:211]
 buffer_load_dwordx4 v18, s[12:15], s21 offen lds
 v_mfma_f32_16x16x32_bf16 a[208:211], a[36:39], a[132:135], a[208:211]
 ds_read_b64_tr_b16 a[120:121], v29 offset:24576
 v_mfma_f32_16x16x32_bf16 a[212:215], a[44:47], a[132:135], a[212:215]
 v_mfma_f32_16x16x32_bf16 a[212:215], a[40:43], a[128:131], a[212:215]
 ds_read_b64_tr_b16 a[122:123], v29 offset:26624
 v_mfma_f32_16x16x32_bf16 a[216:219], a[48:51], a[128:131], a[216:219]
 s_add_u32 m0, s55, 17408
 v_mfma_f32_16x16x32_bf16 a[216:219], a[52:55], a[132:135], a[216:219]
 buffer_load_dwordx4 v19, s[12:15], s21 offen lds
 v_mfma_f32_16x16x32_bf16 a[220:223], a[60:63], a[132:135], a[220:223]
 ds_read_b64_tr_b16 a[124:125], v29 offset:28672
 v_mfma_f32_16x16x32_bf16 a[220:223], a[56:59], a[128:131], a[220:223]
 ds_read_b64_tr_b16 a[126:127], v29 offset:30720
 v_mfma_f32_16x16x32_bf16 a[252:255], a[56:59], a[136:139], a[252:255]
 v_mfma_f32_16x16x32_bf16 a[252:255], a[60:63], a[140:143], a[252:255]
 s_add_u32 m0, s55, 22528
 ds_read_b64_tr_b16 a[128:129], v27 offset:32768
 v_mfma_f32_16x16x32_bf16 a[248:251], a[52:55], a[140:143], a[248:251]
 buffer_load_dwordx4 v18, s[12:15], s21 offen offset:2048 lds
 v_mfma_f32_16x16x32_bf16 a[248:251], a[48:51], a[136:139], a[248:251]
 ds_read_b64_tr_b16 a[130:131], v27 offset:34816
 v_mfma_f32_16x16x32_bf16 a[244:247], a[40:43], a[136:139], a[244:247]
 s_branch L_tp_L_tA_5_o
L_tp_L_tA_5:
 s_nop 0
 s_nop 0
 s_branch L_tr00
L_tp_L_tA_5_o:
 v_mfma_f32_16x16x32_bf16 a[244:247], a[44:47], a[140:143], a[244:247]
 s_add_u32 m0, s55, 23552
 ds_read_b64_tr_b16 a[132:133], v27 offset:36864
 v_mfma_f32_16x16x32_bf16 a[240:243], a[36:39], a[140:143], a[240:243]
 buffer_load_dwordx4 v19, s[12:15], s21 offen offset:2048 lds
 v_mfma_f32_16x16x32_bf16 a[240:243], a[32:35], a[136:139], a[240:243]
 ds_read_b64_tr_b16 a[134:135], v27 offset:38912
 s_waitcnt lgkmcnt(4)
 v_mfma_f32_16x16x32_bf16 v[48:51], a[64:67], a[0:3], v[48:51]
 v_mfma_f32_16x16x32_bf16 v[48:51], a[68:71], a[4:7], v[48:51]
 ds_read_b64_tr_b16 a[136:137], v29 offset:32768
 v_mfma_f32_16x16x32_bf16 v[52:55], a[68:71], a[12:15], v[52:55]
 v_mfma_f32_16x16x32_bf16 v[52:55], a[64:67], a[8:11], v[52:55]
 s_add_u32 m0, s55, 32768
 v_mfma_f32_16x16x32_bf16 v[56:59], a[64:67], a[16:19], v[56:59]
 buffer_load_dwordx4 v20, s[12:15], s21 offen lds
 v_mfma_f32_16x16x32_bf16 v[56:59], a[68:71], a[20:23], v[56:59]
 ds_read_b64_tr_b16 a[138:139], v29 offset:34816
 v_mfma_f32_16x16x32_bf16 v[60:63], a[68:71], a[28:31], v[60:63]
 v_mfma_f32_16x16x32_bf16 v[60:63], a[64:67], a[24:27], v[60:63]
 ds_read_b64_tr_b16 a[140:141], v29 offset:36864
 v_mfma_f32_16x16x32_bf16 v[92:95], a[72:75], a[24:27], v[92:95]
 s_add_u32 m0, s55, 33792
 v_mfma_f32_16x16x32_bf16 v[92:95], a[76:79], a[28:31], v[92:95]
 buffer_load_dwordx4 v21, s[12:15], s21 offen lds
 v_mfma_f32_16x16x32_bf16 v[88:91], a[76:79], a[20:23], v[88:91]
 ds_read_b64_tr_b16 a[142:143], v29 offset:38912
 v_mfma_f32_16x16x32_bf16 v[88:91], a[72:75], a[16:19], v[88:91]
 v_mfma_f32_16x16x32_bf16 v[84:87], a[72:75], a[8:11], v[84:87]
 v_mfma_f32_16x16x32_bf16 v[84:87], a[76:79], a[12:15], v[84:87]
 ds_read_b128 a[32:35], v24 offset:8192
 v_mfma_f32_16x16x32_bf16 v[80:83], a[76:79], a[4:7], v[80:83]
 v_mfma_f32_16x16x32_bf16 v[80:83], a[72:75], a[0:3], v[80:83]
 v_mfma_f32_16x16x32_bf16 v[112:115], a[80:83], a[0:3], v[112:115]
 ds_read_b128 a[36:39], v25 offset:8192
 v_mfma_f32_16x16x32_bf16 v[112:115], a[84:87], a[4:7], v[112:115]
 v_mfma_f32_16x16x32_bf16 v[116:119], a[84:87], a[12:15], v[116:119]
 v_mfma_f32_16x16x32_bf16 v[116:119], a[80:83], a[8:11], v[116:119]
 ds_read_b128 a[40:43], v24 offset:10240
 v_mfma_f32_16x16x32_bf16 v[120:123], a[80:83], a[16:19], v[120:123]
 v_mfma_f32_16x16x32_bf16 v[120:123], a[84:87], a[20:23], v[120:123]
 v_mfma_f32_16x16x32_bf16 v[124:127], a[84:87], a[28:31], v[124:127]
 ds_read_b128 a[44:47], v25 offset:10240
 v_mfma_f32_16x16x32_bf16 v[124:127], a[80:83], a[24:27], v[124:127]
 v_mfma_f32_16x16x32_bf16 v[156:159], a[88:91], a[24:27], v[156:159]
 v_mfma_f32_16x16x32_bf16 v[156:159], a[92:95], a[28:31], v[156:159]
 ds_read_b128 a[48:51], v24 offset:12288
 v_mfma_f32_16x16x32_bf16 v[152:155], a[92:95], a[20:23], v[152:155]
 v_mfma_f32_16x16x32_bf16 v[152:155], a[88:91], a[16:19], v[152:155]
 buffer_load_dword v0, v33, s[44:47], s60 offen
 v_mfma_f32_16x16x32_bf16 v[148:151], a[88:91], a[8:11], v[148:151]
 s_add_u32 s60, s60, 1664
 ds_read_b128 a[52:55], v25 offset:12288
 v_mfma_f32_16x16x32_bf16 v[148:151], a[92:95], a[12:15], v[148:151]
 v_mfma_f32_16x16x32_bf16 v[144:147], a[92:95], a[4:7], v[144:147]
 v_mfma_f32_16x16x32_bf16 v[144:147], a[88:91], a[0:3], v[144:147]
 ds_read_b128 a[56:59], v24 offset:14336
 v_mfma_f32_16x16x32_bf16 v[176:179], a[96:99], a[0:3], v[176:179]
 v_mfma_f32_16x16x32_bf16 v[176:179], a[100:103], a[4:7], v[176:179]
 v_mfma_f32_16x16x32_bf16 v[180:183], a[100:103], a[12:15], v[180:183]
 ds_read_b128 a[60:63], v25 offset:14336
 v_mfma_f32_16x16x32_bf16 v[180:183], a[96:99], a[8:11], v[180:183]
 v_mfma_f32_16x16x32_bf16 v[184:187], a[96:99], a[16:19], v[184:187]
 v_mfma_f32_16x16x32_bf16 v[184:187], a[100:103], a[20:23], v[184:187]
 v_mfma_f32_16x16x32_bf16 v[188:191], a[100:103], a[28:31], v[188:191]
 v_mfma_f32_16x16x32_bf16 v[188:191], a[96:99], a[24:27], v[188:191]
 v_mfma_f32_16x16x32_bf16 v[220:223], a[104:107], a[24:27], v[220:223]
 v_mfma_f32_16x16x32_bf16 v[220:223], a[108:111], a[28:31], v[220:223]
 v_mfma_f32_16x16x32_bf16 v[216:219], a[108:111], a[20:23], v[216:219]
 v_mfma_f32_16x16x32_bf16 v[216:219], a[104:107], a[16:19], v[216:219]
 v_mfma_f32_16x16x32_bf16 v[212:215], a[104:107], a[8:11], v[212:215]
 v_mfma_f32_16x16x32_bf16 v[212:215], a[108:111], a[12:15], v[212:215]
 v_mfma_f32_16x16x32_bf16 v[208:211], a[108:111], a[4:7], v[208:211]
 v_mfma_f32_16x16x32_bf16 v[208:211], a[104:107], a[0:3], v[208:211]
 v_mfma_f32_16x16x32_bf16 v[240:243], a[0:3], a[112:115], v[240:243]
 v_mfma_f32_16x16x32_bf16 v[240:243], a[4:7], a[116:119], v[240:243]
 v_mfma_f32_16x16x32_bf16 v[244:247], a[12:15], a[116:119], v[244:247]
 v_mfma_f32_16x16x32_bf16 v[244:247], a[8:11], a[112:115], v[244:247]
 v_mfma_f32_16x16x32_bf16 v[248:251], a[16:19], a[112:115], v[248:251]
 v_mfma_f32_16x16x32_bf16 v[248:251], a[20:23], a[116:119], v[248:251]
 v_mfma_f32_16x16x32_bf16 v[252:255], a[28:31], a[116:119], v[252:255]
 v_mfma_f32_16x16x32_bf16 v[252:255], a[24:27], a[112:115], v[252:255]
 v_mfma_f32_16x16x32_bf16 a[172:175], a[24:27], a[120:123], a[172:175]
 v_mfma_f32_16x16x32_bf16 a[172:175], a[28:31], a[124:127], a[172:175]
 v_mfma_f32_16x16x32_bf16 a[168:171], a[20:23], a[124:127], a[168:171]
 v_mfma_f32_16x16x32_bf16 a[168:171], a[16:19], a[120:123], a[168:171]
 v_mfma_f32_16x16x32_bf16 a[164:167], a[8:11], a[120:123], a[164:167]
 v_mfma_f32_16x16x32_bf16 a[164:167], a[12:15], a[124:127], a[164:167]
 v_mfma_f32_16x16x32_bf16 a[160:163], a[4:7], a[124:127], a[160:163]
 v_mfma_f32_16x16x32_bf16 a[160:163], a[0:3], a[120:123], a[160:163]
 s_waitcnt lgkmcnt(0)
 v_mfma_f32_16x16x32_bf16 a[192:195], a[0:3], a[128:131], a[192:195]
 s_add_u32 s23, s23, 1
 s_and_b32 s23, s23, 15
 s_mul_i32 s22, s23, 458752
 v_mfma_f32_16x16x32_bf16 a[192:195], a[4:7], a[132:135], a[192:195]
 s_mul_i32 s21, s23, 393216
 s_lshl_b32 s20, s23, 7
 v_mfma_f32_16x16x32_bf16 a[196:199], a[12:15], a[132:135], a[196:199]
 v_mfma_f32_16x16x32_bf16 a[196:199], a[8:11], a[128:131], a[196:199]
 v_mfma_f32_16x16x32_bf16 a[200:203], a[16:19], a[128:131], a[200:203]
 v_mfma_f32_16x16x32_bf16 a[200:203], a[20:23], a[132:135], a[200:203]
 v_mfma_f32_16x16x32_bf16 a[204:207], a[28:31], a[132:135], a[204:207]
 v_mfma_f32_16x16x32_bf16 a[204:207], a[24:27], a[128:131], a[204:207]
 v_mfma_f32_16x16x32_bf16 a[236:239], a[24:27], a[136:139], a[236:239]
 v_mfma_f32_16x16x32_bf16 a[236:239], a[28:31], a[140:143], a[236:239]
 v_mfma_f32_16x16x32_bf16 a[232:235], a[20:23], a[140:143], a[232:235]
 v_mfma_f32_16x16x32_bf16 a[232:235], a[16:19], a[136:139], a[232:235]
 v_mfma_f32_16x16x32_bf16 a[228:231], a[8:11], a[136:139], a[228:231]
 v_mfma_f32_16x16x32_bf16 a[228:231], a[12:15], a[140:143], a[228:231]
 v_mfma_f32_16x16x32_bf16 a[224:227], a[4:7], a[140:143], a[224:227]
 v_mfma_f32_16x16x32_bf16 a[224:227], a[0:3], a[136:139], a[224:227]
 v_mfma_f32_16x16x32_bf16 v[64:67], a[64:67], a[32:35], v[64:67]
 s_waitcnt vmcnt(1)
 s_barrier
 v_mfma_f32_16x16x32_bf16 v[64:67], a[68:71], a[36:39], v[64:67]
 s_cmp_eq_u32 s57, s71
 v_mfma_f32_16x16x32_bf16 v[68:71], a[68:71], a[44:47], v[68:71]
 s_cbranch_scc1 L_at01
L_at01_d:
 v_mfma_f32_16x16x32_bf16 v[68:71], a[64:67], a[40:43], v[68:71]
 s_add_u32 m0, s54, 73728
 v_mfma_f32_16x16x32_bf16 v[72:75], a[64:67], a[48:51], v[72:75]
 buffer_load_dwordx4 v8, s[8:11], s20 offen lds
 v_mfma_f32_16x16x32_bf16 v[72:75], a[68:71], a[52:55], v[72:75]
 ds_read_b128 a[0:3], v22 offset:0
 v_mfma_f32_16x16x32_bf16 v[76:79], a[68:71], a[60:63], v[76:79]
 ds_read_b128 a[4:7], v23 offset:0
 v_mfma_f32_16x16x32_bf16 v[76:79], a[64:67], a[56:59], v[76:79]
 v_mfma_f32_16x16x32_bf16 v[108:111], a[72:75], a[56:59], v[108:111]
 s_add_u32 m0, s54, 74752
 v_mfma_f32_16x16x32_bf16 v[108:111], a[76:79], a[60:63], v[108:111]
 buffer_load_dwordx4 v9, s[8:11], s20 offen lds
 v_mfma_f32_16x16x32_bf16 v[104:107], a[76:79], a[52:55], v[104:107]
 ds_read_b64_tr_b16 a[64:65], v26 offset:0
 v_mfma_f32_16x16x32_bf16 v[104:107], a[72:75], a[48:51], v[104:107]
 ds_read_b64_tr_b16 a[66:67], v26 offset:2048
 v_mfma_f32_16x16x32_bf16 v[100:103], a[72:75], a[40:43], v[100:103]
 v_mfma_f32_16x16x32_bf16 v[100:103], a[76:79], a[44:47], v[100:103]
 s_add_u32 m0, s54, 75776
 ds_read_b64_tr_b16 a[68:69], v26 offset:4096
 v_mfma_f32_16x16x32_bf16 v[96:99], a[76:79], a[36:39], v[96:99]
 buffer_load_dwordx4 v10, s[8:11], s20 offen lds
 v_mfma_f32_16x16x32_bf16 v[96:99], a[72:75], a[32:35], v[96:99]
 ds_read_b64_tr_b16 a[70:71], v26 offset:6144
 v_mfma_f32_16x16x32_bf16 v[128:131], a[80:83], a[32:35], v[128:131]
 ds_read_b128 a[8:11], v22 offset:2048
 v_mfma_f32_16x16x32_bf16 v[128:131], a[84:87], a[36:39], v[128:131]
 ds_read_b64_tr_b16 a[72:73], v26 offset:8192
 v_mfma_f32_16x16x32_bf16 v[132:135], a[84:87], a[44:47], v[132:135]
 s_add_u32 m0, s54, 76800
 v_mfma_f32_16x16x32_bf16 v[132:135], a[80:83], a[40:43], v[132:135]
 buffer_load_dwordx4 v11, s[8:11], s20 offen lds
 v_mfma_f32_16x16x32_bf16 v[136:139], a[80:83], a[48:51], v[136:139]
 ds_read_b64_tr_b16 a[74:75], v26 offset:10240
 v_mfma_f32_16x16x32_bf16 v[136:139], a[84:87], a[52:55], v[136:139]
 ds_read_b64_tr_b16 a[76:77], v26 offset:12288
 v_mfma_f32_16x16x32_bf16 v[140:143], a[84:87], a[60:63], v[140:143]
 ds_read_b128 a[12:15], v23 offset:2048
 v_mfma_f32_16x16x32_bf16 v[140:143], a[80:83], a[56:59], v[140:143]
 s_add_u32 m0, s54, 77824
 ds_read_b64_tr_b16 a[78:79], v26 offset:14336
 v_mfma_f32_16x16x32_bf16 v[172:175], a[88:91], a[56:59], v[172:175]
 buffer_load_dwordx4 v12, s[8:11], s20 offen lds
 v_mfma_f32_16x16x32_bf16 v[172:175], a[92:95], a[60:63], v[172:175]
 ds_read_b64_tr_b16 a[80:81], v28 offset:0
 v_mfma_f32_16x16x32_bf16 v[168:171], a[92:95], a[52:55], v[168:171]
 v_mfma_f32_16x16x32_bf16 v[168:171], a[88:91], a[48:51], v[168:171]
 ds_read_b64_tr_b16 a[82:83], v28 offset:2048
 v_mfma_f32_16x16x32_bf16 v[164:167], a[88:91], a[40:43], v[164:167]
 s_add_u32 m0, s54, 78848
 v_mfma_f32_16x16x32_bf16 v[164:167], a[92:95], a[44:47], v[164:167]
 buffer_load_dwordx4 v13, s[8:11], s20 offen lds
 v_mfma_f32_16x16x32_bf16 v[160:163], a[92:95], a[36:39], v[160:163]
 ds_read_b64_tr_b16 a[84:85], v28 offset:4096
 v_mfma_f32_16x16x32_bf16 v[160:163], a[88:91], a[32:35], v[160:163]
 ds_read_b64_tr_b16 a[86:87], v28 offset:6144
 v_mfma_f32_16x16x32_bf16 v[192:195], a[96:99], a[32:35], v[192:195]
 ds_read_b128 a[16:19], v22 offset:4096
 v_mfma_f32_16x16x32_bf16 v[192:195], a[100:103], a[36:39], v[192:195]
 s_add_u32 m0, s54, 79872
 ds_read_b64_tr_b16 a[88:89], v28 offset:8192
 v_mfma_f32_16x16x32_bf16 v[196:199], a[100:103], a[44:47], v[196:199]
 buffer_load_dwordx4 v14, s[8:11], s20 offen lds
 v_mfma_f32_16x16x32_bf16 v[196:199], a[96:99], a[40:43], v[196:199]
 ds_read_b64_tr_b16 a[90:91], v28 offset:10240
 v_mfma_f32_16x16x32_bf16 v[200:203], a[96:99], a[48:51], v[200:203]
 v_mfma_f32_16x16x32_bf16 v[200:203], a[100:103], a[52:55], v[200:203]
 ds_read_b64_tr_b16 a[92:93], v28 offset:12288
 v_mfma_f32_16x16x32_bf16 v[204:207], a[100:103], a[60:63], v[204:207]
 s_add_u32 m0, s54, 80896
 ds_read_b128 a[20:23], v23 offset:4096
 v_mfma_f32_16x16x32_bf16 v[204:207], a[96:99], a[56:59], v[204:207]
 buffer_load_dwordx4 v15, s[8:11], s20 offen lds
 v_mfma_f32_16x16x32_bf16 v[236:239], a[104:107], a[56:59], v[236:239]
 ds_read_b64_tr_b16 a[94:95], v28 offset:14336
 v_mfma_f32_16x16x32_bf16 v[236:239], a[108:111], a[60:63], v[236:239]
 ds_read_b64_tr_b16 a[96:97], v26 offset:16384
 v_mfma_f32_16x16x32_bf16 v[232:235], a[108:111], a[52:55], v[232:235]
 v_mfma_f32_16x16x32_bf16 v[232:235], a[104:107], a[48:51], v[232:235]
 s_add_u32 m0, s55, 73728
 ds_read_b64_tr_b16 a[98:99], v26 offset:18432
 v_mfma_f32_16x16x32_bf16 v[228:231], a[104:107], a[40:43], v[228:231]
 buffer_load_dwordx4 v16, s[16:19], s22 offen lds
 v_mfma_f32_16x16x32_bf16 v[228:231], a[108:111], a[44:47], v[228:231]
 ds_read_b64_tr_b16 a[100:101], v26 offset:20480
 v_mfma_f32_16x16x32_bf16 v[224:227], a[108:111], a[36:39], v[224:227]
 ds_read_b128 a[24:27], v22 offset:6144
 v_mfma_f32_16x16x32_bf16 v[224:227], a[104:107], a[32:35], v[224:227]
 ds_read_b64_tr_b16 a[102:103], v26 offset:22528
 v_mfma_f32_16x16x32_bf16 a[144:147], a[32:35], a[112:115], a[144:147]
 s_add_u32 m0, s55, 74752
 v_mfma_f32_16x16x32_bf16 a[144:147], a[36:39], a[116:119], a[144:147]
 buffer_load_dwordx4 v17, s[16:19], s22 offen lds
 v_mfma_f32_16x16x32_bf16 a[148:151], a[44:47], a[116:119], a[148:151]
 ds_read_b64_tr_b16 a[104:105], v28 offset:16384
 v_mfma_f32_16x16x32_bf16 a[148:151], a[40:43], a[112:115], a[148:151]
 ds_read_b64_tr_b16 a[106:107], v28 offset:18432
 v_mfma_f32_16x16x32_bf16 a[152:155], a[48:51], a[112:115], a[152:155]
 v_mfma_f32_16x16x32_bf16 a[152:155], a[52:55], a[116:119], a[152:155]
 s_add_u32 m0, s55, 81920
 ds_read_b64_tr_b16 a[108:109], v28 offset:20480
 v_mfma_f32_16x16x32_bf16 a[156:159], a[60:63], a[116:119], a[156:159]
 buffer_load_dwordx4 v16, s[64:67], s22 offen lds
 v_mfma_f32_16x16x32_bf16 a[156:159], a[56:59], a[112:115], a[156:159]
 ds_read_b64_tr_b16 a[110:111], v28 offset:22528
 v_mfma_f32_16x16x32_bf16 a[188:191], a[56:59], a[120:123], a[188:191]
 ds_read_b128 a[28:31], v23 offset:6144
 v_mfma_f32_16x16x32_bf16 a[188:191], a[60:63], a[124:127], a[188:191]
 ds_read_b64_tr_b16 a[112:113], v26 offset:24576
 v_mfma_f32_16x16x32_bf16 a[184:187], a[52:55], a[124:127], a[184:187]
 s_add_u32 m0, s55, 82944
 v_mfma_f32_16x16x32_bf16 a[184:187], a[48:51], a[120:123], a[184:187]
 buffer_load_dwordx4 v17, s[64:67], s22 offen lds
 v_mfma_f32_16x16x32_bf16 a[180:183], a[40:43], a[120:123], a[180:183]
 ds_read_b64_tr_b16 a[114:115], v26 offset:26624
 v_mfma_f32_16x16x32_bf16 a[180:183], a[44:47], a[124:127], a[180:183]
 ds_read_b64_tr_b16 a[116:117], v26 offset:28672
 v_mfma_f32_16x16x32_bf16 a[176:179], a[36:39], a[124:127], a[176:179]
 v_mfma_f32_16x16x32_bf16 a[176:179], a[32:35], a[120:123], a[176:179]
 s_add_u32 m0, s55, 90112
 ds_read_b64_tr_b16 a[118:119], v26 offset:30720
 v_mfma_f32_16x16x32_bf16 a[208:211], a[32:35], a[128:131], a[208:211]
 buffer_load_dwordx4 v18, s[12:15], s21 offen lds
 v_mfma_f32_16x16x32_bf16 a[208:211], a[36:39], a[132:135], a[208:211]
 ds_read_b64_tr_b16 a[120:121], v28 offset:24576
 v_mfma_f32_16x16x32_bf16 a[212:215], a[44:47], a[132:135], a[212:215]
 v_mfma_f32_16x16x32_bf16 a[212:215], a[40:43], a[128:131], a[212:215]
 ds_read_b64_tr_b16 a[122:123], v28 offset:26624
 v_mfma_f32_16x16x32_bf16 a[216:219], a[48:51], a[128:131], a[216:219]
 s_add_u32 m0, s55, 91136
 v_mfma_f32_16x16x32_bf16 a[216:219], a[52:55], a[132:135], a[216:219]
 buffer_load_dwordx4 v19, s[12:15], s21 offen lds
 v_mfma_f32_16x16x32_bf16 a[220:223], a[60:63], a[132:135], a[220:223]
 ds_read_b64_tr_b16 a[124:125], v28 offset:28672
 v_mfma_f32_16x16x32_bf16 a[220:223], a[56:59], a[128:131], a[220:223]
 ds_read_b64_tr_b16 a[126:127], v28 offset:30720
 v_mfma_f32_16x16x32_bf16 a[252:255], a[56:59], a[136:139], a[252:255]
 v_mfma_f32_16x16x32_bf16 a[252:255], a[60:63], a[140:143], a[252:255]
 s_add_u32 m0, s55, 96256
 ds_read_b64_tr_b16 a[128:129], v26 offset:32768
 v_mfma_f32_16x16x32_bf16 a[248:251], a[52:55], a[140:143], a[248:251]
 buffer_load_dwordx4 v18, s[12:15], s21 offen offset:2048 lds
 v_mfma_f32_16x16x32_bf16 a[248:251], a[48:51], a[136:139], a[248:251]
 ds_read_b64_tr_b16 a[130:131], v26 offset:34816
 v_mfma_f32_16x16x32_bf16 a[244:247], a[40:43], a[136:139], a[244:247]
 s_add_u32 s57, s57, 1
 v_mfma_f32_16x16x32_bf16 a[244:247], a[44:47], a[140:143], a[244:247]
 s_add_u32 m0, s55, 97280
 ds_read_b64_tr_b16 a[132:133], v26 offset:36864
 v_mfma_f32_16x16x32_bf16 a[240:243], a[36:39], a[140:143], a[240:243]
 s_cmp_lt_u32 s57, 7
 buffer_load_dwordx4 v19, s[12:15], s21 offen offset:2048 lds
 v_mfma_f32_16x16x32_bf16 a[240:243], a[32:35], a[136:139], a[240:243]
 ds_read_b64_tr_b16 a[134:135], v26 offset:38912
 s_cbranch_scc1 L_lb0
 s_waitcnt lgkmcnt(4)
 v_mfma_f32_16x16x32_bf16 v[48:51], a[64:67], a[0:3], v[48:51]
 v_and_b32 v35, 1, v2
 v_lshlrev_b32 v35, 7, v35
 v_mfma_f32_16x16x32_bf16 v[48:51], a[68:71], a[4:7], v[48:51]
 ds_read_b64_tr_b16 a[136:137], v28 offset:32768
 v_mfma_f32_16x16x32_bf16 v[52:55], a[68:71], a[12:15], v[52:55]
 global_load_dword v3, v35, s[62:63] sc1
 v_mfma_f32_16x16x32_bf16 v[52:55], a[64:67], a[8:11], v[52:55]
 s_add_u32 m0, s55, 106496
 v_mfma_f32_16x16x32_bf16 v[56:59], a[64:67], a[16:19], v[56:59]
 buffer_load_dwordx4 v20, s[12:15], s21 offen lds
 v_mfma_f32_16x16x32_bf16 v[56:59], a[68:71], a[20:23], v[56:59]
 ds_read_b64_tr_b16 a[138:139], v28 offset:34816
 v_mfma_f32_16x16x32_bf16 v[60:63], a[68:71], a[28:31], v[60:63]
 v_mfma_f32_16x16x32_bf16 v[60:63], a[64:67], a[24:27], v[60:63]
 ds_read_b64_tr_b16 a[140:141], v28 offset:36864
 v_mfma_f32_16x16x32_bf16 v[92:95], a[72:75], a[24:27], v[92:95]
 s_add_u32 m0, s55, 107520
 v_mfma_f32_16x16x32_bf16 v[92:95], a[76:79], a[28:31], v[92:95]
 buffer_load_dwordx4 v21, s[12:15], s21 offen lds
 v_mfma_f32_16x16x32_bf16 v[88:91], a[76:79], a[20:23], v[88:91]
 s_mul_i32 s6, s4, 10240
 ds_read_b64_tr_b16 a[142:143], v28 offset:38912
 v_mfma_f32_16x16x32_bf16 v[88:91], a[72:75], a[16:19], v[88:91]
 s_add_u32 s6, s6, 29360128
 s_mul_i32 s7, s5, 6144
 s_add_u32 s7, s7, 29874176
 v_mfma_f32_16x16x32_bf16 v[84:87], a[72:75], a[8:11], v[84:87]
 s_lshl_b32 s18, s3, 12
 s_add_u32 s6, s6, s18
 s_add_u32 s7, s7, s18
 v_mfma_f32_16x16x32_bf16 v[84:87], a[76:79], a[12:15], v[84:87]
 ds_read_b128 a[32:35], v22 offset:8192
 v_mfma_f32_16x16x32_bf16 v[80:83], a[76:79], a[4:7], v[80:83]
 s_cmp_lt_u32 s3, 3
 s_cselect_b32 s58, s6, s7
 v_mfma_f32_16x16x32_bf16 v[80:83], a[72:75], a[0:3], v[80:83]
 s_cmp_lt_u32 s3, 2
 s_cselect_b32 s59, s6, s7
 s_mov_b32 s50, 8192
 v_mfma_f32_16x16x32_bf16 v[112:115], a[80:83], a[0:3], v[112:115]
 s_movk_i32 s61, 4096
 ds_read_b128 a[36:39], v23 offset:8192
 v_mfma_f32_16x16x32_bf16 v[112:115], a[84:87], a[4:7], v[112:115]
 v_mfma_f32_16x16x32_bf16 v[116:119], a[84:87], a[12:15], v[116:119]
 v_mfma_f32_16x16x32_bf16 v[116:119], a[80:83], a[8:11], v[116:119]
 ds_read_b128 a[40:43], v22 offset:10240
 v_mfma_f32_16x16x32_bf16 v[120:123], a[80:83], a[16:19], v[120:123]
 v_mfma_f32_16x16x32_bf16 v[120:123], a[84:87], a[20:23], v[120:123]
 v_mfma_f32_16x16x32_bf16 v[124:127], a[84:87], a[28:31], v[124:127]
 ds_read_b128 a[44:47], v23 offset:10240
 v_mfma_f32_16x16x32_bf16 v[124:127], a[80:83], a[24:27], v[124:127]
 v_mfma_f32_16x16x32_bf16 v[156:159], a[88:91], a[24:27], v[156:159]
 v_mfma_f32_16x16x32_bf16 v[156:159], a[92:95], a[28:31], v[156:159]
 ds_read_b128 a[48:51], v22 offset:12288
 v_mfma_f32_16x16x32_bf16 v[152:155], a[92:95], a[20:23], v[152:155]
 v_mfma_f32_16x16x32_bf16 v[152:155], a[88:91], a[16:19], v[152:155]
 v_mfma_f32_16x16x32_bf16 v[148:151], a[88:91], a[8:11], v[148:151]
 ds_read_b128 a[52:55], v23 offset:12288
 v_mfma_f32_16x16x32_bf16 v[148:151], a[92:95], a[12:15], v[148:151]
 v_mfma_f32_16x16x32_bf16 v[144:147], a[92:95], a[4:7], v[144:147]
 v_mfma_f32_16x16x32_bf16 v[144:147], a[88:91], a[0:3], v[144:147]
 ds_read_b128 a[56:59], v22 offset:14336
 v_mfma_f32_16x16x32_bf16 v[176:179], a[96:99], a[0:3], v[176:179]
 v_mfma_f32_16x16x32_bf16 v[176:179], a[100:103], a[4:7], v[176:179]
 v_mfma_f32_16x16x32_bf16 v[180:183], a[100:103], a[12:15], v[180:183]
 ds_read_b128 a[60:63], v23 offset:14336
 v_mfma_f32_16x16x32_bf16 v[180:183], a[96:99], a[8:11], v[180:183]
 v_mfma_f32_16x16x32_bf16 v[184:187], a[96:99], a[16:19], v[184:187]
 v_mfma_f32_16x16x32_bf16 v[184:187], a[100:103], a[20:23], v[184:187]
 v_mfma_f32_16x16x32_bf16 v[188:191], a[100:103], a[28:31], v[188:191]
 v_mfma_f32_16x16x32_bf16 v[188:191], a[96:99], a[24:27], v[188:191]
 v_mfma_f32_16x16x32_bf16 v[220:223], a[104:107], a[24:27], v[220:223]
 v_mfma_f32_16x16x32_bf16 v[220:223], a[108:111], a[28:31], v[220:223]
 s_waitcnt vmcnt(2)
 v_mfma_f32_16x16x32_bf16 v[216:219], a[108:111], a[20:23], v[216:219]
 v_cmp_gt_u32 vcc, 0x80, v3
 v_mfma_f32_16x16x32_bf16 v[216:219], a[104:107], a[16:19], v[216:219]
 v_mfma_f32_16x16x32_bf16 v[212:215], a[104:107], a[8:11], v[212:215]
 s_cbranch_vccnz L_ini0_s
L_ini0_d:
 v_mfma_f32_16x16x32_bf16 v[212:215], a[108:111], a[12:15], v[212:215]
 s_add_u32 m0, s18, 147456
 v_mfma_f32_16x16x32_bf16 v[208:211], a[108:111], a[4:7], v[208:211]
 buffer_load_dwordx4 v1, s[24:27], s58 offen sc1 lds
 v_mfma_f32_16x16x32_bf16 v[208:211], a[104:107], a[0:3], v[208:211]
 s_bfe_u32 s20, s2, 0x10002
 s_and_b32 s6, s2, 1
 s_bfe_u32 s7, s2, 0x10001
 v_mfma_f32_16x16x32_bf16 v[240:243], a[0:3], a[112:115], v[240:243]
 s_lshl1_add_u32 s6, s6, s7
 s_lshr_b32 s7, s2, 6
 s_lshl2_add_u32 s21, s6, s7
 v_mfma_f32_16x16x32_bf16 v[240:243], a[4:7], a[116:119], v[240:243]
 s_bfe_u32 s22, s2, 0x20003
 buffer_load_dwordx4 v1, s[24:27], s58 offen offset:1024 sc1 lds
 v_mfma_f32_16x16x32_bf16 v[244:247], a[12:15], a[116:119], v[244:247]
 s_getpc_b64 s[72:73]
L_pd0:
 s_sub_u32 s72, s72, L_pd0-L_pc
 s_subb_u32 s73, s73, 0
 v_mfma_f32_16x16x32_bf16 v[244:247], a[8:11], a[112:115], v[244:247]
 s_lshr_b32 s0, s2, 3
 s_lshl2_add_u32 s0, s0, s3
 s_lshl_b32 s0, s0, 3
 v_mfma_f32_16x16x32_bf16 v[248:251], a[16:19], a[112:115], v[248:251]
 s_bfe_u32 s7, s2, 0x10005
 buffer_load_dwordx4 v1, s[24:27], s59 offen offset:2048 sc1 lds
 v_min_u32 v36, 7, v2
 v_add_lshl_u32 v36, v36, s0, 7
 v_mfma_f32_16x16x32_bf16 v[248:251], a[20:23], a[116:119], v[248:251]
 s_lshl1_add_u32 s22, s22, s7
 v_min_u32 v36, L_cend-L_pc-4, v36
 v_mfma_f32_16x16x32_bf16 v[252:255], a[28:31], a[116:119], v[252:255]
 s_lshl_b32 s22, s22, 8
 s_mul_i32 s14, s20, 3670016
 s_add_u32 s14, s14, s22
 v_mfma_f32_16x16x32_bf16 v[252:255], a[24:27], a[112:115], v[252:255]
 s_xor_b32 s6, s53, s20
 buffer_load_dwordx4 v1, s[24:27], s59 offen offset:3072 sc1 lds
 v_mfma_f32_16x16x32_bf16 a[172:175], a[24:27], a[120:123], a[172:175]
 s_xor_b32 s6, s6, 0
 s_lshl_b32 s6, s6, 7
 s_add_u32 s14, s14, s6
 v_mfma_f32_16x16x32_bf16 a[172:175], a[28:31], a[124:127], a[172:175]
 s_lshl_b32 s15, s52, 16
 global_load_dword v0, v36, s[72:73]
 v_mfma_f32_16x16x32_bf16 a[168:171], a[20:23], a[124:127], a[168:171]
 s_add_u32 s14, s15, s14
 s_mov_b32 s15, s14
 v_mfma_f32_16x16x32_bf16 a[168:171], a[16:19], a[120:123], a[168:171]
 buffer_store_dwordx4 v[4:7], v1, s[48:51], s61 offen sc1
 v_mfma_f32_16x16x32_bf16 a[164:167], a[8:11], a[120:123], a[164:167]
 v_mfma_f32_16x16x32_bf16 a[164:167], a[12:15], a[124:127], a[164:167]
 v_mfma_f32_16x16x32_bf16 a[160:163], a[4:7], a[124:127], a[160:163]
 v_mfma_f32_16x16x32_bf16 a[160:163], a[0:3], a[120:123], a[160:163]
 s_waitcnt lgkmcnt(0)
 v_mfma_f32_16x16x32_bf16 a[192:195], a[0:3], a[128:131], a[192:195]
 buffer_store_dwordx4 v[4:7], v1, s[48:51], s61 offen offset:1024 sc1
 v_mfma_f32_16x16x32_bf16 a[192:195], a[4:7], a[132:135], a[192:195]
 v_mfma_f32_16x16x32_bf16 a[196:199], a[12:15], a[132:135], a[196:199]
 v_lshrrev_b32 v12, 3, v2
 v_mfma_f32_16x16x32_bf16 a[196:199], a[8:11], a[128:131], a[196:199]
 v_bfe_u32 v13, v2, 4, 2
 v_mfma_f32_16x16x32_bf16 a[200:203], a[16:19], a[128:131], a[200:203]
 v_lshlrev_b32 v13, 1, v13
 v_mfma_f32_16x16x32_bf16 a[200:203], a[20:23], a[132:135], a[200:203]
 buffer_store_dwordx4 v[4:7], v1, s[48:51], s61 offen offset:2048 sc1
 v_and_b32 v14, 7, v2
 v_mfma_f32_16x16x32_bf16 a[204:207], a[28:31], a[132:135], a[204:207]
 v_xor_b32 v14, v14, v13
 v_mfma_f32_16x16x32_bf16 a[204:207], a[24:27], a[128:131], a[204:207]
 v_lshlrev_b32 v14, 4, v14
 v_mfma_f32_16x16x32_bf16 a[236:239], a[24:27], a[136:139], a[236:239]
 v_lshl_add_u32 v8, v12, 11, v14
 v_mfma_f32_16x16x32_bf16 a[236:239], a[28:31], a[140:143], a[236:239]
 v_add_u32 v9, 16384, v8
 v_mfma_f32_16x16x32_bf16 a[232:235], a[20:23], a[140:143], a[232:235]
 buffer_store_dwordx4 v[4:7], v1, s[48:51], s61 offen offset:3072 sc1
 v_add_u32 v10, 32768, v8
 v_mfma_f32_16x16x32_bf16 a[232:235], a[16:19], a[136:139], a[232:235]
 v_add_u32 v11, 49152, v8
 v_mfma_f32_16x16x32_bf16 a[228:231], a[8:11], a[136:139], a[228:231]
 v_mfma_f32_16x16x32_bf16 a[228:231], a[12:15], a[140:143], a[228:231]
 v_mfma_f32_16x16x32_bf16 a[224:227], a[4:7], a[140:143], a[224:227]
 v_mfma_f32_16x16x32_bf16 a[224:227], a[0:3], a[136:139], a[224:227]
 v_mfma_f32_16x16x32_bf16 v[64:67], a[64:67], a[32:35], v[64:67]
 s_waitcnt vmcnt(9)
 s_barrier
 v_mfma_f32_16x16x32_bf16 v[64:67], a[68:71], a[36:39], v[64:67]
 v_mfma_f32_16x16x32_bf16 v[68:71], a[68:71], a[44:47], v[68:71]
 v_mfma_f32_16x16x32_bf16 v[68:71], a[64:67], a[40:43], v[68:71]
 v_mfma_f32_16x16x32_bf16 v[72:75], a[64:67], a[48:51], v[72:75]
 ds_read_b128 a[0:3], v24 offset:0
 v_mfma_f32_16x16x32_bf16 v[72:75], a[68:71], a[52:55], v[72:75]
 v_mfma_f32_16x16x32_bf16 v[76:79], a[68:71], a[60:63], v[76:79]
 ds_read_b128 a[4:7], v25 offset:0
 v_mfma_f32_16x16x32_bf16 v[76:79], a[64:67], a[56:59], v[76:79]
 v_mfma_f32_16x16x32_bf16 v[108:111], a[72:75], a[56:59], v[108:111]
 v_mfma_f32_16x16x32_bf16 v[108:111], a[76:79], a[60:63], v[108:111]
 s_add_u32 m0, s18, 0
 ds_read_b64_tr_b16 a[64:65], v27 offset:0
 v_mfma_f32_16x16x32_bf16 v[104:107], a[76:79], a[52:55], v[104:107]
 buffer_load_dwordx4 v8, s[28:31], s15 offen lds
 v_mfma_f32_16x16x32_bf16 v[104:107], a[72:75], a[48:51], v[104:107]
 ds_read_b64_tr_b16 a[66:67], v27 offset:2048
 v_mfma_f32_16x16x32_bf16 v[100:103], a[72:75], a[40:43], v[100:103]
 v_mfma_f32_16x16x32_bf16 v[100:103], a[76:79], a[44:47], v[100:103]
 ds_read_b64_tr_b16 a[68:69], v27 offset:4096
 v_mfma_f32_16x16x32_bf16 v[96:99], a[76:79], a[36:39], v[96:99]
 ds_read_b128 a[8:11], v24 offset:2048
 v_mfma_f32_16x16x32_bf16 v[96:99], a[72:75], a[32:35], v[96:99]
 ds_read_b64_tr_b16 a[70:71], v27 offset:6144
 v_mfma_f32_16x16x32_bf16 v[128:131], a[80:83], a[32:35], v[128:131]
 v_mfma_f32_16x16x32_bf16 v[128:131], a[84:87], a[36:39], v[128:131]
 ds_read_b64_tr_b16 a[72:73], v27 offset:8192
 v_mfma_f32_16x16x32_bf16 v[132:135], a[84:87], a[44:47], v[132:135]
 v_mfma_f32_16x16x32_bf16 v[132:135], a[80:83], a[40:43], v[132:135]
 s_add_u32 m0, s18, 1024
 ds_read_b64_tr_b16 a[74:75], v27 offset:10240
 v_mfma_f32_16x16x32_bf16 v[136:139], a[80:83], a[48:51], v[136:139]
 buffer_load_dwordx4 v9, s[28:31], s15 offen lds
 v_mfma_f32_16x16x32_bf16 v[136:139], a[84:87], a[52:55], v[136:139]
 ds_read_b64_tr_b16 a[76:77], v27 offset:12288
 v_mfma_f32_16x16x32_bf16 v[140:143], a[84:87], a[60:63], v[140:143]
 ds_read_b128 a[12:15], v25 offset:2048
 v_mfma_f32_16x16x32_bf16 v[140:143], a[80:83], a[56:59], v[140:143]
 ds_read_b64_tr_b16 a[78:79], v27 offset:14336
 v_mfma_f32_16x16x32_bf16 v[172:175], a[88:91], a[56:59], v[172:175]
 v_mfma_f32_16x16x32_bf16 v[172:175], a[92:95], a[60:63], v[172:175]
 ds_read_b64_tr_b16 a[80:81], v29 offset:0
 v_mfma_f32_16x16x32_bf16 v[168:171], a[92:95], a[52:55], v[168:171]
 v_mfma_f32_16x16x32_bf16 v[168:171], a[88:91], a[48:51], v[168:171]
 ds_read_b64_tr_b16 a[82:83], v29 offset:2048
 v_mfma_f32_16x16x32_bf16 v[164:167], a[88:91], a[40:43], v[164:167]
 v_mfma_f32_16x16x32_bf16 v[164:167], a[92:95], a[44:47], v[164:167]
 s_add_u32 m0, s18, 2048
 ds_read_b64_tr_b16 a[84:85], v29 offset:4096
 v_mfma_f32_16x16x32_bf16 v[160:163], a[92:95], a[36:39], v[160:163]
 buffer_load_dwordx4 v10, s[28:31], s15 offen lds
 v_mfma_f32_16x16x32_bf16 v[160:163], a[88:91], a[32:35], v[160:163]
 ds_read_b64_tr_b16 a[86:87], v29 offset:6144
 v_mfma_f32_16x16x32_bf16 v[192:195], a[96:99], a[32:35], v[192:195]
 ds_read_b128 a[16:19], v24 offset:4096
 v_mfma_f32_16x16x32_bf16 v[192:195], a[100:103], a[36:39], v[192:195]
 ds_read_b64_tr_b16 a[88:89], v29 offset:8192
 v_mfma_f32_16x16x32_bf16 v[196:199], a[100:103], a[44:47], v[196:199]
 v_mfma_f32_16x16x32_bf16 v[196:199], a[96:99], a[40:43], v[196:199]
 ds_read_b64_tr_b16 a[90:91], v29 offset:10240
 v_mfma_f32_16x16x32_bf16 v[200:203], a[96:99], a[48:51], v[200:203]
 v_mfma_f32_16x16x32_bf16 v[200:203], a[100:103], a[52:55], v[200:203]
 ds_read_b64_tr_b16 a[92:93], v29 offset:12288
 v_mfma_f32_16x16x32_bf16 v[204:207], a[100:103], a[60:63], v[204:207]
 ds_read_b128 a[20:23], v25 offset:4096
 v_mfma_f32_16x16x32_bf16 v[204:207], a[96:99], a[56:59], v[204:207]
 s_add_u32 m0, s18, 3072
 ds_read_b64_tr_b16 a[94:95], v29 offset:14336
 v_mfma_f32_16x16x32_bf16 v[236:239], a[104:107], a[56:59], v[236:239]
 buffer_load_dwordx4 v11, s[28:31], s15 offen lds
 v_mfma_f32_16x16x32_bf16 v[236:239], a[108:111], a[60:63], v[236:239]
 ds_read_b64_tr_b16 a[96:97], v27 offset:16384
 v_mfma_f32_16x16x32_bf16 v[232:235], a[108:111], a[52:55], v[232:235]
 v_mfma_f32_16x16x32_bf16 v[232:235], a[104:107], a[48:51], v[232:235]
 ds_read_b64_tr_b16 a[98:99], v27 offset:18432
 v_mfma_f32_16x16x32_bf16 v[228:231], a[104:107], a[40:43], v[228:231]
 v_mfma_f32_16x16x32_bf16 v[228:231], a[108:111], a[44:47], v[228:231]
 ds_read_b64_tr_b16 a[100:101], v27 offset:20480
 v_mfma_f32_16x16x32_bf16 v[224:227], a[108:111], a[36:39], v[224:227]
 ds_read_b128 a[24:27], v24 offset:6144
 v_mfma_f32_16x16x32_bf16 v[224:227], a[104:107], a[32:35], v[224:227]
 ds_read_b64_tr_b16 a[102:103], v27 offset:22528
 v_mfma_f32_16x16x32_bf16 a[144:147], a[32:35], a[112:115], a[144:147]
 s_add_u32 s15, s14, 131072
 v_mfma_f32_16x16x32_bf16 a[144:147], a[36:39], a[116:119], a[144:147]
 s_add_u32 m0, s18, 16384
 ds_read_b64_tr_b16 a[104:105], v29 offset:16384
 v_mfma_f32_16x16x32_bf16 a[148:151], a[44:47], a[116:119], a[148:151]
 buffer_load_dwordx4 v8, s[28:31], s15 offen lds
 v_mfma_f32_16x16x32_bf16 a[148:151], a[40:43], a[112:115], a[148:151]
 ds_read_b64_tr_b16 a[106:107], v29 offset:18432
 v_mfma_f32_16x16x32_bf16 a[152:155], a[48:51], a[112:115], a[152:155]
 v_mfma_f32_16x16x32_bf16 a[152:155], a[52:55], a[116:119], a[152:155]
 ds_read_b64_tr_b16 a[108:109], v29 offset:20480
 s_branch L_tp_L_tA_6_o
L_tp_L_tA_6:
 s_nop 0
 s_nop 0
 s_branch L_tr00
L_tp_L_tA_6_o:
 v_mfma_f32_16x16x32_bf16 a[156:159], a[60:63], a[116:119], a[156:159]
 ds_read_b128 a[28:31], v25 offset:6144
 v_mfma_f32_16x16x32_bf16 a[156:159], a[56:59], a[112:115], a[156:159]
 ds_read_b64_tr_b16 a[110:111], v29 offset:22528
 v_mfma_f32_16x16x32_bf16 a[188:191], a[56:59], a[120:123], a[188:191]
 v_mfma_f32_16x16x32_bf16 a[188:191], a[60:63], a[124:127], a[188:191]
 ds_read_b64_tr_b16 a[112:113], v27 offset:24576
 v_mfma_f32_16x16x32_bf16 a[184:187], a[52:55], a[124:127], a[184:187]
 v_mfma_f32_16x16x32_bf16 a[184:187], a[48:51], a[120:123], a[184:187]
 s_add_u32 m0, s18, 17408
 ds_read_b64_tr_b16 a[114:115], v27 offset:26624
 v_mfma_f32_16x16x32_bf16 a[180:183], a[40:43], a[120:123], a[180:183]
 buffer_load_dwordx4 v9, s[28:31], s15 offen lds
 v_mfma_f32_16x16x32_bf16 a[180:183], a[44:47], a[124:127], a[180:183]
 ds_read_b64_tr_b16 a[116:117], v27 offset:28672
 v_mfma_f32_16x16x32_bf16 a[176:179], a[36:39], a[124:127], a[176:179]
 v_mfma_f32_16x16x32_bf16 a[176:179], a[32:35], a[120:123], a[176:179]
 ds_read_b64_tr_b16 a[118:119], v27 offset:30720
 v_mfma_f32_16x16x32_bf16 a[208:211], a[32:35], a[128:131], a[208:211]
 v_mfma_f32_16x16x32_bf16 a[208:211], a[36:39], a[132:135], a[208:211]
 ds_read_b64_tr_b16 a[120:121], v29 offset:24576
 v_mfma_f32_16x16x32_bf16 a[212:215], a[44:47], a[132:135], a[212:215]
 v_mfma_f32_16x16x32_bf16 a[212:215], a[40:43], a[128:131], a[212:215]
 ds_read_b64_tr_b16 a[122:123], v29 offset:26624
 v_mfma_f32_16x16x32_bf16 a[216:219], a[48:51], a[128:131], a[216:219]
 v_mfma_f32_16x16x32_bf16 a[216:219], a[52:55], a[132:135], a[216:219]
 s_add_u32 m0, s18, 18432
 ds_read_b64_tr_b16 a[124:125], v29 offset:28672
 v_mfma_f32_16x16x32_bf16 a[220:223], a[60:63], a[132:135], a[220:223]
 buffer_load_dwordx4 v10, s[28:31], s15 offen lds
 v_mfma_f32_16x16x32_bf16 a[220:223], a[56:59], a[128:131], a[220:223]
 ds_read_b64_tr_b16 a[126:127], v29 offset:30720
 v_mfma_f32_16x16x32_bf16 a[252:255], a[56:59], a[136:139], a[252:255]
 v_mfma_f32_16x16x32_bf16 a[252:255], a[60:63], a[140:143], a[252:255]
 ds_read_b64_tr_b16 a[128:129], v27 offset:32768
 v_mfma_f32_16x16x32_bf16 a[248:251], a[52:55], a[140:143], a[248:251]
 v_mfma_f32_16x16x32_bf16 a[248:251], a[48:51], a[136:139], a[248:251]
 ds_read_b64_tr_b16 a[130:131], v27 offset:34816
 v_mfma_f32_16x16x32_bf16 a[244:247], a[40:43], a[136:139], a[244:247]
 v_mfma_f32_16x16x32_bf16 a[244:247], a[44:47], a[140:143], a[244:247]
 ds_read_b64_tr_b16 a[132:133], v27 offset:36864
 v_mfma_f32_16x16x32_bf16 a[240:243], a[36:39], a[140:143], a[240:243]
 v_mfma_f32_16x16x32_bf16 a[240:243], a[32:35], a[136:139], a[240:243]
 ds_read_b64_tr_b16 a[134:135], v27 offset:38912
 s_waitcnt lgkmcnt(4)
 v_mfma_f32_16x16x32_bf16 v[48:51], a[64:67], a[0:3], v[48:51]
 s_waitcnt vmcnt(12)
 s_barrier
 v_mfma_f32_16x16x32_bf16 v[48:51], a[68:71], a[4:7], v[48:51]
 ds_read_b64_tr_b16 a[136:137], v29 offset:32768
 v_mfma_f32_16x16x32_bf16 v[52:55], a[68:71], a[12:15], v[52:55]
 s_mul_i32 s6, s3, 320
 v_lshl_add_u32 v12, v2, 3, s6
 v_mfma_f32_16x16x32_bf16 v[52:55], a[64:67], a[8:11], v[52:55]
 s_add_u32 m0, s18, 19456
 v_mfma_f32_16x16x32_bf16 v[56:59], a[64:67], a[16:19], v[56:59]
 s_lshl_b32 s7, s53, 7
 buffer_load_dwordx4 v11, s[28:31], s15 offen lds
 v_mfma_f32_16x16x32_bf16 v[56:59], a[68:71], a[20:23], v[56:59]
 s_mul_i32 s64, s52, 640
 ds_read_b64_tr_b16 a[138:139], v29 offset:34816
 v_add_u32 v13, 147456, v12
 v_mfma_f32_16x16x32_bf16 v[60:63], a[68:71], a[28:31], v[60:63]
 s_add_u32 s64, s64, 65536
 v_add_u32 v12, 65536, v12
 v_mfma_f32_16x16x32_bf16 v[60:63], a[64:67], a[24:27], v[60:63]
 s_lshl1_add_u32 s0, s5, s53
 ds_read_b64_tr_b16 a[140:141], v29 offset:36864
 v_mfma_f32_16x16x32_bf16 v[92:95], a[72:75], a[24:27], v[92:95]
 s_add_u32 s15, s14, 786432
 s_mul_i32 s1, s0, 1179648
 s_lshr_b32 s6, s4, 4
 v_mfma_f32_16x16x32_bf16 v[92:95], a[76:79], a[28:31], v[92:95]
 s_add_u32 m0, s18, 32768
 v_mfma_f32_16x16x32_bf16 v[88:91], a[76:79], a[20:23], v[88:91]
 s_mul_i32 s48, s6, 56
 buffer_load_dwordx4 v8, s[28:31], s15 offen lds
 v_mfma_f32_16x16x32_bf16 v[88:91], a[72:75], a[16:19], v[88:91]
 s_add_u32 s48, s48, 32
 ds_read_b64_tr_b16 a[142:143], v29 offset:38912
 v_mfma_f32_16x16x32_bf16 v[84:87], a[72:75], a[8:11], v[84:87]
 s_and_b32 s56, s4, 15
 s_lshl1_add_u32 s41, s56, s52
 s_add_u32 s40, s41, s48
 v_mfma_f32_16x16x32_bf16 v[84:87], a[76:79], a[12:15], v[84:87]
 s_lshl_b32 s40, s40, 11
 ds_read_b128 a[32:35], v24 offset:8192
 v_mfma_f32_16x16x32_bf16 v[80:83], a[76:79], a[4:7], v[80:83]
 s_add_u32 s40, s40, s1
 s_add_u32 s41, s4, s52
 s_lshl_b32 s44, s41, 11
 v_mfma_f32_16x16x32_bf16 v[80:83], a[72:75], a[0:3], v[80:83]
 s_add_u32 s44, s44, s1
 s_add_u32 s41, s40, 294912
 s_add_u32 s42, s40, 589824
 v_mfma_f32_16x16x32_bf16 v[112:115], a[80:83], a[0:3], v[112:115]
 s_add_u32 s43, s40, 884736
 ds_read_b128 a[36:39], v25 offset:8192
 v_mfma_f32_16x16x32_bf16 v[112:115], a[84:87], a[4:7], v[112:115]
 s_add_u32 s45, s44, 294912
 s_add_u32 s46, s44, 589824
 s_add_u32 s47, s44, 884736
 v_mfma_f32_16x16x32_bf16 v[116:119], a[84:87], a[12:15], v[116:119]
 s_bfe_u32 s58, s21, 0x20001
 s_lshr_b32 s59, s21, 3
 s_lshl3_add_u32 s58, s58, s59
 v_mfma_f32_16x16x32_bf16 v[116:119], a[80:83], a[8:11], v[116:119]
 s_add_u32 m0, s18, 33792
 ds_read_b128 a[40:43], v24 offset:10240
 v_mfma_f32_16x16x32_bf16 v[120:123], a[80:83], a[16:19], v[120:123]
 s_and_b32 s59, s21, 1
 buffer_load_dwordx4 v9, s[28:31], s15 offen lds
 v_mfma_f32_16x16x32_bf16 v[120:123], a[84:87], a[20:23], v[120:123]
 s_lshl2_add_u32 s58, s58, s59
 s_lshl4_add_u32 s59, s20, s58
 s_lshl3_add_u32 s69, s3, s58
 v_mfma_f32_16x16x32_bf16 v[124:127], a[84:87], a[28:31], v[124:127]
 s_lshl_b32 s59, s59, 9
 ds_read_b128 a[44:47], v25 offset:10240
 v_mfma_f32_16x16x32_bf16 v[124:127], a[80:83], a[24:27], v[124:127]
 s_lshl_b32 s69, s69, 9
 s_add_u32 s59, s59, 30408704
 s_add_u32 s69, s69, 30408704
 v_mfma_f32_16x16x32_bf16 v[156:159], a[88:91], a[24:27], v[156:159]
 s_lshl_b32 s60, s53, 18
 s_lshl_b32 s0, s52, 12
 s_add_u32 s60, s60, s0
 v_mfma_f32_16x16x32_bf16 v[156:159], a[92:95], a[28:31], v[156:159]
 s_add_u32 s60, s60, s59
 ds_read_b128 a[48:51], v24 offset:12288
 v_mfma_f32_16x16x32_bf16 v[152:155], a[92:95], a[20:23], v[152:155]
 s_add_u32 s60, s60, 65536
 s_lshl2_add_u32 s19, s21, s3
 s_mul_i32 s13, s19, 294912
 v_mfma_f32_16x16x32_bf16 v[152:155], a[88:91], a[16:19], v[152:155]
 s_mul_i32 s12, s20, 114688
 s_add_u32 s12, s12, s13
 s_add_u32 s12, s12, 65536
 v_mfma_f32_16x16x32_bf16 v[148:151], a[88:91], a[8:11], v[148:151]
 s_xor_b32 s0, s20, 0
 ds_read_b128 a[52:55], v25 offset:12288
 v_mfma_f32_16x16x32_bf16 v[148:151], a[92:95], a[12:15], v[148:151]
 s_add_u32 m0, s18, 34816
 v_mfma_f32_16x16x32_bf16 v[144:147], a[92:95], a[4:7], v[144:147]
 s_lshl_b32 s0, s0, 7
 buffer_load_dwordx4 v10, s[28:31], s15 offen lds
 v_mfma_f32_16x16x32_bf16 v[144:147], a[88:91], a[0:3], v[144:147]
 s_add_u32 s0, s0, s22
 ds_read_b128 a[56:59], v24 offset:14336
 v_mfma_f32_16x16x32_bf16 v[176:179], a[96:99], a[0:3], v[176:179]
 s_lshl_b32 s19, s19, 16
 s_add_u32 s19, s19, s0
 s_lshl_b32 s17, s3, 16
 v_mfma_f32_16x16x32_bf16 v[176:179], a[100:103], a[4:7], v[176:179]
 s_add_u32 s17, s17, s0
 s_lshl2_add_u32 s61, s2, s3
 s_lshl_b32 s61, s61, 13
 v_mfma_f32_16x16x32_bf16 v[180:183], a[100:103], a[12:15], v[180:183]
 s_xor_b32 s65, s61, 131072
 ds_read_b128 a[60:63], v25 offset:14336
 v_mfma_f32_16x16x32_bf16 v[180:183], a[96:99], a[8:11], v[180:183]
 s_add_u32 s54, s61, 20971520
 s_lshr_b32 s55, s65, 4
 s_add_u32 s55, s55, 30408704
 v_mfma_f32_16x16x32_bf16 v[184:187], a[96:99], a[16:19], v[184:187]
 s_lshr_b32 s23, s61, 4
 s_add_u32 s23, s23, 30408704
 s_add_u32 s61, s61, 20975616
 v_mfma_f32_16x16x32_bf16 v[184:187], a[100:103], a[20:23], v[184:187]
 s_add_u32 s65, s65, 20975616
 ds_read_b64 v[32:33], v13 offset:0
 v_mfma_f32_16x16x32_bf16 v[188:191], a[100:103], a[28:31], v[188:191]
 s_mov_b32 s68, 0x358637bd
 ds_read_b64 v[34:35], v13 offset:1280
 v_mfma_f32_16x16x32_bf16 v[188:191], a[96:99], a[24:27], v[188:191]
 s_add_u32 m0, s18, 35840
 ds_read_b64 v[36:37], v13 offset:2560
 v_mfma_f32_16x16x32_bf16 v[220:223], a[104:107], a[24:27], v[220:223]
 s_mov_b32 s56, 0x3fb8aa3b
 buffer_load_dwordx4 v11, s[28:31], s15 offen lds
 v_mfma_f32_16x16x32_bf16 v[220:223], a[108:111], a[28:31], v[220:223]
 ds_read_b64 v[38:39], v13 offset:3840
 v_mfma_f32_16x16x32_bf16 v[216:219], a[108:111], a[20:23], v[216:219]
 ds_read_b64 v[40:41], v13 offset:5120
 v_mfma_f32_16x16x32_bf16 v[216:219], a[104:107], a[16:19], v[216:219]
 ds_read_b64 v[42:43], v13 offset:6400
 v_mfma_f32_16x16x32_bf16 v[212:215], a[104:107], a[8:11], v[212:215]
 ds_read_b64 v[44:45], v13 offset:7680
 v_mfma_f32_16x16x32_bf16 v[212:215], a[108:111], a[12:15], v[212:215]
 ds_read_b64 v[46:47], v13 offset:8960
 v_mfma_f32_16x16x32_bf16 v[208:211], a[108:111], a[4:7], v[208:211]
 v_mfma_f32_16x16x32_bf16 v[208:211], a[104:107], a[0:3], v[208:211]
 v_mfma_f32_16x16x32_bf16 v[240:243], a[0:3], a[112:115], v[240:243]
 s_add_u32 s15, s14, 524288
 v_mfma_f32_16x16x32_bf16 v[240:243], a[4:7], a[116:119], v[240:243]
 s_add_u32 m0, s18, 49152
 v_mfma_f32_16x16x32_bf16 v[244:247], a[12:15], a[116:119], v[244:247]
 buffer_load_dwordx4 v8, s[28:31], s15 offen lds
 v_mfma_f32_16x16x32_bf16 v[244:247], a[8:11], a[112:115], v[244:247]
 v_mfma_f32_16x16x32_bf16 v[248:251], a[16:19], a[112:115], v[248:251]
 v_mfma_f32_16x16x32_bf16 v[248:251], a[20:23], a[116:119], v[248:251]
 v_mfma_f32_16x16x32_bf16 v[252:255], a[28:31], a[116:119], v[252:255]
 s_waitcnt lgkmcnt(0)
 v_add_f32 v32, v32, v40
 v_add_f32 v33, v33, v41
 v_mfma_f32_16x16x32_bf16 v[252:255], a[24:27], a[112:115], v[252:255]
 v_add_f32 v34, v34, v42
 v_add_f32 v35, v35, v43
 v_mfma_f32_16x16x32_bf16 a[172:175], a[24:27], a[120:123], a[172:175]
 v_add_f32 v36, v36, v44
 v_add_f32 v37, v37, v45
 v_mfma_f32_16x16x32_bf16 a[172:175], a[28:31], a[124:127], a[172:175]
 v_add_f32 v38, v38, v46
 v_add_f32 v39, v39, v47
 v_mfma_f32_16x16x32_bf16 a[168:171], a[20:23], a[124:127], a[168:171]
 v_add_f32 v32, v32, v36
 v_add_f32 v33, v33, v37
 v_mfma_f32_16x16x32_bf16 a[168:171], a[16:19], a[120:123], a[168:171]
 s_add_u32 m0, s18, 50176
 v_add_f32 v34, v34, v38
 v_add_f32 v35, v35, v39
 v_mfma_f32_16x16x32_bf16 a[164:167], a[8:11], a[120:123], a[164:167]
 buffer_load_dwordx4 v9, s[28:31], s15 offen lds
 v_add_f32 v32, v32, v34
 v_mfma_f32_16x16x32_bf16 a[164:167], a[12:15], a[124:127], a[164:167]
 v_add_f32 v33, v33, v35
 v_mfma_f32_16x16x32_bf16 a[160:163], a[4:7], a[124:127], a[160:163]
 v_mfma_f32_16x16x32_bf16 a[160:163], a[0:3], a[120:123], a[160:163]
 s_waitcnt lgkmcnt(0)
 v_mfma_f32_16x16x32_bf16 a[192:195], a[0:3], a[128:131], a[192:195]
 v_mfma_f32_16x16x32_bf16 a[192:195], a[4:7], a[132:135], a[192:195]
 ds_write_b64 v12, v[32:33]
 v_mfma_f32_16x16x32_bf16 a[196:199], a[12:15], a[132:135], a[196:199]
 v_and_b32 v44, 15, v2
 v_lshrrev_b32 v45, 4, v2
 v_mfma_f32_16x16x32_bf16 a[196:199], a[8:11], a[128:131], a[196:199]
 v_lshlrev_b32 v4, 11, v44
 v_add_u32 v44, s7, v44
 v_mfma_f32_16x16x32_bf16 a[200:203], a[16:19], a[128:131], a[200:203]
 v_lshlrev_b32 v44, 4, v44
 v_add_u32 v44, 157696, v44
 v_mfma_f32_16x16x32_bf16 a[200:203], a[20:23], a[132:135], a[200:203]
 s_add_u32 m0, s18, 51200
 v_lshl_add_u32 v4, v45, 4, v4
 v_lshl_add_u32 v45, v45, 4, s64
 v_mfma_f32_16x16x32_bf16 a[204:207], a[28:31], a[132:135], a[204:207]
 buffer_load_dwordx4 v10, s[28:31], s15 offen lds
 v_add_u32 v5, 32768, v4
 v_mfma_f32_16x16x32_bf16 a[204:207], a[24:27], a[128:131], a[204:207]
 v_bfe_u32 v46, v2, 1, 3
 v_bfe_u32 v47, v2, 4, 1
 v_mfma_f32_16x16x32_bf16 a[236:239], a[24:27], a[136:139], a[236:239]
 v_lshl_or_b32 v46, v46, 4, v47
 v_and_b32 v47, 1, v2
 v_mfma_f32_16x16x32_bf16 a[236:239], a[28:31], a[140:143], a[236:239]
 v_lshl_or_b32 v46, v46, 2, v47
 v_lshlrev_b32 v46, 10, v46
 v_mfma_f32_16x16x32_bf16 a[232:235], a[20:23], a[140:143], a[232:235]
 v_mov_b32 v3, 1
 v_lshrrev_b32 v7, 2, v2
 v_mfma_f32_16x16x32_bf16 a[232:235], a[16:19], a[136:139], a[232:235]
 v_lshlrev_b32 v7, 7, v7
 v_and_b32 v6, 3, v2
 v_mfma_f32_16x16x32_bf16 a[228:231], a[8:11], a[136:139], a[228:231]
 v_lshl_add_u32 v7, v6, 3, v7
 v_bfe_u32 v6, v2, 3, 2
 v_mfma_f32_16x16x32_bf16 a[228:231], a[12:15], a[140:143], a[228:231]
 v_lshl_add_u32 v7, v6, 5, v7
 v_mfma_f32_16x16x32_bf16 a[224:227], a[4:7], a[140:143], a[224:227]
 v_mfma_f32_16x16x32_bf16 a[224:227], a[0:3], a[136:139], a[224:227]
 v_mfma_f32_16x16x32_bf16 v[64:67], a[64:67], a[32:35], v[64:67]
 s_waitcnt vmcnt(11) lgkmcnt(0)
 s_barrier
 v_mfma_f32_16x16x32_bf16 v[64:67], a[68:71], a[36:39], v[64:67]
 ds_read_b128 v[12:15], v45 offset:0
 v_mfma_f32_16x16x32_bf16 v[68:71], a[68:71], a[44:47], v[68:71]
 ds_read_b128 v[16:19], v45 offset:64
 v_mfma_f32_16x16x32_bf16 v[68:71], a[64:67], a[40:43], v[68:71]
 s_add_u32 m0, s18, 52224
 ds_read_b128 v[20:23], v45 offset:128
 v_mfma_f32_16x16x32_bf16 v[72:75], a[64:67], a[48:51], v[72:75]
 buffer_load_dwordx4 v11, s[28:31], s15 offen lds
 ds_read_b128 v[24:27], v45 offset:192
 v_mfma_f32_16x16x32_bf16 v[72:75], a[68:71], a[52:55], v[72:75]
 ds_read_b128 v[28:31], v44 offset:0
 v_mfma_f32_16x16x32_bf16 v[76:79], a[68:71], a[60:63], v[76:79]
 ds_read_b128 v[32:35], v44 offset:256
 v_mfma_f32_16x16x32_bf16 v[76:79], a[64:67], a[56:59], v[76:79]
 buffer_load_dwordx4 a[0:3], v4, s[8:11], s19 offen offset:0
 v_mfma_f32_16x16x32_bf16 v[108:111], a[72:75], a[56:59], v[108:111]
 v_mfma_f32_16x16x32_bf16 v[108:111], a[76:79], a[60:63], v[108:111]
 buffer_load_dwordx4 a[4:7], v4, s[8:11], s19 offen offset:64
 v_mfma_f32_16x16x32_bf16 v[104:107], a[76:79], a[52:55], v[104:107]
 v_mfma_f32_16x16x32_bf16 v[104:107], a[72:75], a[48:51], v[104:107]
 buffer_load_dwordx4 a[8:11], v5, s[8:11], s19 offen offset:0
 v_mfma_f32_16x16x32_bf16 v[100:103], a[72:75], a[40:43], v[100:103]
 v_mfma_f32_16x16x32_bf16 v[100:103], a[76:79], a[44:47], v[100:103]
 buffer_load_dwordx4 a[12:15], v5, s[8:11], s19 offen offset:64
 v_mfma_f32_16x16x32_bf16 v[96:99], a[76:79], a[36:39], v[96:99]
 s_add_u32 s15, s17, 0
 s_waitcnt lgkmcnt(0)
 v_fmac_f32 v48, v12, v28
 v_fmac_f32 v49, v13, v28
 v_fmac_f32 v50, v14, v28
 v_mfma_f32_16x16x32_bf16 v[96:99], a[72:75], a[32:35], v[96:99]
 s_add_u32 m0, s18, 81920
 v_fmac_f32 v51, v15, v28
 v_fmac_f32 v112, v20, v28
 v_fmac_f32 v113, v21, v28
 v_fmac_f32 v114, v22, v28
 v_mfma_f32_16x16x32_bf16 v[128:131], a[80:83], a[32:35], v[128:131]
 buffer_load_dwordx4 v8, s[32:35], s15 offen lds
 v_fmac_f32 v115, v23, v28
 v_mul_f32 v36, v48, v48
 v_mfma_f32_16x16x32_bf16 v[128:131], a[84:87], a[36:39], v[128:131]
 v_mul_f32 v37, v49, v49
 v_mul_f32 v38, v50, v50
 v_mul_f32 v39, v51, v51
 v_mfma_f32_16x16x32_bf16 v[132:135], a[84:87], a[44:47], v[132:135]
 v_mul_f32 v40, v112, v112
 v_mul_f32 v41, v113, v113
 v_mul_f32 v42, v114, v114
 v_mfma_f32_16x16x32_bf16 v[132:135], a[80:83], a[40:43], v[132:135]
 v_mul_f32_e64 v43, v115, v115
 v_fma_f32 v36, v36, v30, v29
 v_fma_f32 v37, v37, v30, v29
 v_fma_f32 v38, v38, v30, v29
 v_mfma_f32_16x16x32_bf16 v[136:139], a[80:83], a[48:51], v[136:139]
 v_fma_f32 v39, v39, v30, v29
 v_fma_f32 v40, v40, v30, v29
 v_fma_f32 v41, v41, v30, v29
 v_mfma_f32_16x16x32_bf16 v[136:139], a[84:87], a[52:55], v[136:139]
 v_fma_f32 v42, v42, v30, v29
 v_fma_f32 v43, v43, v30, v29
 v_mul_f32 v36, v36, v48
 v_mfma_f32_16x16x32_bf16 v[140:143], a[84:87], a[60:63], v[140:143]
 v_mul_f32 v37, v37, v49
 v_mul_f32 v38, v38, v50
 v_mul_f32 v39, v39, v51
 v_mfma_f32_16x16x32_bf16 v[140:143], a[80:83], a[56:59], v[140:143]
 s_add_u32 m0, s18, 82944
 v_mul_f32 v40, v40, v112
 v_mul_f32 v41, v41, v113
 v_mul_f32 v42, v42, v114
 v_mul_f32 v43, v43, v115
 v_mfma_f32_16x16x32_bf16 v[172:175], a[88:91], a[56:59], v[172:175]
 buffer_load_dwordx4 v9, s[32:35], s15 offen lds
 v_exp_f32 v36, v36
 v_mfma_f32_16x16x32_bf16 v[172:175], a[92:95], a[60:63], v[172:175]
 v_exp_f32 v37, v37
 v_exp_f32 v38, v38
 v_mfma_f32_16x16x32_bf16 v[168:171], a[92:95], a[52:55], v[168:171]
 v_exp_f32 v39, v39
 v_mfma_f32_16x16x32_bf16 v[168:171], a[88:91], a[48:51], v[168:171]
 v_exp_f32 v40, v40
 v_exp_f32 v41, v41
 v_mfma_f32_16x16x32_bf16 v[164:167], a[88:91], a[40:43], v[164:167]
 v_exp_f32 v42, v42
 v_mfma_f32_16x16x32_bf16 v[164:167], a[92:95], a[44:47], v[164:167]
 v_exp_f32 v43, v43
 v_fmac_f32 v80, v16, v28
 v_fmac_f32 v81, v17, v28
 v_mfma_f32_16x16x32_bf16 v[160:163], a[92:95], a[36:39], v[160:163]
 v_fmac_f32 v82, v18, v28
 v_fmac_f32 v83, v19, v28
 v_fmac_f32 v144, v24, v28
 v_mfma_f32_16x16x32_bf16 v[160:163], a[88:91], a[32:35], v[160:163]
 s_add_u32 m0, s18, 83968
 v_fmac_f32 v145, v25, v28
 v_fmac_f32 v146, v26, v28
 v_fmac_f32 v147, v27, v28
 v_fma_f32 v36, v36, v31, v31
 v_mfma_f32_16x16x32_bf16 v[192:195], a[96:99], a[32:35], v[192:195]
 buffer_load_dwordx4 v10, s[32:35], s15 offen lds
 v_fma_f32 v37, v37, v31, v31
 v_fma_f32 v38, v38, v31, v31
 v_mfma_f32_16x16x32_bf16 v[192:195], a[100:103], a[36:39], v[192:195]
 v_fma_f32 v39, v39, v31, v31
 v_fma_f32 v40, v40, v31, v31
 v_fma_f32 v41, v41, v31, v31
 v_mfma_f32_16x16x32_bf16 v[196:199], a[100:103], a[44:47], v[196:199]
 v_fma_f32 v42, v42, v31, v31
 v_fma_f32 v43, v43, v31, v31
 v_rcp_f32 v36, v36
 v_mfma_f32_16x16x32_bf16 v[196:199], a[96:99], a[40:43], v[196:199]
 v_rcp_f32 v37, v37
 v_mfma_f32_16x16x32_bf16 v[200:203], a[96:99], a[48:51], v[200:203]
 v_rcp_f32 v38, v38
 v_rcp_f32 v39, v39
 v_mfma_f32_16x16x32_bf16 v[200:203], a[100:103], a[52:55], v[200:203]
 v_rcp_f32 v40, v40
 v_rcp_f32 v41, v41
 v_mfma_f32_16x16x32_bf16 v[204:207], a[100:103], a[60:63], v[204:207]
 v_rcp_f32 v42, v42
 v_mfma_f32_16x16x32_bf16 v[204:207], a[96:99], a[56:59], v[204:207]
 s_add_u32 m0, s18, 84992
 v_rcp_f32 v43, v43
 v_mul_f32 v80, v80, v48
 v_mul_f32 v81, v81, v49
 v_mfma_f32_16x16x32_bf16 v[236:239], a[104:107], a[56:59], v[236:239]
 buffer_load_dwordx4 v11, s[32:35], s15 offen lds
 v_mul_f32 v82, v82, v50
 v_mul_f32 v83, v83, v51
 v_mfma_f32_16x16x32_bf16 v[236:239], a[108:111], a[60:63], v[236:239]
 v_mul_f32 v144, v144, v112
 v_mul_f32 v145, v145, v113
 v_mul_f32 v146, v146, v114
 v_mfma_f32_16x16x32_bf16 v[232:235], a[108:111], a[52:55], v[232:235]
 v_mul_f32 v147, v147, v115
 v_mul_f32 v80, v80, v36
 v_mul_f32 v81, v81, v37
 v_mfma_f32_16x16x32_bf16 v[232:235], a[104:107], a[48:51], v[232:235]
 v_mul_f32 v82, v82, v38
 v_mul_f32 v83, v83, v39
 v_mul_f32 v144, v144, v40
 v_mul_f32 v145, v145, v41
 v_mfma_f32_16x16x32_bf16 v[228:231], a[104:107], a[40:43], v[228:231]
 v_mul_f32 v146, v146, v42
 v_mul_f32 v147, v147, v43
 v_cvt_pk_bf16_f32 v48, v80, v81
 v_mfma_f32_16x16x32_bf16 v[228:231], a[108:111], a[44:47], v[228:231]
 v_cvt_pk_bf16_f32 v49, v82, v83
 v_cvt_pk_bf16_f32 v50, v144, v145
 v_cvt_pk_bf16_f32 v51, v146, v147
 v_mfma_f32_16x16x32_bf16 v[224:227], a[108:111], a[36:39], v[224:227]
 s_add_u32 s15, s17, 262144
 buffer_store_dwordx4 v[48:51], v1, s[24:27], s40 offen sc1
 v_fmac_f32 v52, v12, v32
 v_fmac_f32 v53, v13, v32
 v_mfma_f32_16x16x32_bf16 v[224:227], a[104:107], a[32:35], v[224:227]
 s_add_u32 m0, s18, 98304
 ds_read_b128 v[28:31], v44 offset:512
 v_fmac_f32 v54, v14, v32
 v_fmac_f32 v55, v15, v32
 v_fmac_f32 v116, v20, v32
 v_mfma_f32_16x16x32_bf16 a[144:147], a[32:35], a[112:115], a[144:147]
 buffer_load_dwordx4 v8, s[32:35], s15 offen lds
 v_fmac_f32 v117, v21, v32
 v_fmac_f32 v118, v22, v32
 v_fmac_f32 v119, v23, v32
 v_mfma_f32_16x16x32_bf16 a[144:147], a[36:39], a[116:119], a[144:147]
 v_mul_f32 v36, v52, v52
 v_mul_f32 v37, v53, v53
 v_mul_f32 v38, v54, v54
 v_mfma_f32_16x16x32_bf16 a[148:151], a[44:47], a[116:119], a[148:151]
 v_mul_f32 v39, v55, v55
 v_mul_f32 v40, v116, v116
 v_mul_f32 v41, v117, v117
 v_mfma_f32_16x16x32_bf16 a[148:151], a[40:43], a[112:115], a[148:151]
 v_mul_f32 v42, v118, v118
 v_mul_f32 v43, v119, v119
 v_fma_f32 v36, v36, v34, v33
 v_mfma_f32_16x16x32_bf16 a[152:155], a[48:51], a[112:115], a[152:155]
 v_fma_f32 v37, v37, v34, v33
 v_fma_f32 v38, v38, v34, v33
 v_fma_f32 v39, v39, v34, v33
 v_mfma_f32_16x16x32_bf16 a[152:155], a[52:55], a[116:119], a[152:155]
 v_fma_f32 v40, v40, v34, v33
 v_fma_f32 v41, v41, v34, v33
 v_fma_f32 v42, v42, v34, v33
 v_mfma_f32_16x16x32_bf16 a[156:159], a[60:63], a[116:119], a[156:159]
 v_fma_f32 v43, v43, v34, v33
 v_mul_f32 v36, v36, v52
 v_mul_f32 v37, v37, v53
 v_mul_f32 v38, v38, v54
 v_mfma_f32_16x16x32_bf16 a[156:159], a[56:59], a[112:115], a[156:159]
 s_add_u32 m0, s18, 99328
 v_mul_f32 v39, v39, v55
 v_mul_f32 v40, v40, v116
 v_mul_f32 v41, v41, v117
 v_mfma_f32_16x16x32_bf16 a[188:191], a[56:59], a[120:123], a[188:191]
 buffer_load_dwordx4 v9, s[32:35], s15 offen lds
 v_mul_f32 v42, v42, v118
 v_mul_f32 v43, v43, v119
 v_mfma_f32_16x16x32_bf16 a[188:191], a[60:63], a[124:127], a[188:191]
 v_exp_f32 v36, v36
 v_exp_f32 v37, v37
 v_mfma_f32_16x16x32_bf16 a[184:187], a[52:55], a[124:127], a[184:187]
 v_exp_f32 v38, v38
 v_mfma_f32_16x16x32_bf16 a[184:187], a[48:51], a[120:123], a[184:187]
 v_exp_f32 v39, v39
 v_exp_f32 v40, v40
 v_mfma_f32_16x16x32_bf16 a[180:183], a[40:43], a[120:123], a[180:183]
 v_exp_f32 v41, v41
 v_mfma_f32_16x16x32_bf16 a[180:183], a[44:47], a[124:127], a[180:183]
 v_exp_f32 v42, v42
 v_exp_f32 v43, v43
 v_mfma_f32_16x16x32_bf16 a[176:179], a[36:39], a[124:127], a[176:179]
 v_fmac_f32 v84, v16, v32
 v_fmac_f32 v85, v17, v32
 v_fmac_f32 v86, v18, v32
 v_mfma_f32_16x16x32_bf16 a[176:179], a[32:35], a[120:123], a[176:179]
 s_add_u32 m0, s18, 100352
 v_fmac_f32 v87, v19, v32
 v_fmac_f32 v148, v24, v32
 v_fmac_f32 v149, v25, v32
 v_mfma_f32_16x16x32_bf16 a[208:211], a[32:35], a[128:131], a[208:211]
 buffer_load_dwordx4 v10, s[32:35], s15 offen lds
 v_fmac_f32 v150, v26, v32
 v_fmac_f32 v151, v27, v32
 v_mfma_f32_16x16x32_bf16 a[208:211], a[36:39], a[132:135], a[208:211]
 v_fma_f32 v36, v36, v35, v35
 v_fma_f32 v37, v37, v35, v35
 v_fma_f32 v38, v38, v35, v35
 v_fma_f32 v39, v39, v35, v35
 v_mfma_f32_16x16x32_bf16 a[212:215], a[44:47], a[132:135], a[212:215]
 v_fma_f32 v40, v40, v35, v35
 v_fma_f32 v41, v41, v35, v35
 v_fma_f32 v42, v42, v35, v35
 v_mfma_f32_16x16x32_bf16 a[212:215], a[40:43], a[128:131], a[212:215]
 v_fma_f32 v43, v43, v35, v35
 v_rcp_f32 v36, v36
 v_mfma_f32_16x16x32_bf16 a[216:219], a[48:51], a[128:131], a[216:219]
 v_rcp_f32 v37, v37
 v_rcp_f32 v38, v38
 v_mfma_f32_16x16x32_bf16 a[216:219], a[52:55], a[132:135], a[216:219]
 v_rcp_f32 v39, v39
 v_mfma_f32_16x16x32_bf16 a[220:223], a[60:63], a[132:135], a[220:223]
 v_rcp_f32 v40, v40
 v_rcp_f32 v41, v41
 v_mfma_f32_16x16x32_bf16 a[220:223], a[56:59], a[128:131], a[220:223]
 s_add_u32 m0, s18, 101376
 v_rcp_f32 v42, v42
 v_mfma_f32_16x16x32_bf16 a[252:255], a[56:59], a[136:139], a[252:255]
 buffer_load_dwordx4 v11, s[32:35], s15 offen lds
 v_rcp_f32 v43, v43
 v_mul_f32 v84, v84, v52
 v_mfma_f32_16x16x32_bf16 a[252:255], a[60:63], a[140:143], a[252:255]
 v_mul_f32 v85, v85, v53
 v_mul_f32 v86, v86, v54
 v_mul_f32 v87, v87, v55
 v_mfma_f32_16x16x32_bf16 a[248:251], a[52:55], a[140:143], a[248:251]
 v_mul_f32 v148, v148, v116
 v_mul_f32 v149, v149, v117
 v_mul_f32 v150, v150, v118
 v_mfma_f32_16x16x32_bf16 a[248:251], a[48:51], a[136:139], a[248:251]
 v_mul_f32 v151, v151, v119
 v_mul_f32 v84, v84, v36
 v_mul_f32 v85, v85, v37
 v_mfma_f32_16x16x32_bf16 a[244:247], a[40:43], a[136:139], a[244:247]
 v_mul_f32 v86, v86, v38
 v_mul_f32 v87, v87, v39
 v_mul_f32 v148, v148, v40
 v_mul_f32 v149, v149, v41
 v_mfma_f32_16x16x32_bf16 a[244:247], a[44:47], a[140:143], a[244:247]
 v_mul_f32 v150, v150, v42
 v_mul_f32 v151, v151, v43
 v_cvt_pk_bf16_f32 v52, v84, v85
 v_mfma_f32_16x16x32_bf16 a[240:243], a[36:39], a[140:143], a[240:243]
 v_cvt_pk_bf16_f32 v53, v86, v87
 v_cvt_pk_bf16_f32 v54, v148, v149
 v_cvt_pk_bf16_f32 v55, v150, v151
 v_mfma_f32_16x16x32_bf16 a[240:243], a[32:35], a[136:139], a[240:243]
 buffer_store_dwordx4 v[52:55], v1, s[24:27], s40 offen offset:1024 sc1
 s_waitcnt lgkmcnt(0)
 s_nop 0
 ds_read_b128 v[32:35], v44 offset:768
 v_pk_fma_f32 v[56:57], v[12:13], v[28:29], v[56:57] op_sel_hi:[1,0,1]
 v_pk_fma_f32 v[58:59], v[14:15], v[28:29], v[58:59] op_sel_hi:[1,0,1]
 v_pk_fma_f32 v[120:121], v[20:21], v[28:29], v[120:121] op_sel_hi:[1,0,1]
 v_pk_fma_f32 v[122:123], v[22:23], v[28:29], v[122:123] op_sel_hi:[1,0,1]
 v_pk_mul_f32 v[36:37], v[56:57], v[56:57]
 v_pk_mul_f32 v[38:39], v[58:59], v[58:59]
 v_pk_mul_f32 v[40:41], v[120:121], v[120:121]
 v_pk_mul_f32 v[42:43], v[122:123], v[122:123]
 v_pk_fma_f32 v[36:37], v[36:37], v[30:31], v[28:29] op_sel:[0,0,1] op_sel_hi:[1,0,1]
 v_pk_fma_f32 v[38:39], v[38:39], v[30:31], v[28:29] op_sel:[0,0,1] op_sel_hi:[1,0,1]
 v_pk_fma_f32 v[40:41], v[40:41], v[30:31], v[28:29] op_sel:[0,0,1] op_sel_hi:[1,0,1]
 v_pk_fma_f32 v[42:43], v[42:43], v[30:31], v[28:29] op_sel:[0,0,1] op_sel_hi:[1,0,1]
 v_pk_mul_f32 v[36:37], v[36:37], v[56:57]
 v_pk_mul_f32 v[38:39], v[38:39], v[58:59]
 v_pk_mul_f32 v[40:41], v[40:41], v[120:121]
 v_pk_mul_f32 v[42:43], v[42:43], v[122:123]
 v_exp_f32 v36, v36
 v_exp_f32 v37, v37
 s_add_u32 s15, s17, 524288
 s_add_u32 m0, s18, 114688
 s_nop 0
 buffer_load_dwordx4 v8, s[32:35], s15 offen lds
 v_exp_f32 v38, v38
 v_exp_f32 v39, v39
 v_exp_f32 v40, v40
 v_exp_f32 v41, v41
 v_exp_f32 v42, v42
 v_exp_f32_e64 v43, v43
 v_pk_fma_f32 v[88:89], v[16:17], v[28:29], v[88:89] op_sel_hi:[1,0,1]
 v_pk_fma_f32 v[90:91], v[18:19], v[28:29], v[90:91] op_sel_hi:[1,0,1]
 v_pk_fma_f32 v[152:153], v[24:25], v[28:29], v[152:153] op_sel_hi:[1,0,1]
 v_pk_fma_f32 v[154:155], v[26:27], v[28:29], v[154:155] op_sel_hi:[1,0,1]
 v_pk_fma_f32 v[36:37], v[36:37], v[30:31], v[30:31] op_sel:[0,1,1] op_sel_hi:[1,1,1]
 v_pk_fma_f32 v[38:39], v[38:39], v[30:31], v[30:31] op_sel:[0,1,1] op_sel_hi:[1,1,1]
 v_pk_fma_f32 v[40:41], v[40:41], v[30:31], v[30:31] op_sel:[0,1,1] op_sel_hi:[1,1,1]
 v_pk_fma_f32 v[42:43], v[42:43], v[30:31], v[30:31] op_sel:[0,1,1] op_sel_hi:[1,1,1]
 v_rcp_f32 v36, v36
 v_rcp_f32 v37, v37
 s_add_u32 m0, s18, 115712
 s_nop 0
 buffer_load_dwordx4 v9, s[32:35], s15 offen lds
 v_rcp_f32 v38, v38
 v_rcp_f32 v39, v39
 v_rcp_f32 v40, v40
 v_rcp_f32 v41, v41
 v_rcp_f32 v42, v42
 v_rcp_f32_e64 v43, v43
 v_pk_mul_f32 v[88:89], v[88:89], v[56:57]
 v_pk_mul_f32 v[90:91], v[90:91], v[58:59]
 v_pk_mul_f32 v[152:153], v[152:153], v[120:121]
 v_pk_mul_f32 v[154:155], v[154:155], v[122:123]
 v_pk_mul_f32 v[88:89], v[88:89], v[36:37]
 v_pk_mul_f32 v[90:91], v[90:91], v[38:39]
 v_pk_mul_f32 v[152:153], v[152:153], v[40:41]
 v_pk_mul_f32 v[154:155], v[154:155], v[42:43]
 v_cvt_pk_bf16_f32 v56, v88, v89
 v_cvt_pk_bf16_f32 v57, v90, v91
 v_cvt_pk_bf16_f32 v58, v152, v153
 v_cvt_pk_bf16_f32 v59, v154, v155
 buffer_store_dwordx4 v[56:59], v1, s[24:27], s41 offen sc1
 v_xor_b32 v6, 0, v7
 s_waitcnt lgkmcnt(0)
 ds_read_b128 v[28:31], v44 offset:1024
 s_branch L_tp_L_tA_7_o
L_tp_L_tA_7:
 s_nop 0
 s_branch L_tr00
 s_nop 0
L_tp_L_tA_7_o:
 ds_read_b64_tr_b16 a[16:17], v6 offset:0
 ds_read_b64_tr_b16 a[18:19], v6 offset:2048
 ds_read_b64_tr_b16 a[48:49], v6 offset:8192
 ds_read_b64_tr_b16 a[50:51], v6 offset:10240
 ds_read_b64_tr_b16 a[32:33], v6 offset:4096
 ds_read_b64_tr_b16 a[34:35], v6 offset:6144
 ds_read_b64_tr_b16 a[64:65], v6 offset:12288
 ds_read_b64_tr_b16 a[66:67], v6 offset:14336
 v_pk_fma_f32 v[60:61], v[12:13], v[32:33], v[60:61] op_sel_hi:[1,0,1]
 v_pk_fma_f32 v[62:63], v[14:15], v[32:33], v[62:63] op_sel_hi:[1,0,1]
 v_pk_fma_f32 v[124:125], v[20:21], v[32:33], v[124:125] op_sel_hi:[1,0,1]
 v_pk_fma_f32 v[126:127], v[22:23], v[32:33], v[126:127] op_sel_hi:[1,0,1]
 v_pk_mul_f32 v[36:37], v[60:61], v[60:61]
 v_pk_mul_f32 v[38:39], v[62:63], v[62:63]
 v_pk_mul_f32 v[40:41], v[124:125], v[124:125]
 v_pk_mul_f32 v[42:43], v[126:127], v[126:127]
 v_pk_fma_f32 v[36:37], v[36:37], v[34:35], v[32:33] op_sel:[0,0,1] op_sel_hi:[1,0,1]
 v_pk_fma_f32 v[38:39], v[38:39], v[34:35], v[32:33] op_sel:[0,0,1] op_sel_hi:[1,0,1]
 v_pk_fma_f32 v[40:41], v[40:41], v[34:35], v[32:33] op_sel:[0,0,1] op_sel_hi:[1,0,1]
 v_pk_fma_f32 v[42:43], v[42:43], v[34:35], v[32:33] op_sel:[0,0,1] op_sel_hi:[1,0,1]
 v_pk_mul_f32 v[36:37], v[36:37], v[60:61]
 v_pk_mul_f32 v[38:39], v[38:39], v[62:63]
 v_pk_mul_f32 v[40:41], v[40:41], v[124:125]
 v_pk_mul_f32 v[42:43], v[42:43], v[126:127]
 v_exp_f32 v36, v36
 v_exp_f32 v37, v37
 s_add_u32 m0, s18, 116736
 s_nop 0
 buffer_load_dwordx4 v10, s[32:35], s15 offen lds
 v_exp_f32 v38, v38
 v_exp_f32 v39, v39
 v_exp_f32 v40, v40
 v_exp_f32 v41, v41
 v_exp_f32 v42, v42
 v_exp_f32_e64 v43, v43
 v_pk_fma_f32 v[92:93], v[16:17], v[32:33], v[92:93] op_sel_hi:[1,0,1]
 v_pk_fma_f32 v[94:95], v[18:19], v[32:33], v[94:95] op_sel_hi:[1,0,1]
 v_pk_fma_f32 v[156:157], v[24:25], v[32:33], v[156:157] op_sel_hi:[1,0,1]
 v_pk_fma_f32 v[158:159], v[26:27], v[32:33], v[158:159] op_sel_hi:[1,0,1]
 v_pk_fma_f32 v[36:37], v[36:37], v[34:35], v[34:35] op_sel:[0,1,1] op_sel_hi:[1,1,1]
 v_pk_fma_f32 v[38:39], v[38:39], v[34:35], v[34:35] op_sel:[0,1,1] op_sel_hi:[1,1,1]
 v_pk_fma_f32 v[40:41], v[40:41], v[34:35], v[34:35] op_sel:[0,1,1] op_sel_hi:[1,1,1]
 v_pk_fma_f32 v[42:43], v[42:43], v[34:35], v[34:35] op_sel:[0,1,1] op_sel_hi:[1,1,1]
 v_rcp_f32 v36, v36
 v_rcp_f32 v37, v37
 s_add_u32 m0, s18, 117760
 s_nop 0
 buffer_load_dwordx4 v11, s[32:35], s15 offen lds
 v_rcp_f32 v38, v38
 v_rcp_f32 v39, v39
 v_rcp_f32 v40, v40
 v_rcp_f32 v41, v41
 v_rcp_f32 v42, v42
 v_rcp_f32_e64 v43, v43
 v_pk_mul_f32 v[92:93], v[92:93], v[60:61]
 v_pk_mul_f32 v[94:95], v[94:95], v[62:63]
 v_pk_mul_f32 v[156:157], v[156:157], v[124:125]
 v_pk_mul_f32 v[158:159], v[158:159], v[126:127]
 v_pk_mul_f32 v[92:93], v[92:93], v[36:37]
 v_pk_mul_f32 v[94:95], v[94:95], v[38:39]
 v_pk_mul_f32 v[156:157], v[156:157], v[40:41]
 v_pk_mul_f32 v[158:159], v[158:159], v[42:43]
 v_cvt_pk_bf16_f32 v60, v92, v93
 v_cvt_pk_bf16_f32 v61, v94, v95
 v_cvt_pk_bf16_f32 v62, v156, v157
 v_cvt_pk_bf16_f32 v63, v158, v159
 buffer_store_dwordx4 v[60:63], v1, s[24:27], s41 offen offset:1024 sc1
 v_xor_b32 v6, 32, v7
 s_waitcnt lgkmcnt(0)
 ds_read_b128 v[32:35], v44 offset:1280
 ds_read_b64_tr_b16 a[20:21], v6 offset:0
 ds_read_b64_tr_b16 a[22:23], v6 offset:2048
 ds_read_b64_tr_b16 a[52:53], v6 offset:8192
 ds_read_b64_tr_b16 a[54:55], v6 offset:10240
 ds_read_b64_tr_b16 a[36:37], v6 offset:4096
 ds_read_b64_tr_b16 a[38:39], v6 offset:6144
 ds_read_b64_tr_b16 a[68:69], v6 offset:12288
 ds_read_b64_tr_b16 a[70:71], v6 offset:14336
 v_pk_fma_f32 v[64:65], v[12:13], v[28:29], v[64:65] op_sel_hi:[1,0,1]
 v_pk_fma_f32 v[66:67], v[14:15], v[28:29], v[66:67] op_sel_hi:[1,0,1]
 v_pk_fma_f32 v[128:129], v[20:21], v[28:29], v[128:129] op_sel_hi:[1,0,1]
 v_pk_fma_f32 v[130:131], v[22:23], v[28:29], v[130:131] op_sel_hi:[1,0,1]
 v_pk_mul_f32 v[36:37], v[64:65], v[64:65]
 v_pk_mul_f32 v[38:39], v[66:67], v[66:67]
 v_pk_mul_f32 v[40:41], v[128:129], v[128:129]
 v_pk_mul_f32 v[42:43], v[130:131], v[130:131]
 v_pk_fma_f32 v[36:37], v[36:37], v[30:31], v[28:29] op_sel:[0,0,1] op_sel_hi:[1,0,1]
 v_pk_fma_f32 v[38:39], v[38:39], v[30:31], v[28:29] op_sel:[0,0,1] op_sel_hi:[1,0,1]
 v_pk_fma_f32 v[40:41], v[40:41], v[30:31], v[28:29] op_sel:[0,0,1] op_sel_hi:[1,0,1]
 v_pk_fma_f32 v[42:43], v[42:43], v[30:31], v[28:29] op_sel:[0,0,1] op_sel_hi:[1,0,1]
 v_pk_mul_f32 v[36:37], v[36:37], v[64:65]
 v_pk_mul_f32 v[38:39], v[38:39], v[66:67]
 v_pk_mul_f32 v[40:41], v[40:41], v[128:129]
 v_pk_mul_f32 v[42:43], v[42:43], v[130:131]
 v_exp_f32 v36, v36
 v_exp_f32 v37, v37
 s_add_u32 s15, s17, 786432
 s_add_u32 m0, s18, 131072
 s_nop 0
 buffer_load_dwordx4 v8, s[32:35], s15 offen lds
 v_exp_f32 v38, v38
 v_exp_f32 v39, v39
 v_exp_f32 v40, v40
 v_exp_f32 v41, v41
 v_exp_f32 v42, v42
 v_exp_f32_e64 v43, v43
 v_pk_fma_f32 v[96:97], v[16:17], v[28:29], v[96:97] op_sel_hi:[1,0,1]
 v_pk_fma_f32 v[98:99], v[18:19], v[28:29], v[98:99] op_sel_hi:[1,0,1]
 v_pk_fma_f32 v[160:161], v[24:25], v[28:29], v[160:161] op_sel_hi:[1,0,1]
 v_pk_fma_f32 v[162:163], v[26:27], v[28:29], v[162:163] op_sel_hi:[1,0,1]
 v_pk_fma_f32 v[36:37], v[36:37], v[30:31], v[30:31] op_sel:[0,1,1] op_sel_hi:[1,1,1]
 v_pk_fma_f32 v[38:39], v[38:39], v[30:31], v[30:31] op_sel:[0,1,1] op_sel_hi:[1,1,1]
 v_pk_fma_f32 v[40:41], v[40:41], v[30:31], v[30:31] op_sel:[0,1,1] op_sel_hi:[1,1,1]
 v_pk_fma_f32 v[42:43], v[42:43], v[30:31], v[30:31] op_sel:[0,1,1] op_sel_hi:[1,1,1]
 v_rcp_f32 v36, v36
 v_rcp_f32 v37, v37
 s_add_u32 m0, s18, 132096
 s_nop 0
 buffer_load_dwordx4 v9, s[32:35], s15 offen lds
 v_rcp_f32 v38, v38
 v_rcp_f32 v39, v39
 v_rcp_f32 v40, v40
 v_rcp_f32 v41, v41
 v_rcp_f32 v42, v42
 v_rcp_f32_e64 v43, v43
 v_pk_mul_f32 v[96:97], v[96:97], v[64:65]
 v_pk_mul_f32 v[98:99], v[98:99], v[66:67]
 v_pk_mul_f32 v[160:161], v[160:161], v[128:129]
 v_pk_mul_f32 v[162:163], v[162:163], v[130:131]
 v_pk_mul_f32 v[96:97], v[96:97], v[36:37]
 v_pk_mul_f32 v[98:99], v[98:99], v[38:39]
 v_pk_mul_f32 v[160:161], v[160:161], v[40:41]
 v_pk_mul_f32 v[162:163], v[162:163], v[42:43]
 v_cvt_pk_bf16_f32 v64, v96, v97
 v_cvt_pk_bf16_f32 v65, v98, v99
 v_cvt_pk_bf16_f32 v66, v160, v161
 v_cvt_pk_bf16_f32 v67, v162, v163
 buffer_store_dwordx4 v[64:67], v1, s[24:27], s42 offen sc1
 v_xor_b32 v6, 64, v7
 s_waitcnt lgkmcnt(0)
 ds_read_b128 v[28:31], v44 offset:1536
 ds_read_b64_tr_b16 a[24:25], v6 offset:0
 ds_read_b64_tr_b16 a[26:27], v6 offset:2048
 ds_read_b64_tr_b16 a[56:57], v6 offset:8192
 ds_read_b64_tr_b16 a[58:59], v6 offset:10240
 ds_read_b64_tr_b16 a[40:41], v6 offset:4096
 ds_read_b64_tr_b16 a[42:43], v6 offset:6144
 ds_read_b64_tr_b16 a[72:73], v6 offset:12288
 ds_read_b64_tr_b16 a[74:75], v6 offset:14336
 v_pk_fma_f32 v[68:69], v[12:13], v[32:33], v[68:69] op_sel_hi:[1,0,1]
 v_pk_fma_f32 v[70:71], v[14:15], v[32:33], v[70:71] op_sel_hi:[1,0,1]
 v_pk_fma_f32 v[132:133], v[20:21], v[32:33], v[132:133] op_sel_hi:[1,0,1]
 v_pk_fma_f32 v[134:135], v[22:23], v[32:33], v[134:135] op_sel_hi:[1,0,1]
 v_pk_mul_f32 v[36:37], v[68:69], v[68:69]
 v_pk_mul_f32 v[38:39], v[70:71], v[70:71]
 v_pk_mul_f32 v[40:41], v[132:133], v[132:133]
 v_pk_mul_f32 v[42:43], v[134:135], v[134:135]
 v_pk_fma_f32 v[36:37], v[36:37], v[34:35], v[32:33] op_sel:[0,0,1] op_sel_hi:[1,0,1]
 v_pk_fma_f32 v[38:39], v[38:39], v[34:35], v[32:33] op_sel:[0,0,1] op_sel_hi:[1,0,1]
 v_pk_fma_f32 v[40:41], v[40:41], v[34:35], v[32:33] op_sel:[0,0,1] op_sel_hi:[1,0,1]
 v_pk_fma_f32 v[42:43], v[42:43], v[34:35], v[32:33] op_sel:[0,0,1] op_sel_hi:[1,0,1]
 v_pk_mul_f32 v[36:37], v[36:37], v[68:69]
 v_pk_mul_f32 v[38:39], v[38:39], v[70:71]
 v_pk_mul_f32 v[40:41], v[40:41], v[132:133]
 v_pk_mul_f32 v[42:43], v[42:43], v[134:135]
 v_exp_f32 v36, v36
 v_exp_f32 v37, v37
 s_add_u32 m0, s18, 133120
 s_nop 0
 buffer_load_dwordx4 v10, s[32:35], s15 offen lds
 v_exp_f32 v38, v38
 v_exp_f32 v39, v39
 v_exp_f32 v40, v40
 v_exp_f32 v41, v41
 v_exp_f32 v42, v42
 v_exp_f32_e64 v43, v43
 v_pk_fma_f32 v[100:101], v[16:17], v[32:33], v[100:101] op_sel_hi:[1,0,1]
 v_pk_fma_f32 v[102:103], v[18:19], v[32:33], v[102:103] op_sel_hi:[1,0,1]
 v_pk_fma_f32 v[164:165], v[24:25], v[32:33], v[164:165] op_sel_hi:[1,0,1]
 v_pk_fma_f32 v[166:167], v[26:27], v[32:33], v[166:167] op_sel_hi:[1,0,1]
 v_pk_fma_f32 v[36:37], v[36:37], v[34:35], v[34:35] op_sel:[0,1,1] op_sel_hi:[1,1,1]
 v_pk_fma_f32 v[38:39], v[38:39], v[34:35], v[34:35] op_sel:[0,1,1] op_sel_hi:[1,1,1]
 v_pk_fma_f32 v[40:41], v[40:41], v[34:35], v[34:35] op_sel:[0,1,1] op_sel_hi:[1,1,1]
 v_pk_fma_f32 v[42:43], v[42:43], v[34:35], v[34:35] op_sel:[0,1,1] op_sel_hi:[1,1,1]
 v_rcp_f32 v36, v36
 v_rcp_f32 v37, v37
 s_add_u32 m0, s18, 134144
 s_nop 0
 buffer_load_dwordx4 v11, s[32:35], s15 offen lds
 v_rcp_f32 v38, v38
 v_rcp_f32 v39, v39
 v_rcp_f32 v40, v40
 v_rcp_f32 v41, v41
 v_rcp_f32 v42, v42
 v_rcp_f32_e64 v43, v43
 v_pk_mul_f32 v[100:101], v[100:101], v[68:69]
 v_pk_mul_f32 v[102:103], v[102:103], v[70:71]
 v_pk_mul_f32 v[164:165], v[164:165], v[132:133]
 v_pk_mul_f32 v[166:167], v[166:167], v[134:135]
 v_pk_mul_f32 v[100:101], v[100:101], v[36:37]
 v_pk_mul_f32 v[102:103], v[102:103], v[38:39]
 v_pk_mul_f32 v[164:165], v[164:165], v[40:41]
 v_pk_mul_f32 v[166:167], v[166:167], v[42:43]
 v_cvt_pk_bf16_f32 v68, v100, v101
 v_cvt_pk_bf16_f32 v69, v102, v103
 v_cvt_pk_bf16_f32 v70, v164, v165
 v_cvt_pk_bf16_f32 v71, v166, v167
 buffer_store_dwordx4 v[68:71], v1, s[24:27], s42 offen offset:1024 sc1
 v_xor_b32 v6, 96, v7
 s_waitcnt lgkmcnt(0)
 s_nop 0
 ds_read_b128 v[32:35], v44 offset:1792
 ds_read_b64_tr_b16 a[28:29], v6 offset:0
 ds_read_b64_tr_b16 a[30:31], v6 offset:2048
 ds_read_b64_tr_b16 a[60:61], v6 offset:8192
 ds_read_b64_tr_b16 a[62:63], v6 offset:10240
 ds_read_b64_tr_b16 a[44:45], v6 offset:4096
 ds_read_b64_tr_b16 a[46:47], v6 offset:6144
 ds_read_b64_tr_b16 a[76:77], v6 offset:12288
 ds_read_b64_tr_b16 a[78:79], v6 offset:14336
 v_pk_fma_f32 v[72:73], v[12:13], v[28:29], v[72:73] op_sel_hi:[1,0,1]
 v_pk_fma_f32 v[74:75], v[14:15], v[28:29], v[74:75] op_sel_hi:[1,0,1]
 v_pk_fma_f32 v[136:137], v[20:21], v[28:29], v[136:137] op_sel_hi:[1,0,1]
 v_pk_fma_f32 v[138:139], v[22:23], v[28:29], v[138:139] op_sel_hi:[1,0,1]
 v_pk_mul_f32 v[36:37], v[72:73], v[72:73]
 v_pk_mul_f32 v[38:39], v[74:75], v[74:75]
 v_pk_mul_f32 v[40:41], v[136:137], v[136:137]
 v_pk_mul_f32 v[42:43], v[138:139], v[138:139]
 v_pk_fma_f32 v[36:37], v[36:37], v[30:31], v[28:29] op_sel:[0,0,1] op_sel_hi:[1,0,1]
 v_pk_fma_f32 v[38:39], v[38:39], v[30:31], v[28:29] op_sel:[0,0,1] op_sel_hi:[1,0,1]
 v_pk_fma_f32 v[40:41], v[40:41], v[30:31], v[28:29] op_sel:[0,0,1] op_sel_hi:[1,0,1]
 v_pk_fma_f32 v[42:43], v[42:43], v[30:31], v[28:29] op_sel:[0,0,1] op_sel_hi:[1,0,1]
 v_pk_mul_f32 v[36:37], v[36:37], v[72:73]
 v_pk_mul_f32 v[38:39], v[38:39], v[74:75]
 v_pk_mul_f32 v[40:41], v[40:41], v[136:137]
 v_pk_mul_f32 v[42:43], v[42:43], v[138:139]
 v_exp_f32 v36, v36
 v_exp_f32 v37, v37
 v_exp_f32 v38, v38
 v_exp_f32 v39, v39
 v_exp_f32 v40, v40
 v_exp_f32 v41, v41
 v_exp_f32 v42, v42
 v_exp_f32 v43, v43
 v_pk_fma_f32 v[104:105], v[16:17], v[28:29], v[104:105] op_sel_hi:[1,0,1]
 v_pk_fma_f32 v[106:107], v[18:19], v[28:29], v[106:107] op_sel_hi:[1,0,1]
 v_pk_fma_f32 v[168:169], v[24:25], v[28:29], v[168:169] op_sel_hi:[1,0,1]
 v_pk_fma_f32 v[170:171], v[26:27], v[28:29], v[170:171] op_sel_hi:[1,0,1]
 v_pk_fma_f32 v[36:37], v[36:37], v[30:31], v[30:31] op_sel:[0,1,1] op_sel_hi:[1,1,1]
 v_pk_fma_f32 v[38:39], v[38:39], v[30:31], v[30:31] op_sel:[0,1,1] op_sel_hi:[1,1,1]
 v_pk_fma_f32 v[40:41], v[40:41], v[30:31], v[30:31] op_sel:[0,1,1] op_sel_hi:[1,1,1]
 v_pk_fma_f32 v[42:43], v[42:43], v[30:31], v[30:31] op_sel:[0,1,1] op_sel_hi:[1,1,1]
 v_rcp_f32 v36, v36
 v_rcp_f32 v37, v37
 v_rcp_f32 v38, v38
 v_rcp_f32 v39, v39
 v_rcp_f32 v40, v40
 v_rcp_f32 v41, v41
 v_rcp_f32 v42, v42
 v_rcp_f32 v43, v43
 v_pk_mul_f32 v[104:105], v[104:105], v[72:73]
 v_pk_mul_f32 v[106:107], v[106:107], v[74:75]
 v_pk_mul_f32 v[168:169], v[168:169], v[136:137]
 v_pk_mul_f32 v[170:171], v[170:171], v[138:139]
 v_pk_mul_f32 v[104:105], v[104:105], v[36:37]
 v_pk_mul_f32 v[106:107], v[106:107], v[38:39]
 v_pk_mul_f32 v[168:169], v[168:169], v[40:41]
 v_pk_mul_f32 v[170:171], v[170:171], v[42:43]
 v_cvt_pk_bf16_f32 v72, v104, v105
 v_cvt_pk_bf16_f32 v73, v106, v107
 v_cvt_pk_bf16_f32 v74, v168, v169
 v_cvt_pk_bf16_f32 v75, v170, v171
 buffer_store_dwordx4 v[72:75], v1, s[24:27], s43 offen sc1
 s_waitcnt lgkmcnt(0)
 s_nop 0
 v_pk_fma_f32 v[76:77], v[12:13], v[32:33], v[76:77] op_sel_hi:[1,0,1]
 v_pk_fma_f32 v[78:79], v[14:15], v[32:33], v[78:79] op_sel_hi:[1,0,1]
 v_pk_fma_f32 v[140:141], v[20:21], v[32:33], v[140:141] op_sel_hi:[1,0,1]
 v_pk_fma_f32 v[142:143], v[22:23], v[32:33], v[142:143] op_sel_hi:[1,0,1]
 v_pk_mul_f32 v[36:37], v[76:77], v[76:77]
 v_pk_mul_f32 v[38:39], v[78:79], v[78:79]
 v_pk_mul_f32 v[40:41], v[140:141], v[140:141]
 v_pk_mul_f32 v[42:43], v[142:143], v[142:143]
 v_pk_fma_f32 v[36:37], v[36:37], v[34:35], v[32:33] op_sel:[0,0,1] op_sel_hi:[1,0,1]
 v_pk_fma_f32 v[38:39], v[38:39], v[34:35], v[32:33] op_sel:[0,0,1] op_sel_hi:[1,0,1]
 v_pk_fma_f32 v[40:41], v[40:41], v[34:35], v[32:33] op_sel:[0,0,1] op_sel_hi:[1,0,1]
 v_pk_fma_f32 v[42:43], v[42:43], v[34:35], v[32:33] op_sel:[0,0,1] op_sel_hi:[1,0,1]
 v_pk_mul_f32 v[36:37], v[36:37], v[76:77]
 v_pk_mul_f32 v[38:39], v[38:39], v[78:79]
 v_pk_mul_f32 v[40:41], v[40:41], v[140:141]
 v_pk_mul_f32 v[42:43], v[42:43], v[142:143]
 v_exp_f32 v36, v36
 v_exp_f32 v37, v37
 v_exp_f32 v38, v38
 v_exp_f32 v39, v39
 v_exp_f32 v40, v40
 v_exp_f32 v41, v41
 v_exp_f32 v42, v42
 v_exp_f32 v43, v43
 v_pk_fma_f32 v[108:109], v[16:17], v[32:33], v[108:109] op_sel_hi:[1,0,1]
 v_pk_fma_f32 v[110:111], v[18:19], v[32:33], v[110:111] op_sel_hi:[1,0,1]
 v_pk_fma_f32 v[172:173], v[24:25], v[32:33], v[172:173] op_sel_hi:[1,0,1]
 v_pk_fma_f32 v[174:175], v[26:27], v[32:33], v[174:175] op_sel_hi:[1,0,1]
 v_pk_fma_f32 v[36:37], v[36:37], v[34:35], v[34:35] op_sel:[0,1,1] op_sel_hi:[1,1,1]
 v_pk_fma_f32 v[38:39], v[38:39], v[34:35], v[34:35] op_sel:[0,1,1] op_sel_hi:[1,1,1]
 v_pk_fma_f32 v[40:41], v[40:41], v[34:35], v[34:35] op_sel:[0,1,1] op_sel_hi:[1,1,1]
 v_pk_fma_f32 v[42:43], v[42:43], v[34:35], v[34:35] op_sel:[0,1,1] op_sel_hi:[1,1,1]
 v_rcp_f32 v36, v36
 v_rcp_f32 v37, v37
 v_rcp_f32 v38, v38
 v_rcp_f32 v39, v39
 v_rcp_f32 v40, v40
 v_rcp_f32 v41, v41
 v_rcp_f32 v42, v42
 v_rcp_f32 v43, v43
 v_pk_mul_f32 v[108:109], v[108:109], v[76:77]
 v_pk_mul_f32 v[110:111], v[110:111], v[78:79]
 v_pk_mul_f32 v[172:173], v[172:173], v[140:141]
 v_pk_mul_f32 v[174:175], v[174:175], v[142:143]
 v_pk_mul_f32 v[108:109], v[108:109], v[36:37]
 v_pk_mul_f32 v[110:111], v[110:111], v[38:39]
 v_pk_mul_f32 v[172:173], v[172:173], v[40:41]
 v_pk_mul_f32 v[174:175], v[174:175], v[42:43]
 v_cvt_pk_bf16_f32 v76, v108, v109
 v_cvt_pk_bf16_f32 v77, v110, v111
 v_cvt_pk_bf16_f32 v78, v172, v173
 v_cvt_pk_bf16_f32 v79, v174, v175
 buffer_store_dwordx4 v[76:79], v1, s[24:27], s43 offen offset:1024 sc1
 v_and_b32 v4, 15, v2
 v_lshl_add_u32 v4, v4, 2, s64
 s_lshl_b32 s0, s53, 9
 s_add_u32 s0, s0, 161792
 s_sub_u32 s0, s0, s64
 v_add_u32 v5, s0, v45
 ds_read_b32 v12, v4 offset:384
 ds_read_b32 v13, v4 offset:448
 ds_read_b32 v14, v4 offset:512
 ds_read_b32 v15, v4 offset:576
 v_mov_b32 v136, 0x3f803f80
 v_mov_b32 v137, 0x3f803f80
 v_mov_b32 v138, 0x3f803f80
 v_mov_b32 v139, 0x3f803f80
 ds_read_b128 v[16:19], v5 offset:0
 ds_read_b128 v[20:23], v5 offset:1024
 ds_read_b128 v[24:27], v5 offset:64
 ds_read_b128 v[28:31], v5 offset:1088
 v_accvgpr_read_b32 v56, a160
 v_accvgpr_read_b32 v57, a161
 v_accvgpr_read_b32 v58, a162
 v_accvgpr_read_b32 v59, a163
 v_accvgpr_read_b32 v60, a164
 v_accvgpr_read_b32 v61, a165
 v_accvgpr_read_b32 v62, a166
 v_accvgpr_read_b32 v63, a167
 v_accvgpr_read_b32 v64, a192
 v_accvgpr_read_b32 v65, a193
 v_accvgpr_read_b32 v66, a194
 v_accvgpr_read_b32 v67, a195
 v_accvgpr_read_b32 v68, a196
 v_accvgpr_read_b32 v69, a197
 v_accvgpr_read_b32 v70, a198
 v_accvgpr_read_b32 v71, a199
 v_accvgpr_read_b32 v72, a224
 v_accvgpr_read_b32 v73, a225
 v_accvgpr_read_b32 v74, a226
 v_accvgpr_read_b32 v75, a227
 v_accvgpr_read_b32 v76, a228
 v_accvgpr_read_b32 v77, a229
 v_accvgpr_read_b32 v78, a230
 v_accvgpr_read_b32 v79, a231
 s_waitcnt lgkmcnt(0)
 s_nop 0
 v_pk_fma_f32 v[240:241], v[16:17], v[12:13], v[240:241] op_sel:[0,0,0] op_sel_hi:[1,0,1]
 v_pk_fma_f32 v[242:243], v[18:19], v[12:13], v[242:243] op_sel:[0,0,0] op_sel_hi:[1,0,1]
 v_pk_fma_f32 v[244:245], v[24:25], v[12:13], v[244:245] op_sel:[0,0,0] op_sel_hi:[1,0,1]
 v_pk_fma_f32 v[246:247], v[26:27], v[12:13], v[246:247] op_sel:[0,0,0] op_sel_hi:[1,0,1]
 v_pk_mul_f32 v[240:241], v[240:241], v[20:21]
 v_pk_mul_f32 v[242:243], v[242:243], v[22:23]
 v_pk_mul_f32 v[244:245], v[244:245], v[28:29]
 v_pk_mul_f32 v[246:247], v[246:247], v[30:31]
 v_pk_mul_f32 v[36:37], v[240:241], s[56:57] op_sel_hi:[1,0]
 v_pk_mul_f32 v[38:39], v[242:243], s[56:57] op_sel_hi:[1,0]
 v_pk_mul_f32 v[40:41], v[244:245], s[56:57] op_sel_hi:[1,0]
 v_pk_mul_f32 v[42:43], v[246:247], s[56:57] op_sel_hi:[1,0]
 v_exp_f32_e64 v36, v36 clamp
 v_exp_f32_e64 v37, v37 clamp
 v_exp_f32_e64 v38, v38 clamp
 v_exp_f32_e64 v39, v39 clamp
 v_exp_f32_e64 v40, v40 clamp
 v_exp_f32_e64 v41, v41 clamp
 v_exp_f32_e64 v42, v42 clamp
 v_exp_f32_e64 v43, v43 clamp
 v_max_f32 v240, 0, v240
 v_max_f32 v241, 0, v241
 v_max_f32 v242, 0, v242
 v_max_f32 v243, 0, v243
 v_max_f32 v244, 0, v244
 v_max_f32 v245, 0, v245
 v_max_f32 v246, 0, v246
 v_max_f32 v247, 0, v247
 v_pk_add_f32 v[240:241], v[240:241], s[68:69] op_sel_hi:[1,0]
 v_pk_add_f32 v[242:243], v[242:243], s[68:69] op_sel_hi:[1,0]
 v_pk_add_f32 v[244:245], v[244:245], s[68:69] op_sel_hi:[1,0]
 v_pk_add_f32 v[246:247], v[246:247], s[68:69] op_sel_hi:[1,0]
 v_pk_add_f32 v[240:241], v[240:241], v[36:37]
 v_pk_add_f32 v[242:243], v[242:243], v[38:39]
 v_pk_add_f32 v[244:245], v[244:245], v[40:41]
 v_pk_add_f32 v[246:247], v[246:247], v[42:43]
 v_cvt_pk_bf16_f32 v240, v240, v241
 v_cvt_pk_bf16_f32 v241, v242, v243
 v_cvt_pk_bf16_f32 v242, v244, v245
 v_cvt_pk_bf16_f32 v243, v246, v247
 v_pk_fma_f32 v[56:57], v[16:17], v[12:13], v[56:57] op_sel:[0,1,0] op_sel_hi:[1,1,1]
 v_pk_fma_f32 v[58:59], v[18:19], v[12:13], v[58:59] op_sel:[0,1,0] op_sel_hi:[1,1,1]
 v_pk_fma_f32 v[60:61], v[24:25], v[12:13], v[60:61] op_sel:[0,1,0] op_sel_hi:[1,1,1]
 v_pk_fma_f32 v[62:63], v[26:27], v[12:13], v[62:63] op_sel:[0,1,0] op_sel_hi:[1,1,1]
 v_pk_mul_f32 v[56:57], v[56:57], v[20:21]
 v_pk_mul_f32 v[58:59], v[58:59], v[22:23]
 v_pk_mul_f32 v[60:61], v[60:61], v[28:29]
 v_pk_mul_f32 v[62:63], v[62:63], v[30:31]
 v_pk_mul_f32 v[36:37], v[56:57], s[56:57] op_sel_hi:[1,0]
 v_pk_mul_f32 v[38:39], v[58:59], s[56:57] op_sel_hi:[1,0]
 v_pk_mul_f32 v[40:41], v[60:61], s[56:57] op_sel_hi:[1,0]
 v_pk_mul_f32 v[42:43], v[62:63], s[56:57] op_sel_hi:[1,0]
 v_exp_f32_e64 v36, v36 clamp
 v_exp_f32_e64 v37, v37 clamp
 v_exp_f32_e64 v38, v38 clamp
 v_exp_f32_e64 v39, v39 clamp
 v_exp_f32_e64 v40, v40 clamp
 v_exp_f32_e64 v41, v41 clamp
 v_exp_f32_e64 v42, v42 clamp
 v_exp_f32_e64 v43, v43 clamp
 v_max_f32 v56, 0, v56
 v_max_f32 v57, 0, v57
 v_max_f32 v58, 0, v58
 v_max_f32 v59, 0, v59
 v_max_f32 v60, 0, v60
 v_max_f32 v61, 0, v61
 v_max_f32 v62, 0, v62
 v_max_f32 v63, 0, v63
 v_pk_add_f32 v[56:57], v[56:57], s[68:69] op_sel_hi:[1,0]
 v_pk_add_f32 v[58:59], v[58:59], s[68:69] op_sel_hi:[1,0]
 v_pk_add_f32 v[60:61], v[60:61], s[68:69] op_sel_hi:[1,0]
 v_pk_add_f32 v[62:63], v[62:63], s[68:69] op_sel_hi:[1,0]
 v_pk_add_f32 v[56:57], v[56:57], v[36:37]
 v_pk_add_f32 v[58:59], v[58:59], v[38:39]
 v_pk_add_f32 v[60:61], v[60:61], v[40:41]
 v_pk_add_f32 v[62:63], v[62:63], v[42:43]
 v_cvt_pk_bf16_f32 v56, v56, v57
 v_cvt_pk_bf16_f32 v57, v58, v59
 v_cvt_pk_bf16_f32 v58, v60, v61
 v_cvt_pk_bf16_f32 v59, v62, v63
 v_pk_fma_f32 v[64:65], v[16:17], v[14:15], v[64:65] op_sel:[0,0,0] op_sel_hi:[1,0,1]
 v_pk_fma_f32 v[66:67], v[18:19], v[14:15], v[66:67] op_sel:[0,0,0] op_sel_hi:[1,0,1]
 v_pk_fma_f32 v[68:69], v[24:25], v[14:15], v[68:69] op_sel:[0,0,0] op_sel_hi:[1,0,1]
 v_pk_fma_f32 v[70:71], v[26:27], v[14:15], v[70:71] op_sel:[0,0,0] op_sel_hi:[1,0,1]
 v_pk_mul_f32 v[64:65], v[64:65], v[20:21]
 v_pk_mul_f32 v[66:67], v[66:67], v[22:23]
 v_pk_mul_f32 v[68:69], v[68:69], v[28:29]
 v_pk_mul_f32 v[70:71], v[70:71], v[30:31]
 v_cvt_pk_bf16_f32 v64, v64, v65
 v_cvt_pk_bf16_f32 v65, v66, v67
 v_cvt_pk_bf16_f32 v66, v68, v69
 v_cvt_pk_bf16_f32 v67, v70, v71
 v_pk_fma_f32 v[72:73], v[16:17], v[14:15], v[72:73] op_sel:[0,1,0] op_sel_hi:[1,1,1]
 v_pk_fma_f32 v[74:75], v[18:19], v[14:15], v[74:75] op_sel:[0,1,0] op_sel_hi:[1,1,1]
 v_pk_fma_f32 v[76:77], v[24:25], v[14:15], v[76:77] op_sel:[0,1,0] op_sel_hi:[1,1,1]
 v_pk_fma_f32 v[78:79], v[26:27], v[14:15], v[78:79] op_sel:[0,1,0] op_sel_hi:[1,1,1]
 v_pk_mul_f32 v[72:73], v[72:73], v[20:21]
 v_pk_mul_f32 v[74:75], v[74:75], v[22:23]
 v_pk_mul_f32 v[76:77], v[76:77], v[28:29]
 v_pk_mul_f32 v[78:79], v[78:79], v[30:31]
 v_cvt_pk_bf16_f32 v72, v72, v73
 v_cvt_pk_bf16_f32 v73, v74, v75
 v_cvt_pk_bf16_f32 v74, v76, v77
 v_cvt_pk_bf16_f32 v75, v78, v79
 s_waitcnt vmcnt(0)
 s_mov_b64 exec, 1
 buffer_store_dword v3, off, s[24:27], s23 sc1
 s_mov_b64 exec, -1
 v_mfma_f32_16x16x32_bf16 v[112:115], v[240:243], v[64:67], 0
 v_mfma_f32_16x16x32_bf16 v[116:119], v[240:243], v[72:75], 0
 v_mfma_f32_16x16x32_bf16 v[120:123], v[240:243], v[136:139], 0
 v_mfma_f32_16x16x32_bf16 v[124:127], v[56:59], v[64:67], 0
 v_mfma_f32_16x16x32_bf16 v[128:131], v[56:59], v[72:75], 0
 v_mfma_f32_16x16x32_bf16 v[132:135], v[56:59], v[136:139], 0
 s_nop 0
 ds_read_b128 v[16:19], v5 offset:128
 ds_read_b128 v[20:23], v5 offset:1152
 ds_read_b128 v[24:27], v5 offset:192
 ds_read_b128 v[28:31], v5 offset:1216
 v_accvgpr_read_b32 v88, a168
 v_accvgpr_read_b32 v89, a169
 v_accvgpr_read_b32 v90, a170
 v_accvgpr_read_b32 v91, a171
 v_accvgpr_read_b32 v92, a172
 v_accvgpr_read_b32 v93, a173
 v_accvgpr_read_b32 v94, a174
 v_accvgpr_read_b32 v95, a175
 v_accvgpr_read_b32 v96, a200
 v_accvgpr_read_b32 v97, a201
 v_accvgpr_read_b32 v98, a202
 v_accvgpr_read_b32 v99, a203
 v_accvgpr_read_b32 v100, a204
 v_accvgpr_read_b32 v101, a205
 v_accvgpr_read_b32 v102, a206
 v_accvgpr_read_b32 v103, a207
 v_accvgpr_read_b32 v104, a232
 v_accvgpr_read_b32 v105, a233
 v_accvgpr_read_b32 v106, a234
 v_accvgpr_read_b32 v107, a235
 v_accvgpr_read_b32 v108, a236
 v_accvgpr_read_b32 v109, a237
 v_accvgpr_read_b32 v110, a238
 v_accvgpr_read_b32 v111, a239
 s_waitcnt lgkmcnt(0)
 s_nop 0
 v_pk_fma_f32 v[248:249], v[16:17], v[12:13], v[248:249] op_sel:[0,0,0] op_sel_hi:[1,0,1]
 v_pk_fma_f32 v[250:251], v[18:19], v[12:13], v[250:251] op_sel:[0,0,0] op_sel_hi:[1,0,1]
 v_pk_fma_f32 v[252:253], v[24:25], v[12:13], v[252:253] op_sel:[0,0,0] op_sel_hi:[1,0,1]
 v_pk_fma_f32 v[254:255], v[26:27], v[12:13], v[254:255] op_sel:[0,0,0] op_sel_hi:[1,0,1]
 v_pk_mul_f32 v[248:249], v[248:249], v[20:21]
 v_pk_mul_f32 v[250:251], v[250:251], v[22:23]
 v_pk_mul_f32 v[252:253], v[252:253], v[28:29]
 v_pk_mul_f32 v[254:255], v[254:255], v[30:31]
 v_pk_mul_f32 v[36:37], v[248:249], s[56:57] op_sel_hi:[1,0]
 v_pk_mul_f32 v[38:39], v[250:251], s[56:57] op_sel_hi:[1,0]
 v_pk_mul_f32 v[40:41], v[252:253], s[56:57] op_sel_hi:[1,0]
 v_pk_mul_f32 v[42:43], v[254:255], s[56:57] op_sel_hi:[1,0]
 v_exp_f32_e64 v36, v36 clamp
 v_exp_f32_e64 v37, v37 clamp
 v_exp_f32_e64 v38, v38 clamp
 v_exp_f32_e64 v39, v39 clamp
 v_exp_f32_e64 v40, v40 clamp
 v_exp_f32_e64 v41, v41 clamp
 v_exp_f32_e64 v42, v42 clamp
 v_exp_f32_e64 v43, v43 clamp
 v_max_f32 v248, 0, v248
 v_max_f32 v249, 0, v249
 v_max_f32 v250, 0, v250
 v_max_f32 v251, 0, v251
 v_max_f32 v252, 0, v252
 v_max_f32 v253, 0, v253
 v_max_f32 v254, 0, v254
 v_max_f32 v255, 0, v255
 v_pk_add_f32 v[248:249], v[248:249], s[68:69] op_sel_hi:[1,0]
 v_pk_add_f32 v[250:251], v[250:251], s[68:69] op_sel_hi:[1,0]
 v_pk_add_f32 v[252:253], v[252:253], s[68:69] op_sel_hi:[1,0]
 v_pk_add_f32 v[254:255], v[254:255], s[68:69] op_sel_hi:[1,0]
 v_pk_add_f32 v[248:249], v[248:249], v[36:37]
 v_pk_add_f32 v[250:251], v[250:251], v[38:39]
 v_pk_add_f32 v[252:253], v[252:253], v[40:41]
 v_pk_add_f32 v[254:255], v[254:255], v[42:43]
 v_cvt_pk_bf16_f32 v248, v248, v249
 v_cvt_pk_bf16_f32 v249, v250, v251
 v_cvt_pk_bf16_f32 v250, v252, v253
 v_cvt_pk_bf16_f32 v251, v254, v255
 v_pk_fma_f32 v[88:89], v[16:17], v[12:13], v[88:89] op_sel:[0,1,0] op_sel_hi:[1,1,1]
 v_pk_fma_f32 v[90:91], v[18:19], v[12:13], v[90:91] op_sel:[0,1,0] op_sel_hi:[1,1,1]
 v_pk_fma_f32 v[92:93], v[24:25], v[12:13], v[92:93] op_sel:[0,1,0] op_sel_hi:[1,1,1]
 v_pk_fma_f32 v[94:95], v[26:27], v[12:13], v[94:95] op_sel:[0,1,0] op_sel_hi:[1,1,1]
 v_pk_mul_f32 v[88:89], v[88:89], v[20:21]
 v_pk_mul_f32 v[90:91], v[90:91], v[22:23]
 v_pk_mul_f32 v[92:93], v[92:93], v[28:29]
 v_pk_mul_f32 v[94:95], v[94:95], v[30:31]
 v_pk_mul_f32 v[36:37], v[88:89], s[56:57] op_sel_hi:[1,0]
 v_pk_mul_f32 v[38:39], v[90:91], s[56:57] op_sel_hi:[1,0]
 v_pk_mul_f32 v[40:41], v[92:93], s[56:57] op_sel_hi:[1,0]
 v_pk_mul_f32 v[42:43], v[94:95], s[56:57] op_sel_hi:[1,0]
 v_exp_f32_e64 v36, v36 clamp
 v_exp_f32_e64 v37, v37 clamp
 v_exp_f32_e64 v38, v38 clamp
 s_branch L_tp_L_tA_8_o
L_tp_L_tA_8:
 s_nop 0
 s_branch L_tr00
 s_nop 0
L_tp_L_tA_8_o:
 v_exp_f32_e64 v39, v39 clamp
 v_exp_f32_e64 v40, v40 clamp
 v_exp_f32_e64 v41, v41 clamp
 v_exp_f32_e64 v42, v42 clamp
 v_exp_f32_e64 v43, v43 clamp
 v_max_f32 v88, 0, v88
 v_max_f32 v89, 0, v89
 v_max_f32 v90, 0, v90
 v_max_f32 v91, 0, v91
 v_max_f32 v92, 0, v92
 v_max_f32 v93, 0, v93
 v_max_f32 v94, 0, v94
 v_max_f32 v95, 0, v95
 v_pk_add_f32 v[88:89], v[88:89], s[68:69] op_sel_hi:[1,0]
 v_pk_add_f32 v[90:91], v[90:91], s[68:69] op_sel_hi:[1,0]
 v_pk_add_f32 v[92:93], v[92:93], s[68:69] op_sel_hi:[1,0]
 v_pk_add_f32 v[94:95], v[94:95], s[68:69] op_sel_hi:[1,0]
 v_pk_add_f32 v[88:89], v[88:89], v[36:37]
 v_pk_add_f32 v[90:91], v[90:91], v[38:39]
 v_pk_add_f32 v[92:93], v[92:93], v[40:41]
 v_pk_add_f32 v[94:95], v[94:95], v[42:43]
 v_cvt_pk_bf16_f32 v88, v88, v89
 v_cvt_pk_bf16_f32 v89, v90, v91
 v_cvt_pk_bf16_f32 v90, v92, v93
 v_cvt_pk_bf16_f32 v91, v94, v95
 v_pk_fma_f32 v[96:97], v[16:17], v[14:15], v[96:97] op_sel:[0,0,0] op_sel_hi:[1,0,1]
 v_pk_fma_f32 v[98:99], v[18:19], v[14:15], v[98:99] op_sel:[0,0,0] op_sel_hi:[1,0,1]
 v_pk_fma_f32 v[100:101], v[24:25], v[14:15], v[100:101] op_sel:[0,0,0] op_sel_hi:[1,0,1]
 v_pk_fma_f32 v[102:103], v[26:27], v[14:15], v[102:103] op_sel:[0,0,0] op_sel_hi:[1,0,1]
 v_pk_mul_f32 v[96:97], v[96:97], v[20:21]
 v_pk_mul_f32 v[98:99], v[98:99], v[22:23]
 v_pk_mul_f32 v[100:101], v[100:101], v[28:29]
 v_pk_mul_f32 v[102:103], v[102:103], v[30:31]
 v_cvt_pk_bf16_f32 v96, v96, v97
 v_cvt_pk_bf16_f32 v97, v98, v99
 v_cvt_pk_bf16_f32 v98, v100, v101
 v_cvt_pk_bf16_f32 v99, v102, v103
 v_pk_fma_f32 v[104:105], v[16:17], v[14:15], v[104:105] op_sel:[0,1,0] op_sel_hi:[1,1,1]
 v_pk_fma_f32 v[106:107], v[18:19], v[14:15], v[106:107] op_sel:[0,1,0] op_sel_hi:[1,1,1]
 v_pk_fma_f32 v[108:109], v[24:25], v[14:15], v[108:109] op_sel:[0,1,0] op_sel_hi:[1,1,1]
 v_pk_fma_f32 v[110:111], v[26:27], v[14:15], v[110:111] op_sel:[0,1,0] op_sel_hi:[1,1,1]
 v_pk_mul_f32 v[104:105], v[104:105], v[20:21]
 v_pk_mul_f32 v[106:107], v[106:107], v[22:23]
 v_pk_mul_f32 v[108:109], v[108:109], v[28:29]
 v_pk_mul_f32 v[110:111], v[110:111], v[30:31]
 v_cvt_pk_bf16_f32 v104, v104, v105
 v_cvt_pk_bf16_f32 v105, v106, v107
 v_cvt_pk_bf16_f32 v106, v108, v109
 v_cvt_pk_bf16_f32 v107, v110, v111
 v_mfma_f32_16x16x32_bf16 v[112:115], v[248:251], v[96:99], v[112:115]
    s_nop 0
 v_mfma_f32_16x16x32_bf16 v[116:119], v[248:251], v[104:107], v[116:119]
 v_mfma_f32_16x16x32_bf16 v[120:123], v[248:251], v[136:139], v[120:123]
 v_mfma_f32_16x16x32_bf16 v[124:127], v[88:91], v[96:99], v[124:127]
 v_mfma_f32_16x16x32_bf16 v[128:131], v[88:91], v[104:107], v[128:131]
 v_mfma_f32_16x16x32_bf16 v[132:135], v[88:91], v[136:139], v[132:135]
 s_nop 0
 ds_read_b128 v[16:19], v5 offset:256
 ds_read_b128 v[20:23], v5 offset:1280
 ds_read_b128 v[24:27], v5 offset:320
 ds_read_b128 v[28:31], v5 offset:1344
 v_accvgpr_read_b32 v48, a144
 v_accvgpr_read_b32 v49, a145
 v_accvgpr_read_b32 v50, a146
 v_accvgpr_read_b32 v51, a147
 v_accvgpr_read_b32 v52, a148
 v_accvgpr_read_b32 v53, a149
 v_accvgpr_read_b32 v54, a150
 v_accvgpr_read_b32 v55, a151
 v_accvgpr_read_b32 v56, a176
 v_accvgpr_read_b32 v57, a177
 v_accvgpr_read_b32 v58, a178
 v_accvgpr_read_b32 v59, a179
 v_accvgpr_read_b32 v60, a180
 v_accvgpr_read_b32 v61, a181
 v_accvgpr_read_b32 v62, a182
 v_accvgpr_read_b32 v63, a183
 v_accvgpr_read_b32 v64, a208
 v_accvgpr_read_b32 v65, a209
 v_accvgpr_read_b32 v66, a210
 v_accvgpr_read_b32 v67, a211
 v_accvgpr_read_b32 v68, a212
 v_accvgpr_read_b32 v69, a213
 v_accvgpr_read_b32 v70, a214
 v_accvgpr_read_b32 v71, a215
 v_accvgpr_read_b32 v72, a240
 v_accvgpr_read_b32 v73, a241
 v_accvgpr_read_b32 v74, a242
 v_accvgpr_read_b32 v75, a243
 v_accvgpr_read_b32 v76, a244
 v_accvgpr_read_b32 v77, a245
 v_accvgpr_read_b32 v78, a246
 v_accvgpr_read_b32 v79, a247
 s_waitcnt lgkmcnt(0)
 s_nop 0
 v_pk_fma_f32 v[48:49], v[16:17], v[12:13], v[48:49] op_sel:[0,0,0] op_sel_hi:[1,0,1]
 v_pk_fma_f32 v[50:51], v[18:19], v[12:13], v[50:51] op_sel:[0,0,0] op_sel_hi:[1,0,1]
 v_pk_fma_f32 v[52:53], v[24:25], v[12:13], v[52:53] op_sel:[0,0,0] op_sel_hi:[1,0,1]
 v_pk_fma_f32 v[54:55], v[26:27], v[12:13], v[54:55] op_sel:[0,0,0] op_sel_hi:[1,0,1]
 v_pk_mul_f32 v[48:49], v[48:49], v[20:21]
 v_pk_mul_f32 v[50:51], v[50:51], v[22:23]
 v_pk_mul_f32 v[52:53], v[52:53], v[28:29]
 v_pk_mul_f32 v[54:55], v[54:55], v[30:31]
 v_pk_mul_f32 v[36:37], v[48:49], s[56:57] op_sel_hi:[1,0]
 v_pk_mul_f32 v[38:39], v[50:51], s[56:57] op_sel_hi:[1,0]
 v_pk_mul_f32 v[40:41], v[52:53], s[56:57] op_sel_hi:[1,0]
 v_pk_mul_f32 v[42:43], v[54:55], s[56:57] op_sel_hi:[1,0]
 v_exp_f32_e64 v36, v36 clamp
 v_exp_f32_e64 v37, v37 clamp
 v_exp_f32_e64 v38, v38 clamp
 v_exp_f32_e64 v39, v39 clamp
 v_exp_f32_e64 v40, v40 clamp
 v_exp_f32_e64 v41, v41 clamp
 v_exp_f32_e64 v42, v42 clamp
 v_exp_f32_e64 v43, v43 clamp
 v_max_f32 v48, 0, v48
 v_max_f32 v49, 0, v49
 v_max_f32 v50, 0, v50
 v_max_f32 v51, 0, v51
 v_max_f32 v52, 0, v52
 v_max_f32 v53, 0, v53
 v_max_f32 v54, 0, v54
 v_max_f32 v55, 0, v55
 v_pk_add_f32 v[48:49], v[48:49], s[68:69] op_sel_hi:[1,0]
 v_pk_add_f32 v[50:51], v[50:51], s[68:69] op_sel_hi:[1,0]
 v_pk_add_f32 v[52:53], v[52:53], s[68:69] op_sel_hi:[1,0]
 v_pk_add_f32 v[54:55], v[54:55], s[68:69] op_sel_hi:[1,0]
 v_pk_add_f32 v[48:49], v[48:49], v[36:37]
 v_pk_add_f32 v[50:51], v[50:51], v[38:39]
 v_pk_add_f32 v[52:53], v[52:53], v[40:41]
 v_pk_add_f32 v[54:55], v[54:55], v[42:43]
 v_cvt_pk_bf16_f32 v48, v48, v49
 v_cvt_pk_bf16_f32 v49, v50, v51
 v_cvt_pk_bf16_f32 v50, v52, v53
 v_cvt_pk_bf16_f32 v51, v54, v55
 v_pk_fma_f32 v[56:57], v[16:17], v[12:13], v[56:57] op_sel:[0,1,0] op_sel_hi:[1,1,1]
 v_pk_fma_f32 v[58:59], v[18:19], v[12:13], v[58:59] op_sel:[0,1,0] op_sel_hi:[1,1,1]
 v_pk_fma_f32 v[60:61], v[24:25], v[12:13], v[60:61] op_sel:[0,1,0] op_sel_hi:[1,1,1]
 v_pk_fma_f32 v[62:63], v[26:27], v[12:13], v[62:63] op_sel:[0,1,0] op_sel_hi:[1,1,1]
 v_pk_mul_f32 v[56:57], v[56:57], v[20:21]
 v_pk_mul_f32 v[58:59], v[58:59], v[22:23]
 v_pk_mul_f32 v[60:61], v[60:61], v[28:29]
 v_pk_mul_f32 v[62:63], v[62:63], v[30:31]
 v_pk_mul_f32 v[36:37], v[56:57], s[56:57] op_sel_hi:[1,0]
 v_pk_mul_f32 v[38:39], v[58:59], s[56:57] op_sel_hi:[1,0]
 v_pk_mul_f32 v[40:41], v[60:61], s[56:57] op_sel_hi:[1,0]
 v_pk_mul_f32 v[42:43], v[62:63], s[56:57] op_sel_hi:[1,0]
 v_exp_f32_e64 v36, v36 clamp
 v_exp_f32_e64 v37, v37 clamp
 v_exp_f32_e64 v38, v38 clamp
 v_exp_f32_e64 v39, v39 clamp
 v_exp_f32_e64 v40, v40 clamp
 v_exp_f32_e64 v41, v41 clamp
 v_exp_f32_e64 v42, v42 clamp
 v_exp_f32_e64 v43, v43 clamp
 v_max_f32 v56, 0, v56
 v_max_f32 v57, 0, v57
 v_max_f32 v58, 0, v58
 v_max_f32 v59, 0, v59
 v_max_f32 v60, 0, v60
 v_max_f32 v61, 0, v61
 v_max_f32 v62, 0, v62
 v_max_f32 v63, 0, v63
 v_pk_add_f32 v[56:57], v[56:57], s[68:69] op_sel_hi:[1,0]
 v_pk_add_f32 v[58:59], v[58:59], s[68:69] op_sel_hi:[1,0]
 v_pk_add_f32 v[60:61], v[60:61], s[68:69] op_sel_hi:[1,0]
 v_pk_add_f32 v[62:63], v[62:63], s[68:69] op_sel_hi:[1,0]
 v_pk_add_f32 v[56:57], v[56:57], v[36:37]
 v_pk_add_f32 v[58:59], v[58:59], v[38:39]
 v_pk_add_f32 v[60:61], v[60:61], v[40:41]
 v_pk_add_f32 v[62:63], v[62:63], v[42:43]
 v_cvt_pk_bf16_f32 v56, v56, v57
 v_cvt_pk_bf16_f32 v57, v58, v59
 v_cvt_pk_bf16_f32 v58, v60, v61
 v_cvt_pk_bf16_f32 v59, v62, v63
 buffer_load_dword v47, v46, s[24:27], s59 offen sc1
 v_pk_fma_f32 v[64:65], v[16:17], v[14:15], v[64:65] op_sel:[0,0,0] op_sel_hi:[1,0,1]
 v_pk_fma_f32 v[66:67], v[18:19], v[14:15], v[66:67] op_sel:[0,0,0] op_sel_hi:[1,0,1]
 v_pk_fma_f32 v[68:69], v[24:25], v[14:15], v[68:69] op_sel:[0,0,0] op_sel_hi:[1,0,1]
 v_pk_fma_f32 v[70:71], v[26:27], v[14:15], v[70:71] op_sel:[0,0,0] op_sel_hi:[1,0,1]
 v_pk_mul_f32 v[64:65], v[64:65], v[20:21]
 v_pk_mul_f32 v[66:67], v[66:67], v[22:23]
 v_pk_mul_f32 v[68:69], v[68:69], v[28:29]
 v_pk_mul_f32 v[70:71], v[70:71], v[30:31]
 v_cvt_pk_bf16_f32 v64, v64, v65
 v_cvt_pk_bf16_f32 v65, v66, v67
 v_cvt_pk_bf16_f32 v66, v68, v69
 v_cvt_pk_bf16_f32 v67, v70, v71
 v_pk_fma_f32 v[72:73], v[16:17], v[14:15], v[72:73] op_sel:[0,1,0] op_sel_hi:[1,1,1]
 v_pk_fma_f32 v[74:75], v[18:19], v[14:15], v[74:75] op_sel:[0,1,0] op_sel_hi:[1,1,1]
 v_pk_fma_f32 v[76:77], v[24:25], v[14:15], v[76:77] op_sel:[0,1,0] op_sel_hi:[1,1,1]
 v_pk_fma_f32 v[78:79], v[26:27], v[14:15], v[78:79] op_sel:[0,1,0] op_sel_hi:[1,1,1]
 v_pk_mul_f32 v[72:73], v[72:73], v[20:21]
 v_pk_mul_f32 v[74:75], v[74:75], v[22:23]
 v_pk_mul_f32 v[76:77], v[76:77], v[28:29]
 v_pk_mul_f32 v[78:79], v[78:79], v[30:31]
 v_cvt_pk_bf16_f32 v72, v72, v73
 v_cvt_pk_bf16_f32 v73, v74, v75
 v_cvt_pk_bf16_f32 v74, v76, v77
 v_cvt_pk_bf16_f32 v75, v78, v79
 v_mfma_f32_16x16x32_bf16 v[112:115], v[48:51], v[64:67], v[112:115]
    s_nop 0
 v_mfma_f32_16x16x32_bf16 v[116:119], v[48:51], v[72:75], v[116:119]
 v_mfma_f32_16x16x32_bf16 v[120:123], v[48:51], v[136:139], v[120:123]
 v_mfma_f32_16x16x32_bf16 v[124:127], v[56:59], v[64:67], v[124:127]
 v_mfma_f32_16x16x32_bf16 v[128:131], v[56:59], v[72:75], v[128:131]
 v_mfma_f32_16x16x32_bf16 v[132:135], v[56:59], v[136:139], v[132:135]
 s_nop 0
 ds_read_b128 v[16:19], v5 offset:384
 ds_read_b128 v[20:23], v5 offset:1408
 ds_read_b128 v[24:27], v5 offset:448
 ds_read_b128 v[28:31], v5 offset:1472
 v_accvgpr_read_b32 v80, a152
 v_accvgpr_read_b32 v81, a153
 v_accvgpr_read_b32 v82, a154
 v_accvgpr_read_b32 v83, a155
 v_accvgpr_read_b32 v84, a156
 v_accvgpr_read_b32 v85, a157
 v_accvgpr_read_b32 v86, a158
 v_accvgpr_read_b32 v87, a159
 v_accvgpr_read_b32 v88, a184
 v_accvgpr_read_b32 v89, a185
 v_accvgpr_read_b32 v90, a186
 v_accvgpr_read_b32 v91, a187
 v_accvgpr_read_b32 v92, a188
 v_accvgpr_read_b32 v93, a189
 v_accvgpr_read_b32 v94, a190
 v_accvgpr_read_b32 v95, a191
 v_accvgpr_read_b32 v96, a216
 v_accvgpr_read_b32 v97, a217
 v_accvgpr_read_b32 v98, a218
 v_accvgpr_read_b32 v99, a219
 v_accvgpr_read_b32 v100, a220
 v_accvgpr_read_b32 v101, a221
 v_accvgpr_read_b32 v102, a222
 v_accvgpr_read_b32 v103, a223
 v_accvgpr_read_b32 v104, a248
 v_accvgpr_read_b32 v105, a249
 v_accvgpr_read_b32 v106, a250
 v_accvgpr_read_b32 v107, a251
 v_accvgpr_read_b32 v108, a252
 v_accvgpr_read_b32 v109, a253
 v_accvgpr_read_b32 v110, a254
 v_accvgpr_read_b32 v111, a255
 s_waitcnt lgkmcnt(0)
 s_nop 0
 v_pk_fma_f32 v[80:81], v[16:17], v[12:13], v[80:81] op_sel:[0,0,0] op_sel_hi:[1,0,1]
 v_pk_fma_f32 v[82:83], v[18:19], v[12:13], v[82:83] op_sel:[0,0,0] op_sel_hi:[1,0,1]
 v_pk_fma_f32 v[84:85], v[24:25], v[12:13], v[84:85] op_sel:[0,0,0] op_sel_hi:[1,0,1]
 v_pk_fma_f32 v[86:87], v[26:27], v[12:13], v[86:87] op_sel:[0,0,0] op_sel_hi:[1,0,1]
 v_pk_mul_f32 v[80:81], v[80:81], v[20:21]
 v_pk_mul_f32 v[82:83], v[82:83], v[22:23]
 v_pk_mul_f32 v[84:85], v[84:85], v[28:29]
 v_pk_mul_f32 v[86:87], v[86:87], v[30:31]
 v_pk_mul_f32 v[36:37], v[80:81], s[56:57] op_sel_hi:[1,0]
 v_pk_mul_f32 v[38:39], v[82:83], s[56:57] op_sel_hi:[1,0]
 v_pk_mul_f32 v[40:41], v[84:85], s[56:57] op_sel_hi:[1,0]
 v_pk_mul_f32 v[42:43], v[86:87], s[56:57] op_sel_hi:[1,0]
 v_exp_f32_e64 v36, v36 clamp
 v_exp_f32_e64 v37, v37 clamp
 v_exp_f32_e64 v38, v38 clamp
 v_exp_f32_e64 v39, v39 clamp
 v_exp_f32_e64 v40, v40 clamp
 v_exp_f32_e64 v41, v41 clamp
 v_exp_f32_e64 v42, v42 clamp
 v_exp_f32_e64 v43, v43 clamp
 v_max_f32 v80, 0, v80
 v_max_f32 v81, 0, v81
 v_max_f32 v82, 0, v82
 v_max_f32 v83, 0, v83
 v_max_f32 v84, 0, v84
 v_max_f32 v85, 0, v85
 v_max_f32 v86, 0, v86
 v_max_f32 v87, 0, v87
 v_pk_add_f32 v[80:81], v[80:81], s[68:69] op_sel_hi:[1,0]
 v_pk_add_f32 v[82:83], v[82:83], s[68:69] op_sel_hi:[1,0]
 v_pk_add_f32 v[84:85], v[84:85], s[68:69] op_sel_hi:[1,0]
 v_pk_add_f32 v[86:87], v[86:87], s[68:69] op_sel_hi:[1,0]
 v_pk_add_f32 v[80:81], v[80:81], v[36:37]
 v_pk_add_f32 v[82:83], v[82:83], v[38:39]
 v_pk_add_f32 v[84:85], v[84:85], v[40:41]
 v_pk_add_f32 v[86:87], v[86:87], v[42:43]
 v_cvt_pk_bf16_f32 v80, v80, v81
 v_cvt_pk_bf16_f32 v81, v82, v83
 v_cvt_pk_bf16_f32 v82, v84, v85
 v_cvt_pk_bf16_f32 v83, v86, v87
 v_pk_fma_f32 v[88:89], v[16:17], v[12:13], v[88:89] op_sel:[0,1,0] op_sel_hi:[1,1,1]
 v_pk_fma_f32 v[90:91], v[18:19], v[12:13], v[90:91] op_sel:[0,1,0] op_sel_hi:[1,1,1]
 v_pk_fma_f32 v[92:93], v[24:25], v[12:13], v[92:93] op_sel:[0,1,0] op_sel_hi:[1,1,1]
 v_pk_fma_f32 v[94:95], v[26:27], v[12:13], v[94:95] op_sel:[0,1,0] op_sel_hi:[1,1,1]
 v_pk_mul_f32 v[88:89], v[88:89], v[20:21]
 v_pk_mul_f32 v[90:91], v[90:91], v[22:23]
 v_pk_mul_f32 v[92:93], v[92:93], v[28:29]
 v_pk_mul_f32 v[94:95], v[94:95], v[30:31]
 v_pk_mul_f32 v[36:37], v[88:89], s[56:57] op_sel_hi:[1,0]
 v_pk_mul_f32 v[38:39], v[90:91], s[56:57] op_sel_hi:[1,0]
 v_pk_mul_f32 v[40:41], v[92:93], s[56:57] op_sel_hi:[1,0]
 v_pk_mul_f32 v[42:43], v[94:95], s[56:57] op_sel_hi:[1,0]
 v_exp_f32_e64 v36, v36 clamp
 v_exp_f32_e64 v37, v37 clamp
 v_exp_f32_e64 v38, v38 clamp
 v_exp_f32_e64 v39, v39 clamp
 v_exp_f32_e64 v40, v40 clamp
 v_exp_f32_e64 v41, v41 clamp
 v_exp_f32_e64 v42, v42 clamp
 v_exp_f32_e64 v43, v43 clamp
 v_max_f32 v88, 0, v88
 v_max_f32 v89, 0, v89
 v_max_f32 v90, 0, v90
 v_max_f32 v91, 0, v91
 v_max_f32 v92, 0, v92
 v_max_f32 v93, 0, v93
 v_max_f32 v94, 0, v94
 v_max_f32 v95, 0, v95
 v_pk_add_f32 v[88:89], v[88:89], s[68:69] op_sel_hi:[1,0]
 v_pk_add_f32 v[90:91], v[90:91], s[68:69] op_sel_hi:[1,0]
 v_pk_add_f32 v[92:93], v[92:93], s[68:69] op_sel_hi:[1,0]
 v_pk_add_f32 v[94:95], v[94:95], s[68:69] op_sel_hi:[1,0]
 v_pk_add_f32 v[88:89], v[88:89], v[36:37]
 v_pk_add_f32 v[90:91], v[90:91], v[38:39]
 v_pk_add_f32 v[92:93], v[92:93], v[40:41]
 v_pk_add_f32 v[94:95], v[94:95], v[42:43]
 v_cvt_pk_bf16_f32 v88, v88, v89
 v_cvt_pk_bf16_f32 v89, v90, v91
 v_cvt_pk_bf16_f32 v90, v92, v93
 v_cvt_pk_bf16_f32 v91, v94, v95
 v_pk_fma_f32 v[96:97], v[16:17], v[14:15], v[96:97] op_sel:[0,0,0] op_sel_hi:[1,0,1]
 v_pk_fma_f32 v[98:99], v[18:19], v[14:15], v[98:99] op_sel:[0,0,0] op_sel_hi:[1,0,1]
 v_pk_fma_f32 v[100:101], v[24:25], v[14:15], v[100:101] op_sel:[0,0,0] op_sel_hi:[1,0,1]
 v_pk_fma_f32 v[102:103], v[26:27], v[14:15], v[102:103] op_sel:[0,0,0] op_sel_hi:[1,0,1]
 v_pk_mul_f32 v[96:97], v[96:97], v[20:21]
 v_pk_mul_f32 v[98:99], v[98:99], v[22:23]
 v_pk_mul_f32 v[100:101], v[100:101], v[28:29]
 v_pk_mul_f32 v[102:103], v[102:103], v[30:31]
 v_cvt_pk_bf16_f32 v96, v96, v97
 v_cvt_pk_bf16_f32 v97, v98, v99
 v_cvt_pk_bf16_f32 v98, v100, v101
 v_cvt_pk_bf16_f32 v99, v102, v103
 v_pk_fma_f32 v[104:105], v[16:17], v[14:15], v[104:105] op_sel:[0,1,0] op_sel_hi:[1,1,1]
 v_pk_fma_f32 v[106:107], v[18:19], v[14:15], v[106:107] op_sel:[0,1,0] op_sel_hi:[1,1,1]
 v_pk_fma_f32 v[108:109], v[24:25], v[14:15], v[108:109] op_sel:[0,1,0] op_sel_hi:[1,1,1]
 v_pk_fma_f32 v[110:111], v[26:27], v[14:15], v[110:111] op_sel:[0,1,0] op_sel_hi:[1,1,1]
 v_pk_mul_f32 v[104:105], v[104:105], v[20:21]
 v_pk_mul_f32 v[106:107], v[106:107], v[22:23]
 v_pk_mul_f32 v[108:109], v[108:109], v[28:29]
 v_pk_mul_f32 v[110:111], v[110:111], v[30:31]
 v_cvt_pk_bf16_f32 v104, v104, v105
 v_cvt_pk_bf16_f32 v105, v106, v107
 v_cvt_pk_bf16_f32 v106, v108, v109
 v_cvt_pk_bf16_f32 v107, v110, v111
 v_mfma_f32_16x16x32_bf16 v[112:115], v[80:83], v[96:99], v[112:115]
    s_nop 0
 v_mfma_f32_16x16x32_bf16 v[116:119], v[80:83], v[104:107], v[116:119]
 v_mfma_f32_16x16x32_bf16 v[120:123], v[80:83], v[136:139], v[120:123]
 v_mfma_f32_16x16x32_bf16 v[124:127], v[88:91], v[96:99], v[124:127]
 v_mfma_f32_16x16x32_bf16 v[128:131], v[88:91], v[104:107], v[128:131]
 v_mfma_f32_16x16x32_bf16 v[132:135], v[88:91], v[136:139], v[132:135]
 ds_read_b128 v[12:15], v45 offset:256
 ds_read_b128 v[16:19], v45 offset:320
 ds_read_b128 v[28:31], v44 offset:0
 s_mul_i32 s0, s3, 3072
 s_add_u32 s0, s0, 67584
 v_add_u32 v4, s0, v1
 s_xor_b32 s1, s3, 1
 s_mul_i32 s1, s1, 3072
 s_add_u32 s1, s1, 67584
 v_add_u32 v5, s1, v1
 s_waitcnt vmcnt(0)
 v_cmp_ne_u32 vcc, 1, v47
 s_nop 3
 s_cbranch_vccnz L_b10_s
L_b10_d:
 buffer_load_dwordx4 a[80:83], v1, s[24:27], s12 offen sc1
 buffer_load_dwordx4 a[84:87], v1, s[24:27], s12 offen offset:1024 sc1
 buffer_load_dwordx4 a[88:91], v1, s[24:27], s12 offen offset:2048 sc1
 buffer_load_dwordx4 a[92:95], v1, s[24:27], s12 offen offset:3072 sc1
 s_add_u32 s12, s12, 4096
L_ml0:
 s_cmp_eq_u32 s53, 0
 s_nop 3
 s_cbranch_scc1 L_kv0
 ds_write_b128 v5, v[112:115] offset:0
 ds_write_b128 v5, v[116:119] offset:1024
 ds_write_b128 v5, v[120:123] offset:2048
 v_mov_b64 v[48:49], v[124:125]
 v_mov_b64 v[50:51], v[126:127]
 v_mov_b64 v[52:53], v[128:129]
 v_mov_b64 v[54:55], v[130:131]
 v_mov_b64 v[56:57], v[132:133]
 v_mov_b64 v[58:59], v[134:135]
 s_branch L_kv1
L_kv0:
 ds_write_b128 v5, v[124:127] offset:0
 ds_write_b128 v5, v[128:131] offset:1024
 ds_write_b128 v5, v[132:135] offset:2048
 v_mov_b64 v[48:49], v[112:113]
 v_mov_b64 v[50:51], v[114:115]
 v_mov_b64 v[52:53], v[116:117]
 v_mov_b64 v[54:55], v[118:119]
 v_mov_b64 v[56:57], v[120:121]
 v_mov_b64_e64 v[58:59], v[122:123]
L_kv1:
 s_waitcnt lgkmcnt(0)
 ds_read_b128 v[32:35], v44 offset:256
 v_mul_f32 v30, 0xbede652a, v29
 v_mul_f32 v31, 0xbf206c99, v29
 v_pk_fma_f32 v[176:177], v[12:13], v[28:29], v[176:177] op_sel_hi:[1,0,1]
 v_pk_fma_f32 v[178:179], v[14:15], v[28:29], v[178:179] op_sel_hi:[1,0,1]
 v_pk_fma_f32 v[208:209], v[16:17], v[28:29], v[208:209] op_sel_hi:[1,0,1]
 v_pk_fma_f32 v[210:211], v[18:19], v[28:29], v[210:211] op_sel_hi:[1,0,1]
 v_pk_mul_f32 v[36:37], v[176:177], v[30:31] op_sel:[0,1] op_sel_hi:[1,1]
 v_pk_mul_f32 v[38:39], v[178:179], v[30:31] op_sel:[0,1] op_sel_hi:[1,1]
 v_pk_mul_f32 v[40:41], v[208:209], v[30:31] op_sel:[0,1] op_sel_hi:[1,1]
 v_pk_mul_f32 v[42:43], v[210:211], v[30:31] op_sel:[0,1] op_sel_hi:[1,1]
 v_exp_f32_e64 v36, v36 clamp
 v_exp_f32_e64 v37, v37 clamp
 v_exp_f32_e64 v38, v38 clamp
 v_exp_f32_e64 v39, v39 clamp
 v_exp_f32_e64 v40, v40 clamp
 v_exp_f32_e64 v41, v41 clamp
 v_exp_f32_e64 v42, v42 clamp
 v_exp_f32_e64 v43, v43 clamp
 v_max_f32 v176, 0, v176
 v_max_f32 v177, 0, v177
 v_max_f32 v178, 0, v178
 v_max_f32 v179, 0, v179
 v_max_f32 v208, 0, v208
 v_max_f32 v209, 0, v209
 v_max_f32 v210, 0, v210
 v_max_f32 v211, 0, v211
 v_pk_fma_f32 v[176:177], v[176:177], v[30:31], s[68:69] op_sel_hi:[1,0,0]
 v_pk_fma_f32 v[178:179], v[178:179], v[30:31], s[68:69] op_sel_hi:[1,0,0]
 v_pk_fma_f32 v[208:209], v[208:209], v[30:31], s[68:69] op_sel_hi:[1,0,0]
 v_pk_fma_f32 v[210:211], v[210:211], v[30:31], s[68:69] op_sel_hi:[1,0,0]
 v_pk_add_f32 v[176:177], v[176:177], v[36:37]
 v_pk_add_f32 v[178:179], v[178:179], v[38:39]
 v_pk_add_f32 v[208:209], v[208:209], v[40:41]
 v_pk_add_f32 v[210:211], v[210:211], v[42:43]
 v_cvt_pk_bf16_f32 v176, v176, v177
 v_cvt_pk_bf16_f32 v177, v178, v179
 v_cvt_pk_bf16_f32 v178, v208, v209
 v_cvt_pk_bf16_f32 v179, v210, v211
 buffer_load_dwordx4 a[96:99], v1, s[24:27], s12 offen sc1
 buffer_load_dwordx4 a[100:103], v1, s[24:27], s12 offen offset:1024 sc1
 buffer_load_dwordx4 a[104:107], v1, s[24:27], s12 offen offset:2048 sc1
 buffer_load_dwordx4 a[108:111], v1, s[24:27], s12 offen offset:3072 sc1
 s_add_u32 s12, s12, 4096
 s_barrier
 ds_read_b128 v[60:63], v4 offset:0
 ds_read_b128 v[64:67], v4 offset:1024
 ds_read_b128 v[68:71], v4 offset:2048
 s_waitcnt lgkmcnt(0)
 ds_read_b128 v[28:31], v44 offset:512
 v_mul_f32 v34, 0xbede652a, v33
 v_mul_f32 v35, 0xbf206c99, v33
 v_pk_fma_f32 v[180:181], v[12:13], v[32:33], v[180:181] op_sel_hi:[1,0,1]
 v_pk_fma_f32 v[182:183], v[14:15], v[32:33], v[182:183] op_sel_hi:[1,0,1]
 v_pk_fma_f32 v[212:213], v[16:17], v[32:33], v[212:213] op_sel_hi:[1,0,1]
 v_pk_fma_f32 v[214:215], v[18:19], v[32:33], v[214:215] op_sel_hi:[1,0,1]
 v_pk_mul_f32 v[36:37], v[180:181], v[34:35] op_sel:[0,1] op_sel_hi:[1,1]
 v_pk_mul_f32 v[38:39], v[182:183], v[34:35] op_sel:[0,1] op_sel_hi:[1,1]
 v_pk_mul_f32 v[40:41], v[212:213], v[34:35] op_sel:[0,1] op_sel_hi:[1,1]
 v_pk_mul_f32 v[42:43], v[214:215], v[34:35] op_sel:[0,1] op_sel_hi:[1,1]
 v_exp_f32_e64 v36, v36 clamp
 v_exp_f32_e64 v37, v37 clamp
 v_exp_f32_e64 v38, v38 clamp
 v_exp_f32_e64 v39, v39 clamp
 v_exp_f32_e64 v40, v40 clamp
 v_exp_f32_e64 v41, v41 clamp
 v_exp_f32_e64 v42, v42 clamp
 v_exp_f32_e64 v43, v43 clamp
 v_max_f32 v180, 0, v180
 v_max_f32 v181, 0, v181
 v_max_f32 v182, 0, v182
 v_max_f32 v183, 0, v183
 v_max_f32 v212, 0, v212
 v_max_f32 v213, 0, v213
 v_max_f32 v214, 0, v214
 v_max_f32 v215, 0, v215
 v_pk_fma_f32 v[180:181], v[180:181], v[34:35], s[68:69] op_sel_hi:[1,0,0]
 v_pk_fma_f32 v[182:183], v[182:183], v[34:35], s[68:69] op_sel_hi:[1,0,0]
 v_pk_fma_f32 v[212:213], v[212:213], v[34:35], s[68:69] op_sel_hi:[1,0,0]
 v_pk_fma_f32 v[214:215], v[214:215], v[34:35], s[68:69] op_sel_hi:[1,0,0]
 v_pk_add_f32 v[180:181], v[180:181], v[36:37]
 v_pk_add_f32 v[182:183], v[182:183], v[38:39]
 v_pk_add_f32 v[212:213], v[212:213], v[40:41]
 v_pk_add_f32 v[214:215], v[214:215], v[42:43]
 v_cvt_pk_bf16_f32 v180, v180, v181
 v_cvt_pk_bf16_f32 v181, v182, v183
 v_cvt_pk_bf16_f32 v182, v212, v213
 v_cvt_pk_bf16_f32 v183, v214, v215
 buffer_load_dwordx4 a[112:115], v1, s[24:27], s12 offen sc1
 buffer_load_dwordx4 a[116:119], v1, s[24:27], s12 offen offset:1024 sc1
 buffer_load_dwordx4 a[120:123], v1, s[24:27], s12 offen offset:2048 sc1
 buffer_load_dwordx4 a[124:127], v1, s[24:27], s12 offen offset:3072 sc1
 s_add_u32 s12, s12, 4096
 v_pk_add_f32 v[48:49], v[48:49], v[60:61]
 v_pk_add_f32 v[50:51], v[50:51], v[62:63]
 v_pk_add_f32 v[52:53], v[52:53], v[64:65]
 v_pk_add_f32 v[54:55], v[54:55], v[66:67]
 v_pk_add_f32 v[56:57], v[56:57], v[68:69]
 v_pk_add_f32 v[58:59], v[58:59], v[70:71]
 s_waitcnt lgkmcnt(0)
 s_nop 0
 ds_read_b128 v[32:35], v44 offset:768
 v_mul_f32 v30, 0xbede652a, v29
 v_mul_f32 v31, 0xbf206c99, v29
 v_pk_fma_f32 v[184:185], v[12:13], v[28:29], v[184:185] op_sel_hi:[1,0,1]
 v_pk_fma_f32 v[186:187], v[14:15], v[28:29], v[186:187] op_sel_hi:[1,0,1]
 v_pk_fma_f32 v[216:217], v[16:17], v[28:29], v[216:217] op_sel_hi:[1,0,1]
 v_pk_fma_f32 v[218:219], v[18:19], v[28:29], v[218:219] op_sel_hi:[1,0,1]
 v_pk_mul_f32 v[36:37], v[184:185], v[30:31] op_sel:[0,1] op_sel_hi:[1,1]
 v_pk_mul_f32 v[38:39], v[186:187], v[30:31] op_sel:[0,1] op_sel_hi:[1,1]
 v_pk_mul_f32 v[40:41], v[216:217], v[30:31] op_sel:[0,1] op_sel_hi:[1,1]
 v_pk_mul_f32 v[42:43], v[218:219], v[30:31] op_sel:[0,1] op_sel_hi:[1,1]
 v_exp_f32_e64 v36, v36 clamp
 v_exp_f32_e64 v37, v37 clamp
 buffer_store_dwordx4 v[48:51], v1, s[24:27], s54 offen offset:1024 sc1
 v_exp_f32_e64 v38, v38 clamp
 v_exp_f32_e64 v39, v39 clamp
 v_exp_f32_e64 v40, v40 clamp
 v_exp_f32_e64 v41, v41 clamp
 v_exp_f32_e64 v42, v42 clamp
 buffer_store_dwordx4 v[52:55], v1, s[24:27], s54 offen offset:2048 sc1
 v_exp_f32_e64 v43, v43 clamp
 v_max_f32 v184, 0, v184
 v_max_f32 v185, 0, v185
 v_max_f32 v186, 0, v186
 v_max_f32 v187, 0, v187
 v_max_f32 v216, 0, v216
 v_max_f32 v217, 0, v217
 v_max_f32 v218, 0, v218
 v_max_f32 v219, 0, v219
 buffer_store_dwordx4 v[56:59], v1, s[24:27], s54 offen offset:3072 sc1
 v_pk_fma_f32 v[184:185], v[184:185], v[30:31], s[68:69] op_sel_hi:[1,0,0]
 v_pk_fma_f32 v[186:187], v[186:187], v[30:31], s[68:69] op_sel_hi:[1,0,0]
 v_pk_fma_f32 v[216:217], v[216:217], v[30:31], s[68:69] op_sel_hi:[1,0,0]
 v_pk_fma_f32 v[218:219], v[218:219], v[30:31], s[68:69] op_sel_hi:[1,0,0]
 v_pk_add_f32 v[184:185], v[184:185], v[36:37]
 v_pk_add_f32 v[186:187], v[186:187], v[38:39]
 v_pk_add_f32 v[216:217], v[216:217], v[40:41]
 v_pk_add_f32 v[218:219], v[218:219], v[42:43]
 v_cvt_pk_bf16_f32 v184, v184, v185
 v_cvt_pk_bf16_f32 v185, v186, v187
 v_cvt_pk_bf16_f32 v186, v216, v217
 v_cvt_pk_bf16_f32 v187, v218, v219
 v_xor_b32 v36, 0, v7
 v_xor_b32 v37, 32, v7
 v_xor_b32 v38, 64, v7
 v_xor_b32 v39, 96, v7
 s_waitcnt vmcnt(11) lgkmcnt(0)
 v_mfma_f32_16x16x32_bf16 v[144:147], a[16:19], a[80:83], 0
 s_barrier
 s_add_u32 s15, s14, 917504
 ds_read_b64_tr_b16 a[192:193], v36 offset:16384
 ds_read_b64_tr_b16 a[194:195], v36 offset:18432
 ds_read_b128 v[28:31], v44 offset:1024
 v_mfma_f32_16x16x32_bf16 v[144:147], a[48:51], a[88:91], v[144:147]
 s_add_u32 m0, s18, 0
 ds_read_b64_tr_b16 a[224:225], v36 offset:24576
 ds_read_b64_tr_b16 a[226:227], v36 offset:26624
 v_mfma_f32_16x16x32_bf16 v[148:151], a[48:51], a[92:95], 0
 buffer_load_dwordx4 v8, s[28:31], s15 offen lds
 v_bfe_u32 v25, v2, 1, 2
 v_mfma_f32_16x16x32_bf16 v[148:151], a[16:19], a[84:87], v[148:151]
 ds_read_b64_tr_b16 a[196:197], v37 offset:16384
 v_and_b32 v24, 1, v2
 s_branch L_tp_L_tA_9_o
L_tp_L_tA_9:
 s_nop 0
 s_nop 0
 s_branch L_tp_L_tA_11
L_tp_L_tA_9_o:
 v_mfma_f32_16x16x32_bf16 v[156:159], a[20:23], a[84:87], 0
 ds_read_b64_tr_b16 a[198:199], v37 offset:18432
 ds_read_b64_tr_b16 a[228:229], v37 offset:24576
 v_mfma_f32_16x16x32_bf16 v[156:159], a[52:55], a[92:95], v[156:159]
 buffer_load_dwordx4 a[128:131], v1, s[24:27], s12 offen sc1
 v_lshl_or_b32 v25, v25, 7, v24
 v_mfma_f32_16x16x32_bf16 v[152:155], a[52:55], a[88:91], 0
 ds_read_b64_tr_b16 a[230:231], v37 offset:26624
 v_lshlrev_b32 v25, 10, v25
 v_and_b32 v24, 4294705151, v25
 v_mfma_f32_16x16x32_bf16 v[152:155], a[20:23], a[80:83], v[152:155]
 ds_read_b64_tr_b16 a[200:201], v38 offset:16384
 ds_read_b64_tr_b16 a[202:203], v38 offset:18432
 v_mfma_f32_16x16x32_bf16 v[160:163], a[24:27], a[80:83], 0
 s_add_u32 m0, s18, 1024
 ds_read_b64_tr_b16 a[232:233], v38 offset:24576
 ds_read_b64_tr_b16 a[234:235], v38 offset:26624
 v_mfma_f32_16x16x32_bf16 v[160:163], a[56:59], a[88:91], v[160:163]
 buffer_load_dwordx4 v9, s[28:31], s15 offen lds
 v_mul_f32 v34, 0xbede652a, v33
 v_mfma_f32_16x16x32_bf16 v[164:167], a[56:59], a[92:95], 0
 ds_read_b64_tr_b16 a[204:205], v39 offset:16384
 v_mul_f32 v35, 0xbf206c99, v33
 v_fmac_f32 v188, v12, v32
 v_mfma_f32_16x16x32_bf16 v[164:167], a[24:27], a[84:87], v[164:167]
 ds_read_b64_tr_b16 a[206:207], v39 offset:18432
 ds_read_b64_tr_b16 a[236:237], v39 offset:24576
 v_mfma_f32_16x16x32_bf16 v[172:175], a[28:31], a[84:87], 0
 buffer_load_dwordx4 a[132:135], v1, s[24:27], s12 offen offset:1024 sc1
 v_fmac_f32 v189, v13, v32
 v_mfma_f32_16x16x32_bf16 v[172:175], a[60:63], a[92:95], v[172:175]
 ds_read_b64_tr_b16 a[238:239], v39 offset:26624
 v_fmac_f32 v190, v14, v32
 v_mfma_f32_16x16x32_bf16 v[168:171], a[60:63], a[88:91], 0
 ds_read_b64_tr_b16 a[208:209], v36 offset:20480
 ds_read_b64_tr_b16 a[210:211], v36 offset:22528
 v_fmac_f32 v191, v15, v32
 v_mfma_f32_16x16x32_bf16 v[168:171], a[28:31], a[80:83], v[168:171]
 s_add_u32 m0, s18, 2048
 ds_read_b64_tr_b16 a[240:241], v36 offset:28672
 ds_read_b64_tr_b16 a[242:243], v36 offset:30720
 v_mfma_f32_16x16x32_bf16 v[112:115], a[32:35], a[80:83], 0
 buffer_load_dwordx4 v10, s[28:31], s15 offen lds
 v_fmac_f32 v220, v16, v32
 v_mfma_f32_16x16x32_bf16 v[112:115], a[64:67], a[88:91], v[112:115]
 ds_read_b64_tr_b16 a[212:213], v37 offset:20480
 v_fmac_f32 v221, v17, v32
 v_mfma_f32_16x16x32_bf16 v[116:119], a[64:67], a[92:95], 0
 ds_read_b64_tr_b16 a[214:215], v37 offset:22528
 ds_read_b64_tr_b16 a[244:245], v37 offset:28672
 v_fmac_f32 v222, v18, v32
 v_mfma_f32_16x16x32_bf16 v[116:119], a[32:35], a[84:87], v[116:119]
 ds_read_b64_tr_b16 a[246:247], v37 offset:30720
 v_fmac_f32 v223, v19, v32
 v_mfma_f32_16x16x32_bf16 v[124:127], a[36:39], a[84:87], 0
 buffer_load_dwordx4 a[136:139], v1, s[24:27], s12 offen offset:2048 sc1
 v_mul_f32 v240, v188, v35
 v_mfma_f32_16x16x32_bf16 v[124:127], a[68:71], a[92:95], v[124:127]
 ds_read_b64_tr_b16 a[216:217], v38 offset:20480
 ds_read_b64_tr_b16 a[218:219], v38 offset:22528
 v_mfma_f32_16x16x32_bf16 v[120:123], a[68:71], a[88:91], 0
 s_add_u32 m0, s18, 3072
 ds_read_b64_tr_b16 a[248:249], v38 offset:28672
 ds_read_b64_tr_b16 a[250:251], v38 offset:30720
 v_mul_f32 v241, v189, v35
 v_mfma_f32_16x16x32_bf16 v[120:123], a[36:39], a[80:83], v[120:123]
 buffer_load_dwordx4 v11, s[28:31], s15 offen lds
 v_mul_f32 v242, v190, v35
 v_mfma_f32_16x16x32_bf16 v[128:131], a[40:43], a[80:83], 0
 ds_read_b64_tr_b16 a[220:221], v39 offset:20480
 v_mul_f32 v243, v191, v35
 v_mfma_f32_16x16x32_bf16 v[128:131], a[72:75], a[88:91], v[128:131]
 ds_read_b64_tr_b16 a[222:223], v39 offset:22528
 ds_read_b64_tr_b16 a[252:253], v39 offset:28672
 v_mfma_f32_16x16x32_bf16 v[132:135], a[72:75], a[92:95], 0
 ds_read_b64_tr_b16 a[254:255], v39 offset:30720
 v_mul_f32 v244, v220, v35
 v_mul_f32 v245, v221, v35
 v_mfma_f32_16x16x32_bf16 v[132:135], a[40:43], a[84:87], v[132:135]
 buffer_load_dwordx4 a[140:143], v1, s[24:27], s12 offen offset:3072 sc1
 v_mul_f32 v246, v222, v35
 v_mfma_f32_16x16x32_bf16 v[140:143], a[44:47], a[84:87], 0
 v_mul_f32 v247, v223, v35
 v_exp_f32_e64 v240, v240 clamp
 v_mfma_f32_16x16x32_bf16 v[140:143], a[76:79], a[92:95], v[140:143]
 v_max_f32 v188, 0, v188
 v_mfma_f32_16x16x32_bf16 v[136:139], a[76:79], a[88:91], 0
 v_fma_f32 v188, v188, v34, s68
 v_exp_f32_e64 v241, v241 clamp
 v_mfma_f32_16x16x32_bf16 v[136:139], a[44:47], a[80:83], v[136:139]
 s_add_u32 s12, s12, 4096
 v_max_f32 v189, 0, v189
 v_fma_f32 v189, v189, v34, s68
 s_waitcnt vmcnt(15) lgkmcnt(0)
 v_mfma_f32_16x16x32_bf16 v[144:147], a[192:195], a[96:99], v[144:147]
 s_barrier
 s_add_u32 s15, s14, 1048576
 ds_read_b64_tr_b16 a[16:17], v36 offset:32768
 ds_read_b64_tr_b16 a[18:19], v36 offset:34816
 v_mfma_f32_16x16x32_bf16 v[144:147], a[224:227], a[104:107], v[144:147]
 s_add_u32 m0, s18, 16384
 ds_read_b64_tr_b16 a[48:49], v36 offset:40960
 ds_read_b64_tr_b16 a[50:51], v36 offset:43008
 v_mfma_f32_16x16x32_bf16 v[148:151], a[224:227], a[108:111], v[148:151]
 buffer_load_dwordx4 v8, s[28:31], s15 offen lds
 v_exp_f32_e64 v242, v242 clamp
 v_mfma_f32_16x16x32_bf16 v[148:151], a[192:195], a[100:103], v[148:151]
 ds_read_b64_tr_b16 a[20:21], v37 offset:32768
 v_max_f32 v190, 0, v190
 v_mfma_f32_16x16x32_bf16 v[156:159], a[196:199], a[100:103], v[156:159]
 ds_read_b64_tr_b16 a[22:23], v37 offset:34816
 ds_read_b64_tr_b16 a[52:53], v37 offset:40960
 v_mfma_f32_16x16x32_bf16 v[156:159], a[228:231], a[108:111], v[156:159]
 buffer_load_dwordx4 a[80:83], v1, s[24:27], s12 offen sc1
 v_fma_f32 v190, v190, v34, s68
 v_mfma_f32_16x16x32_bf16 v[152:155], a[228:231], a[104:107], v[152:155]
 ds_read_b64_tr_b16 a[54:55], v37 offset:43008
 v_exp_f32_e64 v243, v243 clamp
 v_mfma_f32_16x16x32_bf16 v[152:155], a[196:199], a[96:99], v[152:155]
 ds_read_b64_tr_b16 a[24:25], v38 offset:32768
 ds_read_b64_tr_b16 a[26:27], v38 offset:34816
 v_mfma_f32_16x16x32_bf16 v[160:163], a[200:203], a[96:99], v[160:163]
 s_add_u32 m0, s18, 17408
 ds_read_b64_tr_b16 a[56:57], v38 offset:40960
 ds_read_b64_tr_b16 a[58:59], v38 offset:43008
 v_mfma_f32_16x16x32_bf16 v[160:163], a[232:235], a[104:107], v[160:163]
 buffer_load_dwordx4 v9, s[28:31], s15 offen lds
 v_max_f32 v191, 0, v191
 v_mfma_f32_16x16x32_bf16 v[164:167], a[232:235], a[108:111], v[164:167]
 ds_read_b64_tr_b16 a[28:29], v39 offset:32768
 v_fma_f32 v191, v191, v34, s68
 v_mfma_f32_16x16x32_bf16 v[164:167], a[200:203], a[100:103], v[164:167]
 ds_read_b64_tr_b16 a[30:31], v39 offset:34816
 ds_read_b64_tr_b16 a[60:61], v39 offset:40960
 v_mfma_f32_16x16x32_bf16 v[172:175], a[204:207], a[100:103], v[172:175]
 buffer_load_dwordx4 a[84:87], v1, s[24:27], s12 offen offset:1024 sc1
 v_exp_f32_e64 v244, v244 clamp
 v_mfma_f32_16x16x32_bf16 v[172:175], a[236:239], a[108:111], v[172:175]
 ds_read_b64_tr_b16 a[62:63], v39 offset:43008
 v_max_f32 v220, 0, v220
 v_mfma_f32_16x16x32_bf16 v[168:171], a[236:239], a[104:107], v[168:171]
 ds_read_b64_tr_b16 a[32:33], v36 offset:36864
 ds_read_b64_tr_b16 a[34:35], v36 offset:38912
 v_mfma_f32_16x16x32_bf16 v[168:171], a[204:207], a[96:99], v[168:171]
 s_add_u32 m0, s18, 18432
 ds_read_b64_tr_b16 a[64:65], v36 offset:45056
 ds_read_b64_tr_b16 a[66:67], v36 offset:47104
 v_fma_f32 v220, v220, v34, s68
 v_mfma_f32_16x16x32_bf16 v[112:115], a[208:211], a[96:99], v[112:115]
 buffer_load_dwordx4 v10, s[28:31], s15 offen lds
 v_mfma_f32_16x16x32_bf16 v[112:115], a[240:243], a[104:107], v[112:115]
 ds_read_b64_tr_b16 a[36:37], v37 offset:36864
 v_exp_f32_e64 v245, v245 clamp
 v_mfma_f32_16x16x32_bf16 v[116:119], a[240:243], a[108:111], v[116:119]
 ds_read_b64_tr_b16 a[38:39], v37 offset:38912
 ds_read_b64_tr_b16 a[68:69], v37 offset:45056
 v_mfma_f32_16x16x32_bf16 v[116:119], a[208:211], a[100:103], v[116:119]
 ds_read_b64_tr_b16 a[70:71], v37 offset:47104
 v_max_f32 v221, 0, v221
 v_fma_f32 v221, v221, v34, s68
 v_mfma_f32_16x16x32_bf16 v[124:127], a[212:215], a[100:103], v[124:127]
 buffer_load_dwordx4 a[88:91], v1, s[24:27], s12 offen offset:2048 sc1
 v_mfma_f32_16x16x32_bf16 v[124:127], a[244:247], a[108:111], v[124:127]
 ds_read_b64_tr_b16 a[40:41], v38 offset:36864
 ds_read_b64_tr_b16 a[42:43], v38 offset:38912
 v_exp_f32_e64 v246, v246 clamp
 v_mfma_f32_16x16x32_bf16 v[120:123], a[244:247], a[104:107], v[120:123]
 s_add_u32 m0, s18, 19456
 ds_read_b64_tr_b16 a[72:73], v38 offset:45056
 ds_read_b64_tr_b16 a[74:75], v38 offset:47104
 v_mfma_f32_16x16x32_bf16 v[120:123], a[212:215], a[96:99], v[120:123]
 buffer_load_dwordx4 v11, s[28:31], s15 offen lds
 v_max_f32 v222, 0, v222
 v_mfma_f32_16x16x32_bf16 v[128:131], a[216:219], a[96:99], v[128:131]
 ds_read_b64_tr_b16 a[44:45], v39 offset:36864
 v_fma_f32 v222, v222, v34, s68
 v_mfma_f32_16x16x32_bf16 v[128:131], a[248:251], a[104:107], v[128:131]
 ds_read_b64_tr_b16 a[46:47], v39 offset:38912
 ds_read_b64_tr_b16 a[76:77], v39 offset:45056
 v_mfma_f32_16x16x32_bf16 v[132:135], a[248:251], a[108:111], v[132:135]
 ds_read_b64_tr_b16 a[78:79], v39 offset:47104
 v_exp_f32_e64 v247, v247 clamp
 v_mfma_f32_16x16x32_bf16 v[132:135], a[216:219], a[100:103], v[132:135]
 buffer_load_dwordx4 a[92:95], v1, s[24:27], s12 offen offset:3072 sc1
 v_max_f32 v223, 0, v223
 v_mfma_f32_16x16x32_bf16 v[140:143], a[220:223], a[100:103], v[140:143]
 v_fma_f32 v223, v223, v34, s68
 v_add_f32 v188, v188, v240
 v_mfma_f32_16x16x32_bf16 v[140:143], a[252:255], a[108:111], v[140:143]
 v_add_f32 v189, v189, v241
 v_add_f32 v190, v190, v242
 v_mfma_f32_16x16x32_bf16 v[136:139], a[252:255], a[104:107], v[136:139]
 v_add_f32 v191, v191, v243
 v_add_f32 v220, v220, v244
 v_mfma_f32_16x16x32_bf16 v[136:139], a[220:223], a[96:99], v[136:139]
 s_add_u32 s12, s12, 4096
 v_add_f32 v221, v221, v245
 v_add_f32 v222, v222, v246
 v_add_f32 v223, v223, v247
 s_waitcnt vmcnt(19) lgkmcnt(0)
 v_mfma_f32_16x16x32_bf16 v[144:147], a[16:19], a[112:115], v[144:147]
 s_barrier
 s_add_u32 s15, s14, 1703936
 ds_read_b64_tr_b16 a[192:193], v36 offset:49152
 ds_read_b64_tr_b16 a[194:195], v36 offset:51200
 v_mfma_f32_16x16x32_bf16 v[144:147], a[48:51], a[120:123], v[144:147]
 s_add_u32 m0, s18, 32768
 ds_read_b64_tr_b16 a[224:225], v36 offset:57344
 ds_read_b64_tr_b16 a[226:227], v36 offset:59392
 v_mfma_f32_16x16x32_bf16 v[148:151], a[48:51], a[124:127], v[148:151]
 buffer_load_dwordx4 v8, s[28:31], s15 offen lds
 v_cvt_pk_bf16_f32 v188, v188, v189
 v_mfma_f32_16x16x32_bf16 v[148:151], a[16:19], a[116:119], v[148:151]
 ds_read_b64_tr_b16 a[196:197], v37 offset:49152
 v_cvt_pk_bf16_f32 v189, v190, v191
 v_cvt_pk_bf16_f32 v190, v220, v221
 v_mfma_f32_16x16x32_bf16 v[156:159], a[20:23], a[116:119], v[156:159]
 ds_read_b64_tr_b16 a[198:199], v37 offset:51200
 ds_read_b64_tr_b16 a[228:229], v37 offset:57344
 v_mfma_f32_16x16x32_bf16 v[156:159], a[52:55], a[124:127], v[156:159]
 buffer_load_dwordx4 a[96:99], v1, s[24:27], s12 offen sc1
 v_cvt_pk_bf16_f32 v191, v222, v223
 v_mfma_f32_16x16x32_bf16 v[152:155], a[52:55], a[120:123], v[152:155]
 ds_read_b64_tr_b16 a[230:231], v37 offset:59392
 ds_read_b128 v[32:35], v44 offset:1280
 v_mfma_f32_16x16x32_bf16 v[152:155], a[20:23], a[112:115], v[152:155]
 ds_read_b64_tr_b16 a[200:201], v38 offset:49152
 ds_read_b64_tr_b16 a[202:203], v38 offset:51200
 v_mfma_f32_16x16x32_bf16 v[160:163], a[24:27], a[112:115], v[160:163]
 s_add_u32 m0, s18, 33792
 ds_read_b64_tr_b16 a[232:233], v38 offset:57344
 ds_read_b64_tr_b16 a[234:235], v38 offset:59392
 v_mul_f32 v30, 0xbede652a, v29
 v_mfma_f32_16x16x32_bf16 v[160:163], a[56:59], a[120:123], v[160:163]
 buffer_load_dwordx4 v9, s[28:31], s15 offen lds
 v_mul_f32 v31, 0xbf206c99, v29
 v_mfma_f32_16x16x32_bf16 v[164:167], a[56:59], a[124:127], v[164:167]
 ds_read_b64_tr_b16 a[204:205], v39 offset:49152
 v_fmac_f32 v192, v12, v28
 v_mfma_f32_16x16x32_bf16 v[164:167], a[24:27], a[116:119], v[164:167]
 ds_read_b64_tr_b16 a[206:207], v39 offset:51200
 ds_read_b64_tr_b16 a[236:237], v39 offset:57344
 v_mfma_f32_16x16x32_bf16 v[172:175], a[28:31], a[116:119], v[172:175]
 buffer_load_dwordx4 a[100:103], v1, s[24:27], s12 offen offset:1024 sc1
 v_fmac_f32 v193, v13, v28
 v_mfma_f32_16x16x32_bf16 v[172:175], a[60:63], a[124:127], v[172:175]
 ds_read_b64_tr_b16 a[238:239], v39 offset:59392
 v_fmac_f32 v194, v14, v28
 v_mfma_f32_16x16x32_bf16 v[168:171], a[60:63], a[120:123], v[168:171]
 ds_read_b64_tr_b16 a[208:209], v36 offset:53248
 ds_read_b64_tr_b16 a[210:211], v36 offset:55296
 v_fmac_f32 v195, v15, v28
 v_mfma_f32_16x16x32_bf16 v[168:171], a[28:31], a[112:115], v[168:171]
 s_add_u32 m0, s18, 34816
 ds_read_b64_tr_b16 a[240:241], v36 offset:61440
 ds_read_b64_tr_b16 a[242:243], v36 offset:63488
 v_mfma_f32_16x16x32_bf16 v[112:115], a[32:35], a[112:115], v[112:115]
 buffer_load_dwordx4 v10, s[28:31], s15 offen lds
 v_fmac_f32 v224, v16, v28
 v_mfma_f32_16x16x32_bf16 v[112:115], a[64:67], a[120:123], v[112:115]
 ds_read_b64_tr_b16 a[212:213], v37 offset:53248
 v_fmac_f32 v225, v17, v28
 v_mfma_f32_16x16x32_bf16 v[116:119], a[64:67], a[124:127], v[116:119]
 ds_read_b64_tr_b16 a[214:215], v37 offset:55296
 ds_read_b64_tr_b16 a[244:245], v37 offset:61440
 v_mfma_f32_16x16x32_bf16 v[116:119], a[32:35], a[116:119], v[116:119]
 ds_read_b64_tr_b16 a[246:247], v37 offset:63488
 v_fmac_f32 v226, v18, v28
 v_mfma_f32_16x16x32_bf16 v[124:127], a[36:39], a[116:119], v[124:127]
 buffer_load_dwordx4 a[104:107], v1, s[24:27], s12 offen offset:2048 sc1
 v_fmac_f32 v227, v19, v28
 v_mul_f32 v240, v192, v31
 v_mfma_f32_16x16x32_bf16 v[124:127], a[68:71], a[124:127], v[124:127]
 ds_read_b64_tr_b16 a[216:217], v38 offset:53248
 ds_read_b64_tr_b16 a[218:219], v38 offset:55296
 v_mfma_f32_16x16x32_bf16 v[120:123], a[68:71], a[120:123], v[120:123]
 s_add_u32 m0, s18, 35840
 ds_read_b64_tr_b16 a[248:249], v38 offset:61440
 ds_read_b64_tr_b16 a[250:251], v38 offset:63488
 v_mfma_f32_16x16x32_bf16 v[120:123], a[36:39], a[112:115], v[120:123]
 buffer_load_dwordx4 v11, s[28:31], s15 offen lds
 v_mul_f32 v241, v193, v31
 v_mfma_f32_16x16x32_bf16 v[128:131], a[40:43], a[112:115], v[128:131]
 ds_read_b64_tr_b16 a[220:221], v39 offset:53248
 v_mul_f32 v242, v194, v31
 v_mfma_f32_16x16x32_bf16 v[128:131], a[72:75], a[120:123], v[128:131]
 ds_read_b64_tr_b16 a[222:223], v39 offset:55296
 ds_read_b64_tr_b16 a[252:253], v39 offset:61440
 v_mfma_f32_16x16x32_bf16 v[132:135], a[72:75], a[124:127], v[132:135]
 ds_read_b64_tr_b16 a[254:255], v39 offset:63488
 v_mul_f32 v243, v195, v31
 v_mul_f32 v244, v224, v31
 v_mfma_f32_16x16x32_bf16 v[132:135], a[40:43], a[116:119], v[132:135]
 buffer_load_dwordx4 a[108:111], v1, s[24:27], s12 offen offset:3072 sc1
 v_mul_f32 v245, v225, v31
 v_mfma_f32_16x16x32_bf16 v[140:143], a[44:47], a[116:119], v[140:143]
 v_mul_f32 v246, v226, v31
 v_mul_f32 v247, v227, v31
 v_mfma_f32_16x16x32_bf16 v[140:143], a[76:79], a[124:127], v[140:143]
 v_exp_f32_e64 v240, v240 clamp
 v_mfma_f32_16x16x32_bf16 v[136:139], a[76:79], a[120:123], v[136:139]
 v_max_f32 v192, 0, v192
 v_fma_f32 v192, v192, v30, s68
 v_mfma_f32_16x16x32_bf16 v[136:139], a[44:47], a[112:115], v[136:139]
 s_add_u32 s12, s12, 4096
 v_exp_f32_e64 v241, v241 clamp
 s_waitcnt vmcnt(16) lgkmcnt(0)
 v_mfma_f32_16x16x32_bf16 v[144:147], a[192:195], a[128:131], v[144:147]
 s_barrier
 s_add_u32 s15, s14, 1441792
 ds_read_b64_tr_b16 a[16:17], v36 offset:0
 ds_read_b64_tr_b16 a[18:19], v36 offset:2048
 v_max_f32 v193, 0, v193
 v_mfma_f32_16x16x32_bf16 v[144:147], a[224:227], a[136:139], v[144:147]
 s_add_u32 m0, s18, 49152
 ds_read_b64_tr_b16 a[48:49], v36 offset:8192
 ds_read_b64_tr_b16 a[50:51], v36 offset:10240
 v_mfma_f32_16x16x32_bf16 v[148:151], a[224:227], a[140:143], v[148:151]
 buffer_load_dwordx4 v8, s[28:31], s15 offen lds
 v_fma_f32 v193, v193, v30, s68
 v_mfma_f32_16x16x32_bf16 v[148:151], a[192:195], a[132:135], v[148:151]
 ds_read_b64_tr_b16 a[20:21], v37 offset:0
 v_exp_f32_e64 v242, v242 clamp
 v_mfma_f32_16x16x32_bf16 v[156:159], a[196:199], a[132:135], v[156:159]
 ds_read_b64_tr_b16 a[22:23], v37 offset:2048
 ds_read_b64_tr_b16 a[52:53], v37 offset:8192
 v_mfma_f32_16x16x32_bf16 v[156:159], a[228:231], a[140:143], v[156:159]
 buffer_load_dwordx4 a[112:115], v1, s[24:27], s12 offen sc1
 v_mfma_f32_16x16x32_bf16 v[152:155], a[228:231], a[136:139], v[152:155]
 ds_read_b64_tr_b16 a[54:55], v37 offset:10240
 v_max_f32 v194, 0, v194
 v_fma_f32 v194, v194, v30, s68
 v_mfma_f32_16x16x32_bf16 v[152:155], a[196:199], a[128:131], v[152:155]
 ds_read_b64_tr_b16 a[24:25], v38 offset:0
 ds_read_b64_tr_b16 a[26:27], v38 offset:2048
 v_mfma_f32_16x16x32_bf16 v[160:163], a[200:203], a[128:131], v[160:163]
 s_add_u32 m0, s18, 50176
 ds_read_b64_tr_b16 a[56:57], v38 offset:8192
 ds_read_b64_tr_b16 a[58:59], v38 offset:10240
 v_mfma_f32_16x16x32_bf16 v[160:163], a[232:235], a[136:139], v[160:163]
 buffer_load_dwordx4 v9, s[28:31], s15 offen lds
 v_exp_f32_e64 v243, v243 clamp
 v_mfma_f32_16x16x32_bf16 v[164:167], a[232:235], a[140:143], v[164:167]
 ds_read_b64_tr_b16 a[28:29], v39 offset:0
 v_mfma_f32_16x16x32_bf16 v[164:167], a[200:203], a[132:135], v[164:167]
 ds_read_b64_tr_b16 a[30:31], v39 offset:2048
 ds_read_b64_tr_b16 a[60:61], v39 offset:8192
 v_max_f32 v195, 0, v195
 v_mfma_f32_16x16x32_bf16 v[172:175], a[204:207], a[132:135], v[172:175]
 buffer_load_dwordx4 a[116:119], v1, s[24:27], s12 offen offset:1024 sc1
 v_fma_f32 v195, v195, v30, s68
 v_mfma_f32_16x16x32_bf16 v[172:175], a[236:239], a[140:143], v[172:175]
 ds_read_b64_tr_b16 a[62:63], v39 offset:10240
 v_mfma_f32_16x16x32_bf16 v[168:171], a[236:239], a[136:139], v[168:171]
 ds_read_b64_tr_b16 a[32:33], v36 offset:4096
 ds_read_b64_tr_b16 a[34:35], v36 offset:6144
 v_exp_f32_e64 v244, v244 clamp
 v_mfma_f32_16x16x32_bf16 v[168:171], a[204:207], a[128:131], v[168:171]
 s_add_u32 m0, s18, 51200
 ds_read_b64_tr_b16 a[64:65], v36 offset:12288
 ds_read_b64_tr_b16 a[66:67], v36 offset:14336
 v_mfma_f32_16x16x32_bf16 v[112:115], a[208:211], a[128:131], v[112:115]
 buffer_load_dwordx4 v10, s[28:31], s15 offen lds
 v_mfma_f32_16x16x32_bf16 v[112:115], a[240:243], a[136:139], v[112:115]
 ds_read_b64_tr_b16 a[36:37], v37 offset:4096
 v_max_f32 v224, 0, v224
 v_fma_f32 v224, v224, v30, s68
 v_mfma_f32_16x16x32_bf16 v[116:119], a[240:243], a[140:143], v[116:119]
 ds_read_b64_tr_b16 a[38:39], v37 offset:6144
 ds_read_b64_tr_b16 a[68:69], v37 offset:12288
 v_mfma_f32_16x16x32_bf16 v[116:119], a[208:211], a[132:135], v[116:119]
 ds_read_b64_tr_b16 a[70:71], v37 offset:14336
 v_mfma_f32_16x16x32_bf16 v[124:127], a[212:215], a[132:135], v[124:127]
 buffer_load_dwordx4 a[120:123], v1, s[24:27], s12 offen offset:2048 sc1
 v_exp_f32_e64 v245, v245 clamp
 v_mfma_f32_16x16x32_bf16 v[124:127], a[244:247], a[140:143], v[124:127]
 ds_read_b64_tr_b16 a[40:41], v38 offset:4096
 ds_read_b64_tr_b16 a[42:43], v38 offset:6144
 v_mfma_f32_16x16x32_bf16 v[120:123], a[244:247], a[136:139], v[120:123]
 s_add_u32 m0, s18, 52224
 ds_read_b64_tr_b16 a[72:73], v38 offset:12288
 ds_read_b64_tr_b16 a[74:75], v38 offset:14336
 v_mfma_f32_16x16x32_bf16 v[120:123], a[212:215], a[128:131], v[120:123]
 buffer_load_dwordx4 v11, s[28:31], s15 offen lds
 v_max_f32 v225, 0, v225
 v_fma_f32 v225, v225, v30, s68
 v_mfma_f32_16x16x32_bf16 v[128:131], a[216:219], a[128:131], v[128:131]
 ds_read_b64_tr_b16 a[44:45], v39 offset:4096
 v_mfma_f32_16x16x32_bf16 v[128:131], a[248:251], a[136:139], v[128:131]
 ds_read_b64_tr_b16 a[46:47], v39 offset:6144
 ds_read_b64_tr_b16 a[76:77], v39 offset:12288
 v_mfma_f32_16x16x32_bf16 v[132:135], a[248:251], a[140:143], v[132:135]
 ds_read_b64_tr_b16 a[78:79], v39 offset:14336
 v_exp_f32_e64 v246, v246 clamp
 v_mfma_f32_16x16x32_bf16 v[132:135], a[216:219], a[132:135], v[132:135]
 buffer_load_dwordx4 a[124:127], v1, s[24:27], s12 offen offset:3072 sc1
 v_max_f32 v226, 0, v226
 v_mfma_f32_16x16x32_bf16 v[140:143], a[220:223], a[132:135], v[140:143]
 v_fma_f32 v226, v226, v30, s68
 v_exp_f32_e64 v247, v247 clamp
 v_mfma_f32_16x16x32_bf16 v[140:143], a[252:255], a[140:143], v[140:143]
 v_max_f32 v227, 0, v227
 v_fma_f32 v227, v227, v30, s68
 v_mfma_f32_16x16x32_bf16 v[136:139], a[252:255], a[136:139], v[136:139]
 v_add_f32 v192, v192, v240
 v_add_f32 v193, v193, v241
 v_mfma_f32_16x16x32_bf16 v[136:139], a[220:223], a[128:131], v[136:139]
 s_add_u32 s12, s12, 4096
 v_add_f32 v194, v194, v242
 v_add_f32 v195, v195, v243
 s_waitcnt vmcnt(16) lgkmcnt(0)
 v_mfma_f32_16x16x32_bf16 v[144:147], a[16:19], a[80:83], v[144:147]
 s_barrier
 s_add_u32 s15, s14, 1835008
 ds_read_b64_tr_b16 a[192:193], v36 offset:16384
 ds_read_b64_tr_b16 a[194:195], v36 offset:18432
 v_mfma_f32_16x16x32_bf16 v[144:147], a[48:51], a[88:91], v[144:147]
 s_add_u32 m0, s18, 0
 ds_read_b64_tr_b16 a[224:225], v36 offset:24576
 ds_read_b64_tr_b16 a[226:227], v36 offset:26624
 v_mfma_f32_16x16x32_bf16 v[148:151], a[48:51], a[92:95], v[148:151]
 buffer_load_dwordx4 v8, s[28:31], s15 offen lds
 v_add_f32 v224, v224, v244
 v_mfma_f32_16x16x32_bf16 v[148:151], a[16:19], a[84:87], v[148:151]
 ds_read_b64_tr_b16 a[196:197], v37 offset:16384
 v_add_f32 v225, v225, v245
 v_add_f32 v226, v226, v246
 v_mfma_f32_16x16x32_bf16 v[156:159], a[20:23], a[84:87], v[156:159]
 ds_read_b64_tr_b16 a[198:199], v37 offset:18432
 ds_read_b64_tr_b16 a[228:229], v37 offset:24576
 v_mfma_f32_16x16x32_bf16 v[156:159], a[52:55], a[92:95], v[156:159]
 buffer_load_dwordx4 a[128:131], v1, s[24:27], s12 offen sc1
 v_add_f32 v227, v227, v247
 v_mfma_f32_16x16x32_bf16 v[152:155], a[52:55], a[88:91], v[152:155]
 ds_read_b64_tr_b16 a[230:231], v37 offset:26624
 v_cvt_pk_bf16_f32 v192, v192, v193
 v_mfma_f32_16x16x32_bf16 v[152:155], a[20:23], a[80:83], v[152:155]
 ds_read_b64_tr_b16 a[200:201], v38 offset:16384
 ds_read_b64_tr_b16 a[202:203], v38 offset:18432
 v_mfma_f32_16x16x32_bf16 v[160:163], a[24:27], a[80:83], v[160:163]
 s_add_u32 m0, s18, 1024
 ds_read_b64_tr_b16 a[232:233], v38 offset:24576
 ds_read_b64_tr_b16 a[234:235], v38 offset:26624
 v_mfma_f32_16x16x32_bf16 v[160:163], a[56:59], a[88:91], v[160:163]
 buffer_load_dwordx4 v9, s[28:31], s15 offen lds
 v_cvt_pk_bf16_f32 v193, v194, v195
 v_cvt_pk_bf16_f32 v194, v224, v225
 v_mfma_f32_16x16x32_bf16 v[164:167], a[56:59], a[92:95], v[164:167]
 ds_read_b64_tr_b16 a[204:205], v39 offset:16384
 v_cvt_pk_bf16_f32 v195, v226, v227
 v_mfma_f32_16x16x32_bf16 v[164:167], a[24:27], a[84:87], v[164:167]
 ds_read_b64_tr_b16 a[206:207], v39 offset:18432
 ds_read_b64_tr_b16 a[236:237], v39 offset:24576
 v_mfma_f32_16x16x32_bf16 v[172:175], a[28:31], a[84:87], v[172:175]
 buffer_load_dwordx4 a[132:135], v1, s[24:27], s12 offen offset:1024 sc1
 ds_read_b128 v[28:31], v44 offset:1536
 v_mfma_f32_16x16x32_bf16 v[172:175], a[60:63], a[92:95], v[172:175]
 ds_read_b64_tr_b16 a[238:239], v39 offset:26624
 v_mul_f32 v34, 0xbede652a, v33
 v_mfma_f32_16x16x32_bf16 v[168:171], a[60:63], a[88:91], v[168:171]
 ds_read_b64_tr_b16 a[208:209], v36 offset:20480
 ds_read_b64_tr_b16 a[210:211], v36 offset:22528
 v_mfma_f32_16x16x32_bf16 v[168:171], a[28:31], a[80:83], v[168:171]
 s_add_u32 m0, s18, 2048
 ds_read_b64_tr_b16 a[240:241], v36 offset:28672
 ds_read_b64_tr_b16 a[242:243], v36 offset:30720
 v_mul_f32 v35, 0xbf206c99, v33
 v_mfma_f32_16x16x32_bf16 v[112:115], a[32:35], a[80:83], v[112:115]
 buffer_load_dwordx4 v10, s[28:31], s15 offen lds
 v_fmac_f32 v196, v12, v32
 v_mfma_f32_16x16x32_bf16 v[112:115], a[64:67], a[88:91], v[112:115]
 ds_read_b64_tr_b16 a[212:213], v37 offset:20480
 v_fmac_f32 v197, v13, v32
 v_mfma_f32_16x16x32_bf16 v[116:119], a[64:67], a[92:95], v[116:119]
 ds_read_b64_tr_b16 a[214:215], v37 offset:22528
 ds_read_b64_tr_b16 a[244:245], v37 offset:28672
 v_mfma_f32_16x16x32_bf16 v[116:119], a[32:35], a[84:87], v[116:119]
 ds_read_b64_tr_b16 a[246:247], v37 offset:30720
 v_fmac_f32 v198, v14, v32
 v_mfma_f32_16x16x32_bf16 v[124:127], a[36:39], a[84:87], v[124:127]
 buffer_load_dwordx4 a[136:139], v1, s[24:27], s12 offen offset:2048 sc1
 v_fmac_f32 v199, v15, v32
 v_mfma_f32_16x16x32_bf16 v[124:127], a[68:71], a[92:95], v[124:127]
 ds_read_b64_tr_b16 a[216:217], v38 offset:20480
 ds_read_b64_tr_b16 a[218:219], v38 offset:22528
 v_fmac_f32 v228, v16, v32
 v_mfma_f32_16x16x32_bf16 v[120:123], a[68:71], a[88:91], v[120:123]
 s_add_u32 m0, s18, 3072
 ds_read_b64_tr_b16 a[248:249], v38 offset:28672
 ds_read_b64_tr_b16 a[250:251], v38 offset:30720
 v_mfma_f32_16x16x32_bf16 v[120:123], a[36:39], a[80:83], v[120:123]
 buffer_load_dwordx4 v11, s[28:31], s15 offen lds
 v_fmac_f32 v229, v17, v32
 v_mfma_f32_16x16x32_bf16 v[128:131], a[40:43], a[80:83], v[128:131]
 ds_read_b64_tr_b16 a[220:221], v39 offset:20480
 v_fmac_f32 v230, v18, v32
 v_mfma_f32_16x16x32_bf16 v[128:131], a[72:75], a[88:91], v[128:131]
 ds_read_b64_tr_b16 a[222:223], v39 offset:22528
 ds_read_b64_tr_b16 a[252:253], v39 offset:28672
 v_mfma_f32_16x16x32_bf16 v[132:135], a[72:75], a[92:95], v[132:135]
 ds_read_b64_tr_b16 a[254:255], v39 offset:30720
 v_fmac_f32 v231, v19, v32
 v_mfma_f32_16x16x32_bf16 v[132:135], a[40:43], a[84:87], v[132:135]
 buffer_load_dwordx4 a[140:143], v1, s[24:27], s12 offen offset:3072 sc1
 v_mul_f32 v240, v196, v35
 v_mul_f32 v241, v197, v35
 v_mfma_f32_16x16x32_bf16 v[140:143], a[44:47], a[84:87], v[140:143]
 v_mul_f32 v242, v198, v35
 v_mul_f32 v243, v199, v35
 v_mfma_f32_16x16x32_bf16 v[140:143], a[76:79], a[92:95], v[140:143]
 v_mul_f32 v244, v228, v35
 v_mul_f32 v245, v229, v35
 v_mfma_f32_16x16x32_bf16 v[136:139], a[76:79], a[88:91], v[136:139]
 v_mul_f32 v246, v230, v35
 v_mul_f32 v247, v231, v35
 v_mfma_f32_16x16x32_bf16 v[136:139], a[44:47], a[80:83], v[136:139]
 s_add_u32 s12, s12, 4096
 v_exp_f32_e64 v240, v240 clamp
 s_waitcnt vmcnt(16) lgkmcnt(0)
 v_mfma_f32_16x16x32_bf16 v[144:147], a[192:195], a[96:99], v[144:147]
 s_barrier
 s_add_u32 s15, s14, 1966080
 ds_read_b64_tr_b16 a[16:17], v36 offset:32768
 ds_read_b64_tr_b16 a[18:19], v36 offset:34816
 v_mfma_f32_16x16x32_bf16 v[144:147], a[224:227], a[104:107], v[144:147]
 s_add_u32 m0, s18, 16384
 ds_read_b64_tr_b16 a[48:49], v36 offset:40960
 ds_read_b64_tr_b16 a[50:51], v36 offset:43008
 v_mfma_f32_16x16x32_bf16 v[148:151], a[224:227], a[108:111], v[148:151]
 buffer_load_dwordx4 v8, s[28:31], s15 offen lds
 v_max_f32 v196, 0, v196
 v_fma_f32 v196, v196, v34, s68
 v_mfma_f32_16x16x32_bf16 v[148:151], a[192:195], a[100:103], v[148:151]
 ds_read_b64_tr_b16 a[20:21], v37 offset:32768
 v_mfma_f32_16x16x32_bf16 v[156:159], a[196:199], a[100:103], v[156:159]
 ds_read_b64_tr_b16 a[22:23], v37 offset:34816
 ds_read_b64_tr_b16 a[52:53], v37 offset:40960
 v_mfma_f32_16x16x32_bf16 v[156:159], a[228:231], a[108:111], v[156:159]
 buffer_load_dwordx4 a[80:83], v1, s[24:27], s12 offen sc1
 v_exp_f32_e64 v241, v241 clamp
 v_mfma_f32_16x16x32_bf16 v[152:155], a[228:231], a[104:107], v[152:155]
 ds_read_b64_tr_b16 a[54:55], v37 offset:43008
 v_max_f32 v197, 0, v197
 v_mfma_f32_16x16x32_bf16 v[152:155], a[196:199], a[96:99], v[152:155]
 ds_read_b64_tr_b16 a[24:25], v38 offset:32768
 ds_read_b64_tr_b16 a[26:27], v38 offset:34816
 v_mfma_f32_16x16x32_bf16 v[160:163], a[200:203], a[96:99], v[160:163]
 s_add_u32 m0, s18, 17408
 ds_read_b64_tr_b16 a[56:57], v38 offset:40960
 ds_read_b64_tr_b16 a[58:59], v38 offset:43008
 v_fma_f32 v197, v197, v34, s68
 v_mfma_f32_16x16x32_bf16 v[160:163], a[232:235], a[104:107], v[160:163]
 buffer_load_dwordx4 v9, s[28:31], s15 offen lds
 v_mfma_f32_16x16x32_bf16 v[164:167], a[232:235], a[108:111], v[164:167]
 ds_read_b64_tr_b16 a[28:29], v39 offset:32768
 v_exp_f32_e64 v242, v242 clamp
 v_mfma_f32_16x16x32_bf16 v[164:167], a[200:203], a[100:103], v[164:167]
 s_branch L_tp_L_tA_10_o
L_tp_L_tA_10:
 s_nop 0
 s_nop 0
 s_branch L_tp_L_tA_12
L_tp_L_tA_10_o:
 ds_read_b64_tr_b16 a[30:31], v39 offset:34816
 ds_read_b64_tr_b16 a[60:61], v39 offset:40960
 v_mfma_f32_16x16x32_bf16 v[172:175], a[204:207], a[100:103], v[172:175]
 buffer_load_dwordx4 a[84:87], v1, s[24:27], s12 offen offset:1024 sc1
 v_max_f32 v198, 0, v198
 v_mfma_f32_16x16x32_bf16 v[172:175], a[236:239], a[108:111], v[172:175]
 ds_read_b64_tr_b16 a[62:63], v39 offset:43008
 v_fma_f32 v198, v198, v34, s68
 v_mfma_f32_16x16x32_bf16 v[168:171], a[236:239], a[104:107], v[168:171]
 ds_read_b64_tr_b16 a[32:33], v36 offset:36864
 ds_read_b64_tr_b16 a[34:35], v36 offset:38912
 v_mfma_f32_16x16x32_bf16 v[168:171], a[204:207], a[96:99], v[168:171]
 s_add_u32 m0, s18, 18432
 ds_read_b64_tr_b16 a[64:65], v36 offset:45056
 ds_read_b64_tr_b16 a[66:67], v36 offset:47104
 v_mfma_f32_16x16x32_bf16 v[112:115], a[208:211], a[96:99], v[112:115]
 buffer_load_dwordx4 v10, s[28:31], s15 offen lds
 v_exp_f32_e64 v243, v243 clamp
 v_mfma_f32_16x16x32_bf16 v[112:115], a[240:243], a[104:107], v[112:115]
 ds_read_b64_tr_b16 a[36:37], v37 offset:36864
 v_max_f32 v199, 0, v199
 v_mfma_f32_16x16x32_bf16 v[116:119], a[240:243], a[108:111], v[116:119]
 ds_read_b64_tr_b16 a[38:39], v37 offset:38912
 ds_read_b64_tr_b16 a[68:69], v37 offset:45056
 v_mfma_f32_16x16x32_bf16 v[116:119], a[208:211], a[100:103], v[116:119]
 ds_read_b64_tr_b16 a[70:71], v37 offset:47104
 v_fma_f32 v199, v199, v34, s68
 v_mfma_f32_16x16x32_bf16 v[124:127], a[212:215], a[100:103], v[124:127]
 buffer_load_dwordx4 a[88:91], v1, s[24:27], s12 offen offset:2048 sc1
 v_exp_f32_e64 v244, v244 clamp
 v_mfma_f32_16x16x32_bf16 v[124:127], a[244:247], a[108:111], v[124:127]
 ds_read_b64_tr_b16 a[40:41], v38 offset:36864
 ds_read_b64_tr_b16 a[42:43], v38 offset:38912
 v_mfma_f32_16x16x32_bf16 v[120:123], a[244:247], a[104:107], v[120:123]
 s_add_u32 m0, s18, 19456
 ds_read_b64_tr_b16 a[72:73], v38 offset:45056
 ds_read_b64_tr_b16 a[74:75], v38 offset:47104
 v_mfma_f32_16x16x32_bf16 v[120:123], a[212:215], a[96:99], v[120:123]
 buffer_load_dwordx4 v11, s[28:31], s15 offen lds
 v_max_f32 v228, 0, v228
 v_mfma_f32_16x16x32_bf16 v[128:131], a[216:219], a[96:99], v[128:131]
 ds_read_b64_tr_b16 a[44:45], v39 offset:36864
 v_fma_f32 v228, v228, v34, s68
 v_mfma_f32_16x16x32_bf16 v[128:131], a[248:251], a[104:107], v[128:131]
 ds_read_b64_tr_b16 a[46:47], v39 offset:38912
 ds_read_b64_tr_b16 a[76:77], v39 offset:45056
 v_mfma_f32_16x16x32_bf16 v[132:135], a[248:251], a[108:111], v[132:135]
 ds_read_b64_tr_b16 a[78:79], v39 offset:47104
 v_exp_f32_e64 v245, v245 clamp
 v_mfma_f32_16x16x32_bf16 v[132:135], a[216:219], a[100:103], v[132:135]
 buffer_load_dwordx4 a[92:95], v1, s[24:27], s12 offen offset:3072 sc1
 v_max_f32 v229, 0, v229
 v_mfma_f32_16x16x32_bf16 v[140:143], a[220:223], a[100:103], v[140:143]
 v_fma_f32 v229, v229, v34, s68
 v_mfma_f32_16x16x32_bf16 v[140:143], a[252:255], a[108:111], v[140:143]
 v_exp_f32_e64 v246, v246 clamp
 v_max_f32 v230, 0, v230
 v_mfma_f32_16x16x32_bf16 v[136:139], a[252:255], a[104:107], v[136:139]
 v_fma_f32 v230, v230, v34, s68
 v_exp_f32_e64 v247, v247 clamp
 v_mfma_f32_16x16x32_bf16 v[136:139], a[220:223], a[96:99], v[136:139]
 s_add_u32 s12, s12, 4096
 v_max_f32 v231, 0, v231
 s_waitcnt vmcnt(16) lgkmcnt(0)
 v_mfma_f32_16x16x32_bf16 v[144:147], a[16:19], a[112:115], v[144:147]
 s_barrier
 s_add_u32 s15, s14, 2621440
 ds_read_b64_tr_b16 a[192:193], v36 offset:49152
 ds_read_b64_tr_b16 a[194:195], v36 offset:51200
 v_mfma_f32_16x16x32_bf16 v[144:147], a[48:51], a[120:123], v[144:147]
 s_add_u32 m0, s18, 32768
 ds_read_b64_tr_b16 a[224:225], v36 offset:57344
 ds_read_b64_tr_b16 a[226:227], v36 offset:59392
 v_mfma_f32_16x16x32_bf16 v[148:151], a[48:51], a[124:127], v[148:151]
 buffer_load_dwordx4 v8, s[28:31], s15 offen lds
 v_fma_f32 v231, v231, v34, s68
 v_add_f32 v196, v196, v240
 v_mfma_f32_16x16x32_bf16 v[148:151], a[16:19], a[116:119], v[148:151]
 ds_read_b64_tr_b16 a[196:197], v37 offset:49152
 v_add_f32 v197, v197, v241
 v_mfma_f32_16x16x32_bf16 v[156:159], a[20:23], a[116:119], v[156:159]
 ds_read_b64_tr_b16 a[198:199], v37 offset:51200
 ds_read_b64_tr_b16 a[228:229], v37 offset:57344
 v_mfma_f32_16x16x32_bf16 v[156:159], a[52:55], a[124:127], v[156:159]
 buffer_load_dwordx4 a[96:99], v1, s[24:27], s12 offen sc1
 v_add_f32 v198, v198, v242
 v_mfma_f32_16x16x32_bf16 v[152:155], a[52:55], a[120:123], v[152:155]
 ds_read_b64_tr_b16 a[230:231], v37 offset:59392
 v_add_f32 v199, v199, v243
 v_mfma_f32_16x16x32_bf16 v[152:155], a[20:23], a[112:115], v[152:155]
 ds_read_b64_tr_b16 a[200:201], v38 offset:49152
 ds_read_b64_tr_b16 a[202:203], v38 offset:51200
 v_mfma_f32_16x16x32_bf16 v[160:163], a[24:27], a[112:115], v[160:163]
 s_add_u32 m0, s18, 33792
 ds_read_b64_tr_b16 a[232:233], v38 offset:57344
 ds_read_b64_tr_b16 a[234:235], v38 offset:59392
 v_add_f32 v228, v228, v244
 v_mfma_f32_16x16x32_bf16 v[160:163], a[56:59], a[120:123], v[160:163]
 buffer_load_dwordx4 v9, s[28:31], s15 offen lds
 v_add_f32 v229, v229, v245
 v_mfma_f32_16x16x32_bf16 v[164:167], a[56:59], a[124:127], v[164:167]
 ds_read_b64_tr_b16 a[204:205], v39 offset:49152
 v_add_f32 v230, v230, v246
 v_mfma_f32_16x16x32_bf16 v[164:167], a[24:27], a[116:119], v[164:167]
 ds_read_b64_tr_b16 a[206:207], v39 offset:51200
 ds_read_b64_tr_b16 a[236:237], v39 offset:57344
 v_mfma_f32_16x16x32_bf16 v[172:175], a[28:31], a[116:119], v[172:175]
 buffer_load_dwordx4 a[100:103], v1, s[24:27], s12 offen offset:1024 sc1
 v_add_f32 v231, v231, v247
 v_mfma_f32_16x16x32_bf16 v[172:175], a[60:63], a[124:127], v[172:175]
 ds_read_b64_tr_b16 a[238:239], v39 offset:59392
 v_cvt_pk_bf16_f32 v196, v196, v197
 v_mfma_f32_16x16x32_bf16 v[168:171], a[60:63], a[120:123], v[168:171]
 ds_read_b64_tr_b16 a[208:209], v36 offset:53248
 ds_read_b64_tr_b16 a[210:211], v36 offset:55296
 v_cvt_pk_bf16_f32 v197, v198, v199
 v_mfma_f32_16x16x32_bf16 v[168:171], a[28:31], a[112:115], v[168:171]
 s_add_u32 m0, s18, 34816
 ds_read_b64_tr_b16 a[240:241], v36 offset:61440
 ds_read_b64_tr_b16 a[242:243], v36 offset:63488
 v_mfma_f32_16x16x32_bf16 v[112:115], a[32:35], a[112:115], v[112:115]
 buffer_load_dwordx4 v10, s[28:31], s15 offen lds
 v_cvt_pk_bf16_f32 v198, v228, v229
 v_mfma_f32_16x16x32_bf16 v[112:115], a[64:67], a[120:123], v[112:115]
 ds_read_b64_tr_b16 a[212:213], v37 offset:53248
 v_cvt_pk_bf16_f32 v199, v230, v231
 v_mfma_f32_16x16x32_bf16 v[116:119], a[64:67], a[124:127], v[116:119]
 ds_read_b64_tr_b16 a[214:215], v37 offset:55296
 ds_read_b64_tr_b16 a[244:245], v37 offset:61440
 ds_read_b128 v[32:35], v44 offset:1792
 v_mfma_f32_16x16x32_bf16 v[116:119], a[32:35], a[116:119], v[116:119]
 ds_read_b64_tr_b16 a[246:247], v37 offset:63488
 v_mfma_f32_16x16x32_bf16 v[124:127], a[36:39], a[116:119], v[124:127]
 buffer_load_dwordx4 a[104:107], v1, s[24:27], s12 offen offset:2048 sc1
 v_mul_f32 v30, 0xbede652a, v29
 v_mul_f32 v31, 0xbf206c99, v29
 v_mfma_f32_16x16x32_bf16 v[124:127], a[68:71], a[124:127], v[124:127]
 ds_read_b64_tr_b16 a[216:217], v38 offset:53248
 ds_read_b64_tr_b16 a[218:219], v38 offset:55296
 v_mfma_f32_16x16x32_bf16 v[120:123], a[68:71], a[120:123], v[120:123]
 s_add_u32 m0, s18, 35840
 ds_read_b64_tr_b16 a[248:249], v38 offset:61440
 ds_read_b64_tr_b16 a[250:251], v38 offset:63488
 v_mfma_f32_16x16x32_bf16 v[120:123], a[36:39], a[112:115], v[120:123]
 buffer_load_dwordx4 v11, s[28:31], s15 offen lds
 v_fmac_f32 v200, v12, v28
 v_mfma_f32_16x16x32_bf16 v[128:131], a[40:43], a[112:115], v[128:131]
 ds_read_b64_tr_b16 a[220:221], v39 offset:53248
 v_fmac_f32 v201, v13, v28
 v_mfma_f32_16x16x32_bf16 v[128:131], a[72:75], a[120:123], v[128:131]
 ds_read_b64_tr_b16 a[222:223], v39 offset:55296
 ds_read_b64_tr_b16 a[252:253], v39 offset:61440
 v_mfma_f32_16x16x32_bf16 v[132:135], a[72:75], a[124:127], v[132:135]
 ds_read_b64_tr_b16 a[254:255], v39 offset:63488
 v_fmac_f32 v202, v14, v28
 v_fmac_f32 v203, v15, v28
 v_mfma_f32_16x16x32_bf16 v[132:135], a[40:43], a[116:119], v[132:135]
 buffer_load_dwordx4 a[108:111], v1, s[24:27], s12 offen offset:3072 sc1
 v_fmac_f32 v232, v16, v28
 v_mfma_f32_16x16x32_bf16 v[140:143], a[44:47], a[116:119], v[140:143]
 v_fmac_f32 v233, v17, v28
 v_fmac_f32 v234, v18, v28
 v_mfma_f32_16x16x32_bf16 v[140:143], a[76:79], a[124:127], v[140:143]
 v_fmac_f32 v235, v19, v28
 v_mul_f32 v240, v200, v31
 v_mfma_f32_16x16x32_bf16 v[136:139], a[76:79], a[120:123], v[136:139]
 v_mul_f32 v241, v201, v31
 v_mul_f32 v242, v202, v31
 v_mfma_f32_16x16x32_bf16 v[136:139], a[44:47], a[112:115], v[136:139]
 s_add_u32 s12, s12, 4096
 v_mul_f32 v243, v203, v31
 v_mul_f32 v244, v232, v31
 s_waitcnt vmcnt(16) lgkmcnt(0)
 v_mfma_f32_16x16x32_bf16 v[144:147], a[192:195], a[128:131], v[144:147]
 s_barrier
 s_add_u32 s15, s14, 2359296
 ds_read_b64_tr_b16 a[16:17], v36 offset:0
 ds_read_b64_tr_b16 a[18:19], v36 offset:2048
 v_mul_f32 v245, v233, v31
 v_mfma_f32_16x16x32_bf16 v[144:147], a[224:227], a[136:139], v[144:147]
 s_add_u32 m0, s18, 49152
 ds_read_b64_tr_b16 a[48:49], v36 offset:8192
 ds_read_b64_tr_b16 a[50:51], v36 offset:10240
 v_mfma_f32_16x16x32_bf16 v[148:151], a[224:227], a[140:143], v[148:151]
 buffer_load_dwordx4 v8, s[28:31], s15 offen lds
 v_mul_f32 v246, v234, v31
 v_mfma_f32_16x16x32_bf16 v[148:151], a[192:195], a[132:135], v[148:151]
 ds_read_b64_tr_b16 a[20:21], v37 offset:0
 v_mul_f32 v247, v235, v31
 v_mfma_f32_16x16x32_bf16 v[156:159], a[196:199], a[132:135], v[156:159]
 ds_read_b64_tr_b16 a[22:23], v37 offset:2048
 ds_read_b64_tr_b16 a[52:53], v37 offset:8192
 v_mfma_f32_16x16x32_bf16 v[156:159], a[228:231], a[140:143], v[156:159]
 buffer_load_dwordx4 a[112:115], v1, s[24:27], s12 offen sc1
 v_exp_f32_e64 v240, v240 clamp
 v_mfma_f32_16x16x32_bf16 v[152:155], a[228:231], a[136:139], v[152:155]
 ds_read_b64_tr_b16 a[54:55], v37 offset:10240
 v_max_f32 v200, 0, v200
 v_mfma_f32_16x16x32_bf16 v[152:155], a[196:199], a[128:131], v[152:155]
 ds_read_b64_tr_b16 a[24:25], v38 offset:0
 ds_read_b64_tr_b16 a[26:27], v38 offset:2048
 v_mfma_f32_16x16x32_bf16 v[160:163], a[200:203], a[128:131], v[160:163]
 s_add_u32 m0, s18, 50176
 ds_read_b64_tr_b16 a[56:57], v38 offset:8192
 ds_read_b64_tr_b16 a[58:59], v38 offset:10240
 v_mfma_f32_16x16x32_bf16 v[160:163], a[232:235], a[136:139], v[160:163]
 buffer_load_dwordx4 v9, s[28:31], s15 offen lds
 v_fma_f32 v200, v200, v30, s68
 v_mfma_f32_16x16x32_bf16 v[164:167], a[232:235], a[140:143], v[164:167]
 ds_read_b64_tr_b16 a[28:29], v39 offset:0
 v_exp_f32_e64 v241, v241 clamp
 v_mfma_f32_16x16x32_bf16 v[164:167], a[200:203], a[132:135], v[164:167]
 ds_read_b64_tr_b16 a[30:31], v39 offset:2048
 ds_read_b64_tr_b16 a[60:61], v39 offset:8192
 v_mfma_f32_16x16x32_bf16 v[172:175], a[204:207], a[132:135], v[172:175]
 buffer_load_dwordx4 a[116:119], v1, s[24:27], s12 offen offset:1024 sc1
 v_max_f32 v201, 0, v201
 v_mfma_f32_16x16x32_bf16 v[172:175], a[236:239], a[140:143], v[172:175]
 ds_read_b64_tr_b16 a[62:63], v39 offset:10240
 v_fma_f32 v201, v201, v30, s68
 v_mfma_f32_16x16x32_bf16 v[168:171], a[236:239], a[136:139], v[168:171]
 ds_read_b64_tr_b16 a[32:33], v36 offset:4096
 ds_read_b64_tr_b16 a[34:35], v36 offset:6144
 v_mfma_f32_16x16x32_bf16 v[168:171], a[204:207], a[128:131], v[168:171]
 s_add_u32 m0, s18, 51200
 ds_read_b64_tr_b16 a[64:65], v36 offset:12288
 ds_read_b64_tr_b16 a[66:67], v36 offset:14336
 v_mfma_f32_16x16x32_bf16 v[112:115], a[208:211], a[128:131], v[112:115]
 buffer_load_dwordx4 v10, s[28:31], s15 offen lds
 v_exp_f32_e64 v242, v242 clamp
 v_mfma_f32_16x16x32_bf16 v[112:115], a[240:243], a[136:139], v[112:115]
 ds_read_b64_tr_b16 a[36:37], v37 offset:4096
 v_mfma_f32_16x16x32_bf16 v[116:119], a[240:243], a[140:143], v[116:119]
 ds_read_b64_tr_b16 a[38:39], v37 offset:6144
 ds_read_b64_tr_b16 a[68:69], v37 offset:12288
 v_max_f32 v202, 0, v202
 v_mfma_f32_16x16x32_bf16 v[116:119], a[208:211], a[132:135], v[116:119]
 ds_read_b64_tr_b16 a[70:71], v37 offset:14336
 v_fma_f32 v202, v202, v30, s68
 v_mfma_f32_16x16x32_bf16 v[124:127], a[212:215], a[132:135], v[124:127]
 buffer_load_dwordx4 a[120:123], v1, s[24:27], s12 offen offset:2048 sc1
 v_exp_f32_e64 v243, v243 clamp
 v_mfma_f32_16x16x32_bf16 v[124:127], a[244:247], a[140:143], v[124:127]
 ds_read_b64_tr_b16 a[40:41], v38 offset:4096
 ds_read_b64_tr_b16 a[42:43], v38 offset:6144
 v_mfma_f32_16x16x32_bf16 v[120:123], a[244:247], a[136:139], v[120:123]
 s_add_u32 m0, s18, 52224
 ds_read_b64_tr_b16 a[72:73], v38 offset:12288
 ds_read_b64_tr_b16 a[74:75], v38 offset:14336
 v_mfma_f32_16x16x32_bf16 v[120:123], a[212:215], a[128:131], v[120:123]
 buffer_load_dwordx4 v11, s[28:31], s15 offen lds
 v_max_f32 v203, 0, v203
 v_mfma_f32_16x16x32_bf16 v[128:131], a[216:219], a[128:131], v[128:131]
 ds_read_b64_tr_b16 a[44:45], v39 offset:4096
 v_fma_f32 v203, v203, v30, s68
 v_mfma_f32_16x16x32_bf16 v[128:131], a[248:251], a[136:139], v[128:131]
 ds_read_b64_tr_b16 a[46:47], v39 offset:6144
 ds_read_b64_tr_b16 a[76:77], v39 offset:12288
 v_mfma_f32_16x16x32_bf16 v[132:135], a[248:251], a[140:143], v[132:135]
 ds_read_b64_tr_b16 a[78:79], v39 offset:14336
 v_exp_f32_e64 v244, v244 clamp
 v_mfma_f32_16x16x32_bf16 v[132:135], a[216:219], a[132:135], v[132:135]
 buffer_load_dwordx4 a[124:127], v1, s[24:27], s12 offen offset:3072 sc1
 v_mfma_f32_16x16x32_bf16 v[140:143], a[220:223], a[132:135], v[140:143]
 v_max_f32 v232, 0, v232
 v_fma_f32 v232, v232, v30, s68
 v_mfma_f32_16x16x32_bf16 v[140:143], a[252:255], a[140:143], v[140:143]
 v_exp_f32_e64 v245, v245 clamp
 v_max_f32 v233, 0, v233
 v_mfma_f32_16x16x32_bf16 v[136:139], a[252:255], a[136:139], v[136:139]
 v_fma_f32 v233, v233, v30, s68
 v_mfma_f32_16x16x32_bf16 v[136:139], a[220:223], a[128:131], v[136:139]
 s_add_u32 s12, s12, 4096
 v_exp_f32_e64 v246, v246 clamp
 v_max_f32 v234, 0, v234
 s_waitcnt vmcnt(16) lgkmcnt(0)
 v_mfma_f32_16x16x32_bf16 v[144:147], a[16:19], a[80:83], v[144:147]
 s_barrier
 s_add_u32 s15, s14, 2752512
 ds_read_b64_tr_b16 a[192:193], v36 offset:16384
 ds_read_b64_tr_b16 a[194:195], v36 offset:18432
 v_mfma_f32_16x16x32_bf16 v[144:147], a[48:51], a[88:91], v[144:147]
 s_add_u32 m0, s18, 0
 ds_read_b64_tr_b16 a[224:225], v36 offset:24576
 ds_read_b64_tr_b16 a[226:227], v36 offset:26624
 v_mfma_f32_16x16x32_bf16 v[148:151], a[48:51], a[92:95], v[148:151]
 buffer_load_dwordx4 v8, s[28:31], s15 offen lds
 v_fma_f32 v234, v234, v30, s68
 v_mfma_f32_16x16x32_bf16 v[148:151], a[16:19], a[84:87], v[148:151]
 ds_read_b64_tr_b16 a[196:197], v37 offset:16384
 v_exp_f32_e64 v247, v247 clamp
 v_mfma_f32_16x16x32_bf16 v[156:159], a[20:23], a[84:87], v[156:159]
 ds_read_b64_tr_b16 a[198:199], v37 offset:18432
 ds_read_b64_tr_b16 a[228:229], v37 offset:24576
 v_mfma_f32_16x16x32_bf16 v[156:159], a[52:55], a[92:95], v[156:159]
 buffer_load_dwordx4 a[128:131], v1, s[24:27], s12 offen sc1
 v_max_f32 v235, 0, v235
 v_mfma_f32_16x16x32_bf16 v[152:155], a[52:55], a[88:91], v[152:155]
 ds_read_b64_tr_b16 a[230:231], v37 offset:26624
 v_fma_f32 v235, v235, v30, s68
 v_mfma_f32_16x16x32_bf16 v[152:155], a[20:23], a[80:83], v[152:155]
 ds_read_b64_tr_b16 a[200:201], v38 offset:16384
 ds_read_b64_tr_b16 a[202:203], v38 offset:18432
 v_mfma_f32_16x16x32_bf16 v[160:163], a[24:27], a[80:83], v[160:163]
 s_add_u32 m0, s18, 1024
 ds_read_b64_tr_b16 a[232:233], v38 offset:24576
 ds_read_b64_tr_b16 a[234:235], v38 offset:26624
 v_mfma_f32_16x16x32_bf16 v[160:163], a[56:59], a[88:91], v[160:163]
 buffer_load_dwordx4 v9, s[28:31], s15 offen lds
 v_add_f32 v200, v200, v240
 v_add_f32 v201, v201, v241
 v_mfma_f32_16x16x32_bf16 v[164:167], a[56:59], a[92:95], v[164:167]
 ds_read_b64_tr_b16 a[204:205], v39 offset:16384
 v_add_f32 v202, v202, v242
 v_mfma_f32_16x16x32_bf16 v[164:167], a[24:27], a[84:87], v[164:167]
 ds_read_b64_tr_b16 a[206:207], v39 offset:18432
 ds_read_b64_tr_b16 a[236:237], v39 offset:24576
 v_mfma_f32_16x16x32_bf16 v[172:175], a[28:31], a[84:87], v[172:175]
 buffer_load_dwordx4 a[132:135], v1, s[24:27], s12 offen offset:1024 sc1
 v_add_f32 v203, v203, v243
 v_mfma_f32_16x16x32_bf16 v[172:175], a[60:63], a[92:95], v[172:175]
 s_and_b32 s64, s2, 0xc6
 ds_read_b64_tr_b16 a[238:239], v39 offset:26624
 v_add_f32 v232, v232, v244
 v_mfma_f32_16x16x32_bf16 v[168:171], a[60:63], a[88:91], v[168:171]
 s_or_b32 s64, s64, s52
 ds_read_b64_tr_b16 a[208:209], v36 offset:20480
 ds_read_b64_tr_b16 a[210:211], v36 offset:22528
 v_mfma_f32_16x16x32_bf16 v[168:171], a[28:31], a[80:83], v[168:171]
 s_add_u32 m0, s18, 2048
 ds_read_b64_tr_b16 a[240:241], v36 offset:28672
 ds_read_b64_tr_b16 a[242:243], v36 offset:30720
 v_add_f32 v233, v233, v245
 v_mfma_f32_16x16x32_bf16 v[112:115], a[32:35], a[80:83], v[112:115]
 s_lshl_b32 s64, s64, 15
 buffer_load_dwordx4 v10, s[28:31], s15 offen lds
 v_add_f32 v234, v234, v246
 v_mfma_f32_16x16x32_bf16 v[112:115], a[64:67], a[88:91], v[112:115]
 s_add_u32 s64, s64, 22283264
 ds_read_b64_tr_b16 a[212:213], v37 offset:20480
 v_add_f32 v235, v235, v247
 v_mfma_f32_16x16x32_bf16 v[116:119], a[64:67], a[92:95], v[116:119]
 s_add_u32 s66, s64, 524288
 ds_read_b64_tr_b16 a[214:215], v37 offset:22528
 ds_read_b64_tr_b16 a[244:245], v37 offset:28672
 v_mfma_f32_16x16x32_bf16 v[116:119], a[32:35], a[84:87], v[116:119]
 s_add_u32 s67, s64, 8192
 ds_read_b64_tr_b16 a[246:247], v37 offset:30720
 v_cvt_pk_bf16_f32 v200, v200, v201
 v_mfma_f32_16x16x32_bf16 v[124:127], a[36:39], a[84:87], v[124:127]
 buffer_load_dwordx4 a[136:139], v1, s[24:27], s12 offen offset:2048 sc1
 v_cvt_pk_bf16_f32 v201, v202, v203
 v_mfma_f32_16x16x32_bf16 v[124:127], a[68:71], a[92:95], v[124:127]
 ds_read_b64_tr_b16 a[216:217], v38 offset:20480
 ds_read_b64_tr_b16 a[218:219], v38 offset:22528
 v_cvt_pk_bf16_f32 v202, v232, v233
 v_mfma_f32_16x16x32_bf16 v[120:123], a[68:71], a[88:91], v[120:123]
 s_add_u32 m0, s18, 3072
 ds_read_b64_tr_b16 a[248:249], v38 offset:28672
 ds_read_b64_tr_b16 a[250:251], v38 offset:30720
 v_mfma_f32_16x16x32_bf16 v[120:123], a[36:39], a[80:83], v[120:123]
 buffer_load_dwordx4 v11, s[28:31], s15 offen lds
 v_cvt_pk_bf16_f32 v203, v234, v235
 v_mfma_f32_16x16x32_bf16 v[128:131], a[40:43], a[80:83], v[128:131]
 ds_read_b64_tr_b16 a[220:221], v39 offset:20480
 v_mul_f32 v34, 0xbede652a, v33
 v_mfma_f32_16x16x32_bf16 v[128:131], a[72:75], a[88:91], v[128:131]
 ds_read_b64_tr_b16 a[222:223], v39 offset:22528
 ds_read_b64_tr_b16 a[252:253], v39 offset:28672
 v_mfma_f32_16x16x32_bf16 v[132:135], a[72:75], a[92:95], v[132:135]
 ds_read_b64_tr_b16 a[254:255], v39 offset:30720
 v_mul_f32 v35, 0xbf206c99, v33
 v_mfma_f32_16x16x32_bf16 v[132:135], a[40:43], a[84:87], v[132:135]
 buffer_load_dwordx4 a[140:143], v1, s[24:27], s12 offen offset:3072 sc1
 v_fmac_f32 v204, v12, v32
 v_fmac_f32 v205, v13, v32
 v_mfma_f32_16x16x32_bf16 v[140:143], a[44:47], a[84:87], v[140:143]
 v_fmac_f32 v206, v14, v32
 v_fmac_f32 v207, v15, v32
 v_mfma_f32_16x16x32_bf16 v[140:143], a[76:79], a[92:95], v[140:143]
 v_fmac_f32 v236, v16, v32
 v_fmac_f32 v237, v17, v32
 v_mfma_f32_16x16x32_bf16 v[136:139], a[76:79], a[88:91], v[136:139]
 v_fmac_f32 v238, v18, v32
 v_fmac_f32 v239, v19, v32
 v_mfma_f32_16x16x32_bf16 v[136:139], a[44:47], a[80:83], v[136:139]
 s_add_u32 s12, s12, 4096
 v_mul_f32 v240, v204, v35
 v_mul_f32 v241, v205, v35
 s_waitcnt vmcnt(16) lgkmcnt(0)
 v_mfma_f32_16x16x32_bf16 v[144:147], a[192:195], a[96:99], v[144:147]
 s_barrier
 ds_read_b64_tr_b16 a[16:17], v36 offset:32768
 ds_read_b64_tr_b16 a[18:19], v36 offset:34816
 v_mfma_f32_16x16x32_bf16 v[144:147], a[224:227], a[104:107], v[144:147]
 buffer_load_dwordx4 v[100:103], v1, s[24:27], s64 offen sc1
 v_mul_f32 v242, v206, v35
 v_mul_f32 v243, v207, v35
 v_mfma_f32_16x16x32_bf16 v[148:151], a[224:227], a[108:111], v[148:151]
 buffer_load_dwordx4 v[104:107], v1, s[24:27], s66 offen sc1
 v_mul_f32 v244, v236, v35
 v_mfma_f32_16x16x32_bf16 v[148:151], a[192:195], a[100:103], v[148:151]
 s_add_u32 s15, s14, 2883584
 buffer_load_dwordx4 v[108:111], v1, s[24:27], s67 offen sc1
 v_mul_f32 v245, v237, v35
 v_mfma_f32_16x16x32_bf16 v[156:159], a[196:199], a[100:103], v[156:159]
 s_add_u32 m0, s18, 16384
 ds_read_b64_tr_b16 a[48:49], v36 offset:40960
 ds_read_b64_tr_b16 a[50:51], v36 offset:43008
 v_mfma_f32_16x16x32_bf16 v[156:159], a[228:231], a[108:111], v[156:159]
 buffer_load_dwordx4 v8, s[28:31], s15 offen lds
 v_mul_f32 v246, v238, v35
 v_mfma_f32_16x16x32_bf16 v[152:155], a[228:231], a[104:107], v[152:155]
 ds_read_b64_tr_b16 a[20:21], v37 offset:32768
 ds_read_b64_tr_b16 a[22:23], v37 offset:34816
 v_mfma_f32_16x16x32_bf16 v[152:155], a[196:199], a[96:99], v[152:155]
 ds_read_b64_tr_b16 a[52:53], v37 offset:40960
 ds_read_b64_tr_b16 a[54:55], v37 offset:43008
 v_mul_f32 v247, v239, v35
 v_mfma_f32_16x16x32_bf16 v[160:163], a[200:203], a[96:99], v[160:163]
 buffer_load_dwordx4 a[80:83], v1, s[24:27], s12 offen sc1
 v_mfma_f32_16x16x32_bf16 v[160:163], a[232:235], a[104:107], v[160:163]
 ds_read_b64_tr_b16 a[24:25], v38 offset:32768
 ds_read_b64_tr_b16 a[26:27], v38 offset:34816
 v_mfma_f32_16x16x32_bf16 v[164:167], a[232:235], a[108:111], v[164:167]
 s_add_u32 m0, s18, 17408
 ds_read_b64_tr_b16 a[56:57], v38 offset:40960
 ds_read_b64_tr_b16 a[58:59], v38 offset:43008
 v_mfma_f32_16x16x32_bf16 v[164:167], a[200:203], a[100:103], v[164:167]
 buffer_load_dwordx4 v9, s[28:31], s15 offen lds
 v_exp_f32_e64 v240, v240 clamp
 v_mfma_f32_16x16x32_bf16 v[172:175], a[204:207], a[100:103], v[172:175]
 ds_read_b64_tr_b16 a[28:29], v39 offset:32768
 ds_read_b64_tr_b16 a[30:31], v39 offset:34816
 v_mfma_f32_16x16x32_bf16 v[172:175], a[236:239], a[108:111], v[172:175]
 ds_read_b64_tr_b16 a[60:61], v39 offset:40960
 ds_read_b64_tr_b16 a[62:63], v39 offset:43008
 v_mfma_f32_16x16x32_bf16 v[168:171], a[236:239], a[104:107], v[168:171]
 buffer_load_dwordx4 a[84:87], v1, s[24:27], s12 offen offset:1024 sc1
 v_max_f32 v204, 0, v204
 v_fma_f32 v204, v204, v34, s68
 v_mfma_f32_16x16x32_bf16 v[168:171], a[204:207], a[96:99], v[168:171]
 ds_read_b64_tr_b16 a[32:33], v36 offset:36864
 v_mfma_f32_16x16x32_bf16 v[112:115], a[208:211], a[96:99], v[112:115]
 ds_read_b64_tr_b16 a[34:35], v36 offset:38912
 ds_read_b64_tr_b16 a[64:65], v36 offset:45056
 v_mfma_f32_16x16x32_bf16 v[112:115], a[240:243], a[104:107], v[112:115]
 s_add_u32 m0, s18, 18432
 ds_read_b64_tr_b16 a[66:67], v36 offset:47104
 ds_read_b64_tr_b16 a[36:37], v37 offset:36864
 v_exp_f32_e64 v241, v241 clamp
 v_mfma_f32_16x16x32_bf16 v[116:119], a[240:243], a[108:111], v[116:119]
 buffer_load_dwordx4 v10, s[28:31], s15 offen lds
 v_mfma_f32_16x16x32_bf16 v[116:119], a[208:211], a[100:103], v[116:119]
 ds_read_b64_tr_b16 a[38:39], v37 offset:38912
 ds_read_b64_tr_b16 a[68:69], v37 offset:45056
 v_mfma_f32_16x16x32_bf16 v[124:127], a[212:215], a[100:103], v[124:127]
 ds_read_b64_tr_b16 a[70:71], v37 offset:47104
 ds_read_b64_tr_b16 a[40:41], v38 offset:36864
 v_max_f32 v205, 0, v205
 v_mfma_f32_16x16x32_bf16 v[124:127], a[244:247], a[108:111], v[124:127]
 buffer_load_dwordx4 a[88:91], v1, s[24:27], s12 offen offset:2048 sc1
 v_fma_f32 v205, v205, v34, s68
 v_mfma_f32_16x16x32_bf16 v[120:123], a[244:247], a[104:107], v[120:123]
 ds_read_b64_tr_b16 a[42:43], v38 offset:38912
 ds_read_b64_tr_b16 a[72:73], v38 offset:45056
 v_mfma_f32_16x16x32_bf16 v[120:123], a[212:215], a[96:99], v[120:123]
 s_add_u32 m0, s18, 19456
 ds_read_b64_tr_b16 a[74:75], v38 offset:47104
 ds_read_b64_tr_b16 a[44:45], v39 offset:36864
 v_mfma_f32_16x16x32_bf16 v[128:131], a[216:219], a[96:99], v[128:131]
 buffer_load_dwordx4 v11, s[28:31], s15 offen lds
 v_exp_f32_e64 v242, v242 clamp
 v_mfma_f32_16x16x32_bf16 v[128:131], a[248:251], a[104:107], v[128:131]
 ds_read_b64_tr_b16 a[46:47], v39 offset:38912
 ds_read_b64_tr_b16 a[76:77], v39 offset:45056
 v_mfma_f32_16x16x32_bf16 v[132:135], a[248:251], a[108:111], v[132:135]
 ds_read_b64_tr_b16 a[78:79], v39 offset:47104
 v_max_f32 v206, 0, v206
 v_mfma_f32_16x16x32_bf16 v[132:135], a[216:219], a[100:103], v[132:135]
 buffer_load_dwordx4 a[92:95], v1, s[24:27], s12 offen offset:3072 sc1
 v_fma_f32 v206, v206, v34, s68
 v_mfma_f32_16x16x32_bf16 v[140:143], a[220:223], a[100:103], v[140:143]
 v_exp_f32_e64 v243, v243 clamp
 v_mfma_f32_16x16x32_bf16 v[140:143], a[252:255], a[108:111], v[140:143]
 v_max_f32 v207, 0, v207
 v_fma_f32 v207, v207, v34, s68
 v_mfma_f32_16x16x32_bf16 v[136:139], a[252:255], a[104:107], v[136:139]
 v_exp_f32_e64 v244, v244 clamp
 v_mfma_f32_16x16x32_bf16 v[136:139], a[220:223], a[96:99], v[136:139]
 s_add_u32 s12, s12, 4096
 buffer_load_dword v47, v24, s[24:27], s60 offen offset:128 sc1
 v_max_f32 v236, 0, v236
 s_waitcnt vmcnt(20) lgkmcnt(0)
 v_mfma_f32_16x16x32_bf16 v[144:147], a[16:19], a[112:115], v[144:147]
 s_barrier
 s_add_u32 s15, s14, 3538944
 ds_read_b64_tr_b16 a[192:193], v36 offset:49152
 ds_read_b64_tr_b16 a[194:195], v36 offset:51200
 v_mfma_f32_16x16x32_bf16 v[144:147], a[48:51], a[120:123], v[144:147]
 s_add_u32 m0, s18, 32768
 ds_read_b64_tr_b16 a[224:225], v36 offset:57344
 ds_read_b64_tr_b16 a[226:227], v36 offset:59392
 v_fma_f32 v236, v236, v34, s68
 v_mfma_f32_16x16x32_bf16 v[148:151], a[48:51], a[124:127], v[148:151]
 buffer_load_dwordx4 v8, s[28:31], s15 offen lds
 v_mfma_f32_16x16x32_bf16 v[148:151], a[16:19], a[116:119], v[148:151]
 ds_read_b64_tr_b16 a[196:197], v37 offset:49152
 v_exp_f32_e64 v245, v245 clamp
 v_mfma_f32_16x16x32_bf16 v[156:159], a[20:23], a[116:119], v[156:159]
 ds_read_b64_tr_b16 a[198:199], v37 offset:51200
 ds_read_b64_tr_b16 a[228:229], v37 offset:57344
 v_mfma_f32_16x16x32_bf16 v[156:159], a[52:55], a[124:127], v[156:159]
 buffer_load_dwordx4 a[96:99], v1, s[24:27], s12 offen sc1
 v_max_f32 v237, 0, v237
 v_mfma_f32_16x16x32_bf16 v[152:155], a[52:55], a[120:123], v[152:155]
 ds_read_b64_tr_b16 a[230:231], v37 offset:59392
 v_fma_f32 v237, v237, v34, s68
 v_mfma_f32_16x16x32_bf16 v[152:155], a[20:23], a[112:115], v[152:155]
 ds_read_b64_tr_b16 a[200:201], v38 offset:49152
 ds_read_b64_tr_b16 a[202:203], v38 offset:51200
 v_mfma_f32_16x16x32_bf16 v[160:163], a[24:27], a[112:115], v[160:163]
 s_add_u32 m0, s18, 33792
 ds_read_b64_tr_b16 a[232:233], v38 offset:57344
 ds_read_b64_tr_b16 a[234:235], v38 offset:59392
 v_mfma_f32_16x16x32_bf16 v[160:163], a[56:59], a[120:123], v[160:163]
 buffer_load_dwordx4 v9, s[28:31], s15 offen lds
 v_exp_f32_e64 v246, v246 clamp
 v_mfma_f32_16x16x32_bf16 v[164:167], a[56:59], a[124:127], v[164:167]
 ds_read_b64_tr_b16 a[204:205], v39 offset:49152
 v_max_f32 v238, 0, v238
 v_mfma_f32_16x16x32_bf16 v[164:167], a[24:27], a[116:119], v[164:167]
 ds_read_b64_tr_b16 a[206:207], v39 offset:51200
 ds_read_b64_tr_b16 a[236:237], v39 offset:57344
 v_mfma_f32_16x16x32_bf16 v[172:175], a[28:31], a[116:119], v[172:175]
 buffer_load_dwordx4 a[100:103], v1, s[24:27], s12 offen offset:1024 sc1
 v_fma_f32 v238, v238, v34, s68
 v_mfma_f32_16x16x32_bf16 v[172:175], a[60:63], a[124:127], v[172:175]
 ds_read_b64_tr_b16 a[238:239], v39 offset:59392
 v_exp_f32_e64 v247, v247 clamp
 v_mfma_f32_16x16x32_bf16 v[168:171], a[60:63], a[120:123], v[168:171]
 ds_read_b64_tr_b16 a[208:209], v36 offset:53248
 ds_read_b64_tr_b16 a[210:211], v36 offset:55296
 v_mfma_f32_16x16x32_bf16 v[168:171], a[28:31], a[112:115], v[168:171]
 s_add_u32 m0, s18, 34816
 ds_read_b64_tr_b16 a[240:241], v36 offset:61440
 ds_read_b64_tr_b16 a[242:243], v36 offset:63488
 v_mfma_f32_16x16x32_bf16 v[112:115], a[32:35], a[112:115], v[112:115]
 buffer_load_dwordx4 v10, s[28:31], s15 offen lds
 v_max_f32 v239, 0, v239
 v_mfma_f32_16x16x32_bf16 v[112:115], a[64:67], a[120:123], v[112:115]
 ds_read_b64_tr_b16 a[212:213], v37 offset:53248
 s_branch L_tp_L_tA_11_o
L_tp_L_tA_11:
 s_nop 0
 s_branch L_tr01
 s_nop 0
L_tp_L_tA_11_o:
 v_fma_f32 v239, v239, v34, s68
 v_mfma_f32_16x16x32_bf16 v[116:119], a[64:67], a[124:127], v[116:119]
 ds_read_b64_tr_b16 a[214:215], v37 offset:55296
 ds_read_b64_tr_b16 a[244:245], v37 offset:61440
 v_mfma_f32_16x16x32_bf16 v[116:119], a[32:35], a[116:119], v[116:119]
 ds_read_b64_tr_b16 a[246:247], v37 offset:63488
 v_add_f32 v204, v204, v240
 v_mfma_f32_16x16x32_bf16 v[124:127], a[36:39], a[116:119], v[124:127]
 buffer_load_dwordx4 a[104:107], v1, s[24:27], s12 offen offset:2048 sc1
 v_add_f32 v205, v205, v241
 v_add_f32 v206, v206, v242
 v_mfma_f32_16x16x32_bf16 v[124:127], a[68:71], a[124:127], v[124:127]
 ds_read_b64_tr_b16 a[216:217], v38 offset:53248
 ds_read_b64_tr_b16 a[218:219], v38 offset:55296
 v_mfma_f32_16x16x32_bf16 v[120:123], a[68:71], a[120:123], v[120:123]
 s_add_u32 m0, s18, 35840
 ds_read_b64_tr_b16 a[248:249], v38 offset:61440
 ds_read_b64_tr_b16 a[250:251], v38 offset:63488
 v_mfma_f32_16x16x32_bf16 v[120:123], a[36:39], a[112:115], v[120:123]
 buffer_load_dwordx4 v11, s[28:31], s15 offen lds
 v_add_f32 v207, v207, v243
 v_mfma_f32_16x16x32_bf16 v[128:131], a[40:43], a[112:115], v[128:131]
 ds_read_b64_tr_b16 a[220:221], v39 offset:53248
 v_add_f32 v236, v236, v244
 v_mfma_f32_16x16x32_bf16 v[128:131], a[72:75], a[120:123], v[128:131]
 ds_read_b64_tr_b16 a[222:223], v39 offset:55296
 ds_read_b64_tr_b16 a[252:253], v39 offset:61440
 v_mfma_f32_16x16x32_bf16 v[132:135], a[72:75], a[124:127], v[132:135]
 ds_read_b64_tr_b16 a[254:255], v39 offset:63488
 v_add_f32 v237, v237, v245
 v_add_f32 v238, v238, v246
 v_mfma_f32_16x16x32_bf16 v[132:135], a[40:43], a[116:119], v[132:135]
 buffer_load_dwordx4 a[108:111], v1, s[24:27], s12 offen offset:3072 sc1
 v_add_f32 v239, v239, v247
 v_mfma_f32_16x16x32_bf16 v[140:143], a[44:47], a[116:119], v[140:143]
 v_cvt_pk_bf16_f32 v204, v204, v205
 v_cvt_pk_bf16_f32 v205, v206, v207
 v_mfma_f32_16x16x32_bf16 v[140:143], a[76:79], a[124:127], v[140:143]
 v_cvt_pk_bf16_f32 v206, v236, v237
 v_cvt_pk_bf16_f32 v207, v238, v239
 v_mfma_f32_16x16x32_bf16 v[136:139], a[76:79], a[120:123], v[136:139]
 v_mfma_f32_16x16x32_bf16 v[136:139], a[44:47], a[112:115], v[136:139]
 s_add_u32 s12, s12, 4096
 s_waitcnt vmcnt(17) lgkmcnt(0)
 v_mfma_f32_16x16x32_bf16 v[144:147], a[192:195], a[128:131], v[144:147]
 s_barrier
 s_add_u32 s15, s14, 3276800
 ds_read_b64_tr_b16 a[16:17], v36 offset:0
 ds_read_b64_tr_b16 a[18:19], v36 offset:2048
 v_max3_u32 v4, v100, v101, v102
 v_mfma_f32_16x16x32_bf16 v[144:147], a[224:227], a[136:139], v[144:147]
 s_add_u32 m0, s18, 49152
 ds_read_b64_tr_b16 a[48:49], v36 offset:8192
 v_max3_u32 v5, v103, v104, v105
 v_mfma_f32_16x16x32_bf16 v[148:151], a[224:227], a[140:143], v[148:151]
 buffer_load_dwordx4 v8, s[28:31], s15 offen lds
 v_max3_u32 v4, v4, v106, v107
 v_mfma_f32_16x16x32_bf16 v[148:151], a[192:195], a[132:135], v[148:151]
 ds_read_b64_tr_b16 a[50:51], v36 offset:10240
 v_max3_u32 v5, v5, v108, v109
 v_mfma_f32_16x16x32_bf16 v[156:159], a[196:199], a[132:135], v[156:159]
 ds_read_b64_tr_b16 a[20:21], v37 offset:0
 v_max3_u32 v4, v4, v110, v111
 v_mfma_f32_16x16x32_bf16 v[156:159], a[228:231], a[140:143], v[156:159]
 ds_read_b64_tr_b16 a[22:23], v37 offset:2048
 ds_read_b64_tr_b16 a[52:53], v37 offset:8192
 v_max_u32 v4, v4, v5
 v_mfma_f32_16x16x32_bf16 v[152:155], a[228:231], a[136:139], v[152:155]
 buffer_load_dwordx4 a[112:115], v1, s[24:27], s12 offen sc1
 v_cmp_eq_u32 vcc, -1, v4
 v_mfma_f32_16x16x32_bf16 v[152:155], a[196:199], a[128:131], v[152:155]
 ds_read_b64_tr_b16 a[54:55], v37 offset:10240
 v_mfma_f32_16x16x32_bf16 v[160:163], a[200:203], a[128:131], v[160:163]
 ds_read_b64_tr_b16 a[24:25], v38 offset:0
 s_cbranch_vccnz L_kvf_s
L_kvf_d:
 v_mfma_f32_16x16x32_bf16 v[56:59], v[108:111], v[176:179], 0
 s_add_u32 m0, s18, 50176
 ds_read_b64_tr_b16 a[26:27], v38 offset:2048
 v_mfma_f32_16x16x32_bf16 v[48:51], v[100:103], v[176:179], 0
 buffer_load_dwordx4 v9, s[28:31], s15 offen lds
 v_mfma_f32_16x16x32_bf16 v[52:55], v[104:107], v[176:179], 0
 ds_read_b64_tr_b16 a[56:57], v38 offset:8192
 ds_read_b64_tr_b16 a[58:59], v38 offset:10240
 v_mfma_f32_16x16x32_bf16 v[68:71], v[108:111], v[180:183], 0
 ds_read_b64_tr_b16 a[28:29], v39 offset:0
 v_mfma_f32_16x16x32_bf16 v[60:63], v[100:103], v[180:183], 0
 ds_read_b64_tr_b16 a[30:31], v39 offset:2048
 v_mfma_f32_16x16x32_bf16 v[64:67], v[104:107], v[180:183], 0
 ds_read_b64_tr_b16 a[60:61], v39 offset:8192
 v_mfma_f32_16x16x32_bf16 v[160:163], a[232:235], a[136:139], v[160:163]
 buffer_load_dwordx4 a[116:119], v1, s[24:27], s12 offen offset:1024 sc1
 v_add_f32 v56, s68, v56
 v_mfma_f32_16x16x32_bf16 v[164:167], a[232:235], a[140:143], v[164:167]
 ds_read_b64_tr_b16 a[62:63], v39 offset:10240
 v_rcp_f32 v56, v56
 v_mfma_f32_16x16x32_bf16 v[164:167], a[200:203], a[132:135], v[164:167]
 ds_read_b64_tr_b16 a[32:33], v36 offset:4096
 ds_read_b64_tr_b16 a[34:35], v36 offset:6144
 v_mul_f32 v48, v48, v56
 v_mfma_f32_16x16x32_bf16 v[172:175], a[204:207], a[132:135], v[172:175]
 s_add_u32 m0, s18, 51200
 ds_read_b64_tr_b16 a[64:65], v36 offset:12288
 v_mul_f32 v49, v49, v56
 v_mfma_f32_16x16x32_bf16 v[172:175], a[236:239], a[140:143], v[172:175]
 buffer_load_dwordx4 v10, s[28:31], s15 offen lds
 v_mul_f32 v50, v50, v56
 v_mul_f32 v51, v51, v56
 v_mfma_f32_16x16x32_bf16 v[168:171], a[236:239], a[136:139], v[168:171]
 ds_read_b64_tr_b16 a[66:67], v36 offset:14336
 v_mul_f32 v52, v52, v56
 v_mfma_f32_16x16x32_bf16 v[168:171], a[204:207], a[128:131], v[168:171]
 ds_read_b64_tr_b16 a[36:37], v37 offset:4096
 v_mul_f32 v53, v53, v56
 v_mul_f32 v54, v54, v56
 v_mfma_f32_16x16x32_bf16 v[112:115], a[208:211], a[128:131], v[112:115]
 ds_read_b64_tr_b16 a[38:39], v37 offset:6144
 ds_read_b64_tr_b16 a[68:69], v37 offset:12288
 v_mfma_f32_16x16x32_bf16 v[112:115], a[240:243], a[136:139], v[112:115]
 buffer_load_dwordx4 a[120:123], v1, s[24:27], s12 offen offset:2048 sc1
 v_mul_f32 v55, v55, v56
 v_cvt_pk_bf16_f32 v48, v48, v49
 v_mfma_f32_16x16x32_bf16 v[116:119], a[240:243], a[140:143], v[116:119]
 ds_read_b64_tr_b16 a[70:71], v37 offset:14336
 v_cvt_pk_bf16_f32 v49, v50, v51
 v_mfma_f32_16x16x32_bf16 v[116:119], a[208:211], a[132:135], v[116:119]
 ds_read_b64_tr_b16 a[40:41], v38 offset:4096
 v_cvt_pk_bf16_f32 v50, v52, v53
 v_cvt_pk_bf16_f32 v51, v54, v55
 v_mfma_f32_16x16x32_bf16 v[124:127], a[212:215], a[132:135], v[124:127]
 ds_read_b64_tr_b16 a[42:43], v38 offset:6144
 buffer_store_dwordx4 v[48:51], v1, s[24:27], s44 offen sc1
 v_mfma_f32_16x16x32_bf16 v[124:127], a[244:247], a[140:143], v[124:127]
 s_add_u32 m0, s18, 52224
 ds_read_b64_tr_b16 a[72:73], v38 offset:12288
 ds_read_b64_tr_b16 a[74:75], v38 offset:14336
 v_add_f32 v68, s68, v68
 v_mfma_f32_16x16x32_bf16 v[120:123], a[244:247], a[136:139], v[120:123]
 buffer_load_dwordx4 v11, s[28:31], s15 offen lds
 v_mfma_f32_16x16x32_bf16 v[120:123], a[212:215], a[128:131], v[120:123]
 ds_read_b64_tr_b16 a[44:45], v39 offset:4096
 v_rcp_f32 v68, v68
 v_mfma_f32_16x16x32_bf16 v[128:131], a[216:219], a[128:131], v[128:131]
 ds_read_b64_tr_b16 a[46:47], v39 offset:6144
 v_mul_f32 v60, v60, v68
 v_mfma_f32_16x16x32_bf16 v[128:131], a[248:251], a[136:139], v[128:131]
 ds_read_b64_tr_b16 a[76:77], v39 offset:12288
 v_mul_f32 v61, v61, v68
 v_mul_f32 v62, v62, v68
 v_mfma_f32_16x16x32_bf16 v[132:135], a[248:251], a[140:143], v[132:135]
 buffer_load_dwordx4 a[124:127], v1, s[24:27], s12 offen offset:3072 sc1
 v_mul_f32 v63, v63, v68
 v_mfma_f32_16x16x32_bf16 v[132:135], a[216:219], a[132:135], v[132:135]
 ds_read_b64_tr_b16 a[78:79], v39 offset:14336
 v_mul_f32 v64, v64, v68
 v_mfma_f32_16x16x32_bf16 v[140:143], a[220:223], a[132:135], v[140:143]
 v_mul_f32 v65, v65, v68
 v_mul_f32 v66, v66, v68
 v_mfma_f32_16x16x32_bf16 v[140:143], a[252:255], a[140:143], v[140:143]
 v_mul_f32 v67, v67, v68
 v_cvt_pk_bf16_f32 v60, v60, v61
 v_cvt_pk_bf16_f32 v61, v62, v63
 v_mfma_f32_16x16x32_bf16 v[136:139], a[252:255], a[136:139], v[136:139]
 v_cvt_pk_bf16_f32 v62, v64, v65
 v_cvt_pk_bf16_f32 v63, v66, v67
 v_mfma_f32_16x16x32_bf16 v[136:139], a[220:223], a[128:131], v[136:139]
 s_add_u32 s12, s12, 4096
 buffer_store_dwordx4 v[60:63], v1, s[24:27], s44 offen offset:1024 sc1
 s_waitcnt vmcnt(18) lgkmcnt(0)
 v_mfma_f32_16x16x32_bf16 v[144:147], a[16:19], a[80:83], v[144:147]
 s_barrier
 s_add_u32 s15, s14, 262144
 ds_read_b64_tr_b16 a[192:193], v36 offset:16384
 ds_read_b64_tr_b16 a[194:195], v36 offset:18432
 v_cmp_ne_u32 vcc, 1, v47
 v_mfma_f32_16x16x32_bf16 v[144:147], a[48:51], a[88:91], v[144:147]
 s_add_u32 m0, s18, 0
 ds_read_b64_tr_b16 a[224:225], v36 offset:24576
 v_mfma_f32_16x16x32_bf16 v[148:151], a[48:51], a[92:95], v[148:151]
 buffer_load_dwordx4 v8, s[28:31], s15 offen lds
 s_cbranch_vccnz L_b20_s
L_b20_d:
 v_mfma_f32_16x16x32_bf16 v[80:83], v[108:111], v[184:187], 0
 ds_read_b64_tr_b16 a[226:227], v36 offset:26624
 v_mfma_f32_16x16x32_bf16 v[72:75], v[100:103], v[184:187], 0
 ds_read_b64_tr_b16 a[196:197], v37 offset:16384
 v_mfma_f32_16x16x32_bf16 v[76:79], v[104:107], v[184:187], 0
 ds_read_b64_tr_b16 a[198:199], v37 offset:18432
 v_mfma_f32_16x16x32_bf16 v[92:95], v[108:111], v[188:191], 0
 buffer_load_dwordx4 a[128:131], v1, s[24:27], s12 offen sc1
 v_mfma_f32_16x16x32_bf16 v[84:87], v[100:103], v[188:191], 0
 ds_read_b64_tr_b16 a[228:229], v37 offset:24576
 v_mfma_f32_16x16x32_bf16 v[88:91], v[104:107], v[188:191], 0
 ds_read_b64_tr_b16 a[230:231], v37 offset:26624
 v_mfma_f32_16x16x32_bf16 v[216:219], v[108:111], v[192:195], 0
 ds_read_b64_tr_b16 a[200:201], v38 offset:16384
 v_add_f32 v80, s68, v80
 v_mfma_f32_16x16x32_bf16 v[208:211], v[100:103], v[192:195], 0
 s_add_u32 m0, s18, 1024
 ds_read_b64_tr_b16 a[202:203], v38 offset:18432
 v_rcp_f32 v80, v80
 v_mfma_f32_16x16x32_bf16 v[212:215], v[104:107], v[192:195], 0
 buffer_load_dwordx4 v9, s[28:31], s15 offen lds
 v_mul_f32 v72, v72, v80
 v_mul_f32 v73, v73, v80
 v_mfma_f32_16x16x32_bf16 v[148:151], a[16:19], a[84:87], v[148:151]
 ds_read_b64_tr_b16 a[232:233], v38 offset:24576
 ds_read_b64_tr_b16 a[234:235], v38 offset:26624
 v_mfma_f32_16x16x32_bf16 v[156:159], a[20:23], a[84:87], v[156:159]
 ds_read_b64_tr_b16 a[204:205], v39 offset:16384
 v_mul_f32 v74, v74, v80
 v_mul_f32 v75, v75, v80
 v_mfma_f32_16x16x32_bf16 v[156:159], a[52:55], a[92:95], v[156:159]
 ds_read_b64_tr_b16 a[206:207], v39 offset:18432
 v_mul_f32 v76, v76, v80
 v_mul_f32 v77, v77, v80
 v_mfma_f32_16x16x32_bf16 v[152:155], a[52:55], a[88:91], v[152:155]
 ds_read_b64_tr_b16 a[236:237], v39 offset:24576
 v_mul_f32 v78, v78, v80
 v_mfma_f32_16x16x32_bf16 v[152:155], a[20:23], a[80:83], v[152:155]
 buffer_load_dwordx4 a[132:135], v1, s[24:27], s12 offen offset:1024 sc1
 v_mul_f32 v79, v79, v80
 v_cvt_pk_bf16_f32 v72, v72, v73
 v_mfma_f32_16x16x32_bf16 v[160:163], a[24:27], a[80:83], v[160:163]
 ds_read_b64_tr_b16 a[238:239], v39 offset:26624
 v_cvt_pk_bf16_f32 v73, v74, v75
 v_mfma_f32_16x16x32_bf16 v[160:163], a[56:59], a[88:91], v[160:163]
 ds_read_b64_tr_b16 a[208:209], v36 offset:20480
 v_cvt_pk_bf16_f32 v74, v76, v77
 v_cvt_pk_bf16_f32 v75, v78, v79
 v_mfma_f32_16x16x32_bf16 v[164:167], a[56:59], a[92:95], v[164:167]
 ds_read_b64_tr_b16 a[210:211], v36 offset:22528
 buffer_store_dwordx4 v[72:75], v1, s[24:27], s45 offen sc1
 v_add_f32 v92, s68, v92
 v_mfma_f32_16x16x32_bf16 v[164:167], a[24:27], a[84:87], v[164:167]
 s_add_u32 m0, s18, 2048
 ds_read_b64_tr_b16 a[240:241], v36 offset:28672
 v_rcp_f32 v92, v92
 v_mfma_f32_16x16x32_bf16 v[172:175], a[28:31], a[84:87], v[172:175]
 buffer_load_dwordx4 v10, s[28:31], s15 offen lds
 v_mul_f32 v84, v84, v92
 v_mfma_f32_16x16x32_bf16 v[172:175], a[60:63], a[92:95], v[172:175]
 ds_read_b64_tr_b16 a[242:243], v36 offset:30720
 v_mul_f32 v85, v85, v92
 v_mul_f32 v86, v86, v92
 v_mfma_f32_16x16x32_bf16 v[168:171], a[60:63], a[88:91], v[168:171]
 ds_read_b64_tr_b16 a[212:213], v37 offset:20480
 v_mul_f32 v87, v87, v92
 v_mul_f32 v88, v88, v92
 v_mfma_f32_16x16x32_bf16 v[168:171], a[28:31], a[80:83], v[168:171]
 ds_read_b64_tr_b16 a[214:215], v37 offset:22528
 ds_read_b64_tr_b16 a[244:245], v37 offset:28672
 v_mfma_f32_16x16x32_bf16 v[112:115], a[32:35], a[80:83], v[112:115]
 buffer_load_dwordx4 a[136:139], v1, s[24:27], s12 offen offset:2048 sc1
 v_mul_f32 v89, v89, v92
 v_mul_f32 v90, v90, v92
 v_mfma_f32_16x16x32_bf16 v[112:115], a[64:67], a[88:91], v[112:115]
 ds_read_b64_tr_b16 a[246:247], v37 offset:30720
 v_mul_f32 v91, v91, v92
 v_cvt_pk_bf16_f32 v84, v84, v85
 v_mfma_f32_16x16x32_bf16 v[116:119], a[64:67], a[92:95], v[116:119]
 ds_read_b64_tr_b16 a[216:217], v38 offset:20480
 v_cvt_pk_bf16_f32 v85, v86, v87
 v_mfma_f32_16x16x32_bf16 v[116:119], a[32:35], a[84:87], v[116:119]
 ds_read_b64_tr_b16 a[218:219], v38 offset:22528
 v_cvt_pk_bf16_f32 v86, v88, v89
 v_cvt_pk_bf16_f32 v87, v90, v91
 v_mfma_f32_16x16x32_bf16 v[124:127], a[36:39], a[84:87], v[124:127]
 s_add_u32 m0, s18, 3072
 ds_read_b64_tr_b16 a[248:249], v38 offset:28672
 buffer_store_dwordx4 v[84:87], v1, s[24:27], s45 offen offset:1024 sc1
 v_mfma_f32_16x16x32_bf16 v[124:127], a[68:71], a[92:95], v[124:127]
 buffer_load_dwordx4 v11, s[28:31], s15 offen lds
 v_add_f32 v216, s68, v216
 v_mfma_f32_16x16x32_bf16 v[120:123], a[68:71], a[88:91], v[120:123]
 ds_read_b64_tr_b16 a[250:251], v38 offset:30720
 v_rcp_f32 v216, v216
 v_mfma_f32_16x16x32_bf16 v[120:123], a[36:39], a[80:83], v[120:123]
 ds_read_b64_tr_b16 a[220:221], v39 offset:20480
 v_mul_f32 v208, v208, v216
 v_mul_f32 v209, v209, v216
 v_mfma_f32_16x16x32_bf16 v[128:131], a[40:43], a[80:83], v[128:131]
 ds_read_b64_tr_b16 a[222:223], v39 offset:22528
 v_mul_f32 v210, v210, v216
 v_mfma_f32_16x16x32_bf16 v[128:131], a[72:75], a[88:91], v[128:131]
 ds_read_b64_tr_b16 a[252:253], v39 offset:28672
 v_mul_f32 v211, v211, v216
 v_mfma_f32_16x16x32_bf16 v[132:135], a[72:75], a[92:95], v[132:135]
 buffer_load_dwordx4 a[140:143], v1, s[24:27], s12 offen offset:3072 sc1
 v_mul_f32 v212, v212, v216
 v_mul_f32 v213, v213, v216
 v_mfma_f32_16x16x32_bf16 v[132:135], a[40:43], a[84:87], v[132:135]
 ds_read_b64_tr_b16 a[254:255], v39 offset:30720
 v_mul_f32 v214, v214, v216
 v_mfma_f32_16x16x32_bf16 v[140:143], a[44:47], a[84:87], v[140:143]
 v_mul_f32 v215, v215, v216
 v_cvt_pk_bf16_f32 v208, v208, v209
 v_cvt_pk_bf16_f32 v209, v210, v211
 v_mfma_f32_16x16x32_bf16 v[140:143], a[76:79], a[92:95], v[140:143]
 v_cvt_pk_bf16_f32 v210, v212, v213
 v_cvt_pk_bf16_f32 v211, v214, v215
 v_mfma_f32_16x16x32_bf16 v[136:139], a[76:79], a[88:91], v[136:139]
 buffer_store_dwordx4 v[208:211], v1, s[24:27], s46 offen sc1
 v_mfma_f32_16x16x32_bf16 v[136:139], a[44:47], a[80:83], v[136:139]
 s_add_u32 s12, s12, 4096
 s_waitcnt vmcnt(21) lgkmcnt(0)
 v_mfma_f32_16x16x32_bf16 v[144:147], a[192:195], a[96:99], v[144:147]
 s_barrier
 s_add_u32 s15, s14, 655360
 ds_read_b64_tr_b16 a[16:17], v36 offset:32768
 ds_read_b64_tr_b16 a[18:19], v36 offset:34816
 v_mfma_f32_16x16x32_bf16 v[228:231], v[108:111], v[196:199], 0
 s_add_u32 m0, s18, 16384
 ds_read_b64_tr_b16 a[48:49], v36 offset:40960
 v_mfma_f32_16x16x32_bf16 v[220:223], v[100:103], v[196:199], 0
 buffer_load_dwordx4 v8, s[28:31], s15 offen lds
 v_mfma_f32_16x16x32_bf16 v[224:227], v[104:107], v[196:199], 0
 ds_read_b64_tr_b16 a[50:51], v36 offset:43008
 v_mfma_f32_16x16x32_bf16 v[240:243], v[108:111], v[200:203], 0
 ds_read_b64_tr_b16 a[20:21], v37 offset:32768
 v_mfma_f32_16x16x32_bf16 v[232:235], v[100:103], v[200:203], 0
 ds_read_b64_tr_b16 a[22:23], v37 offset:34816
 v_mfma_f32_16x16x32_bf16 v[236:239], v[104:107], v[200:203], 0
 buffer_load_dwordx4 a[80:83], v1, s[24:27], s12 offen sc1
 v_mfma_f32_16x16x32_bf16 v[252:255], v[108:111], v[204:207], 0
 ds_read_b64_tr_b16 a[52:53], v37 offset:40960
 v_add_f32 v228, s68, v228
 v_mfma_f32_16x16x32_bf16 v[244:247], v[100:103], v[204:207], 0
 ds_read_b64_tr_b16 a[54:55], v37 offset:43008
 v_rcp_f32 v228, v228
 v_mfma_f32_16x16x32_bf16 v[248:251], v[104:107], v[204:207], 0
 ds_read_b64_tr_b16 a[24:25], v38 offset:32768
 v_mul_f32 v220, v220, v228
 v_mfma_f32_16x16x32_bf16 v[144:147], a[224:227], a[104:107], v[144:147]
 s_add_u32 m0, s18, 17408
 ds_read_b64_tr_b16 a[26:27], v38 offset:34816
 v_mul_f32 v221, v221, v228
 v_mul_f32 v222, v222, v228
 v_mfma_f32_16x16x32_bf16 v[148:151], a[224:227], a[108:111], v[148:151]
 buffer_load_dwordx4 v9, s[28:31], s15 offen lds
 v_mul_f32 v223, v223, v228
 v_mfma_f32_16x16x32_bf16 v[148:151], a[192:195], a[100:103], v[148:151]
 ds_read_b64_tr_b16 a[56:57], v38 offset:40960
 ds_read_b64_tr_b16 a[58:59], v38 offset:43008
 v_mul_f32 v224, v224, v228
 v_mfma_f32_16x16x32_bf16 v[156:159], a[196:199], a[100:103], v[156:159]
 ds_read_b64_tr_b16 a[28:29], v39 offset:32768
 v_mul_f32 v225, v225, v228
 v_mfma_f32_16x16x32_bf16 v[156:159], a[228:231], a[108:111], v[156:159]
 ds_read_b64_tr_b16 a[30:31], v39 offset:34816
 v_mul_f32 v226, v226, v228
 v_mul_f32 v227, v227, v228
 v_mfma_f32_16x16x32_bf16 v[152:155], a[228:231], a[104:107], v[152:155]
 ds_read_b64_tr_b16 a[60:61], v39 offset:40960
 v_cvt_pk_bf16_f32 v220, v220, v221
 v_mfma_f32_16x16x32_bf16 v[152:155], a[196:199], a[96:99], v[152:155]
 buffer_load_dwordx4 a[84:87], v1, s[24:27], s12 offen offset:1024 sc1
 v_cvt_pk_bf16_f32 v221, v222, v223
 v_cvt_pk_bf16_f32 v222, v224, v225
 v_mfma_f32_16x16x32_bf16 v[160:163], a[200:203], a[96:99], v[160:163]
 ds_read_b64_tr_b16 a[62:63], v39 offset:43008
 v_cvt_pk_bf16_f32 v223, v226, v227
 v_mfma_f32_16x16x32_bf16 v[160:163], a[232:235], a[104:107], v[160:163]
 ds_read_b64_tr_b16 a[32:33], v36 offset:36864
 buffer_store_dwordx4 v[220:223], v1, s[24:27], s46 offen offset:1024 sc1
 v_add_f32 v240, s68, v240
 v_mfma_f32_16x16x32_bf16 v[164:167], a[232:235], a[108:111], v[164:167]
 ds_read_b64_tr_b16 a[34:35], v36 offset:38912
 v_rcp_f32 v240, v240
 v_mfma_f32_16x16x32_bf16 v[164:167], a[200:203], a[100:103], v[164:167]
 s_add_u32 m0, s18, 18432
 ds_read_b64_tr_b16 a[64:65], v36 offset:45056
 v_mul_f32 v232, v232, v240
 v_mfma_f32_16x16x32_bf16 v[172:175], a[204:207], a[100:103], v[172:175]
 buffer_load_dwordx4 v10, s[28:31], s15 offen lds
 v_mul_f32 v233, v233, v240
 v_mfma_f32_16x16x32_bf16 v[172:175], a[236:239], a[108:111], v[172:175]
 ds_read_b64_tr_b16 a[66:67], v36 offset:47104
 v_mul_f32 v234, v234, v240
 v_mul_f32 v235, v235, v240
 v_mfma_f32_16x16x32_bf16 v[168:171], a[236:239], a[104:107], v[168:171]
 ds_read_b64_tr_b16 a[36:37], v37 offset:36864
 v_mul_f32 v236, v236, v240
 v_mfma_f32_16x16x32_bf16 v[168:171], a[204:207], a[96:99], v[168:171]
 ds_read_b64_tr_b16 a[38:39], v37 offset:38912
 ds_read_b64_tr_b16 a[68:69], v37 offset:45056
 v_mul_f32 v237, v237, v240
 v_mfma_f32_16x16x32_bf16 v[112:115], a[208:211], a[96:99], v[112:115]
 buffer_load_dwordx4 a[88:91], v1, s[24:27], s12 offen offset:2048 sc1
 v_mul_f32 v238, v238, v240
 v_mfma_f32_16x16x32_bf16 v[112:115], a[240:243], a[104:107], v[112:115]
 ds_read_b64_tr_b16 a[70:71], v37 offset:47104
 v_mul_f32 v239, v239, v240
 v_cvt_pk_bf16_f32 v232, v232, v233
 v_mfma_f32_16x16x32_bf16 v[116:119], a[240:243], a[108:111], v[116:119]
 ds_read_b64_tr_b16 a[40:41], v38 offset:36864
 v_cvt_pk_bf16_f32 v233, v234, v235
 v_mfma_f32_16x16x32_bf16 v[116:119], a[208:211], a[100:103], v[116:119]
 ds_read_b64_tr_b16 a[42:43], v38 offset:38912
 v_cvt_pk_bf16_f32 v234, v236, v237
 v_cvt_pk_bf16_f32 v235, v238, v239
 v_mfma_f32_16x16x32_bf16 v[124:127], a[212:215], a[100:103], v[124:127]
 s_add_u32 m0, s18, 19456
 ds_read_b64_tr_b16 a[72:73], v38 offset:45056
 buffer_store_dwordx4 v[232:235], v1, s[24:27], s47 offen sc1
 v_mfma_f32_16x16x32_bf16 v[124:127], a[244:247], a[108:111], v[124:127]
 buffer_load_dwordx4 v11, s[28:31], s15 offen lds
 v_add_f32 v252, s68, v252
 v_mfma_f32_16x16x32_bf16 v[120:123], a[244:247], a[104:107], v[120:123]
 ds_read_b64_tr_b16 a[74:75], v38 offset:47104
 v_rcp_f32 v252, v252
 v_mfma_f32_16x16x32_bf16 v[120:123], a[212:215], a[96:99], v[120:123]
 ds_read_b64_tr_b16 a[44:45], v39 offset:36864
 v_mul_f32 v244, v244, v252
 v_mfma_f32_16x16x32_bf16 v[128:131], a[216:219], a[96:99], v[128:131]
 ds_read_b64_tr_b16 a[46:47], v39 offset:38912
 v_mul_f32 v245, v245, v252
 v_mfma_f32_16x16x32_bf16 v[128:131], a[248:251], a[104:107], v[128:131]
 ds_read_b64_tr_b16 a[76:77], v39 offset:45056
 v_mul_f32 v246, v246, v252
 v_mfma_f32_16x16x32_bf16 v[132:135], a[248:251], a[108:111], v[132:135]
 buffer_load_dwordx4 a[92:95], v1, s[24:27], s12 offen offset:3072 sc1
 v_mul_f32 v247, v247, v252
 v_mfma_f32_16x16x32_bf16 v[132:135], a[216:219], a[100:103], v[132:135]
 ds_read_b64_tr_b16 a[78:79], v39 offset:47104
 v_mul_f32 v248, v248, v252
 v_mfma_f32_16x16x32_bf16 v[140:143], a[220:223], a[100:103], v[140:143]
 v_mul_f32 v249, v249, v252
 v_mul_f32 v250, v250, v252
 v_mul_f32 v251, v251, v252
 v_mfma_f32_16x16x32_bf16 v[140:143], a[252:255], a[108:111], v[140:143]
 v_cvt_pk_bf16_f32 v244, v244, v245
 v_cvt_pk_bf16_f32 v245, v246, v247
 v_mfma_f32_16x16x32_bf16 v[136:139], a[252:255], a[104:107], v[136:139]
 v_cvt_pk_bf16_f32 v246, v248, v249
 v_cvt_pk_bf16_f32 v247, v250, v251
 v_mfma_f32_16x16x32_bf16 v[136:139], a[220:223], a[96:99], v[136:139]
 s_add_u32 s12, s12, 4096
 buffer_store_dwordx4 v[244:247], v1, s[24:27], s47 offen offset:1024 sc1
 s_waitcnt vmcnt(23) lgkmcnt(0)
 v_mfma_f32_16x16x32_bf16 v[144:147], a[16:19], a[112:115], v[144:147]
 s_barrier
 s_add_u32 s15, s14, 1179648
 ds_read_b64_tr_b16 a[192:193], v36 offset:49152
 ds_read_b64_tr_b16 a[194:195], v36 offset:51200
 v_mfma_f32_16x16x32_bf16 v[144:147], a[48:51], a[120:123], v[144:147]
 s_add_u32 m0, s18, 32768
 ds_read_b64_tr_b16 a[224:225], v36 offset:57344
 ds_read_b64_tr_b16 a[226:227], v36 offset:59392
 v_mfma_f32_16x16x32_bf16 v[148:151], a[48:51], a[124:127], v[148:151]
 buffer_load_dwordx4 v8, s[28:31], s15 offen lds
 v_add_u32 v40, 4096, v1
 v_mfma_f32_16x16x32_bf16 v[148:151], a[16:19], a[116:119], v[148:151]
 ds_read_b64_tr_b16 a[196:197], v37 offset:49152
 v_and_b32 v4, 15, v2
 v_mfma_f32_16x16x32_bf16 v[156:159], a[20:23], a[116:119], v[156:159]
 ds_read_b64_tr_b16 a[198:199], v37 offset:51200
 ds_read_b64_tr_b16 a[228:229], v37 offset:57344
 v_mfma_f32_16x16x32_bf16 v[156:159], a[52:55], a[124:127], v[156:159]
 buffer_load_dwordx4 a[96:99], v1, s[24:27], s12 offen sc1
 v_lshlrev_b32 v4, 11, v4
 v_mfma_f32_16x16x32_bf16 v[152:155], a[52:55], a[120:123], v[152:155]
 ds_read_b64_tr_b16 a[230:231], v37 offset:59392
 v_bfe_u32 v6, v2, 4, 1
 v_mfma_f32_16x16x32_bf16 v[152:155], a[20:23], a[112:115], v[152:155]
 ds_read_b64_tr_b16 a[200:201], v38 offset:49152
 ds_read_b64_tr_b16 a[202:203], v38 offset:51200
 v_mfma_f32_16x16x32_bf16 v[160:163], a[24:27], a[112:115], v[160:163]
 s_add_u32 m0, s18, 33792
 ds_read_b64_tr_b16 a[232:233], v38 offset:57344
 ds_read_b64_tr_b16 a[234:235], v38 offset:59392
 v_mfma_f32_16x16x32_bf16 v[160:163], a[56:59], a[120:123], v[160:163]
 buffer_load_dwordx4 v9, s[28:31], s15 offen lds
 v_lshl_add_u32 v4, v6, 5, v4
 v_mfma_f32_16x16x32_bf16 v[164:167], a[56:59], a[124:127], v[164:167]
 ds_read_b64_tr_b16 a[204:205], v39 offset:49152
 v_lshrrev_b32 v6, 5, v2
 v_mfma_f32_16x16x32_bf16 v[164:167], a[24:27], a[116:119], v[164:167]
 ds_read_b64_tr_b16 a[206:207], v39 offset:51200
 ds_read_b64_tr_b16 a[236:237], v39 offset:57344
 v_mfma_f32_16x16x32_bf16 v[172:175], a[28:31], a[116:119], v[172:175]
 buffer_load_dwordx4 a[100:103], v1, s[24:27], s12 offen offset:1024 sc1
 v_lshl_add_u32 v42, v6, 4, v4
 v_mfma_f32_16x16x32_bf16 v[172:175], a[60:63], a[124:127], v[172:175]
 ds_read_b64_tr_b16 a[238:239], v39 offset:59392
 v_add_u32 v43, 32768, v42
 v_mfma_f32_16x16x32_bf16 v[168:171], a[60:63], a[120:123], v[168:171]
 ds_read_b64_tr_b16 a[208:209], v36 offset:53248
 ds_read_b64_tr_b16 a[210:211], v36 offset:55296
 v_mfma_f32_16x16x32_bf16 v[168:171], a[28:31], a[112:115], v[168:171]
 s_add_u32 m0, s18, 34816
 ds_read_b64_tr_b16 a[240:241], v36 offset:61440
 ds_read_b64_tr_b16 a[242:243], v36 offset:63488
 v_mfma_f32_16x16x32_bf16 v[112:115], a[32:35], a[112:115], v[112:115]
 buffer_load_dwordx4 v10, s[28:31], s15 offen lds
 v_and_b32 v4, 0x1f0, v1
 v_mfma_f32_16x16x32_bf16 v[112:115], a[64:67], a[120:123], v[112:115]
 ds_read_b64_tr_b16 a[212:213], v37 offset:53248
 v_lshl_add_u32 v41, v6, 3, v4
 v_mfma_f32_16x16x32_bf16 v[116:119], a[64:67], a[124:127], v[116:119]
 ds_read_b64_tr_b16 a[214:215], v37 offset:55296
 ds_read_b64_tr_b16 a[244:245], v37 offset:61440
 v_mfma_f32_16x16x32_bf16 v[116:119], a[32:35], a[116:119], v[116:119]
 ds_read_b64_tr_b16 a[246:247], v37 offset:63488
 v_mfma_f32_16x16x32_bf16 v[124:127], a[36:39], a[116:119], v[124:127]
 s_add_u32 s66, s23, 256
 buffer_load_dwordx4 a[104:107], v1, s[24:27], s12 offen offset:2048 sc1
 v_mfma_f32_16x16x32_bf16 v[124:127], a[68:71], a[124:127], v[124:127]
 ds_read_b64_tr_b16 a[216:217], v38 offset:53248
 ds_read_b64_tr_b16 a[218:219], v38 offset:55296
 v_mfma_f32_16x16x32_bf16 v[120:123], a[68:71], a[120:123], v[120:123]
 s_add_u32 m0, s18, 35840
 ds_read_b64_tr_b16 a[248:249], v38 offset:61440
 ds_read_b64_tr_b16 a[250:251], v38 offset:63488
 v_mfma_f32_16x16x32_bf16 v[120:123], a[36:39], a[112:115], v[120:123]
 buffer_load_dwordx4 v11, s[28:31], s15 offen lds
 v_mfma_f32_16x16x32_bf16 v[128:131], a[40:43], a[112:115], v[128:131]
 ds_read_b64_tr_b16 a[220:221], v39 offset:53248
 v_mfma_f32_16x16x32_bf16 v[128:131], a[72:75], a[120:123], v[128:131]
 ds_read_b64_tr_b16 a[222:223], v39 offset:55296
 ds_read_b64_tr_b16 a[252:253], v39 offset:61440
 v_mfma_f32_16x16x32_bf16 v[132:135], a[72:75], a[124:127], v[132:135]
 ds_read_b64_tr_b16 a[254:255], v39 offset:63488
 v_mfma_f32_16x16x32_bf16 v[132:135], a[40:43], a[116:119], v[132:135]
 buffer_load_dwordx4 a[108:111], v1, s[24:27], s12 offen offset:3072 sc1
 v_mfma_f32_16x16x32_bf16 v[140:143], a[44:47], a[116:119], v[140:143]
 v_mfma_f32_16x16x32_bf16 v[140:143], a[76:79], a[124:127], v[140:143]
 v_mfma_f32_16x16x32_bf16 v[136:139], a[76:79], a[120:123], v[136:139]
 v_mfma_f32_16x16x32_bf16 v[136:139], a[44:47], a[112:115], v[136:139]
 s_add_u32 s12, s12, 4096
 s_waitcnt vmcnt(20) lgkmcnt(0)
 v_mfma_f32_16x16x32_bf16 v[144:147], a[192:195], a[128:131], v[144:147]
 s_barrier
 s_add_u32 s15, s14, 1572864
 ds_read_b64_tr_b16 a[16:17], v36 offset:0
 ds_read_b64_tr_b16 a[18:19], v36 offset:2048
 v_mfma_f32_16x16x32_bf16 v[144:147], a[224:227], a[136:139], v[144:147]
 s_add_u32 m0, s18, 49152
 ds_read_b64_tr_b16 a[48:49], v36 offset:8192
 ds_read_b64_tr_b16 a[50:51], v36 offset:10240
 v_mfma_f32_16x16x32_bf16 v[148:151], a[224:227], a[140:143], v[148:151]
 buffer_load_dwordx4 v8, s[28:31], s15 offen lds
 v_mfma_f32_16x16x32_bf16 v[148:151], a[192:195], a[132:135], v[148:151]
 ds_read_b64_tr_b16 a[20:21], v37 offset:0
 v_mfma_f32_16x16x32_bf16 v[156:159], a[196:199], a[132:135], v[156:159]
 ds_read_b64_tr_b16 a[22:23], v37 offset:2048
 ds_read_b64_tr_b16 a[52:53], v37 offset:8192
 v_mfma_f32_16x16x32_bf16 v[156:159], a[228:231], a[140:143], v[156:159]
 buffer_load_dwordx4 a[112:115], v1, s[24:27], s12 offen sc1
 v_mfma_f32_16x16x32_bf16 v[152:155], a[228:231], a[136:139], v[152:155]
 ds_read_b64_tr_b16 a[54:55], v37 offset:10240
 v_mfma_f32_16x16x32_bf16 v[152:155], a[196:199], a[128:131], v[152:155]
 ds_read_b64_tr_b16 a[24:25], v38 offset:0
 ds_read_b64_tr_b16 a[26:27], v38 offset:2048
 v_mfma_f32_16x16x32_bf16 v[160:163], a[200:203], a[128:131], v[160:163]
 s_add_u32 m0, s18, 50176
 ds_read_b64_tr_b16 a[56:57], v38 offset:8192
 ds_read_b64_tr_b16 a[58:59], v38 offset:10240
 v_mfma_f32_16x16x32_bf16 v[160:163], a[232:235], a[136:139], v[160:163]
 buffer_load_dwordx4 v9, s[28:31], s15 offen lds
 v_mfma_f32_16x16x32_bf16 v[164:167], a[232:235], a[140:143], v[164:167]
 ds_read_b64_tr_b16 a[28:29], v39 offset:0
 v_mfma_f32_16x16x32_bf16 v[164:167], a[200:203], a[132:135], v[164:167]
 ds_read_b64_tr_b16 a[30:31], v39 offset:2048
 ds_read_b64_tr_b16 a[60:61], v39 offset:8192
 s_branch L_tp_L_tA_12_o
L_tp_L_tA_12:
 s_nop 0
 s_nop 0
 s_branch L_tr01
L_tp_L_tA_12_o:
 v_mfma_f32_16x16x32_bf16 v[172:175], a[204:207], a[132:135], v[172:175]
 buffer_load_dwordx4 a[116:119], v1, s[24:27], s12 offen offset:1024 sc1
 v_mfma_f32_16x16x32_bf16 v[172:175], a[236:239], a[140:143], v[172:175]
 ds_read_b64_tr_b16 a[62:63], v39 offset:10240
 v_mfma_f32_16x16x32_bf16 v[168:171], a[236:239], a[136:139], v[168:171]
 ds_read_b64_tr_b16 a[32:33], v36 offset:4096
 ds_read_b64_tr_b16 a[34:35], v36 offset:6144
 v_mfma_f32_16x16x32_bf16 v[168:171], a[204:207], a[128:131], v[168:171]
 s_add_u32 m0, s18, 51200
 ds_read_b64_tr_b16 a[64:65], v36 offset:12288
 ds_read_b64_tr_b16 a[66:67], v36 offset:14336
 v_mfma_f32_16x16x32_bf16 v[112:115], a[208:211], a[128:131], v[112:115]
 buffer_load_dwordx4 v10, s[28:31], s15 offen lds
 v_mfma_f32_16x16x32_bf16 v[112:115], a[240:243], a[136:139], v[112:115]
 ds_read_b64_tr_b16 a[36:37], v37 offset:4096
 v_mfma_f32_16x16x32_bf16 v[116:119], a[240:243], a[140:143], v[116:119]
 ds_read_b64_tr_b16 a[38:39], v37 offset:6144
 ds_read_b64_tr_b16 a[68:69], v37 offset:12288
 v_mfma_f32_16x16x32_bf16 v[116:119], a[208:211], a[132:135], v[116:119]
 ds_read_b64_tr_b16 a[70:71], v37 offset:14336
 v_mfma_f32_16x16x32_bf16 v[124:127], a[212:215], a[132:135], v[124:127]
 buffer_load_dwordx4 a[120:123], v1, s[24:27], s12 offen offset:2048 sc1
 v_mfma_f32_16x16x32_bf16 v[124:127], a[244:247], a[140:143], v[124:127]
 ds_read_b64_tr_b16 a[40:41], v38 offset:4096
 ds_read_b64_tr_b16 a[42:43], v38 offset:6144
 v_mfma_f32_16x16x32_bf16 v[120:123], a[244:247], a[136:139], v[120:123]
 s_add_u32 m0, s18, 52224
 ds_read_b64_tr_b16 a[72:73], v38 offset:12288
 ds_read_b64_tr_b16 a[74:75], v38 offset:14336
 v_mfma_f32_16x16x32_bf16 v[120:123], a[212:215], a[128:131], v[120:123]
 buffer_load_dwordx4 v11, s[28:31], s15 offen lds
 v_mfma_f32_16x16x32_bf16 v[128:131], a[216:219], a[128:131], v[128:131]
 ds_read_b64_tr_b16 a[44:45], v39 offset:4096
 v_mfma_f32_16x16x32_bf16 v[128:131], a[248:251], a[136:139], v[128:131]
 ds_read_b64_tr_b16 a[46:47], v39 offset:6144
 ds_read_b64_tr_b16 a[76:77], v39 offset:12288
 v_mfma_f32_16x16x32_bf16 v[132:135], a[248:251], a[140:143], v[132:135]
 ds_read_b64_tr_b16 a[78:79], v39 offset:14336
 v_mfma_f32_16x16x32_bf16 v[132:135], a[216:219], a[132:135], v[132:135]
 buffer_load_dwordx4 a[124:127], v1, s[24:27], s12 offen offset:3072 sc1
 v_mfma_f32_16x16x32_bf16 v[140:143], a[220:223], a[132:135], v[140:143]
 v_mfma_f32_16x16x32_bf16 v[140:143], a[252:255], a[140:143], v[140:143]
 v_mfma_f32_16x16x32_bf16 v[136:139], a[252:255], a[136:139], v[136:139]
 v_mfma_f32_16x16x32_bf16 v[136:139], a[220:223], a[128:131], v[136:139]
 s_add_u32 s12, s12, 4096
 s_cmp_eq_u32 s20, 0
 s_cbranch_scc1 L_tail0
 s_branch L_tail1
L_te0:
L_at00:
 s_and_b32 s6, s2, 1
 s_lshl_b32 s6, s6, 7
 v_mov_b32 v44, s6
 v_mov_b32 v45, 1
 s_mov_b64 exec, 1
 global_atomic_add v44, v45, s[62:63] sc1
 s_mov_b64 exec, -1
 s_branch L_at00_d
L_at01:
 s_and_b32 s6, s2, 1
 s_lshl_b32 s6, s6, 7
 v_mov_b32 v44, s6
 v_mov_b32 v45, 1
 s_mov_b64 exec, 1
 global_atomic_add v44, v45, s[62:63] sc1
 s_mov_b64 exec, -1
 s_branch L_at01_d
L_ini0_s:
 s_mov_b32 s0, 0
 s_branch L_ini0_r
L_ini0_l:
 s_sleep 8
L_ini0_r:
 global_load_dword v3, v35, s[62:63] sc1
 s_waitcnt vmcnt(0)
 v_cmp_gt_u32 vcc, 0x80, v3
 s_add_u32 s0, s0, 1
 s_cmp_ge_u32 s0, 524288
 s_cbranch_scc1 L_ini0_d
 s_nop 1
 s_cbranch_vccnz L_ini0_l
 s_branch L_ini0_d
L_b10_s:
 s_mov_b32 s0, 0
 s_branch L_b10_r
L_b10_l:
 s_sleep 8
L_b10_r:
 buffer_load_dword v47, v46, s[24:27], s59 offen sc1
 s_waitcnt vmcnt(0)
 v_cmp_ne_u32 vcc, 1, v47
 s_add_u32 s0, s0, 1
 s_cmp_ge_u32 s0, 524288
 s_cbranch_scc1 L_b10_d
 s_nop 1
 s_cbranch_vccnz L_b10_l
 s_branch L_b10_d
L_kvf_s:
 s_mov_b32 s0, 0
 s_branch L_kvf_r
L_kvf_l:
 s_sleep 8
L_kvf_r:
 buffer_load_dwordx4 v[100:103], v1, s[24:27], s64 offen sc1
 buffer_load_dwordx4 v[104:107], v1, s[24:27], s66 offen sc1
 buffer_load_dwordx4 v[108:111], v1, s[24:27], s67 offen sc1
 s_waitcnt vmcnt(0)
 v_max3_u32 v4, v100, v101, v102
 v_max3_u32 v5, v103, v104, v105
 v_max3_u32 v4, v4, v106, v107
 v_max3_u32 v5, v5, v108, v109
 v_max3_u32 v4, v4, v110, v111
 v_max_u32 v4, v4, v5
 v_cmp_eq_u32 vcc, -1, v4
 s_add_u32 s0, s0, 1
 s_cmp_ge_u32 s0, 524288
 s_cbranch_scc1 L_kvf_d
 s_nop 1
 s_cbranch_vccnz L_kvf_l
 s_branch L_kvf_d
L_b20_s:
 s_mov_b32 s0, 0
 s_branch L_b20_r
L_b20_l:
 s_sleep 8
L_b20_r:
 buffer_load_dword v47, v24, s[24:27], s60 offen offset:128 sc1
 s_waitcnt vmcnt(0)
 v_cmp_ne_u32 vcc, 1, v47
 s_add_u32 s0, s0, 1
 s_cmp_ge_u32 s0, 524288
 s_cbranch_scc1 L_b20_d
 s_nop 1
 s_cbranch_vccnz L_b20_l
 s_branch L_b20_d
 .p2align 12
L_tB:
 s_lshr_b32 s7, 128, s1
 s_add_u32 s7, s6, s7
 v_add_u32 v6, s7, v5
 v_mad_u32_u24 v16, v3, s57, v6
 s_xor_b32 s7, s1, 1
 s_mul_i32 s7, s7, 384
 s_add_u32 s7, s6, s7
 v_add_u32 v17, 114688, v16
 v_bfe_u32 v3, v2, 2, 2
 s_branch L_tp_L_tB_0_o
L_tp_L_tB_0:
 s_nop 0
 s_branch L_tr10
 s_nop 0
L_tp_L_tB_0_o:
 v_lshl_add_u32 v3, v4, 3, v3
 v_add_u32 v3, s61, v3
 v_and_b32 v5, 3, v2
 v_and_b32 v6, 1, v4
 v_lshlrev_b32 v6, 1, v6
 v_xor_b32 v5, v5, v6
 v_lshl_add_u32 v5, v5, 4, s7
 v_mad_u32_u24 v18, v3, s57, v5
 s_add_u32 m0, s54, 0
    s_nop 0
 buffer_load_dwordx4 v8, s[8:11], s20 offen lds
 s_add_u32 m0, s54, 1024
    s_nop 0
 buffer_load_dwordx4 v9, s[8:11], s20 offen lds
 s_add_u32 m0, s54, 2048
    s_nop 0
 buffer_load_dwordx4 v10, s[8:11], s20 offen lds
 s_add_u32 m0, s54, 3072
    s_nop 0
 buffer_load_dwordx4 v11, s[8:11], s20 offen lds
 s_add_u32 m0, s54, 4096
    s_nop 0
 s_nop 0
 buffer_load_dwordx4 v12, s[8:11], s20 offen lds
 s_mov_b32 s26, 31457280
 s_mov_b32 s27, 0x20000
 s_mov_b32 s30, 7340032
 s_mov_b32 s31, 0x20000
 s_mov_b32 s34, 2097152
 s_mov_b32 s35, 0x20000
 s_mov_b32 s38, 4194304
 s_mov_b32 s39, 0x20000
 s_lshl2_add_u32 s6, s2, s3
 s_lshl_b32 s6, s6, 13
 s_add_u32 s6, s6, 20971520
 s_add_u32 s48, s24, s6
 s_addc_u32 s49, s25, 0
 s_mov_b32 s50, 2048
 s_mov_b32 s51, 0x20000
 s_mul_i32 s6, s2, 28672
 s_mul_i32 s7, s3, 9600
 s_add_u32 s6, s6, s7
 s_sub_u32 s7, 28672, s7
 s_min_u32 s7, s7, 9600
 s_lshl_b32 s0, s2, 13
 s_cmp_eq_u32 s3, 3
 s_cselect_b32 s6, s0, s6
 s_cselect_b32 s46, 8192, s7
 s_cselect_b32 s0, s32, s28
 s_cselect_b32 s1, s33, s29
 s_add_u32 s44, s0, s6
 s_addc_u32 s45, s1, 0
 s_mov_b32 s47, 0x20000
 v_and_b32 v3, 15, v2
 v_bfe_u32 v5, v3, 1, 3
 s_lshl_b32 s6, s53, 7
 v_add_u32 v7, s6, v3
 v_lshlrev_b32 v7, 7, v7
 v_add_u32 v6, 0, v4
 v_xor_b32 v6, v6, v5
 v_lshl_add_u32 v22, v6, 4, v7
 v_add_u32 v24, 73728, v22
 v_add_u32 v6, 4, v4
 v_xor_b32 v6, v6, v5
 v_lshl_add_u32 v23, v6, 4, v7
 v_add_u32 v25, 73728, v23
 s_mul_i32 s6, s3, 320
 v_lshl_add_u32 v5, v3, 6, s6
 v_lshl_add_u32 v5, v4, 4, v5
 v_cmp_gt_u32 vcc, 5, v3
 v_mov_b32 v6, 2146435072
 v_lshlrev_b32 v33, 7, v2
 v_cndmask_b32 v34, v6, v5, vcc
 v_cmp_gt_u32 vcc, 13, v2
 v_and_b32 v3, 3, v2
 v_lshlrev_b32 v3, 3, v3
 v_cndmask_b32 v33, v6, v33, vcc
 v_lshrrev_b32 v5, 2, v2
 v_add_u32 v3, 32768, v3
 v_lshl_add_u32 v6, v5, 7, v3
 v_bfe_u32 v7, v2, 3, 2
 s_lshl_b32 s6, s52, 1
 v_xor_b32 v7, s6, v7
 v_lshl_add_u32 v26, v7, 5, v6
 v_xor_b32 v7, 1, v7
 v_lshl_add_u32 v28, v7, 5, v6
 v_lshl_add_u32 v6, v5, 6, v3
 v_and_b32 v7, 1, v4
 v_xor_b32_e64 v7, s52, v7
 v_lshl_add_u32 v6, v7, 5, v6
 v_add_u32 v30, 32768, v6
 v_add_u32 v27, 73728, v26
 v_add_u32 v29, 73728, v28
 v_add_u32 v31, 73728, v30
 s_bfe_u32 s68, s2, 0x20003
 s_lshl3_add_u32 s69, s4, s5
 s_mul_i32 s69, s69, 1280
 s_add_u32 s69, s69, 29360128
 s_mov_b32 s57, 0
 s_min_u32 s71, s68, 2
 s_add_u32 s71, s71, 9
 s_lshr_b32 s70, s71, 1
 s_lshl4_add_u32 s70, s3, s70
 s_and_b32 s71, s71, 1
 s_lshl3_add_u32 s70, s71, s70
 s_xor_b32 s71, s70, 8
 s_mov_b32 s60, 0
 s_mov_b32 s61, 1024
 s_lshl_b32 s0, s3, 12
 s_lshl_b32 s1, s2, 14
 s_add_u32 s1, s1, s0
 s_add_u32 s0, s0, 147456
 v_and_b32 v3, 15, v2
 v_cmp_eq_u32 vcc, 0, v3
 v_mov_b32 v3, 0x3f803f80
    s_nop 0
 v_cndmask_b32 v35, 0, v3, vcc
 v_mov_b64 v[4:5], -1
 v_mov_b64 v[6:7], -1
 s_mov_b32 s72, 0
L_cs1:
 s_cmp_eq_u32 s53, 0
 s_cbranch_scc0 L_cs1_1
 v_mfma_f32_16x16x32_bf16 v[40:43], a[64:67], v[44:47], v[40:43]
 v_mov_b32_dpp v36, v44 row_shr:1 row_mask:0xf bank_mask:0xf bound_ctrl:0
 v_mov_b32_dpp v37, v45 row_shr:1 row_mask:0xf bank_mask:0xf bound_ctrl:0
 v_mov_b64 v[38:39], v[36:37]
 v_mfma_f32_16x16x32_bf16 v[40:43], a[68:71], v[44:47], v[40:43]
    s_nop 0
 v_mfma_f32_16x16x32_bf16 v[40:43], a[72:75], v[36:39], v[40:43]
 v_mov_b32_dpp v44, v36 row_shr:1 row_mask:0xf bank_mask:0xf bound_ctrl:0
 v_mov_b32_dpp v45, v37 row_shr:1 row_mask:0xf bank_mask:0xf bound_ctrl:0
 v_mov_b64 v[46:47], v[44:45]
 v_mfma_f32_16x16x32_bf16 v[40:43], a[76:79], v[36:39], v[40:43]
    s_nop 0
 v_mfma_f32_16x16x32_bf16 v[40:43], a[80:83], v[44:47], v[40:43]
 v_mov_b32_dpp v36, v44 row_shr:1 row_mask:0xf bank_mask:0xf bound_ctrl:0
 v_mov_b32_dpp v37, v45 row_shr:1 row_mask:0xf bank_mask:0xf bound_ctrl:0
 v_mov_b64 v[38:39], v[36:37]
 v_mfma_f32_16x16x32_bf16 v[40:43], a[84:87], v[44:47], v[40:43]
    s_nop 0
 v_mfma_f32_16x16x32_bf16 v[40:43], a[88:91], v[36:39], v[40:43]
 v_mov_b32_dpp v44, v36 row_shr:1 row_mask:0xf bank_mask:0xf bound_ctrl:0
 v_mov_b32_dpp v45, v37 row_shr:1 row_mask:0xf bank_mask:0xf bound_ctrl:0
 v_mov_b64 v[46:47], v[44:45]
 v_mfma_f32_16x16x32_bf16 v[40:43], a[92:95], v[36:39], v[40:43]
    s_nop 0
 v_mfma_f32_16x16x32_bf16 v[40:43], a[96:99], v[44:47], v[40:43]
 s_cmp_eq_u32 s72, 3
 v_mfma_f32_16x16x32_bf16 v[40:43], a[100:103], v[44:47], v[40:43]
 s_cbranch_scc1 L_cs1_d3
 s_cmp_eq_u32 s72, 2
 s_cbranch_scc1 L_cs1_d2
 s_cmp_eq_u32 s72, 1
 s_cbranch_scc1 L_cs1_d1
 s_branch L_cs1_d0
L_cs1_1:
 v_mfma_f32_16x16x32_bf16 v[40:43], a[104:107], v[44:47], v[40:43]
 v_mov_b32_dpp v36, v44 row_shr:1 row_mask:0xf bank_mask:0xf bound_ctrl:0
 v_mov_b32_dpp v37, v45 row_shr:1 row_mask:0xf bank_mask:0xf bound_ctrl:0
 v_mov_b64 v[38:39], v[36:37]
 v_mfma_f32_16x16x32_bf16 v[40:43], a[108:111], v[44:47], v[40:43]
    s_nop 0
 v_mfma_f32_16x16x32_bf16 v[40:43], a[112:115], v[36:39], v[40:43]
 v_mov_b32_dpp v44, v36 row_shr:1 row_mask:0xf bank_mask:0xf bound_ctrl:0
 v_mov_b32_dpp v45, v37 row_shr:1 row_mask:0xf bank_mask:0xf bound_ctrl:0
 v_mov_b64 v[46:47], v[44:45]
 v_mfma_f32_16x16x32_bf16 v[40:43], a[116:119], v[36:39], v[40:43]
    s_nop 0
 v_mfma_f32_16x16x32_bf16 v[40:43], a[120:123], v[44:47], v[40:43]
 v_mov_b32_dpp v36, v44 row_shr:1 row_mask:0xf bank_mask:0xf bound_ctrl:0
 v_mov_b32_dpp v37, v45 row_shr:1 row_mask:0xf bank_mask:0xf bound_ctrl:0
 v_mov_b64 v[38:39], v[36:37]
 v_mfma_f32_16x16x32_bf16 v[40:43], a[124:127], v[44:47], v[40:43]
    s_nop 0
 v_mfma_f32_16x16x32_bf16 v[40:43], a[128:131], v[36:39], v[40:43]
 v_mov_b32_dpp v44, v36 row_shr:1 row_mask:0xf bank_mask:0xf bound_ctrl:0
 v_mov_b32_dpp v45, v37 row_shr:1 row_mask:0xf bank_mask:0xf bound_ctrl:0
 v_mov_b64 v[46:47], v[44:45]
 v_mfma_f32_16x16x32_bf16 v[40:43], a[132:135], v[36:39], v[40:43]
    s_nop 0
 v_mfma_f32_16x16x32_bf16 v[40:43], a[136:139], v[44:47], v[40:43]
 s_cmp_eq_u32 s72, 3
 v_mfma_f32_16x16x32_bf16 v[40:43], a[140:143], v[44:47], v[40:43]
 s_cbranch_scc1 L_cs1_d3
 s_cmp_eq_u32 s72, 2
 s_cbranch_scc1 L_cs1_d2
 s_cmp_eq_u32 s72, 1
 s_cbranch_scc1 L_cs1_d1
L_cs1_d0:
 s_cmp_eq_u32 s3, 0
 s_cbranch_scc1 L_tp_L_tB_1
 s_cmp_eq_u32 s3, 1
 s_cbranch_scc1 L_tp_L_tB_2
 s_cmp_eq_u32 s3, 2
 s_cbranch_scc1 L_tp_L_tB_3
 s_branch L_tp_L_tB_4
L_tr10:
 s_add_u32 m0, s54, 5120
    s_nop 0
 buffer_load_dwordx4 v13, s[8:11], s20 offen lds
 s_add_u32 m0, s54, 6144
    s_nop 0
 buffer_load_dwordx4 v14, s[8:11], s20 offen lds
 s_add_u32 m0, s54, 7168
    s_nop 0
 buffer_load_dwordx4 v15, s[8:11], s20 offen lds
 s_add_u32 m0, s55, 0
    s_nop 0
 buffer_load_dwordx4 v16, s[16:19], s22 offen lds
 s_add_u32 m0, s55, 16256
    s_nop 0
 buffer_load_dwordx4 v16, s[16:19], s22 offen offset:128 lds
 s_add_u32 m0, s55, 1024
    s_nop 0
 buffer_load_dwordx4 v17, s[16:19], s22 offen lds
 s_add_u32 m0, s55, 17280
    s_nop 0
 buffer_load_dwordx4 v17, s[16:19], s22 offen offset:128 lds
 s_add_u32 m0, s55, 8192
    s_nop 0
 buffer_load_dwordx4 v16, s[64:67], s22 offen lds
 s_add_u32 m0, s55, 24448
    s_nop 0
 buffer_load_dwordx4 v16, s[64:67], s22 offen offset:128 lds
 s_add_u32 m0, s55, 9216
    s_nop 0
 buffer_load_dwordx4 v17, s[64:67], s22 offen lds
 s_add_u32 m0, s55, 25472
    s_nop 0
 buffer_load_dwordx4 v17, s[64:67], s22 offen offset:128 lds
 s_add_u32 m0, s56, 0
    s_nop 0
 buffer_load_dwordx4 v18, s[16:19], s22 offen lds
 s_add_u32 m0, s56, 4096
    s_nop 0
 buffer_load_dwordx4 v18, s[64:67], s22 offen lds
 v_mov_b64 v[40:41], 0
 v_mov_b64 v[42:43], 0
 s_barrier
 buffer_load_dword v0, v32, s[40:43], s58 offen
 s_add_u32 s23, s23, 1
 s_and_b32 s23, s23, 15
 s_mul_i32 s22, s23, 458752
 s_mul_i32 s21, s23, 393216
 s_lshl_b32 s20, s23, 7
 s_mov_b32 s100, 1
 s_bitcmp1_b32 s2, 2
 s_cselect_b32 s6, 2, 0
 s_cmp_lt_u32 s3, 2
 s_cselect_b32 s6, 0, s6
 s_add_u32 s6, s6, s3
 s_cmp_eq_u32 s6, 0
 s_cbranch_scc1 L_tp_L_tB_9
 s_cmp_eq_u32 s6, 1
 s_cbranch_scc1 L_tp_L_tB_10
 s_cmp_eq_u32 s6, 2
 s_cbranch_scc1 L_tp_L_tail0_0
 s_cmp_eq_u32 s6, 3
 s_cbranch_scc1 L_tp_L_tail0_1
 s_cmp_eq_u32 s6, 4
 s_cbranch_scc1 L_tp_L_tail1_0
 s_branch L_tp_L_tail1_1
L_tr11:
 s_waitcnt vmcnt(1)
 s_barrier
 ds_read_b128 a[0:3], v22 offset:0
 ds_read_b128 a[4:7], v23 offset:0
 ds_read_b64_tr_b16 a[64:65], v26 offset:0
 ds_read_b64_tr_b16 a[66:67], v26 offset:2048
 ds_read_b64_tr_b16 a[68:69], v26 offset:4096
 ds_read_b64_tr_b16 a[70:71], v26 offset:6144
 ds_read_b128 a[8:11], v22 offset:2048
 ds_read_b128 a[12:15], v23 offset:2048
 ds_read_b128 a[16:19], v22 offset:4096
 ds_read_b128 a[20:23], v23 offset:4096
 ds_read_b128 a[24:27], v22 offset:6144
 ds_read_b128 a[28:31], v23 offset:6144
 ds_read_b64_tr_b16 a[72:73], v26 offset:8192
 ds_read_b64_tr_b16 a[74:75], v26 offset:10240
 ds_read_b64_tr_b16 a[76:77], v26 offset:12288
 ds_read_b64_tr_b16 a[78:79], v26 offset:14336
 s_waitcnt lgkmcnt(4)
 v_mfma_f32_16x16x32_bf16 v[48:51], a[64:67], a[0:3], 0
 s_add_u32 s58, s23, 1
 ds_read_b64_tr_b16 a[80:81], v28 offset:0
 v_mfma_f32_16x16x32_bf16 v[48:51], a[68:71], a[4:7], v[48:51]
 s_and_b32 s58, s58, 15
 ds_read_b64_tr_b16 a[82:83], v28 offset:2048
 v_mfma_f32_16x16x32_bf16 v[52:55], a[68:71], a[12:15], 0
 s_mul_i32 s58, s58, s59
 ds_read_b64_tr_b16 a[84:85], v28 offset:4096
 v_mfma_f32_16x16x32_bf16 v[52:55], a[64:67], a[8:11], v[52:55]
 ds_read_b64_tr_b16 a[86:87], v28 offset:6144
 v_mfma_f32_16x16x32_bf16 v[56:59], a[64:67], a[16:19], 0
 ds_read_b128 a[32:35], v22 offset:8192
 v_mfma_f32_16x16x32_bf16 v[56:59], a[68:71], a[20:23], v[56:59]
 v_mfma_f32_16x16x32_bf16 v[60:63], a[68:71], a[28:31], 0
 v_mfma_f32_16x16x32_bf16 v[60:63], a[64:67], a[24:27], v[60:63]
 s_waitcnt lgkmcnt(5)
 v_mfma_f32_16x16x32_bf16 v[92:95], a[72:75], a[24:27], 0
 ds_read_b64_tr_b16 a[88:89], v28 offset:8192
 v_mfma_f32_16x16x32_bf16 v[92:95], a[76:79], a[28:31], v[92:95]
 ds_read_b64_tr_b16 a[90:91], v28 offset:10240
 v_mfma_f32_16x16x32_bf16 v[88:91], a[76:79], a[20:23], 0
 ds_read_b64_tr_b16 a[92:93], v28 offset:12288
 v_mfma_f32_16x16x32_bf16 v[88:91], a[72:75], a[16:19], v[88:91]
 ds_read_b64_tr_b16 a[94:95], v28 offset:14336
 v_mfma_f32_16x16x32_bf16 v[84:87], a[72:75], a[8:11], 0
 ds_read_b128 a[36:39], v23 offset:8192
 v_mfma_f32_16x16x32_bf16 v[84:87], a[76:79], a[12:15], v[84:87]
 v_mfma_f32_16x16x32_bf16 v[80:83], a[76:79], a[4:7], 0
 v_mfma_f32_16x16x32_bf16 v[80:83], a[72:75], a[0:3], v[80:83]
 s_add_u32 m0, s54, 73728
 s_waitcnt lgkmcnt(5)
 v_mfma_f32_16x16x32_bf16 v[112:115], a[80:83], a[0:3], 0
 buffer_load_dwordx4 v8, s[8:11], s20 offen lds
 ds_read_b64_tr_b16 a[96:97], v30 offset:0
 v_mfma_f32_16x16x32_bf16 v[112:115], a[84:87], a[4:7], v[112:115]
 ds_read_b64_tr_b16 a[98:99], v30 offset:1024
 v_mfma_f32_16x16x32_bf16 v[116:119], a[84:87], a[12:15], 0
 s_add_u32 m0, s54, 74752
 ds_read_b64_tr_b16 a[100:101], v30 offset:2048
 v_mfma_f32_16x16x32_bf16 v[116:119], a[80:83], a[8:11], v[116:119]
 buffer_load_dwordx4 v9, s[8:11], s20 offen lds
 v_mfma_f32_16x16x32_bf16 v[120:123], a[80:83], a[16:19], 0
 ds_read_b64_tr_b16 a[102:103], v30 offset:3072
 v_mfma_f32_16x16x32_bf16 v[120:123], a[84:87], a[20:23], v[120:123]
 s_add_u32 m0, s54, 75776
 ds_read_b128 a[40:43], v22 offset:10240
 v_mfma_f32_16x16x32_bf16 v[124:127], a[84:87], a[28:31], 0
 buffer_load_dwordx4 v10, s[8:11], s20 offen lds
 v_mfma_f32_16x16x32_bf16 v[124:127], a[80:83], a[24:27], v[124:127]
 s_waitcnt lgkmcnt(5)
 v_mfma_f32_16x16x32_bf16 v[156:159], a[88:91], a[24:27], 0
 s_add_u32 m0, s54, 76800
 ds_read_b64_tr_b16 a[104:105], v30 offset:4096
 v_mfma_f32_16x16x32_bf16 v[156:159], a[92:95], a[28:31], v[156:159]
 buffer_load_dwordx4 v11, s[8:11], s20 offen lds
 v_mfma_f32_16x16x32_bf16 v[152:155], a[92:95], a[20:23], 0
 ds_read_b64_tr_b16 a[106:107], v30 offset:5120
 v_mfma_f32_16x16x32_bf16 v[152:155], a[88:91], a[16:19], v[152:155]
 s_add_u32 m0, s54, 77824
 ds_read_b64_tr_b16 a[108:109], v30 offset:6144
 v_mfma_f32_16x16x32_bf16 v[148:151], a[88:91], a[8:11], 0
 buffer_load_dwordx4 v12, s[8:11], s20 offen lds
 v_mfma_f32_16x16x32_bf16 v[148:151], a[92:95], a[12:15], v[148:151]
 ds_read_b64_tr_b16 a[110:111], v30 offset:7168
 v_mfma_f32_16x16x32_bf16 v[144:147], a[92:95], a[4:7], 0
 s_add_u32 m0, s54, 78848
 ds_read_b128 a[44:47], v23 offset:10240
 v_mfma_f32_16x16x32_bf16 v[144:147], a[88:91], a[0:3], v[144:147]
 s_waitcnt lgkmcnt(5)
 buffer_load_dwordx4 v13, s[8:11], s20 offen lds
 v_mfma_f32_16x16x32_bf16 v[176:179], a[96:99], a[0:3], 0
 ds_read_b64_tr_b16 a[112:113], v26 offset:16384
 v_mfma_f32_16x16x32_bf16 v[176:179], a[100:103], a[4:7], v[176:179]
 s_add_u32 m0, s54, 79872
 ds_read_b64_tr_b16 a[114:115], v26 offset:18432
 v_mfma_f32_16x16x32_bf16 v[180:183], a[100:103], a[12:15], 0
 buffer_load_dwordx4 v14, s[8:11], s20 offen lds
 v_mfma_f32_16x16x32_bf16 v[180:183], a[96:99], a[8:11], v[180:183]
 ds_read_b64_tr_b16 a[116:117], v26 offset:20480
 v_mfma_f32_16x16x32_bf16 v[184:187], a[96:99], a[16:19], 0
 s_add_u32 m0, s54, 80896
 ds_read_b64_tr_b16 a[118:119], v26 offset:22528
 v_mfma_f32_16x16x32_bf16 v[184:187], a[100:103], a[20:23], v[184:187]
 buffer_load_dwordx4 v15, s[8:11], s20 offen lds
 v_mfma_f32_16x16x32_bf16 v[188:191], a[100:103], a[28:31], 0
 ds_read_b128 a[48:51], v22 offset:12288
 v_mfma_f32_16x16x32_bf16 v[188:191], a[96:99], a[24:27], v[188:191]
 s_add_u32 m0, s55, 73728
 s_waitcnt lgkmcnt(5)
 v_mfma_f32_16x16x32_bf16 v[220:223], a[104:107], a[24:27], 0
 buffer_load_dwordx4 v16, s[16:19], s22 offen lds
 ds_read_b64_tr_b16 a[120:121], v26 offset:24576
 v_mfma_f32_16x16x32_bf16 v[220:223], a[108:111], a[28:31], v[220:223]
 ds_read_b64_tr_b16 a[122:123], v26 offset:26624
 v_mfma_f32_16x16x32_bf16 v[216:219], a[108:111], a[20:23], 0
 s_add_u32 m0, s55, 89984
 ds_read_b64_tr_b16 a[124:125], v26 offset:28672
 v_mfma_f32_16x16x32_bf16 v[216:219], a[104:107], a[16:19], v[216:219]
 buffer_load_dwordx4 v16, s[16:19], s22 offen offset:128 lds
 v_mfma_f32_16x16x32_bf16 v[212:215], a[104:107], a[8:11], 0
 ds_read_b64_tr_b16 a[126:127], v26 offset:30720
 v_mfma_f32_16x16x32_bf16 v[212:215], a[108:111], a[12:15], v[212:215]
 s_add_u32 m0, s55, 74752
 ds_read_b128 a[52:55], v23 offset:12288
 v_mfma_f32_16x16x32_bf16 v[208:211], a[108:111], a[4:7], 0
 buffer_load_dwordx4 v17, s[16:19], s22 offen lds
 v_mfma_f32_16x16x32_bf16 v[208:211], a[104:107], a[0:3], v[208:211]
 s_waitcnt lgkmcnt(5)
 v_mfma_f32_16x16x32_bf16 v[240:243], a[112:115], a[0:3], 0
 s_add_u32 m0, s55, 91008
 ds_read_b64_tr_b16 a[128:129], v28 offset:16384
 v_mfma_f32_16x16x32_bf16 v[240:243], a[116:119], a[4:7], v[240:243]
 buffer_load_dwordx4 v17, s[16:19], s22 offen offset:128 lds
 v_mfma_f32_16x16x32_bf16 v[244:247], a[116:119], a[12:15], 0
 ds_read_b64_tr_b16 a[130:131], v28 offset:18432
 v_mfma_f32_16x16x32_bf16 v[244:247], a[112:115], a[8:11], v[244:247]
 s_add_u32 m0, s55, 81920
 ds_read_b64_tr_b16 a[132:133], v28 offset:20480
 v_mfma_f32_16x16x32_bf16 v[248:251], a[112:115], a[16:19], 0
 buffer_load_dwordx4 v16, s[64:67], s22 offen lds
 v_mfma_f32_16x16x32_bf16 v[248:251], a[116:119], a[20:23], v[248:251]
 ds_read_b64_tr_b16 a[134:135], v28 offset:22528
 v_mfma_f32_16x16x32_bf16 v[252:255], a[116:119], a[28:31], 0
 s_add_u32 m0, s55, 98176
 ds_read_b128 a[56:59], v22 offset:14336
 v_mfma_f32_16x16x32_bf16 v[252:255], a[112:115], a[24:27], v[252:255]
 s_waitcnt lgkmcnt(5)
 buffer_load_dwordx4 v16, s[64:67], s22 offen offset:128 lds
 v_mfma_f32_16x16x32_bf16 a[172:175], a[120:123], a[24:27], 0
 ds_read_b64_tr_b16 a[136:137], v28 offset:24576
 v_mfma_f32_16x16x32_bf16 a[172:175], a[124:127], a[28:31], a[172:175]
 s_add_u32 m0, s55, 82944
 ds_read_b64_tr_b16 a[138:139], v28 offset:26624
 v_mfma_f32_16x16x32_bf16 a[168:171], a[124:127], a[20:23], 0
 buffer_load_dwordx4 v17, s[64:67], s22 offen lds
 v_mfma_f32_16x16x32_bf16 a[168:171], a[120:123], a[16:19], a[168:171]
 ds_read_b64_tr_b16 a[140:141], v28 offset:28672
 v_mfma_f32_16x16x32_bf16 a[164:167], a[120:123], a[8:11], 0
 s_add_u32 m0, s55, 99200
 ds_read_b64_tr_b16 a[142:143], v28 offset:30720
 v_mfma_f32_16x16x32_bf16 a[164:167], a[124:127], a[12:15], a[164:167]
 buffer_load_dwordx4 v17, s[64:67], s22 offen offset:128 lds
 v_mfma_f32_16x16x32_bf16 a[160:163], a[124:127], a[4:7], 0
 s_mov_b32 s72, 1
 ds_read_b128 a[60:63], v23 offset:14336
 v_mfma_f32_16x16x32_bf16 a[160:163], a[120:123], a[0:3], a[160:163]
 s_add_u32 m0, s56, 73728
 s_waitcnt lgkmcnt(5)
 v_mfma_f32_16x16x32_bf16 a[192:195], a[128:131], a[0:3], 0
 buffer_load_dwordx4 v18, s[16:19], s22 offen lds
 v_mfma_f32_16x16x32_bf16 a[192:195], a[132:135], a[4:7], a[192:195]
 v_mfma_f32_16x16x32_bf16 a[196:199], a[132:135], a[12:15], 0
 s_add_u32 m0, s56, 77824
 v_mov_b32 v44, v35
 v_mfma_f32_16x16x32_bf16 a[196:199], a[128:131], a[8:11], a[196:199]
 buffer_load_dwordx4 v18, s[64:67], s22 offen lds
 v_mfma_f32_16x16x32_bf16 a[200:203], a[128:131], a[16:19], 0
 s_add_u32 s23, s23, 1
 s_and_b32 s23, s23, 15
 s_mul_i32 s22, s23, 458752
 v_mov_b32 v45, v35
 v_mfma_f32_16x16x32_bf16 a[200:203], a[132:135], a[20:23], a[200:203]
 s_mul_i32 s21, s23, 393216
 s_lshl_b32 s20, s23, 7
 v_mfma_f32_16x16x32_bf16 a[204:207], a[132:135], a[28:31], 0
 v_mov_b32 v46, v35
 v_mfma_f32_16x16x32_bf16 a[204:207], a[128:131], a[24:27], a[204:207]
 s_waitcnt lgkmcnt(0)
 v_mfma_f32_16x16x32_bf16 a[236:239], a[136:139], a[24:27], 0
 buffer_load_dword v0, v32, s[40:43], s58 offen
 v_mov_b32 v47, v35
 v_mfma_f32_16x16x32_bf16 a[236:239], a[140:143], a[28:31], a[236:239]
 v_mfma_f32_16x16x32_bf16 a[232:235], a[140:143], a[20:23], 0
 v_mfma_f32_16x16x32_bf16 a[232:235], a[136:139], a[16:19], a[232:235]
 v_mfma_f32_16x16x32_bf16 a[228:231], a[136:139], a[8:11], 0
 v_mfma_f32_16x16x32_bf16 a[228:231], a[140:143], a[12:15], a[228:231]
 v_mfma_f32_16x16x32_bf16 a[224:227], a[140:143], a[4:7], 0
 s_cmp_eq_u32 s57, s68
 v_mfma_f32_16x16x32_bf16 a[224:227], a[136:139], a[0:3], a[224:227]
 s_cbranch_scc1 L_cs1
L_cs1_d1:
 v_mfma_f32_16x16x32_bf16 v[64:67], a[64:67], a[32:35], 0
 s_barrier
 v_mfma_f32_16x16x32_bf16 v[64:67], a[68:71], a[36:39], v[64:67]
 v_mfma_f32_16x16x32_bf16 v[68:71], a[68:71], a[44:47], 0
 v_mfma_f32_16x16x32_bf16 v[68:71], a[64:67], a[40:43], v[68:71]
 v_mfma_f32_16x16x32_bf16 v[72:75], a[64:67], a[48:51], 0
 v_mfma_f32_16x16x32_bf16 v[72:75], a[68:71], a[52:55], v[72:75]
 v_mfma_f32_16x16x32_bf16 v[76:79], a[68:71], a[60:63], 0
 v_mfma_f32_16x16x32_bf16 v[76:79], a[64:67], a[56:59], v[76:79]
 v_mfma_f32_16x16x32_bf16 v[108:111], a[72:75], a[56:59], 0
 v_mfma_f32_16x16x32_bf16 v[108:111], a[76:79], a[60:63], v[108:111]
 v_mfma_f32_16x16x32_bf16 v[104:107], a[76:79], a[52:55], 0
 v_mfma_f32_16x16x32_bf16 v[104:107], a[72:75], a[48:51], v[104:107]
 v_mfma_f32_16x16x32_bf16 v[100:103], a[72:75], a[40:43], 0
 v_mfma_f32_16x16x32_bf16 v[100:103], a[76:79], a[44:47], v[100:103]
 v_mfma_f32_16x16x32_bf16 v[96:99], a[76:79], a[36:39], 0
 v_mfma_f32_16x16x32_bf16 v[96:99], a[72:75], a[32:35], v[96:99]
 v_mfma_f32_16x16x32_bf16 v[128:131], a[80:83], a[32:35], 0
 v_mfma_f32_16x16x32_bf16 v[128:131], a[84:87], a[36:39], v[128:131]
 s_add_u32 m0, s54, 0
 v_mfma_f32_16x16x32_bf16 v[132:135], a[84:87], a[44:47], 0
 buffer_load_dwordx4 v8, s[8:11], s20 offen lds
 v_mfma_f32_16x16x32_bf16 v[132:135], a[80:83], a[40:43], v[132:135]
 v_mfma_f32_16x16x32_bf16 v[136:139], a[80:83], a[48:51], 0
 v_mfma_f32_16x16x32_bf16 v[136:139], a[84:87], a[52:55], v[136:139]
 v_mfma_f32_16x16x32_bf16 v[140:143], a[84:87], a[60:63], 0
 s_add_u32 m0, s54, 1024
 v_mfma_f32_16x16x32_bf16 v[140:143], a[80:83], a[56:59], v[140:143]
 buffer_load_dwordx4 v9, s[8:11], s20 offen lds
 v_mfma_f32_16x16x32_bf16 v[172:175], a[88:91], a[56:59], 0
 v_mfma_f32_16x16x32_bf16 v[172:175], a[92:95], a[60:63], v[172:175]
 v_mfma_f32_16x16x32_bf16 v[168:171], a[92:95], a[52:55], 0
 v_mfma_f32_16x16x32_bf16 v[168:171], a[88:91], a[48:51], v[168:171]
 s_add_u32 m0, s54, 2048
 v_mfma_f32_16x16x32_bf16 v[164:167], a[88:91], a[40:43], 0
 buffer_load_dwordx4 v10, s[8:11], s20 offen lds
 v_mfma_f32_16x16x32_bf16 v[164:167], a[92:95], a[44:47], v[164:167]
 v_mfma_f32_16x16x32_bf16 v[160:163], a[92:95], a[36:39], 0
 v_mfma_f32_16x16x32_bf16 v[160:163], a[88:91], a[32:35], v[160:163]
 v_mfma_f32_16x16x32_bf16 v[192:195], a[96:99], a[32:35], 0
 s_add_u32 m0, s54, 3072
 v_mfma_f32_16x16x32_bf16 v[192:195], a[100:103], a[36:39], v[192:195]
 buffer_load_dwordx4 v11, s[8:11], s20 offen lds
 v_mfma_f32_16x16x32_bf16 v[196:199], a[100:103], a[44:47], 0
 v_mfma_f32_16x16x32_bf16 v[196:199], a[96:99], a[40:43], v[196:199]
 v_mfma_f32_16x16x32_bf16 v[200:203], a[96:99], a[48:51], 0
 v_mfma_f32_16x16x32_bf16 v[200:203], a[100:103], a[52:55], v[200:203]
 s_add_u32 m0, s54, 4096
 v_mfma_f32_16x16x32_bf16 v[204:207], a[100:103], a[60:63], 0
 buffer_load_dwordx4 v12, s[8:11], s20 offen lds
 v_mfma_f32_16x16x32_bf16 v[204:207], a[96:99], a[56:59], v[204:207]
 v_mfma_f32_16x16x32_bf16 v[236:239], a[104:107], a[56:59], 0
 s_waitcnt vmcnt(6)
 s_barrier
 ds_read_b128 a[0:3], v24 offset:0
 ds_read_b128 a[4:7], v25 offset:0
 v_mfma_f32_16x16x32_bf16 v[236:239], a[108:111], a[60:63], v[236:239]
 ds_read_b128 a[8:11], v24 offset:2048
 v_mfma_f32_16x16x32_bf16 v[232:235], a[108:111], a[52:55], 0
 s_add_u32 m0, s54, 5120
 ds_read_b128 a[12:15], v25 offset:2048
 v_mfma_f32_16x16x32_bf16 v[232:235], a[104:107], a[48:51], v[232:235]
 buffer_load_dwordx4 v13, s[8:11], s20 offen lds
 ds_read_b128 a[16:19], v24 offset:4096
 v_mfma_f32_16x16x32_bf16 v[228:231], a[104:107], a[40:43], 0
 ds_read_b128 a[20:23], v25 offset:4096
 v_mfma_f32_16x16x32_bf16 v[228:231], a[108:111], a[44:47], v[228:231]
 ds_read_b128 a[24:27], v24 offset:6144
 v_mfma_f32_16x16x32_bf16 v[224:227], a[108:111], a[36:39], 0
 ds_read_b128 a[28:31], v25 offset:6144
 v_mfma_f32_16x16x32_bf16 v[224:227], a[104:107], a[32:35], v[224:227]
 s_add_u32 m0, s54, 6144
 ds_read_b64_tr_b16 a[64:65], v27 offset:0
 v_mfma_f32_16x16x32_bf16 a[144:147], a[112:115], a[32:35], 0
 buffer_load_dwordx4 v14, s[8:11], s20 offen lds
 ds_read_b64_tr_b16 a[66:67], v27 offset:2048
 v_mfma_f32_16x16x32_bf16 a[144:147], a[116:119], a[36:39], a[144:147]
 ds_read_b64_tr_b16 a[68:69], v27 offset:4096
 v_mfma_f32_16x16x32_bf16 a[148:151], a[116:119], a[44:47], 0
 ds_read_b64_tr_b16 a[70:71], v27 offset:6144
 ds_read_b64_tr_b16 a[72:73], v27 offset:8192
 v_mfma_f32_16x16x32_bf16 a[148:151], a[112:115], a[40:43], a[148:151]
 ds_read_b64_tr_b16 a[74:75], v27 offset:10240
 v_mfma_f32_16x16x32_bf16 a[152:155], a[112:115], a[48:51], 0
 s_add_u32 m0, s54, 7168
 ds_read_b64_tr_b16 a[76:77], v27 offset:12288
 v_mfma_f32_16x16x32_bf16 a[152:155], a[116:119], a[52:55], a[152:155]
 buffer_load_dwordx4 v15, s[8:11], s20 offen lds
 ds_read_b64_tr_b16 a[78:79], v27 offset:14336
 v_mfma_f32_16x16x32_bf16 a[156:159], a[116:119], a[60:63], 0
 ds_read_b64_tr_b16 a[80:81], v29 offset:0
 v_mfma_f32_16x16x32_bf16 a[156:159], a[112:115], a[56:59], a[156:159]
 ds_read_b64_tr_b16 a[82:83], v29 offset:2048
 v_mfma_f32_16x16x32_bf16 a[188:191], a[120:123], a[56:59], 0
 ds_read_b64_tr_b16 a[84:85], v29 offset:4096
 v_mfma_f32_16x16x32_bf16 a[188:191], a[124:127], a[60:63], a[188:191]
 s_add_u32 m0, s55, 0
 ds_read_b64_tr_b16 a[86:87], v29 offset:6144
 v_mfma_f32_16x16x32_bf16 a[184:187], a[124:127], a[52:55], 0
 buffer_load_dwordx4 v16, s[16:19], s22 offen lds
 ds_read_b64_tr_b16 a[88:89], v29 offset:8192
 v_mfma_f32_16x16x32_bf16 a[184:187], a[120:123], a[48:51], a[184:187]
 ds_read_b64_tr_b16 a[90:91], v29 offset:10240
 v_mfma_f32_16x16x32_bf16 a[180:183], a[120:123], a[40:43], 0
 ds_read_b64_tr_b16 a[92:93], v29 offset:12288
 ds_read_b64_tr_b16 a[94:95], v29 offset:14336
 v_mfma_f32_16x16x32_bf16 a[180:183], a[124:127], a[44:47], a[180:183]
 ds_read_b64_tr_b16 a[96:97], v31 offset:0
 v_mfma_f32_16x16x32_bf16 a[176:179], a[124:127], a[36:39], 0
 s_add_u32 m0, s55, 16256
 ds_read_b64_tr_b16 a[98:99], v31 offset:1024
 v_mfma_f32_16x16x32_bf16 a[176:179], a[120:123], a[32:35], a[176:179]
 buffer_load_dwordx4 v16, s[16:19], s22 offen offset:128 lds
 ds_read_b64_tr_b16 a[100:101], v31 offset:2048
 v_mfma_f32_16x16x32_bf16 a[208:211], a[128:131], a[32:35], 0
 ds_read_b64_tr_b16 a[102:103], v31 offset:3072
 v_mfma_f32_16x16x32_bf16 a[208:211], a[132:135], a[36:39], a[208:211]
 ds_read_b64_tr_b16 a[104:105], v31 offset:4096
 v_mfma_f32_16x16x32_bf16 a[212:215], a[132:135], a[44:47], 0
 ds_read_b64_tr_b16 a[106:107], v31 offset:5120
 v_mfma_f32_16x16x32_bf16 a[212:215], a[128:131], a[40:43], a[212:215]
 s_add_u32 m0, s55, 1024
 ds_read_b64_tr_b16 a[108:109], v31 offset:6144
 v_mfma_f32_16x16x32_bf16 a[216:219], a[128:131], a[48:51], 0
 buffer_load_dwordx4 v17, s[16:19], s22 offen lds
 ds_read_b64_tr_b16 a[110:111], v31 offset:7168
 v_mfma_f32_16x16x32_bf16 a[216:219], a[132:135], a[52:55], a[216:219]
 ds_read_b64_tr_b16 a[112:113], v27 offset:16384
 v_mfma_f32_16x16x32_bf16 a[220:223], a[132:135], a[60:63], 0
 ds_read_b64_tr_b16 a[114:115], v27 offset:18432
 ds_read_b64_tr_b16 a[116:117], v27 offset:20480
 v_mfma_f32_16x16x32_bf16 a[220:223], a[128:131], a[56:59], a[220:223]
 ds_read_b64_tr_b16 a[118:119], v27 offset:22528
 v_mfma_f32_16x16x32_bf16 a[252:255], a[136:139], a[56:59], 0
 s_add_u32 m0, s55, 17280
 ds_read_b64_tr_b16 a[120:121], v27 offset:24576
 s_branch L_tp_L_tB_1_o
L_tp_L_tB_1:
 s_nop 0
 s_branch L_tp_L_tB_5
 s_nop 0
L_tp_L_tB_1_o:
 v_mfma_f32_16x16x32_bf16 a[252:255], a[140:143], a[60:63], a[252:255]
 buffer_load_dwordx4 v17, s[16:19], s22 offen offset:128 lds
 ds_read_b64_tr_b16 a[122:123], v27 offset:26624
 v_mfma_f32_16x16x32_bf16 a[248:251], a[140:143], a[52:55], 0
 ds_read_b64_tr_b16 a[124:125], v27 offset:28672
 v_mfma_f32_16x16x32_bf16 a[248:251], a[136:139], a[48:51], a[248:251]
 ds_read_b64_tr_b16 a[126:127], v27 offset:30720
 v_mfma_f32_16x16x32_bf16 a[244:247], a[136:139], a[40:43], 0
 ds_read_b64_tr_b16 a[128:129], v29 offset:16384
 v_mfma_f32_16x16x32_bf16 a[244:247], a[140:143], a[44:47], a[244:247]
 s_add_u32 m0, s55, 8192
 ds_read_b64_tr_b16 a[130:131], v29 offset:18432
 v_mfma_f32_16x16x32_bf16 a[240:243], a[140:143], a[36:39], 0
 buffer_load_dwordx4 v16, s[64:67], s22 offen lds
 ds_read_b64_tr_b16 a[132:133], v29 offset:20480
 v_mfma_f32_16x16x32_bf16 a[240:243], a[136:139], a[32:35], a[240:243]
 ds_read_b64_tr_b16 a[134:135], v29 offset:22528
 s_branch L_lam1
 .p2align 4
L_la1:
 s_waitcnt lgkmcnt(4)
 v_mfma_f32_16x16x32_bf16 v[48:51], a[64:67], a[0:3], v[48:51]
 s_add_u32 s58, s23, 1
 s_and_b32 s58, s58, 15
 s_mul_i32 s58, s58, s59
 v_mfma_f32_16x16x32_bf16 v[48:51], a[68:71], a[4:7], v[48:51]
 ds_read_b64_tr_b16 a[136:137], v28 offset:24576
 v_mfma_f32_16x16x32_bf16 v[52:55], a[68:71], a[12:15], v[52:55]
 s_add_u32 m0, s55, 98176
 v_mfma_f32_16x16x32_bf16 v[52:55], a[64:67], a[8:11], v[52:55]
 buffer_load_dwordx4 v16, s[64:67], s22 offen offset:128 lds
 v_mfma_f32_16x16x32_bf16 v[56:59], a[64:67], a[16:19], v[56:59]
 ds_read_b64_tr_b16 a[138:139], v28 offset:26624
 v_mfma_f32_16x16x32_bf16 v[56:59], a[68:71], a[20:23], v[56:59]
 v_mfma_f32_16x16x32_bf16 v[60:63], a[68:71], a[28:31], v[60:63]
 v_mfma_f32_16x16x32_bf16 v[60:63], a[64:67], a[24:27], v[60:63]
 s_add_u32 m0, s55, 82944
 ds_read_b64_tr_b16 a[140:141], v28 offset:28672
 v_mfma_f32_16x16x32_bf16 v[92:95], a[72:75], a[24:27], v[92:95]
 buffer_load_dwordx4 v17, s[64:67], s22 offen lds
 v_mfma_f32_16x16x32_bf16 v[92:95], a[76:79], a[28:31], v[92:95]
 v_mfma_f32_16x16x32_bf16 v[88:91], a[76:79], a[20:23], v[88:91]
 ds_read_b64_tr_b16 a[142:143], v28 offset:30720
 v_mfma_f32_16x16x32_bf16 v[88:91], a[72:75], a[16:19], v[88:91]
 v_mfma_f32_16x16x32_bf16 v[84:87], a[72:75], a[8:11], v[84:87]
 s_add_u32 m0, s55, 99200
 v_mfma_f32_16x16x32_bf16 v[84:87], a[76:79], a[12:15], v[84:87]
 buffer_load_dwordx4 v17, s[64:67], s22 offen offset:128 lds
 v_mfma_f32_16x16x32_bf16 v[80:83], a[76:79], a[4:7], v[80:83]
 ds_read_b128 a[32:35], v22 offset:8192
 v_mfma_f32_16x16x32_bf16 v[80:83], a[72:75], a[0:3], v[80:83]
 v_mfma_f32_16x16x32_bf16 v[112:115], a[80:83], a[0:3], v[112:115]
 ds_read_b128 a[36:39], v23 offset:8192
 v_mfma_f32_16x16x32_bf16 v[112:115], a[84:87], a[4:7], v[112:115]
 s_add_u32 m0, s56, 73728
 v_mfma_f32_16x16x32_bf16 v[116:119], a[84:87], a[12:15], v[116:119]
 buffer_load_dwordx4 v18, s[16:19], s22 offen lds
 v_mfma_f32_16x16x32_bf16 v[116:119], a[80:83], a[8:11], v[116:119]
 ds_read_b128 a[40:43], v22 offset:10240
 v_mfma_f32_16x16x32_bf16 v[120:123], a[80:83], a[16:19], v[120:123]
 v_mfma_f32_16x16x32_bf16 v[120:123], a[84:87], a[20:23], v[120:123]
 v_mfma_f32_16x16x32_bf16 v[124:127], a[84:87], a[28:31], v[124:127]
 s_add_u32 m0, s56, 77824
 ds_read_b128 a[44:47], v23 offset:10240
 v_mfma_f32_16x16x32_bf16 v[124:127], a[80:83], a[24:27], v[124:127]
 buffer_load_dwordx4 v18, s[64:67], s22 offen lds
 v_mfma_f32_16x16x32_bf16 v[156:159], a[88:91], a[24:27], v[156:159]
 v_mfma_f32_16x16x32_bf16 v[156:159], a[92:95], a[28:31], v[156:159]
 ds_read_b128 a[48:51], v22 offset:12288
 v_mfma_f32_16x16x32_bf16 v[152:155], a[92:95], a[20:23], v[152:155]
 v_mfma_f32_16x16x32_bf16 v[152:155], a[88:91], a[16:19], v[152:155]
 v_mfma_f32_16x16x32_bf16 v[148:151], a[88:91], a[8:11], v[148:151]
 ds_read_b128 a[52:55], v23 offset:12288
 v_mfma_f32_16x16x32_bf16 v[148:151], a[92:95], a[12:15], v[148:151]
 v_mfma_f32_16x16x32_bf16 v[144:147], a[92:95], a[4:7], v[144:147]
 v_mfma_f32_16x16x32_bf16 v[144:147], a[88:91], a[0:3], v[144:147]
 ds_read_b128 a[56:59], v22 offset:14336
 v_mfma_f32_16x16x32_bf16 v[176:179], a[96:99], a[0:3], v[176:179]
 v_mfma_f32_16x16x32_bf16 v[176:179], a[100:103], a[4:7], v[176:179]
 v_mfma_f32_16x16x32_bf16 v[180:183], a[100:103], a[12:15], v[180:183]
 ds_read_b128 a[60:63], v23 offset:14336
 v_mfma_f32_16x16x32_bf16 v[180:183], a[96:99], a[8:11], v[180:183]
 v_mfma_f32_16x16x32_bf16 v[184:187], a[96:99], a[16:19], v[184:187]
 v_mfma_f32_16x16x32_bf16 v[184:187], a[100:103], a[20:23], v[184:187]
 v_mfma_f32_16x16x32_bf16 v[188:191], a[100:103], a[28:31], v[188:191]
 v_mfma_f32_16x16x32_bf16 v[188:191], a[96:99], a[24:27], v[188:191]
 v_mfma_f32_16x16x32_bf16 v[220:223], a[104:107], a[24:27], v[220:223]
 v_mfma_f32_16x16x32_bf16 v[220:223], a[108:111], a[28:31], v[220:223]
 v_mfma_f32_16x16x32_bf16 v[216:219], a[108:111], a[20:23], v[216:219]
 v_mfma_f32_16x16x32_bf16 v[216:219], a[104:107], a[16:19], v[216:219]
 v_mfma_f32_16x16x32_bf16 v[212:215], a[104:107], a[8:11], v[212:215]
 buffer_load_dword v0, v32, s[40:43], s58 offen
 v_mfma_f32_16x16x32_bf16 v[212:215], a[108:111], a[12:15], v[212:215]
 v_mfma_f32_16x16x32_bf16 v[208:211], a[108:111], a[4:7], v[208:211]
 v_mfma_f32_16x16x32_bf16 v[208:211], a[104:107], a[0:3], v[208:211]
 buffer_store_dwordx4 v[4:7], v1, s[48:51], s61 offen sc1
 v_mfma_f32_16x16x32_bf16 v[240:243], a[112:115], a[0:3], v[240:243]
 s_add_u32 s61, s61, 1024
 v_mfma_f32_16x16x32_bf16 v[240:243], a[116:119], a[4:7], v[240:243]
 v_mfma_f32_16x16x32_bf16 v[244:247], a[116:119], a[12:15], v[244:247]
 v_mfma_f32_16x16x32_bf16 v[244:247], a[112:115], a[8:11], v[244:247]
 v_mfma_f32_16x16x32_bf16 v[248:251], a[112:115], a[16:19], v[248:251]
 v_mfma_f32_16x16x32_bf16 v[248:251], a[116:119], a[20:23], v[248:251]
 v_mfma_f32_16x16x32_bf16 v[252:255], a[116:119], a[28:31], v[252:255]
 v_mfma_f32_16x16x32_bf16 v[252:255], a[112:115], a[24:27], v[252:255]
 v_mfma_f32_16x16x32_bf16 a[172:175], a[120:123], a[24:27], a[172:175]
 v_mfma_f32_16x16x32_bf16 a[172:175], a[124:127], a[28:31], a[172:175]
 v_mfma_f32_16x16x32_bf16 a[168:171], a[124:127], a[20:23], a[168:171]
 v_mfma_f32_16x16x32_bf16 a[168:171], a[120:123], a[16:19], a[168:171]
 v_mfma_f32_16x16x32_bf16 a[164:167], a[120:123], a[8:11], a[164:167]
 v_mfma_f32_16x16x32_bf16 a[164:167], a[124:127], a[12:15], a[164:167]
 v_mfma_f32_16x16x32_bf16 a[160:163], a[124:127], a[4:7], a[160:163]
 s_mov_b32 s72, 2
 v_mfma_f32_16x16x32_bf16 a[160:163], a[120:123], a[0:3], a[160:163]
 s_waitcnt lgkmcnt(0)
 v_mfma_f32_16x16x32_bf16 a[192:195], a[128:131], a[0:3], a[192:195]
 s_add_u32 s23, s23, 1
 s_and_b32 s23, s23, 15
 s_mul_i32 s22, s23, 458752
 v_mfma_f32_16x16x32_bf16 a[192:195], a[132:135], a[4:7], a[192:195]
 s_mul_i32 s21, s23, 393216
 s_lshl_b32 s20, s23, 7
 v_mfma_f32_16x16x32_bf16 a[196:199], a[132:135], a[12:15], a[196:199]
 v_mov_b32 v44, v35
 v_mfma_f32_16x16x32_bf16 a[196:199], a[128:131], a[8:11], a[196:199]
 v_mfma_f32_16x16x32_bf16 a[200:203], a[128:131], a[16:19], a[200:203]
 v_mov_b32 v45, v35
 v_mfma_f32_16x16x32_bf16 a[200:203], a[132:135], a[20:23], a[200:203]
 v_mfma_f32_16x16x32_bf16 a[204:207], a[132:135], a[28:31], a[204:207]
 v_mov_b32 v46, v35
 v_mfma_f32_16x16x32_bf16 a[204:207], a[128:131], a[24:27], a[204:207]
 v_mfma_f32_16x16x32_bf16 a[236:239], a[136:139], a[24:27], a[236:239]
 v_mov_b32 v47, v35
 v_mfma_f32_16x16x32_bf16 a[236:239], a[140:143], a[28:31], a[236:239]
 v_mfma_f32_16x16x32_bf16 a[232:235], a[140:143], a[20:23], a[232:235]
 v_mfma_f32_16x16x32_bf16 a[232:235], a[136:139], a[16:19], a[232:235]
 v_mfma_f32_16x16x32_bf16 a[228:231], a[136:139], a[8:11], a[228:231]
 v_mfma_f32_16x16x32_bf16 a[228:231], a[140:143], a[12:15], a[228:231]
 v_mfma_f32_16x16x32_bf16 a[224:227], a[140:143], a[4:7], a[224:227]
 s_cmp_eq_u32 s57, s68
 v_mfma_f32_16x16x32_bf16 a[224:227], a[136:139], a[0:3], a[224:227]
 s_cbranch_scc1 L_cs1
L_cs1_d2:
 v_mfma_f32_16x16x32_bf16 v[64:67], a[64:67], a[32:35], v[64:67]
 s_waitcnt vmcnt(2)
 s_barrier
 v_mfma_f32_16x16x32_bf16 v[64:67], a[68:71], a[36:39], v[64:67]
 v_mfma_f32_16x16x32_bf16 v[68:71], a[68:71], a[44:47], v[68:71]
 v_mfma_f32_16x16x32_bf16 v[68:71], a[64:67], a[40:43], v[68:71]
 v_mfma_f32_16x16x32_bf16 v[72:75], a[64:67], a[48:51], v[72:75]
 ds_read_b128 a[0:3], v24 offset:0
 v_mfma_f32_16x16x32_bf16 v[72:75], a[68:71], a[52:55], v[72:75]
 v_mfma_f32_16x16x32_bf16 v[76:79], a[68:71], a[60:63], v[76:79]
 ds_read_b128 a[4:7], v25 offset:0
 v_mfma_f32_16x16x32_bf16 v[76:79], a[64:67], a[56:59], v[76:79]
 v_mfma_f32_16x16x32_bf16 v[108:111], a[72:75], a[56:59], v[108:111]
 v_mfma_f32_16x16x32_bf16 v[108:111], a[76:79], a[60:63], v[108:111]
 ds_read_b64_tr_b16 a[64:65], v27 offset:0
 v_mfma_f32_16x16x32_bf16 v[104:107], a[76:79], a[52:55], v[104:107]
 v_mfma_f32_16x16x32_bf16 v[104:107], a[72:75], a[48:51], v[104:107]
 ds_read_b64_tr_b16 a[66:67], v27 offset:2048
 v_mfma_f32_16x16x32_bf16 v[100:103], a[72:75], a[40:43], v[100:103]
 v_mfma_f32_16x16x32_bf16 v[100:103], a[76:79], a[44:47], v[100:103]
 ds_read_b64_tr_b16 a[68:69], v27 offset:4096
 v_mfma_f32_16x16x32_bf16 v[96:99], a[76:79], a[36:39], v[96:99]
 ds_read_b128 a[8:11], v24 offset:2048
 v_mfma_f32_16x16x32_bf16 v[96:99], a[72:75], a[32:35], v[96:99]
 ds_read_b64_tr_b16 a[70:71], v27 offset:6144
 v_mfma_f32_16x16x32_bf16 v[128:131], a[80:83], a[32:35], v[128:131]
 v_mfma_f32_16x16x32_bf16 v[128:131], a[84:87], a[36:39], v[128:131]
 s_add_u32 m0, s54, 0
 ds_read_b64_tr_b16 a[72:73], v27 offset:8192
 v_mfma_f32_16x16x32_bf16 v[132:135], a[84:87], a[44:47], v[132:135]
 buffer_load_dwordx4 v8, s[8:11], s20 offen lds
 v_mfma_f32_16x16x32_bf16 v[132:135], a[80:83], a[40:43], v[132:135]
 ds_read_b64_tr_b16 a[74:75], v27 offset:10240
 v_mfma_f32_16x16x32_bf16 v[136:139], a[80:83], a[48:51], v[136:139]
 v_mfma_f32_16x16x32_bf16 v[136:139], a[84:87], a[52:55], v[136:139]
 ds_read_b64_tr_b16 a[76:77], v27 offset:12288
 v_mfma_f32_16x16x32_bf16 v[140:143], a[84:87], a[60:63], v[140:143]
 s_add_u32 m0, s54, 1024
 ds_read_b128 a[12:15], v25 offset:2048
 v_mfma_f32_16x16x32_bf16 v[140:143], a[80:83], a[56:59], v[140:143]
 buffer_load_dwordx4 v9, s[8:11], s20 offen lds
 v_mfma_f32_16x16x32_bf16 v[172:175], a[88:91], a[56:59], v[172:175]
 ds_read_b64_tr_b16 a[78:79], v27 offset:14336
 v_mfma_f32_16x16x32_bf16 v[172:175], a[92:95], a[60:63], v[172:175]
 ds_read_b64_tr_b16 a[80:81], v29 offset:0
 v_mfma_f32_16x16x32_bf16 v[168:171], a[92:95], a[52:55], v[168:171]
 v_mfma_f32_16x16x32_bf16 v[168:171], a[88:91], a[48:51], v[168:171]
 s_add_u32 m0, s54, 2048
 ds_read_b64_tr_b16 a[82:83], v29 offset:2048
 v_mfma_f32_16x16x32_bf16 v[164:167], a[88:91], a[40:43], v[164:167]
 buffer_load_dwordx4 v10, s[8:11], s20 offen lds
 v_mfma_f32_16x16x32_bf16 v[164:167], a[92:95], a[44:47], v[164:167]
 ds_read_b64_tr_b16 a[84:85], v29 offset:4096
 v_mfma_f32_16x16x32_bf16 v[160:163], a[92:95], a[36:39], v[160:163]
 ds_read_b128 a[16:19], v24 offset:4096
 v_mfma_f32_16x16x32_bf16 v[160:163], a[88:91], a[32:35], v[160:163]
 ds_read_b64_tr_b16 a[86:87], v29 offset:6144
 v_mfma_f32_16x16x32_bf16 v[192:195], a[96:99], a[32:35], v[192:195]
 s_add_u32 m0, s54, 3072
 v_mfma_f32_16x16x32_bf16 v[192:195], a[100:103], a[36:39], v[192:195]
 buffer_load_dwordx4 v11, s[8:11], s20 offen lds
 v_mfma_f32_16x16x32_bf16 v[196:199], a[100:103], a[44:47], v[196:199]
 ds_read_b64_tr_b16 a[88:89], v29 offset:8192
 v_mfma_f32_16x16x32_bf16 v[196:199], a[96:99], a[40:43], v[196:199]
 ds_read_b64_tr_b16 a[90:91], v29 offset:10240
 v_mfma_f32_16x16x32_bf16 v[200:203], a[96:99], a[48:51], v[200:203]
 v_mfma_f32_16x16x32_bf16 v[200:203], a[100:103], a[52:55], v[200:203]
 s_add_u32 m0, s54, 4096
 ds_read_b64_tr_b16 a[92:93], v29 offset:12288
 v_mfma_f32_16x16x32_bf16 v[204:207], a[100:103], a[60:63], v[204:207]
 buffer_load_dwordx4 v12, s[8:11], s20 offen lds
 v_mfma_f32_16x16x32_bf16 v[204:207], a[96:99], a[56:59], v[204:207]
 ds_read_b64_tr_b16 a[94:95], v29 offset:14336
 v_mfma_f32_16x16x32_bf16 v[236:239], a[104:107], a[56:59], v[236:239]
 ds_read_b128 a[20:23], v25 offset:4096
 v_mfma_f32_16x16x32_bf16 v[236:239], a[108:111], a[60:63], v[236:239]
 ds_read_b64_tr_b16 a[96:97], v31 offset:0
 v_mfma_f32_16x16x32_bf16 v[232:235], a[108:111], a[52:55], v[232:235]
 s_add_u32 m0, s54, 5120
 v_mfma_f32_16x16x32_bf16 v[232:235], a[104:107], a[48:51], v[232:235]
 buffer_load_dwordx4 v13, s[8:11], s20 offen lds
 v_mfma_f32_16x16x32_bf16 v[228:231], a[104:107], a[40:43], v[228:231]
 ds_read_b64_tr_b16 a[98:99], v31 offset:1024
 v_mfma_f32_16x16x32_bf16 v[228:231], a[108:111], a[44:47], v[228:231]
 ds_read_b64_tr_b16 a[100:101], v31 offset:2048
 v_mfma_f32_16x16x32_bf16 v[224:227], a[108:111], a[36:39], v[224:227]
 ds_read_b128 a[24:27], v24 offset:6144
 v_mfma_f32_16x16x32_bf16 v[224:227], a[104:107], a[32:35], v[224:227]
 s_add_u32 m0, s54, 6144
 ds_read_b64_tr_b16 a[102:103], v31 offset:3072
 v_mfma_f32_16x16x32_bf16 a[144:147], a[112:115], a[32:35], a[144:147]
 buffer_load_dwordx4 v14, s[8:11], s20 offen lds
 v_mfma_f32_16x16x32_bf16 a[144:147], a[116:119], a[36:39], a[144:147]
 ds_read_b64_tr_b16 a[104:105], v31 offset:4096
 v_mfma_f32_16x16x32_bf16 a[148:151], a[116:119], a[44:47], a[148:151]
 v_mfma_f32_16x16x32_bf16 a[148:151], a[112:115], a[40:43], a[148:151]
 ds_read_b64_tr_b16 a[106:107], v31 offset:5120
 v_mfma_f32_16x16x32_bf16 a[152:155], a[112:115], a[48:51], a[152:155]
 s_add_u32 m0, s54, 7168
 v_mfma_f32_16x16x32_bf16 a[152:155], a[116:119], a[52:55], a[152:155]
 buffer_load_dwordx4 v15, s[8:11], s20 offen lds
 v_mfma_f32_16x16x32_bf16 a[156:159], a[116:119], a[60:63], a[156:159]
 ds_read_b64_tr_b16 a[108:109], v31 offset:6144
 v_mfma_f32_16x16x32_bf16 a[156:159], a[112:115], a[56:59], a[156:159]
 ds_read_b64_tr_b16 a[110:111], v31 offset:7168
 v_mfma_f32_16x16x32_bf16 a[188:191], a[120:123], a[56:59], a[188:191]
 ds_read_b128 a[28:31], v25 offset:6144
 v_mfma_f32_16x16x32_bf16 a[188:191], a[124:127], a[60:63], a[188:191]
 s_add_u32 m0, s55, 0
 ds_read_b64_tr_b16 a[112:113], v27 offset:16384
 v_mfma_f32_16x16x32_bf16 a[184:187], a[124:127], a[52:55], a[184:187]
 buffer_load_dwordx4 v16, s[16:19], s22 offen lds
 v_mfma_f32_16x16x32_bf16 a[184:187], a[120:123], a[48:51], a[184:187]
 ds_read_b64_tr_b16 a[114:115], v27 offset:18432
 v_mfma_f32_16x16x32_bf16 a[180:183], a[120:123], a[40:43], a[180:183]
 v_mfma_f32_16x16x32_bf16 a[180:183], a[124:127], a[44:47], a[180:183]
 ds_read_b64_tr_b16 a[116:117], v27 offset:20480
 v_mfma_f32_16x16x32_bf16 a[176:179], a[124:127], a[36:39], a[176:179]
 s_add_u32 m0, s55, 16256
 v_mfma_f32_16x16x32_bf16 a[176:179], a[120:123], a[32:35], a[176:179]
 buffer_load_dwordx4 v16, s[16:19], s22 offen offset:128 lds
 v_mfma_f32_16x16x32_bf16 a[208:211], a[128:131], a[32:35], a[208:211]
 ds_read_b64_tr_b16 a[118:119], v27 offset:22528
 v_mfma_f32_16x16x32_bf16 a[208:211], a[132:135], a[36:39], a[208:211]
 ds_read_b64_tr_b16 a[120:121], v27 offset:24576
 v_mfma_f32_16x16x32_bf16 a[212:215], a[132:135], a[44:47], a[212:215]
 v_mfma_f32_16x16x32_bf16 a[212:215], a[128:131], a[40:43], a[212:215]
 s_add_u32 m0, s55, 1024
 ds_read_b64_tr_b16 a[122:123], v27 offset:26624
 v_mfma_f32_16x16x32_bf16 a[216:219], a[128:131], a[48:51], a[216:219]
 buffer_load_dwordx4 v17, s[16:19], s22 offen lds
 v_mfma_f32_16x16x32_bf16 a[216:219], a[132:135], a[52:55], a[216:219]
 ds_read_b64_tr_b16 a[124:125], v27 offset:28672
 v_mfma_f32_16x16x32_bf16 a[220:223], a[132:135], a[60:63], a[220:223]
 v_mfma_f32_16x16x32_bf16 a[220:223], a[128:131], a[56:59], a[220:223]
 ds_read_b64_tr_b16 a[126:127], v27 offset:30720
 v_mfma_f32_16x16x32_bf16 a[252:255], a[136:139], a[56:59], a[252:255]
 s_add_u32 m0, s55, 17280
 v_mfma_f32_16x16x32_bf16 a[252:255], a[140:143], a[60:63], a[252:255]
 buffer_load_dwordx4 v17, s[16:19], s22 offen offset:128 lds
 v_mfma_f32_16x16x32_bf16 a[248:251], a[140:143], a[52:55], a[248:251]
 ds_read_b64_tr_b16 a[128:129], v29 offset:16384
 v_mfma_f32_16x16x32_bf16 a[248:251], a[136:139], a[48:51], a[248:251]
 ds_read_b64_tr_b16 a[130:131], v29 offset:18432
 v_mfma_f32_16x16x32_bf16 a[244:247], a[136:139], a[40:43], a[244:247]
 v_mfma_f32_16x16x32_bf16 a[244:247], a[140:143], a[44:47], a[244:247]
 s_add_u32 m0, s55, 8192
 ds_read_b64_tr_b16 a[132:133], v29 offset:20480
 v_mfma_f32_16x16x32_bf16 a[240:243], a[140:143], a[36:39], a[240:243]
 buffer_load_dwordx4 v16, s[64:67], s22 offen lds
 v_mfma_f32_16x16x32_bf16 a[240:243], a[136:139], a[32:35], a[240:243]
 ds_read_b64_tr_b16 a[134:135], v29 offset:22528
L_lam1:
 s_waitcnt lgkmcnt(4)
 v_mfma_f32_16x16x32_bf16 v[48:51], a[64:67], a[0:3], v[48:51]
 s_add_u32 s58, s23, 1
 s_and_b32 s58, s58, 15
 s_branch L_tp_L_tB_2_o
L_tp_L_tB_2:
 s_nop 0
 s_branch L_tp_L_tB_6
 s_nop 0
L_tp_L_tB_2_o:
 s_mul_i32 s58, s58, s59
 v_mfma_f32_16x16x32_bf16 v[48:51], a[68:71], a[4:7], v[48:51]
 ds_read_b64_tr_b16 a[136:137], v29 offset:24576
 v_mfma_f32_16x16x32_bf16 v[52:55], a[68:71], a[12:15], v[52:55]
 s_add_u32 m0, s55, 24448
 v_mfma_f32_16x16x32_bf16 v[52:55], a[64:67], a[8:11], v[52:55]
 buffer_load_dwordx4 v16, s[64:67], s22 offen offset:128 lds
 v_mfma_f32_16x16x32_bf16 v[56:59], a[64:67], a[16:19], v[56:59]
 ds_read_b64_tr_b16 a[138:139], v29 offset:26624
 v_mfma_f32_16x16x32_bf16 v[56:59], a[68:71], a[20:23], v[56:59]
 v_mfma_f32_16x16x32_bf16 v[60:63], a[68:71], a[28:31], v[60:63]
 v_mfma_f32_16x16x32_bf16 v[60:63], a[64:67], a[24:27], v[60:63]
 s_add_u32 m0, s55, 9216
 ds_read_b64_tr_b16 a[140:141], v29 offset:28672
 v_mfma_f32_16x16x32_bf16 v[92:95], a[72:75], a[24:27], v[92:95]
 buffer_load_dwordx4 v17, s[64:67], s22 offen lds
 v_mfma_f32_16x16x32_bf16 v[92:95], a[76:79], a[28:31], v[92:95]
 v_mfma_f32_16x16x32_bf16 v[88:91], a[76:79], a[20:23], v[88:91]
 ds_read_b64_tr_b16 a[142:143], v29 offset:30720
 v_mfma_f32_16x16x32_bf16 v[88:91], a[72:75], a[16:19], v[88:91]
 v_mfma_f32_16x16x32_bf16 v[84:87], a[72:75], a[8:11], v[84:87]
 s_add_u32 m0, s55, 25472
 v_mfma_f32_16x16x32_bf16 v[84:87], a[76:79], a[12:15], v[84:87]
 buffer_load_dwordx4 v17, s[64:67], s22 offen offset:128 lds
 v_mfma_f32_16x16x32_bf16 v[80:83], a[76:79], a[4:7], v[80:83]
 ds_read_b128 a[32:35], v24 offset:8192
 v_mfma_f32_16x16x32_bf16 v[80:83], a[72:75], a[0:3], v[80:83]
 v_mfma_f32_16x16x32_bf16 v[112:115], a[80:83], a[0:3], v[112:115]
 ds_read_b128 a[36:39], v25 offset:8192
 v_mfma_f32_16x16x32_bf16 v[112:115], a[84:87], a[4:7], v[112:115]
 s_add_u32 m0, s56, 0
 v_mfma_f32_16x16x32_bf16 v[116:119], a[84:87], a[12:15], v[116:119]
 buffer_load_dwordx4 v18, s[16:19], s22 offen lds
 v_mfma_f32_16x16x32_bf16 v[116:119], a[80:83], a[8:11], v[116:119]
 ds_read_b128 a[40:43], v24 offset:10240
 v_mfma_f32_16x16x32_bf16 v[120:123], a[80:83], a[16:19], v[120:123]
 v_mfma_f32_16x16x32_bf16 v[120:123], a[84:87], a[20:23], v[120:123]
 v_mfma_f32_16x16x32_bf16 v[124:127], a[84:87], a[28:31], v[124:127]
 s_add_u32 m0, s56, 4096
 ds_read_b128 a[44:47], v25 offset:10240
 v_mfma_f32_16x16x32_bf16 v[124:127], a[80:83], a[24:27], v[124:127]
 buffer_load_dwordx4 v18, s[64:67], s22 offen lds
 v_mfma_f32_16x16x32_bf16 v[156:159], a[88:91], a[24:27], v[156:159]
 v_mfma_f32_16x16x32_bf16 v[156:159], a[92:95], a[28:31], v[156:159]
 ds_read_b128 a[48:51], v24 offset:12288
 v_mfma_f32_16x16x32_bf16 v[152:155], a[92:95], a[20:23], v[152:155]
 v_mfma_f32_16x16x32_bf16 v[152:155], a[88:91], a[16:19], v[152:155]
 v_mfma_f32_16x16x32_bf16 v[148:151], a[88:91], a[8:11], v[148:151]
 ds_read_b128 a[52:55], v25 offset:12288
 v_mfma_f32_16x16x32_bf16 v[148:151], a[92:95], a[12:15], v[148:151]
 v_mfma_f32_16x16x32_bf16 v[144:147], a[92:95], a[4:7], v[144:147]
 v_mfma_f32_16x16x32_bf16 v[144:147], a[88:91], a[0:3], v[144:147]
 ds_read_b128 a[56:59], v24 offset:14336
 v_mfma_f32_16x16x32_bf16 v[176:179], a[96:99], a[0:3], v[176:179]
 v_mfma_f32_16x16x32_bf16 v[176:179], a[100:103], a[4:7], v[176:179]
 v_mfma_f32_16x16x32_bf16 v[180:183], a[100:103], a[12:15], v[180:183]
 ds_read_b128 a[60:63], v25 offset:14336
 v_mfma_f32_16x16x32_bf16 v[180:183], a[96:99], a[8:11], v[180:183]
 v_mfma_f32_16x16x32_bf16 v[184:187], a[96:99], a[16:19], v[184:187]
 v_mfma_f32_16x16x32_bf16 v[184:187], a[100:103], a[20:23], v[184:187]
 v_mfma_f32_16x16x32_bf16 v[188:191], a[100:103], a[28:31], v[188:191]
 v_mfma_f32_16x16x32_bf16 v[188:191], a[96:99], a[24:27], v[188:191]
 v_mfma_f32_16x16x32_bf16 v[220:223], a[104:107], a[24:27], v[220:223]
 v_mfma_f32_16x16x32_bf16 v[220:223], a[108:111], a[28:31], v[220:223]
 v_mfma_f32_16x16x32_bf16 v[216:219], a[108:111], a[20:23], v[216:219]
 v_mfma_f32_16x16x32_bf16 v[216:219], a[104:107], a[16:19], v[216:219]
 v_mfma_f32_16x16x32_bf16 v[212:215], a[104:107], a[8:11], v[212:215]
 buffer_load_dword v0, v32, s[40:43], s58 offen
 v_mfma_f32_16x16x32_bf16 v[212:215], a[108:111], a[12:15], v[212:215]
 s_mov_b32 m0, s0
 v_mfma_f32_16x16x32_bf16 v[208:211], a[108:111], a[4:7], v[208:211]
 buffer_load_dwordx4 v1, s[8:11], s1 offen lds
 v_mfma_f32_16x16x32_bf16 v[208:211], a[104:107], a[0:3], v[208:211]
 s_add_u32 s0, s0, 1024
 s_add_u32 s1, s1, 1024
 v_mfma_f32_16x16x32_bf16 v[240:243], a[112:115], a[0:3], v[240:243]
 v_mfma_f32_16x16x32_bf16 v[240:243], a[116:119], a[4:7], v[240:243]
 v_mfma_f32_16x16x32_bf16 v[244:247], a[116:119], a[12:15], v[244:247]
 v_mfma_f32_16x16x32_bf16 v[244:247], a[112:115], a[8:11], v[244:247]
 v_mfma_f32_16x16x32_bf16 v[248:251], a[112:115], a[16:19], v[248:251]
 v_mfma_f32_16x16x32_bf16 v[248:251], a[116:119], a[20:23], v[248:251]
 v_mfma_f32_16x16x32_bf16 v[252:255], a[116:119], a[28:31], v[252:255]
 v_mfma_f32_16x16x32_bf16 v[252:255], a[112:115], a[24:27], v[252:255]
 v_mfma_f32_16x16x32_bf16 a[172:175], a[120:123], a[24:27], a[172:175]
 v_mfma_f32_16x16x32_bf16 a[172:175], a[124:127], a[28:31], a[172:175]
 v_mfma_f32_16x16x32_bf16 a[168:171], a[124:127], a[20:23], a[168:171]
 v_mfma_f32_16x16x32_bf16 a[168:171], a[120:123], a[16:19], a[168:171]
 v_mfma_f32_16x16x32_bf16 a[164:167], a[120:123], a[8:11], a[164:167]
 v_mfma_f32_16x16x32_bf16 a[164:167], a[124:127], a[12:15], a[164:167]
 v_mfma_f32_16x16x32_bf16 a[160:163], a[124:127], a[4:7], a[160:163]
 s_mov_b32 s72, 3
 v_mfma_f32_16x16x32_bf16 a[160:163], a[120:123], a[0:3], a[160:163]
 s_waitcnt lgkmcnt(0)
 v_mfma_f32_16x16x32_bf16 a[192:195], a[128:131], a[0:3], a[192:195]
 s_add_u32 s23, s23, 1
 s_and_b32 s23, s23, 15
 s_mul_i32 s22, s23, 458752
 v_mfma_f32_16x16x32_bf16 a[192:195], a[132:135], a[4:7], a[192:195]
 s_mul_i32 s21, s23, 393216
 s_lshl_b32 s20, s23, 7
 v_mfma_f32_16x16x32_bf16 a[196:199], a[132:135], a[12:15], a[196:199]
 v_mov_b32 v44, v35
 v_mfma_f32_16x16x32_bf16 a[196:199], a[128:131], a[8:11], a[196:199]
 v_mfma_f32_16x16x32_bf16 a[200:203], a[128:131], a[16:19], a[200:203]
 v_mov_b32 v45, v35
 v_mfma_f32_16x16x32_bf16 a[200:203], a[132:135], a[20:23], a[200:203]
 v_mfma_f32_16x16x32_bf16 a[204:207], a[132:135], a[28:31], a[204:207]
 v_mov_b32 v46, v35
 v_mfma_f32_16x16x32_bf16 a[204:207], a[128:131], a[24:27], a[204:207]
 v_mfma_f32_16x16x32_bf16 a[236:239], a[136:139], a[24:27], a[236:239]
 v_mov_b32 v47, v35
 v_mfma_f32_16x16x32_bf16 a[236:239], a[140:143], a[28:31], a[236:239]
 v_mfma_f32_16x16x32_bf16 a[232:235], a[140:143], a[20:23], a[232:235]
 v_mfma_f32_16x16x32_bf16 a[232:235], a[136:139], a[16:19], a[232:235]
 v_mfma_f32_16x16x32_bf16 a[228:231], a[136:139], a[8:11], a[228:231]
 v_mfma_f32_16x16x32_bf16 a[228:231], a[140:143], a[12:15], a[228:231]
 v_mfma_f32_16x16x32_bf16 a[224:227], a[140:143], a[4:7], a[224:227]
 s_cmp_eq_u32 s57, s68
 v_mfma_f32_16x16x32_bf16 a[224:227], a[136:139], a[0:3], a[224:227]
 s_cbranch_scc1 L_cs1
L_cs1_d3:
 v_mfma_f32_16x16x32_bf16 v[64:67], a[64:67], a[32:35], v[64:67]
 s_waitcnt vmcnt(2)
 s_barrier
 v_mfma_f32_16x16x32_bf16 v[64:67], a[68:71], a[36:39], v[64:67]
 v_mfma_f32_16x16x32_bf16 v[68:71], a[68:71], a[44:47], v[68:71]
 v_mfma_f32_16x16x32_bf16 v[68:71], a[64:67], a[40:43], v[68:71]
 v_mfma_f32_16x16x32_bf16 v[72:75], a[64:67], a[48:51], v[72:75]
 ds_read_b128 a[0:3], v22 offset:0
 v_mfma_f32_16x16x32_bf16 v[72:75], a[68:71], a[52:55], v[72:75]
 v_mfma_f32_16x16x32_bf16 v[76:79], a[68:71], a[60:63], v[76:79]
 ds_read_b128 a[4:7], v23 offset:0
 v_mfma_f32_16x16x32_bf16 v[76:79], a[64:67], a[56:59], v[76:79]
 v_mfma_f32_16x16x32_bf16 v[108:111], a[72:75], a[56:59], v[108:111]
 v_mfma_f32_16x16x32_bf16 v[108:111], a[76:79], a[60:63], v[108:111]
 ds_read_b64_tr_b16 a[64:65], v26 offset:0
 v_mfma_f32_16x16x32_bf16 v[104:107], a[76:79], a[52:55], v[104:107]
 v_mfma_f32_16x16x32_bf16 v[104:107], a[72:75], a[48:51], v[104:107]
 ds_read_b64_tr_b16 a[66:67], v26 offset:2048
 v_mfma_f32_16x16x32_bf16 v[100:103], a[72:75], a[40:43], v[100:103]
 v_mfma_f32_16x16x32_bf16 v[100:103], a[76:79], a[44:47], v[100:103]
 ds_read_b64_tr_b16 a[68:69], v26 offset:4096
 v_mfma_f32_16x16x32_bf16 v[96:99], a[76:79], a[36:39], v[96:99]
 ds_read_b128 a[8:11], v22 offset:2048
 v_mfma_f32_16x16x32_bf16 v[96:99], a[72:75], a[32:35], v[96:99]
 ds_read_b64_tr_b16 a[70:71], v26 offset:6144
 v_mfma_f32_16x16x32_bf16 v[128:131], a[80:83], a[32:35], v[128:131]
 v_mfma_f32_16x16x32_bf16 v[128:131], a[84:87], a[36:39], v[128:131]
 s_add_u32 m0, s54, 73728
 ds_read_b64_tr_b16 a[72:73], v26 offset:8192
 v_mfma_f32_16x16x32_bf16 v[132:135], a[84:87], a[44:47], v[132:135]
 buffer_load_dwordx4 v8, s[8:11], s20 offen lds
 v_mfma_f32_16x16x32_bf16 v[132:135], a[80:83], a[40:43], v[132:135]
 ds_read_b64_tr_b16 a[74:75], v26 offset:10240
 v_mfma_f32_16x16x32_bf16 v[136:139], a[80:83], a[48:51], v[136:139]
 v_mfma_f32_16x16x32_bf16 v[136:139], a[84:87], a[52:55], v[136:139]
 ds_read_b64_tr_b16 a[76:77], v26 offset:12288
 v_mfma_f32_16x16x32_bf16 v[140:143], a[84:87], a[60:63], v[140:143]
 s_add_u32 m0, s54, 74752
 ds_read_b128 a[12:15], v23 offset:2048
 v_mfma_f32_16x16x32_bf16 v[140:143], a[80:83], a[56:59], v[140:143]
 buffer_load_dwordx4 v9, s[8:11], s20 offen lds
 v_mfma_f32_16x16x32_bf16 v[172:175], a[88:91], a[56:59], v[172:175]
 ds_read_b64_tr_b16 a[78:79], v26 offset:14336
 v_mfma_f32_16x16x32_bf16 v[172:175], a[92:95], a[60:63], v[172:175]
 ds_read_b64_tr_b16 a[80:81], v28 offset:0
 v_mfma_f32_16x16x32_bf16 v[168:171], a[92:95], a[52:55], v[168:171]
 v_mfma_f32_16x16x32_bf16 v[168:171], a[88:91], a[48:51], v[168:171]
 s_add_u32 m0, s54, 75776
 ds_read_b64_tr_b16 a[82:83], v28 offset:2048
 v_mfma_f32_16x16x32_bf16 v[164:167], a[88:91], a[40:43], v[164:167]
 buffer_load_dwordx4 v10, s[8:11], s20 offen lds
 v_mfma_f32_16x16x32_bf16 v[164:167], a[92:95], a[44:47], v[164:167]
 ds_read_b64_tr_b16 a[84:85], v28 offset:4096
 v_mfma_f32_16x16x32_bf16 v[160:163], a[92:95], a[36:39], v[160:163]
 ds_read_b128 a[16:19], v22 offset:4096
 v_mfma_f32_16x16x32_bf16 v[160:163], a[88:91], a[32:35], v[160:163]
 ds_read_b64_tr_b16 a[86:87], v28 offset:6144
 v_mfma_f32_16x16x32_bf16 v[192:195], a[96:99], a[32:35], v[192:195]
 s_add_u32 m0, s54, 76800
 v_mfma_f32_16x16x32_bf16 v[192:195], a[100:103], a[36:39], v[192:195]
 buffer_load_dwordx4 v11, s[8:11], s20 offen lds
 v_mfma_f32_16x16x32_bf16 v[196:199], a[100:103], a[44:47], v[196:199]
 ds_read_b64_tr_b16 a[88:89], v28 offset:8192
 v_mfma_f32_16x16x32_bf16 v[196:199], a[96:99], a[40:43], v[196:199]
 ds_read_b64_tr_b16 a[90:91], v28 offset:10240
 v_mfma_f32_16x16x32_bf16 v[200:203], a[96:99], a[48:51], v[200:203]
 v_mfma_f32_16x16x32_bf16 v[200:203], a[100:103], a[52:55], v[200:203]
 s_add_u32 m0, s54, 77824
 ds_read_b64_tr_b16 a[92:93], v28 offset:12288
 v_mfma_f32_16x16x32_bf16 v[204:207], a[100:103], a[60:63], v[204:207]
 buffer_load_dwordx4 v12, s[8:11], s20 offen lds
 v_mfma_f32_16x16x32_bf16 v[204:207], a[96:99], a[56:59], v[204:207]
 ds_read_b64_tr_b16 a[94:95], v28 offset:14336
 v_mfma_f32_16x16x32_bf16 v[236:239], a[104:107], a[56:59], v[236:239]
 ds_read_b128 a[20:23], v23 offset:4096
 v_mfma_f32_16x16x32_bf16 v[236:239], a[108:111], a[60:63], v[236:239]
 ds_read_b64_tr_b16 a[96:97], v30 offset:0
 v_mfma_f32_16x16x32_bf16 v[232:235], a[108:111], a[52:55], v[232:235]
 s_add_u32 m0, s54, 78848
 v_mfma_f32_16x16x32_bf16 v[232:235], a[104:107], a[48:51], v[232:235]
 buffer_load_dwordx4 v13, s[8:11], s20 offen lds
 v_mfma_f32_16x16x32_bf16 v[228:231], a[104:107], a[40:43], v[228:231]
 ds_read_b64_tr_b16 a[98:99], v30 offset:1024
 v_mfma_f32_16x16x32_bf16 v[228:231], a[108:111], a[44:47], v[228:231]
 ds_read_b64_tr_b16 a[100:101], v30 offset:2048
 v_mfma_f32_16x16x32_bf16 v[224:227], a[108:111], a[36:39], v[224:227]
 ds_read_b128 a[24:27], v22 offset:6144
 v_mfma_f32_16x16x32_bf16 v[224:227], a[104:107], a[32:35], v[224:227]
 s_add_u32 m0, s54, 79872
 ds_read_b64_tr_b16 a[102:103], v30 offset:3072
 v_mfma_f32_16x16x32_bf16 a[144:147], a[112:115], a[32:35], a[144:147]
 buffer_load_dwordx4 v14, s[8:11], s20 offen lds
 v_mfma_f32_16x16x32_bf16 a[144:147], a[116:119], a[36:39], a[144:147]
 ds_read_b64_tr_b16 a[104:105], v30 offset:4096
 v_mfma_f32_16x16x32_bf16 a[148:151], a[116:119], a[44:47], a[148:151]
 v_mfma_f32_16x16x32_bf16 a[148:151], a[112:115], a[40:43], a[148:151]
 ds_read_b64_tr_b16 a[106:107], v30 offset:5120
 v_mfma_f32_16x16x32_bf16 a[152:155], a[112:115], a[48:51], a[152:155]
 s_add_u32 m0, s54, 80896
 v_mfma_f32_16x16x32_bf16 a[152:155], a[116:119], a[52:55], a[152:155]
 buffer_load_dwordx4 v15, s[8:11], s20 offen lds
 v_mfma_f32_16x16x32_bf16 a[156:159], a[116:119], a[60:63], a[156:159]
 ds_read_b64_tr_b16 a[108:109], v30 offset:6144
 v_mfma_f32_16x16x32_bf16 a[156:159], a[112:115], a[56:59], a[156:159]
 ds_read_b64_tr_b16 a[110:111], v30 offset:7168
 v_mfma_f32_16x16x32_bf16 a[188:191], a[120:123], a[56:59], a[188:191]
 ds_read_b128 a[28:31], v23 offset:6144
 v_mfma_f32_16x16x32_bf16 a[188:191], a[124:127], a[60:63], a[188:191]
 s_add_u32 m0, s55, 73728
 ds_read_b64_tr_b16 a[112:113], v26 offset:16384
 s_branch L_tp_L_tB_3_o
L_tp_L_tB_3:
 s_nop 0
 s_branch L_tp_L_tB_7
 s_nop 0
L_tp_L_tB_3_o:
 v_mfma_f32_16x16x32_bf16 a[184:187], a[124:127], a[52:55], a[184:187]
 buffer_load_dwordx4 v16, s[16:19], s22 offen lds
 v_mfma_f32_16x16x32_bf16 a[184:187], a[120:123], a[48:51], a[184:187]
 ds_read_b64_tr_b16 a[114:115], v26 offset:18432
 v_mfma_f32_16x16x32_bf16 a[180:183], a[120:123], a[40:43], a[180:183]
 v_mfma_f32_16x16x32_bf16 a[180:183], a[124:127], a[44:47], a[180:183]
 ds_read_b64_tr_b16 a[116:117], v26 offset:20480
 v_mfma_f32_16x16x32_bf16 a[176:179], a[124:127], a[36:39], a[176:179]
 s_add_u32 m0, s55, 89984
 v_mfma_f32_16x16x32_bf16 a[176:179], a[120:123], a[32:35], a[176:179]
 buffer_load_dwordx4 v16, s[16:19], s22 offen offset:128 lds
 v_mfma_f32_16x16x32_bf16 a[208:211], a[128:131], a[32:35], a[208:211]
 ds_read_b64_tr_b16 a[118:119], v26 offset:22528
 v_mfma_f32_16x16x32_bf16 a[208:211], a[132:135], a[36:39], a[208:211]
 ds_read_b64_tr_b16 a[120:121], v26 offset:24576
 v_mfma_f32_16x16x32_bf16 a[212:215], a[132:135], a[44:47], a[212:215]
 v_mfma_f32_16x16x32_bf16 a[212:215], a[128:131], a[40:43], a[212:215]
 s_add_u32 m0, s55, 74752
 ds_read_b64_tr_b16 a[122:123], v26 offset:26624
 v_mfma_f32_16x16x32_bf16 a[216:219], a[128:131], a[48:51], a[216:219]
 buffer_load_dwordx4 v17, s[16:19], s22 offen lds
 v_mfma_f32_16x16x32_bf16 a[216:219], a[132:135], a[52:55], a[216:219]
 ds_read_b64_tr_b16 a[124:125], v26 offset:28672
 v_mfma_f32_16x16x32_bf16 a[220:223], a[132:135], a[60:63], a[220:223]
 v_mfma_f32_16x16x32_bf16 a[220:223], a[128:131], a[56:59], a[220:223]
 ds_read_b64_tr_b16 a[126:127], v26 offset:30720
 v_mfma_f32_16x16x32_bf16 a[252:255], a[136:139], a[56:59], a[252:255]
 s_add_u32 m0, s55, 91008
 v_mfma_f32_16x16x32_bf16 a[252:255], a[140:143], a[60:63], a[252:255]
 buffer_load_dwordx4 v17, s[16:19], s22 offen offset:128 lds
 v_mfma_f32_16x16x32_bf16 a[248:251], a[140:143], a[52:55], a[248:251]
 ds_read_b64_tr_b16 a[128:129], v28 offset:16384
 v_mfma_f32_16x16x32_bf16 a[248:251], a[136:139], a[48:51], a[248:251]
 ds_read_b64_tr_b16 a[130:131], v28 offset:18432
 v_mfma_f32_16x16x32_bf16 a[244:247], a[136:139], a[40:43], a[244:247]
 s_add_u32 s57, s57, 1
 v_mfma_f32_16x16x32_bf16 a[244:247], a[140:143], a[44:47], a[244:247]
 s_add_u32 m0, s55, 81920
 ds_read_b64_tr_b16 a[132:133], v28 offset:20480
 v_mfma_f32_16x16x32_bf16 a[240:243], a[140:143], a[36:39], a[240:243]
 s_cmp_lt_u32 s57, 4
 buffer_load_dwordx4 v16, s[64:67], s22 offen lds
 v_mfma_f32_16x16x32_bf16 a[240:243], a[136:139], a[32:35], a[240:243]
 ds_read_b64_tr_b16 a[134:135], v28 offset:22528
 s_cbranch_scc1 L_la1
 s_sub_u32 s0, s0, 4096
 s_lshl2_add_u32 s61, s2, s3
 s_lshl_b32 s61, s61, 9
 s_add_u32 s61, s61, 30408704
 s_mov_b32 exec_hi, 0
 s_waitcnt vmcnt(13)
 buffer_store_dwordx4 v[4:7], v1, s[24:27], s61 offen sc1
 s_mov_b32 exec_hi, -1
 s_waitcnt lgkmcnt(4)
 buffer_store_dwordx4 v[40:43], v34, s[24:27], s69 offen sc1
 v_add_u32 v3, s0, v1
 v_mfma_f32_16x16x32_bf16 v[48:51], a[64:67], a[0:3], v[48:51]
 ds_read_b128 v[36:39], v3 offset:0
 v_mfma_f32_16x16x32_bf16 v[48:51], a[68:71], a[4:7], v[48:51]
 ds_read_b128 v[44:47], v3 offset:1024
 v_mfma_f32_16x16x32_bf16 v[52:55], a[68:71], a[12:15], v[52:55]
 s_add_u32 m0, s55, 98176
 ds_read_b128 v[40:43], v3 offset:2048
 v_mfma_f32_16x16x32_bf16 v[52:55], a[64:67], a[8:11], v[52:55]
 buffer_load_dwordx4 v16, s[64:67], s22 offen offset:128 lds
 v_mfma_f32_16x16x32_bf16 v[56:59], a[64:67], a[16:19], v[56:59]
 s_mov_b32 s72, 1
 s_mov_b32 s73, 1
 v_mfma_f32_16x16x32_bf16 v[56:59], a[68:71], a[20:23], v[56:59]
 v_mfma_f32_16x16x32_bf16 v[60:63], a[68:71], a[28:31], v[60:63]
 v_mfma_f32_16x16x32_bf16 v[60:63], a[64:67], a[24:27], v[60:63]
 s_add_u32 m0, s55, 82944
 s_waitcnt lgkmcnt(0)
 v_lshlrev_b32 v34, 16, v36
 v_and_b32 v36, 0xffff0000, v36
 v_add_f32 v4, v34, v36
 v_mfma_f32_16x16x32_bf16 v[92:95], a[72:75], a[24:27], v[92:95]
 s_lshr_b32 s0, s2, 5
 buffer_load_dwordx4 v17, s[64:67], s22 offen lds
 v_mul_f32 v6, v34, v34
 v_mfma_f32_16x16x32_bf16 v[92:95], a[76:79], a[28:31], v[92:95]
 s_mul_i32 s0, s0, 6144
 ds_read_b64_tr_b16 a[136:137], v28 offset:24576
 v_fmac_f32 v6, v36, v36
 v_lshlrev_b32 v34, 16, v37
 v_mfma_f32_16x16x32_bf16 v[88:91], a[76:79], a[20:23], v[88:91]
 s_add_u32 s0, s0, 29884416
 ds_read_b64_tr_b16 a[138:139], v28 offset:26624
 v_and_b32 v37, 0xffff0000, v37
 v_mfma_f32_16x16x32_bf16 v[88:91], a[72:75], a[16:19], v[88:91]
 s_and_b32 s7, s2, 31
 s_lshl2_add_u32 s7, s7, s3
 s_lshl3_add_u32 s1, s7, s0
 v_add_f32 v4, v4, v34
 v_fmac_f32 v6, v34, v34
 v_add_f32 v4, v4, v37
 v_mfma_f32_16x16x32_bf16 v[84:87], a[72:75], a[8:11], v[84:87]
 s_add_u32 m0, s55, 99200
 ds_read_b64_tr_b16 a[140:141], v28 offset:28672
 v_fmac_f32 v6, v37, v37
 v_lshlrev_b32 v34, 16, v38
 v_mfma_f32_16x16x32_bf16 v[84:87], a[76:79], a[12:15], v[84:87]
 s_add_u32 s1, s1, 4096
 buffer_load_dwordx4 v17, s[64:67], s22 offen offset:128 lds
 v_and_b32 v38, 0xffff0000, v38
 v_mfma_f32_16x16x32_bf16 v[80:83], a[76:79], a[4:7], v[80:83]
 s_lshl_b32 s7, s7, 5
 ds_read_b64_tr_b16 a[142:143], v28 offset:30720
 v_add_f32 v4, v4, v34
 v_fmac_f32 v6, v34, v34
 v_mfma_f32_16x16x32_bf16 v[80:83], a[72:75], a[0:3], v[80:83]
 s_add_u32 s0, s0, s7
 v_add_f32 v4, v4, v38
 v_fmac_f32 v6, v38, v38
 v_mfma_f32_16x16x32_bf16 v[112:115], a[80:83], a[0:3], v[112:115]
 ds_read_b128 a[32:35], v22 offset:8192
 v_lshlrev_b32 v34, 16, v39
 v_and_b32 v39, 0xffff0000, v39
 v_mfma_f32_16x16x32_bf16 v[112:115], a[84:87], a[4:7], v[112:115]
 s_add_u32 m0, s56, 73728
 v_add_f32 v4, v4, v34
 v_fmac_f32 v6, v34, v34
 v_mfma_f32_16x16x32_bf16 v[116:119], a[84:87], a[12:15], v[116:119]
 buffer_load_dwordx4 v18, s[16:19], s22 offen lds
 v_add_f32 v4, v4, v39
 v_fmac_f32 v6, v39, v39
 v_mfma_f32_16x16x32_bf16 v[116:119], a[80:83], a[8:11], v[116:119]
 ds_read_b128 a[36:39], v23 offset:8192
 ds_read_b128 v[36:39], v3 offset:3072
 v_mfma_f32_16x16x32_bf16 v[120:123], a[80:83], a[16:19], v[120:123]
 ds_read_b128 a[40:43], v22 offset:10240
 v_lshlrev_b32 v34, 16, v44
 v_and_b32 v44, 0xffff0000, v44
 v_mfma_f32_16x16x32_bf16 v[120:123], a[84:87], a[20:23], v[120:123]
 v_add_f32 v4, v4, v34
 v_fmac_f32 v6, v34, v34
 v_mfma_f32_16x16x32_bf16 v[124:127], a[84:87], a[28:31], v[124:127]
 s_add_u32 m0, s56, 77824
 ds_read_b128 a[44:47], v23 offset:10240
 v_add_f32 v4, v4, v44
 v_fmac_f32 v6, v44, v44
 v_mfma_f32_16x16x32_bf16 v[124:127], a[80:83], a[24:27], v[124:127]
 buffer_load_dwordx4 v18, s[64:67], s22 offen lds
 v_lshlrev_b32 v34, 16, v45
 v_mfma_f32_16x16x32_bf16 v[156:159], a[88:91], a[24:27], v[156:159]
 ds_read_b128 a[48:51], v22 offset:12288
 v_and_b32 v45, 0xffff0000, v45
 v_add_f32 v4, v4, v34
 v_mfma_f32_16x16x32_bf16 v[156:159], a[92:95], a[28:31], v[156:159]
 v_fmac_f32 v6, v34, v34
 v_add_f32 v4, v4, v45
 v_mfma_f32_16x16x32_bf16 v[152:155], a[92:95], a[20:23], v[152:155]
 ds_read_b128 a[52:55], v23 offset:12288
 v_fmac_f32 v6, v45, v45
 v_mfma_f32_16x16x32_bf16 v[152:155], a[88:91], a[16:19], v[152:155]
 v_lshlrev_b32 v34, 16, v46
 v_and_b32 v46, 0xffff0000, v46
 v_add_f32 v4, v4, v34
 v_mfma_f32_16x16x32_bf16 v[148:151], a[88:91], a[8:11], v[148:151]
 ds_read_b128 a[56:59], v22 offset:14336
 v_fmac_f32 v6, v34, v34
 v_mfma_f32_16x16x32_bf16 v[148:151], a[92:95], a[12:15], v[148:151]
 v_add_f32 v4, v4, v46
 v_fmac_f32 v6, v46, v46
 v_lshlrev_b32 v34, 16, v47
 v_mfma_f32_16x16x32_bf16 v[144:147], a[92:95], a[4:7], v[144:147]
 ds_read_b128 a[60:63], v23 offset:14336
 v_and_b32 v47, 0xffff0000, v47
 v_mfma_f32_16x16x32_bf16 v[144:147], a[88:91], a[0:3], v[144:147]
 v_add_f32 v4, v4, v34
 v_fmac_f32 v6, v34, v34
 v_add_f32 v4, v4, v47
 v_mfma_f32_16x16x32_bf16 v[176:179], a[96:99], a[0:3], v[176:179]
 v_fmac_f32 v6, v47, v47
 v_lshlrev_b32 v34, 16, v40
 v_mfma_f32_16x16x32_bf16 v[176:179], a[100:103], a[4:7], v[176:179]
 v_and_b32 v40, 0xffff0000, v40
 v_add_f32 v5, v34, v40
 v_mul_f32 v7, v34, v34
 v_mfma_f32_16x16x32_bf16 v[180:183], a[100:103], a[12:15], v[180:183]
 v_fmac_f32 v7, v40, v40
 v_lshlrev_b32 v34, 16, v41
 v_mfma_f32_16x16x32_bf16 v[180:183], a[96:99], a[8:11], v[180:183]
 v_and_b32 v41, 0xffff0000, v41
 v_add_f32 v5, v5, v34
 v_mfma_f32_16x16x32_bf16 v[184:187], a[96:99], a[16:19], v[184:187]
 v_fmac_f32 v7, v34, v34
 v_add_f32 v5, v5, v41
 v_fmac_f32 v7, v41, v41
 v_mfma_f32_16x16x32_bf16 v[184:187], a[100:103], a[20:23], v[184:187]
 v_lshlrev_b32 v34, 16, v42
 v_and_b32 v42, 0xffff0000, v42
 v_mfma_f32_16x16x32_bf16 v[188:191], a[100:103], a[28:31], v[188:191]
 v_add_f32 v5, v5, v34
 v_fmac_f32 v7, v34, v34
 v_add_f32 v5, v5, v42
 v_mfma_f32_16x16x32_bf16 v[188:191], a[96:99], a[24:27], v[188:191]
 v_fmac_f32 v7, v42, v42
 v_lshlrev_b32 v34, 16, v43
 v_mfma_f32_16x16x32_bf16 v[220:223], a[104:107], a[24:27], v[220:223]
 v_and_b32 v43, 0xffff0000, v43
 v_add_f32 v5, v5, v34
 v_fmac_f32 v7, v34, v34
 v_mfma_f32_16x16x32_bf16 v[220:223], a[108:111], a[28:31], v[220:223]
 v_add_f32 v5, v5, v43
 v_fmac_f32 v7, v43, v43
 v_mfma_f32_16x16x32_bf16 v[216:219], a[108:111], a[20:23], v[216:219]
 s_waitcnt lgkmcnt(0)
 v_lshlrev_b32 v34, 16, v36
 v_and_b32 v36, 0xffff0000, v36
 v_mfma_f32_16x16x32_bf16 v[216:219], a[104:107], a[16:19], v[216:219]
 v_add_f32 v5, v5, v34
 v_fmac_f32 v7, v34, v34
 v_add_f32 v5, v5, v36
 v_mfma_f32_16x16x32_bf16 v[212:215], a[104:107], a[8:11], v[212:215]
 v_fmac_f32 v7, v36, v36
 v_lshlrev_b32 v34, 16, v37
 v_mfma_f32_16x16x32_bf16 v[212:215], a[108:111], a[12:15], v[212:215]
 v_and_b32 v37, 0xffff0000, v37
 v_add_f32 v5, v5, v34
 v_mfma_f32_16x16x32_bf16 v[208:211], a[108:111], a[4:7], v[208:211]
 v_fmac_f32 v7, v34, v34
 v_add_f32 v5, v5, v37
 v_mfma_f32_16x16x32_bf16 v[208:211], a[104:107], a[0:3], v[208:211]
 buffer_load_dword v0, v33, s[44:47], s60 offen
 v_fmac_f32 v7, v37, v37
 v_lshlrev_b32 v34, 16, v38
 v_mfma_f32_16x16x32_bf16 v[240:243], a[112:115], a[0:3], v[240:243]
 s_add_u32 s60, s60, 1664
 v_and_b32 v38, 0xffff0000, v38
 v_add_f32 v5, v5, v34
 v_mfma_f32_16x16x32_bf16 v[240:243], a[116:119], a[4:7], v[240:243]
 v_fmac_f32 v7, v34, v34
 v_add_f32 v5, v5, v38
 v_mfma_f32_16x16x32_bf16 v[244:247], a[116:119], a[12:15], v[244:247]
 v_fmac_f32 v7, v38, v38
 v_lshlrev_b32 v34, 16, v39
 v_mfma_f32_16x16x32_bf16 v[244:247], a[112:115], a[8:11], v[244:247]
 v_and_b32 v39, 0xffff0000, v39
 v_add_f32 v5, v5, v34
 v_fmac_f32 v7, v34, v34
 v_mfma_f32_16x16x32_bf16 v[248:251], a[112:115], a[16:19], v[248:251]
 v_add_f32 v5, v5, v39
 v_fmac_f32 v7, v39, v39
 v_mfma_f32_16x16x32_bf16 v[248:251], a[116:119], a[20:23], v[248:251]
 v_lshrrev_b32 v46, 3, v2
 v_lshrrev_b32 v47, 1, v2
 v_mfma_f32_16x16x32_bf16 v[252:255], a[116:119], a[28:31], v[252:255]
 v_permlane32_swap_b32 v4, v5
 v_permlane32_swap_b32 v6, v7
 v_mfma_f32_16x16x32_bf16 v[252:255], a[112:115], a[24:27], v[252:255]
 v_add_f32 v4, v4, v5
 v_add_f32 v6, v6, v7
 v_mfma_f32_16x16x32_bf16 a[172:175], a[120:123], a[24:27], a[172:175]
 v_mov_b32 v45, 0x3a800000
 v_mfma_f32_16x16x32_bf16 a[172:175], a[124:127], a[28:31], a[172:175]
 v_permlane16_swap_b32 v4, v6
 v_add_f32 v4, v4, v6
 v_mfma_f32_16x16x32_bf16 a[168:171], a[124:127], a[20:23], a[168:171]
 s_nop 0
 v_add_f32_dpp v4, v4, v4 row_ror:8 row_mask:0xf bank_mask:0xf
 v_mfma_f32_16x16x32_bf16 a[168:171], a[120:123], a[16:19], a[168:171]
 s_nop 0
 v_add_f32_dpp v4, v4, v4 row_ror:4 row_mask:0xf bank_mask:0xf
 v_mfma_f32_16x16x32_bf16 a[164:167], a[120:123], a[8:11], a[164:167]
 s_nop 0
 v_add_f32_dpp v4, v4, v4 row_ror:2 row_mask:0xf bank_mask:0xf
 v_mfma_f32_16x16x32_bf16 a[164:167], a[124:127], a[12:15], a[164:167]
 s_nop 0
 v_add_f32_dpp v4, v4, v4 row_ror:1 row_mask:0xf bank_mask:0xf
 v_mfma_f32_16x16x32_bf16 a[160:163], a[124:127], a[4:7], a[160:163]
 v_mov_b32 v6, v4
 v_mfma_f32_16x16x32_bf16 a[160:163], a[120:123], a[0:3], a[160:163]
 s_waitcnt lgkmcnt(0)
 s_nop 0
 v_permlane16_swap_b32 v4, v6
 v_mul_f32 v36, 0xba800000, v4
 v_mfma_f32_16x16x32_bf16 a[192:195], a[128:131], a[0:3], a[192:195]
 s_add_u32 s23, s23, 1
 s_and_b32 s23, s23, 15
 s_mul_i32 s22, s23, 458752
 v_mul_f32 v44, v36, v36
 v_fma_f32 v44, v6, v45, -v44
 v_mfma_f32_16x16x32_bf16 a[192:195], a[132:135], a[4:7], a[192:195]
 s_mul_i32 s21, s23, 393216
 s_lshl_b32 s20, s23, 7
 v_max_f32 v44, 0, v44
 v_cvt_pk_bf16_f32 v44, v36, v44
 v_mfma_f32_16x16x32_bf16 a[196:199], a[132:135], a[12:15], a[196:199]
 v_lshlrev_b32 v36, 16, v44
 v_and_b32 v44, 0xffff0000, v44
 v_mfma_f32_16x16x32_bf16 a[196:199], a[128:131], a[8:11], a[196:199]
 v_add_f32 v44, 0x3727c5ac, v44
 v_cvt_pk_bf16_f32 v44, 0, v44
 v_mfma_f32_16x16x32_bf16 a[200:203], a[128:131], a[16:19], a[200:203]
 v_sqrt_f32 v44, v44
 v_mfma_f32_16x16x32_bf16 a[200:203], a[132:135], a[20:23], a[200:203]
 v_cvt_pk_bf16_f32 v44, 0, v44
 v_mul_f32 v39, v44, v44
 v_mfma_f32_16x16x32_bf16 a[204:207], a[132:135], a[28:31], a[204:207]
 v_rcp_f32 v44, v44
 v_mfma_f32_16x16x32_bf16 a[204:207], a[128:131], a[24:27], a[204:207]
 v_mul_f32 v37, 0xc0135761, v44
 v_mul_f32 v45, v44, v44
 v_mfma_f32_16x16x32_bf16 a[236:239], a[136:139], a[24:27], a[236:239]
 v_mul_f32 v38, 0x3d372713, v37
 v_mul_f32 v38, v38, v45
 v_mfma_f32_16x16x32_bf16 a[236:239], a[140:143], a[28:31], a[236:239]
 v_mov_b64 v[4:5], -1
 v_mov_b64 v[6:7], -1
 v_mfma_f32_16x16x32_bf16 a[232:235], a[140:143], a[20:23], a[232:235]
 s_mov_b64 exec, s[72:73]
 buffer_store_dwordx4 v[36:39], v47, s[24:27], s0 offen sc1
 s_mov_b64 exec, -1
 v_mfma_f32_16x16x32_bf16 a[232:235], a[136:139], a[16:19], a[232:235]
 v_mfma_f32_16x16x32_bf16 a[228:231], a[136:139], a[8:11], a[228:231]
 s_mov_b64 exec, s[72:73]
 buffer_store_dword v36, v46, s[24:27], s1 offen sc1
 s_mov_b64 exec, -1
 v_mfma_f32_16x16x32_bf16 a[228:231], a[140:143], a[12:15], a[228:231]
 v_mfma_f32_16x16x32_bf16 a[224:227], a[140:143], a[4:7], a[224:227]
 s_mov_b64 exec, s[72:73]
 buffer_store_dword v44, v46, s[24:27], s1 offen offset:1024 sc1
 s_mov_b64 exec, -1
 v_mfma_f32_16x16x32_bf16 a[224:227], a[136:139], a[0:3], a[224:227]
 v_mfma_f32_16x16x32_bf16 v[64:67], a[64:67], a[32:35], v[64:67]
 s_waitcnt vmcnt(4)
 s_barrier
 s_branch L_lbm1
 .p2align 4
L_lb1:
 s_waitcnt lgkmcnt(4)
 v_mfma_f32_16x16x32_bf16 v[48:51], a[64:67], a[0:3], v[48:51]
 v_mfma_f32_16x16x32_bf16 v[48:51], a[68:71], a[4:7], v[48:51]
 ds_read_b64_tr_b16 a[136:137], v28 offset:24576
 v_mfma_f32_16x16x32_bf16 v[52:55], a[68:71], a[12:15], v[52:55]
 v_mfma_f32_16x16x32_bf16 v[52:55], a[64:67], a[8:11], v[52:55]
 s_add_u32 m0, s56, 73728
 v_mfma_f32_16x16x32_bf16 v[56:59], a[64:67], a[16:19], v[56:59]
 buffer_load_dwordx4 v18, s[16:19], s22 offen lds
 v_mfma_f32_16x16x32_bf16 v[56:59], a[68:71], a[20:23], v[56:59]
 ds_read_b64_tr_b16 a[138:139], v28 offset:26624
 v_mfma_f32_16x16x32_bf16 v[60:63], a[68:71], a[28:31], v[60:63]
 v_mfma_f32_16x16x32_bf16 v[60:63], a[64:67], a[24:27], v[60:63]
 ds_read_b64_tr_b16 a[140:141], v28 offset:28672
 v_mfma_f32_16x16x32_bf16 v[92:95], a[72:75], a[24:27], v[92:95]
 s_add_u32 m0, s56, 77824
 v_mfma_f32_16x16x32_bf16 v[92:95], a[76:79], a[28:31], v[92:95]
 buffer_load_dwordx4 v18, s[64:67], s22 offen lds
 v_mfma_f32_16x16x32_bf16 v[88:91], a[76:79], a[20:23], v[88:91]
 ds_read_b64_tr_b16 a[142:143], v28 offset:30720
 v_mfma_f32_16x16x32_bf16 v[88:91], a[72:75], a[16:19], v[88:91]
 v_mfma_f32_16x16x32_bf16 v[84:87], a[72:75], a[8:11], v[84:87]
 v_mfma_f32_16x16x32_bf16 v[84:87], a[76:79], a[12:15], v[84:87]
 ds_read_b128 a[32:35], v22 offset:8192
 v_mfma_f32_16x16x32_bf16 v[80:83], a[76:79], a[4:7], v[80:83]
 v_mfma_f32_16x16x32_bf16 v[80:83], a[72:75], a[0:3], v[80:83]
 v_mfma_f32_16x16x32_bf16 v[112:115], a[80:83], a[0:3], v[112:115]
 ds_read_b128 a[36:39], v23 offset:8192
 v_mfma_f32_16x16x32_bf16 v[112:115], a[84:87], a[4:7], v[112:115]
 v_mfma_f32_16x16x32_bf16 v[116:119], a[84:87], a[12:15], v[116:119]
 v_mfma_f32_16x16x32_bf16 v[116:119], a[80:83], a[8:11], v[116:119]
 ds_read_b128 a[40:43], v22 offset:10240
 v_mfma_f32_16x16x32_bf16 v[120:123], a[80:83], a[16:19], v[120:123]
 v_mfma_f32_16x16x32_bf16 v[120:123], a[84:87], a[20:23], v[120:123]
 v_mfma_f32_16x16x32_bf16 v[124:127], a[84:87], a[28:31], v[124:127]
 ds_read_b128 a[44:47], v23 offset:10240
 v_mfma_f32_16x16x32_bf16 v[124:127], a[80:83], a[24:27], v[124:127]
 v_mfma_f32_16x16x32_bf16 v[156:159], a[88:91], a[24:27], v[156:159]
 v_mfma_f32_16x16x32_bf16 v[156:159], a[92:95], a[28:31], v[156:159]
 ds_read_b128 a[48:51], v22 offset:12288
 v_mfma_f32_16x16x32_bf16 v[152:155], a[92:95], a[20:23], v[152:155]
 v_mfma_f32_16x16x32_bf16 v[152:155], a[88:91], a[16:19], v[152:155]
 buffer_load_dword v0, v33, s[44:47], s60 offen
 v_mfma_f32_16x16x32_bf16 v[148:151], a[88:91], a[8:11], v[148:151]
 s_add_u32 s60, s60, 1664
 ds_read_b128 a[52:55], v23 offset:12288
 v_mfma_f32_16x16x32_bf16 v[148:151], a[92:95], a[12:15], v[148:151]
 v_mfma_f32_16x16x32_bf16 v[144:147], a[92:95], a[4:7], v[144:147]
 v_mfma_f32_16x16x32_bf16 v[144:147], a[88:91], a[0:3], v[144:147]
 ds_read_b128 a[56:59], v22 offset:14336
 v_mfma_f32_16x16x32_bf16 v[176:179], a[96:99], a[0:3], v[176:179]
 v_mfma_f32_16x16x32_bf16 v[176:179], a[100:103], a[4:7], v[176:179]
 v_mfma_f32_16x16x32_bf16 v[180:183], a[100:103], a[12:15], v[180:183]
 ds_read_b128 a[60:63], v23 offset:14336
 v_mfma_f32_16x16x32_bf16 v[180:183], a[96:99], a[8:11], v[180:183]
 v_mfma_f32_16x16x32_bf16 v[184:187], a[96:99], a[16:19], v[184:187]
 v_mfma_f32_16x16x32_bf16 v[184:187], a[100:103], a[20:23], v[184:187]
 v_mfma_f32_16x16x32_bf16 v[188:191], a[100:103], a[28:31], v[188:191]
 v_mfma_f32_16x16x32_bf16 v[188:191], a[96:99], a[24:27], v[188:191]
 v_mfma_f32_16x16x32_bf16 v[220:223], a[104:107], a[24:27], v[220:223]
 v_mfma_f32_16x16x32_bf16 v[220:223], a[108:111], a[28:31], v[220:223]
 v_mfma_f32_16x16x32_bf16 v[216:219], a[108:111], a[20:23], v[216:219]
 v_mfma_f32_16x16x32_bf16 v[216:219], a[104:107], a[16:19], v[216:219]
 v_mfma_f32_16x16x32_bf16 v[212:215], a[104:107], a[8:11], v[212:215]
 v_mfma_f32_16x16x32_bf16 v[212:215], a[108:111], a[12:15], v[212:215]
 v_mfma_f32_16x16x32_bf16 v[208:211], a[108:111], a[4:7], v[208:211]
 v_mfma_f32_16x16x32_bf16 v[208:211], a[104:107], a[0:3], v[208:211]
 v_mfma_f32_16x16x32_bf16 v[240:243], a[112:115], a[0:3], v[240:243]
 v_mfma_f32_16x16x32_bf16 v[240:243], a[116:119], a[4:7], v[240:243]
 v_mfma_f32_16x16x32_bf16 v[244:247], a[116:119], a[12:15], v[244:247]
 v_mfma_f32_16x16x32_bf16 v[244:247], a[112:115], a[8:11], v[244:247]
 v_mfma_f32_16x16x32_bf16 v[248:251], a[112:115], a[16:19], v[248:251]
 v_mfma_f32_16x16x32_bf16 v[248:251], a[116:119], a[20:23], v[248:251]
 v_mfma_f32_16x16x32_bf16 v[252:255], a[116:119], a[28:31], v[252:255]
 v_mfma_f32_16x16x32_bf16 v[252:255], a[112:115], a[24:27], v[252:255]
 v_mfma_f32_16x16x32_bf16 a[172:175], a[120:123], a[24:27], a[172:175]
 v_mfma_f32_16x16x32_bf16 a[172:175], a[124:127], a[28:31], a[172:175]
 v_mfma_f32_16x16x32_bf16 a[168:171], a[124:127], a[20:23], a[168:171]
 v_mfma_f32_16x16x32_bf16 a[168:171], a[120:123], a[16:19], a[168:171]
 v_mfma_f32_16x16x32_bf16 a[164:167], a[120:123], a[8:11], a[164:167]
 v_mfma_f32_16x16x32_bf16 a[164:167], a[124:127], a[12:15], a[164:167]
 v_mfma_f32_16x16x32_bf16 a[160:163], a[124:127], a[4:7], a[160:163]
 v_mfma_f32_16x16x32_bf16 a[160:163], a[120:123], a[0:3], a[160:163]
 s_waitcnt lgkmcnt(0)
 v_mfma_f32_16x16x32_bf16 a[192:195], a[128:131], a[0:3], a[192:195]
 s_add_u32 s23, s23, 1
 s_and_b32 s23, s23, 15
 s_mul_i32 s22, s23, 458752
 v_mfma_f32_16x16x32_bf16 a[192:195], a[132:135], a[4:7], a[192:195]
 s_mul_i32 s21, s23, 393216
 s_lshl_b32 s20, s23, 7
 v_mfma_f32_16x16x32_bf16 a[196:199], a[132:135], a[12:15], a[196:199]
 v_mfma_f32_16x16x32_bf16 a[196:199], a[128:131], a[8:11], a[196:199]
 v_mfma_f32_16x16x32_bf16 a[200:203], a[128:131], a[16:19], a[200:203]
 v_mfma_f32_16x16x32_bf16 a[200:203], a[132:135], a[20:23], a[200:203]
 v_mfma_f32_16x16x32_bf16 a[204:207], a[132:135], a[28:31], a[204:207]
 v_mfma_f32_16x16x32_bf16 a[204:207], a[128:131], a[24:27], a[204:207]
 v_mfma_f32_16x16x32_bf16 a[236:239], a[136:139], a[24:27], a[236:239]
 v_mfma_f32_16x16x32_bf16 a[236:239], a[140:143], a[28:31], a[236:239]
 v_mfma_f32_16x16x32_bf16 a[232:235], a[140:143], a[20:23], a[232:235]
 v_mfma_f32_16x16x32_bf16 a[232:235], a[136:139], a[16:19], a[232:235]
 v_mfma_f32_16x16x32_bf16 a[228:231], a[136:139], a[8:11], a[228:231]
 v_mfma_f32_16x16x32_bf16 a[228:231], a[140:143], a[12:15], a[228:231]
 v_mfma_f32_16x16x32_bf16 a[224:227], a[140:143], a[4:7], a[224:227]
 v_mfma_f32_16x16x32_bf16 a[224:227], a[136:139], a[0:3], a[224:227]
 v_mfma_f32_16x16x32_bf16 v[64:67], a[64:67], a[32:35], v[64:67]
 s_waitcnt vmcnt(1)
 s_barrier
L_lbm1:
 s_branch L_tp_L_tB_4_o
L_tp_L_tB_4:
 s_nop 0
 s_nop 0
 s_branch L_tp_L_tB_8
L_tp_L_tB_4_o:
 v_mfma_f32_16x16x32_bf16 v[64:67], a[68:71], a[36:39], v[64:67]
 s_cmp_eq_u32 s57, s70
 v_mfma_f32_16x16x32_bf16 v[68:71], a[68:71], a[44:47], v[68:71]
 s_cbranch_scc1 L_at10
L_at10_d:
 v_mfma_f32_16x16x32_bf16 v[68:71], a[64:67], a[40:43], v[68:71]
 s_add_u32 m0, s54, 0
 v_mfma_f32_16x16x32_bf16 v[72:75], a[64:67], a[48:51], v[72:75]
 buffer_load_dwordx4 v8, s[8:11], s20 offen lds
 v_mfma_f32_16x16x32_bf16 v[72:75], a[68:71], a[52:55], v[72:75]
 ds_read_b128 a[0:3], v24 offset:0
 v_mfma_f32_16x16x32_bf16 v[76:79], a[68:71], a[60:63], v[76:79]
 ds_read_b128 a[4:7], v25 offset:0
 v_mfma_f32_16x16x32_bf16 v[76:79], a[64:67], a[56:59], v[76:79]
 v_mfma_f32_16x16x32_bf16 v[108:111], a[72:75], a[56:59], v[108:111]
 s_add_u32 m0, s54, 1024
 v_mfma_f32_16x16x32_bf16 v[108:111], a[76:79], a[60:63], v[108:111]
 buffer_load_dwordx4 v9, s[8:11], s20 offen lds
 v_mfma_f32_16x16x32_bf16 v[104:107], a[76:79], a[52:55], v[104:107]
 ds_read_b64_tr_b16 a[64:65], v27 offset:0
 v_mfma_f32_16x16x32_bf16 v[104:107], a[72:75], a[48:51], v[104:107]
 ds_read_b64_tr_b16 a[66:67], v27 offset:2048
 v_mfma_f32_16x16x32_bf16 v[100:103], a[72:75], a[40:43], v[100:103]
 v_mfma_f32_16x16x32_bf16 v[100:103], a[76:79], a[44:47], v[100:103]
 s_add_u32 m0, s54, 2048
 ds_read_b64_tr_b16 a[68:69], v27 offset:4096
 v_mfma_f32_16x16x32_bf16 v[96:99], a[76:79], a[36:39], v[96:99]
 buffer_load_dwordx4 v10, s[8:11], s20 offen lds
 v_mfma_f32_16x16x32_bf16 v[96:99], a[72:75], a[32:35], v[96:99]
 ds_read_b64_tr_b16 a[70:71], v27 offset:6144
 v_mfma_f32_16x16x32_bf16 v[128:131], a[80:83], a[32:35], v[128:131]
 ds_read_b128 a[8:11], v24 offset:2048
 v_mfma_f32_16x16x32_bf16 v[128:131], a[84:87], a[36:39], v[128:131]
 ds_read_b64_tr_b16 a[72:73], v27 offset:8192
 v_mfma_f32_16x16x32_bf16 v[132:135], a[84:87], a[44:47], v[132:135]
 s_add_u32 m0, s54, 3072
 v_mfma_f32_16x16x32_bf16 v[132:135], a[80:83], a[40:43], v[132:135]
 buffer_load_dwordx4 v11, s[8:11], s20 offen lds
 v_mfma_f32_16x16x32_bf16 v[136:139], a[80:83], a[48:51], v[136:139]
 ds_read_b64_tr_b16 a[74:75], v27 offset:10240
 v_mfma_f32_16x16x32_bf16 v[136:139], a[84:87], a[52:55], v[136:139]
 ds_read_b64_tr_b16 a[76:77], v27 offset:12288
 v_mfma_f32_16x16x32_bf16 v[140:143], a[84:87], a[60:63], v[140:143]
 ds_read_b128 a[12:15], v25 offset:2048
 v_mfma_f32_16x16x32_bf16 v[140:143], a[80:83], a[56:59], v[140:143]
 s_add_u32 m0, s54, 4096
 ds_read_b64_tr_b16 a[78:79], v27 offset:14336
 v_mfma_f32_16x16x32_bf16 v[172:175], a[88:91], a[56:59], v[172:175]
 buffer_load_dwordx4 v12, s[8:11], s20 offen lds
 v_mfma_f32_16x16x32_bf16 v[172:175], a[92:95], a[60:63], v[172:175]
 ds_read_b64_tr_b16 a[80:81], v29 offset:0
 v_mfma_f32_16x16x32_bf16 v[168:171], a[92:95], a[52:55], v[168:171]
 v_mfma_f32_16x16x32_bf16 v[168:171], a[88:91], a[48:51], v[168:171]
 ds_read_b64_tr_b16 a[82:83], v29 offset:2048
 v_mfma_f32_16x16x32_bf16 v[164:167], a[88:91], a[40:43], v[164:167]
 s_add_u32 m0, s54, 5120
 v_mfma_f32_16x16x32_bf16 v[164:167], a[92:95], a[44:47], v[164:167]
 buffer_load_dwordx4 v13, s[8:11], s20 offen lds
 v_mfma_f32_16x16x32_bf16 v[160:163], a[92:95], a[36:39], v[160:163]
 ds_read_b64_tr_b16 a[84:85], v29 offset:4096
 v_mfma_f32_16x16x32_bf16 v[160:163], a[88:91], a[32:35], v[160:163]
 ds_read_b64_tr_b16 a[86:87], v29 offset:6144
 v_mfma_f32_16x16x32_bf16 v[192:195], a[96:99], a[32:35], v[192:195]
 ds_read_b128 a[16:19], v24 offset:4096
 v_mfma_f32_16x16x32_bf16 v[192:195], a[100:103], a[36:39], v[192:195]
 s_add_u32 m0, s54, 6144
 ds_read_b64_tr_b16 a[88:89], v29 offset:8192
 v_mfma_f32_16x16x32_bf16 v[196:199], a[100:103], a[44:47], v[196:199]
 buffer_load_dwordx4 v14, s[8:11], s20 offen lds
 v_mfma_f32_16x16x32_bf16 v[196:199], a[96:99], a[40:43], v[196:199]
 ds_read_b64_tr_b16 a[90:91], v29 offset:10240
 v_mfma_f32_16x16x32_bf16 v[200:203], a[96:99], a[48:51], v[200:203]
 v_mfma_f32_16x16x32_bf16 v[200:203], a[100:103], a[52:55], v[200:203]
 ds_read_b64_tr_b16 a[92:93], v29 offset:12288
 v_mfma_f32_16x16x32_bf16 v[204:207], a[100:103], a[60:63], v[204:207]
 s_add_u32 m0, s54, 7168
 ds_read_b128 a[20:23], v25 offset:4096
 v_mfma_f32_16x16x32_bf16 v[204:207], a[96:99], a[56:59], v[204:207]
 buffer_load_dwordx4 v15, s[8:11], s20 offen lds
 v_mfma_f32_16x16x32_bf16 v[236:239], a[104:107], a[56:59], v[236:239]
 ds_read_b64_tr_b16 a[94:95], v29 offset:14336
 v_mfma_f32_16x16x32_bf16 v[236:239], a[108:111], a[60:63], v[236:239]
 ds_read_b64_tr_b16 a[96:97], v31 offset:0
 v_mfma_f32_16x16x32_bf16 v[232:235], a[108:111], a[52:55], v[232:235]
 v_mfma_f32_16x16x32_bf16 v[232:235], a[104:107], a[48:51], v[232:235]
 s_add_u32 m0, s55, 0
 ds_read_b64_tr_b16 a[98:99], v31 offset:1024
 v_mfma_f32_16x16x32_bf16 v[228:231], a[104:107], a[40:43], v[228:231]
 buffer_load_dwordx4 v16, s[16:19], s22 offen lds
 v_mfma_f32_16x16x32_bf16 v[228:231], a[108:111], a[44:47], v[228:231]
 ds_read_b64_tr_b16 a[100:101], v31 offset:2048
 v_mfma_f32_16x16x32_bf16 v[224:227], a[108:111], a[36:39], v[224:227]
 ds_read_b128 a[24:27], v24 offset:6144
 v_mfma_f32_16x16x32_bf16 v[224:227], a[104:107], a[32:35], v[224:227]
 ds_read_b64_tr_b16 a[102:103], v31 offset:3072
 v_mfma_f32_16x16x32_bf16 a[144:147], a[112:115], a[32:35], a[144:147]
 s_add_u32 m0, s55, 16256
 v_mfma_f32_16x16x32_bf16 a[144:147], a[116:119], a[36:39], a[144:147]
 buffer_load_dwordx4 v16, s[16:19], s22 offen offset:128 lds
 v_mfma_f32_16x16x32_bf16 a[148:151], a[116:119], a[44:47], a[148:151]
 ds_read_b64_tr_b16 a[104:105], v31 offset:4096
 v_mfma_f32_16x16x32_bf16 a[148:151], a[112:115], a[40:43], a[148:151]
 ds_read_b64_tr_b16 a[106:107], v31 offset:5120
 v_mfma_f32_16x16x32_bf16 a[152:155], a[112:115], a[48:51], a[152:155]
 v_mfma_f32_16x16x32_bf16 a[152:155], a[116:119], a[52:55], a[152:155]
 s_add_u32 m0, s55, 1024
 ds_read_b64_tr_b16 a[108:109], v31 offset:6144
 v_mfma_f32_16x16x32_bf16 a[156:159], a[116:119], a[60:63], a[156:159]
 buffer_load_dwordx4 v17, s[16:19], s22 offen lds
 v_mfma_f32_16x16x32_bf16 a[156:159], a[112:115], a[56:59], a[156:159]
 ds_read_b64_tr_b16 a[110:111], v31 offset:7168
 v_mfma_f32_16x16x32_bf16 a[188:191], a[120:123], a[56:59], a[188:191]
 ds_read_b128 a[28:31], v25 offset:6144
 v_mfma_f32_16x16x32_bf16 a[188:191], a[124:127], a[60:63], a[188:191]
 ds_read_b64_tr_b16 a[112:113], v27 offset:16384
 v_mfma_f32_16x16x32_bf16 a[184:187], a[124:127], a[52:55], a[184:187]
 s_add_u32 m0, s55, 17280
 v_mfma_f32_16x16x32_bf16 a[184:187], a[120:123], a[48:51], a[184:187]
 buffer_load_dwordx4 v17, s[16:19], s22 offen offset:128 lds
 v_mfma_f32_16x16x32_bf16 a[180:183], a[120:123], a[40:43], a[180:183]
 ds_read_b64_tr_b16 a[114:115], v27 offset:18432
 v_mfma_f32_16x16x32_bf16 a[180:183], a[124:127], a[44:47], a[180:183]
 ds_read_b64_tr_b16 a[116:117], v27 offset:20480
 v_mfma_f32_16x16x32_bf16 a[176:179], a[124:127], a[36:39], a[176:179]
 v_mfma_f32_16x16x32_bf16 a[176:179], a[120:123], a[32:35], a[176:179]
 s_add_u32 m0, s55, 8192
 ds_read_b64_tr_b16 a[118:119], v27 offset:22528
 v_mfma_f32_16x16x32_bf16 a[208:211], a[128:131], a[32:35], a[208:211]
 buffer_load_dwordx4 v16, s[64:67], s22 offen lds
 v_mfma_f32_16x16x32_bf16 a[208:211], a[132:135], a[36:39], a[208:211]
 ds_read_b64_tr_b16 a[120:121], v27 offset:24576
 v_mfma_f32_16x16x32_bf16 a[212:215], a[132:135], a[44:47], a[212:215]
 v_mfma_f32_16x16x32_bf16 a[212:215], a[128:131], a[40:43], a[212:215]
 ds_read_b64_tr_b16 a[122:123], v27 offset:26624
 v_mfma_f32_16x16x32_bf16 a[216:219], a[128:131], a[48:51], a[216:219]
 s_add_u32 m0, s55, 24448
 v_mfma_f32_16x16x32_bf16 a[216:219], a[132:135], a[52:55], a[216:219]
 buffer_load_dwordx4 v16, s[64:67], s22 offen offset:128 lds
 v_mfma_f32_16x16x32_bf16 a[220:223], a[132:135], a[60:63], a[220:223]
 ds_read_b64_tr_b16 a[124:125], v27 offset:28672
 v_mfma_f32_16x16x32_bf16 a[220:223], a[128:131], a[56:59], a[220:223]
 ds_read_b64_tr_b16 a[126:127], v27 offset:30720
 v_mfma_f32_16x16x32_bf16 a[252:255], a[136:139], a[56:59], a[252:255]
 v_mfma_f32_16x16x32_bf16 a[252:255], a[140:143], a[60:63], a[252:255]
 s_add_u32 m0, s55, 9216
 s_branch L_tp_L_tB_5_o
L_tp_L_tB_5:
 s_nop 0
 s_nop 0
 s_branch L_tr10
L_tp_L_tB_5_o:
 ds_read_b64_tr_b16 a[128:129], v29 offset:16384
 v_mfma_f32_16x16x32_bf16 a[248:251], a[140:143], a[52:55], a[248:251]
 buffer_load_dwordx4 v17, s[64:67], s22 offen lds
 v_mfma_f32_16x16x32_bf16 a[248:251], a[136:139], a[48:51], a[248:251]
 ds_read_b64_tr_b16 a[130:131], v29 offset:18432
 v_mfma_f32_16x16x32_bf16 a[244:247], a[136:139], a[40:43], a[244:247]
 v_mfma_f32_16x16x32_bf16 a[244:247], a[140:143], a[44:47], a[244:247]
 s_add_u32 m0, s55, 25472
 ds_read_b64_tr_b16 a[132:133], v29 offset:20480
 v_mfma_f32_16x16x32_bf16 a[240:243], a[140:143], a[36:39], a[240:243]
 buffer_load_dwordx4 v17, s[64:67], s22 offen offset:128 lds
 v_mfma_f32_16x16x32_bf16 a[240:243], a[136:139], a[32:35], a[240:243]
 ds_read_b64_tr_b16 a[134:135], v29 offset:22528
 s_waitcnt lgkmcnt(4)
 v_mfma_f32_16x16x32_bf16 v[48:51], a[64:67], a[0:3], v[48:51]
 v_mfma_f32_16x16x32_bf16 v[48:51], a[68:71], a[4:7], v[48:51]
 ds_read_b64_tr_b16 a[136:137], v29 offset:24576
 v_mfma_f32_16x16x32_bf16 v[52:55], a[68:71], a[12:15], v[52:55]
 v_mfma_f32_16x16x32_bf16 v[52:55], a[64:67], a[8:11], v[52:55]
 s_add_u32 m0, s56, 0
 v_mfma_f32_16x16x32_bf16 v[56:59], a[64:67], a[16:19], v[56:59]
 buffer_load_dwordx4 v18, s[16:19], s22 offen lds
 v_mfma_f32_16x16x32_bf16 v[56:59], a[68:71], a[20:23], v[56:59]
 ds_read_b64_tr_b16 a[138:139], v29 offset:26624
 v_mfma_f32_16x16x32_bf16 v[60:63], a[68:71], a[28:31], v[60:63]
 v_mfma_f32_16x16x32_bf16 v[60:63], a[64:67], a[24:27], v[60:63]
 ds_read_b64_tr_b16 a[140:141], v29 offset:28672
 v_mfma_f32_16x16x32_bf16 v[92:95], a[72:75], a[24:27], v[92:95]
 s_add_u32 m0, s56, 4096
 v_mfma_f32_16x16x32_bf16 v[92:95], a[76:79], a[28:31], v[92:95]
 buffer_load_dwordx4 v18, s[64:67], s22 offen lds
 v_mfma_f32_16x16x32_bf16 v[88:91], a[76:79], a[20:23], v[88:91]
 ds_read_b64_tr_b16 a[142:143], v29 offset:30720
 v_mfma_f32_16x16x32_bf16 v[88:91], a[72:75], a[16:19], v[88:91]
 v_mfma_f32_16x16x32_bf16 v[84:87], a[72:75], a[8:11], v[84:87]
 v_mfma_f32_16x16x32_bf16 v[84:87], a[76:79], a[12:15], v[84:87]
 ds_read_b128 a[32:35], v24 offset:8192
 v_mfma_f32_16x16x32_bf16 v[80:83], a[76:79], a[4:7], v[80:83]
 v_mfma_f32_16x16x32_bf16 v[80:83], a[72:75], a[0:3], v[80:83]
 v_mfma_f32_16x16x32_bf16 v[112:115], a[80:83], a[0:3], v[112:115]
 ds_read_b128 a[36:39], v25 offset:8192
 v_mfma_f32_16x16x32_bf16 v[112:115], a[84:87], a[4:7], v[112:115]
 v_mfma_f32_16x16x32_bf16 v[116:119], a[84:87], a[12:15], v[116:119]
 v_mfma_f32_16x16x32_bf16 v[116:119], a[80:83], a[8:11], v[116:119]
 ds_read_b128 a[40:43], v24 offset:10240
 v_mfma_f32_16x16x32_bf16 v[120:123], a[80:83], a[16:19], v[120:123]
 v_mfma_f32_16x16x32_bf16 v[120:123], a[84:87], a[20:23], v[120:123]
 v_mfma_f32_16x16x32_bf16 v[124:127], a[84:87], a[28:31], v[124:127]
 ds_read_b128 a[44:47], v25 offset:10240
 v_mfma_f32_16x16x32_bf16 v[124:127], a[80:83], a[24:27], v[124:127]
 v_mfma_f32_16x16x32_bf16 v[156:159], a[88:91], a[24:27], v[156:159]
 v_mfma_f32_16x16x32_bf16 v[156:159], a[92:95], a[28:31], v[156:159]
 ds_read_b128 a[48:51], v24 offset:12288
 v_mfma_f32_16x16x32_bf16 v[152:155], a[92:95], a[20:23], v[152:155]
 v_mfma_f32_16x16x32_bf16 v[152:155], a[88:91], a[16:19], v[152:155]
 buffer_load_dword v0, v33, s[44:47], s60 offen
 v_mfma_f32_16x16x32_bf16 v[148:151], a[88:91], a[8:11], v[148:151]
 s_add_u32 s60, s60, 1664
 ds_read_b128 a[52:55], v25 offset:12288
 v_mfma_f32_16x16x32_bf16 v[148:151], a[92:95], a[12:15], v[148:151]
 v_mfma_f32_16x16x32_bf16 v[144:147], a[92:95], a[4:7], v[144:147]
 v_mfma_f32_16x16x32_bf16 v[144:147], a[88:91], a[0:3], v[144:147]
 ds_read_b128 a[56:59], v24 offset:14336
 v_mfma_f32_16x16x32_bf16 v[176:179], a[96:99], a[0:3], v[176:179]
 v_mfma_f32_16x16x32_bf16 v[176:179], a[100:103], a[4:7], v[176:179]
 v_mfma_f32_16x16x32_bf16 v[180:183], a[100:103], a[12:15], v[180:183]
 ds_read_b128 a[60:63], v25 offset:14336
 v_mfma_f32_16x16x32_bf16 v[180:183], a[96:99], a[8:11], v[180:183]
 v_mfma_f32_16x16x32_bf16 v[184:187], a[96:99], a[16:19], v[184:187]
 v_mfma_f32_16x16x32_bf16 v[184:187], a[100:103], a[20:23], v[184:187]
 v_mfma_f32_16x16x32_bf16 v[188:191], a[100:103], a[28:31], v[188:191]
 v_mfma_f32_16x16x32_bf16 v[188:191], a[96:99], a[24:27], v[188:191]
 v_mfma_f32_16x16x32_bf16 v[220:223], a[104:107], a[24:27], v[220:223]
 v_mfma_f32_16x16x32_bf16 v[220:223], a[108:111], a[28:31], v[220:223]
 v_mfma_f32_16x16x32_bf16 v[216:219], a[108:111], a[20:23], v[216:219]
 v_mfma_f32_16x16x32_bf16 v[216:219], a[104:107], a[16:19], v[216:219]
 v_mfma_f32_16x16x32_bf16 v[212:215], a[104:107], a[8:11], v[212:215]
 v_mfma_f32_16x16x32_bf16 v[212:215], a[108:111], a[12:15], v[212:215]
 v_mfma_f32_16x16x32_bf16 v[208:211], a[108:111], a[4:7], v[208:211]
 v_mfma_f32_16x16x32_bf16 v[208:211], a[104:107], a[0:3], v[208:211]
 v_mfma_f32_16x16x32_bf16 v[240:243], a[112:115], a[0:3], v[240:243]
 v_mfma_f32_16x16x32_bf16 v[240:243], a[116:119], a[4:7], v[240:243]
 v_mfma_f32_16x16x32_bf16 v[244:247], a[116:119], a[12:15], v[244:247]
 v_mfma_f32_16x16x32_bf16 v[244:247], a[112:115], a[8:11], v[244:247]
 v_mfma_f32_16x16x32_bf16 v[248:251], a[112:115], a[16:19], v[248:251]
 v_mfma_f32_16x16x32_bf16 v[248:251], a[116:119], a[20:23], v[248:251]
 v_mfma_f32_16x16x32_bf16 v[252:255], a[116:119], a[28:31], v[252:255]
 v_mfma_f32_16x16x32_bf16 v[252:255], a[112:115], a[24:27], v[252:255]
 v_mfma_f32_16x16x32_bf16 a[172:175], a[120:123], a[24:27], a[172:175]
 v_mfma_f32_16x16x32_bf16 a[172:175], a[124:127], a[28:31], a[172:175]
 v_mfma_f32_16x16x32_bf16 a[168:171], a[124:127], a[20:23], a[168:171]
 v_mfma_f32_16x16x32_bf16 a[168:171], a[120:123], a[16:19], a[168:171]
 v_mfma_f32_16x16x32_bf16 a[164:167], a[120:123], a[8:11], a[164:167]
 v_mfma_f32_16x16x32_bf16 a[164:167], a[124:127], a[12:15], a[164:167]
 v_mfma_f32_16x16x32_bf16 a[160:163], a[124:127], a[4:7], a[160:163]
 v_mfma_f32_16x16x32_bf16 a[160:163], a[120:123], a[0:3], a[160:163]
 s_waitcnt lgkmcnt(0)
 v_mfma_f32_16x16x32_bf16 a[192:195], a[128:131], a[0:3], a[192:195]
 s_add_u32 s23, s23, 1
 s_and_b32 s23, s23, 15
 s_mul_i32 s22, s23, 458752
 v_mfma_f32_16x16x32_bf16 a[192:195], a[132:135], a[4:7], a[192:195]
 s_mul_i32 s21, s23, 393216
 s_lshl_b32 s20, s23, 7
 v_mfma_f32_16x16x32_bf16 a[196:199], a[132:135], a[12:15], a[196:199]
 v_mfma_f32_16x16x32_bf16 a[196:199], a[128:131], a[8:11], a[196:199]
 v_mfma_f32_16x16x32_bf16 a[200:203], a[128:131], a[16:19], a[200:203]
 v_mfma_f32_16x16x32_bf16 a[200:203], a[132:135], a[20:23], a[200:203]
 v_mfma_f32_16x16x32_bf16 a[204:207], a[132:135], a[28:31], a[204:207]
 v_mfma_f32_16x16x32_bf16 a[204:207], a[128:131], a[24:27], a[204:207]
 v_mfma_f32_16x16x32_bf16 a[236:239], a[136:139], a[24:27], a[236:239]
 v_mfma_f32_16x16x32_bf16 a[236:239], a[140:143], a[28:31], a[236:239]
 v_mfma_f32_16x16x32_bf16 a[232:235], a[140:143], a[20:23], a[232:235]
 v_mfma_f32_16x16x32_bf16 a[232:235], a[136:139], a[16:19], a[232:235]
 v_mfma_f32_16x16x32_bf16 a[228:231], a[136:139], a[8:11], a[228:231]
 v_mfma_f32_16x16x32_bf16 a[228:231], a[140:143], a[12:15], a[228:231]
 v_mfma_f32_16x16x32_bf16 a[224:227], a[140:143], a[4:7], a[224:227]
 v_mfma_f32_16x16x32_bf16 a[224:227], a[136:139], a[0:3], a[224:227]
 v_mfma_f32_16x16x32_bf16 v[64:67], a[64:67], a[32:35], v[64:67]
 s_waitcnt vmcnt(1)
 s_barrier
 v_mfma_f32_16x16x32_bf16 v[64:67], a[68:71], a[36:39], v[64:67]
 s_cmp_eq_u32 s57, s71
 v_mfma_f32_16x16x32_bf16 v[68:71], a[68:71], a[44:47], v[68:71]
 s_cbranch_scc1 L_at11
L_at11_d:
 v_mfma_f32_16x16x32_bf16 v[68:71], a[64:67], a[40:43], v[68:71]
 s_add_u32 m0, s54, 73728
 v_mfma_f32_16x16x32_bf16 v[72:75], a[64:67], a[48:51], v[72:75]
 buffer_load_dwordx4 v8, s[8:11], s20 offen lds
 v_mfma_f32_16x16x32_bf16 v[72:75], a[68:71], a[52:55], v[72:75]
 ds_read_b128 a[0:3], v22 offset:0
 v_mfma_f32_16x16x32_bf16 v[76:79], a[68:71], a[60:63], v[76:79]
 ds_read_b128 a[4:7], v23 offset:0
 v_mfma_f32_16x16x32_bf16 v[76:79], a[64:67], a[56:59], v[76:79]
 v_mfma_f32_16x16x32_bf16 v[108:111], a[72:75], a[56:59], v[108:111]
 s_add_u32 m0, s54, 74752
 v_mfma_f32_16x16x32_bf16 v[108:111], a[76:79], a[60:63], v[108:111]
 buffer_load_dwordx4 v9, s[8:11], s20 offen lds
 v_mfma_f32_16x16x32_bf16 v[104:107], a[76:79], a[52:55], v[104:107]
 ds_read_b64_tr_b16 a[64:65], v26 offset:0
 v_mfma_f32_16x16x32_bf16 v[104:107], a[72:75], a[48:51], v[104:107]
 ds_read_b64_tr_b16 a[66:67], v26 offset:2048
 v_mfma_f32_16x16x32_bf16 v[100:103], a[72:75], a[40:43], v[100:103]
 v_mfma_f32_16x16x32_bf16 v[100:103], a[76:79], a[44:47], v[100:103]
 s_add_u32 m0, s54, 75776
 ds_read_b64_tr_b16 a[68:69], v26 offset:4096
 v_mfma_f32_16x16x32_bf16 v[96:99], a[76:79], a[36:39], v[96:99]
 buffer_load_dwordx4 v10, s[8:11], s20 offen lds
 v_mfma_f32_16x16x32_bf16 v[96:99], a[72:75], a[32:35], v[96:99]
 ds_read_b64_tr_b16 a[70:71], v26 offset:6144
 v_mfma_f32_16x16x32_bf16 v[128:131], a[80:83], a[32:35], v[128:131]
 ds_read_b128 a[8:11], v22 offset:2048
 v_mfma_f32_16x16x32_bf16 v[128:131], a[84:87], a[36:39], v[128:131]
 ds_read_b64_tr_b16 a[72:73], v26 offset:8192
 v_mfma_f32_16x16x32_bf16 v[132:135], a[84:87], a[44:47], v[132:135]
 s_add_u32 m0, s54, 76800
 v_mfma_f32_16x16x32_bf16 v[132:135], a[80:83], a[40:43], v[132:135]
 buffer_load_dwordx4 v11, s[8:11], s20 offen lds
 v_mfma_f32_16x16x32_bf16 v[136:139], a[80:83], a[48:51], v[136:139]
 ds_read_b64_tr_b16 a[74:75], v26 offset:10240
 v_mfma_f32_16x16x32_bf16 v[136:139], a[84:87], a[52:55], v[136:139]
 ds_read_b64_tr_b16 a[76:77], v26 offset:12288
 v_mfma_f32_16x16x32_bf16 v[140:143], a[84:87], a[60:63], v[140:143]
 ds_read_b128 a[12:15], v23 offset:2048
 v_mfma_f32_16x16x32_bf16 v[140:143], a[80:83], a[56:59], v[140:143]
 s_add_u32 m0, s54, 77824
 ds_read_b64_tr_b16 a[78:79], v26 offset:14336
 v_mfma_f32_16x16x32_bf16 v[172:175], a[88:91], a[56:59], v[172:175]
 buffer_load_dwordx4 v12, s[8:11], s20 offen lds
 v_mfma_f32_16x16x32_bf16 v[172:175], a[92:95], a[60:63], v[172:175]
 ds_read_b64_tr_b16 a[80:81], v28 offset:0
 v_mfma_f32_16x16x32_bf16 v[168:171], a[92:95], a[52:55], v[168:171]
 v_mfma_f32_16x16x32_bf16 v[168:171], a[88:91], a[48:51], v[168:171]
 ds_read_b64_tr_b16 a[82:83], v28 offset:2048
 v_mfma_f32_16x16x32_bf16 v[164:167], a[88:91], a[40:43], v[164:167]
 s_add_u32 m0, s54, 78848
 v_mfma_f32_16x16x32_bf16 v[164:167], a[92:95], a[44:47], v[164:167]
 buffer_load_dwordx4 v13, s[8:11], s20 offen lds
 v_mfma_f32_16x16x32_bf16 v[160:163], a[92:95], a[36:39], v[160:163]
 ds_read_b64_tr_b16 a[84:85], v28 offset:4096
 v_mfma_f32_16x16x32_bf16 v[160:163], a[88:91], a[32:35], v[160:163]
 ds_read_b64_tr_b16 a[86:87], v28 offset:6144
 v_mfma_f32_16x16x32_bf16 v[192:195], a[96:99], a[32:35], v[192:195]
 ds_read_b128 a[16:19], v22 offset:4096
 v_mfma_f32_16x16x32_bf16 v[192:195], a[100:103], a[36:39], v[192:195]
 s_add_u32 m0, s54, 79872
 ds_read_b64_tr_b16 a[88:89], v28 offset:8192
 v_mfma_f32_16x16x32_bf16 v[196:199], a[100:103], a[44:47], v[196:199]
 buffer_load_dwordx4 v14, s[8:11], s20 offen lds
 v_mfma_f32_16x16x32_bf16 v[196:199], a[96:99], a[40:43], v[196:199]
 ds_read_b64_tr_b16 a[90:91], v28 offset:10240
 v_mfma_f32_16x16x32_bf16 v[200:203], a[96:99], a[48:51], v[200:203]
 v_mfma_f32_16x16x32_bf16 v[200:203], a[100:103], a[52:55], v[200:203]
 ds_read_b64_tr_b16 a[92:93], v28 offset:12288
 v_mfma_f32_16x16x32_bf16 v[204:207], a[100:103], a[60:63], v[204:207]
 s_add_u32 m0, s54, 80896
 ds_read_b128 a[20:23], v23 offset:4096
 v_mfma_f32_16x16x32_bf16 v[204:207], a[96:99], a[56:59], v[204:207]
 buffer_load_dwordx4 v15, s[8:11], s20 offen lds
 v_mfma_f32_16x16x32_bf16 v[236:239], a[104:107], a[56:59], v[236:239]
 ds_read_b64_tr_b16 a[94:95], v28 offset:14336
 v_mfma_f32_16x16x32_bf16 v[236:239], a[108:111], a[60:63], v[236:239]
 ds_read_b64_tr_b16 a[96:97], v30 offset:0
 v_mfma_f32_16x16x32_bf16 v[232:235], a[108:111], a[52:55], v[232:235]
 v_mfma_f32_16x16x32_bf16 v[232:235], a[104:107], a[48:51], v[232:235]
 s_add_u32 m0, s55, 73728
 ds_read_b64_tr_b16 a[98:99], v30 offset:1024
 v_mfma_f32_16x16x32_bf16 v[228:231], a[104:107], a[40:43], v[228:231]
 buffer_load_dwordx4 v16, s[16:19], s22 offen lds
 v_mfma_f32_16x16x32_bf16 v[228:231], a[108:111], a[44:47], v[228:231]
 ds_read_b64_tr_b16 a[100:101], v30 offset:2048
 v_mfma_f32_16x16x32_bf16 v[224:227], a[108:111], a[36:39], v[224:227]
 ds_read_b128 a[24:27], v22 offset:6144
 v_mfma_f32_16x16x32_bf16 v[224:227], a[104:107], a[32:35], v[224:227]
 ds_read_b64_tr_b16 a[102:103], v30 offset:3072
 v_mfma_f32_16x16x32_bf16 a[144:147], a[112:115], a[32:35], a[144:147]
 s_add_u32 m0, s55, 89984
 v_mfma_f32_16x16x32_bf16 a[144:147], a[116:119], a[36:39], a[144:147]
 buffer_load_dwordx4 v16, s[16:19], s22 offen offset:128 lds
 v_mfma_f32_16x16x32_bf16 a[148:151], a[116:119], a[44:47], a[148:151]
 ds_read_b64_tr_b16 a[104:105], v30 offset:4096
 v_mfma_f32_16x16x32_bf16 a[148:151], a[112:115], a[40:43], a[148:151]
 ds_read_b64_tr_b16 a[106:107], v30 offset:5120
 v_mfma_f32_16x16x32_bf16 a[152:155], a[112:115], a[48:51], a[152:155]
 v_mfma_f32_16x16x32_bf16 a[152:155], a[116:119], a[52:55], a[152:155]
 s_add_u32 m0, s55, 74752
 ds_read_b64_tr_b16 a[108:109], v30 offset:6144
 v_mfma_f32_16x16x32_bf16 a[156:159], a[116:119], a[60:63], a[156:159]
 buffer_load_dwordx4 v17, s[16:19], s22 offen lds
 v_mfma_f32_16x16x32_bf16 a[156:159], a[112:115], a[56:59], a[156:159]
 ds_read_b64_tr_b16 a[110:111], v30 offset:7168
 v_mfma_f32_16x16x32_bf16 a[188:191], a[120:123], a[56:59], a[188:191]
 ds_read_b128 a[28:31], v23 offset:6144
 v_mfma_f32_16x16x32_bf16 a[188:191], a[124:127], a[60:63], a[188:191]
 ds_read_b64_tr_b16 a[112:113], v26 offset:16384
 v_mfma_f32_16x16x32_bf16 a[184:187], a[124:127], a[52:55], a[184:187]
 s_add_u32 m0, s55, 91008
 v_mfma_f32_16x16x32_bf16 a[184:187], a[120:123], a[48:51], a[184:187]
 buffer_load_dwordx4 v17, s[16:19], s22 offen offset:128 lds
 v_mfma_f32_16x16x32_bf16 a[180:183], a[120:123], a[40:43], a[180:183]
 ds_read_b64_tr_b16 a[114:115], v26 offset:18432
 v_mfma_f32_16x16x32_bf16 a[180:183], a[124:127], a[44:47], a[180:183]
 ds_read_b64_tr_b16 a[116:117], v26 offset:20480
 v_mfma_f32_16x16x32_bf16 a[176:179], a[124:127], a[36:39], a[176:179]
 v_mfma_f32_16x16x32_bf16 a[176:179], a[120:123], a[32:35], a[176:179]
 s_add_u32 m0, s55, 81920
 ds_read_b64_tr_b16 a[118:119], v26 offset:22528
 v_mfma_f32_16x16x32_bf16 a[208:211], a[128:131], a[32:35], a[208:211]
 buffer_load_dwordx4 v16, s[64:67], s22 offen lds
 v_mfma_f32_16x16x32_bf16 a[208:211], a[132:135], a[36:39], a[208:211]
 ds_read_b64_tr_b16 a[120:121], v26 offset:24576
 v_mfma_f32_16x16x32_bf16 a[212:215], a[132:135], a[44:47], a[212:215]
 v_mfma_f32_16x16x32_bf16 a[212:215], a[128:131], a[40:43], a[212:215]
 ds_read_b64_tr_b16 a[122:123], v26 offset:26624
 v_mfma_f32_16x16x32_bf16 a[216:219], a[128:131], a[48:51], a[216:219]
 s_add_u32 m0, s55, 98176
 v_mfma_f32_16x16x32_bf16 a[216:219], a[132:135], a[52:55], a[216:219]
 buffer_load_dwordx4 v16, s[64:67], s22 offen offset:128 lds
 v_mfma_f32_16x16x32_bf16 a[220:223], a[132:135], a[60:63], a[220:223]
 ds_read_b64_tr_b16 a[124:125], v26 offset:28672
 v_mfma_f32_16x16x32_bf16 a[220:223], a[128:131], a[56:59], a[220:223]
 ds_read_b64_tr_b16 a[126:127], v26 offset:30720
 v_mfma_f32_16x16x32_bf16 a[252:255], a[136:139], a[56:59], a[252:255]
 v_mfma_f32_16x16x32_bf16 a[252:255], a[140:143], a[60:63], a[252:255]
 s_add_u32 m0, s55, 82944
 ds_read_b64_tr_b16 a[128:129], v28 offset:16384
 v_mfma_f32_16x16x32_bf16 a[248:251], a[140:143], a[52:55], a[248:251]
 buffer_load_dwordx4 v17, s[64:67], s22 offen lds
 v_mfma_f32_16x16x32_bf16 a[248:251], a[136:139], a[48:51], a[248:251]
 ds_read_b64_tr_b16 a[130:131], v28 offset:18432
 v_mfma_f32_16x16x32_bf16 a[244:247], a[136:139], a[40:43], a[244:247]
 s_add_u32 s57, s57, 1
 v_mfma_f32_16x16x32_bf16 a[244:247], a[140:143], a[44:47], a[244:247]
 s_add_u32 m0, s55, 99200
 ds_read_b64_tr_b16 a[132:133], v28 offset:20480
 v_mfma_f32_16x16x32_bf16 a[240:243], a[140:143], a[36:39], a[240:243]
 s_cmp_lt_u32 s57, 7
 buffer_load_dwordx4 v17, s[64:67], s22 offen offset:128 lds
 v_mfma_f32_16x16x32_bf16 a[240:243], a[136:139], a[32:35], a[240:243]
 ds_read_b64_tr_b16 a[134:135], v28 offset:22528
 s_cbranch_scc1 L_lb1
 s_waitcnt lgkmcnt(4)
 v_mfma_f32_16x16x32_bf16 v[48:51], a[64:67], a[0:3], v[48:51]
 v_and_b32 v35, 1, v2
 v_lshlrev_b32 v35, 7, v35
 v_mfma_f32_16x16x32_bf16 v[48:51], a[68:71], a[4:7], v[48:51]
 ds_read_b64_tr_b16 a[136:137], v28 offset:24576
 v_mfma_f32_16x16x32_bf16 v[52:55], a[68:71], a[12:15], v[52:55]
 global_load_dword v3, v35, s[62:63] sc1
 v_mfma_f32_16x16x32_bf16 v[52:55], a[64:67], a[8:11], v[52:55]
 s_add_u32 m0, s56, 73728
 v_mfma_f32_16x16x32_bf16 v[56:59], a[64:67], a[16:19], v[56:59]
 buffer_load_dwordx4 v18, s[16:19], s22 offen lds
 v_mfma_f32_16x16x32_bf16 v[56:59], a[68:71], a[20:23], v[56:59]
 ds_read_b64_tr_b16 a[138:139], v28 offset:26624
 v_mfma_f32_16x16x32_bf16 v[60:63], a[68:71], a[28:31], v[60:63]
 v_mfma_f32_16x16x32_bf16 v[60:63], a[64:67], a[24:27], v[60:63]
 ds_read_b64_tr_b16 a[140:141], v28 offset:28672
 v_mfma_f32_16x16x32_bf16 v[92:95], a[72:75], a[24:27], v[92:95]
 s_add_u32 m0, s56, 77824
 v_mfma_f32_16x16x32_bf16 v[92:95], a[76:79], a[28:31], v[92:95]
 buffer_load_dwordx4 v18, s[64:67], s22 offen lds
 v_mfma_f32_16x16x32_bf16 v[88:91], a[76:79], a[20:23], v[88:91]
 s_mul_i32 s6, s4, 10240
 ds_read_b64_tr_b16 a[142:143], v28 offset:30720
 v_mfma_f32_16x16x32_bf16 v[88:91], a[72:75], a[16:19], v[88:91]
 s_add_u32 s6, s6, 29360128
 s_mul_i32 s7, s5, 6144
 s_add_u32 s7, s7, 29874176
 v_mfma_f32_16x16x32_bf16 v[84:87], a[72:75], a[8:11], v[84:87]
 s_lshl_b32 s18, s3, 12
 s_add_u32 s6, s6, s18
 s_add_u32 s7, s7, s18
 v_mfma_f32_16x16x32_bf16 v[84:87], a[76:79], a[12:15], v[84:87]
 ds_read_b128 a[32:35], v22 offset:8192
 v_mfma_f32_16x16x32_bf16 v[80:83], a[76:79], a[4:7], v[80:83]
 s_cmp_lt_u32 s3, 3
 s_cselect_b32 s58, s6, s7
 v_mfma_f32_16x16x32_bf16 v[80:83], a[72:75], a[0:3], v[80:83]
 s_cmp_lt_u32 s3, 2
 s_cselect_b32 s59, s6, s7
 s_mov_b32 s50, 8192
 v_mfma_f32_16x16x32_bf16 v[112:115], a[80:83], a[0:3], v[112:115]
 s_movk_i32 s61, 4096
 ds_read_b128 a[36:39], v23 offset:8192
 v_mfma_f32_16x16x32_bf16 v[112:115], a[84:87], a[4:7], v[112:115]
 v_mfma_f32_16x16x32_bf16 v[116:119], a[84:87], a[12:15], v[116:119]
 v_mfma_f32_16x16x32_bf16 v[116:119], a[80:83], a[8:11], v[116:119]
 ds_read_b128 a[40:43], v22 offset:10240
 v_mfma_f32_16x16x32_bf16 v[120:123], a[80:83], a[16:19], v[120:123]
 v_mfma_f32_16x16x32_bf16 v[120:123], a[84:87], a[20:23], v[120:123]
 v_mfma_f32_16x16x32_bf16 v[124:127], a[84:87], a[28:31], v[124:127]
 ds_read_b128 a[44:47], v23 offset:10240
 v_mfma_f32_16x16x32_bf16 v[124:127], a[80:83], a[24:27], v[124:127]
 v_mfma_f32_16x16x32_bf16 v[156:159], a[88:91], a[24:27], v[156:159]
 v_mfma_f32_16x16x32_bf16 v[156:159], a[92:95], a[28:31], v[156:159]
 ds_read_b128 a[48:51], v22 offset:12288
 v_mfma_f32_16x16x32_bf16 v[152:155], a[92:95], a[20:23], v[152:155]
 v_mfma_f32_16x16x32_bf16 v[152:155], a[88:91], a[16:19], v[152:155]
 v_mfma_f32_16x16x32_bf16 v[148:151], a[88:91], a[8:11], v[148:151]
 ds_read_b128 a[52:55], v23 offset:12288
 v_mfma_f32_16x16x32_bf16 v[148:151], a[92:95], a[12:15], v[148:151]
 v_mfma_f32_16x16x32_bf16 v[144:147], a[92:95], a[4:7], v[144:147]
 v_mfma_f32_16x16x32_bf16 v[144:147], a[88:91], a[0:3], v[144:147]
 ds_read_b128 a[56:59], v22 offset:14336
 v_mfma_f32_16x16x32_bf16 v[176:179], a[96:99], a[0:3], v[176:179]
 v_mfma_f32_16x16x32_bf16 v[176:179], a[100:103], a[4:7], v[176:179]
 v_mfma_f32_16x16x32_bf16 v[180:183], a[100:103], a[12:15], v[180:183]
 ds_read_b128 a[60:63], v23 offset:14336
 v_mfma_f32_16x16x32_bf16 v[180:183], a[96:99], a[8:11], v[180:183]
 v_mfma_f32_16x16x32_bf16 v[184:187], a[96:99], a[16:19], v[184:187]
 v_mfma_f32_16x16x32_bf16 v[184:187], a[100:103], a[20:23], v[184:187]
 v_mfma_f32_16x16x32_bf16 v[188:191], a[100:103], a[28:31], v[188:191]
 v_mfma_f32_16x16x32_bf16 v[188:191], a[96:99], a[24:27], v[188:191]
 v_mfma_f32_16x16x32_bf16 v[220:223], a[104:107], a[24:27], v[220:223]
 v_mfma_f32_16x16x32_bf16 v[220:223], a[108:111], a[28:31], v[220:223]
 s_waitcnt vmcnt(2)
 v_mfma_f32_16x16x32_bf16 v[216:219], a[108:111], a[20:23], v[216:219]
 v_cmp_gt_u32 vcc, 0x80, v3
 v_mfma_f32_16x16x32_bf16 v[216:219], a[104:107], a[16:19], v[216:219]
 v_mfma_f32_16x16x32_bf16 v[212:215], a[104:107], a[8:11], v[212:215]
 s_cbranch_vccnz L_ini1_s
L_ini1_d:
 v_mfma_f32_16x16x32_bf16 v[212:215], a[108:111], a[12:15], v[212:215]
 s_add_u32 m0, s18, 147456
 v_mfma_f32_16x16x32_bf16 v[208:211], a[108:111], a[4:7], v[208:211]
 buffer_load_dwordx4 v1, s[24:27], s58 offen sc1 lds
 v_mfma_f32_16x16x32_bf16 v[208:211], a[104:107], a[0:3], v[208:211]
 s_bfe_u32 s20, s2, 0x10002
 s_and_b32 s6, s2, 1
 s_bfe_u32 s7, s2, 0x10001
 v_mfma_f32_16x16x32_bf16 v[240:243], a[112:115], a[0:3], v[240:243]
 s_lshl1_add_u32 s6, s6, s7
 s_lshr_b32 s7, s2, 6
 s_lshl2_add_u32 s21, s6, s7
 v_mfma_f32_16x16x32_bf16 v[240:243], a[116:119], a[4:7], v[240:243]
 s_bfe_u32 s22, s2, 0x20003
 buffer_load_dwordx4 v1, s[24:27], s58 offen offset:1024 sc1 lds
 v_mfma_f32_16x16x32_bf16 v[244:247], a[116:119], a[12:15], v[244:247]
 s_getpc_b64 s[72:73]
L_pd1:
 s_sub_u32 s72, s72, L_pd1-L_pc
 s_subb_u32 s73, s73, 0
 v_mfma_f32_16x16x32_bf16 v[244:247], a[112:115], a[8:11], v[244:247]
 s_lshr_b32 s0, s2, 3
 s_lshl2_add_u32 s0, s0, s3
 s_lshl_b32 s0, s0, 3
 v_mfma_f32_16x16x32_bf16 v[248:251], a[112:115], a[16:19], v[248:251]
 s_bfe_u32 s7, s2, 0x10005
 buffer_load_dwordx4 v1, s[24:27], s59 offen offset:2048 sc1 lds
 v_min_u32 v36, 7, v2
 v_add_lshl_u32 v36, v36, s0, 7
 v_mfma_f32_16x16x32_bf16 v[248:251], a[116:119], a[20:23], v[248:251]
 s_lshl1_add_u32 s22, s22, s7
 v_min_u32 v36, L_cend-L_pc-4, v36
 v_mfma_f32_16x16x32_bf16 v[252:255], a[116:119], a[28:31], v[252:255]
 s_lshl_b32 s22, s22, 8
 s_mul_i32 s14, s20, 3670016
 s_add_u32 s14, s14, s22
 v_mfma_f32_16x16x32_bf16 v[252:255], a[112:115], a[24:27], v[252:255]
 s_xor_b32 s6, s53, s20
 buffer_load_dwordx4 v1, s[24:27], s59 offen offset:3072 sc1 lds
 v_mfma_f32_16x16x32_bf16 a[172:175], a[120:123], a[24:27], a[172:175]
 s_xor_b32 s6, s6, 0
 s_lshl_b32 s6, s6, 7
 s_add_u32 s14, s14, s6
 v_mfma_f32_16x16x32_bf16 a[172:175], a[124:127], a[28:31], a[172:175]
 s_lshl_b32 s15, s52, 16
 global_load_dword v0, v36, s[72:73]
 v_mfma_f32_16x16x32_bf16 a[168:171], a[124:127], a[20:23], a[168:171]
 s_add_u32 s14, s15, s14
 s_mov_b32 s15, s14
 v_mfma_f32_16x16x32_bf16 a[168:171], a[120:123], a[16:19], a[168:171]
 buffer_store_dwordx4 v[4:7], v1, s[48:51], s61 offen sc1
 v_mfma_f32_16x16x32_bf16 a[164:167], a[120:123], a[8:11], a[164:167]
 v_mfma_f32_16x16x32_bf16 a[164:167], a[124:127], a[12:15], a[164:167]
 v_mfma_f32_16x16x32_bf16 a[160:163], a[124:127], a[4:7], a[160:163]
 v_mfma_f32_16x16x32_bf16 a[160:163], a[120:123], a[0:3], a[160:163]
 s_waitcnt lgkmcnt(0)
 v_mfma_f32_16x16x32_bf16 a[192:195], a[128:131], a[0:3], a[192:195]
 buffer_store_dwordx4 v[4:7], v1, s[48:51], s61 offen offset:1024 sc1
 v_mfma_f32_16x16x32_bf16 a[192:195], a[132:135], a[4:7], a[192:195]
 v_mfma_f32_16x16x32_bf16 a[196:199], a[132:135], a[12:15], a[196:199]
 v_lshrrev_b32 v12, 3, v2
 v_mfma_f32_16x16x32_bf16 a[196:199], a[128:131], a[8:11], a[196:199]
 v_bfe_u32 v13, v2, 4, 2
 v_mfma_f32_16x16x32_bf16 a[200:203], a[128:131], a[16:19], a[200:203]
 v_lshlrev_b32 v13, 1, v13
 v_mfma_f32_16x16x32_bf16 a[200:203], a[132:135], a[20:23], a[200:203]
 buffer_store_dwordx4 v[4:7], v1, s[48:51], s61 offen offset:2048 sc1
 v_and_b32 v14, 7, v2
 v_mfma_f32_16x16x32_bf16 a[204:207], a[132:135], a[28:31], a[204:207]
 v_xor_b32 v14, v14, v13
 v_mfma_f32_16x16x32_bf16 a[204:207], a[128:131], a[24:27], a[204:207]
 v_lshlrev_b32 v14, 4, v14
 v_mfma_f32_16x16x32_bf16 a[236:239], a[136:139], a[24:27], a[236:239]
 v_lshl_add_u32 v8, v12, 11, v14
 v_mfma_f32_16x16x32_bf16 a[236:239], a[140:143], a[28:31], a[236:239]
 v_add_u32 v9, 16384, v8
 v_mfma_f32_16x16x32_bf16 a[232:235], a[140:143], a[20:23], a[232:235]
 buffer_store_dwordx4 v[4:7], v1, s[48:51], s61 offen offset:3072 sc1
 v_add_u32 v10, 32768, v8
 v_mfma_f32_16x16x32_bf16 a[232:235], a[136:139], a[16:19], a[232:235]
 v_add_u32 v11, 49152, v8
 v_mfma_f32_16x16x32_bf16 a[228:231], a[136:139], a[8:11], a[228:231]
 v_mfma_f32_16x16x32_bf16 a[228:231], a[140:143], a[12:15], a[228:231]
 v_mfma_f32_16x16x32_bf16 a[224:227], a[140:143], a[4:7], a[224:227]
 v_mfma_f32_16x16x32_bf16 a[224:227], a[136:139], a[0:3], a[224:227]
 v_mfma_f32_16x16x32_bf16 v[64:67], a[64:67], a[32:35], v[64:67]
 s_waitcnt vmcnt(9)
 s_barrier
 v_mfma_f32_16x16x32_bf16 v[64:67], a[68:71], a[36:39], v[64:67]
 v_mfma_f32_16x16x32_bf16 v[68:71], a[68:71], a[44:47], v[68:71]
 v_mfma_f32_16x16x32_bf16 v[68:71], a[64:67], a[40:43], v[68:71]
 v_mfma_f32_16x16x32_bf16 v[72:75], a[64:67], a[48:51], v[72:75]
 ds_read_b128 a[0:3], v24 offset:0
 v_mfma_f32_16x16x32_bf16 v[72:75], a[68:71], a[52:55], v[72:75]
 v_mfma_f32_16x16x32_bf16 v[76:79], a[68:71], a[60:63], v[76:79]
 ds_read_b128 a[4:7], v25 offset:0
 v_mfma_f32_16x16x32_bf16 v[76:79], a[64:67], a[56:59], v[76:79]
 v_mfma_f32_16x16x32_bf16 v[108:111], a[72:75], a[56:59], v[108:111]
 v_mfma_f32_16x16x32_bf16 v[108:111], a[76:79], a[60:63], v[108:111]
 s_add_u32 m0, s18, 0
 ds_read_b64_tr_b16 a[64:65], v27 offset:0
 v_mfma_f32_16x16x32_bf16 v[104:107], a[76:79], a[52:55], v[104:107]
 buffer_load_dwordx4 v8, s[28:31], s15 offen lds
 v_mfma_f32_16x16x32_bf16 v[104:107], a[72:75], a[48:51], v[104:107]
 ds_read_b64_tr_b16 a[66:67], v27 offset:2048
 v_mfma_f32_16x16x32_bf16 v[100:103], a[72:75], a[40:43], v[100:103]
 v_mfma_f32_16x16x32_bf16 v[100:103], a[76:79], a[44:47], v[100:103]
 ds_read_b64_tr_b16 a[68:69], v27 offset:4096
 v_mfma_f32_16x16x32_bf16 v[96:99], a[76:79], a[36:39], v[96:99]
 ds_read_b128 a[8:11], v24 offset:2048
 v_mfma_f32_16x16x32_bf16 v[96:99], a[72:75], a[32:35], v[96:99]
 ds_read_b64_tr_b16 a[70:71], v27 offset:6144
 v_mfma_f32_16x16x32_bf16 v[128:131], a[80:83], a[32:35], v[128:131]
 v_mfma_f32_16x16x32_bf16 v[128:131], a[84:87], a[36:39], v[128:131]
 ds_read_b64_tr_b16 a[72:73], v27 offset:8192
 v_mfma_f32_16x16x32_bf16 v[132:135], a[84:87], a[44:47], v[132:135]
 v_mfma_f32_16x16x32_bf16 v[132:135], a[80:83], a[40:43], v[132:135]
 s_add_u32 m0, s18, 1024
 ds_read_b64_tr_b16 a[74:75], v27 offset:10240
 v_mfma_f32_16x16x32_bf16 v[136:139], a[80:83], a[48:51], v[136:139]
 buffer_load_dwordx4 v9, s[28:31], s15 offen lds
 v_mfma_f32_16x16x32_bf16 v[136:139], a[84:87], a[52:55], v[136:139]
 ds_read_b64_tr_b16 a[76:77], v27 offset:12288
 v_mfma_f32_16x16x32_bf16 v[140:143], a[84:87], a[60:63], v[140:143]
 ds_read_b128 a[12:15], v25 offset:2048
 v_mfma_f32_16x16x32_bf16 v[140:143], a[80:83], a[56:59], v[140:143]
 ds_read_b64_tr_b16 a[78:79], v27 offset:14336
 v_mfma_f32_16x16x32_bf16 v[172:175], a[88:91], a[56:59], v[172:175]
 v_mfma_f32_16x16x32_bf16 v[172:175], a[92:95], a[60:63], v[172:175]
 ds_read_b64_tr_b16 a[80:81], v29 offset:0
 v_mfma_f32_16x16x32_bf16 v[168:171], a[92:95], a[52:55], v[168:171]
 v_mfma_f32_16x16x32_bf16 v[168:171], a[88:91], a[48:51], v[168:171]
 ds_read_b64_tr_b16 a[82:83], v29 offset:2048
 v_mfma_f32_16x16x32_bf16 v[164:167], a[88:91], a[40:43], v[164:167]
 v_mfma_f32_16x16x32_bf16 v[164:167], a[92:95], a[44:47], v[164:167]
 s_add_u32 m0, s18, 2048
 ds_read_b64_tr_b16 a[84:85], v29 offset:4096
 v_mfma_f32_16x16x32_bf16 v[160:163], a[92:95], a[36:39], v[160:163]
 buffer_load_dwordx4 v10, s[28:31], s15 offen lds
 v_mfma_f32_16x16x32_bf16 v[160:163], a[88:91], a[32:35], v[160:163]
 ds_read_b64_tr_b16 a[86:87], v29 offset:6144
 v_mfma_f32_16x16x32_bf16 v[192:195], a[96:99], a[32:35], v[192:195]
 ds_read_b128 a[16:19], v24 offset:4096
 v_mfma_f32_16x16x32_bf16 v[192:195], a[100:103], a[36:39], v[192:195]
 ds_read_b64_tr_b16 a[88:89], v29 offset:8192
 v_mfma_f32_16x16x32_bf16 v[196:199], a[100:103], a[44:47], v[196:199]
 v_mfma_f32_16x16x32_bf16 v[196:199], a[96:99], a[40:43], v[196:199]
 ds_read_b64_tr_b16 a[90:91], v29 offset:10240
 v_mfma_f32_16x16x32_bf16 v[200:203], a[96:99], a[48:51], v[200:203]
 v_mfma_f32_16x16x32_bf16 v[200:203], a[100:103], a[52:55], v[200:203]
 ds_read_b64_tr_b16 a[92:93], v29 offset:12288
 v_mfma_f32_16x16x32_bf16 v[204:207], a[100:103], a[60:63], v[204:207]
 ds_read_b128 a[20:23], v25 offset:4096
 v_mfma_f32_16x16x32_bf16 v[204:207], a[96:99], a[56:59], v[204:207]
 s_add_u32 m0, s18, 3072
 ds_read_b64_tr_b16 a[94:95], v29 offset:14336
 v_mfma_f32_16x16x32_bf16 v[236:239], a[104:107], a[56:59], v[236:239]
 buffer_load_dwordx4 v11, s[28:31], s15 offen lds
 v_mfma_f32_16x16x32_bf16 v[236:239], a[108:111], a[60:63], v[236:239]
 ds_read_b64_tr_b16 a[96:97], v31 offset:0
 v_mfma_f32_16x16x32_bf16 v[232:235], a[108:111], a[52:55], v[232:235]
 v_mfma_f32_16x16x32_bf16 v[232:235], a[104:107], a[48:51], v[232:235]
 ds_read_b64_tr_b16 a[98:99], v31 offset:1024
 v_mfma_f32_16x16x32_bf16 v[228:231], a[104:107], a[40:43], v[228:231]
 v_mfma_f32_16x16x32_bf16 v[228:231], a[108:111], a[44:47], v[228:231]
 ds_read_b64_tr_b16 a[100:101], v31 offset:2048
 v_mfma_f32_16x16x32_bf16 v[224:227], a[108:111], a[36:39], v[224:227]
 ds_read_b128 a[24:27], v24 offset:6144
 v_mfma_f32_16x16x32_bf16 v[224:227], a[104:107], a[32:35], v[224:227]
 ds_read_b64_tr_b16 a[102:103], v31 offset:3072
 v_mfma_f32_16x16x32_bf16 a[144:147], a[112:115], a[32:35], a[144:147]
 s_add_u32 s15, s14, 131072
 v_mfma_f32_16x16x32_bf16 a[144:147], a[116:119], a[36:39], a[144:147]
 s_add_u32 m0, s18, 16384
 ds_read_b64_tr_b16 a[104:105], v31 offset:4096
 v_mfma_f32_16x16x32_bf16 a[148:151], a[116:119], a[44:47], a[148:151]
 buffer_load_dwordx4 v8, s[28:31], s15 offen lds
 s_branch L_tp_L_tB_6_o
L_tp_L_tB_6:
 s_nop 0
 s_branch L_tr10
 s_nop 0
L_tp_L_tB_6_o:
 v_mfma_f32_16x16x32_bf16 a[148:151], a[112:115], a[40:43], a[148:151]
 ds_read_b64_tr_b16 a[106:107], v31 offset:5120
 v_mfma_f32_16x16x32_bf16 a[152:155], a[112:115], a[48:51], a[152:155]
 v_mfma_f32_16x16x32_bf16 a[152:155], a[116:119], a[52:55], a[152:155]
 ds_read_b64_tr_b16 a[108:109], v31 offset:6144
 v_mfma_f32_16x16x32_bf16 a[156:159], a[116:119], a[60:63], a[156:159]
 ds_read_b128 a[28:31], v25 offset:6144
 v_mfma_f32_16x16x32_bf16 a[156:159], a[112:115], a[56:59], a[156:159]
 ds_read_b64_tr_b16 a[110:111], v31 offset:7168
 v_mfma_f32_16x16x32_bf16 a[188:191], a[120:123], a[56:59], a[188:191]
 v_mfma_f32_16x16x32_bf16 a[188:191], a[124:127], a[60:63], a[188:191]
 ds_read_b64_tr_b16 a[112:113], v27 offset:16384
 v_mfma_f32_16x16x32_bf16 a[184:187], a[124:127], a[52:55], a[184:187]
 v_mfma_f32_16x16x32_bf16 a[184:187], a[120:123], a[48:51], a[184:187]
 s_add_u32 m0, s18, 17408
 ds_read_b64_tr_b16 a[114:115], v27 offset:18432
 v_mfma_f32_16x16x32_bf16 a[180:183], a[120:123], a[40:43], a[180:183]
 buffer_load_dwordx4 v9, s[28:31], s15 offen lds
 v_mfma_f32_16x16x32_bf16 a[180:183], a[124:127], a[44:47], a[180:183]
 ds_read_b64_tr_b16 a[116:117], v27 offset:20480
 v_mfma_f32_16x16x32_bf16 a[176:179], a[124:127], a[36:39], a[176:179]
 v_mfma_f32_16x16x32_bf16 a[176:179], a[120:123], a[32:35], a[176:179]
 ds_read_b64_tr_b16 a[118:119], v27 offset:22528
 v_mfma_f32_16x16x32_bf16 a[208:211], a[128:131], a[32:35], a[208:211]
 v_mfma_f32_16x16x32_bf16 a[208:211], a[132:135], a[36:39], a[208:211]
 ds_read_b64_tr_b16 a[120:121], v27 offset:24576
 v_mfma_f32_16x16x32_bf16 a[212:215], a[132:135], a[44:47], a[212:215]
 v_mfma_f32_16x16x32_bf16 a[212:215], a[128:131], a[40:43], a[212:215]
 ds_read_b64_tr_b16 a[122:123], v27 offset:26624
 v_mfma_f32_16x16x32_bf16 a[216:219], a[128:131], a[48:51], a[216:219]
 v_mfma_f32_16x16x32_bf16 a[216:219], a[132:135], a[52:55], a[216:219]
 s_add_u32 m0, s18, 18432
 ds_read_b64_tr_b16 a[124:125], v27 offset:28672
 v_mfma_f32_16x16x32_bf16 a[220:223], a[132:135], a[60:63], a[220:223]
 buffer_load_dwordx4 v10, s[28:31], s15 offen lds
 v_mfma_f32_16x16x32_bf16 a[220:223], a[128:131], a[56:59], a[220:223]
 ds_read_b64_tr_b16 a[126:127], v27 offset:30720
 v_mfma_f32_16x16x32_bf16 a[252:255], a[136:139], a[56:59], a[252:255]
 v_mfma_f32_16x16x32_bf16 a[252:255], a[140:143], a[60:63], a[252:255]
 ds_read_b64_tr_b16 a[128:129], v29 offset:16384
 v_mfma_f32_16x16x32_bf16 a[248:251], a[140:143], a[52:55], a[248:251]
 v_mfma_f32_16x16x32_bf16 a[248:251], a[136:139], a[48:51], a[248:251]
 ds_read_b64_tr_b16 a[130:131], v29 offset:18432
 v_mfma_f32_16x16x32_bf16 a[244:247], a[136:139], a[40:43], a[244:247]
 v_mfma_f32_16x16x32_bf16 a[244:247], a[140:143], a[44:47], a[244:247]
 ds_read_b64_tr_b16 a[132:133], v29 offset:20480
 v_mfma_f32_16x16x32_bf16 a[240:243], a[140:143], a[36:39], a[240:243]
 v_mfma_f32_16x16x32_bf16 a[240:243], a[136:139], a[32:35], a[240:243]
 ds_read_b64_tr_b16 a[134:135], v29 offset:22528
 s_waitcnt lgkmcnt(4)
 v_mfma_f32_16x16x32_bf16 v[48:51], a[64:67], a[0:3], v[48:51]
 s_waitcnt vmcnt(12)
 s_barrier
 v_mfma_f32_16x16x32_bf16 v[48:51], a[68:71], a[4:7], v[48:51]
 ds_read_b64_tr_b16 a[136:137], v29 offset:24576
 v_mfma_f32_16x16x32_bf16 v[52:55], a[68:71], a[12:15], v[52:55]
 s_mul_i32 s6, s3, 320
 v_lshl_add_u32 v12, v2, 3, s6
 v_mfma_f32_16x16x32_bf16 v[52:55], a[64:67], a[8:11], v[52:55]
 s_add_u32 m0, s18, 19456
 v_mfma_f32_16x16x32_bf16 v[56:59], a[64:67], a[16:19], v[56:59]
 s_lshl_b32 s7, s53, 7
 buffer_load_dwordx4 v11, s[28:31], s15 offen lds
 v_mfma_f32_16x16x32_bf16 v[56:59], a[68:71], a[20:23], v[56:59]
 s_mul_i32 s64, s52, 640
 ds_read_b64_tr_b16 a[138:139], v29 offset:26624
 v_add_u32 v13, 147456, v12
 v_mfma_f32_16x16x32_bf16 v[60:63], a[68:71], a[28:31], v[60:63]
 s_add_u32 s64, s64, 65536
 v_add_u32 v12, 65536, v12
 v_mfma_f32_16x16x32_bf16 v[60:63], a[64:67], a[24:27], v[60:63]
 s_lshl1_add_u32 s0, s5, s53
 ds_read_b64_tr_b16 a[140:141], v29 offset:28672
 v_mfma_f32_16x16x32_bf16 v[92:95], a[72:75], a[24:27], v[92:95]
 s_add_u32 s15, s14, 786432
 s_mul_i32 s1, s0, 1179648
 s_lshr_b32 s6, s4, 4
 v_mfma_f32_16x16x32_bf16 v[92:95], a[76:79], a[28:31], v[92:95]
 s_add_u32 m0, s18, 32768
 v_mfma_f32_16x16x32_bf16 v[88:91], a[76:79], a[20:23], v[88:91]
 s_mul_i32 s48, s6, 56
 buffer_load_dwordx4 v8, s[28:31], s15 offen lds
 v_mfma_f32_16x16x32_bf16 v[88:91], a[72:75], a[16:19], v[88:91]
 s_add_u32 s48, s48, 32
 ds_read_b64_tr_b16 a[142:143], v29 offset:30720
 v_mfma_f32_16x16x32_bf16 v[84:87], a[72:75], a[8:11], v[84:87]
 s_and_b32 s56, s4, 15
 s_lshl1_add_u32 s41, s56, s52
 s_add_u32 s40, s41, s48
 v_mfma_f32_16x16x32_bf16 v[84:87], a[76:79], a[12:15], v[84:87]
 s_lshl_b32 s40, s40, 11
 ds_read_b128 a[32:35], v24 offset:8192
 v_mfma_f32_16x16x32_bf16 v[80:83], a[76:79], a[4:7], v[80:83]
 s_add_u32 s40, s40, s1
 s_add_u32 s41, s56, s52
 s_sub_u32 s41, s41, 1
 v_mfma_f32_16x16x32_bf16 v[80:83], a[72:75], a[0:3], v[80:83]
 s_add_u32 s44, s41, s48
 s_add_u32 s44, s44, 32
 s_lshl_b32 s44, s44, 11
 v_mfma_f32_16x16x32_bf16 v[112:115], a[80:83], a[0:3], v[112:115]
 s_add_u32 s44, s44, s1
 ds_read_b128 a[36:39], v25 offset:8192
 v_mfma_f32_16x16x32_bf16 v[112:115], a[84:87], a[4:7], v[112:115]
 s_lshl1_add_u32 s48, s48, s41
 s_add_u32 s48, s48, 96
 s_lshl_b32 s48, s48, 10
 v_mfma_f32_16x16x32_bf16 v[116:119], a[84:87], a[12:15], v[116:119]
 s_add_u32 s48, s48, s1
 s_add_u32 s41, s40, 294912
 s_add_u32 s42, s40, 589824
 v_mfma_f32_16x16x32_bf16 v[116:119], a[80:83], a[8:11], v[116:119]
 s_add_u32 m0, s18, 33792
 ds_read_b128 a[40:43], v24 offset:10240
 v_mfma_f32_16x16x32_bf16 v[120:123], a[80:83], a[16:19], v[120:123]
 s_add_u32 s43, s40, 884736
 buffer_load_dwordx4 v9, s[28:31], s15 offen lds
 v_mfma_f32_16x16x32_bf16 v[120:123], a[84:87], a[20:23], v[120:123]
 s_add_u32 s45, s44, 294912
 s_add_u32 s46, s44, 589824
 s_add_u32 s47, s44, 884736
 v_mfma_f32_16x16x32_bf16 v[124:127], a[84:87], a[28:31], v[124:127]
 s_add_u32 s49, s48, 294912
 ds_read_b128 a[44:47], v25 offset:10240
 v_mfma_f32_16x16x32_bf16 v[124:127], a[80:83], a[24:27], v[124:127]
 s_add_u32 s50, s48, 589824
 s_add_u32 s51, s48, 884736
 s_bfe_u32 s58, s21, 0x20001
 v_mfma_f32_16x16x32_bf16 v[156:159], a[88:91], a[24:27], v[156:159]
 s_lshr_b32 s59, s21, 3
 s_lshl3_add_u32 s58, s58, s59
 s_and_b32 s59, s21, 1
 v_mfma_f32_16x16x32_bf16 v[156:159], a[92:95], a[28:31], v[156:159]
 s_lshl2_add_u32 s58, s58, s59
 ds_read_b128 a[48:51], v24 offset:12288
 v_mfma_f32_16x16x32_bf16 v[152:155], a[92:95], a[20:23], v[152:155]
 s_lshl4_add_u32 s59, s20, s58
 s_lshl3_add_u32 s69, s3, s58
 s_lshl_b32 s59, s59, 9
 v_mfma_f32_16x16x32_bf16 v[152:155], a[88:91], a[16:19], v[152:155]
 s_lshl_b32 s69, s69, 9
 s_add_u32 s59, s59, 30408704
 s_add_u32 s69, s69, 30408704
 v_mfma_f32_16x16x32_bf16 v[148:151], a[88:91], a[8:11], v[148:151]
 s_lshl_b32 s60, s53, 18
 ds_read_b128 a[52:55], v25 offset:12288
 v_mfma_f32_16x16x32_bf16 v[148:151], a[92:95], a[12:15], v[148:151]
 s_add_u32 m0, s18, 34816
 v_mfma_f32_16x16x32_bf16 v[144:147], a[92:95], a[4:7], v[144:147]
 s_lshl_b32 s0, s52, 12
 buffer_load_dwordx4 v10, s[28:31], s15 offen lds
 v_mfma_f32_16x16x32_bf16 v[144:147], a[88:91], a[0:3], v[144:147]
 s_add_u32 s60, s60, s0
 ds_read_b128 a[56:59], v24 offset:14336
 v_mfma_f32_16x16x32_bf16 v[176:179], a[96:99], a[0:3], v[176:179]
 s_add_u32 s60, s60, s59
 s_add_u32 s60, s60, 65536
 s_lshl2_add_u32 s19, s21, s3
 v_mfma_f32_16x16x32_bf16 v[176:179], a[100:103], a[4:7], v[176:179]
 s_mul_i32 s13, s19, 294912
 s_mul_i32 s12, s20, 114688
 s_add_u32 s12, s12, s13
 v_mfma_f32_16x16x32_bf16 v[180:183], a[100:103], a[12:15], v[180:183]
 s_add_u32 s12, s12, 65536
 ds_read_b128 a[60:63], v25 offset:14336
 v_mfma_f32_16x16x32_bf16 v[180:183], a[96:99], a[8:11], v[180:183]
 s_xor_b32 s0, s20, 0
 s_lshl_b32 s0, s0, 7
 s_add_u32 s0, s0, s22
 v_mfma_f32_16x16x32_bf16 v[184:187], a[96:99], a[16:19], v[184:187]
 s_lshl_b32 s19, s19, 16
 s_add_u32 s19, s19, s0
 s_lshl_b32 s17, s3, 16
 v_mfma_f32_16x16x32_bf16 v[184:187], a[100:103], a[20:23], v[184:187]
 s_add_u32 s17, s17, s0
 ds_read_b64 v[32:33], v13 offset:0
 v_mfma_f32_16x16x32_bf16 v[188:191], a[100:103], a[28:31], v[188:191]
 s_lshl2_add_u32 s61, s2, s3
 ds_read_b64 v[34:35], v13 offset:1280
 v_mfma_f32_16x16x32_bf16 v[188:191], a[96:99], a[24:27], v[188:191]
 s_add_u32 m0, s18, 35840
 ds_read_b64 v[36:37], v13 offset:2560
 v_mfma_f32_16x16x32_bf16 v[220:223], a[104:107], a[24:27], v[220:223]
 s_lshl_b32 s61, s61, 13
 buffer_load_dwordx4 v11, s[28:31], s15 offen lds
 v_mfma_f32_16x16x32_bf16 v[220:223], a[108:111], a[28:31], v[220:223]
 s_xor_b32 s65, s61, 131072
 ds_read_b64 v[38:39], v13 offset:3840
 v_mfma_f32_16x16x32_bf16 v[216:219], a[108:111], a[20:23], v[216:219]
 s_add_u32 s54, s61, 20971520
 ds_read_b64 v[40:41], v13 offset:5120
 v_mfma_f32_16x16x32_bf16 v[216:219], a[104:107], a[16:19], v[216:219]
 s_lshr_b32 s55, s65, 4
 ds_read_b64 v[42:43], v13 offset:6400
 v_mfma_f32_16x16x32_bf16 v[212:215], a[104:107], a[8:11], v[212:215]
 s_add_u32 s55, s55, 30408704
 ds_read_b64 v[44:45], v13 offset:7680
 v_mfma_f32_16x16x32_bf16 v[212:215], a[108:111], a[12:15], v[212:215]
 s_lshr_b32 s23, s61, 4
 ds_read_b64 v[46:47], v13 offset:8960
 v_mfma_f32_16x16x32_bf16 v[208:211], a[108:111], a[4:7], v[208:211]
 s_add_u32 s23, s23, 30408704
 s_add_u32 s61, s61, 20975616
 s_add_u32 s65, s65, 20975616
 v_mfma_f32_16x16x32_bf16 v[208:211], a[104:107], a[0:3], v[208:211]
 s_mov_b32 s68, 0x358637bd
 s_mov_b32 s56, 0x3fb8aa3b
 v_mfma_f32_16x16x32_bf16 v[240:243], a[112:115], a[0:3], v[240:243]
 s_add_u32 s15, s14, 524288
 v_mfma_f32_16x16x32_bf16 v[240:243], a[116:119], a[4:7], v[240:243]
 s_add_u32 m0, s18, 49152
 v_mfma_f32_16x16x32_bf16 v[244:247], a[116:119], a[12:15], v[244:247]
 buffer_load_dwordx4 v8, s[28:31], s15 offen lds
 v_mfma_f32_16x16x32_bf16 v[244:247], a[112:115], a[8:11], v[244:247]
 v_mfma_f32_16x16x32_bf16 v[248:251], a[112:115], a[16:19], v[248:251]
 v_mfma_f32_16x16x32_bf16 v[248:251], a[116:119], a[20:23], v[248:251]
 v_mfma_f32_16x16x32_bf16 v[252:255], a[116:119], a[28:31], v[252:255]
 s_waitcnt lgkmcnt(0)
 v_add_f32 v32, v32, v40
 v_add_f32 v33, v33, v41
 v_mfma_f32_16x16x32_bf16 v[252:255], a[112:115], a[24:27], v[252:255]
 v_add_f32 v34, v34, v42
 v_add_f32 v35, v35, v43
 v_mfma_f32_16x16x32_bf16 a[172:175], a[120:123], a[24:27], a[172:175]
 v_add_f32 v36, v36, v44
 v_add_f32 v37, v37, v45
 v_mfma_f32_16x16x32_bf16 a[172:175], a[124:127], a[28:31], a[172:175]
 v_add_f32 v38, v38, v46
 v_add_f32 v39, v39, v47
 v_mfma_f32_16x16x32_bf16 a[168:171], a[124:127], a[20:23], a[168:171]
 v_add_f32 v32, v32, v36
 v_add_f32 v33, v33, v37
 v_mfma_f32_16x16x32_bf16 a[168:171], a[120:123], a[16:19], a[168:171]
 s_add_u32 m0, s18, 50176
 v_add_f32 v34, v34, v38
 v_add_f32 v35, v35, v39
 v_mfma_f32_16x16x32_bf16 a[164:167], a[120:123], a[8:11], a[164:167]
 buffer_load_dwordx4 v9, s[28:31], s15 offen lds
 v_add_f32 v32, v32, v34
 v_mfma_f32_16x16x32_bf16 a[164:167], a[124:127], a[12:15], a[164:167]
 v_add_f32 v33, v33, v35
 v_mfma_f32_16x16x32_bf16 a[160:163], a[124:127], a[4:7], a[160:163]
 v_mfma_f32_16x16x32_bf16 a[160:163], a[120:123], a[0:3], a[160:163]
 s_waitcnt lgkmcnt(0)
 v_mfma_f32_16x16x32_bf16 a[192:195], a[128:131], a[0:3], a[192:195]
 v_mfma_f32_16x16x32_bf16 a[192:195], a[132:135], a[4:7], a[192:195]
 ds_write_b64 v12, v[32:33]
 v_mfma_f32_16x16x32_bf16 a[196:199], a[132:135], a[12:15], a[196:199]
 v_and_b32 v44, 15, v2
 v_lshrrev_b32 v45, 4, v2
 v_mfma_f32_16x16x32_bf16 a[196:199], a[128:131], a[8:11], a[196:199]
 v_lshlrev_b32 v4, 11, v44
 v_add_u32 v44, s7, v44
 v_mfma_f32_16x16x32_bf16 a[200:203], a[128:131], a[16:19], a[200:203]
 v_lshlrev_b32 v44, 4, v44
 v_add_u32 v44, 157696, v44
 v_mfma_f32_16x16x32_bf16 a[200:203], a[132:135], a[20:23], a[200:203]
 s_add_u32 m0, s18, 51200
 v_lshl_add_u32 v4, v45, 4, v4
 v_lshl_add_u32 v45, v45, 4, s64
 v_mfma_f32_16x16x32_bf16 a[204:207], a[132:135], a[28:31], a[204:207]
 buffer_load_dwordx4 v10, s[28:31], s15 offen lds
 v_add_u32 v5, 32768, v4
 v_mfma_f32_16x16x32_bf16 a[204:207], a[128:131], a[24:27], a[204:207]
 v_bfe_u32 v46, v2, 1, 3
 v_bfe_u32 v47, v2, 4, 1
 v_mfma_f32_16x16x32_bf16 a[236:239], a[136:139], a[24:27], a[236:239]
 v_lshl_or_b32 v46, v46, 4, v47
 v_and_b32 v47, 1, v2
 v_mfma_f32_16x16x32_bf16 a[236:239], a[140:143], a[28:31], a[236:239]
 v_lshl_or_b32 v46, v46, 2, v47
 v_lshlrev_b32 v46, 10, v46
 v_mfma_f32_16x16x32_bf16 a[232:235], a[140:143], a[20:23], a[232:235]
 v_mov_b32 v3, 1
 v_lshrrev_b32 v7, 2, v2
 v_mfma_f32_16x16x32_bf16 a[232:235], a[136:139], a[16:19], a[232:235]
 v_lshlrev_b32 v7, 7, v7
 v_and_b32 v6, 3, v2
 v_mfma_f32_16x16x32_bf16 a[228:231], a[136:139], a[8:11], a[228:231]
 v_lshl_add_u32 v7, v6, 3, v7
 v_bfe_u32 v6, v2, 3, 2
 v_mfma_f32_16x16x32_bf16 a[228:231], a[140:143], a[12:15], a[228:231]
 v_lshl_add_u32 v7, v6, 5, v7
 v_mfma_f32_16x16x32_bf16 a[224:227], a[140:143], a[4:7], a[224:227]
 v_mfma_f32_16x16x32_bf16 a[224:227], a[136:139], a[0:3], a[224:227]
 v_mfma_f32_16x16x32_bf16 v[64:67], a[64:67], a[32:35], v[64:67]
 s_waitcnt vmcnt(11) lgkmcnt(0)
 s_barrier
 v_mfma_f32_16x16x32_bf16 v[64:67], a[68:71], a[36:39], v[64:67]
 ds_read_b128 v[12:15], v45 offset:0
 v_mfma_f32_16x16x32_bf16 v[68:71], a[68:71], a[44:47], v[68:71]
 ds_read_b128 v[16:19], v45 offset:64
 v_mfma_f32_16x16x32_bf16 v[68:71], a[64:67], a[40:43], v[68:71]
 s_add_u32 m0, s18, 52224
 ds_read_b128 v[20:23], v45 offset:128
 v_mfma_f32_16x16x32_bf16 v[72:75], a[64:67], a[48:51], v[72:75]
 buffer_load_dwordx4 v11, s[28:31], s15 offen lds
 ds_read_b128 v[24:27], v45 offset:192
 v_mfma_f32_16x16x32_bf16 v[72:75], a[68:71], a[52:55], v[72:75]
 ds_read_b128 v[28:31], v44 offset:0
 v_mfma_f32_16x16x32_bf16 v[76:79], a[68:71], a[60:63], v[76:79]
 ds_read_b128 v[32:35], v44 offset:256
 v_mfma_f32_16x16x32_bf16 v[76:79], a[64:67], a[56:59], v[76:79]
 buffer_load_dwordx4 a[0:3], v4, s[8:11], s19 offen offset:0
 v_mfma_f32_16x16x32_bf16 v[108:111], a[72:75], a[56:59], v[108:111]
 v_mfma_f32_16x16x32_bf16 v[108:111], a[76:79], a[60:63], v[108:111]
 buffer_load_dwordx4 a[4:7], v4, s[8:11], s19 offen offset:64
 v_mfma_f32_16x16x32_bf16 v[104:107], a[76:79], a[52:55], v[104:107]
 v_mfma_f32_16x16x32_bf16 v[104:107], a[72:75], a[48:51], v[104:107]
 buffer_load_dwordx4 a[8:11], v5, s[8:11], s19 offen offset:0
 v_mfma_f32_16x16x32_bf16 v[100:103], a[72:75], a[40:43], v[100:103]
 v_mfma_f32_16x16x32_bf16 v[100:103], a[76:79], a[44:47], v[100:103]
 buffer_load_dwordx4 a[12:15], v5, s[8:11], s19 offen offset:64
 v_mfma_f32_16x16x32_bf16 v[96:99], a[76:79], a[36:39], v[96:99]
 s_add_u32 s15, s17, 0
 s_waitcnt lgkmcnt(0)
 v_fmac_f32 v48, v12, v28
 v_fmac_f32 v49, v13, v28
 v_fmac_f32 v50, v14, v28
 v_mfma_f32_16x16x32_bf16 v[96:99], a[72:75], a[32:35], v[96:99]
 s_add_u32 m0, s18, 81920
 v_fmac_f32 v51, v15, v28
 v_fmac_f32 v112, v20, v28
 v_fmac_f32 v113, v21, v28
 v_fmac_f32 v114, v22, v28
 v_mfma_f32_16x16x32_bf16 v[128:131], a[80:83], a[32:35], v[128:131]
 buffer_load_dwordx4 v8, s[32:35], s15 offen lds
 v_fmac_f32 v115, v23, v28
 v_mul_f32 v36, v48, v48
 v_mfma_f32_16x16x32_bf16 v[128:131], a[84:87], a[36:39], v[128:131]
 v_mul_f32 v37, v49, v49
 v_mul_f32 v38, v50, v50
 v_mul_f32 v39, v51, v51
 v_mfma_f32_16x16x32_bf16 v[132:135], a[84:87], a[44:47], v[132:135]
 v_mul_f32 v40, v112, v112
 v_mul_f32 v41, v113, v113
 v_mul_f32 v42, v114, v114
 v_mfma_f32_16x16x32_bf16 v[132:135], a[80:83], a[40:43], v[132:135]
 v_mul_f32 v43, v115, v115
 v_fma_f32 v36, v36, v30, v29
 v_fma_f32 v37, v37, v30, v29
 v_fma_f32 v38, v38, v30, v29
 v_mfma_f32_16x16x32_bf16 v[136:139], a[80:83], a[48:51], v[136:139]
 v_fma_f32 v39, v39, v30, v29
 v_fma_f32 v40, v40, v30, v29
 v_fma_f32 v41, v41, v30, v29
 v_mfma_f32_16x16x32_bf16 v[136:139], a[84:87], a[52:55], v[136:139]
 v_fma_f32 v42, v42, v30, v29
 v_fma_f32 v43, v43, v30, v29
 v_mul_f32 v36, v36, v48
 v_mfma_f32_16x16x32_bf16 v[140:143], a[84:87], a[60:63], v[140:143]
 v_mul_f32 v37, v37, v49
 v_mul_f32 v38, v38, v50
 v_mul_f32 v39, v39, v51
 v_mfma_f32_16x16x32_bf16 v[140:143], a[80:83], a[56:59], v[140:143]
 s_add_u32 m0, s18, 82944
 v_mul_f32 v40, v40, v112
 v_mul_f32 v41, v41, v113
 v_mul_f32 v42, v42, v114
 v_mul_f32 v43, v43, v115
 v_mfma_f32_16x16x32_bf16 v[172:175], a[88:91], a[56:59], v[172:175]
 buffer_load_dwordx4 v9, s[32:35], s15 offen lds
 v_exp_f32 v36, v36
 v_mfma_f32_16x16x32_bf16 v[172:175], a[92:95], a[60:63], v[172:175]
 v_exp_f32 v37, v37
 v_exp_f32 v38, v38
 v_mfma_f32_16x16x32_bf16 v[168:171], a[92:95], a[52:55], v[168:171]
 v_exp_f32 v39, v39
 v_mfma_f32_16x16x32_bf16 v[168:171], a[88:91], a[48:51], v[168:171]
 v_exp_f32 v40, v40
 v_exp_f32 v41, v41
 v_mfma_f32_16x16x32_bf16 v[164:167], a[88:91], a[40:43], v[164:167]
 v_exp_f32 v42, v42
 v_mfma_f32_16x16x32_bf16 v[164:167], a[92:95], a[44:47], v[164:167]
 v_exp_f32 v43, v43
 v_fmac_f32 v80, v16, v28
 v_fmac_f32 v81, v17, v28
 v_mfma_f32_16x16x32_bf16 v[160:163], a[92:95], a[36:39], v[160:163]
 v_fmac_f32 v82, v18, v28
 v_fmac_f32 v83, v19, v28
 v_fmac_f32 v144, v24, v28
 v_mfma_f32_16x16x32_bf16 v[160:163], a[88:91], a[32:35], v[160:163]
 s_add_u32 m0, s18, 83968
 v_fmac_f32 v145, v25, v28
 v_fmac_f32 v146, v26, v28
 v_fmac_f32 v147, v27, v28
 v_fma_f32 v36, v36, v31, v31
 v_mfma_f32_16x16x32_bf16 v[192:195], a[96:99], a[32:35], v[192:195]
 buffer_load_dwordx4 v10, s[32:35], s15 offen lds
 v_fma_f32 v37, v37, v31, v31
 v_fma_f32 v38, v38, v31, v31
 v_mfma_f32_16x16x32_bf16 v[192:195], a[100:103], a[36:39], v[192:195]
 v_fma_f32 v39, v39, v31, v31
 v_fma_f32 v40, v40, v31, v31
 v_fma_f32 v41, v41, v31, v31
 v_mfma_f32_16x16x32_bf16 v[196:199], a[100:103], a[44:47], v[196:199]
 v_fma_f32 v42, v42, v31, v31
 v_fma_f32 v43, v43, v31, v31
 v_rcp_f32 v36, v36
 v_mfma_f32_16x16x32_bf16 v[196:199], a[96:99], a[40:43], v[196:199]
 v_rcp_f32 v37, v37
 v_mfma_f32_16x16x32_bf16 v[200:203], a[96:99], a[48:51], v[200:203]
 v_rcp_f32 v38, v38
 v_rcp_f32 v39, v39
 v_mfma_f32_16x16x32_bf16 v[200:203], a[100:103], a[52:55], v[200:203]
 v_rcp_f32 v40, v40
 v_rcp_f32 v41, v41
 v_mfma_f32_16x16x32_bf16 v[204:207], a[100:103], a[60:63], v[204:207]
 v_rcp_f32 v42, v42
 v_mfma_f32_16x16x32_bf16 v[204:207], a[96:99], a[56:59], v[204:207]
 s_add_u32 m0, s18, 84992
 v_rcp_f32 v43, v43
 v_mul_f32 v80, v80, v48
 v_mul_f32 v81, v81, v49
 v_mfma_f32_16x16x32_bf16 v[236:239], a[104:107], a[56:59], v[236:239]
 buffer_load_dwordx4 v11, s[32:35], s15 offen lds
 v_mul_f32 v82, v82, v50
 v_mul_f32 v83, v83, v51
 v_mfma_f32_16x16x32_bf16 v[236:239], a[108:111], a[60:63], v[236:239]
 v_mul_f32 v144, v144, v112
 v_mul_f32 v145, v145, v113
 v_mul_f32 v146, v146, v114
 v_mfma_f32_16x16x32_bf16 v[232:235], a[108:111], a[52:55], v[232:235]
 v_mul_f32 v147, v147, v115
 v_mul_f32 v80, v80, v36
 v_mul_f32 v81, v81, v37
 v_mfma_f32_16x16x32_bf16 v[232:235], a[104:107], a[48:51], v[232:235]
 v_mul_f32 v82, v82, v38
 v_mul_f32 v83, v83, v39
 v_mul_f32 v144, v144, v40
 v_mul_f32 v145, v145, v41
 v_mfma_f32_16x16x32_bf16 v[228:231], a[104:107], a[40:43], v[228:231]
 v_mul_f32 v146, v146, v42
 v_mul_f32 v147, v147, v43
 v_cvt_pk_bf16_f32 v48, v80, v81
 v_mfma_f32_16x16x32_bf16 v[228:231], a[108:111], a[44:47], v[228:231]
 v_cvt_pk_bf16_f32 v49, v82, v83
 v_cvt_pk_bf16_f32 v50, v144, v145
 v_cvt_pk_bf16_f32 v51, v146, v147
 v_mfma_f32_16x16x32_bf16 v[224:227], a[108:111], a[36:39], v[224:227]
 s_add_u32 s15, s17, 262144
 buffer_store_dwordx4 v[48:51], v1, s[24:27], s40 offen sc1
 v_fmac_f32 v52, v12, v32
 v_fmac_f32 v53, v13, v32
 v_mfma_f32_16x16x32_bf16 v[224:227], a[104:107], a[32:35], v[224:227]
 s_add_u32 m0, s18, 98304
 ds_read_b128 v[28:31], v44 offset:512
 v_fmac_f32 v54, v14, v32
 v_fmac_f32 v55, v15, v32
 v_fmac_f32 v116, v20, v32
 v_mfma_f32_16x16x32_bf16 a[144:147], a[112:115], a[32:35], a[144:147]
 buffer_load_dwordx4 v8, s[32:35], s15 offen lds
 v_fmac_f32 v117, v21, v32
 v_fmac_f32 v118, v22, v32
 v_fmac_f32 v119, v23, v32
 v_mfma_f32_16x16x32_bf16 a[144:147], a[116:119], a[36:39], a[144:147]
 v_mul_f32 v36, v52, v52
 v_mul_f32 v37, v53, v53
 v_mul_f32 v38, v54, v54
 v_mfma_f32_16x16x32_bf16 a[148:151], a[116:119], a[44:47], a[148:151]
 v_mul_f32 v39, v55, v55
 v_mul_f32 v40, v116, v116
 v_mul_f32 v41, v117, v117
 v_mfma_f32_16x16x32_bf16 a[148:151], a[112:115], a[40:43], a[148:151]
 v_mul_f32 v42, v118, v118
 v_mul_f32 v43, v119, v119
 v_fma_f32 v36, v36, v34, v33
 v_mfma_f32_16x16x32_bf16 a[152:155], a[112:115], a[48:51], a[152:155]
 v_fma_f32 v37, v37, v34, v33
 v_fma_f32 v38, v38, v34, v33
 v_fma_f32 v39, v39, v34, v33
 v_mfma_f32_16x16x32_bf16 a[152:155], a[116:119], a[52:55], a[152:155]
 v_fma_f32 v40, v40, v34, v33
 v_fma_f32 v41, v41, v34, v33
 v_fma_f32 v42, v42, v34, v33
 v_mfma_f32_16x16x32_bf16 a[156:159], a[116:119], a[60:63], a[156:159]
 v_fma_f32 v43, v43, v34, v33
 v_mul_f32 v36, v36, v52
 v_mul_f32 v37, v37, v53
 v_mul_f32 v38, v38, v54
 v_mfma_f32_16x16x32_bf16 a[156:159], a[112:115], a[56:59], a[156:159]
 s_add_u32 m0, s18, 99328
 v_mul_f32 v39, v39, v55
 v_mul_f32 v40, v40, v116
 v_mul_f32 v41, v41, v117
 v_mfma_f32_16x16x32_bf16 a[188:191], a[120:123], a[56:59], a[188:191]
 buffer_load_dwordx4 v9, s[32:35], s15 offen lds
 v_mul_f32 v42, v42, v118
 v_mul_f32 v43, v43, v119
 v_mfma_f32_16x16x32_bf16 a[188:191], a[124:127], a[60:63], a[188:191]
 v_exp_f32 v36, v36
 v_exp_f32 v37, v37
 v_mfma_f32_16x16x32_bf16 a[184:187], a[124:127], a[52:55], a[184:187]
 v_exp_f32 v38, v38
 v_mfma_f32_16x16x32_bf16 a[184:187], a[120:123], a[48:51], a[184:187]
 v_exp_f32 v39, v39
 v_exp_f32 v40, v40
 v_mfma_f32_16x16x32_bf16 a[180:183], a[120:123], a[40:43], a[180:183]
 v_exp_f32 v41, v41
 v_mfma_f32_16x16x32_bf16 a[180:183], a[124:127], a[44:47], a[180:183]
 v_exp_f32 v42, v42
 v_exp_f32 v43, v43
 v_mfma_f32_16x16x32_bf16 a[176:179], a[124:127], a[36:39], a[176:179]
 v_fmac_f32 v84, v16, v32
 v_fmac_f32 v85, v17, v32
 v_fmac_f32 v86, v18, v32
 v_mfma_f32_16x16x32_bf16 a[176:179], a[120:123], a[32:35], a[176:179]
 s_add_u32 m0, s18, 100352
 v_fmac_f32 v87, v19, v32
 v_fmac_f32 v148, v24, v32
 v_fmac_f32 v149, v25, v32
 v_mfma_f32_16x16x32_bf16 a[208:211], a[128:131], a[32:35], a[208:211]
 buffer_load_dwordx4 v10, s[32:35], s15 offen lds
 v_fmac_f32 v150, v26, v32
 v_fmac_f32 v151, v27, v32
 v_mfma_f32_16x16x32_bf16 a[208:211], a[132:135], a[36:39], a[208:211]
 v_fma_f32 v36, v36, v35, v35
 v_fma_f32 v37, v37, v35, v35
 v_fma_f32 v38, v38, v35, v35
 v_fma_f32 v39, v39, v35, v35
 v_mfma_f32_16x16x32_bf16 a[212:215], a[132:135], a[44:47], a[212:215]
 v_fma_f32 v40, v40, v35, v35
 v_fma_f32 v41, v41, v35, v35
 v_fma_f32 v42, v42, v35, v35
 v_mfma_f32_16x16x32_bf16 a[212:215], a[128:131], a[40:43], a[212:215]
 v_fma_f32 v43, v43, v35, v35
 v_rcp_f32 v36, v36
 v_mfma_f32_16x16x32_bf16 a[216:219], a[128:131], a[48:51], a[216:219]
 v_rcp_f32 v37, v37
 v_rcp_f32 v38, v38
 v_mfma_f32_16x16x32_bf16 a[216:219], a[132:135], a[52:55], a[216:219]
 v_rcp_f32 v39, v39
 v_mfma_f32_16x16x32_bf16 a[220:223], a[132:135], a[60:63], a[220:223]
 v_rcp_f32 v40, v40
 v_rcp_f32 v41, v41
 v_mfma_f32_16x16x32_bf16 a[220:223], a[128:131], a[56:59], a[220:223]
 s_add_u32 m0, s18, 101376
 v_rcp_f32 v42, v42
 v_mfma_f32_16x16x32_bf16 a[252:255], a[136:139], a[56:59], a[252:255]
 buffer_load_dwordx4 v11, s[32:35], s15 offen lds
 v_rcp_f32 v43, v43
 v_mul_f32 v84, v84, v52
 v_mfma_f32_16x16x32_bf16 a[252:255], a[140:143], a[60:63], a[252:255]
 v_mul_f32 v85, v85, v53
 v_mul_f32 v86, v86, v54
 v_mul_f32 v87, v87, v55
 v_mfma_f32_16x16x32_bf16 a[248:251], a[140:143], a[52:55], a[248:251]
 v_mul_f32 v148, v148, v116
 v_mul_f32 v149, v149, v117
 v_mul_f32 v150, v150, v118
 v_mfma_f32_16x16x32_bf16 a[248:251], a[136:139], a[48:51], a[248:251]
 v_mul_f32 v151, v151, v119
 v_mul_f32 v84, v84, v36
 v_mul_f32 v85, v85, v37
 v_mfma_f32_16x16x32_bf16 a[244:247], a[136:139], a[40:43], a[244:247]
 v_mul_f32 v86, v86, v38
 v_mul_f32 v87, v87, v39
 v_mul_f32 v148, v148, v40
 v_mul_f32 v149, v149, v41
 v_mfma_f32_16x16x32_bf16 a[244:247], a[140:143], a[44:47], a[244:247]
 v_mul_f32 v150, v150, v42
 v_mul_f32 v151, v151, v43
 v_cvt_pk_bf16_f32 v52, v84, v85
 v_mfma_f32_16x16x32_bf16 a[240:243], a[140:143], a[36:39], a[240:243]
 v_cvt_pk_bf16_f32 v53, v86, v87
 v_cvt_pk_bf16_f32 v54, v148, v149
 v_cvt_pk_bf16_f32 v55, v150, v151
 v_mfma_f32_16x16x32_bf16 a[240:243], a[136:139], a[32:35], a[240:243]
 buffer_store_dwordx4 v[52:55], v1, s[24:27], s40 offen offset:1024 sc1
 s_waitcnt lgkmcnt(0)
 s_nop 0
 ds_read_b128 v[32:35], v44 offset:768
 v_pk_fma_f32 v[56:57], v[12:13], v[28:29], v[56:57] op_sel_hi:[1,0,1]
 v_pk_fma_f32 v[58:59], v[14:15], v[28:29], v[58:59] op_sel_hi:[1,0,1]
 v_pk_fma_f32 v[120:121], v[20:21], v[28:29], v[120:121] op_sel_hi:[1,0,1]
 v_pk_fma_f32 v[122:123], v[22:23], v[28:29], v[122:123] op_sel_hi:[1,0,1]
 v_pk_mul_f32 v[36:37], v[56:57], v[56:57]
 v_pk_mul_f32 v[38:39], v[58:59], v[58:59]
 v_pk_mul_f32 v[40:41], v[120:121], v[120:121]
 v_pk_mul_f32 v[42:43], v[122:123], v[122:123]
 v_pk_fma_f32 v[36:37], v[36:37], v[30:31], v[28:29] op_sel:[0,0,1] op_sel_hi:[1,0,1]
 v_pk_fma_f32 v[38:39], v[38:39], v[30:31], v[28:29] op_sel:[0,0,1] op_sel_hi:[1,0,1]
 v_pk_fma_f32 v[40:41], v[40:41], v[30:31], v[28:29] op_sel:[0,0,1] op_sel_hi:[1,0,1]
 v_pk_fma_f32 v[42:43], v[42:43], v[30:31], v[28:29] op_sel:[0,0,1] op_sel_hi:[1,0,1]
 v_pk_mul_f32 v[36:37], v[36:37], v[56:57]
 v_pk_mul_f32 v[38:39], v[38:39], v[58:59]
 v_pk_mul_f32 v[40:41], v[40:41], v[120:121]
 v_pk_mul_f32 v[42:43], v[42:43], v[122:123]
 v_exp_f32 v36, v36
 v_exp_f32 v37, v37
 s_add_u32 s15, s17, 524288
 s_add_u32 m0, s18, 114688
 s_nop 0
 buffer_load_dwordx4 v8, s[32:35], s15 offen lds
 v_exp_f32 v38, v38
 v_exp_f32 v39, v39
 v_exp_f32 v40, v40
 v_exp_f32 v41, v41
 v_exp_f32 v42, v42
 v_exp_f32_e64 v43, v43
 v_pk_fma_f32 v[88:89], v[16:17], v[28:29], v[88:89] op_sel_hi:[1,0,1]
 v_pk_fma_f32 v[90:91], v[18:19], v[28:29], v[90:91] op_sel_hi:[1,0,1]
 v_pk_fma_f32 v[152:153], v[24:25], v[28:29], v[152:153] op_sel_hi:[1,0,1]
 v_pk_fma_f32 v[154:155], v[26:27], v[28:29], v[154:155] op_sel_hi:[1,0,1]
 v_pk_fma_f32 v[36:37], v[36:37], v[30:31], v[30:31] op_sel:[0,1,1] op_sel_hi:[1,1,1]
 v_pk_fma_f32 v[38:39], v[38:39], v[30:31], v[30:31] op_sel:[0,1,1] op_sel_hi:[1,1,1]
 v_pk_fma_f32 v[40:41], v[40:41], v[30:31], v[30:31] op_sel:[0,1,1] op_sel_hi:[1,1,1]
 v_pk_fma_f32 v[42:43], v[42:43], v[30:31], v[30:31] op_sel:[0,1,1] op_sel_hi:[1,1,1]
 v_rcp_f32 v36, v36
 v_rcp_f32 v37, v37
 s_add_u32 m0, s18, 115712
 s_nop 0
 buffer_load_dwordx4 v9, s[32:35], s15 offen lds
 v_rcp_f32 v38, v38
 v_rcp_f32 v39, v39
 v_rcp_f32 v40, v40
 v_rcp_f32 v41, v41
 v_rcp_f32 v42, v42
 v_rcp_f32_e64 v43, v43
 v_pk_mul_f32 v[88:89], v[88:89], v[56:57]
 v_pk_mul_f32 v[90:91], v[90:91], v[58:59]
 v_pk_mul_f32 v[152:153], v[152:153], v[120:121]
 s_branch L_tp_L_tB_7_o
L_tp_L_tB_7:
 s_nop 0
 s_branch L_tr10
 s_nop 0
L_tp_L_tB_7_o:
 v_pk_mul_f32 v[154:155], v[154:155], v[122:123]
 v_pk_mul_f32 v[88:89], v[88:89], v[36:37]
 v_pk_mul_f32 v[90:91], v[90:91], v[38:39]
 v_pk_mul_f32 v[152:153], v[152:153], v[40:41]
 v_pk_mul_f32 v[154:155], v[154:155], v[42:43]
 v_cvt_pk_bf16_f32 v56, v88, v89
 v_cvt_pk_bf16_f32 v57, v90, v91
 v_cvt_pk_bf16_f32 v58, v152, v153
 v_cvt_pk_bf16_f32 v59, v154, v155
 buffer_store_dwordx4 v[56:59], v1, s[24:27], s41 offen sc1
 v_xor_b32 v6, 0, v7
 s_waitcnt lgkmcnt(0)
 ds_read_b128 v[28:31], v44 offset:1024
 ds_read_b64_tr_b16 a[16:17], v6 offset:0
 ds_read_b64_tr_b16 a[18:19], v6 offset:2048
 ds_read_b64_tr_b16 a[48:49], v6 offset:8192
 ds_read_b64_tr_b16 a[50:51], v6 offset:10240
 ds_read_b64_tr_b16 a[32:33], v6 offset:4096
 ds_read_b64_tr_b16 a[34:35], v6 offset:6144
 ds_read_b64_tr_b16 a[64:65], v6 offset:12288
 ds_read_b64_tr_b16 a[66:67], v6 offset:14336
 v_pk_fma_f32 v[60:61], v[12:13], v[32:33], v[60:61] op_sel_hi:[1,0,1]
 v_pk_fma_f32 v[62:63], v[14:15], v[32:33], v[62:63] op_sel_hi:[1,0,1]
 v_pk_fma_f32 v[124:125], v[20:21], v[32:33], v[124:125] op_sel_hi:[1,0,1]
 v_pk_fma_f32 v[126:127], v[22:23], v[32:33], v[126:127] op_sel_hi:[1,0,1]
 v_pk_mul_f32 v[36:37], v[60:61], v[60:61]
 v_pk_mul_f32 v[38:39], v[62:63], v[62:63]
 v_pk_mul_f32 v[40:41], v[124:125], v[124:125]
 v_pk_mul_f32 v[42:43], v[126:127], v[126:127]
 v_pk_fma_f32 v[36:37], v[36:37], v[34:35], v[32:33] op_sel:[0,0,1] op_sel_hi:[1,0,1]
 v_pk_fma_f32 v[38:39], v[38:39], v[34:35], v[32:33] op_sel:[0,0,1] op_sel_hi:[1,0,1]
 v_pk_fma_f32 v[40:41], v[40:41], v[34:35], v[32:33] op_sel:[0,0,1] op_sel_hi:[1,0,1]
 v_pk_fma_f32 v[42:43], v[42:43], v[34:35], v[32:33] op_sel:[0,0,1] op_sel_hi:[1,0,1]
 v_pk_mul_f32 v[36:37], v[36:37], v[60:61]
 v_pk_mul_f32 v[38:39], v[38:39], v[62:63]
 v_pk_mul_f32 v[40:41], v[40:41], v[124:125]
 v_pk_mul_f32 v[42:43], v[42:43], v[126:127]
 v_exp_f32 v36, v36
 v_exp_f32 v37, v37
 s_add_u32 m0, s18, 116736
 s_nop 0
 buffer_load_dwordx4 v10, s[32:35], s15 offen lds
 v_exp_f32 v38, v38
 v_exp_f32 v39, v39
 v_exp_f32 v40, v40
 v_exp_f32 v41, v41
 v_exp_f32 v42, v42
 v_exp_f32_e64 v43, v43
 v_pk_fma_f32 v[92:93], v[16:17], v[32:33], v[92:93] op_sel_hi:[1,0,1]
 v_pk_fma_f32 v[94:95], v[18:19], v[32:33], v[94:95] op_sel_hi:[1,0,1]
 v_pk_fma_f32 v[156:157], v[24:25], v[32:33], v[156:157] op_sel_hi:[1,0,1]
 v_pk_fma_f32 v[158:159], v[26:27], v[32:33], v[158:159] op_sel_hi:[1,0,1]
 v_pk_fma_f32 v[36:37], v[36:37], v[34:35], v[34:35] op_sel:[0,1,1] op_sel_hi:[1,1,1]
 v_pk_fma_f32 v[38:39], v[38:39], v[34:35], v[34:35] op_sel:[0,1,1] op_sel_hi:[1,1,1]
 v_pk_fma_f32 v[40:41], v[40:41], v[34:35], v[34:35] op_sel:[0,1,1] op_sel_hi:[1,1,1]
 v_pk_fma_f32 v[42:43], v[42:43], v[34:35], v[34:35] op_sel:[0,1,1] op_sel_hi:[1,1,1]
 v_rcp_f32 v36, v36
 v_rcp_f32 v37, v37
 s_add_u32 m0, s18, 117760
 s_nop 0
 buffer_load_dwordx4 v11, s[32:35], s15 offen lds
 v_rcp_f32 v38, v38
 v_rcp_f32 v39, v39
 v_rcp_f32 v40, v40
 v_rcp_f32 v41, v41
 v_rcp_f32 v42, v42
 v_rcp_f32_e64 v43, v43
 v_pk_mul_f32 v[92:93], v[92:93], v[60:61]
 v_pk_mul_f32 v[94:95], v[94:95], v[62:63]
 v_pk_mul_f32 v[156:157], v[156:157], v[124:125]
 v_pk_mul_f32 v[158:159], v[158:159], v[126:127]
 v_pk_mul_f32 v[92:93], v[92:93], v[36:37]
 v_pk_mul_f32 v[94:95], v[94:95], v[38:39]
 v_pk_mul_f32 v[156:157], v[156:157], v[40:41]
 v_pk_mul_f32 v[158:159], v[158:159], v[42:43]
 v_cvt_pk_bf16_f32 v60, v92, v93
 v_cvt_pk_bf16_f32 v61, v94, v95
 v_cvt_pk_bf16_f32 v62, v156, v157
 v_cvt_pk_bf16_f32 v63, v158, v159
 buffer_store_dwordx4 v[60:63], v1, s[24:27], s41 offen offset:1024 sc1
 v_xor_b32 v6, 32, v7
 s_waitcnt lgkmcnt(0)
 ds_read_b128 v[32:35], v44 offset:1280
 ds_read_b64_tr_b16 a[20:21], v6 offset:0
 ds_read_b64_tr_b16 a[22:23], v6 offset:2048
 ds_read_b64_tr_b16 a[52:53], v6 offset:8192
 ds_read_b64_tr_b16 a[54:55], v6 offset:10240
 ds_read_b64_tr_b16 a[36:37], v6 offset:4096
 ds_read_b64_tr_b16 a[38:39], v6 offset:6144
 ds_read_b64_tr_b16 a[68:69], v6 offset:12288
 ds_read_b64_tr_b16 a[70:71], v6 offset:14336
 v_pk_fma_f32 v[64:65], v[12:13], v[28:29], v[64:65] op_sel_hi:[1,0,1]
 v_pk_fma_f32 v[66:67], v[14:15], v[28:29], v[66:67] op_sel_hi:[1,0,1]
 v_pk_fma_f32 v[128:129], v[20:21], v[28:29], v[128:129] op_sel_hi:[1,0,1]
 v_pk_fma_f32 v[130:131], v[22:23], v[28:29], v[130:131] op_sel_hi:[1,0,1]
 v_pk_mul_f32 v[36:37], v[64:65], v[64:65]
 v_pk_mul_f32 v[38:39], v[66:67], v[66:67]
 v_pk_mul_f32 v[40:41], v[128:129], v[128:129]
 v_pk_mul_f32 v[42:43], v[130:131], v[130:131]
 v_pk_fma_f32 v[36:37], v[36:37], v[30:31], v[28:29] op_sel:[0,0,1] op_sel_hi:[1,0,1]
 v_pk_fma_f32 v[38:39], v[38:39], v[30:31], v[28:29] op_sel:[0,0,1] op_sel_hi:[1,0,1]
 v_pk_fma_f32 v[40:41], v[40:41], v[30:31], v[28:29] op_sel:[0,0,1] op_sel_hi:[1,0,1]
 v_pk_fma_f32 v[42:43], v[42:43], v[30:31], v[28:29] op_sel:[0,0,1] op_sel_hi:[1,0,1]
 v_pk_mul_f32 v[36:37], v[36:37], v[64:65]
 v_pk_mul_f32 v[38:39], v[38:39], v[66:67]
 v_pk_mul_f32 v[40:41], v[40:41], v[128:129]
 v_pk_mul_f32 v[42:43], v[42:43], v[130:131]
 v_exp_f32 v36, v36
 v_exp_f32 v37, v37
 s_add_u32 s15, s17, 786432
 s_add_u32 m0, s18, 131072
 s_nop 0
 buffer_load_dwordx4 v8, s[32:35], s15 offen lds
 v_exp_f32 v38, v38
 v_exp_f32 v39, v39
 v_exp_f32 v40, v40
 v_exp_f32 v41, v41
 v_exp_f32 v42, v42
 v_exp_f32_e64 v43, v43
 v_pk_fma_f32 v[96:97], v[16:17], v[28:29], v[96:97] op_sel_hi:[1,0,1]
 v_pk_fma_f32 v[98:99], v[18:19], v[28:29], v[98:99] op_sel_hi:[1,0,1]
 v_pk_fma_f32 v[160:161], v[24:25], v[28:29], v[160:161] op_sel_hi:[1,0,1]
 v_pk_fma_f32 v[162:163], v[26:27], v[28:29], v[162:163] op_sel_hi:[1,0,1]
 v_pk_fma_f32 v[36:37], v[36:37], v[30:31], v[30:31] op_sel:[0,1,1] op_sel_hi:[1,1,1]
 v_pk_fma_f32 v[38:39], v[38:39], v[30:31], v[30:31] op_sel:[0,1,1] op_sel_hi:[1,1,1]
 v_pk_fma_f32 v[40:41], v[40:41], v[30:31], v[30:31] op_sel:[0,1,1] op_sel_hi:[1,1,1]
 v_pk_fma_f32 v[42:43], v[42:43], v[30:31], v[30:31] op_sel:[0,1,1] op_sel_hi:[1,1,1]
 v_rcp_f32 v36, v36
 v_rcp_f32 v37, v37
 s_add_u32 m0, s18, 132096
 s_nop 0
 buffer_load_dwordx4 v9, s[32:35], s15 offen lds
 v_rcp_f32 v38, v38
 v_rcp_f32 v39, v39
 v_rcp_f32 v40, v40
 v_rcp_f32 v41, v41
 v_rcp_f32 v42, v42
 v_rcp_f32_e64 v43, v43
 v_pk_mul_f32 v[96:97], v[96:97], v[64:65]
 v_pk_mul_f32 v[98:99], v[98:99], v[66:67]
 v_pk_mul_f32 v[160:161], v[160:161], v[128:129]
 v_pk_mul_f32 v[162:163], v[162:163], v[130:131]
 v_pk_mul_f32 v[96:97], v[96:97], v[36:37]
 v_pk_mul_f32 v[98:99], v[98:99], v[38:39]
 v_pk_mul_f32 v[160:161], v[160:161], v[40:41]
 v_pk_mul_f32 v[162:163], v[162:163], v[42:43]
 v_cvt_pk_bf16_f32 v64, v96, v97
 v_cvt_pk_bf16_f32 v65, v98, v99
 v_cvt_pk_bf16_f32 v66, v160, v161
 v_cvt_pk_bf16_f32 v67, v162, v163
 buffer_store_dwordx4 v[64:67], v1, s[24:27], s42 offen sc1
 v_xor_b32 v6, 64, v7
 s_waitcnt lgkmcnt(0)
 ds_read_b128 v[28:31], v44 offset:1536
 ds_read_b64_tr_b16 a[24:25], v6 offset:0
 ds_read_b64_tr_b16 a[26:27], v6 offset:2048
 ds_read_b64_tr_b16 a[56:57], v6 offset:8192
 ds_read_b64_tr_b16 a[58:59], v6 offset:10240
 ds_read_b64_tr_b16 a[40:41], v6 offset:4096
 ds_read_b64_tr_b16 a[42:43], v6 offset:6144
 ds_read_b64_tr_b16 a[72:73], v6 offset:12288
 ds_read_b64_tr_b16 a[74:75], v6 offset:14336
 v_pk_fma_f32 v[68:69], v[12:13], v[32:33], v[68:69] op_sel_hi:[1,0,1]
 v_pk_fma_f32 v[70:71], v[14:15], v[32:33], v[70:71] op_sel_hi:[1,0,1]
 v_pk_fma_f32 v[132:133], v[20:21], v[32:33], v[132:133] op_sel_hi:[1,0,1]
 v_pk_fma_f32 v[134:135], v[22:23], v[32:33], v[134:135] op_sel_hi:[1,0,1]
 v_pk_mul_f32 v[36:37], v[68:69], v[68:69]
 v_pk_mul_f32 v[38:39], v[70:71], v[70:71]
 v_pk_mul_f32 v[40:41], v[132:133], v[132:133]
 v_pk_mul_f32 v[42:43], v[134:135], v[134:135]
 v_pk_fma_f32 v[36:37], v[36:37], v[34:35], v[32:33] op_sel:[0,0,1] op_sel_hi:[1,0,1]
 v_pk_fma_f32 v[38:39], v[38:39], v[34:35], v[32:33] op_sel:[0,0,1] op_sel_hi:[1,0,1]
 v_pk_fma_f32 v[40:41], v[40:41], v[34:35], v[32:33] op_sel:[0,0,1] op_sel_hi:[1,0,1]
 v_pk_fma_f32 v[42:43], v[42:43], v[34:35], v[32:33] op_sel:[0,0,1] op_sel_hi:[1,0,1]
 v_pk_mul_f32 v[36:37], v[36:37], v[68:69]
 v_pk_mul_f32 v[38:39], v[38:39], v[70:71]
 v_pk_mul_f32 v[40:41], v[40:41], v[132:133]
 v_pk_mul_f32 v[42:43], v[42:43], v[134:135]
 v_exp_f32 v36, v36
 v_exp_f32 v37, v37
 s_add_u32 m0, s18, 133120
 s_nop 0
 buffer_load_dwordx4 v10, s[32:35], s15 offen lds
 v_exp_f32 v38, v38
 v_exp_f32 v39, v39
 v_exp_f32 v40, v40
 v_exp_f32 v41, v41
 v_exp_f32 v42, v42
 v_exp_f32_e64 v43, v43
 v_pk_fma_f32 v[100:101], v[16:17], v[32:33], v[100:101] op_sel_hi:[1,0,1]
 v_pk_fma_f32 v[102:103], v[18:19], v[32:33], v[102:103] op_sel_hi:[1,0,1]
 v_pk_fma_f32 v[164:165], v[24:25], v[32:33], v[164:165] op_sel_hi:[1,0,1]
 v_pk_fma_f32 v[166:167], v[26:27], v[32:33], v[166:167] op_sel_hi:[1,0,1]
 v_pk_fma_f32 v[36:37], v[36:37], v[34:35], v[34:35] op_sel:[0,1,1] op_sel_hi:[1,1,1]
 v_pk_fma_f32 v[38:39], v[38:39], v[34:35], v[34:35] op_sel:[0,1,1] op_sel_hi:[1,1,1]
 v_pk_fma_f32 v[40:41], v[40:41], v[34:35], v[34:35] op_sel:[0,1,1] op_sel_hi:[1,1,1]
 v_pk_fma_f32 v[42:43], v[42:43], v[34:35], v[34:35] op_sel:[0,1,1] op_sel_hi:[1,1,1]
 v_rcp_f32 v36, v36
 v_rcp_f32 v37, v37
 s_add_u32 m0, s18, 134144
 s_nop 0
 buffer_load_dwordx4 v11, s[32:35], s15 offen lds
 v_rcp_f32 v38, v38
 v_rcp_f32 v39, v39
 v_rcp_f32 v40, v40
 v_rcp_f32 v41, v41
 v_rcp_f32 v42, v42
 v_rcp_f32_e64 v43, v43
 v_pk_mul_f32 v[100:101], v[100:101], v[68:69]
 v_pk_mul_f32 v[102:103], v[102:103], v[70:71]
 v_pk_mul_f32 v[164:165], v[164:165], v[132:133]
 v_pk_mul_f32 v[166:167], v[166:167], v[134:135]
 v_pk_mul_f32 v[100:101], v[100:101], v[36:37]
 v_pk_mul_f32 v[102:103], v[102:103], v[38:39]
 v_pk_mul_f32 v[164:165], v[164:165], v[40:41]
 v_pk_mul_f32 v[166:167], v[166:167], v[42:43]
 v_cvt_pk_bf16_f32 v68, v100, v101
 v_cvt_pk_bf16_f32 v69, v102, v103
 v_cvt_pk_bf16_f32 v70, v164, v165
 v_cvt_pk_bf16_f32 v71, v166, v167
 buffer_store_dwordx4 v[68:71], v1, s[24:27], s42 offen offset:1024 sc1
 v_xor_b32 v6, 96, v7
 s_waitcnt lgkmcnt(0)
 s_nop 0
 ds_read_b128 v[32:35], v44 offset:1792
 ds_read_b64_tr_b16 a[28:29], v6 offset:0
 ds_read_b64_tr_b16 a[30:31], v6 offset:2048
 ds_read_b64_tr_b16 a[60:61], v6 offset:8192
 ds_read_b64_tr_b16 a[62:63], v6 offset:10240
 ds_read_b64_tr_b16 a[44:45], v6 offset:4096
 ds_read_b64_tr_b16 a[46:47], v6 offset:6144
 ds_read_b64_tr_b16 a[76:77], v6 offset:12288
 ds_read_b64_tr_b16 a[78:79], v6 offset:14336
 v_pk_fma_f32 v[72:73], v[12:13], v[28:29], v[72:73] op_sel_hi:[1,0,1]
 v_pk_fma_f32 v[74:75], v[14:15], v[28:29], v[74:75] op_sel_hi:[1,0,1]
 v_pk_fma_f32 v[136:137], v[20:21], v[28:29], v[136:137] op_sel_hi:[1,0,1]
 v_pk_fma_f32 v[138:139], v[22:23], v[28:29], v[138:139] op_sel_hi:[1,0,1]
 v_pk_mul_f32 v[36:37], v[72:73], v[72:73]
 v_pk_mul_f32 v[38:39], v[74:75], v[74:75]
 v_pk_mul_f32 v[40:41], v[136:137], v[136:137]
 v_pk_mul_f32 v[42:43], v[138:139], v[138:139]
 v_pk_fma_f32 v[36:37], v[36:37], v[30:31], v[28:29] op_sel:[0,0,1] op_sel_hi:[1,0,1]
 v_pk_fma_f32 v[38:39], v[38:39], v[30:31], v[28:29] op_sel:[0,0,1] op_sel_hi:[1,0,1]
 v_pk_fma_f32 v[40:41], v[40:41], v[30:31], v[28:29] op_sel:[0,0,1] op_sel_hi:[1,0,1]
 v_pk_fma_f32 v[42:43], v[42:43], v[30:31], v[28:29] op_sel:[0,0,1] op_sel_hi:[1,0,1]
 v_pk_mul_f32 v[36:37], v[36:37], v[72:73]
 v_pk_mul_f32 v[38:39], v[38:39], v[74:75]
 v_pk_mul_f32 v[40:41], v[40:41], v[136:137]
 v_pk_mul_f32 v[42:43], v[42:43], v[138:139]
 v_exp_f32 v36, v36
 v_exp_f32 v37, v37
 v_exp_f32 v38, v38
 v_exp_f32 v39, v39
 v_exp_f32 v40, v40
 v_exp_f32 v41, v41
 v_exp_f32 v42, v42
 v_exp_f32 v43, v43
 v_pk_fma_f32 v[104:105], v[16:17], v[28:29], v[104:105] op_sel_hi:[1,0,1]
 v_pk_fma_f32 v[106:107], v[18:19], v[28:29], v[106:107] op_sel_hi:[1,0,1]
 v_pk_fma_f32 v[168:169], v[24:25], v[28:29], v[168:169] op_sel_hi:[1,0,1]
 v_pk_fma_f32 v[170:171], v[26:27], v[28:29], v[170:171] op_sel_hi:[1,0,1]
 v_pk_fma_f32 v[36:37], v[36:37], v[30:31], v[30:31] op_sel:[0,1,1] op_sel_hi:[1,1,1]
 v_pk_fma_f32 v[38:39], v[38:39], v[30:31], v[30:31] op_sel:[0,1,1] op_sel_hi:[1,1,1]
 v_pk_fma_f32 v[40:41], v[40:41], v[30:31], v[30:31] op_sel:[0,1,1] op_sel_hi:[1,1,1]
 v_pk_fma_f32 v[42:43], v[42:43], v[30:31], v[30:31] op_sel:[0,1,1] op_sel_hi:[1,1,1]
 v_rcp_f32 v36, v36
 v_rcp_f32 v37, v37
 v_rcp_f32 v38, v38
 v_rcp_f32 v39, v39
 v_rcp_f32 v40, v40
 v_rcp_f32 v41, v41
 v_rcp_f32 v42, v42
 v_rcp_f32 v43, v43
 v_pk_mul_f32 v[104:105], v[104:105], v[72:73]
 v_pk_mul_f32 v[106:107], v[106:107], v[74:75]
 v_pk_mul_f32 v[168:169], v[168:169], v[136:137]
 v_pk_mul_f32 v[170:171], v[170:171], v[138:139]
 v_pk_mul_f32 v[104:105], v[104:105], v[36:37]
 v_pk_mul_f32 v[106:107], v[106:107], v[38:39]
 v_pk_mul_f32 v[168:169], v[168:169], v[40:41]
 v_pk_mul_f32 v[170:171], v[170:171], v[42:43]
 v_cvt_pk_bf16_f32 v72, v104, v105
 v_cvt_pk_bf16_f32 v73, v106, v107
 v_cvt_pk_bf16_f32 v74, v168, v169
 v_cvt_pk_bf16_f32 v75, v170, v171
 buffer_store_dwordx4 v[72:75], v1, s[24:27], s43 offen sc1
 s_waitcnt lgkmcnt(0)
 s_nop 0
 ds_read_b128 v[28:31], v44 offset:0
 v_pk_fma_f32 v[76:77], v[12:13], v[32:33], v[76:77] op_sel_hi:[1,0,1]
 v_pk_fma_f32 v[78:79], v[14:15], v[32:33], v[78:79] op_sel_hi:[1,0,1]
 v_pk_fma_f32 v[140:141], v[20:21], v[32:33], v[140:141] op_sel_hi:[1,0,1]
 v_pk_fma_f32 v[142:143], v[22:23], v[32:33], v[142:143] op_sel_hi:[1,0,1]
 v_pk_mul_f32 v[36:37], v[76:77], v[76:77]
 v_pk_mul_f32 v[38:39], v[78:79], v[78:79]
 v_pk_mul_f32 v[40:41], v[140:141], v[140:141]
 v_pk_mul_f32 v[42:43], v[142:143], v[142:143]
 v_pk_fma_f32 v[36:37], v[36:37], v[34:35], v[32:33] op_sel:[0,0,1] op_sel_hi:[1,0,1]
 v_pk_fma_f32 v[38:39], v[38:39], v[34:35], v[32:33] op_sel:[0,0,1] op_sel_hi:[1,0,1]
 v_pk_fma_f32 v[40:41], v[40:41], v[34:35], v[32:33] op_sel:[0,0,1] op_sel_hi:[1,0,1]
 v_pk_fma_f32 v[42:43], v[42:43], v[34:35], v[32:33] op_sel:[0,0,1] op_sel_hi:[1,0,1]
 v_pk_mul_f32 v[36:37], v[36:37], v[76:77]
 v_pk_mul_f32 v[38:39], v[38:39], v[78:79]
 v_pk_mul_f32 v[40:41], v[40:41], v[140:141]
 v_pk_mul_f32 v[42:43], v[42:43], v[142:143]
 v_exp_f32 v36, v36
 v_exp_f32 v37, v37
 v_exp_f32 v38, v38
 v_exp_f32 v39, v39
 v_exp_f32 v40, v40
 v_exp_f32 v41, v41
 v_exp_f32 v42, v42
 v_exp_f32 v43, v43
 v_pk_fma_f32 v[108:109], v[16:17], v[32:33], v[108:109] op_sel_hi:[1,0,1]
 v_pk_fma_f32 v[110:111], v[18:19], v[32:33], v[110:111] op_sel_hi:[1,0,1]
 v_pk_fma_f32 v[172:173], v[24:25], v[32:33], v[172:173] op_sel_hi:[1,0,1]
 v_pk_fma_f32 v[174:175], v[26:27], v[32:33], v[174:175] op_sel_hi:[1,0,1]
 v_pk_fma_f32 v[36:37], v[36:37], v[34:35], v[34:35] op_sel:[0,1,1] op_sel_hi:[1,1,1]
 v_pk_fma_f32 v[38:39], v[38:39], v[34:35], v[34:35] op_sel:[0,1,1] op_sel_hi:[1,1,1]
 v_pk_fma_f32 v[40:41], v[40:41], v[34:35], v[34:35] op_sel:[0,1,1] op_sel_hi:[1,1,1]
 v_pk_fma_f32 v[42:43], v[42:43], v[34:35], v[34:35] op_sel:[0,1,1] op_sel_hi:[1,1,1]
 v_rcp_f32 v36, v36
 v_rcp_f32 v37, v37
 v_rcp_f32 v38, v38
 v_rcp_f32 v39, v39
 v_rcp_f32 v40, v40
 v_rcp_f32 v41, v41
 v_rcp_f32 v42, v42
 v_rcp_f32 v43, v43
 v_pk_mul_f32 v[108:109], v[108:109], v[76:77]
 v_pk_mul_f32 v[110:111], v[110:111], v[78:79]
 v_pk_mul_f32 v[172:173], v[172:173], v[140:141]
 v_pk_mul_f32 v[174:175], v[174:175], v[142:143]
 v_pk_mul_f32 v[108:109], v[108:109], v[36:37]
 v_pk_mul_f32 v[110:111], v[110:111], v[38:39]
 v_pk_mul_f32 v[172:173], v[172:173], v[40:41]
 v_pk_mul_f32 v[174:175], v[174:175], v[42:43]
 v_cvt_pk_bf16_f32 v76, v108, v109
 v_cvt_pk_bf16_f32 v77, v110, v111
 v_cvt_pk_bf16_f32 v78, v172, v173
 v_cvt_pk_bf16_f32 v79, v174, v175
 buffer_store_dwordx4 v[76:79], v1, s[24:27], s43 offen offset:1024 sc1
 ds_read_b128 v[12:15], v45 offset:384
 ds_read_b128 v[16:19], v45 offset:448
 ds_read_b128 v[20:23], v45 offset:512
 ds_read_b128 v[24:27], v45 offset:576
 v_accvgpr_read_b32 v80, a160
 v_accvgpr_read_b32 v81, a161
 v_accvgpr_read_b32 v82, a162
 v_accvgpr_read_b32 v83, a163
 v_accvgpr_read_b32 v112, a192
 v_accvgpr_read_b32 v113, a193
 v_accvgpr_read_b32 v114, a194
 v_accvgpr_read_b32 v115, a195
 v_accvgpr_read_b32 v144, a224
 v_accvgpr_read_b32 v145, a225
 v_accvgpr_read_b32 v146, a226
 v_accvgpr_read_b32 v147, a227
 s_waitcnt lgkmcnt(0)
 s_nop 0
 ds_read_b128 v[32:35], v44 offset:256
 v_pk_fma_f32 v[240:241], v[12:13], v[28:29], v[240:241] op_sel_hi:[1,0,1]
 v_pk_fma_f32 v[242:243], v[14:15], v[28:29], v[242:243] op_sel_hi:[1,0,1]
 v_pk_fma_f32 v[112:113], v[20:21], v[28:29], v[112:113] op_sel_hi:[1,0,1]
 v_pk_fma_f32 v[114:115], v[22:23], v[28:29], v[114:115] op_sel_hi:[1,0,1]
 v_pk_mul_f32 v[36:37], v[240:241], v[240:241]
 v_pk_mul_f32 v[38:39], v[242:243], v[242:243]
 v_pk_mul_f32 v[40:41], v[112:113], v[112:113]
 v_pk_mul_f32 v[42:43], v[114:115], v[114:115]
 v_pk_fma_f32 v[36:37], v[36:37], v[30:31], v[28:29] op_sel:[0,0,1] op_sel_hi:[1,0,1]
 v_pk_fma_f32 v[38:39], v[38:39], v[30:31], v[28:29] op_sel:[0,0,1] op_sel_hi:[1,0,1]
 v_pk_fma_f32 v[40:41], v[40:41], v[30:31], v[28:29] op_sel:[0,0,1] op_sel_hi:[1,0,1]
 v_pk_fma_f32 v[42:43], v[42:43], v[30:31], v[28:29] op_sel:[0,0,1] op_sel_hi:[1,0,1]
 v_pk_mul_f32 v[36:37], v[36:37], v[240:241]
 v_pk_mul_f32 v[38:39], v[38:39], v[242:243]
 v_pk_mul_f32 v[40:41], v[40:41], v[112:113]
 v_pk_mul_f32 v[42:43], v[42:43], v[114:115]
 v_exp_f32 v36, v36
 v_exp_f32 v37, v37
 v_exp_f32 v38, v38
 v_exp_f32 v39, v39
 v_exp_f32 v40, v40
 v_exp_f32 v41, v41
 v_exp_f32 v42, v42
 v_exp_f32 v43, v43
 v_pk_fma_f32 v[80:81], v[16:17], v[28:29], v[80:81] op_sel_hi:[1,0,1]
 v_pk_fma_f32 v[82:83], v[18:19], v[28:29], v[82:83] op_sel_hi:[1,0,1]
 v_pk_fma_f32 v[144:145], v[24:25], v[28:29], v[144:145] op_sel_hi:[1,0,1]
 v_pk_fma_f32 v[146:147], v[26:27], v[28:29], v[146:147] op_sel_hi:[1,0,1]
 v_pk_fma_f32 v[36:37], v[36:37], v[30:31], v[30:31] op_sel:[0,1,1] op_sel_hi:[1,1,1]
 v_pk_fma_f32 v[38:39], v[38:39], v[30:31], v[30:31] op_sel:[0,1,1] op_sel_hi:[1,1,1]
 v_pk_fma_f32 v[40:41], v[40:41], v[30:31], v[30:31] op_sel:[0,1,1] op_sel_hi:[1,1,1]
 v_pk_fma_f32 v[42:43], v[42:43], v[30:31], v[30:31] op_sel:[0,1,1] op_sel_hi:[1,1,1]
 v_rcp_f32 v36, v36
 v_rcp_f32 v37, v37
 v_rcp_f32 v38, v38
 v_rcp_f32 v39, v39
 v_rcp_f32 v40, v40
 v_rcp_f32 v41, v41
 v_rcp_f32 v42, v42
 v_rcp_f32 v43, v43
 v_pk_mul_f32 v[80:81], v[80:81], v[240:241]
 v_pk_mul_f32 v[82:83], v[82:83], v[242:243]
 v_pk_mul_f32 v[144:145], v[144:145], v[112:113]
 v_pk_mul_f32 v[146:147], v[146:147], v[114:115]
 v_pk_mul_f32 v[80:81], v[80:81], v[36:37]
 v_pk_mul_f32 v[82:83], v[82:83], v[38:39]
 v_pk_mul_f32 v[144:145], v[144:145], v[40:41]
 v_pk_mul_f32 v[146:147], v[146:147], v[42:43]
 v_cvt_pk_bf16_f32 v240, v80, v81
 v_cvt_pk_bf16_f32 v241, v82, v83
 v_cvt_pk_bf16_f32 v242, v144, v145
 v_cvt_pk_bf16_f32 v243, v146, v147
 buffer_store_dwordx4 v[240:243], v1, s[24:27], s44 offen sc1
 v_accvgpr_read_b32 v84, a164
 v_accvgpr_read_b32 v85, a165
 v_accvgpr_read_b32 v86, a166
 v_accvgpr_read_b32 v87, a167
 v_accvgpr_read_b32 v116, a196
 v_accvgpr_read_b32 v117, a197
 v_accvgpr_read_b32 v118, a198
 v_accvgpr_read_b32 v119, a199
 v_accvgpr_read_b32 v148, a228
 v_accvgpr_read_b32 v149, a229
 v_accvgpr_read_b32 v150, a230
 v_accvgpr_read_b32 v151, a231
 s_waitcnt lgkmcnt(0)
 s_nop 0
 ds_read_b128 v[28:31], v44 offset:512
 v_pk_fma_f32 v[244:245], v[12:13], v[32:33], v[244:245] op_sel_hi:[1,0,1]
 v_pk_fma_f32 v[246:247], v[14:15], v[32:33], v[246:247] op_sel_hi:[1,0,1]
 v_pk_fma_f32 v[116:117], v[20:21], v[32:33], v[116:117] op_sel_hi:[1,0,1]
 v_pk_fma_f32 v[118:119], v[22:23], v[32:33], v[118:119] op_sel_hi:[1,0,1]
 v_pk_mul_f32 v[36:37], v[244:245], v[244:245]
 v_pk_mul_f32 v[38:39], v[246:247], v[246:247]
 v_pk_mul_f32 v[40:41], v[116:117], v[116:117]
 v_pk_mul_f32 v[42:43], v[118:119], v[118:119]
 v_pk_fma_f32 v[36:37], v[36:37], v[34:35], v[32:33] op_sel:[0,0,1] op_sel_hi:[1,0,1]
 v_pk_fma_f32 v[38:39], v[38:39], v[34:35], v[32:33] op_sel:[0,0,1] op_sel_hi:[1,0,1]
 v_pk_fma_f32 v[40:41], v[40:41], v[34:35], v[32:33] op_sel:[0,0,1] op_sel_hi:[1,0,1]
 v_pk_fma_f32 v[42:43], v[42:43], v[34:35], v[32:33] op_sel:[0,0,1] op_sel_hi:[1,0,1]
 v_pk_mul_f32 v[36:37], v[36:37], v[244:245]
 v_pk_mul_f32 v[38:39], v[38:39], v[246:247]
 v_pk_mul_f32 v[40:41], v[40:41], v[116:117]
 v_pk_mul_f32 v[42:43], v[42:43], v[118:119]
 v_exp_f32 v36, v36
 v_exp_f32 v37, v37
 v_exp_f32 v38, v38
 v_exp_f32 v39, v39
 v_exp_f32 v40, v40
 v_exp_f32 v41, v41
 v_exp_f32 v42, v42
 v_exp_f32 v43, v43
 v_pk_fma_f32 v[84:85], v[16:17], v[32:33], v[84:85] op_sel_hi:[1,0,1]
 v_pk_fma_f32 v[86:87], v[18:19], v[32:33], v[86:87] op_sel_hi:[1,0,1]
 v_pk_fma_f32 v[148:149], v[24:25], v[32:33], v[148:149] op_sel_hi:[1,0,1]
 v_pk_fma_f32 v[150:151], v[26:27], v[32:33], v[150:151] op_sel_hi:[1,0,1]
 v_pk_fma_f32 v[36:37], v[36:37], v[34:35], v[34:35] op_sel:[0,1,1] op_sel_hi:[1,1,1]
 v_pk_fma_f32 v[38:39], v[38:39], v[34:35], v[34:35] op_sel:[0,1,1] op_sel_hi:[1,1,1]
 v_pk_fma_f32 v[40:41], v[40:41], v[34:35], v[34:35] op_sel:[0,1,1] op_sel_hi:[1,1,1]
 v_pk_fma_f32 v[42:43], v[42:43], v[34:35], v[34:35] op_sel:[0,1,1] op_sel_hi:[1,1,1]
 v_rcp_f32 v36, v36
 v_rcp_f32 v37, v37
 v_rcp_f32 v38, v38
 v_rcp_f32 v39, v39
 v_rcp_f32 v40, v40
 v_rcp_f32 v41, v41
 v_rcp_f32 v42, v42
 v_rcp_f32 v43, v43
 v_pk_mul_f32 v[84:85], v[84:85], v[244:245]
 v_pk_mul_f32 v[86:87], v[86:87], v[246:247]
 v_pk_mul_f32 v[148:149], v[148:149], v[116:117]
 v_pk_mul_f32 v[150:151], v[150:151], v[118:119]
 v_pk_mul_f32 v[84:85], v[84:85], v[36:37]
 v_pk_mul_f32 v[86:87], v[86:87], v[38:39]
 v_pk_mul_f32 v[148:149], v[148:149], v[40:41]
 v_pk_mul_f32 v[150:151], v[150:151], v[42:43]
 v_cvt_pk_bf16_f32 v244, v84, v85
 v_cvt_pk_bf16_f32 v245, v86, v87
 v_cvt_pk_bf16_f32 v246, v148, v149
 v_cvt_pk_bf16_f32 v247, v150, v151
 buffer_store_dwordx4 v[244:247], v1, s[24:27], s44 offen offset:1024 sc1
 s_waitcnt vmcnt(2)
 s_mov_b64 exec, 1
 buffer_store_dword v3, off, s[24:27], s23 sc1
 s_mov_b64 exec, -1
 s_nop 0
 v_accvgpr_read_b32 v88, a168
 v_accvgpr_read_b32 v89, a169
 v_accvgpr_read_b32 v90, a170
 v_accvgpr_read_b32 v91, a171
 v_accvgpr_read_b32 v120, a200
 v_accvgpr_read_b32 v121, a201
 v_accvgpr_read_b32 v122, a202
 v_accvgpr_read_b32 v123, a203
 v_accvgpr_read_b32 v152, a232
 v_accvgpr_read_b32 v153, a233
 v_accvgpr_read_b32 v154, a234
 v_accvgpr_read_b32 v155, a235
 s_waitcnt lgkmcnt(0)
 s_nop 0
 ds_read_b128 v[32:35], v44 offset:768
 v_pk_fma_f32 v[248:249], v[12:13], v[28:29], v[248:249] op_sel_hi:[1,0,1]
 v_pk_fma_f32 v[250:251], v[14:15], v[28:29], v[250:251] op_sel_hi:[1,0,1]
 v_pk_fma_f32 v[120:121], v[20:21], v[28:29], v[120:121] op_sel_hi:[1,0,1]
 v_pk_fma_f32 v[122:123], v[22:23], v[28:29], v[122:123] op_sel_hi:[1,0,1]
 v_pk_mul_f32 v[36:37], v[248:249], v[248:249]
 v_pk_mul_f32 v[38:39], v[250:251], v[250:251]
 v_pk_mul_f32 v[40:41], v[120:121], v[120:121]
 v_pk_mul_f32 v[42:43], v[122:123], v[122:123]
 v_pk_fma_f32 v[36:37], v[36:37], v[30:31], v[28:29] op_sel:[0,0,1] op_sel_hi:[1,0,1]
 v_pk_fma_f32 v[38:39], v[38:39], v[30:31], v[28:29] op_sel:[0,0,1] op_sel_hi:[1,0,1]
 v_pk_fma_f32 v[40:41], v[40:41], v[30:31], v[28:29] op_sel:[0,0,1] op_sel_hi:[1,0,1]
 v_pk_fma_f32 v[42:43], v[42:43], v[30:31], v[28:29] op_sel:[0,0,1] op_sel_hi:[1,0,1]
 v_pk_mul_f32 v[36:37], v[36:37], v[248:249]
 v_pk_mul_f32 v[38:39], v[38:39], v[250:251]
 v_pk_mul_f32 v[40:41], v[40:41], v[120:121]
 v_pk_mul_f32 v[42:43], v[42:43], v[122:123]
 v_exp_f32 v36, v36
 v_exp_f32 v37, v37
 v_exp_f32 v38, v38
 v_exp_f32 v39, v39
 v_exp_f32 v40, v40
 v_exp_f32 v41, v41
 v_exp_f32 v42, v42
 v_exp_f32 v43, v43
 v_pk_fma_f32 v[88:89], v[16:17], v[28:29], v[88:89] op_sel_hi:[1,0,1]
 v_pk_fma_f32 v[90:91], v[18:19], v[28:29], v[90:91] op_sel_hi:[1,0,1]
 v_pk_fma_f32 v[152:153], v[24:25], v[28:29], v[152:153] op_sel_hi:[1,0,1]
 v_pk_fma_f32 v[154:155], v[26:27], v[28:29], v[154:155] op_sel_hi:[1,0,1]
 v_pk_fma_f32 v[36:37], v[36:37], v[30:31], v[30:31] op_sel:[0,1,1] op_sel_hi:[1,1,1]
 v_pk_fma_f32 v[38:39], v[38:39], v[30:31], v[30:31] op_sel:[0,1,1] op_sel_hi:[1,1,1]
 v_pk_fma_f32 v[40:41], v[40:41], v[30:31], v[30:31] op_sel:[0,1,1] op_sel_hi:[1,1,1]
 v_pk_fma_f32 v[42:43], v[42:43], v[30:31], v[30:31] op_sel:[0,1,1] op_sel_hi:[1,1,1]
 v_rcp_f32 v36, v36
 v_rcp_f32 v37, v37
 v_rcp_f32 v38, v38
 v_rcp_f32 v39, v39
 v_rcp_f32 v40, v40
 v_rcp_f32 v41, v41
 v_rcp_f32 v42, v42
 v_rcp_f32 v43, v43
 v_pk_mul_f32 v[88:89], v[88:89], v[248:249]
 v_pk_mul_f32 v[90:91], v[90:91], v[250:251]
 v_pk_mul_f32 v[152:153], v[152:153], v[120:121]
 v_pk_mul_f32 v[154:155], v[154:155], v[122:123]
 v_pk_mul_f32 v[88:89], v[88:89], v[36:37]
 v_pk_mul_f32 v[90:91], v[90:91], v[38:39]
 v_pk_mul_f32 v[152:153], v[152:153], v[40:41]
 v_pk_mul_f32 v[154:155], v[154:155], v[42:43]
 v_cvt_pk_bf16_f32 v248, v88, v89
 v_cvt_pk_bf16_f32 v249, v90, v91
 v_cvt_pk_bf16_f32 v250, v152, v153
 v_cvt_pk_bf16_f32 v251, v154, v155
 buffer_store_dwordx4 v[248:251], v1, s[24:27], s45 offen sc1
 v_accvgpr_read_b32 v92, a172
 v_accvgpr_read_b32 v93, a173
 v_accvgpr_read_b32 v94, a174
 v_accvgpr_read_b32 v95, a175
 v_accvgpr_read_b32 v124, a204
 v_accvgpr_read_b32 v125, a205
 v_accvgpr_read_b32 v126, a206
 v_accvgpr_read_b32 v127, a207
 v_accvgpr_read_b32 v156, a236
 v_accvgpr_read_b32 v157, a237
 v_accvgpr_read_b32 v158, a238
 v_accvgpr_read_b32 v159, a239
 s_waitcnt lgkmcnt(0)
 s_nop 0
 ds_read_b128 v[28:31], v44 offset:1024
 v_pk_fma_f32 v[252:253], v[12:13], v[32:33], v[252:253] op_sel_hi:[1,0,1]
 v_pk_fma_f32 v[254:255], v[14:15], v[32:33], v[254:255] op_sel_hi:[1,0,1]
 v_pk_fma_f32 v[124:125], v[20:21], v[32:33], v[124:125] op_sel_hi:[1,0,1]
 v_pk_fma_f32 v[126:127], v[22:23], v[32:33], v[126:127] op_sel_hi:[1,0,1]
 v_pk_mul_f32 v[36:37], v[252:253], v[252:253]
 v_pk_mul_f32 v[38:39], v[254:255], v[254:255]
 v_pk_mul_f32 v[40:41], v[124:125], v[124:125]
 v_pk_mul_f32 v[42:43], v[126:127], v[126:127]
 v_pk_fma_f32 v[36:37], v[36:37], v[34:35], v[32:33] op_sel:[0,0,1] op_sel_hi:[1,0,1]
 v_pk_fma_f32 v[38:39], v[38:39], v[34:35], v[32:33] op_sel:[0,0,1] op_sel_hi:[1,0,1]
 v_pk_fma_f32 v[40:41], v[40:41], v[34:35], v[32:33] op_sel:[0,0,1] op_sel_hi:[1,0,1]
 v_pk_fma_f32 v[42:43], v[42:43], v[34:35], v[32:33] op_sel:[0,0,1] op_sel_hi:[1,0,1]
 v_pk_mul_f32 v[36:37], v[36:37], v[252:253]
 v_pk_mul_f32 v[38:39], v[38:39], v[254:255]
 v_pk_mul_f32 v[40:41], v[40:41], v[124:125]
 s_branch L_tp_L_tB_8_o
L_tp_L_tB_8:
 s_nop 0
 s_branch L_tr10
 s_nop 0
L_tp_L_tB_8_o:
 v_pk_mul_f32 v[42:43], v[42:43], v[126:127]
 v_exp_f32 v36, v36
 v_exp_f32 v37, v37
 v_exp_f32 v38, v38
 v_exp_f32 v39, v39
 v_exp_f32 v40, v40
 v_exp_f32 v41, v41
 v_exp_f32 v42, v42
 v_exp_f32 v43, v43
 v_pk_fma_f32 v[92:93], v[16:17], v[32:33], v[92:93] op_sel_hi:[1,0,1]
 v_pk_fma_f32 v[94:95], v[18:19], v[32:33], v[94:95] op_sel_hi:[1,0,1]
 v_pk_fma_f32 v[156:157], v[24:25], v[32:33], v[156:157] op_sel_hi:[1,0,1]
 v_pk_fma_f32 v[158:159], v[26:27], v[32:33], v[158:159] op_sel_hi:[1,0,1]
 v_pk_fma_f32 v[36:37], v[36:37], v[34:35], v[34:35] op_sel:[0,1,1] op_sel_hi:[1,1,1]
 v_pk_fma_f32 v[38:39], v[38:39], v[34:35], v[34:35] op_sel:[0,1,1] op_sel_hi:[1,1,1]
 v_pk_fma_f32 v[40:41], v[40:41], v[34:35], v[34:35] op_sel:[0,1,1] op_sel_hi:[1,1,1]
 v_pk_fma_f32 v[42:43], v[42:43], v[34:35], v[34:35] op_sel:[0,1,1] op_sel_hi:[1,1,1]
 v_rcp_f32 v36, v36
 v_rcp_f32 v37, v37
 v_rcp_f32 v38, v38
 v_rcp_f32 v39, v39
 v_rcp_f32 v40, v40
 v_rcp_f32 v41, v41
 v_rcp_f32 v42, v42
 v_rcp_f32 v43, v43
 v_pk_mul_f32 v[92:93], v[92:93], v[252:253]
 v_pk_mul_f32 v[94:95], v[94:95], v[254:255]
 v_pk_mul_f32 v[156:157], v[156:157], v[124:125]
 v_pk_mul_f32 v[158:159], v[158:159], v[126:127]
 v_pk_mul_f32 v[92:93], v[92:93], v[36:37]
 v_pk_mul_f32 v[94:95], v[94:95], v[38:39]
 v_pk_mul_f32 v[156:157], v[156:157], v[40:41]
 v_pk_mul_f32 v[158:159], v[158:159], v[42:43]
 v_cvt_pk_bf16_f32 v252, v92, v93
 v_cvt_pk_bf16_f32 v253, v94, v95
 v_cvt_pk_bf16_f32 v254, v156, v157
 v_cvt_pk_bf16_f32 v255, v158, v159
 buffer_store_dwordx4 v[252:255], v1, s[24:27], s45 offen offset:1024 sc1
 v_accvgpr_read_b32 v64, a144
 v_accvgpr_read_b32 v65, a145
 v_accvgpr_read_b32 v66, a146
 v_accvgpr_read_b32 v67, a147
 v_accvgpr_read_b32 v96, a176
 v_accvgpr_read_b32 v97, a177
 v_accvgpr_read_b32 v98, a178
 v_accvgpr_read_b32 v99, a179
 v_accvgpr_read_b32 v128, a208
 v_accvgpr_read_b32 v129, a209
 v_accvgpr_read_b32 v130, a210
 v_accvgpr_read_b32 v131, a211
 v_accvgpr_read_b32 v160, a240
 v_accvgpr_read_b32 v161, a241
 v_accvgpr_read_b32 v162, a242
 v_accvgpr_read_b32 v163, a243
 s_waitcnt lgkmcnt(0)
 s_nop 0
 ds_read_b128 v[32:35], v44 offset:1280
 v_pk_fma_f32 v[64:65], v[12:13], v[28:29], v[64:65] op_sel_hi:[1,0,1]
 v_pk_fma_f32 v[66:67], v[14:15], v[28:29], v[66:67] op_sel_hi:[1,0,1]
 v_pk_fma_f32 v[128:129], v[20:21], v[28:29], v[128:129] op_sel_hi:[1,0,1]
 v_pk_fma_f32 v[130:131], v[22:23], v[28:29], v[130:131] op_sel_hi:[1,0,1]
 v_pk_mul_f32 v[36:37], v[64:65], v[64:65]
 v_pk_mul_f32 v[38:39], v[66:67], v[66:67]
 v_pk_mul_f32 v[40:41], v[128:129], v[128:129]
 v_pk_mul_f32 v[42:43], v[130:131], v[130:131]
 v_pk_fma_f32 v[36:37], v[36:37], v[30:31], v[28:29] op_sel:[0,0,1] op_sel_hi:[1,0,1]
 v_pk_fma_f32 v[38:39], v[38:39], v[30:31], v[28:29] op_sel:[0,0,1] op_sel_hi:[1,0,1]
 v_pk_fma_f32 v[40:41], v[40:41], v[30:31], v[28:29] op_sel:[0,0,1] op_sel_hi:[1,0,1]
 v_pk_fma_f32 v[42:43], v[42:43], v[30:31], v[28:29] op_sel:[0,0,1] op_sel_hi:[1,0,1]
 v_pk_mul_f32 v[36:37], v[36:37], v[64:65]
 v_pk_mul_f32 v[38:39], v[38:39], v[66:67]
 v_pk_mul_f32 v[40:41], v[40:41], v[128:129]
 v_pk_mul_f32 v[42:43], v[42:43], v[130:131]
 v_exp_f32 v36, v36
 v_exp_f32 v37, v37
 v_exp_f32 v38, v38
 v_exp_f32 v39, v39
 v_exp_f32 v40, v40
 v_exp_f32 v41, v41
 v_exp_f32 v42, v42
 v_exp_f32 v43, v43
 v_pk_fma_f32 v[96:97], v[16:17], v[28:29], v[96:97] op_sel_hi:[1,0,1]
 v_pk_fma_f32 v[98:99], v[18:19], v[28:29], v[98:99] op_sel_hi:[1,0,1]
 v_pk_fma_f32 v[160:161], v[24:25], v[28:29], v[160:161] op_sel_hi:[1,0,1]
 v_pk_fma_f32 v[162:163], v[26:27], v[28:29], v[162:163] op_sel_hi:[1,0,1]
 v_pk_fma_f32 v[36:37], v[36:37], v[30:31], v[30:31] op_sel:[0,1,1] op_sel_hi:[1,1,1]
 v_pk_fma_f32 v[38:39], v[38:39], v[30:31], v[30:31] op_sel:[0,1,1] op_sel_hi:[1,1,1]
 v_pk_fma_f32 v[40:41], v[40:41], v[30:31], v[30:31] op_sel:[0,1,1] op_sel_hi:[1,1,1]
 v_pk_fma_f32 v[42:43], v[42:43], v[30:31], v[30:31] op_sel:[0,1,1] op_sel_hi:[1,1,1]
 v_rcp_f32 v36, v36
 v_rcp_f32 v37, v37
 v_rcp_f32 v38, v38
 v_rcp_f32 v39, v39
 v_rcp_f32 v40, v40
 v_rcp_f32 v41, v41
 v_rcp_f32 v42, v42
 v_rcp_f32 v43, v43
 v_pk_mul_f32 v[96:97], v[96:97], v[64:65]
 v_pk_mul_f32 v[98:99], v[98:99], v[66:67]
 v_pk_mul_f32 v[160:161], v[160:161], v[128:129]
 v_pk_mul_f32 v[162:163], v[162:163], v[130:131]
 v_pk_mul_f32 v[96:97], v[96:97], v[36:37]
 v_pk_mul_f32 v[98:99], v[98:99], v[38:39]
 v_pk_mul_f32 v[160:161], v[160:161], v[40:41]
 v_pk_mul_f32 v[162:163], v[162:163], v[42:43]
 v_cvt_pk_bf16_f32 v64, v96, v97
 v_cvt_pk_bf16_f32 v65, v98, v99
 v_cvt_pk_bf16_f32 v66, v160, v161
 v_cvt_pk_bf16_f32 v67, v162, v163
 buffer_store_dwordx4 v[64:67], v1, s[24:27], s46 offen sc1
 v_accvgpr_read_b32 v68, a148
 v_accvgpr_read_b32 v69, a149
 v_accvgpr_read_b32 v70, a150
 v_accvgpr_read_b32 v71, a151
 v_accvgpr_read_b32 v100, a180
 v_accvgpr_read_b32 v101, a181
 v_accvgpr_read_b32 v102, a182
 v_accvgpr_read_b32 v103, a183
 v_accvgpr_read_b32 v132, a212
 v_accvgpr_read_b32 v133, a213
 v_accvgpr_read_b32 v134, a214
 v_accvgpr_read_b32 v135, a215
 v_accvgpr_read_b32 v164, a244
 v_accvgpr_read_b32 v165, a245
 v_accvgpr_read_b32 v166, a246
 v_accvgpr_read_b32 v167, a247
 s_waitcnt lgkmcnt(0)
 s_nop 0
 ds_read_b128 v[28:31], v44 offset:1536
 v_pk_fma_f32 v[68:69], v[12:13], v[32:33], v[68:69] op_sel_hi:[1,0,1]
 v_pk_fma_f32 v[70:71], v[14:15], v[32:33], v[70:71] op_sel_hi:[1,0,1]
 v_pk_fma_f32 v[132:133], v[20:21], v[32:33], v[132:133] op_sel_hi:[1,0,1]
 v_pk_fma_f32 v[134:135], v[22:23], v[32:33], v[134:135] op_sel_hi:[1,0,1]
 v_pk_mul_f32 v[36:37], v[68:69], v[68:69]
 v_pk_mul_f32 v[38:39], v[70:71], v[70:71]
 v_pk_mul_f32 v[40:41], v[132:133], v[132:133]
 v_pk_mul_f32 v[42:43], v[134:135], v[134:135]
 v_pk_fma_f32 v[36:37], v[36:37], v[34:35], v[32:33] op_sel:[0,0,1] op_sel_hi:[1,0,1]
 v_pk_fma_f32 v[38:39], v[38:39], v[34:35], v[32:33] op_sel:[0,0,1] op_sel_hi:[1,0,1]
 v_pk_fma_f32 v[40:41], v[40:41], v[34:35], v[32:33] op_sel:[0,0,1] op_sel_hi:[1,0,1]
 v_pk_fma_f32 v[42:43], v[42:43], v[34:35], v[32:33] op_sel:[0,0,1] op_sel_hi:[1,0,1]
 v_pk_mul_f32 v[36:37], v[36:37], v[68:69]
 v_pk_mul_f32 v[38:39], v[38:39], v[70:71]
 v_pk_mul_f32 v[40:41], v[40:41], v[132:133]
 v_pk_mul_f32 v[42:43], v[42:43], v[134:135]
 v_exp_f32 v36, v36
 v_exp_f32 v37, v37
 v_exp_f32 v38, v38
 v_exp_f32 v39, v39
 v_exp_f32 v40, v40
 v_exp_f32 v41, v41
 v_exp_f32 v42, v42
 v_exp_f32 v43, v43
 v_pk_fma_f32 v[100:101], v[16:17], v[32:33], v[100:101] op_sel_hi:[1,0,1]
 v_pk_fma_f32 v[102:103], v[18:19], v[32:33], v[102:103] op_sel_hi:[1,0,1]
 v_pk_fma_f32 v[164:165], v[24:25], v[32:33], v[164:165] op_sel_hi:[1,0,1]
 v_pk_fma_f32 v[166:167], v[26:27], v[32:33], v[166:167] op_sel_hi:[1,0,1]
 v_pk_fma_f32 v[36:37], v[36:37], v[34:35], v[34:35] op_sel:[0,1,1] op_sel_hi:[1,1,1]
 v_pk_fma_f32 v[38:39], v[38:39], v[34:35], v[34:35] op_sel:[0,1,1] op_sel_hi:[1,1,1]
 v_pk_fma_f32 v[40:41], v[40:41], v[34:35], v[34:35] op_sel:[0,1,1] op_sel_hi:[1,1,1]
 v_pk_fma_f32 v[42:43], v[42:43], v[34:35], v[34:35] op_sel:[0,1,1] op_sel_hi:[1,1,1]
 v_rcp_f32 v36, v36
 v_rcp_f32 v37, v37
 v_rcp_f32 v38, v38
 v_rcp_f32 v39, v39
 v_rcp_f32 v40, v40
 v_rcp_f32 v41, v41
 v_rcp_f32 v42, v42
 v_rcp_f32 v43, v43
 v_pk_mul_f32 v[100:101], v[100:101], v[68:69]
 v_pk_mul_f32 v[102:103], v[102:103], v[70:71]
 v_pk_mul_f32 v[164:165], v[164:165], v[132:133]
 v_pk_mul_f32 v[166:167], v[166:167], v[134:135]
 v_pk_mul_f32 v[100:101], v[100:101], v[36:37]
 v_pk_mul_f32 v[102:103], v[102:103], v[38:39]
 v_pk_mul_f32 v[164:165], v[164:165], v[40:41]
 v_pk_mul_f32 v[166:167], v[166:167], v[42:43]
 v_cvt_pk_bf16_f32 v68, v100, v101
 v_cvt_pk_bf16_f32 v69, v102, v103
 v_cvt_pk_bf16_f32 v70, v164, v165
 v_cvt_pk_bf16_f32 v71, v166, v167
 buffer_store_dwordx4 v[68:71], v1, s[24:27], s46 offen offset:1024 sc1
 buffer_load_dword v47, v46, s[24:27], s59 offen sc1
 v_accvgpr_read_b32 v72, a152
 v_accvgpr_read_b32 v73, a153
 v_accvgpr_read_b32 v74, a154
 v_accvgpr_read_b32 v75, a155
 v_accvgpr_read_b32 v104, a184
 v_accvgpr_read_b32 v105, a185
 v_accvgpr_read_b32 v106, a186
 v_accvgpr_read_b32 v107, a187
 v_accvgpr_read_b32 v136, a216
 v_accvgpr_read_b32 v137, a217
 v_accvgpr_read_b32 v138, a218
 v_accvgpr_read_b32 v139, a219
 v_accvgpr_read_b32 v168, a248
 v_accvgpr_read_b32 v169, a249
 v_accvgpr_read_b32 v170, a250
 v_accvgpr_read_b32 v171, a251
 s_waitcnt lgkmcnt(0)
 s_nop 0
 ds_read_b128 v[32:35], v44 offset:1792
 v_pk_fma_f32 v[72:73], v[12:13], v[28:29], v[72:73] op_sel_hi:[1,0,1]
 v_pk_fma_f32 v[74:75], v[14:15], v[28:29], v[74:75] op_sel_hi:[1,0,1]
 v_pk_fma_f32 v[136:137], v[20:21], v[28:29], v[136:137] op_sel_hi:[1,0,1]
 v_pk_fma_f32 v[138:139], v[22:23], v[28:29], v[138:139] op_sel_hi:[1,0,1]
 v_pk_mul_f32 v[36:37], v[72:73], v[72:73]
 v_pk_mul_f32 v[38:39], v[74:75], v[74:75]
 v_pk_mul_f32 v[40:41], v[136:137], v[136:137]
 v_pk_mul_f32 v[42:43], v[138:139], v[138:139]
 v_pk_fma_f32 v[36:37], v[36:37], v[30:31], v[28:29] op_sel:[0,0,1] op_sel_hi:[1,0,1]
 v_pk_fma_f32 v[38:39], v[38:39], v[30:31], v[28:29] op_sel:[0,0,1] op_sel_hi:[1,0,1]
 v_pk_fma_f32 v[40:41], v[40:41], v[30:31], v[28:29] op_sel:[0,0,1] op_sel_hi:[1,0,1]
 v_pk_fma_f32 v[42:43], v[42:43], v[30:31], v[28:29] op_sel:[0,0,1] op_sel_hi:[1,0,1]
 v_pk_mul_f32 v[36:37], v[36:37], v[72:73]
 v_pk_mul_f32 v[38:39], v[38:39], v[74:75]
 v_pk_mul_f32 v[40:41], v[40:41], v[136:137]
 v_pk_mul_f32 v[42:43], v[42:43], v[138:139]
 v_exp_f32 v36, v36
 v_exp_f32 v37, v37
 v_exp_f32 v38, v38
 v_exp_f32 v39, v39
 v_exp_f32 v40, v40
 v_exp_f32 v41, v41
 v_exp_f32 v42, v42
 v_exp_f32 v43, v43
 v_pk_fma_f32 v[104:105], v[16:17], v[28:29], v[104:105] op_sel_hi:[1,0,1]
 v_pk_fma_f32 v[106:107], v[18:19], v[28:29], v[106:107] op_sel_hi:[1,0,1]
 v_pk_fma_f32 v[168:169], v[24:25], v[28:29], v[168:169] op_sel_hi:[1,0,1]
 v_pk_fma_f32 v[170:171], v[26:27], v[28:29], v[170:171] op_sel_hi:[1,0,1]
 v_pk_fma_f32 v[36:37], v[36:37], v[30:31], v[30:31] op_sel:[0,1,1] op_sel_hi:[1,1,1]
 v_pk_fma_f32 v[38:39], v[38:39], v[30:31], v[30:31] op_sel:[0,1,1] op_sel_hi:[1,1,1]
 v_pk_fma_f32 v[40:41], v[40:41], v[30:31], v[30:31] op_sel:[0,1,1] op_sel_hi:[1,1,1]
 v_pk_fma_f32 v[42:43], v[42:43], v[30:31], v[30:31] op_sel:[0,1,1] op_sel_hi:[1,1,1]
 v_rcp_f32 v36, v36
 v_rcp_f32 v37, v37
 v_rcp_f32 v38, v38
 v_rcp_f32 v39, v39
 v_rcp_f32 v40, v40
 v_rcp_f32 v41, v41
 v_rcp_f32 v42, v42
 v_rcp_f32 v43, v43
 v_pk_mul_f32 v[104:105], v[104:105], v[72:73]
 v_pk_mul_f32 v[106:107], v[106:107], v[74:75]
 v_pk_mul_f32 v[168:169], v[168:169], v[136:137]
 v_pk_mul_f32 v[170:171], v[170:171], v[138:139]
 v_pk_mul_f32 v[104:105], v[104:105], v[36:37]
 v_pk_mul_f32 v[106:107], v[106:107], v[38:39]
 v_pk_mul_f32 v[168:169], v[168:169], v[40:41]
 v_pk_mul_f32 v[170:171], v[170:171], v[42:43]
 v_cvt_pk_bf16_f32 v72, v104, v105
 v_cvt_pk_bf16_f32 v73, v106, v107
 v_cvt_pk_bf16_f32 v74, v168, v169
 v_cvt_pk_bf16_f32 v75, v170, v171
 buffer_store_dwordx4 v[72:75], v1, s[24:27], s47 offen sc1
 v_accvgpr_read_b32 v76, a156
 v_accvgpr_read_b32 v77, a157
 v_accvgpr_read_b32 v78, a158
 v_accvgpr_read_b32 v79, a159
 v_accvgpr_read_b32 v108, a188
 v_accvgpr_read_b32 v109, a189
 v_accvgpr_read_b32 v110, a190
 v_accvgpr_read_b32 v111, a191
 v_accvgpr_read_b32 v140, a220
 v_accvgpr_read_b32 v141, a221
 v_accvgpr_read_b32 v142, a222
 v_accvgpr_read_b32 v143, a223
 v_accvgpr_read_b32 v172, a252
 v_accvgpr_read_b32 v173, a253
 v_accvgpr_read_b32 v174, a254
 v_accvgpr_read_b32 v175, a255
 s_waitcnt lgkmcnt(0)
 s_nop 0
 ds_read_b128 v[28:31], v44 offset:0
 v_pk_fma_f32 v[76:77], v[12:13], v[32:33], v[76:77] op_sel_hi:[1,0,1]
 v_pk_fma_f32 v[78:79], v[14:15], v[32:33], v[78:79] op_sel_hi:[1,0,1]
 v_pk_fma_f32 v[140:141], v[20:21], v[32:33], v[140:141] op_sel_hi:[1,0,1]
 v_pk_fma_f32 v[142:143], v[22:23], v[32:33], v[142:143] op_sel_hi:[1,0,1]
 v_pk_mul_f32 v[36:37], v[76:77], v[76:77]
 v_pk_mul_f32 v[38:39], v[78:79], v[78:79]
 v_pk_mul_f32 v[40:41], v[140:141], v[140:141]
 v_pk_mul_f32 v[42:43], v[142:143], v[142:143]
 v_pk_fma_f32 v[36:37], v[36:37], v[34:35], v[32:33] op_sel:[0,0,1] op_sel_hi:[1,0,1]
 v_pk_fma_f32 v[38:39], v[38:39], v[34:35], v[32:33] op_sel:[0,0,1] op_sel_hi:[1,0,1]
 v_pk_fma_f32 v[40:41], v[40:41], v[34:35], v[32:33] op_sel:[0,0,1] op_sel_hi:[1,0,1]
 v_pk_fma_f32 v[42:43], v[42:43], v[34:35], v[32:33] op_sel:[0,0,1] op_sel_hi:[1,0,1]
 v_pk_mul_f32 v[36:37], v[36:37], v[76:77]
 v_pk_mul_f32 v[38:39], v[38:39], v[78:79]
 v_pk_mul_f32 v[40:41], v[40:41], v[140:141]
 v_pk_mul_f32 v[42:43], v[42:43], v[142:143]
 v_exp_f32 v36, v36
 v_exp_f32 v37, v37
 v_exp_f32 v38, v38
 v_exp_f32 v39, v39
 v_exp_f32 v40, v40
 v_exp_f32 v41, v41
 v_exp_f32 v42, v42
 v_exp_f32 v43, v43
 v_pk_fma_f32 v[108:109], v[16:17], v[32:33], v[108:109] op_sel_hi:[1,0,1]
 v_pk_fma_f32 v[110:111], v[18:19], v[32:33], v[110:111] op_sel_hi:[1,0,1]
 v_pk_fma_f32 v[172:173], v[24:25], v[32:33], v[172:173] op_sel_hi:[1,0,1]
 v_pk_fma_f32 v[174:175], v[26:27], v[32:33], v[174:175] op_sel_hi:[1,0,1]
 v_pk_fma_f32 v[36:37], v[36:37], v[34:35], v[34:35] op_sel:[0,1,1] op_sel_hi:[1,1,1]
 v_pk_fma_f32 v[38:39], v[38:39], v[34:35], v[34:35] op_sel:[0,1,1] op_sel_hi:[1,1,1]
 v_pk_fma_f32 v[40:41], v[40:41], v[34:35], v[34:35] op_sel:[0,1,1] op_sel_hi:[1,1,1]
 v_pk_fma_f32 v[42:43], v[42:43], v[34:35], v[34:35] op_sel:[0,1,1] op_sel_hi:[1,1,1]
 v_rcp_f32 v36, v36
 v_rcp_f32 v37, v37
 v_rcp_f32 v38, v38
 v_rcp_f32 v39, v39
 v_rcp_f32 v40, v40
 v_rcp_f32 v41, v41
 v_rcp_f32 v42, v42
 v_rcp_f32 v43, v43
 v_pk_mul_f32 v[108:109], v[108:109], v[76:77]
 v_pk_mul_f32 v[110:111], v[110:111], v[78:79]
 v_pk_mul_f32 v[172:173], v[172:173], v[140:141]
 v_pk_mul_f32 v[174:175], v[174:175], v[142:143]
 v_pk_mul_f32 v[108:109], v[108:109], v[36:37]
 v_pk_mul_f32 v[110:111], v[110:111], v[38:39]
 v_pk_mul_f32 v[172:173], v[172:173], v[40:41]
 v_pk_mul_f32 v[174:175], v[174:175], v[42:43]
 v_cvt_pk_bf16_f32 v76, v108, v109
 v_cvt_pk_bf16_f32 v77, v110, v111
 v_cvt_pk_bf16_f32 v78, v172, v173
 v_cvt_pk_bf16_f32 v79, v174, v175
 buffer_store_dwordx4 v[76:79], v1, s[24:27], s47 offen offset:1024 sc1
 s_waitcnt vmcnt(2)
 v_cmp_ne_u32 vcc, 1, v47
 s_nop 3
 s_cbranch_vccnz L_b11_s
L_b11_d:
 buffer_load_dwordx4 a[80:83], v1, s[24:27], s12 offen sc1
 buffer_load_dwordx4 a[84:87], v1, s[24:27], s12 offen offset:1024 sc1
 buffer_load_dwordx4 a[88:91], v1, s[24:27], s12 offen offset:2048 sc1
 buffer_load_dwordx4 a[92:95], v1, s[24:27], s12 offen offset:3072 sc1
 s_add_u32 s12, s12, 4096
L_ml1:
 ds_read_b128 v[12:15], v45 offset:256
 ds_read_b128 v[16:19], v45 offset:320
 s_mul_i32 s0, s53, 79872
 s_add_u32 s0, s0, 67584
 s_lshl3_add_u32 s1, s52, s0
 v_add_u32 v4, s1, v1
 s_lshl_b32 s1, s52, 10
 s_add_u32 s1, s1, s0
 v_add_u32 v26, s1, v1
 v_mov_b32 v27, v4
 ds_read_b128 v[32:35], v44 offset:256
 s_waitcnt lgkmcnt(0)
 s_nop 0
 v_pk_fma_f32 v[176:177], v[12:13], v[28:29], v[176:177] op_sel_hi:[1,0,1]
 v_pk_fma_f32 v[178:179], v[14:15], v[28:29], v[178:179] op_sel_hi:[1,0,1]
 v_pk_fma_f32 v[180:181], v[12:13], v[32:33], v[180:181] op_sel_hi:[1,0,1]
 v_pk_fma_f32 v[182:183], v[14:15], v[32:33], v[182:183] op_sel_hi:[1,0,1]
 v_pk_mul_f32 v[36:37], v[176:177], v[176:177]
 v_pk_mul_f32 v[38:39], v[178:179], v[178:179]
 v_pk_mul_f32 v[40:41], v[180:181], v[180:181]
 v_pk_mul_f32 v[42:43], v[182:183], v[182:183]
 v_pk_fma_f32 v[36:37], v[36:37], v[30:31], v[28:29] op_sel:[0,0,1] op_sel_hi:[1,0,1]
 v_pk_fma_f32 v[38:39], v[38:39], v[30:31], v[28:29] op_sel:[0,0,1] op_sel_hi:[1,0,1]
 v_pk_fma_f32 v[40:41], v[40:41], v[34:35], v[32:33] op_sel:[0,0,1] op_sel_hi:[1,0,1]
 v_pk_fma_f32 v[42:43], v[42:43], v[34:35], v[32:33] op_sel:[0,0,1] op_sel_hi:[1,0,1]
 v_pk_mul_f32 v[36:37], v[36:37], v[176:177]
 v_pk_mul_f32 v[38:39], v[38:39], v[178:179]
 v_pk_mul_f32 v[40:41], v[40:41], v[180:181]
 v_pk_mul_f32 v[42:43], v[42:43], v[182:183]
 v_exp_f32 v36, v36
 v_exp_f32 v37, v37
 v_exp_f32 v38, v38
 v_exp_f32 v39, v39
 v_exp_f32 v40, v40
 v_exp_f32 v41, v41
 v_exp_f32 v42, v42
 v_exp_f32 v43, v43
 v_pk_fma_f32 v[208:209], v[16:17], v[28:29], v[208:209] op_sel_hi:[1,0,1]
 v_pk_fma_f32 v[210:211], v[18:19], v[28:29], v[210:211] op_sel_hi:[1,0,1]
 v_pk_fma_f32 v[212:213], v[16:17], v[32:33], v[212:213] op_sel_hi:[1,0,1]
 v_pk_fma_f32 v[214:215], v[18:19], v[32:33], v[214:215] op_sel_hi:[1,0,1]
 v_pk_fma_f32 v[36:37], v[36:37], v[30:31], v[30:31] op_sel:[0,1,1] op_sel_hi:[1,1,1]
 v_pk_fma_f32 v[38:39], v[38:39], v[30:31], v[30:31] op_sel:[0,1,1] op_sel_hi:[1,1,1]
 v_pk_fma_f32 v[40:41], v[40:41], v[34:35], v[34:35] op_sel:[0,1,1] op_sel_hi:[1,1,1]
 v_pk_fma_f32 v[42:43], v[42:43], v[34:35], v[34:35] op_sel:[0,1,1] op_sel_hi:[1,1,1]
 v_rcp_f32 v36, v36
 v_rcp_f32 v37, v37
 v_rcp_f32 v38, v38
 v_rcp_f32 v39, v39
 v_rcp_f32 v40, v40
 v_rcp_f32 v41, v41
 v_rcp_f32 v42, v42
 v_rcp_f32 v43, v43
 v_pk_mul_f32 v[208:209], v[208:209], v[176:177]
 v_pk_mul_f32 v[210:211], v[210:211], v[178:179]
 v_pk_mul_f32 v[212:213], v[212:213], v[180:181]
 v_pk_mul_f32 v[214:215], v[214:215], v[182:183]
 v_pk_mul_f32 v[208:209], v[208:209], v[36:37]
 v_pk_mul_f32 v[210:211], v[210:211], v[38:39]
 v_pk_mul_f32 v[212:213], v[212:213], v[40:41]
 v_pk_mul_f32 v[214:215], v[214:215], v[42:43]
 v_cvt_pk_bf16_f32 v176, v208, v209
 v_cvt_pk_bf16_f32 v177, v210, v211
 v_cvt_pk_bf16_f32 v178, v212, v213
 v_cvt_pk_bf16_f32 v179, v214, v215
 ds_read_b128 v[28:31], v44 offset:512
 ds_write_b64 v4, v[176:177] offset:0
 ds_write_b64 v4, v[178:179] offset:1024
 buffer_load_dwordx4 a[96:99], v1, s[24:27], s12 offen sc1
 buffer_load_dwordx4 a[100:103], v1, s[24:27], s12 offen offset:1024 sc1
 buffer_load_dwordx4 a[104:107], v1, s[24:27], s12 offen offset:2048 sc1
 buffer_load_dwordx4 a[108:111], v1, s[24:27], s12 offen offset:3072 sc1
 s_add_u32 s12, s12, 4096
 ds_read_b128 v[32:35], v44 offset:768
 s_waitcnt lgkmcnt(0)
 s_nop 0
 v_pk_fma_f32 v[184:185], v[12:13], v[28:29], v[184:185] op_sel_hi:[1,0,1]
 v_pk_fma_f32 v[186:187], v[14:15], v[28:29], v[186:187] op_sel_hi:[1,0,1]
 v_pk_fma_f32 v[188:189], v[12:13], v[32:33], v[188:189] op_sel_hi:[1,0,1]
 v_pk_fma_f32 v[190:191], v[14:15], v[32:33], v[190:191] op_sel_hi:[1,0,1]
 v_pk_mul_f32 v[36:37], v[184:185], v[184:185]
 v_pk_mul_f32 v[38:39], v[186:187], v[186:187]
 v_pk_mul_f32 v[40:41], v[188:189], v[188:189]
 v_pk_mul_f32 v[42:43], v[190:191], v[190:191]
 v_pk_fma_f32 v[36:37], v[36:37], v[30:31], v[28:29] op_sel:[0,0,1] op_sel_hi:[1,0,1]
 v_pk_fma_f32 v[38:39], v[38:39], v[30:31], v[28:29] op_sel:[0,0,1] op_sel_hi:[1,0,1]
 v_pk_fma_f32 v[40:41], v[40:41], v[34:35], v[32:33] op_sel:[0,0,1] op_sel_hi:[1,0,1]
 v_pk_fma_f32 v[42:43], v[42:43], v[34:35], v[32:33] op_sel:[0,0,1] op_sel_hi:[1,0,1]
 v_pk_mul_f32 v[36:37], v[36:37], v[184:185]
 v_pk_mul_f32 v[38:39], v[38:39], v[186:187]
 v_pk_mul_f32 v[40:41], v[40:41], v[188:189]
 v_pk_mul_f32 v[42:43], v[42:43], v[190:191]
 v_exp_f32 v36, v36
 v_exp_f32 v37, v37
 v_exp_f32 v38, v38
 v_exp_f32 v39, v39
 v_exp_f32 v40, v40
 v_exp_f32 v41, v41
 v_exp_f32 v42, v42
 v_exp_f32 v43, v43
 v_pk_fma_f32 v[216:217], v[16:17], v[28:29], v[216:217] op_sel_hi:[1,0,1]
 v_pk_fma_f32 v[218:219], v[18:19], v[28:29], v[218:219] op_sel_hi:[1,0,1]
 v_pk_fma_f32 v[220:221], v[16:17], v[32:33], v[220:221] op_sel_hi:[1,0,1]
 v_pk_fma_f32 v[222:223], v[18:19], v[32:33], v[222:223] op_sel_hi:[1,0,1]
 v_pk_fma_f32 v[36:37], v[36:37], v[30:31], v[30:31] op_sel:[0,1,1] op_sel_hi:[1,1,1]
 v_pk_fma_f32 v[38:39], v[38:39], v[30:31], v[30:31] op_sel:[0,1,1] op_sel_hi:[1,1,1]
 v_pk_fma_f32 v[40:41], v[40:41], v[34:35], v[34:35] op_sel:[0,1,1] op_sel_hi:[1,1,1]
 v_pk_fma_f32 v[42:43], v[42:43], v[34:35], v[34:35] op_sel:[0,1,1] op_sel_hi:[1,1,1]
 v_rcp_f32 v36, v36
 v_rcp_f32 v37, v37
 v_rcp_f32 v38, v38
 v_rcp_f32 v39, v39
 v_rcp_f32 v40, v40
 v_rcp_f32 v41, v41
 v_rcp_f32 v42, v42
 v_rcp_f32 v43, v43
 v_pk_mul_f32 v[216:217], v[216:217], v[184:185]
 v_pk_mul_f32 v[218:219], v[218:219], v[186:187]
 v_pk_mul_f32 v[220:221], v[220:221], v[188:189]
 v_pk_mul_f32 v[222:223], v[222:223], v[190:191]
 v_pk_mul_f32 v[216:217], v[216:217], v[36:37]
 v_pk_mul_f32 v[218:219], v[218:219], v[38:39]
 v_pk_mul_f32 v[220:221], v[220:221], v[40:41]
 v_pk_mul_f32 v[222:223], v[222:223], v[42:43]
 v_cvt_pk_bf16_f32 v184, v216, v217
 v_cvt_pk_bf16_f32 v185, v218, v219
 v_cvt_pk_bf16_f32 v186, v220, v221
 v_cvt_pk_bf16_f32 v187, v222, v223
 ds_read_b128 v[28:31], v44 offset:1024
 ds_write_b64 v4, v[184:185] offset:2048
 ds_write_b64 v4, v[186:187] offset:3072
 buffer_load_dwordx4 a[112:115], v1, s[24:27], s12 offen sc1
 buffer_load_dwordx4 a[116:119], v1, s[24:27], s12 offen offset:1024 sc1
 buffer_load_dwordx4 a[120:123], v1, s[24:27], s12 offen offset:2048 sc1
 buffer_load_dwordx4 a[124:127], v1, s[24:27], s12 offen offset:3072 sc1
 s_add_u32 s12, s12, 4096
 s_waitcnt lgkmcnt(0)
 s_barrier
 ds_read_b128 v[176:179], v26 offset:0
 ds_read_b128 v[184:187], v26 offset:2048
 ds_read_b128 v[32:35], v44 offset:1280
 s_waitcnt lgkmcnt(0)
 s_nop 0
 v_pk_fma_f32 v[192:193], v[12:13], v[28:29], v[192:193] op_sel_hi:[1,0,1]
 v_pk_fma_f32 v[194:195], v[14:15], v[28:29], v[194:195] op_sel_hi:[1,0,1]
 v_pk_fma_f32 v[196:197], v[12:13], v[32:33], v[196:197] op_sel_hi:[1,0,1]
 v_pk_fma_f32 v[198:199], v[14:15], v[32:33], v[198:199] op_sel_hi:[1,0,1]
 v_pk_mul_f32 v[36:37], v[192:193], v[192:193]
 v_pk_mul_f32 v[38:39], v[194:195], v[194:195]
 v_pk_mul_f32 v[40:41], v[196:197], v[196:197]
 v_pk_mul_f32 v[42:43], v[198:199], v[198:199]
 v_pk_fma_f32 v[36:37], v[36:37], v[30:31], v[28:29] op_sel:[0,0,1] op_sel_hi:[1,0,1]
 v_pk_fma_f32 v[38:39], v[38:39], v[30:31], v[28:29] op_sel:[0,0,1] op_sel_hi:[1,0,1]
 v_pk_fma_f32 v[40:41], v[40:41], v[34:35], v[32:33] op_sel:[0,0,1] op_sel_hi:[1,0,1]
 v_pk_fma_f32 v[42:43], v[42:43], v[34:35], v[32:33] op_sel:[0,0,1] op_sel_hi:[1,0,1]
 v_pk_mul_f32 v[36:37], v[36:37], v[192:193]
 v_pk_mul_f32 v[38:39], v[38:39], v[194:195]
 v_pk_mul_f32 v[40:41], v[40:41], v[196:197]
 v_pk_mul_f32 v[42:43], v[42:43], v[198:199]
 v_exp_f32 v36, v36
 v_exp_f32 v37, v37
 v_exp_f32 v38, v38
 v_exp_f32 v39, v39
 v_exp_f32 v40, v40
 v_exp_f32 v41, v41
 v_exp_f32 v42, v42
 buffer_store_dwordx4 v[176:179], v1, s[24:27], s48 offen sc1
 v_exp_f32 v43, v43
 v_pk_fma_f32 v[224:225], v[16:17], v[28:29], v[224:225] op_sel_hi:[1,0,1]
 v_pk_fma_f32 v[226:227], v[18:19], v[28:29], v[226:227] op_sel_hi:[1,0,1]
 v_pk_fma_f32 v[228:229], v[16:17], v[32:33], v[228:229] op_sel_hi:[1,0,1]
 v_pk_fma_f32 v[230:231], v[18:19], v[32:33], v[230:231] op_sel_hi:[1,0,1]
 v_pk_fma_f32 v[36:37], v[36:37], v[30:31], v[30:31] op_sel:[0,1,1] op_sel_hi:[1,1,1]
 v_pk_fma_f32 v[38:39], v[38:39], v[30:31], v[30:31] op_sel:[0,1,1] op_sel_hi:[1,1,1]
 v_pk_fma_f32 v[40:41], v[40:41], v[34:35], v[34:35] op_sel:[0,1,1] op_sel_hi:[1,1,1]
 v_pk_fma_f32 v[42:43], v[42:43], v[34:35], v[34:35] op_sel:[0,1,1] op_sel_hi:[1,1,1]
 v_rcp_f32 v36, v36
 v_rcp_f32 v37, v37
 v_rcp_f32 v38, v38
 v_rcp_f32 v39, v39
 v_rcp_f32 v40, v40
 v_rcp_f32 v41, v41
 v_rcp_f32 v42, v42
 buffer_store_dwordx4 v[184:187], v1, s[24:27], s49 offen sc1
 v_rcp_f32 v43, v43
 v_pk_mul_f32 v[224:225], v[224:225], v[192:193]
 v_pk_mul_f32 v[226:227], v[226:227], v[194:195]
 v_pk_mul_f32 v[228:229], v[228:229], v[196:197]
 v_pk_mul_f32 v[230:231], v[230:231], v[198:199]
 v_pk_mul_f32 v[224:225], v[224:225], v[36:37]
 v_pk_mul_f32 v[226:227], v[226:227], v[38:39]
 v_pk_mul_f32 v[228:229], v[228:229], v[40:41]
 v_pk_mul_f32 v[230:231], v[230:231], v[42:43]
 v_cvt_pk_bf16_f32 v192, v224, v225
 v_cvt_pk_bf16_f32 v193, v226, v227
 v_cvt_pk_bf16_f32 v194, v228, v229
 v_cvt_pk_bf16_f32 v195, v230, v231
 ds_read_b128 v[28:31], v44 offset:1536
 ds_write_b64 v4, v[192:193] offset:4096
 ds_write_b64 v4, v[194:195] offset:5120
 v_xor_b32 v36, 0, v7
 v_xor_b32 v37, 32, v7
 v_xor_b32 v38, 64, v7
 v_xor_b32 v39, 96, v7
 s_waitcnt vmcnt(10) lgkmcnt(0)
 v_mfma_f32_16x16x32_bf16 v[144:147], a[16:19], a[80:83], 0
 s_barrier
 s_add_u32 s15, s14, 917504
 ds_read_b64_tr_b16 a[192:193], v36 offset:16384
 ds_read_b64_tr_b16 a[194:195], v36 offset:18432
 ds_read_b128 v[32:35], v44 offset:1792
 v_mfma_f32_16x16x32_bf16 v[144:147], a[48:51], a[88:91], v[144:147]
 s_add_u32 m0, s18, 0
 ds_read_b64_tr_b16 a[224:225], v36 offset:24576
 ds_read_b64_tr_b16 a[226:227], v36 offset:26624
 v_mfma_f32_16x16x32_bf16 v[148:151], a[48:51], a[92:95], 0
 buffer_load_dwordx4 v8, s[28:31], s15 offen lds
 v_mfma_f32_16x16x32_bf16 v[148:151], a[16:19], a[84:87], v[148:151]
 ds_read_b64_tr_b16 a[196:197], v37 offset:16384
 v_bfe_u32 v25, v2, 1, 2
 v_mfma_f32_16x16x32_bf16 v[156:159], a[20:23], a[84:87], 0
 ds_read_b64_tr_b16 a[198:199], v37 offset:18432
 ds_read_b64_tr_b16 a[228:229], v37 offset:24576
 v_mfma_f32_16x16x32_bf16 v[156:159], a[52:55], a[92:95], v[156:159]
 buffer_load_dwordx4 a[128:131], v1, s[24:27], s12 offen sc1
 v_mfma_f32_16x16x32_bf16 v[152:155], a[52:55], a[88:91], 0
 ds_read_b64_tr_b16 a[230:231], v37 offset:26624
 v_and_b32 v24, 1, v2
 v_mfma_f32_16x16x32_bf16 v[152:155], a[20:23], a[80:83], v[152:155]
 ds_read_b64_tr_b16 a[200:201], v38 offset:16384
 ds_read_b64_tr_b16 a[202:203], v38 offset:18432
 v_mfma_f32_16x16x32_bf16 v[160:163], a[24:27], a[80:83], 0
 s_add_u32 m0, s18, 1024
 ds_read_b64_tr_b16 a[232:233], v38 offset:24576
 ds_read_b64_tr_b16 a[234:235], v38 offset:26624
 v_mfma_f32_16x16x32_bf16 v[160:163], a[56:59], a[88:91], v[160:163]
 buffer_load_dwordx4 v9, s[28:31], s15 offen lds
 v_lshl_or_b32 v25, v25, 7, v24
 v_mfma_f32_16x16x32_bf16 v[164:167], a[56:59], a[92:95], 0
 ds_read_b64_tr_b16 a[204:205], v39 offset:16384
 v_lshlrev_b32 v25, 10, v25
 v_mfma_f32_16x16x32_bf16 v[164:167], a[24:27], a[84:87], v[164:167]
 ds_read_b64_tr_b16 a[206:207], v39 offset:18432
 ds_read_b64_tr_b16 a[236:237], v39 offset:24576
 v_mfma_f32_16x16x32_bf16 v[172:175], a[28:31], a[84:87], 0
 s_bfe_u32 s6, s2, 0x10004
 buffer_load_dwordx4 a[132:135], v1, s[24:27], s12 offen offset:1024 sc1
 v_mfma_f32_16x16x32_bf16 v[172:175], a[60:63], a[92:95], v[172:175]
 s_add_u32 s70, s6, s3
 ds_read_b64_tr_b16 a[238:239], v39 offset:26624
 v_and_b32 v24, 4294705151, v25
 v_mfma_f32_16x16x32_bf16 v[168:171], a[60:63], a[88:91], 0
 s_min_u32 s7, s3, 1
 ds_read_b64_tr_b16 a[208:209], v36 offset:20480
 ds_read_b64_tr_b16 a[210:211], v36 offset:22528
 v_mfma_f32_16x16x32_bf16 v[168:171], a[28:31], a[80:83], v[168:171]
 s_branch L_tp_L_tB_9_o
L_tp_L_tB_9:
 s_nop 0
 s_branch L_tp_L_tB_11
 s_nop 0
L_tp_L_tB_9_o:
 s_add_u32 m0, s18, 2048
 ds_read_b64_tr_b16 a[240:241], v36 offset:28672
 ds_read_b64_tr_b16 a[242:243], v36 offset:30720
 v_mfma_f32_16x16x32_bf16 v[112:115], a[32:35], a[80:83], 0
 s_mul_i32 s70, s70, s7
 buffer_load_dwordx4 v10, s[28:31], s15 offen lds
 v_fmac_f32 v200, v12, v28
 v_mfma_f32_16x16x32_bf16 v[112:115], a[64:67], a[88:91], v[112:115]
 s_lshl1_add_u32 s6, s7, s6
 ds_read_b64_tr_b16 a[212:213], v37 offset:20480
 v_fmac_f32 v201, v13, v28
 v_mfma_f32_16x16x32_bf16 v[116:119], a[64:67], a[92:95], 0
 s_andn2_b32 s7, 8, s2
 ds_read_b64_tr_b16 a[214:215], v37 offset:22528
 ds_read_b64_tr_b16 a[244:245], v37 offset:28672
 v_mfma_f32_16x16x32_bf16 v[116:119], a[32:35], a[84:87], v[116:119]
 s_add_u32 s70, s70, s7
 ds_read_b64_tr_b16 a[246:247], v37 offset:30720
 v_fmac_f32 v202, v14, v28
 v_mfma_f32_16x16x32_bf16 v[124:127], a[36:39], a[84:87], 0
 s_and_b32 s64, s2, 0xc6
 buffer_load_dwordx4 a[136:139], v1, s[24:27], s12 offen offset:2048 sc1
 v_fmac_f32 v203, v15, v28
 v_mfma_f32_16x16x32_bf16 v[124:127], a[68:71], a[92:95], v[124:127]
 s_and_b32 s7, s2, 1
 ds_read_b64_tr_b16 a[216:217], v38 offset:20480
 ds_read_b64_tr_b16 a[218:219], v38 offset:22528
 v_mfma_f32_16x16x32_bf16 v[120:123], a[68:71], a[88:91], 0
 s_add_u32 m0, s18, 3072
 ds_read_b64_tr_b16 a[248:249], v38 offset:28672
 ds_read_b64_tr_b16 a[250:251], v38 offset:30720
 v_mfma_f32_16x16x32_bf16 v[120:123], a[36:39], a[80:83], v[120:123]
 s_lshl1_add_u32 s64, s64, s7
 buffer_load_dwordx4 v11, s[28:31], s15 offen lds
 v_mfma_f32_16x16x32_bf16 v[128:131], a[40:43], a[80:83], 0
 s_lshl4_add_u32 s64, s64, s6
 ds_read_b64_tr_b16 a[220:221], v39 offset:20480
 v_mul_f32 v240, v200, v200
 v_mfma_f32_16x16x32_bf16 v[128:131], a[72:75], a[88:91], v[128:131]
 s_lshl_b32 s64, s64, 10
 ds_read_b64_tr_b16 a[222:223], v39 offset:22528
 ds_read_b64_tr_b16 a[252:253], v39 offset:28672
 v_mfma_f32_16x16x32_bf16 v[132:135], a[72:75], a[92:95], 0
 s_add_u32 s64, s64, 20972544
 ds_read_b64_tr_b16 a[254:255], v39 offset:30720
 v_mul_f32 v241, v201, v201
 v_mfma_f32_16x16x32_bf16 v[132:135], a[40:43], a[84:87], v[132:135]
 buffer_load_dwordx4 a[140:143], v1, s[24:27], s12 offen offset:3072 sc1
 v_mul_f32 v242, v202, v202
 v_mfma_f32_16x16x32_bf16 v[140:143], a[44:47], a[84:87], 0
 ds_read_b128 v[192:195], v26 offset:4096
 v_mul_f32 v243, v203, v203
 v_mfma_f32_16x16x32_bf16 v[140:143], a[76:79], a[92:95], v[140:143]
 v_fma_f32 v240, v240, v30, v29
 v_fma_f32 v241, v241, v30, v29
 v_mfma_f32_16x16x32_bf16 v[136:139], a[76:79], a[88:91], 0
 v_fma_f32 v242, v242, v30, v29
 v_mfma_f32_16x16x32_bf16 v[136:139], a[44:47], a[80:83], v[136:139]
 s_add_u32 s12, s12, 4096
 v_fma_f32 v243, v243, v30, v29
 v_mul_f32 v240, v240, v200
 s_waitcnt vmcnt(14) lgkmcnt(0)
 v_mfma_f32_16x16x32_bf16 v[144:147], a[192:195], a[96:99], v[144:147]
 s_barrier
 s_add_u32 s15, s14, 1048576
 ds_read_b64_tr_b16 a[16:17], v36 offset:32768
 ds_read_b64_tr_b16 a[18:19], v36 offset:34816
 v_mfma_f32_16x16x32_bf16 v[144:147], a[224:227], a[104:107], v[144:147]
 s_add_u32 m0, s18, 16384
 ds_read_b64_tr_b16 a[48:49], v36 offset:40960
 ds_read_b64_tr_b16 a[50:51], v36 offset:43008
 v_mfma_f32_16x16x32_bf16 v[148:151], a[224:227], a[108:111], v[148:151]
 buffer_load_dwordx4 v8, s[28:31], s15 offen lds
 v_mul_f32 v241, v241, v201
 v_mfma_f32_16x16x32_bf16 v[148:151], a[192:195], a[100:103], v[148:151]
 ds_read_b64_tr_b16 a[20:21], v37 offset:32768
 v_mul_f32 v242, v242, v202
 v_mfma_f32_16x16x32_bf16 v[156:159], a[196:199], a[100:103], v[156:159]
 ds_read_b64_tr_b16 a[22:23], v37 offset:34816
 ds_read_b64_tr_b16 a[52:53], v37 offset:40960
 v_mfma_f32_16x16x32_bf16 v[156:159], a[228:231], a[108:111], v[156:159]
 buffer_load_dwordx4 a[80:83], v1, s[24:27], s12 offen sc1
 v_mul_f32 v243, v243, v203
 v_mfma_f32_16x16x32_bf16 v[152:155], a[228:231], a[104:107], v[152:155]
 ds_read_b64_tr_b16 a[54:55], v37 offset:43008
 v_mfma_f32_16x16x32_bf16 v[152:155], a[196:199], a[96:99], v[152:155]
 ds_read_b64_tr_b16 a[24:25], v38 offset:32768
 ds_read_b64_tr_b16 a[26:27], v38 offset:34816
 v_mfma_f32_16x16x32_bf16 v[160:163], a[200:203], a[96:99], v[160:163]
 s_add_u32 m0, s18, 17408
 ds_read_b64_tr_b16 a[56:57], v38 offset:40960
 ds_read_b64_tr_b16 a[58:59], v38 offset:43008
 v_mfma_f32_16x16x32_bf16 v[160:163], a[232:235], a[104:107], v[160:163]
 buffer_load_dwordx4 v9, s[28:31], s15 offen lds
 v_exp_f32 v240, v240
 v_mfma_f32_16x16x32_bf16 v[164:167], a[232:235], a[108:111], v[164:167]
 ds_read_b64_tr_b16 a[28:29], v39 offset:32768
 v_mfma_f32_16x16x32_bf16 v[164:167], a[200:203], a[100:103], v[164:167]
 ds_read_b64_tr_b16 a[30:31], v39 offset:34816
 ds_read_b64_tr_b16 a[60:61], v39 offset:40960
 v_mfma_f32_16x16x32_bf16 v[172:175], a[204:207], a[100:103], v[172:175]
 buffer_load_dwordx4 a[84:87], v1, s[24:27], s12 offen offset:1024 sc1
 v_fmac_f32 v232, v16, v28
 v_mfma_f32_16x16x32_bf16 v[172:175], a[236:239], a[108:111], v[172:175]
 ds_read_b64_tr_b16 a[62:63], v39 offset:43008
 v_mfma_f32_16x16x32_bf16 v[168:171], a[236:239], a[104:107], v[168:171]
 ds_read_b64_tr_b16 a[32:33], v36 offset:36864
 ds_read_b64_tr_b16 a[34:35], v36 offset:38912
 v_mfma_f32_16x16x32_bf16 v[168:171], a[204:207], a[96:99], v[168:171]
 s_add_u32 m0, s18, 18432
 ds_read_b64_tr_b16 a[64:65], v36 offset:45056
 ds_read_b64_tr_b16 a[66:67], v36 offset:47104
 v_mfma_f32_16x16x32_bf16 v[112:115], a[208:211], a[96:99], v[112:115]
 buffer_load_dwordx4 v10, s[28:31], s15 offen lds
 buffer_store_dwordx4 v[192:195], v1, s[24:27], s50 offen sc1
 v_mfma_f32_16x16x32_bf16 v[112:115], a[240:243], a[104:107], v[112:115]
 ds_read_b64_tr_b16 a[36:37], v37 offset:36864
 v_exp_f32 v241, v241
 v_mfma_f32_16x16x32_bf16 v[116:119], a[240:243], a[108:111], v[116:119]
 ds_read_b64_tr_b16 a[38:39], v37 offset:38912
 ds_read_b64_tr_b16 a[68:69], v37 offset:45056
 v_mfma_f32_16x16x32_bf16 v[116:119], a[208:211], a[100:103], v[116:119]
 ds_read_b64_tr_b16 a[70:71], v37 offset:47104
 v_mfma_f32_16x16x32_bf16 v[124:127], a[212:215], a[100:103], v[124:127]
 buffer_load_dwordx4 a[88:91], v1, s[24:27], s12 offen offset:2048 sc1
 v_fmac_f32 v233, v17, v28
 v_mfma_f32_16x16x32_bf16 v[124:127], a[244:247], a[108:111], v[124:127]
 ds_read_b64_tr_b16 a[40:41], v38 offset:36864
 ds_read_b64_tr_b16 a[42:43], v38 offset:38912
 v_mfma_f32_16x16x32_bf16 v[120:123], a[244:247], a[104:107], v[120:123]
 s_add_u32 m0, s18, 19456
 ds_read_b64_tr_b16 a[72:73], v38 offset:45056
 ds_read_b64_tr_b16 a[74:75], v38 offset:47104
 v_mfma_f32_16x16x32_bf16 v[120:123], a[212:215], a[96:99], v[120:123]
 buffer_load_dwordx4 v11, s[28:31], s15 offen lds
 v_mfma_f32_16x16x32_bf16 v[128:131], a[216:219], a[96:99], v[128:131]
 ds_read_b64_tr_b16 a[44:45], v39 offset:36864
 v_exp_f32 v242, v242
 v_mfma_f32_16x16x32_bf16 v[128:131], a[248:251], a[104:107], v[128:131]
 ds_read_b64_tr_b16 a[46:47], v39 offset:38912
 ds_read_b64_tr_b16 a[76:77], v39 offset:45056
 v_mfma_f32_16x16x32_bf16 v[132:135], a[248:251], a[108:111], v[132:135]
 ds_read_b64_tr_b16 a[78:79], v39 offset:47104
 v_mfma_f32_16x16x32_bf16 v[132:135], a[216:219], a[100:103], v[132:135]
 buffer_load_dwordx4 a[92:95], v1, s[24:27], s12 offen offset:3072 sc1
 v_fmac_f32 v234, v18, v28
 v_mfma_f32_16x16x32_bf16 v[140:143], a[220:223], a[100:103], v[140:143]
 v_exp_f32 v243, v243
 v_mfma_f32_16x16x32_bf16 v[140:143], a[252:255], a[108:111], v[140:143]
 v_fmac_f32 v235, v19, v28
 v_fma_f32 v240, v240, v31, v31
 v_mfma_f32_16x16x32_bf16 v[136:139], a[252:255], a[104:107], v[136:139]
 v_fma_f32 v241, v241, v31, v31
 v_fma_f32 v242, v242, v31, v31
 v_mfma_f32_16x16x32_bf16 v[136:139], a[220:223], a[96:99], v[136:139]
 s_add_u32 s12, s12, 4096
 v_fma_f32 v243, v243, v31, v31
 s_waitcnt vmcnt(19) lgkmcnt(0)
 v_mfma_f32_16x16x32_bf16 v[144:147], a[16:19], a[112:115], v[144:147]
 s_barrier
 ds_read_b64_tr_b16 a[192:193], v36 offset:49152
 ds_read_b64_tr_b16 a[194:195], v36 offset:51200
 v_mfma_f32_16x16x32_bf16 v[144:147], a[48:51], a[120:123], v[144:147]
 s_mov_b64 exec, 1
 buffer_store_dword v3, off, s[24:27], s23 offset:128 sc1
 s_mov_b64 exec, -1
 s_add_u32 s15, s14, 1703936
 v_rcp_f32 v240, v240
 v_mfma_f32_16x16x32_bf16 v[148:151], a[48:51], a[124:127], v[148:151]
 s_add_u32 m0, s18, 32768
 ds_read_b64_tr_b16 a[224:225], v36 offset:57344
 ds_read_b64_tr_b16 a[226:227], v36 offset:59392
 v_mfma_f32_16x16x32_bf16 v[148:151], a[16:19], a[116:119], v[148:151]
 buffer_load_dwordx4 v8, s[28:31], s15 offen lds
 v_mfma_f32_16x16x32_bf16 v[156:159], a[20:23], a[116:119], v[156:159]
 ds_read_b64_tr_b16 a[196:197], v37 offset:49152
 ds_read_b64_tr_b16 a[198:199], v37 offset:51200
 v_mfma_f32_16x16x32_bf16 v[156:159], a[52:55], a[124:127], v[156:159]
 ds_read_b64_tr_b16 a[228:229], v37 offset:57344
 v_mul_f32 v232, v232, v200
 v_mfma_f32_16x16x32_bf16 v[152:155], a[52:55], a[120:123], v[152:155]
 buffer_load_dwordx4 a[96:99], v1, s[24:27], s12 offen sc1
 v_mfma_f32_16x16x32_bf16 v[152:155], a[20:23], a[112:115], v[152:155]
 ds_read_b64_tr_b16 a[230:231], v37 offset:59392
 ds_read_b64_tr_b16 a[200:201], v38 offset:49152
 v_mfma_f32_16x16x32_bf16 v[160:163], a[24:27], a[112:115], v[160:163]
 ds_read_b64_tr_b16 a[202:203], v38 offset:51200
 ds_read_b64_tr_b16 a[232:233], v38 offset:57344
 v_mfma_f32_16x16x32_bf16 v[160:163], a[56:59], a[120:123], v[160:163]
 s_add_u32 m0, s18, 33792
 ds_read_b64_tr_b16 a[234:235], v38 offset:59392
 v_rcp_f32 v241, v241
 v_mfma_f32_16x16x32_bf16 v[164:167], a[56:59], a[124:127], v[164:167]
 buffer_load_dwordx4 v9, s[28:31], s15 offen lds
 v_mfma_f32_16x16x32_bf16 v[164:167], a[24:27], a[116:119], v[164:167]
 ds_read_b64_tr_b16 a[204:205], v39 offset:49152
 ds_read_b64_tr_b16 a[206:207], v39 offset:51200
 v_mfma_f32_16x16x32_bf16 v[172:175], a[28:31], a[116:119], v[172:175]
 ds_read_b64_tr_b16 a[236:237], v39 offset:57344
 ds_read_b64_tr_b16 a[238:239], v39 offset:59392
 v_mfma_f32_16x16x32_bf16 v[172:175], a[60:63], a[124:127], v[172:175]
 buffer_load_dwordx4 a[100:103], v1, s[24:27], s12 offen offset:1024 sc1
 v_mul_f32 v233, v233, v201
 v_mfma_f32_16x16x32_bf16 v[168:171], a[60:63], a[120:123], v[168:171]
 ds_read_b64_tr_b16 a[208:209], v36 offset:53248
 v_mfma_f32_16x16x32_bf16 v[168:171], a[28:31], a[112:115], v[168:171]
 ds_read_b64_tr_b16 a[210:211], v36 offset:55296
 ds_read_b64_tr_b16 a[240:241], v36 offset:61440
 v_mfma_f32_16x16x32_bf16 v[112:115], a[32:35], a[112:115], v[112:115]
 s_add_u32 m0, s18, 34816
 ds_read_b64_tr_b16 a[242:243], v36 offset:63488
 ds_read_b64_tr_b16 a[212:213], v37 offset:53248
 v_mfma_f32_16x16x32_bf16 v[112:115], a[64:67], a[120:123], v[112:115]
 buffer_load_dwordx4 v10, s[28:31], s15 offen lds
 v_rcp_f32 v242, v242
 v_mfma_f32_16x16x32_bf16 v[116:119], a[64:67], a[124:127], v[116:119]
 ds_read_b64_tr_b16 a[214:215], v37 offset:55296
 v_mfma_f32_16x16x32_bf16 v[116:119], a[32:35], a[116:119], v[116:119]
 ds_read_b64_tr_b16 a[244:245], v37 offset:61440
 ds_read_b64_tr_b16 a[246:247], v37 offset:63488
 v_mfma_f32_16x16x32_bf16 v[124:127], a[36:39], a[116:119], v[124:127]
 buffer_load_dwordx4 a[104:107], v1, s[24:27], s12 offen offset:2048 sc1
 v_mul_f32 v234, v234, v202
 v_mfma_f32_16x16x32_bf16 v[124:127], a[68:71], a[124:127], v[124:127]
 ds_read_b64_tr_b16 a[216:217], v38 offset:53248
 ds_read_b64_tr_b16 a[218:219], v38 offset:55296
 v_mfma_f32_16x16x32_bf16 v[120:123], a[68:71], a[120:123], v[120:123]
 ds_read_b64_tr_b16 a[248:249], v38 offset:61440
 v_mfma_f32_16x16x32_bf16 v[120:123], a[36:39], a[112:115], v[120:123]
 s_add_u32 m0, s18, 35840
 ds_read_b64_tr_b16 a[250:251], v38 offset:63488
 ds_read_b64_tr_b16 a[220:221], v39 offset:53248
 v_mfma_f32_16x16x32_bf16 v[128:131], a[40:43], a[112:115], v[128:131]
 buffer_load_dwordx4 v11, s[28:31], s15 offen lds
 v_rcp_f32 v243, v243
 v_mfma_f32_16x16x32_bf16 v[128:131], a[72:75], a[120:123], v[128:131]
 ds_read_b64_tr_b16 a[222:223], v39 offset:55296
 ds_read_b64_tr_b16 a[252:253], v39 offset:61440
 v_mfma_f32_16x16x32_bf16 v[132:135], a[72:75], a[124:127], v[132:135]
 ds_read_b64_tr_b16 a[254:255], v39 offset:63488
 v_mfma_f32_16x16x32_bf16 v[132:135], a[40:43], a[116:119], v[132:135]
 buffer_load_dwordx4 a[108:111], v1, s[24:27], s12 offen offset:3072 sc1
 v_mul_f32 v235, v235, v203
 v_mfma_f32_16x16x32_bf16 v[140:143], a[44:47], a[116:119], v[140:143]
 v_mul_f32 v232, v232, v240
 v_mul_f32 v233, v233, v241
 v_mfma_f32_16x16x32_bf16 v[140:143], a[76:79], a[124:127], v[140:143]
 v_mul_f32 v234, v234, v242
 v_mul_f32 v235, v235, v243
 v_mfma_f32_16x16x32_bf16 v[136:139], a[76:79], a[120:123], v[136:139]
 v_cvt_pk_bf16_f32 v200, v232, v233
 v_cvt_pk_bf16_f32 v201, v234, v235
 v_mfma_f32_16x16x32_bf16 v[136:139], a[44:47], a[112:115], v[136:139]
 s_add_u32 s12, s12, 4096
 ds_write_b64 v27, v[200:201] offset:6144
 s_cmp_lt_u32 s70, 2
 s_cbranch_scc1 L_gat
L_gat_d:
 s_waitcnt vmcnt(18) lgkmcnt(0)
 v_mfma_f32_16x16x32_bf16 v[144:147], a[192:195], a[128:131], v[144:147]
 s_barrier
 s_add_u32 s15, s14, 1441792
 ds_read_b64_tr_b16 a[16:17], v36 offset:0
 ds_read_b64_tr_b16 a[18:19], v36 offset:2048
 v_mfma_f32_16x16x32_bf16 v[144:147], a[224:227], a[136:139], v[144:147]
 s_add_u32 m0, s18, 49152
 ds_read_b64_tr_b16 a[48:49], v36 offset:8192
 ds_read_b64_tr_b16 a[50:51], v36 offset:10240
 v_mfma_f32_16x16x32_bf16 v[148:151], a[224:227], a[140:143], v[148:151]
 buffer_load_dwordx4 v8, s[28:31], s15 offen lds
 v_fmac_f32 v204, v12, v32
 v_mfma_f32_16x16x32_bf16 v[148:151], a[192:195], a[132:135], v[148:151]
 ds_read_b64_tr_b16 a[20:21], v37 offset:0
 v_fmac_f32 v205, v13, v32
 v_mfma_f32_16x16x32_bf16 v[156:159], a[196:199], a[132:135], v[156:159]
 ds_read_b64_tr_b16 a[22:23], v37 offset:2048
 ds_read_b64_tr_b16 a[52:53], v37 offset:8192
 v_mfma_f32_16x16x32_bf16 v[156:159], a[228:231], a[140:143], v[156:159]
 buffer_load_dwordx4 a[112:115], v1, s[24:27], s12 offen sc1
 v_fmac_f32 v206, v14, v32
 v_mfma_f32_16x16x32_bf16 v[152:155], a[228:231], a[136:139], v[152:155]
 ds_read_b64_tr_b16 a[54:55], v37 offset:10240
 v_fmac_f32 v207, v15, v32
 v_mfma_f32_16x16x32_bf16 v[152:155], a[196:199], a[128:131], v[152:155]
 ds_read_b64_tr_b16 a[24:25], v38 offset:0
 ds_read_b64_tr_b16 a[26:27], v38 offset:2048
 v_mfma_f32_16x16x32_bf16 v[160:163], a[200:203], a[128:131], v[160:163]
 s_add_u32 m0, s18, 50176
 ds_read_b64_tr_b16 a[56:57], v38 offset:8192
 ds_read_b64_tr_b16 a[58:59], v38 offset:10240
 v_mfma_f32_16x16x32_bf16 v[160:163], a[232:235], a[136:139], v[160:163]
 buffer_load_dwordx4 v9, s[28:31], s15 offen lds
 v_mul_f32 v240, v204, v204
 v_mfma_f32_16x16x32_bf16 v[164:167], a[232:235], a[140:143], v[164:167]
 ds_read_b64_tr_b16 a[28:29], v39 offset:0
 v_mul_f32 v241, v205, v205
 v_mfma_f32_16x16x32_bf16 v[164:167], a[200:203], a[132:135], v[164:167]
 ds_read_b64_tr_b16 a[30:31], v39 offset:2048
 ds_read_b64_tr_b16 a[60:61], v39 offset:8192
 v_mfma_f32_16x16x32_bf16 v[172:175], a[204:207], a[132:135], v[172:175]
 buffer_load_dwordx4 a[116:119], v1, s[24:27], s12 offen offset:1024 sc1
 v_mul_f32 v242, v206, v206
 v_mfma_f32_16x16x32_bf16 v[172:175], a[236:239], a[140:143], v[172:175]
 ds_read_b64_tr_b16 a[62:63], v39 offset:10240
 v_mul_f32 v243, v207, v207
 v_mfma_f32_16x16x32_bf16 v[168:171], a[236:239], a[136:139], v[168:171]
 ds_read_b64_tr_b16 a[32:33], v36 offset:4096
 ds_read_b64_tr_b16 a[34:35], v36 offset:6144
 v_mfma_f32_16x16x32_bf16 v[168:171], a[204:207], a[128:131], v[168:171]
 s_add_u32 m0, s18, 51200
 ds_read_b64_tr_b16 a[64:65], v36 offset:12288
 ds_read_b64_tr_b16 a[66:67], v36 offset:14336
 v_mfma_f32_16x16x32_bf16 v[112:115], a[208:211], a[128:131], v[112:115]
 buffer_load_dwordx4 v10, s[28:31], s15 offen lds
 v_fma_f32 v240, v240, v34, v33
 v_mfma_f32_16x16x32_bf16 v[112:115], a[240:243], a[136:139], v[112:115]
 ds_read_b64_tr_b16 a[36:37], v37 offset:4096
 v_fma_f32 v241, v241, v34, v33
 v_mfma_f32_16x16x32_bf16 v[116:119], a[240:243], a[140:143], v[116:119]
 ds_read_b64_tr_b16 a[38:39], v37 offset:6144
 ds_read_b64_tr_b16 a[68:69], v37 offset:12288
 v_mfma_f32_16x16x32_bf16 v[116:119], a[208:211], a[132:135], v[116:119]
 ds_read_b64_tr_b16 a[70:71], v37 offset:14336
 v_fma_f32 v242, v242, v34, v33
 v_mfma_f32_16x16x32_bf16 v[124:127], a[212:215], a[132:135], v[124:127]
 buffer_load_dwordx4 a[120:123], v1, s[24:27], s12 offen offset:2048 sc1
 v_fma_f32 v243, v243, v34, v33
 v_mfma_f32_16x16x32_bf16 v[124:127], a[244:247], a[140:143], v[124:127]
 ds_read_b64_tr_b16 a[40:41], v38 offset:4096
 ds_read_b64_tr_b16 a[42:43], v38 offset:6144
 v_mfma_f32_16x16x32_bf16 v[120:123], a[244:247], a[136:139], v[120:123]
 s_add_u32 m0, s18, 52224
 ds_read_b64_tr_b16 a[72:73], v38 offset:12288
 ds_read_b64_tr_b16 a[74:75], v38 offset:14336
 v_mfma_f32_16x16x32_bf16 v[120:123], a[212:215], a[128:131], v[120:123]
 buffer_load_dwordx4 v11, s[28:31], s15 offen lds
 v_mul_f32 v240, v240, v204
 v_mfma_f32_16x16x32_bf16 v[128:131], a[216:219], a[128:131], v[128:131]
 ds_read_b64_tr_b16 a[44:45], v39 offset:4096
 v_mul_f32 v241, v241, v205
 v_mfma_f32_16x16x32_bf16 v[128:131], a[248:251], a[136:139], v[128:131]
 ds_read_b64_tr_b16 a[46:47], v39 offset:6144
 ds_read_b64_tr_b16 a[76:77], v39 offset:12288
 v_mfma_f32_16x16x32_bf16 v[132:135], a[248:251], a[140:143], v[132:135]
 ds_read_b64_tr_b16 a[78:79], v39 offset:14336
 v_mul_f32 v242, v242, v206
 v_mfma_f32_16x16x32_bf16 v[132:135], a[216:219], a[132:135], v[132:135]
 buffer_load_dwordx4 a[124:127], v1, s[24:27], s12 offen offset:3072 sc1
 v_mul_f32 v243, v243, v207
 v_mfma_f32_16x16x32_bf16 v[140:143], a[220:223], a[132:135], v[140:143]
 v_exp_f32 v240, v240
 v_mfma_f32_16x16x32_bf16 v[140:143], a[252:255], a[140:143], v[140:143]
 v_fmac_f32 v236, v16, v32
 v_mfma_f32_16x16x32_bf16 v[136:139], a[252:255], a[136:139], v[136:139]
 v_exp_f32 v241, v241
 v_mfma_f32_16x16x32_bf16 v[136:139], a[220:223], a[128:131], v[136:139]
 s_add_u32 s12, s12, 4096
 v_fmac_f32 v237, v17, v32
 s_waitcnt vmcnt(17) lgkmcnt(0)
 v_mfma_f32_16x16x32_bf16 v[144:147], a[16:19], a[80:83], v[144:147]
 s_barrier
 s_add_u32 s15, s14, 1835008
 ds_read_b64_tr_b16 a[192:193], v36 offset:16384
 ds_read_b64_tr_b16 a[194:195], v36 offset:18432
 v_mfma_f32_16x16x32_bf16 v[144:147], a[48:51], a[88:91], v[144:147]
 s_add_u32 m0, s18, 0
 ds_read_b64_tr_b16 a[224:225], v36 offset:24576
 ds_read_b64_tr_b16 a[226:227], v36 offset:26624
 v_mfma_f32_16x16x32_bf16 v[148:151], a[48:51], a[92:95], v[148:151]
 buffer_load_dwordx4 v8, s[28:31], s15 offen lds
 v_mfma_f32_16x16x32_bf16 v[148:151], a[16:19], a[84:87], v[148:151]
 ds_read_b64_tr_b16 a[196:197], v37 offset:16384
 v_mfma_f32_16x16x32_bf16 v[156:159], a[20:23], a[84:87], v[156:159]
 ds_read_b64_tr_b16 a[198:199], v37 offset:18432
 ds_read_b64_tr_b16 a[228:229], v37 offset:24576
 v_mfma_f32_16x16x32_bf16 v[156:159], a[52:55], a[92:95], v[156:159]
 buffer_load_dwordx4 a[128:131], v1, s[24:27], s12 offen sc1
 v_mfma_f32_16x16x32_bf16 v[152:155], a[52:55], a[88:91], v[152:155]
 ds_read_b64_tr_b16 a[230:231], v37 offset:26624
 v_mfma_f32_16x16x32_bf16 v[152:155], a[20:23], a[80:83], v[152:155]
 ds_read_b64_tr_b16 a[200:201], v38 offset:16384
 ds_read_b64_tr_b16 a[202:203], v38 offset:18432
 v_mfma_f32_16x16x32_bf16 v[160:163], a[24:27], a[80:83], v[160:163]
 s_add_u32 m0, s18, 1024
 ds_read_b64_tr_b16 a[232:233], v38 offset:24576
 ds_read_b64_tr_b16 a[234:235], v38 offset:26624
 v_mfma_f32_16x16x32_bf16 v[160:163], a[56:59], a[88:91], v[160:163]
 buffer_load_dwordx4 v9, s[28:31], s15 offen lds
 v_mfma_f32_16x16x32_bf16 v[164:167], a[56:59], a[92:95], v[164:167]
 ds_read_b64_tr_b16 a[204:205], v39 offset:16384
 v_mfma_f32_16x16x32_bf16 v[164:167], a[24:27], a[84:87], v[164:167]
 ds_read_b64_tr_b16 a[206:207], v39 offset:18432
 ds_read_b64_tr_b16 a[236:237], v39 offset:24576
 v_mfma_f32_16x16x32_bf16 v[172:175], a[28:31], a[84:87], v[172:175]
 buffer_load_dwordx4 a[132:135], v1, s[24:27], s12 offen offset:1024 sc1
 v_mfma_f32_16x16x32_bf16 v[172:175], a[60:63], a[92:95], v[172:175]
 ds_read_b64_tr_b16 a[238:239], v39 offset:26624
 v_mfma_f32_16x16x32_bf16 v[168:171], a[60:63], a[88:91], v[168:171]
 ds_read_b64_tr_b16 a[208:209], v36 offset:20480
 ds_read_b64_tr_b16 a[210:211], v36 offset:22528
 v_mfma_f32_16x16x32_bf16 v[168:171], a[28:31], a[80:83], v[168:171]
 s_add_u32 m0, s18, 2048
 ds_read_b64_tr_b16 a[240:241], v36 offset:28672
 ds_read_b64_tr_b16 a[242:243], v36 offset:30720
 v_mfma_f32_16x16x32_bf16 v[112:115], a[32:35], a[80:83], v[112:115]
 buffer_load_dwordx4 v10, s[28:31], s15 offen lds
 v_mfma_f32_16x16x32_bf16 v[112:115], a[64:67], a[88:91], v[112:115]
 ds_read_b64_tr_b16 a[212:213], v37 offset:20480
 v_mfma_f32_16x16x32_bf16 v[116:119], a[64:67], a[92:95], v[116:119]
 ds_read_b64_tr_b16 a[214:215], v37 offset:22528
 ds_read_b64_tr_b16 a[244:245], v37 offset:28672
 v_mfma_f32_16x16x32_bf16 v[116:119], a[32:35], a[84:87], v[116:119]
 ds_read_b64_tr_b16 a[246:247], v37 offset:30720
 v_mfma_f32_16x16x32_bf16 v[124:127], a[36:39], a[84:87], v[124:127]
 buffer_load_dwordx4 a[136:139], v1, s[24:27], s12 offen offset:2048 sc1
 v_mfma_f32_16x16x32_bf16 v[124:127], a[68:71], a[92:95], v[124:127]
 ds_read_b64_tr_b16 a[216:217], v38 offset:20480
 ds_read_b64_tr_b16 a[218:219], v38 offset:22528
 v_mfma_f32_16x16x32_bf16 v[120:123], a[68:71], a[88:91], v[120:123]
 s_add_u32 m0, s18, 3072
 ds_read_b64_tr_b16 a[248:249], v38 offset:28672
 ds_read_b64_tr_b16 a[250:251], v38 offset:30720
 v_mfma_f32_16x16x32_bf16 v[120:123], a[36:39], a[80:83], v[120:123]
 buffer_load_dwordx4 v11, s[28:31], s15 offen lds
 v_mfma_f32_16x16x32_bf16 v[128:131], a[40:43], a[80:83], v[128:131]
 ds_read_b64_tr_b16 a[220:221], v39 offset:20480
 v_mfma_f32_16x16x32_bf16 v[128:131], a[72:75], a[88:91], v[128:131]
 ds_read_b64_tr_b16 a[222:223], v39 offset:22528
 ds_read_b64_tr_b16 a[252:253], v39 offset:28672
 v_mfma_f32_16x16x32_bf16 v[132:135], a[72:75], a[92:95], v[132:135]
 ds_read_b64_tr_b16 a[254:255], v39 offset:30720
 v_mfma_f32_16x16x32_bf16 v[132:135], a[40:43], a[84:87], v[132:135]
 buffer_load_dwordx4 a[140:143], v1, s[24:27], s12 offen offset:3072 sc1
 v_mfma_f32_16x16x32_bf16 v[140:143], a[44:47], a[84:87], v[140:143]
 v_exp_f32 v242, v242
 v_mfma_f32_16x16x32_bf16 v[140:143], a[76:79], a[92:95], v[140:143]
 v_fmac_f32 v238, v18, v32
 v_mfma_f32_16x16x32_bf16 v[136:139], a[76:79], a[88:91], v[136:139]
 v_exp_f32 v243, v243
 v_mfma_f32_16x16x32_bf16 v[136:139], a[44:47], a[80:83], v[136:139]
 s_add_u32 s12, s12, 4096
 v_fmac_f32 v239, v19, v32
 v_fma_f32 v240, v240, v35, v35
 s_waitcnt vmcnt(15) lgkmcnt(0)
 s_cmp_lt_u32 s70, 2
 s_cbranch_scc1 L_red
L_red_d:
 v_mfma_f32_16x16x32_bf16 v[144:147], a[192:195], a[96:99], v[144:147]
 s_barrier
 s_add_u32 s15, s14, 1966080
 ds_read_b64_tr_b16 a[16:17], v36 offset:32768
 ds_read_b64_tr_b16 a[18:19], v36 offset:34816
 v_mfma_f32_16x16x32_bf16 v[144:147], a[224:227], a[104:107], v[144:147]
 s_add_u32 m0, s18, 16384
 ds_read_b64_tr_b16 a[48:49], v36 offset:40960
 ds_read_b64_tr_b16 a[50:51], v36 offset:43008
 v_mfma_f32_16x16x32_bf16 v[148:151], a[224:227], a[108:111], v[148:151]
 buffer_load_dwordx4 v8, s[28:31], s15 offen lds
 v_fma_f32 v241, v241, v35, v35
 v_mfma_f32_16x16x32_bf16 v[148:151], a[192:195], a[100:103], v[148:151]
 ds_read_b64_tr_b16 a[20:21], v37 offset:32768
 v_fma_f32 v242, v242, v35, v35
 v_mfma_f32_16x16x32_bf16 v[156:159], a[196:199], a[100:103], v[156:159]
 ds_read_b64_tr_b16 a[22:23], v37 offset:34816
 ds_read_b64_tr_b16 a[52:53], v37 offset:40960
 v_mfma_f32_16x16x32_bf16 v[156:159], a[228:231], a[108:111], v[156:159]
 buffer_load_dwordx4 a[80:83], v1, s[24:27], s12 offen sc1
 v_fma_f32 v243, v243, v35, v35
 v_mfma_f32_16x16x32_bf16 v[152:155], a[228:231], a[104:107], v[152:155]
 ds_read_b64_tr_b16 a[54:55], v37 offset:43008
 v_mfma_f32_16x16x32_bf16 v[152:155], a[196:199], a[96:99], v[152:155]
 ds_read_b64_tr_b16 a[24:25], v38 offset:32768
 ds_read_b64_tr_b16 a[26:27], v38 offset:34816
 v_mfma_f32_16x16x32_bf16 v[160:163], a[200:203], a[96:99], v[160:163]
 s_add_u32 m0, s18, 17408
 ds_read_b64_tr_b16 a[56:57], v38 offset:40960
 ds_read_b64_tr_b16 a[58:59], v38 offset:43008
 v_mfma_f32_16x16x32_bf16 v[160:163], a[232:235], a[104:107], v[160:163]
 buffer_load_dwordx4 v9, s[28:31], s15 offen lds
 v_mfma_f32_16x16x32_bf16 v[164:167], a[232:235], a[108:111], v[164:167]
 ds_read_b64_tr_b16 a[28:29], v39 offset:32768
 v_mfma_f32_16x16x32_bf16 v[164:167], a[200:203], a[100:103], v[164:167]
 ds_read_b64_tr_b16 a[30:31], v39 offset:34816
 ds_read_b64_tr_b16 a[60:61], v39 offset:40960
 v_mfma_f32_16x16x32_bf16 v[172:175], a[204:207], a[100:103], v[172:175]
 buffer_load_dwordx4 a[84:87], v1, s[24:27], s12 offen offset:1024 sc1
 v_mfma_f32_16x16x32_bf16 v[172:175], a[236:239], a[108:111], v[172:175]
 ds_read_b64_tr_b16 a[62:63], v39 offset:43008
 v_mfma_f32_16x16x32_bf16 v[168:171], a[236:239], a[104:107], v[168:171]
 ds_read_b64_tr_b16 a[32:33], v36 offset:36864
 ds_read_b64_tr_b16 a[34:35], v36 offset:38912
 v_mfma_f32_16x16x32_bf16 v[168:171], a[204:207], a[96:99], v[168:171]
 s_add_u32 m0, s18, 18432
 ds_read_b64_tr_b16 a[64:65], v36 offset:45056
 ds_read_b64_tr_b16 a[66:67], v36 offset:47104
 v_mfma_f32_16x16x32_bf16 v[112:115], a[208:211], a[96:99], v[112:115]
 buffer_load_dwordx4 v10, s[28:31], s15 offen lds
 v_mfma_f32_16x16x32_bf16 v[112:115], a[240:243], a[104:107], v[112:115]
 ds_read_b64_tr_b16 a[36:37], v37 offset:36864
 v_mfma_f32_16x16x32_bf16 v[116:119], a[240:243], a[108:111], v[116:119]
 ds_read_b64_tr_b16 a[38:39], v37 offset:38912
 ds_read_b64_tr_b16 a[68:69], v37 offset:45056
 v_mfma_f32_16x16x32_bf16 v[116:119], a[208:211], a[100:103], v[116:119]
 ds_read_b64_tr_b16 a[70:71], v37 offset:47104
 v_mfma_f32_16x16x32_bf16 v[124:127], a[212:215], a[100:103], v[124:127]
 buffer_load_dwordx4 a[88:91], v1, s[24:27], s12 offen offset:2048 sc1
 v_mfma_f32_16x16x32_bf16 v[124:127], a[244:247], a[108:111], v[124:127]
 ds_read_b64_tr_b16 a[40:41], v38 offset:36864
 ds_read_b64_tr_b16 a[42:43], v38 offset:38912
 v_mfma_f32_16x16x32_bf16 v[120:123], a[244:247], a[104:107], v[120:123]
 s_add_u32 m0, s18, 19456
 ds_read_b64_tr_b16 a[72:73], v38 offset:45056
 ds_read_b64_tr_b16 a[74:75], v38 offset:47104
 v_mfma_f32_16x16x32_bf16 v[120:123], a[212:215], a[96:99], v[120:123]
 buffer_load_dwordx4 v11, s[28:31], s15 offen lds
 v_mfma_f32_16x16x32_bf16 v[128:131], a[216:219], a[96:99], v[128:131]
 ds_read_b64_tr_b16 a[44:45], v39 offset:36864
 v_mfma_f32_16x16x32_bf16 v[128:131], a[248:251], a[104:107], v[128:131]
 ds_read_b64_tr_b16 a[46:47], v39 offset:38912
 ds_read_b64_tr_b16 a[76:77], v39 offset:45056
 v_mfma_f32_16x16x32_bf16 v[132:135], a[248:251], a[108:111], v[132:135]
 ds_read_b64_tr_b16 a[78:79], v39 offset:47104
 v_mfma_f32_16x16x32_bf16 v[132:135], a[216:219], a[100:103], v[132:135]
 buffer_load_dwordx4 a[92:95], v1, s[24:27], s12 offen offset:3072 sc1
 v_mfma_f32_16x16x32_bf16 v[140:143], a[220:223], a[100:103], v[140:143]
 v_rcp_f32 v240, v240
 v_mfma_f32_16x16x32_bf16 v[140:143], a[252:255], a[108:111], v[140:143]
 v_mul_f32 v236, v236, v204
 v_mfma_f32_16x16x32_bf16 v[136:139], a[252:255], a[104:107], v[136:139]
 v_rcp_f32 v241, v241
 v_mul_f32 v237, v237, v205
 v_rcp_f32 v242, v242
 v_mul_f32 v238, v238, v206
 v_rcp_f32 v243, v243
 v_mul_f32 v239, v239, v207
 v_mul_f32 v236, v236, v240
 v_mul_f32 v237, v237, v241
 v_mul_f32 v238, v238, v242
 v_mul_f32 v239, v239, v243
 v_cvt_pk_bf16_f32 v202, v236, v237
 v_cvt_pk_bf16_f32 v203, v238, v239
 v_mfma_f32_16x16x32_bf16 v[136:139], a[220:223], a[96:99], v[136:139]
 s_add_u32 s12, s12, 4096
 ds_write_b64 v27, v[202:203] offset:7168
 s_waitcnt vmcnt(16) lgkmcnt(0)
 v_mfma_f32_16x16x32_bf16 v[144:147], a[16:19], a[112:115], v[144:147]
 s_barrier
 s_add_u32 s15, s14, 2621440
 ds_read_b64_tr_b16 a[192:193], v36 offset:49152
 ds_read_b64_tr_b16 a[194:195], v36 offset:51200
 v_mfma_f32_16x16x32_bf16 v[144:147], a[48:51], a[120:123], v[144:147]
 s_add_u32 m0, s18, 32768
 ds_read_b64_tr_b16 a[224:225], v36 offset:57344
 ds_read_b64_tr_b16 a[226:227], v36 offset:59392
 v_mfma_f32_16x16x32_bf16 v[148:151], a[48:51], a[124:127], v[148:151]
 buffer_load_dwordx4 v8, s[28:31], s15 offen lds
 v_mfma_f32_16x16x32_bf16 v[148:151], a[16:19], a[116:119], v[148:151]
 s_branch L_tp_L_tB_10_o
L_tp_L_tB_10:
 s_nop 0
 s_nop 0
 s_branch L_tr11
L_tp_L_tB_10_o:
 ds_read_b64_tr_b16 a[196:197], v37 offset:49152
 v_mfma_f32_16x16x32_bf16 v[156:159], a[20:23], a[116:119], v[156:159]
 ds_read_b64_tr_b16 a[198:199], v37 offset:51200
 ds_read_b64_tr_b16 a[228:229], v37 offset:57344
 v_mfma_f32_16x16x32_bf16 v[156:159], a[52:55], a[124:127], v[156:159]
 buffer_load_dwordx4 a[96:99], v1, s[24:27], s12 offen sc1
 v_mfma_f32_16x16x32_bf16 v[152:155], a[52:55], a[120:123], v[152:155]
 ds_read_b64_tr_b16 a[230:231], v37 offset:59392
 v_mfma_f32_16x16x32_bf16 v[152:155], a[20:23], a[112:115], v[152:155]
 ds_read_b64_tr_b16 a[200:201], v38 offset:49152
 ds_read_b64_tr_b16 a[202:203], v38 offset:51200
 v_mfma_f32_16x16x32_bf16 v[160:163], a[24:27], a[112:115], v[160:163]
 s_add_u32 m0, s18, 33792
 ds_read_b64_tr_b16 a[232:233], v38 offset:57344
 ds_read_b64_tr_b16 a[234:235], v38 offset:59392
 v_mfma_f32_16x16x32_bf16 v[160:163], a[56:59], a[120:123], v[160:163]
 buffer_load_dwordx4 v9, s[28:31], s15 offen lds
 v_mfma_f32_16x16x32_bf16 v[164:167], a[56:59], a[124:127], v[164:167]
 ds_read_b64_tr_b16 a[204:205], v39 offset:49152
 v_mfma_f32_16x16x32_bf16 v[164:167], a[24:27], a[116:119], v[164:167]
 ds_read_b64_tr_b16 a[206:207], v39 offset:51200
 ds_read_b64_tr_b16 a[236:237], v39 offset:57344
 v_mfma_f32_16x16x32_bf16 v[172:175], a[28:31], a[116:119], v[172:175]
 buffer_load_dwordx4 a[100:103], v1, s[24:27], s12 offen offset:1024 sc1
 v_mfma_f32_16x16x32_bf16 v[172:175], a[60:63], a[124:127], v[172:175]
 ds_read_b64_tr_b16 a[238:239], v39 offset:59392
 v_mfma_f32_16x16x32_bf16 v[168:171], a[60:63], a[120:123], v[168:171]
 ds_read_b64_tr_b16 a[208:209], v36 offset:53248
 ds_read_b64_tr_b16 a[210:211], v36 offset:55296
 v_mfma_f32_16x16x32_bf16 v[168:171], a[28:31], a[112:115], v[168:171]
 s_add_u32 m0, s18, 34816
 ds_read_b64_tr_b16 a[240:241], v36 offset:61440
 ds_read_b64_tr_b16 a[242:243], v36 offset:63488
 v_mfma_f32_16x16x32_bf16 v[112:115], a[32:35], a[112:115], v[112:115]
 buffer_load_dwordx4 v10, s[28:31], s15 offen lds
 v_mfma_f32_16x16x32_bf16 v[112:115], a[64:67], a[120:123], v[112:115]
 ds_read_b64_tr_b16 a[212:213], v37 offset:53248
 v_mfma_f32_16x16x32_bf16 v[116:119], a[64:67], a[124:127], v[116:119]
 ds_read_b64_tr_b16 a[214:215], v37 offset:55296
 ds_read_b64_tr_b16 a[244:245], v37 offset:61440
 v_mfma_f32_16x16x32_bf16 v[116:119], a[32:35], a[116:119], v[116:119]
 ds_read_b64_tr_b16 a[246:247], v37 offset:63488
 v_mfma_f32_16x16x32_bf16 v[124:127], a[36:39], a[116:119], v[124:127]
 buffer_load_dwordx4 a[104:107], v1, s[24:27], s12 offen offset:2048 sc1
 v_mfma_f32_16x16x32_bf16 v[124:127], a[68:71], a[124:127], v[124:127]
 ds_read_b64_tr_b16 a[216:217], v38 offset:53248
 ds_read_b64_tr_b16 a[218:219], v38 offset:55296
 v_mfma_f32_16x16x32_bf16 v[120:123], a[68:71], a[120:123], v[120:123]
 s_add_u32 m0, s18, 35840
 ds_read_b64_tr_b16 a[248:249], v38 offset:61440
 ds_read_b64_tr_b16 a[250:251], v38 offset:63488
 v_mfma_f32_16x16x32_bf16 v[120:123], a[36:39], a[112:115], v[120:123]
 buffer_load_dwordx4 v11, s[28:31], s15 offen lds
 v_mfma_f32_16x16x32_bf16 v[128:131], a[40:43], a[112:115], v[128:131]
 ds_read_b64_tr_b16 a[220:221], v39 offset:53248
 v_mfma_f32_16x16x32_bf16 v[128:131], a[72:75], a[120:123], v[128:131]
 ds_read_b64_tr_b16 a[222:223], v39 offset:55296
 ds_read_b64_tr_b16 a[252:253], v39 offset:61440
 v_mfma_f32_16x16x32_bf16 v[132:135], a[72:75], a[124:127], v[132:135]
 ds_read_b64_tr_b16 a[254:255], v39 offset:63488
 v_mfma_f32_16x16x32_bf16 v[132:135], a[40:43], a[116:119], v[132:135]
 buffer_load_dwordx4 a[108:111], v1, s[24:27], s12 offen offset:3072 sc1
 v_mfma_f32_16x16x32_bf16 v[140:143], a[44:47], a[116:119], v[140:143]
 ds_read_b128 v[200:203], v26 offset:6144
 v_mfma_f32_16x16x32_bf16 v[140:143], a[76:79], a[124:127], v[140:143]
 v_mfma_f32_16x16x32_bf16 v[136:139], a[76:79], a[120:123], v[136:139]
 v_mfma_f32_16x16x32_bf16 v[136:139], a[44:47], a[112:115], v[136:139]
 s_add_u32 s12, s12, 4096
 s_waitcnt vmcnt(16) lgkmcnt(0)
 v_mfma_f32_16x16x32_bf16 v[144:147], a[192:195], a[128:131], v[144:147]
 s_barrier
 s_add_u32 s15, s14, 2359296
 ds_read_b64_tr_b16 a[16:17], v36 offset:0
 ds_read_b64_tr_b16 a[18:19], v36 offset:2048
 v_mfma_f32_16x16x32_bf16 v[144:147], a[224:227], a[136:139], v[144:147]
 s_add_u32 m0, s18, 49152
 ds_read_b64_tr_b16 a[48:49], v36 offset:8192
 ds_read_b64_tr_b16 a[50:51], v36 offset:10240
 v_mfma_f32_16x16x32_bf16 v[148:151], a[224:227], a[140:143], v[148:151]
 buffer_load_dwordx4 v8, s[28:31], s15 offen lds
 v_mfma_f32_16x16x32_bf16 v[148:151], a[192:195], a[132:135], v[148:151]
 ds_read_b64_tr_b16 a[20:21], v37 offset:0
 v_mfma_f32_16x16x32_bf16 v[156:159], a[196:199], a[132:135], v[156:159]
 ds_read_b64_tr_b16 a[22:23], v37 offset:2048
 ds_read_b64_tr_b16 a[52:53], v37 offset:8192
 v_mfma_f32_16x16x32_bf16 v[156:159], a[228:231], a[140:143], v[156:159]
 buffer_load_dwordx4 a[112:115], v1, s[24:27], s12 offen sc1
 v_mfma_f32_16x16x32_bf16 v[152:155], a[228:231], a[136:139], v[152:155]
 ds_read_b64_tr_b16 a[54:55], v37 offset:10240
 v_mfma_f32_16x16x32_bf16 v[152:155], a[196:199], a[128:131], v[152:155]
 ds_read_b64_tr_b16 a[24:25], v38 offset:0
 ds_read_b64_tr_b16 a[26:27], v38 offset:2048
 v_mfma_f32_16x16x32_bf16 v[160:163], a[200:203], a[128:131], v[160:163]
 s_add_u32 m0, s18, 50176
 ds_read_b64_tr_b16 a[56:57], v38 offset:8192
 ds_read_b64_tr_b16 a[58:59], v38 offset:10240
 v_mfma_f32_16x16x32_bf16 v[160:163], a[232:235], a[136:139], v[160:163]
 buffer_load_dwordx4 v9, s[28:31], s15 offen lds
 v_mfma_f32_16x16x32_bf16 v[164:167], a[232:235], a[140:143], v[164:167]
 ds_read_b64_tr_b16 a[28:29], v39 offset:0
 v_mfma_f32_16x16x32_bf16 v[164:167], a[200:203], a[132:135], v[164:167]
 ds_read_b64_tr_b16 a[30:31], v39 offset:2048
 ds_read_b64_tr_b16 a[60:61], v39 offset:8192
 v_mfma_f32_16x16x32_bf16 v[172:175], a[204:207], a[132:135], v[172:175]
 buffer_load_dwordx4 a[116:119], v1, s[24:27], s12 offen offset:1024 sc1
 v_mfma_f32_16x16x32_bf16 v[172:175], a[236:239], a[140:143], v[172:175]
 ds_read_b64_tr_b16 a[62:63], v39 offset:10240
 v_mfma_f32_16x16x32_bf16 v[168:171], a[236:239], a[136:139], v[168:171]
 ds_read_b64_tr_b16 a[32:33], v36 offset:4096
 ds_read_b64_tr_b16 a[34:35], v36 offset:6144
 v_mfma_f32_16x16x32_bf16 v[168:171], a[204:207], a[128:131], v[168:171]
 s_add_u32 m0, s18, 51200
 ds_read_b64_tr_b16 a[64:65], v36 offset:12288
 ds_read_b64_tr_b16 a[66:67], v36 offset:14336
 v_mfma_f32_16x16x32_bf16 v[112:115], a[208:211], a[128:131], v[112:115]
 buffer_load_dwordx4 v10, s[28:31], s15 offen lds
 buffer_store_dwordx4 v[200:203], v1, s[24:27], s51 offen sc1
 v_mfma_f32_16x16x32_bf16 v[112:115], a[240:243], a[136:139], v[112:115]
 ds_read_b64_tr_b16 a[36:37], v37 offset:4096
 v_mfma_f32_16x16x32_bf16 v[116:119], a[240:243], a[140:143], v[116:119]
 ds_read_b64_tr_b16 a[38:39], v37 offset:6144
 ds_read_b64_tr_b16 a[68:69], v37 offset:12288
 v_mfma_f32_16x16x32_bf16 v[116:119], a[208:211], a[132:135], v[116:119]
 ds_read_b64_tr_b16 a[70:71], v37 offset:14336
 v_mfma_f32_16x16x32_bf16 v[124:127], a[212:215], a[132:135], v[124:127]
 buffer_load_dwordx4 a[120:123], v1, s[24:27], s12 offen offset:2048 sc1
 v_mfma_f32_16x16x32_bf16 v[124:127], a[244:247], a[140:143], v[124:127]
 ds_read_b64_tr_b16 a[40:41], v38 offset:4096
 ds_read_b64_tr_b16 a[42:43], v38 offset:6144
 v_mfma_f32_16x16x32_bf16 v[120:123], a[244:247], a[136:139], v[120:123]
 s_add_u32 m0, s18, 52224
 ds_read_b64_tr_b16 a[72:73], v38 offset:12288
 ds_read_b64_tr_b16 a[74:75], v38 offset:14336
 v_mfma_f32_16x16x32_bf16 v[120:123], a[212:215], a[128:131], v[120:123]
 buffer_load_dwordx4 v11, s[28:31], s15 offen lds
 v_mfma_f32_16x16x32_bf16 v[128:131], a[216:219], a[128:131], v[128:131]
 ds_read_b64_tr_b16 a[44:45], v39 offset:4096
 v_mfma_f32_16x16x32_bf16 v[128:131], a[248:251], a[136:139], v[128:131]
 ds_read_b64_tr_b16 a[46:47], v39 offset:6144
 ds_read_b64_tr_b16 a[76:77], v39 offset:12288
 v_mfma_f32_16x16x32_bf16 v[132:135], a[248:251], a[140:143], v[132:135]
 ds_read_b64_tr_b16 a[78:79], v39 offset:14336
 v_mfma_f32_16x16x32_bf16 v[132:135], a[216:219], a[132:135], v[132:135]
 buffer_load_dwordx4 a[124:127], v1, s[24:27], s12 offen offset:3072 sc1
 v_mfma_f32_16x16x32_bf16 v[140:143], a[220:223], a[132:135], v[140:143]
 v_mfma_f32_16x16x32_bf16 v[140:143], a[252:255], a[140:143], v[140:143]
 v_mfma_f32_16x16x32_bf16 v[136:139], a[252:255], a[136:139], v[136:139]
 v_mfma_f32_16x16x32_bf16 v[136:139], a[220:223], a[128:131], v[136:139]
 s_add_u32 s12, s12, 4096
 s_waitcnt vmcnt(17) lgkmcnt(0)
 v_mfma_f32_16x16x32_bf16 v[144:147], a[16:19], a[80:83], v[144:147]
 s_barrier
 s_add_u32 s15, s14, 2752512
 ds_read_b64_tr_b16 a[192:193], v36 offset:16384
 ds_read_b64_tr_b16 a[194:195], v36 offset:18432
 v_mfma_f32_16x16x32_bf16 v[144:147], a[48:51], a[88:91], v[144:147]
 s_add_u32 m0, s18, 0
 ds_read_b64_tr_b16 a[224:225], v36 offset:24576
 ds_read_b64_tr_b16 a[226:227], v36 offset:26624
 v_mfma_f32_16x16x32_bf16 v[148:151], a[48:51], a[92:95], v[148:151]
 buffer_load_dwordx4 v8, s[28:31], s15 offen lds
 v_mfma_f32_16x16x32_bf16 v[148:151], a[16:19], a[84:87], v[148:151]
 ds_read_b64_tr_b16 a[196:197], v37 offset:16384
 v_mfma_f32_16x16x32_bf16 v[156:159], a[20:23], a[84:87], v[156:159]
 ds_read_b64_tr_b16 a[198:199], v37 offset:18432
 ds_read_b64_tr_b16 a[228:229], v37 offset:24576
 v_mfma_f32_16x16x32_bf16 v[156:159], a[52:55], a[92:95], v[156:159]
 buffer_load_dwordx4 a[128:131], v1, s[24:27], s12 offen sc1
 v_mfma_f32_16x16x32_bf16 v[152:155], a[52:55], a[88:91], v[152:155]
 ds_read_b64_tr_b16 a[230:231], v37 offset:26624
 v_mfma_f32_16x16x32_bf16 v[152:155], a[20:23], a[80:83], v[152:155]
 ds_read_b64_tr_b16 a[200:201], v38 offset:16384
 ds_read_b64_tr_b16 a[202:203], v38 offset:18432
 v_mfma_f32_16x16x32_bf16 v[160:163], a[24:27], a[80:83], v[160:163]
 s_add_u32 m0, s18, 1024
 ds_read_b64_tr_b16 a[232:233], v38 offset:24576
 ds_read_b64_tr_b16 a[234:235], v38 offset:26624
 v_mfma_f32_16x16x32_bf16 v[160:163], a[56:59], a[88:91], v[160:163]
 buffer_load_dwordx4 v9, s[28:31], s15 offen lds
 v_mfma_f32_16x16x32_bf16 v[164:167], a[56:59], a[92:95], v[164:167]
 ds_read_b64_tr_b16 a[204:205], v39 offset:16384
 v_mfma_f32_16x16x32_bf16 v[164:167], a[24:27], a[84:87], v[164:167]
 ds_read_b64_tr_b16 a[206:207], v39 offset:18432
 ds_read_b64_tr_b16 a[236:237], v39 offset:24576
 v_mfma_f32_16x16x32_bf16 v[172:175], a[28:31], a[84:87], v[172:175]
 buffer_load_dwordx4 a[132:135], v1, s[24:27], s12 offen offset:1024 sc1
 v_mfma_f32_16x16x32_bf16 v[172:175], a[60:63], a[92:95], v[172:175]
 ds_read_b64_tr_b16 a[238:239], v39 offset:26624
 v_mfma_f32_16x16x32_bf16 v[168:171], a[60:63], a[88:91], v[168:171]
 ds_read_b64_tr_b16 a[208:209], v36 offset:20480
 ds_read_b64_tr_b16 a[210:211], v36 offset:22528
 v_mfma_f32_16x16x32_bf16 v[168:171], a[28:31], a[80:83], v[168:171]
 s_add_u32 m0, s18, 2048
 ds_read_b64_tr_b16 a[240:241], v36 offset:28672
 ds_read_b64_tr_b16 a[242:243], v36 offset:30720
 v_mfma_f32_16x16x32_bf16 v[112:115], a[32:35], a[80:83], v[112:115]
 buffer_load_dwordx4 v10, s[28:31], s15 offen lds
 v_mfma_f32_16x16x32_bf16 v[112:115], a[64:67], a[88:91], v[112:115]
 ds_read_b64_tr_b16 a[212:213], v37 offset:20480
 v_mfma_f32_16x16x32_bf16 v[116:119], a[64:67], a[92:95], v[116:119]
 ds_read_b64_tr_b16 a[214:215], v37 offset:22528
 ds_read_b64_tr_b16 a[244:245], v37 offset:28672
 v_mfma_f32_16x16x32_bf16 v[116:119], a[32:35], a[84:87], v[116:119]
 ds_read_b64_tr_b16 a[246:247], v37 offset:30720
 v_mfma_f32_16x16x32_bf16 v[124:127], a[36:39], a[84:87], v[124:127]
 buffer_load_dwordx4 a[136:139], v1, s[24:27], s12 offen offset:2048 sc1
 v_mfma_f32_16x16x32_bf16 v[124:127], a[68:71], a[92:95], v[124:127]
 ds_read_b64_tr_b16 a[216:217], v38 offset:20480
 ds_read_b64_tr_b16 a[218:219], v38 offset:22528
 v_mfma_f32_16x16x32_bf16 v[120:123], a[68:71], a[88:91], v[120:123]
 s_add_u32 m0, s18, 3072
 ds_read_b64_tr_b16 a[248:249], v38 offset:28672
 ds_read_b64_tr_b16 a[250:251], v38 offset:30720
 v_mfma_f32_16x16x32_bf16 v[120:123], a[36:39], a[80:83], v[120:123]
 buffer_load_dwordx4 v11, s[28:31], s15 offen lds
 v_mfma_f32_16x16x32_bf16 v[128:131], a[40:43], a[80:83], v[128:131]
 ds_read_b64_tr_b16 a[220:221], v39 offset:20480
 v_mfma_f32_16x16x32_bf16 v[128:131], a[72:75], a[88:91], v[128:131]
 ds_read_b64_tr_b16 a[222:223], v39 offset:22528
 ds_read_b64_tr_b16 a[252:253], v39 offset:28672
 v_mfma_f32_16x16x32_bf16 v[132:135], a[72:75], a[92:95], v[132:135]
 ds_read_b64_tr_b16 a[254:255], v39 offset:30720
 v_mfma_f32_16x16x32_bf16 v[132:135], a[40:43], a[84:87], v[132:135]
 buffer_load_dwordx4 a[140:143], v1, s[24:27], s12 offen offset:3072 sc1
 v_mfma_f32_16x16x32_bf16 v[140:143], a[44:47], a[84:87], v[140:143]
 v_mfma_f32_16x16x32_bf16 v[140:143], a[76:79], a[92:95], v[140:143]
 v_mfma_f32_16x16x32_bf16 v[136:139], a[76:79], a[88:91], v[136:139]
 v_mfma_f32_16x16x32_bf16 v[136:139], a[44:47], a[80:83], v[136:139]
 s_add_u32 s12, s12, 4096
 s_waitcnt vmcnt(17) lgkmcnt(0)
 v_mfma_f32_16x16x32_bf16 v[144:147], a[192:195], a[96:99], v[144:147]
 s_barrier
 s_add_u32 s15, s14, 2883584
 ds_read_b64_tr_b16 a[16:17], v36 offset:32768
 ds_read_b64_tr_b16 a[18:19], v36 offset:34816
 v_mfma_f32_16x16x32_bf16 v[144:147], a[224:227], a[104:107], v[144:147]
 s_add_u32 m0, s18, 16384
 ds_read_b64_tr_b16 a[48:49], v36 offset:40960
 ds_read_b64_tr_b16 a[50:51], v36 offset:43008
 v_mfma_f32_16x16x32_bf16 v[148:151], a[224:227], a[108:111], v[148:151]
 buffer_load_dwordx4 v8, s[28:31], s15 offen lds
 v_mfma_f32_16x16x32_bf16 v[148:151], a[192:195], a[100:103], v[148:151]
 ds_read_b64_tr_b16 a[20:21], v37 offset:32768
 v_mfma_f32_16x16x32_bf16 v[156:159], a[196:199], a[100:103], v[156:159]
 ds_read_b64_tr_b16 a[22:23], v37 offset:34816
 ds_read_b64_tr_b16 a[52:53], v37 offset:40960
 v_mfma_f32_16x16x32_bf16 v[156:159], a[228:231], a[108:111], v[156:159]
 buffer_load_dwordx4 a[80:83], v1, s[24:27], s12 offen sc1
 v_mfma_f32_16x16x32_bf16 v[152:155], a[228:231], a[104:107], v[152:155]
 ds_read_b64_tr_b16 a[54:55], v37 offset:43008
 v_mfma_f32_16x16x32_bf16 v[152:155], a[196:199], a[96:99], v[152:155]
 ds_read_b64_tr_b16 a[24:25], v38 offset:32768
 ds_read_b64_tr_b16 a[26:27], v38 offset:34816
 v_mfma_f32_16x16x32_bf16 v[160:163], a[200:203], a[96:99], v[160:163]
 s_add_u32 m0, s18, 17408
 ds_read_b64_tr_b16 a[56:57], v38 offset:40960
 ds_read_b64_tr_b16 a[58:59], v38 offset:43008
 v_mfma_f32_16x16x32_bf16 v[160:163], a[232:235], a[104:107], v[160:163]
 buffer_load_dwordx4 v9, s[28:31], s15 offen lds
 v_mfma_f32_16x16x32_bf16 v[164:167], a[232:235], a[108:111], v[164:167]
 ds_read_b64_tr_b16 a[28:29], v39 offset:32768
 v_mfma_f32_16x16x32_bf16 v[164:167], a[200:203], a[100:103], v[164:167]
 ds_read_b64_tr_b16 a[30:31], v39 offset:34816
 ds_read_b64_tr_b16 a[60:61], v39 offset:40960
 v_mfma_f32_16x16x32_bf16 v[172:175], a[204:207], a[100:103], v[172:175]
 buffer_load_dwordx4 a[84:87], v1, s[24:27], s12 offen offset:1024 sc1
 v_mfma_f32_16x16x32_bf16 v[172:175], a[236:239], a[108:111], v[172:175]
 ds_read_b64_tr_b16 a[62:63], v39 offset:43008
 v_mfma_f32_16x16x32_bf16 v[168:171], a[236:239], a[104:107], v[168:171]
 ds_read_b64_tr_b16 a[32:33], v36 offset:36864
 ds_read_b64_tr_b16 a[34:35], v36 offset:38912
 v_mfma_f32_16x16x32_bf16 v[168:171], a[204:207], a[96:99], v[168:171]
 s_add_u32 m0, s18, 18432
 ds_read_b64_tr_b16 a[64:65], v36 offset:45056
 ds_read_b64_tr_b16 a[66:67], v36 offset:47104
 v_mfma_f32_16x16x32_bf16 v[112:115], a[208:211], a[96:99], v[112:115]
 buffer_load_dwordx4 v10, s[28:31], s15 offen lds
 v_mfma_f32_16x16x32_bf16 v[112:115], a[240:243], a[104:107], v[112:115]
 ds_read_b64_tr_b16 a[36:37], v37 offset:36864
 v_mfma_f32_16x16x32_bf16 v[116:119], a[240:243], a[108:111], v[116:119]
 ds_read_b64_tr_b16 a[38:39], v37 offset:38912
 ds_read_b64_tr_b16 a[68:69], v37 offset:45056
 v_mfma_f32_16x16x32_bf16 v[116:119], a[208:211], a[100:103], v[116:119]
 ds_read_b64_tr_b16 a[70:71], v37 offset:47104
 v_mfma_f32_16x16x32_bf16 v[124:127], a[212:215], a[100:103], v[124:127]
 buffer_load_dwordx4 a[88:91], v1, s[24:27], s12 offen offset:2048 sc1
 v_mfma_f32_16x16x32_bf16 v[124:127], a[244:247], a[108:111], v[124:127]
 ds_read_b64_tr_b16 a[40:41], v38 offset:36864
 ds_read_b64_tr_b16 a[42:43], v38 offset:38912
 v_mfma_f32_16x16x32_bf16 v[120:123], a[244:247], a[104:107], v[120:123]
 s_add_u32 m0, s18, 19456
 ds_read_b64_tr_b16 a[72:73], v38 offset:45056
 ds_read_b64_tr_b16 a[74:75], v38 offset:47104
 v_mfma_f32_16x16x32_bf16 v[120:123], a[212:215], a[96:99], v[120:123]
 buffer_load_dwordx4 v11, s[28:31], s15 offen lds
 v_mfma_f32_16x16x32_bf16 v[128:131], a[216:219], a[96:99], v[128:131]
 ds_read_b64_tr_b16 a[44:45], v39 offset:36864
 v_mfma_f32_16x16x32_bf16 v[128:131], a[248:251], a[104:107], v[128:131]
 ds_read_b64_tr_b16 a[46:47], v39 offset:38912
 ds_read_b64_tr_b16 a[76:77], v39 offset:45056
 v_mfma_f32_16x16x32_bf16 v[132:135], a[248:251], a[108:111], v[132:135]
 ds_read_b64_tr_b16 a[78:79], v39 offset:47104
 v_mfma_f32_16x16x32_bf16 v[132:135], a[216:219], a[100:103], v[132:135]
 buffer_load_dwordx4 a[92:95], v1, s[24:27], s12 offen offset:3072 sc1
 v_mfma_f32_16x16x32_bf16 v[140:143], a[220:223], a[100:103], v[140:143]
 v_mfma_f32_16x16x32_bf16 v[140:143], a[252:255], a[108:111], v[140:143]
 v_mfma_f32_16x16x32_bf16 v[136:139], a[252:255], a[104:107], v[136:139]
 v_mfma_f32_16x16x32_bf16 v[136:139], a[220:223], a[96:99], v[136:139]
 s_add_u32 s12, s12, 4096
 buffer_load_dword v47, v24, s[24:27], s60 offen offset:128 sc1
 s_waitcnt vmcnt(17) lgkmcnt(0)
 v_mfma_f32_16x16x32_bf16 v[144:147], a[16:19], a[112:115], v[144:147]
 s_barrier
 ds_read_b64_tr_b16 a[192:193], v36 offset:49152
 ds_read_b64_tr_b16 a[194:195], v36 offset:51200
 v_mfma_f32_16x16x32_bf16 v[144:147], a[48:51], a[120:123], v[144:147]
 s_mov_b64 exec, 1
 buffer_store_dword v3, off, s[24:27], s23 offset:256 sc1
 s_mov_b64 exec, -1
 s_add_u32 s15, s14, 3538944
 v_mfma_f32_16x16x32_bf16 v[148:151], a[48:51], a[124:127], v[148:151]
 s_add_u32 m0, s18, 32768
 ds_read_b64_tr_b16 a[224:225], v36 offset:57344
 ds_read_b64_tr_b16 a[226:227], v36 offset:59392
 v_mfma_f32_16x16x32_bf16 v[148:151], a[16:19], a[116:119], v[148:151]
 buffer_load_dwordx4 v8, s[28:31], s15 offen lds
 v_mfma_f32_16x16x32_bf16 v[156:159], a[20:23], a[116:119], v[156:159]
 ds_read_b64_tr_b16 a[196:197], v37 offset:49152
 ds_read_b64_tr_b16 a[198:199], v37 offset:51200
 v_mfma_f32_16x16x32_bf16 v[156:159], a[52:55], a[124:127], v[156:159]
 ds_read_b64_tr_b16 a[228:229], v37 offset:57344
 v_mfma_f32_16x16x32_bf16 v[152:155], a[52:55], a[120:123], v[152:155]
 buffer_load_dwordx4 a[96:99], v1, s[24:27], s12 offen sc1
 v_mfma_f32_16x16x32_bf16 v[152:155], a[20:23], a[112:115], v[152:155]
 ds_read_b64_tr_b16 a[230:231], v37 offset:59392
 ds_read_b64_tr_b16 a[200:201], v38 offset:49152
 v_mfma_f32_16x16x32_bf16 v[160:163], a[24:27], a[112:115], v[160:163]
 ds_read_b64_tr_b16 a[202:203], v38 offset:51200
 ds_read_b64_tr_b16 a[232:233], v38 offset:57344
 v_mfma_f32_16x16x32_bf16 v[160:163], a[56:59], a[120:123], v[160:163]
 s_add_u32 m0, s18, 33792
 ds_read_b64_tr_b16 a[234:235], v38 offset:59392
 v_mfma_f32_16x16x32_bf16 v[164:167], a[56:59], a[124:127], v[164:167]
 buffer_load_dwordx4 v9, s[28:31], s15 offen lds
 v_mfma_f32_16x16x32_bf16 v[164:167], a[24:27], a[116:119], v[164:167]
 ds_read_b64_tr_b16 a[204:205], v39 offset:49152
 ds_read_b64_tr_b16 a[206:207], v39 offset:51200
 v_mfma_f32_16x16x32_bf16 v[172:175], a[28:31], a[116:119], v[172:175]
 ds_read_b64_tr_b16 a[236:237], v39 offset:57344
 ds_read_b64_tr_b16 a[238:239], v39 offset:59392
 v_mfma_f32_16x16x32_bf16 v[172:175], a[60:63], a[124:127], v[172:175]
 buffer_load_dwordx4 a[100:103], v1, s[24:27], s12 offen offset:1024 sc1
 v_mfma_f32_16x16x32_bf16 v[168:171], a[60:63], a[120:123], v[168:171]
 ds_read_b64_tr_b16 a[208:209], v36 offset:53248
 v_mfma_f32_16x16x32_bf16 v[168:171], a[28:31], a[112:115], v[168:171]
 ds_read_b64_tr_b16 a[210:211], v36 offset:55296
 ds_read_b64_tr_b16 a[240:241], v36 offset:61440
 v_mfma_f32_16x16x32_bf16 v[112:115], a[32:35], a[112:115], v[112:115]
 s_add_u32 m0, s18, 34816
 ds_read_b64_tr_b16 a[242:243], v36 offset:63488
 ds_read_b64_tr_b16 a[212:213], v37 offset:53248
 v_mfma_f32_16x16x32_bf16 v[112:115], a[64:67], a[120:123], v[112:115]
 buffer_load_dwordx4 v10, s[28:31], s15 offen lds
 v_mfma_f32_16x16x32_bf16 v[116:119], a[64:67], a[124:127], v[116:119]
 ds_read_b64_tr_b16 a[214:215], v37 offset:55296
 v_mfma_f32_16x16x32_bf16 v[116:119], a[32:35], a[116:119], v[116:119]
 ds_read_b64_tr_b16 a[244:245], v37 offset:61440
 ds_read_b64_tr_b16 a[246:247], v37 offset:63488
 v_mfma_f32_16x16x32_bf16 v[124:127], a[36:39], a[116:119], v[124:127]
 buffer_load_dwordx4 a[104:107], v1, s[24:27], s12 offen offset:2048 sc1
 v_mfma_f32_16x16x32_bf16 v[124:127], a[68:71], a[124:127], v[124:127]
 ds_read_b64_tr_b16 a[216:217], v38 offset:53248
 ds_read_b64_tr_b16 a[218:219], v38 offset:55296
 v_mfma_f32_16x16x32_bf16 v[120:123], a[68:71], a[120:123], v[120:123]
 ds_read_b64_tr_b16 a[248:249], v38 offset:61440
 v_mfma_f32_16x16x32_bf16 v[120:123], a[36:39], a[112:115], v[120:123]
 s_add_u32 m0, s18, 35840
 ds_read_b64_tr_b16 a[250:251], v38 offset:63488
 ds_read_b64_tr_b16 a[220:221], v39 offset:53248
 v_mfma_f32_16x16x32_bf16 v[128:131], a[40:43], a[112:115], v[128:131]
 buffer_load_dwordx4 v11, s[28:31], s15 offen lds
 v_mfma_f32_16x16x32_bf16 v[128:131], a[72:75], a[120:123], v[128:131]
 ds_read_b64_tr_b16 a[222:223], v39 offset:55296
 ds_read_b64_tr_b16 a[252:253], v39 offset:61440
 v_mfma_f32_16x16x32_bf16 v[132:135], a[72:75], a[124:127], v[132:135]
 ds_read_b64_tr_b16 a[254:255], v39 offset:63488
 v_mfma_f32_16x16x32_bf16 v[132:135], a[40:43], a[116:119], v[132:135]
 buffer_load_dwordx4 a[108:111], v1, s[24:27], s12 offen offset:3072 sc1
 v_mfma_f32_16x16x32_bf16 v[140:143], a[44:47], a[116:119], v[140:143]
 v_mfma_f32_16x16x32_bf16 v[140:143], a[76:79], a[124:127], v[140:143]
 v_mfma_f32_16x16x32_bf16 v[136:139], a[76:79], a[120:123], v[136:139]
 v_mfma_f32_16x16x32_bf16 v[136:139], a[44:47], a[112:115], v[136:139]
 s_add_u32 s12, s12, 4096
 s_waitcnt vmcnt(18) lgkmcnt(0)
 v_mfma_f32_16x16x32_bf16 v[144:147], a[192:195], a[128:131], v[144:147]
 s_barrier
 s_add_u32 s15, s14, 3276800
 ds_read_b64_tr_b16 a[16:17], v36 offset:0
 ds_read_b64_tr_b16 a[18:19], v36 offset:2048
 v_mfma_f32_16x16x32_bf16 v[144:147], a[224:227], a[136:139], v[144:147]
 s_add_u32 m0, s18, 49152
 ds_read_b64_tr_b16 a[48:49], v36 offset:8192
 ds_read_b64_tr_b16 a[50:51], v36 offset:10240
 v_mfma_f32_16x16x32_bf16 v[148:151], a[224:227], a[140:143], v[148:151]
 buffer_load_dwordx4 v8, s[28:31], s15 offen lds
 v_mfma_f32_16x16x32_bf16 v[148:151], a[192:195], a[132:135], v[148:151]
 ds_read_b64_tr_b16 a[20:21], v37 offset:0
 v_mfma_f32_16x16x32_bf16 v[156:159], a[196:199], a[132:135], v[156:159]
 ds_read_b64_tr_b16 a[22:23], v37 offset:2048
 ds_read_b64_tr_b16 a[52:53], v37 offset:8192
 v_mfma_f32_16x16x32_bf16 v[156:159], a[228:231], a[140:143], v[156:159]
 buffer_load_dwordx4 a[112:115], v1, s[24:27], s12 offen sc1
 v_mfma_f32_16x16x32_bf16 v[152:155], a[228:231], a[136:139], v[152:155]
 ds_read_b64_tr_b16 a[54:55], v37 offset:10240
 v_mfma_f32_16x16x32_bf16 v[152:155], a[196:199], a[128:131], v[152:155]
 ds_read_b64_tr_b16 a[24:25], v38 offset:0
 ds_read_b64_tr_b16 a[26:27], v38 offset:2048
 v_mfma_f32_16x16x32_bf16 v[160:163], a[200:203], a[128:131], v[160:163]
 s_add_u32 m0, s18, 50176
 ds_read_b64_tr_b16 a[56:57], v38 offset:8192
 ds_read_b64_tr_b16 a[58:59], v38 offset:10240
 v_mfma_f32_16x16x32_bf16 v[160:163], a[232:235], a[136:139], v[160:163]
 buffer_load_dwordx4 v9, s[28:31], s15 offen lds
 v_mfma_f32_16x16x32_bf16 v[164:167], a[232:235], a[140:143], v[164:167]
 ds_read_b64_tr_b16 a[28:29], v39 offset:0
 v_mfma_f32_16x16x32_bf16 v[164:167], a[200:203], a[132:135], v[164:167]
 ds_read_b64_tr_b16 a[30:31], v39 offset:2048
 ds_read_b64_tr_b16 a[60:61], v39 offset:8192
 v_mfma_f32_16x16x32_bf16 v[172:175], a[204:207], a[132:135], v[172:175]
 buffer_load_dwordx4 a[116:119], v1, s[24:27], s12 offen offset:1024 sc1
 v_mfma_f32_16x16x32_bf16 v[172:175], a[236:239], a[140:143], v[172:175]
 ds_read_b64_tr_b16 a[62:63], v39 offset:10240
 v_mfma_f32_16x16x32_bf16 v[168:171], a[236:239], a[136:139], v[168:171]
 ds_read_b64_tr_b16 a[32:33], v36 offset:4096
 ds_read_b64_tr_b16 a[34:35], v36 offset:6144
 v_mfma_f32_16x16x32_bf16 v[168:171], a[204:207], a[128:131], v[168:171]
 s_add_u32 m0, s18, 51200
 ds_read_b64_tr_b16 a[64:65], v36 offset:12288
 ds_read_b64_tr_b16 a[66:67], v36 offset:14336
 v_mfma_f32_16x16x32_bf16 v[112:115], a[208:211], a[128:131], v[112:115]
 buffer_load_dwordx4 v10, s[28:31], s15 offen lds
 v_mfma_f32_16x16x32_bf16 v[112:115], a[240:243], a[136:139], v[112:115]
 ds_read_b64_tr_b16 a[36:37], v37 offset:4096
 v_mfma_f32_16x16x32_bf16 v[116:119], a[240:243], a[140:143], v[116:119]
 ds_read_b64_tr_b16 a[38:39], v37 offset:6144
 ds_read_b64_tr_b16 a[68:69], v37 offset:12288
 v_mfma_f32_16x16x32_bf16 v[116:119], a[208:211], a[132:135], v[116:119]
 ds_read_b64_tr_b16 a[70:71], v37 offset:14336
 v_mfma_f32_16x16x32_bf16 v[124:127], a[212:215], a[132:135], v[124:127]
 buffer_load_dwordx4 a[120:123], v1, s[24:27], s12 offen offset:2048 sc1
 v_mfma_f32_16x16x32_bf16 v[124:127], a[244:247], a[140:143], v[124:127]
 ds_read_b64_tr_b16 a[40:41], v38 offset:4096
 ds_read_b64_tr_b16 a[42:43], v38 offset:6144
 v_mfma_f32_16x16x32_bf16 v[120:123], a[244:247], a[136:139], v[120:123]
 s_add_u32 m0, s18, 52224
 ds_read_b64_tr_b16 a[72:73], v38 offset:12288
 ds_read_b64_tr_b16 a[74:75], v38 offset:14336
 v_mfma_f32_16x16x32_bf16 v[120:123], a[212:215], a[128:131], v[120:123]
 buffer_load_dwordx4 v11, s[28:31], s15 offen lds
 v_mfma_f32_16x16x32_bf16 v[128:131], a[216:219], a[128:131], v[128:131]
 ds_read_b64_tr_b16 a[44:45], v39 offset:4096
 v_mfma_f32_16x16x32_bf16 v[128:131], a[248:251], a[136:139], v[128:131]
 ds_read_b64_tr_b16 a[46:47], v39 offset:6144
 ds_read_b64_tr_b16 a[76:77], v39 offset:12288
 v_mfma_f32_16x16x32_bf16 v[132:135], a[248:251], a[140:143], v[132:135]
 ds_read_b64_tr_b16 a[78:79], v39 offset:14336
 v_mfma_f32_16x16x32_bf16 v[132:135], a[216:219], a[132:135], v[132:135]
 buffer_load_dwordx4 a[124:127], v1, s[24:27], s12 offen offset:3072 sc1
 v_mfma_f32_16x16x32_bf16 v[140:143], a[220:223], a[132:135], v[140:143]
 v_mfma_f32_16x16x32_bf16 v[140:143], a[252:255], a[140:143], v[140:143]
 v_mfma_f32_16x16x32_bf16 v[136:139], a[252:255], a[136:139], v[136:139]
 v_mfma_f32_16x16x32_bf16 v[136:139], a[220:223], a[128:131], v[136:139]
 s_add_u32 s12, s12, 4096
 s_waitcnt vmcnt(17) lgkmcnt(0)
 v_mfma_f32_16x16x32_bf16 v[144:147], a[16:19], a[80:83], v[144:147]
 s_barrier
 s_add_u32 s15, s14, 262144
 ds_read_b64_tr_b16 a[192:193], v36 offset:16384
 ds_read_b64_tr_b16 a[194:195], v36 offset:18432
 v_cmp_ne_u32 vcc, 1, v47
 v_mfma_f32_16x16x32_bf16 v[144:147], a[48:51], a[88:91], v[144:147]
 s_add_u32 m0, s18, 0
 ds_read_b64_tr_b16 a[224:225], v36 offset:24576
 ds_read_b64_tr_b16 a[226:227], v36 offset:26624
 v_mfma_f32_16x16x32_bf16 v[148:151], a[48:51], a[92:95], v[148:151]
 buffer_load_dwordx4 v8, s[28:31], s15 offen lds
 s_cbranch_vccnz L_b21_s
L_b21_d:
 v_mfma_f32_16x16x32_bf16 v[148:151], a[16:19], a[84:87], v[148:151]
 ds_read_b64_tr_b16 a[196:197], v37 offset:16384
 v_mfma_f32_16x16x32_bf16 v[156:159], a[20:23], a[84:87], v[156:159]
 ds_read_b64_tr_b16 a[198:199], v37 offset:18432
 ds_read_b64_tr_b16 a[228:229], v37 offset:24576
 v_mfma_f32_16x16x32_bf16 v[156:159], a[52:55], a[92:95], v[156:159]
 buffer_load_dwordx4 a[128:131], v1, s[24:27], s12 offen sc1
 v_mfma_f32_16x16x32_bf16 v[152:155], a[52:55], a[88:91], v[152:155]
 ds_read_b64_tr_b16 a[230:231], v37 offset:26624
 v_mfma_f32_16x16x32_bf16 v[152:155], a[20:23], a[80:83], v[152:155]
 ds_read_b64_tr_b16 a[200:201], v38 offset:16384
 ds_read_b64_tr_b16 a[202:203], v38 offset:18432
 v_mfma_f32_16x16x32_bf16 v[160:163], a[24:27], a[80:83], v[160:163]
 s_add_u32 m0, s18, 1024
 ds_read_b64_tr_b16 a[232:233], v38 offset:24576
 ds_read_b64_tr_b16 a[234:235], v38 offset:26624
 v_mfma_f32_16x16x32_bf16 v[160:163], a[56:59], a[88:91], v[160:163]
 buffer_load_dwordx4 v9, s[28:31], s15 offen lds
 v_mfma_f32_16x16x32_bf16 v[164:167], a[56:59], a[92:95], v[164:167]
 ds_read_b64_tr_b16 a[204:205], v39 offset:16384
 v_mfma_f32_16x16x32_bf16 v[164:167], a[24:27], a[84:87], v[164:167]
 ds_read_b64_tr_b16 a[206:207], v39 offset:18432
 ds_read_b64_tr_b16 a[236:237], v39 offset:24576
 v_mfma_f32_16x16x32_bf16 v[172:175], a[28:31], a[84:87], v[172:175]
 buffer_load_dwordx4 a[132:135], v1, s[24:27], s12 offen offset:1024 sc1
 v_mfma_f32_16x16x32_bf16 v[172:175], a[60:63], a[92:95], v[172:175]
 ds_read_b64_tr_b16 a[238:239], v39 offset:26624
 v_mfma_f32_16x16x32_bf16 v[168:171], a[60:63], a[88:91], v[168:171]
 ds_read_b64_tr_b16 a[208:209], v36 offset:20480
 ds_read_b64_tr_b16 a[210:211], v36 offset:22528
 v_mfma_f32_16x16x32_bf16 v[168:171], a[28:31], a[80:83], v[168:171]
 s_add_u32 m0, s18, 2048
 s_branch L_tp_L_tB_11_o
L_tp_L_tB_11:
 s_nop 0
 s_nop 0
 s_branch L_tr11
L_tp_L_tB_11_o:
 ds_read_b64_tr_b16 a[240:241], v36 offset:28672
 ds_read_b64_tr_b16 a[242:243], v36 offset:30720
 v_mfma_f32_16x16x32_bf16 v[112:115], a[32:35], a[80:83], v[112:115]
 buffer_load_dwordx4 v10, s[28:31], s15 offen lds
 v_mfma_f32_16x16x32_bf16 v[112:115], a[64:67], a[88:91], v[112:115]
 ds_read_b64_tr_b16 a[212:213], v37 offset:20480
 v_mfma_f32_16x16x32_bf16 v[116:119], a[64:67], a[92:95], v[116:119]
 ds_read_b64_tr_b16 a[214:215], v37 offset:22528
 ds_read_b64_tr_b16 a[244:245], v37 offset:28672
 v_mfma_f32_16x16x32_bf16 v[116:119], a[32:35], a[84:87], v[116:119]
 ds_read_b64_tr_b16 a[246:247], v37 offset:30720
 v_mfma_f32_16x16x32_bf16 v[124:127], a[36:39], a[84:87], v[124:127]
 buffer_load_dwordx4 a[136:139], v1, s[24:27], s12 offen offset:2048 sc1
 v_mfma_f32_16x16x32_bf16 v[124:127], a[68:71], a[92:95], v[124:127]
 ds_read_b64_tr_b16 a[216:217], v38 offset:20480
 ds_read_b64_tr_b16 a[218:219], v38 offset:22528
 v_mfma_f32_16x16x32_bf16 v[120:123], a[68:71], a[88:91], v[120:123]
 s_add_u32 m0, s18, 3072
 ds_read_b64_tr_b16 a[248:249], v38 offset:28672
 ds_read_b64_tr_b16 a[250:251], v38 offset:30720
 v_mfma_f32_16x16x32_bf16 v[120:123], a[36:39], a[80:83], v[120:123]
 buffer_load_dwordx4 v11, s[28:31], s15 offen lds
 v_mfma_f32_16x16x32_bf16 v[128:131], a[40:43], a[80:83], v[128:131]
 ds_read_b64_tr_b16 a[220:221], v39 offset:20480
 v_mfma_f32_16x16x32_bf16 v[128:131], a[72:75], a[88:91], v[128:131]
 ds_read_b64_tr_b16 a[222:223], v39 offset:22528
 ds_read_b64_tr_b16 a[252:253], v39 offset:28672
 v_mfma_f32_16x16x32_bf16 v[132:135], a[72:75], a[92:95], v[132:135]
 ds_read_b64_tr_b16 a[254:255], v39 offset:30720
 v_mfma_f32_16x16x32_bf16 v[132:135], a[40:43], a[84:87], v[132:135]
 buffer_load_dwordx4 a[140:143], v1, s[24:27], s12 offen offset:3072 sc1
 v_mfma_f32_16x16x32_bf16 v[140:143], a[44:47], a[84:87], v[140:143]
 v_mfma_f32_16x16x32_bf16 v[140:143], a[76:79], a[92:95], v[140:143]
 v_mfma_f32_16x16x32_bf16 v[136:139], a[76:79], a[88:91], v[136:139]
 v_mfma_f32_16x16x32_bf16 v[136:139], a[44:47], a[80:83], v[136:139]
 s_add_u32 s12, s12, 4096
 s_waitcnt vmcnt(16) lgkmcnt(0)
 v_mfma_f32_16x16x32_bf16 v[144:147], a[192:195], a[96:99], v[144:147]
 s_barrier
 s_add_u32 s15, s14, 655360
 ds_read_b64_tr_b16 a[16:17], v36 offset:32768
 ds_read_b64_tr_b16 a[18:19], v36 offset:34816
 v_mfma_f32_16x16x32_bf16 v[144:147], a[224:227], a[104:107], v[144:147]
 s_add_u32 m0, s18, 16384
 ds_read_b64_tr_b16 a[48:49], v36 offset:40960
 ds_read_b64_tr_b16 a[50:51], v36 offset:43008
 v_mfma_f32_16x16x32_bf16 v[148:151], a[224:227], a[108:111], v[148:151]
 buffer_load_dwordx4 v8, s[28:31], s15 offen lds
 v_mfma_f32_16x16x32_bf16 v[148:151], a[192:195], a[100:103], v[148:151]
 ds_read_b64_tr_b16 a[20:21], v37 offset:32768
 v_mfma_f32_16x16x32_bf16 v[156:159], a[196:199], a[100:103], v[156:159]
 ds_read_b64_tr_b16 a[22:23], v37 offset:34816
 ds_read_b64_tr_b16 a[52:53], v37 offset:40960
 v_mfma_f32_16x16x32_bf16 v[156:159], a[228:231], a[108:111], v[156:159]
 buffer_load_dwordx4 a[80:83], v1, s[24:27], s12 offen sc1
 v_mfma_f32_16x16x32_bf16 v[152:155], a[228:231], a[104:107], v[152:155]
 ds_read_b64_tr_b16 a[54:55], v37 offset:43008
 v_mfma_f32_16x16x32_bf16 v[152:155], a[196:199], a[96:99], v[152:155]
 ds_read_b64_tr_b16 a[24:25], v38 offset:32768
 ds_read_b64_tr_b16 a[26:27], v38 offset:34816
 v_mfma_f32_16x16x32_bf16 v[160:163], a[200:203], a[96:99], v[160:163]
 s_add_u32 m0, s18, 17408
 ds_read_b64_tr_b16 a[56:57], v38 offset:40960
 ds_read_b64_tr_b16 a[58:59], v38 offset:43008
 v_mfma_f32_16x16x32_bf16 v[160:163], a[232:235], a[104:107], v[160:163]
 buffer_load_dwordx4 v9, s[28:31], s15 offen lds
 v_mfma_f32_16x16x32_bf16 v[164:167], a[232:235], a[108:111], v[164:167]
 ds_read_b64_tr_b16 a[28:29], v39 offset:32768
 v_mfma_f32_16x16x32_bf16 v[164:167], a[200:203], a[100:103], v[164:167]
 ds_read_b64_tr_b16 a[30:31], v39 offset:34816
 ds_read_b64_tr_b16 a[60:61], v39 offset:40960
 v_mfma_f32_16x16x32_bf16 v[172:175], a[204:207], a[100:103], v[172:175]
 buffer_load_dwordx4 a[84:87], v1, s[24:27], s12 offen offset:1024 sc1
 v_mfma_f32_16x16x32_bf16 v[172:175], a[236:239], a[108:111], v[172:175]
 ds_read_b64_tr_b16 a[62:63], v39 offset:43008
 v_mfma_f32_16x16x32_bf16 v[168:171], a[236:239], a[104:107], v[168:171]
 ds_read_b64_tr_b16 a[32:33], v36 offset:36864
 ds_read_b64_tr_b16 a[34:35], v36 offset:38912
 v_mfma_f32_16x16x32_bf16 v[168:171], a[204:207], a[96:99], v[168:171]
 s_add_u32 m0, s18, 18432
 ds_read_b64_tr_b16 a[64:65], v36 offset:45056
 ds_read_b64_tr_b16 a[66:67], v36 offset:47104
 v_mfma_f32_16x16x32_bf16 v[112:115], a[208:211], a[96:99], v[112:115]
 buffer_load_dwordx4 v10, s[28:31], s15 offen lds
 v_mfma_f32_16x16x32_bf16 v[112:115], a[240:243], a[104:107], v[112:115]
 ds_read_b64_tr_b16 a[36:37], v37 offset:36864
 v_mfma_f32_16x16x32_bf16 v[116:119], a[240:243], a[108:111], v[116:119]
 ds_read_b64_tr_b16 a[38:39], v37 offset:38912
 ds_read_b64_tr_b16 a[68:69], v37 offset:45056
 v_mfma_f32_16x16x32_bf16 v[116:119], a[208:211], a[100:103], v[116:119]
 ds_read_b64_tr_b16 a[70:71], v37 offset:47104
 v_mfma_f32_16x16x32_bf16 v[124:127], a[212:215], a[100:103], v[124:127]
 buffer_load_dwordx4 a[88:91], v1, s[24:27], s12 offen offset:2048 sc1
 v_mfma_f32_16x16x32_bf16 v[124:127], a[244:247], a[108:111], v[124:127]
 ds_read_b64_tr_b16 a[40:41], v38 offset:36864
 ds_read_b64_tr_b16 a[42:43], v38 offset:38912
 v_mfma_f32_16x16x32_bf16 v[120:123], a[244:247], a[104:107], v[120:123]
 s_add_u32 m0, s18, 19456
 ds_read_b64_tr_b16 a[72:73], v38 offset:45056
 ds_read_b64_tr_b16 a[74:75], v38 offset:47104
 v_mfma_f32_16x16x32_bf16 v[120:123], a[212:215], a[96:99], v[120:123]
 buffer_load_dwordx4 v11, s[28:31], s15 offen lds
 v_mfma_f32_16x16x32_bf16 v[128:131], a[216:219], a[96:99], v[128:131]
 ds_read_b64_tr_b16 a[44:45], v39 offset:36864
 v_mfma_f32_16x16x32_bf16 v[128:131], a[248:251], a[104:107], v[128:131]
 ds_read_b64_tr_b16 a[46:47], v39 offset:38912
 ds_read_b64_tr_b16 a[76:77], v39 offset:45056
 v_mfma_f32_16x16x32_bf16 v[132:135], a[248:251], a[108:111], v[132:135]
 ds_read_b64_tr_b16 a[78:79], v39 offset:47104
 v_mfma_f32_16x16x32_bf16 v[132:135], a[216:219], a[100:103], v[132:135]
 buffer_load_dwordx4 a[92:95], v1, s[24:27], s12 offen offset:3072 sc1
 v_mfma_f32_16x16x32_bf16 v[140:143], a[220:223], a[100:103], v[140:143]
 v_mfma_f32_16x16x32_bf16 v[140:143], a[252:255], a[108:111], v[140:143]
 v_mfma_f32_16x16x32_bf16 v[136:139], a[252:255], a[104:107], v[136:139]
 v_mfma_f32_16x16x32_bf16 v[136:139], a[220:223], a[96:99], v[136:139]
 s_add_u32 s12, s12, 4096
 s_waitcnt vmcnt(16) lgkmcnt(0)
 v_mfma_f32_16x16x32_bf16 v[144:147], a[16:19], a[112:115], v[144:147]
 s_barrier
 s_add_u32 s15, s14, 1179648
 ds_read_b64_tr_b16 a[192:193], v36 offset:49152
 ds_read_b64_tr_b16 a[194:195], v36 offset:51200
 v_mfma_f32_16x16x32_bf16 v[144:147], a[48:51], a[120:123], v[144:147]
 s_add_u32 m0, s18, 32768
 ds_read_b64_tr_b16 a[224:225], v36 offset:57344
 ds_read_b64_tr_b16 a[226:227], v36 offset:59392
 v_mfma_f32_16x16x32_bf16 v[148:151], a[48:51], a[124:127], v[148:151]
 buffer_load_dwordx4 v8, s[28:31], s15 offen lds
 v_add_u32 v40, 4096, v1
 v_mfma_f32_16x16x32_bf16 v[148:151], a[16:19], a[116:119], v[148:151]
 ds_read_b64_tr_b16 a[196:197], v37 offset:49152
 v_and_b32 v4, 15, v2
 v_mfma_f32_16x16x32_bf16 v[156:159], a[20:23], a[116:119], v[156:159]
 ds_read_b64_tr_b16 a[198:199], v37 offset:51200
 ds_read_b64_tr_b16 a[228:229], v37 offset:57344
 v_mfma_f32_16x16x32_bf16 v[156:159], a[52:55], a[124:127], v[156:159]
 buffer_load_dwordx4 a[96:99], v1, s[24:27], s12 offen sc1
 v_lshlrev_b32 v4, 11, v4
 v_mfma_f32_16x16x32_bf16 v[152:155], a[52:55], a[120:123], v[152:155]
 ds_read_b64_tr_b16 a[230:231], v37 offset:59392
 v_bfe_u32 v6, v2, 4, 1
 v_mfma_f32_16x16x32_bf16 v[152:155], a[20:23], a[112:115], v[152:155]
 ds_read_b64_tr_b16 a[200:201], v38 offset:49152
 ds_read_b64_tr_b16 a[202:203], v38 offset:51200
 v_mfma_f32_16x16x32_bf16 v[160:163], a[24:27], a[112:115], v[160:163]
 s_add_u32 m0, s18, 33792
 ds_read_b64_tr_b16 a[232:233], v38 offset:57344
 ds_read_b64_tr_b16 a[234:235], v38 offset:59392
 v_mfma_f32_16x16x32_bf16 v[160:163], a[56:59], a[120:123], v[160:163]
 buffer_load_dwordx4 v9, s[28:31], s15 offen lds
 v_lshl_add_u32 v4, v6, 5, v4
 v_mfma_f32_16x16x32_bf16 v[164:167], a[56:59], a[124:127], v[164:167]
 ds_read_b64_tr_b16 a[204:205], v39 offset:49152
 v_lshrrev_b32 v6, 5, v2
 v_mfma_f32_16x16x32_bf16 v[164:167], a[24:27], a[116:119], v[164:167]
 ds_read_b64_tr_b16 a[206:207], v39 offset:51200
 ds_read_b64_tr_b16 a[236:237], v39 offset:57344
 v_mfma_f32_16x16x32_bf16 v[172:175], a[28:31], a[116:119], v[172:175]
 buffer_load_dwordx4 a[100:103], v1, s[24:27], s12 offen offset:1024 sc1
 v_lshl_add_u32 v42, v6, 4, v4
 v_mfma_f32_16x16x32_bf16 v[172:175], a[60:63], a[124:127], v[172:175]
 ds_read_b64_tr_b16 a[238:239], v39 offset:59392
 v_add_u32 v43, 32768, v42
 v_mfma_f32_16x16x32_bf16 v[168:171], a[60:63], a[120:123], v[168:171]
 ds_read_b64_tr_b16 a[208:209], v36 offset:53248
 ds_read_b64_tr_b16 a[210:211], v36 offset:55296
 v_mfma_f32_16x16x32_bf16 v[168:171], a[28:31], a[112:115], v[168:171]
 s_add_u32 m0, s18, 34816
 ds_read_b64_tr_b16 a[240:241], v36 offset:61440
 ds_read_b64_tr_b16 a[242:243], v36 offset:63488
 v_mfma_f32_16x16x32_bf16 v[112:115], a[32:35], a[112:115], v[112:115]
 buffer_load_dwordx4 v10, s[28:31], s15 offen lds
 v_and_b32 v4, 0x1f0, v1
 v_mfma_f32_16x16x32_bf16 v[112:115], a[64:67], a[120:123], v[112:115]
 ds_read_b64_tr_b16 a[212:213], v37 offset:53248
 v_lshl_add_u32 v41, v6, 3, v4
 v_mfma_f32_16x16x32_bf16 v[116:119], a[64:67], a[124:127], v[116:119]
 ds_read_b64_tr_b16 a[214:215], v37 offset:55296
 ds_read_b64_tr_b16 a[244:245], v37 offset:61440
 v_mfma_f32_16x16x32_bf16 v[116:119], a[32:35], a[116:119], v[116:119]
 ds_read_b64_tr_b16 a[246:247], v37 offset:63488
 v_mfma_f32_16x16x32_bf16 v[124:127], a[36:39], a[116:119], v[124:127]
 s_add_u32 s66, s23, 384
 buffer_load_dwordx4 a[104:107], v1, s[24:27], s12 offen offset:2048 sc1
 v_mfma_f32_16x16x32_bf16 v[124:127], a[68:71], a[124:127], v[124:127]
 ds_read_b64_tr_b16 a[216:217], v38 offset:53248
 ds_read_b64_tr_b16 a[218:219], v38 offset:55296
 v_mfma_f32_16x16x32_bf16 v[120:123], a[68:71], a[120:123], v[120:123]
 s_add_u32 m0, s18, 35840
 ds_read_b64_tr_b16 a[248:249], v38 offset:61440
 ds_read_b64_tr_b16 a[250:251], v38 offset:63488
 v_mfma_f32_16x16x32_bf16 v[120:123], a[36:39], a[112:115], v[120:123]
 buffer_load_dwordx4 v11, s[28:31], s15 offen lds
 v_mfma_f32_16x16x32_bf16 v[128:131], a[40:43], a[112:115], v[128:131]
 ds_read_b64_tr_b16 a[220:221], v39 offset:53248
 v_mfma_f32_16x16x32_bf16 v[128:131], a[72:75], a[120:123], v[128:131]
 ds_read_b64_tr_b16 a[222:223], v39 offset:55296
 ds_read_b64_tr_b16 a[252:253], v39 offset:61440
 v_mfma_f32_16x16x32_bf16 v[132:135], a[72:75], a[124:127], v[132:135]
 ds_read_b64_tr_b16 a[254:255], v39 offset:63488
 v_mfma_f32_16x16x32_bf16 v[132:135], a[40:43], a[116:119], v[132:135]
 buffer_load_dwordx4 a[108:111], v1, s[24:27], s12 offen offset:3072 sc1
 v_mfma_f32_16x16x32_bf16 v[140:143], a[44:47], a[116:119], v[140:143]
 v_mfma_f32_16x16x32_bf16 v[140:143], a[76:79], a[124:127], v[140:143]
 v_mfma_f32_16x16x32_bf16 v[136:139], a[76:79], a[120:123], v[136:139]
 v_mfma_f32_16x16x32_bf16 v[136:139], a[44:47], a[112:115], v[136:139]
 s_add_u32 s12, s12, 4096
 s_waitcnt vmcnt(16) lgkmcnt(0)
 v_mfma_f32_16x16x32_bf16 v[144:147], a[192:195], a[128:131], v[144:147]
 s_barrier
 s_add_u32 s15, s14, 1572864
 ds_read_b64_tr_b16 a[16:17], v36 offset:0
 ds_read_b64_tr_b16 a[18:19], v36 offset:2048
 v_mfma_f32_16x16x32_bf16 v[144:147], a[224:227], a[136:139], v[144:147]
 s_add_u32 m0, s18, 49152
 ds_read_b64_tr_b16 a[48:49], v36 offset:8192
 ds_read_b64_tr_b16 a[50:51], v36 offset:10240
 v_mfma_f32_16x16x32_bf16 v[148:151], a[224:227], a[140:143], v[148:151]
 buffer_load_dwordx4 v8, s[28:31], s15 offen lds
 v_mfma_f32_16x16x32_bf16 v[148:151], a[192:195], a[132:135], v[148:151]
 ds_read_b64_tr_b16 a[20:21], v37 offset:0
 v_mfma_f32_16x16x32_bf16 v[156:159], a[196:199], a[132:135], v[156:159]
 ds_read_b64_tr_b16 a[22:23], v37 offset:2048
 ds_read_b64_tr_b16 a[52:53], v37 offset:8192
 v_mfma_f32_16x16x32_bf16 v[156:159], a[228:231], a[140:143], v[156:159]
 buffer_load_dwordx4 a[112:115], v1, s[24:27], s12 offen sc1
 v_mfma_f32_16x16x32_bf16 v[152:155], a[228:231], a[136:139], v[152:155]
 ds_read_b64_tr_b16 a[54:55], v37 offset:10240
 v_mfma_f32_16x16x32_bf16 v[152:155], a[196:199], a[128:131], v[152:155]
 ds_read_b64_tr_b16 a[24:25], v38 offset:0
 ds_read_b64_tr_b16 a[26:27], v38 offset:2048
 v_mfma_f32_16x16x32_bf16 v[160:163], a[200:203], a[128:131], v[160:163]
 s_add_u32 m0, s18, 50176
 ds_read_b64_tr_b16 a[56:57], v38 offset:8192
 ds_read_b64_tr_b16 a[58:59], v38 offset:10240
 v_mfma_f32_16x16x32_bf16 v[160:163], a[232:235], a[136:139], v[160:163]
 buffer_load_dwordx4 v9, s[28:31], s15 offen lds
 v_mfma_f32_16x16x32_bf16 v[164:167], a[232:235], a[140:143], v[164:167]
 ds_read_b64_tr_b16 a[28:29], v39 offset:0
 v_mfma_f32_16x16x32_bf16 v[164:167], a[200:203], a[132:135], v[164:167]
 ds_read_b64_tr_b16 a[30:31], v39 offset:2048
 ds_read_b64_tr_b16 a[60:61], v39 offset:8192
 v_mfma_f32_16x16x32_bf16 v[172:175], a[204:207], a[132:135], v[172:175]
 buffer_load_dwordx4 a[116:119], v1, s[24:27], s12 offen offset:1024 sc1
 v_mfma_f32_16x16x32_bf16 v[172:175], a[236:239], a[140:143], v[172:175]
 ds_read_b64_tr_b16 a[62:63], v39 offset:10240
 v_mfma_f32_16x16x32_bf16 v[168:171], a[236:239], a[136:139], v[168:171]
 ds_read_b64_tr_b16 a[32:33], v36 offset:4096
 ds_read_b64_tr_b16 a[34:35], v36 offset:6144
 v_mfma_f32_16x16x32_bf16 v[168:171], a[204:207], a[128:131], v[168:171]
 s_add_u32 m0, s18, 51200
 ds_read_b64_tr_b16 a[64:65], v36 offset:12288
 ds_read_b64_tr_b16 a[66:67], v36 offset:14336
 v_mfma_f32_16x16x32_bf16 v[112:115], a[208:211], a[128:131], v[112:115]
 buffer_load_dwordx4 v10, s[28:31], s15 offen lds
 v_mfma_f32_16x16x32_bf16 v[112:115], a[240:243], a[136:139], v[112:115]
 ds_read_b64_tr_b16 a[36:37], v37 offset:4096
 v_mfma_f32_16x16x32_bf16 v[116:119], a[240:243], a[140:143], v[116:119]
 ds_read_b64_tr_b16 a[38:39], v37 offset:6144
 ds_read_b64_tr_b16 a[68:69], v37 offset:12288
 v_mfma_f32_16x16x32_bf16 v[116:119], a[208:211], a[132:135], v[116:119]
 ds_read_b64_tr_b16 a[70:71], v37 offset:14336
 v_mfma_f32_16x16x32_bf16 v[124:127], a[212:215], a[132:135], v[124:127]
 buffer_load_dwordx4 a[120:123], v1, s[24:27], s12 offen offset:2048 sc1
 v_mfma_f32_16x16x32_bf16 v[124:127], a[244:247], a[140:143], v[124:127]
 ds_read_b64_tr_b16 a[40:41], v38 offset:4096
 ds_read_b64_tr_b16 a[42:43], v38 offset:6144
 v_mfma_f32_16x16x32_bf16 v[120:123], a[244:247], a[136:139], v[120:123]
 s_add_u32 m0, s18, 52224
 ds_read_b64_tr_b16 a[72:73], v38 offset:12288
 ds_read_b64_tr_b16 a[74:75], v38 offset:14336
 v_mfma_f32_16x16x32_bf16 v[120:123], a[212:215], a[128:131], v[120:123]
 buffer_load_dwordx4 v11, s[28:31], s15 offen lds
 v_mfma_f32_16x16x32_bf16 v[128:131], a[216:219], a[128:131], v[128:131]
 ds_read_b64_tr_b16 a[44:45], v39 offset:4096
 v_mfma_f32_16x16x32_bf16 v[128:131], a[248:251], a[136:139], v[128:131]
 ds_read_b64_tr_b16 a[46:47], v39 offset:6144
 ds_read_b64_tr_b16 a[76:77], v39 offset:12288
 v_mfma_f32_16x16x32_bf16 v[132:135], a[248:251], a[140:143], v[132:135]
 ds_read_b64_tr_b16 a[78:79], v39 offset:14336
 v_mfma_f32_16x16x32_bf16 v[132:135], a[216:219], a[132:135], v[132:135]
 buffer_load_dwordx4 a[124:127], v1, s[24:27], s12 offen offset:3072 sc1
 v_mfma_f32_16x16x32_bf16 v[140:143], a[220:223], a[132:135], v[140:143]
 v_mfma_f32_16x16x32_bf16 v[140:143], a[252:255], a[140:143], v[140:143]
 v_mfma_f32_16x16x32_bf16 v[136:139], a[252:255], a[136:139], v[136:139]
 v_mfma_f32_16x16x32_bf16 v[136:139], a[220:223], a[128:131], v[136:139]
 s_add_u32 s12, s12, 4096
 s_cmp_eq_u32 s20, 0
 s_cbranch_scc1 L_tail0
 s_branch L_tail1
L_te1:
L_at10:
 s_and_b32 s6, s2, 1
 s_lshl_b32 s6, s6, 7
 v_mov_b32 v44, s6
 v_mov_b32 v45, 1
 s_mov_b64 exec, 1
 global_atomic_add v44, v45, s[62:63] sc1
 s_mov_b64 exec, -1
 s_branch L_at10_d
L_at11:
 s_and_b32 s6, s2, 1
 s_lshl_b32 s6, s6, 7
 v_mov_b32 v44, s6
 v_mov_b32 v45, 1
 s_mov_b64 exec, 1
 global_atomic_add v44, v45, s[62:63] sc1
 s_mov_b64 exec, -1
 s_branch L_at11_d
L_ini1_s:
 s_mov_b32 s0, 0
 s_branch L_ini1_r
L_ini1_l:
 s_sleep 8
L_ini1_r:
 global_load_dword v3, v35, s[62:63] sc1
 s_waitcnt vmcnt(0)
 v_cmp_gt_u32 vcc, 0x80, v3
 s_add_u32 s0, s0, 1
 s_cmp_ge_u32 s0, 524288
 s_cbranch_scc1 L_ini1_d
 s_nop 1
 s_cbranch_vccnz L_ini1_l
 s_branch L_ini1_d
L_b11_s:
 s_mov_b32 s0, 0
 s_branch L_b11_r
L_b11_l:
 s_sleep 8
L_b11_r:
 buffer_load_dword v47, v46, s[24:27], s59 offen sc1
 s_waitcnt vmcnt(0)
 v_cmp_ne_u32 vcc, 1, v47
 s_add_u32 s0, s0, 1
 s_cmp_ge_u32 s0, 524288
 s_cbranch_scc1 L_b11_d
 s_nop 1
 s_cbranch_vccnz L_b11_l
 s_branch L_b11_d
L_b21_s:
 s_mov_b32 s0, 0
 s_branch L_b21_r
L_b21_l:
 s_sleep 8
L_b21_r:
 buffer_load_dword v47, v24, s[24:27], s60 offen offset:128 sc1
 s_waitcnt vmcnt(0)
 v_cmp_ne_u32 vcc, 1, v47
 s_add_u32 s0, s0, 1
 s_cmp_ge_u32 s0, 524288
 s_cbranch_scc1 L_b21_d
 s_nop 1
 s_cbranch_vccnz L_b21_l
 s_branch L_b21_d
 .p2align 12
L_tail0:
 s_waitcnt vmcnt(16) lgkmcnt(0)
 v_mfma_f32_16x16x32_bf16 v[144:147], a[16:19], a[80:83], v[144:147]
 s_barrier
 ds_read_b64_tr_b16 a[192:193], v36 offset:16384
 ds_read_b64_tr_b16 a[194:195], v36 offset:18432
 v_mfma_f32_16x16x32_bf16 v[144:147], a[48:51], a[88:91], v[144:147]
 s_mov_b64 exec, 1
 buffer_store_dword v3, off, s[24:27], s66 sc1
 s_mov_b64 exec, -1
 s_branch L_tp_L_tail0_0_o
L_tp_L_tail0_0:
 s_nop 0
 s_branch L_tp_L_tail0_2
 s_nop 0
L_tp_L_tail0_0_o:
 s_add_u32 s15, s14, 2097152
 v_mfma_f32_16x16x32_bf16 v[148:151], a[48:51], a[92:95], v[148:151]
 s_add_u32 m0, s18, 0
 ds_read_b64_tr_b16 a[224:225], v36 offset:24576
 ds_read_b64_tr_b16 a[226:227], v36 offset:26624
 v_mfma_f32_16x16x32_bf16 v[148:151], a[16:19], a[84:87], v[148:151]
 buffer_load_dwordx4 v8, s[28:31], s15 offen lds
 v_mfma_f32_16x16x32_bf16 v[156:159], a[20:23], a[84:87], v[156:159]
 ds_read_b64_tr_b16 a[196:197], v37 offset:16384
 ds_read_b64_tr_b16 a[198:199], v37 offset:18432
 v_mfma_f32_16x16x32_bf16 v[156:159], a[52:55], a[92:95], v[156:159]
 ds_read_b64_tr_b16 a[228:229], v37 offset:24576
 v_mfma_f32_16x16x32_bf16 v[152:155], a[52:55], a[88:91], v[152:155]
 buffer_load_dwordx4 a[128:131], v1, s[24:27], s12 offen sc1
 v_mfma_f32_16x16x32_bf16 v[152:155], a[20:23], a[80:83], v[152:155]
 ds_read_b64_tr_b16 a[230:231], v37 offset:26624
 ds_read_b64_tr_b16 a[200:201], v38 offset:16384
 v_mfma_f32_16x16x32_bf16 v[160:163], a[24:27], a[80:83], v[160:163]
 ds_read_b64_tr_b16 a[202:203], v38 offset:18432
 ds_read_b64_tr_b16 a[232:233], v38 offset:24576
 v_mfma_f32_16x16x32_bf16 v[160:163], a[56:59], a[88:91], v[160:163]
 s_add_u32 m0, s18, 1024
 ds_read_b64_tr_b16 a[234:235], v38 offset:26624
 v_mfma_f32_16x16x32_bf16 v[164:167], a[56:59], a[92:95], v[164:167]
 buffer_load_dwordx4 v9, s[28:31], s15 offen lds
 v_mfma_f32_16x16x32_bf16 v[164:167], a[24:27], a[84:87], v[164:167]
 ds_read_b64_tr_b16 a[204:205], v39 offset:16384
 ds_read_b64_tr_b16 a[206:207], v39 offset:18432
 v_mfma_f32_16x16x32_bf16 v[172:175], a[28:31], a[84:87], v[172:175]
 ds_read_b64_tr_b16 a[236:237], v39 offset:24576
 ds_read_b64_tr_b16 a[238:239], v39 offset:26624
 v_mfma_f32_16x16x32_bf16 v[172:175], a[60:63], a[92:95], v[172:175]
 buffer_load_dwordx4 a[132:135], v1, s[24:27], s12 offen offset:1024 sc1
 v_mfma_f32_16x16x32_bf16 v[168:171], a[60:63], a[88:91], v[168:171]
 ds_read_b64_tr_b16 a[208:209], v36 offset:20480
 v_mfma_f32_16x16x32_bf16 v[168:171], a[28:31], a[80:83], v[168:171]
 ds_read_b64_tr_b16 a[210:211], v36 offset:22528
 ds_read_b64_tr_b16 a[240:241], v36 offset:28672
 v_mfma_f32_16x16x32_bf16 v[112:115], a[32:35], a[80:83], v[112:115]
 s_add_u32 m0, s18, 2048
 ds_read_b64_tr_b16 a[242:243], v36 offset:30720
 ds_read_b64_tr_b16 a[212:213], v37 offset:20480
 v_mfma_f32_16x16x32_bf16 v[112:115], a[64:67], a[88:91], v[112:115]
 buffer_load_dwordx4 v10, s[28:31], s15 offen lds
 v_mfma_f32_16x16x32_bf16 v[116:119], a[64:67], a[92:95], v[116:119]
 ds_read_b64_tr_b16 a[214:215], v37 offset:22528
 v_mfma_f32_16x16x32_bf16 v[116:119], a[32:35], a[84:87], v[116:119]
 ds_read_b64_tr_b16 a[244:245], v37 offset:28672
 ds_read_b64_tr_b16 a[246:247], v37 offset:30720
 v_mfma_f32_16x16x32_bf16 v[124:127], a[36:39], a[84:87], v[124:127]
 buffer_load_dwordx4 a[136:139], v1, s[24:27], s12 offen offset:2048 sc1
 v_mfma_f32_16x16x32_bf16 v[124:127], a[68:71], a[92:95], v[124:127]
 ds_read_b64_tr_b16 a[216:217], v38 offset:20480
 ds_read_b64_tr_b16 a[218:219], v38 offset:22528
 v_mfma_f32_16x16x32_bf16 v[120:123], a[68:71], a[88:91], v[120:123]
 ds_read_b64_tr_b16 a[248:249], v38 offset:28672
 v_mfma_f32_16x16x32_bf16 v[120:123], a[36:39], a[80:83], v[120:123]
 s_add_u32 m0, s18, 3072
 ds_read_b64_tr_b16 a[250:251], v38 offset:30720
 ds_read_b64_tr_b16 a[220:221], v39 offset:20480
 v_mfma_f32_16x16x32_bf16 v[128:131], a[40:43], a[80:83], v[128:131]
 buffer_load_dwordx4 v11, s[28:31], s15 offen lds
 v_mfma_f32_16x16x32_bf16 v[128:131], a[72:75], a[88:91], v[128:131]
 ds_read_b64_tr_b16 a[222:223], v39 offset:22528
 ds_read_b64_tr_b16 a[252:253], v39 offset:28672
 v_mfma_f32_16x16x32_bf16 v[132:135], a[72:75], a[92:95], v[132:135]
 ds_read_b64_tr_b16 a[254:255], v39 offset:30720
 v_mfma_f32_16x16x32_bf16 v[132:135], a[40:43], a[84:87], v[132:135]
 buffer_load_dwordx4 a[140:143], v1, s[24:27], s12 offen offset:3072 sc1
 v_mfma_f32_16x16x32_bf16 v[140:143], a[44:47], a[84:87], v[140:143]
 v_mfma_f32_16x16x32_bf16 v[140:143], a[76:79], a[92:95], v[140:143]
 v_mfma_f32_16x16x32_bf16 v[136:139], a[76:79], a[88:91], v[136:139]
 v_mfma_f32_16x16x32_bf16 v[136:139], a[44:47], a[80:83], v[136:139]
 s_add_u32 s12, s12, 4096
 s_waitcnt vmcnt(17) lgkmcnt(0)
 v_mfma_f32_16x16x32_bf16 v[144:147], a[192:195], a[96:99], v[144:147]
 s_barrier
 s_add_u32 s15, s14, 2490368
 ds_read_b64_tr_b16 a[16:17], v36 offset:32768
 ds_read_b64_tr_b16 a[18:19], v36 offset:34816
 v_mfma_f32_16x16x32_bf16 v[144:147], a[224:227], a[104:107], v[144:147]
 s_add_u32 m0, s18, 16384
 ds_read_b64_tr_b16 a[48:49], v36 offset:40960
 ds_read_b64_tr_b16 a[50:51], v36 offset:43008
 v_mfma_f32_16x16x32_bf16 v[148:151], a[224:227], a[108:111], v[148:151]
 buffer_load_dwordx4 v8, s[28:31], s15 offen lds
 v_mfma_f32_16x16x32_bf16 v[148:151], a[192:195], a[100:103], v[148:151]
 ds_read_b64_tr_b16 a[20:21], v37 offset:32768
 v_mfma_f32_16x16x32_bf16 v[156:159], a[196:199], a[100:103], v[156:159]
 ds_read_b64_tr_b16 a[22:23], v37 offset:34816
 ds_read_b64_tr_b16 a[52:53], v37 offset:40960
 v_mfma_f32_16x16x32_bf16 v[156:159], a[228:231], a[108:111], v[156:159]
 buffer_load_dwordx4 a[80:83], v1, s[24:27], s12 offen sc1
 v_mfma_f32_16x16x32_bf16 v[152:155], a[228:231], a[104:107], v[152:155]
 ds_read_b64_tr_b16 a[54:55], v37 offset:43008
 v_mfma_f32_16x16x32_bf16 v[152:155], a[196:199], a[96:99], v[152:155]
 ds_read_b64_tr_b16 a[24:25], v38 offset:32768
 ds_read_b64_tr_b16 a[26:27], v38 offset:34816
 v_mfma_f32_16x16x32_bf16 v[160:163], a[200:203], a[96:99], v[160:163]
 s_add_u32 m0, s18, 17408
 ds_read_b64_tr_b16 a[56:57], v38 offset:40960
 ds_read_b64_tr_b16 a[58:59], v38 offset:43008
 v_mfma_f32_16x16x32_bf16 v[160:163], a[232:235], a[104:107], v[160:163]
 buffer_load_dwordx4 v9, s[28:31], s15 offen lds
 v_mfma_f32_16x16x32_bf16 v[164:167], a[232:235], a[108:111], v[164:167]
 ds_read_b64_tr_b16 a[28:29], v39 offset:32768
 v_mfma_f32_16x16x32_bf16 v[164:167], a[200:203], a[100:103], v[164:167]
 ds_read_b64_tr_b16 a[30:31], v39 offset:34816
 ds_read_b64_tr_b16 a[60:61], v39 offset:40960
 v_mfma_f32_16x16x32_bf16 v[172:175], a[204:207], a[100:103], v[172:175]
 buffer_load_dwordx4 a[84:87], v1, s[24:27], s12 offen offset:1024 sc1
 v_mfma_f32_16x16x32_bf16 v[172:175], a[236:239], a[108:111], v[172:175]
 ds_read_b64_tr_b16 a[62:63], v39 offset:43008
 v_mfma_f32_16x16x32_bf16 v[168:171], a[236:239], a[104:107], v[168:171]
 ds_read_b64_tr_b16 a[32:33], v36 offset:36864
 ds_read_b64_tr_b16 a[34:35], v36 offset:38912
 v_mfma_f32_16x16x32_bf16 v[168:171], a[204:207], a[96:99], v[168:171]
 s_add_u32 m0, s18, 18432
 ds_read_b64_tr_b16 a[64:65], v36 offset:45056
 ds_read_b64_tr_b16 a[66:67], v36 offset:47104
 v_mfma_f32_16x16x32_bf16 v[112:115], a[208:211], a[96:99], v[112:115]
 buffer_load_dwordx4 v10, s[28:31], s15 offen lds
 v_mfma_f32_16x16x32_bf16 v[112:115], a[240:243], a[104:107], v[112:115]
 ds_read_b64_tr_b16 a[36:37], v37 offset:36864
 v_mfma_f32_16x16x32_bf16 v[116:119], a[240:243], a[108:111], v[116:119]
 ds_read_b64_tr_b16 a[38:39], v37 offset:38912
 ds_read_b64_tr_b16 a[68:69], v37 offset:45056
 v_mfma_f32_16x16x32_bf16 v[116:119], a[208:211], a[100:103], v[116:119]
 ds_read_b64_tr_b16 a[70:71], v37 offset:47104
 v_mfma_f32_16x16x32_bf16 v[124:127], a[212:215], a[100:103], v[124:127]
 buffer_load_dwordx4 a[88:91], v1, s[24:27], s12 offen offset:2048 sc1
 v_mfma_f32_16x16x32_bf16 v[124:127], a[244:247], a[108:111], v[124:127]
 ds_read_b64_tr_b16 a[40:41], v38 offset:36864
 ds_read_b64_tr_b16 a[42:43], v38 offset:38912
 v_mfma_f32_16x16x32_bf16 v[120:123], a[244:247], a[104:107], v[120:123]
 s_add_u32 m0, s18, 19456
 ds_read_b64_tr_b16 a[72:73], v38 offset:45056
 ds_read_b64_tr_b16 a[74:75], v38 offset:47104
 v_mfma_f32_16x16x32_bf16 v[120:123], a[212:215], a[96:99], v[120:123]
 buffer_load_dwordx4 v11, s[28:31], s15 offen lds
 v_mfma_f32_16x16x32_bf16 v[128:131], a[216:219], a[96:99], v[128:131]
 ds_read_b64_tr_b16 a[44:45], v39 offset:36864
 v_mfma_f32_16x16x32_bf16 v[128:131], a[248:251], a[104:107], v[128:131]
 ds_read_b64_tr_b16 a[46:47], v39 offset:38912
 ds_read_b64_tr_b16 a[76:77], v39 offset:45056
 v_mfma_f32_16x16x32_bf16 v[132:135], a[248:251], a[108:111], v[132:135]
 ds_read_b64_tr_b16 a[78:79], v39 offset:47104
 v_mfma_f32_16x16x32_bf16 v[132:135], a[216:219], a[100:103], v[132:135]
 buffer_load_dwordx4 a[92:95], v1, s[24:27], s12 offen offset:3072 sc1
 v_mfma_f32_16x16x32_bf16 v[140:143], a[220:223], a[100:103], v[140:143]
 v_mfma_f32_16x16x32_bf16 v[140:143], a[252:255], a[108:111], v[140:143]
 v_mfma_f32_16x16x32_bf16 v[136:139], a[252:255], a[104:107], v[136:139]
 v_mfma_f32_16x16x32_bf16 v[136:139], a[220:223], a[96:99], v[136:139]
 s_add_u32 s12, s12, 4096
 buffer_load_dword v47, v24, s[24:27], s60 offen offset:256 sc1
 s_waitcnt vmcnt(18) lgkmcnt(0)
 v_mfma_f32_16x16x32_bf16 v[144:147], a[16:19], a[112:115], v[144:147]
 s_barrier
 s_add_u32 s15, s14, 3014656
 ds_read_b64_tr_b16 a[192:193], v36 offset:49152
 ds_read_b64_tr_b16 a[194:195], v36 offset:51200
 v_mfma_f32_16x16x32_bf16 v[144:147], a[48:51], a[120:123], v[144:147]
 s_add_u32 m0, s18, 32768
 ds_read_b64_tr_b16 a[224:225], v36 offset:57344
 ds_read_b64_tr_b16 a[226:227], v36 offset:59392
 v_mfma_f32_16x16x32_bf16 v[148:151], a[48:51], a[124:127], v[148:151]
 buffer_load_dwordx4 v8, s[28:31], s15 offen lds
 v_and_b32 v4, 1, v2
 v_mfma_f32_16x16x32_bf16 v[148:151], a[16:19], a[116:119], v[148:151]
 ds_read_b64_tr_b16 a[196:197], v37 offset:49152
 v_lshlrev_b32 v4, 4, v4
 v_mfma_f32_16x16x32_bf16 v[156:159], a[20:23], a[116:119], v[156:159]
 ds_read_b64_tr_b16 a[198:199], v37 offset:51200
 ds_read_b64_tr_b16 a[228:229], v37 offset:57344
 v_mfma_f32_16x16x32_bf16 v[156:159], a[52:55], a[124:127], v[156:159]
 buffer_load_dwordx4 a[96:99], v1, s[24:27], s12 offen sc1
 v_mov_b32 v5, 0x3f80
 v_mfma_f32_16x16x32_bf16 v[152:155], a[52:55], a[120:123], v[152:155]
 ds_read_b64_tr_b16 a[230:231], v37 offset:59392
 v_lshlrev_b32 v4, v4, v5
 v_mfma_f32_16x16x32_bf16 v[152:155], a[20:23], a[112:115], v[152:155]
 ds_read_b64_tr_b16 a[200:201], v38 offset:49152
 ds_read_b64_tr_b16 a[202:203], v38 offset:51200
 v_mfma_f32_16x16x32_bf16 v[160:163], a[24:27], a[112:115], v[160:163]
 s_add_u32 m0, s18, 33792
 ds_read_b64_tr_b16 a[232:233], v38 offset:57344
 ds_read_b64_tr_b16 a[234:235], v38 offset:59392
 v_mfma_f32_16x16x32_bf16 v[160:163], a[56:59], a[120:123], v[160:163]
 buffer_load_dwordx4 v9, s[28:31], s15 offen lds
 v_lshrrev_b32 v5, 4, v2
 v_mfma_f32_16x16x32_bf16 v[164:167], a[56:59], a[124:127], v[164:167]
 ds_read_b64_tr_b16 a[204:205], v39 offset:49152
 v_bfe_u32 v6, v2, 1, 3
 v_mfma_f32_16x16x32_bf16 v[164:167], a[24:27], a[116:119], v[164:167]
 ds_read_b64_tr_b16 a[206:207], v39 offset:51200
 ds_read_b64_tr_b16 a[236:237], v39 offset:57344
 v_mfma_f32_16x16x32_bf16 v[172:175], a[28:31], a[116:119], v[172:175]
 buffer_load_dwordx4 a[100:103], v1, s[24:27], s12 offen offset:1024 sc1
 v_lshlrev_b32 v7, 1, v5
 v_mfma_f32_16x16x32_bf16 v[172:175], a[60:63], a[124:127], v[172:175]
 ds_read_b64_tr_b16 a[238:239], v39 offset:59392
 v_sub_u32 v6, v6, v7
 v_mfma_f32_16x16x32_bf16 v[168:171], a[60:63], a[120:123], v[168:171]
 ds_read_b64_tr_b16 a[208:209], v36 offset:53248
 ds_read_b64_tr_b16 a[210:211], v36 offset:55296
 v_mfma_f32_16x16x32_bf16 v[168:171], a[28:31], a[112:115], v[168:171]
 s_add_u32 m0, s18, 34816
 ds_read_b64_tr_b16 a[240:241], v36 offset:61440
 ds_read_b64_tr_b16 a[242:243], v36 offset:63488
 v_mfma_f32_16x16x32_bf16 v[112:115], a[32:35], a[112:115], v[112:115]
 buffer_load_dwordx4 v10, s[28:31], s15 offen lds
 v_sub_u32 v7, v6, v7
 v_mfma_f32_16x16x32_bf16 v[112:115], a[64:67], a[120:123], v[112:115]
 ds_read_b64_tr_b16 a[212:213], v37 offset:53248
 v_cmp_eq_u32 vcc, 0, v6
 v_mfma_f32_16x16x32_bf16 v[116:119], a[64:67], a[124:127], v[116:119]
 ds_read_b64_tr_b16 a[214:215], v37 offset:55296
 ds_read_b64_tr_b16 a[244:245], v37 offset:61440
 v_mfma_f32_16x16x32_bf16 v[116:119], a[32:35], a[116:119], v[116:119]
 ds_read_b64_tr_b16 a[246:247], v37 offset:63488
 v_mov_b32 v12, 0
 v_mfma_f32_16x16x32_bf16 v[124:127], a[36:39], a[116:119], v[124:127]
 buffer_load_dwordx4 a[104:107], v1, s[24:27], s12 offen offset:2048 sc1
 v_mov_b32 v16, 0
 v_mfma_f32_16x16x32_bf16 v[124:127], a[68:71], a[124:127], v[124:127]
 ds_read_b64_tr_b16 a[216:217], v38 offset:53248
 ds_read_b64_tr_b16 a[218:219], v38 offset:55296
 v_mfma_f32_16x16x32_bf16 v[120:123], a[68:71], a[120:123], v[120:123]
 s_add_u32 m0, s18, 35840
 ds_read_b64_tr_b16 a[248:249], v38 offset:61440
 ds_read_b64_tr_b16 a[250:251], v38 offset:63488
 v_mfma_f32_16x16x32_bf16 v[120:123], a[36:39], a[112:115], v[120:123]
 buffer_load_dwordx4 v11, s[28:31], s15 offen lds
 v_cndmask_b32 v14, 0, v4, vcc
 v_mfma_f32_16x16x32_bf16 v[128:131], a[40:43], a[112:115], v[128:131]
 ds_read_b64_tr_b16 a[220:221], v39 offset:53248
 v_cmp_eq_u32 vcc, 1, v6
 v_mfma_f32_16x16x32_bf16 v[128:131], a[72:75], a[120:123], v[128:131]
 ds_read_b64_tr_b16 a[222:223], v39 offset:55296
 ds_read_b64_tr_b16 a[252:253], v39 offset:61440
 v_mfma_f32_16x16x32_bf16 v[132:135], a[72:75], a[124:127], v[132:135]
 ds_read_b64_tr_b16 a[254:255], v39 offset:63488
 v_mov_b32 v13, 0
 v_mfma_f32_16x16x32_bf16 v[132:135], a[40:43], a[116:119], v[132:135]
 buffer_load_dwordx4 a[108:111], v1, s[24:27], s12 offen offset:3072 sc1
 v_mov_b32 v17, 0
 v_mfma_f32_16x16x32_bf16 v[140:143], a[44:47], a[116:119], v[140:143]
 v_cndmask_b32 v15, 0, v4, vcc
 v_mfma_f32_16x16x32_bf16 v[140:143], a[76:79], a[124:127], v[140:143]
 v_mfma_f32_16x16x32_bf16 v[136:139], a[76:79], a[120:123], v[136:139]
 v_mfma_f32_16x16x32_bf16 v[136:139], a[44:47], a[112:115], v[136:139]
 s_add_u32 s12, s12, 4096
 s_waitcnt vmcnt(17) lgkmcnt(0)
 v_mfma_f32_16x16x32_bf16 v[144:147], a[192:195], a[128:131], v[144:147]
 s_barrier
 s_add_u32 s15, s14, 3407872
 ds_read_b64_tr_b16 a[16:17], v36 offset:0
 ds_read_b64_tr_b16 a[18:19], v36 offset:2048
 v_mfma_f32_16x16x32_bf16 v[144:147], a[224:227], a[136:139], v[144:147]
 s_add_u32 m0, s18, 49152
 ds_read_b64_tr_b16 a[48:49], v36 offset:8192
 ds_read_b64_tr_b16 a[50:51], v36 offset:10240
 v_cmp_eq_u32 vcc, 0, v7
 v_mfma_f32_16x16x32_bf16 v[148:151], a[224:227], a[140:143], v[148:151]
 buffer_load_dwordx4 v8, s[28:31], s15 offen lds
 v_mfma_f32_16x16x32_bf16 v[148:151], a[192:195], a[132:135], v[148:151]
 ds_read_b64_tr_b16 a[20:21], v37 offset:0
 v_cndmask_b32 v80, 0, v4, vcc
 v_mfma_f32_16x16x32_bf16 v[156:159], a[196:199], a[132:135], v[156:159]
 ds_read_b64_tr_b16 a[22:23], v37 offset:2048
 ds_read_b64_tr_b16 a[52:53], v37 offset:8192
 v_mfma_f32_16x16x32_bf16 v[156:159], a[228:231], a[140:143], v[156:159]
 buffer_load_dwordx4 a[112:115], v1, s[24:27], s12 offen sc1
 v_cmp_eq_u32 vcc, 1, v7
 v_mfma_f32_16x16x32_bf16 v[152:155], a[228:231], a[136:139], v[152:155]
 ds_read_b64_tr_b16 a[54:55], v37 offset:10240
 v_mfma_f32_16x16x32_bf16 v[152:155], a[196:199], a[128:131], v[152:155]
 ds_read_b64_tr_b16 a[24:25], v38 offset:0
 ds_read_b64_tr_b16 a[26:27], v38 offset:2048
 v_cndmask_b32 v81, 0, v4, vcc
 v_mfma_f32_16x16x32_bf16 v[160:163], a[200:203], a[128:131], v[160:163]
 s_add_u32 m0, s18, 50176
 ds_read_b64_tr_b16 a[56:57], v38 offset:8192
 ds_read_b64_tr_b16 a[58:59], v38 offset:10240
 v_mfma_f32_16x16x32_bf16 v[160:163], a[232:235], a[136:139], v[160:163]
 buffer_load_dwordx4 v9, s[28:31], s15 offen lds
 v_cmp_eq_u32 vcc, 2, v7
 v_mfma_f32_16x16x32_bf16 v[164:167], a[232:235], a[140:143], v[164:167]
 ds_read_b64_tr_b16 a[28:29], v39 offset:0
 v_mfma_f32_16x16x32_bf16 v[164:167], a[200:203], a[132:135], v[164:167]
 ds_read_b64_tr_b16 a[30:31], v39 offset:2048
 ds_read_b64_tr_b16 a[60:61], v39 offset:8192
 v_cndmask_b32 v82, 0, v4, vcc
 v_mfma_f32_16x16x32_bf16 v[172:175], a[204:207], a[132:135], v[172:175]
 s_lshl_b32 s67, s53, 18
 buffer_load_dwordx4 a[116:119], v1, s[24:27], s12 offen offset:1024 sc1
 v_mfma_f32_16x16x32_bf16 v[172:175], a[236:239], a[140:143], v[172:175]
 s_add_u32 s67, s67, s59
 ds_read_b64_tr_b16 a[62:63], v39 offset:10240
 v_cmp_eq_u32 vcc, 3, v7
 v_mfma_f32_16x16x32_bf16 v[168:171], a[236:239], a[136:139], v[168:171]
 s_add_u32 s67, s67, 77824
 ds_read_b64_tr_b16 a[32:33], v36 offset:4096
 ds_read_b64_tr_b16 a[34:35], v36 offset:6144
 v_mfma_f32_16x16x32_bf16 v[168:171], a[204:207], a[128:131], v[168:171]
 s_add_u32 m0, s18, 51200
 ds_read_b64_tr_b16 a[64:65], v36 offset:12288
 ds_read_b64_tr_b16 a[66:67], v36 offset:14336
 v_cndmask_b32 v83, 0, v4, vcc
 v_mfma_f32_16x16x32_bf16 v[112:115], a[208:211], a[128:131], v[112:115]
 buffer_load_dwordx4 v10, s[28:31], s15 offen lds
 v_mfma_f32_16x16x32_bf16 v[112:115], a[240:243], a[136:139], v[112:115]
 ds_read_b64_tr_b16 a[36:37], v37 offset:4096
 v_cmp_eq_u32 vcc, -8, v7
 v_mfma_f32_16x16x32_bf16 v[116:119], a[240:243], a[140:143], v[116:119]
 ds_read_b64_tr_b16 a[38:39], v37 offset:6144
 ds_read_b64_tr_b16 a[68:69], v37 offset:12288
 v_mfma_f32_16x16x32_bf16 v[116:119], a[208:211], a[132:135], v[116:119]
 ds_read_b64_tr_b16 a[70:71], v37 offset:14336
 v_cndmask_b32 v84, 0, v4, vcc
 v_mfma_f32_16x16x32_bf16 v[124:127], a[212:215], a[132:135], v[124:127]
 buffer_load_dwordx4 a[120:123], v1, s[24:27], s12 offen offset:2048 sc1
 v_mfma_f32_16x16x32_bf16 v[124:127], a[244:247], a[140:143], v[124:127]
 ds_read_b64_tr_b16 a[40:41], v38 offset:4096
 ds_read_b64_tr_b16 a[42:43], v38 offset:6144
 v_cmp_eq_u32 vcc, -7, v7
 v_mfma_f32_16x16x32_bf16 v[120:123], a[244:247], a[136:139], v[120:123]
 s_add_u32 m0, s18, 52224
 ds_read_b64_tr_b16 a[72:73], v38 offset:12288
 ds_read_b64_tr_b16 a[74:75], v38 offset:14336
 v_mfma_f32_16x16x32_bf16 v[120:123], a[212:215], a[128:131], v[120:123]
 buffer_load_dwordx4 v11, s[28:31], s15 offen lds
 v_cndmask_b32 v85, 0, v4, vcc
 v_mfma_f32_16x16x32_bf16 v[128:131], a[216:219], a[128:131], v[128:131]
 ds_read_b64_tr_b16 a[44:45], v39 offset:4096
 v_mfma_f32_16x16x32_bf16 v[128:131], a[248:251], a[136:139], v[128:131]
 ds_read_b64_tr_b16 a[46:47], v39 offset:6144
 ds_read_b64_tr_b16 a[76:77], v39 offset:12288
 v_cmp_eq_u32 vcc, -6, v7
 v_mfma_f32_16x16x32_bf16 v[132:135], a[248:251], a[140:143], v[132:135]
 ds_read_b64_tr_b16 a[78:79], v39 offset:14336
 v_mfma_f32_16x16x32_bf16 v[132:135], a[216:219], a[132:135], v[132:135]
 buffer_load_dwordx4 a[124:127], v1, s[24:27], s12 offen offset:3072 sc1
 v_cndmask_b32 v86, 0, v4, vcc
 v_mfma_f32_16x16x32_bf16 v[140:143], a[220:223], a[132:135], v[140:143]
 v_mfma_f32_16x16x32_bf16 v[140:143], a[252:255], a[140:143], v[140:143]
 v_cmp_eq_u32 vcc, -5, v7
 v_mfma_f32_16x16x32_bf16 v[136:139], a[252:255], a[136:139], v[136:139]
 v_mfma_f32_16x16x32_bf16 v[136:139], a[220:223], a[128:131], v[136:139]
 s_add_u32 s12, s12, 4096
 v_cndmask_b32 v87, 0, v4, vcc
 s_waitcnt vmcnt(16) lgkmcnt(0)
 v_mfma_f32_16x16x32_bf16 v[144:147], a[16:19], a[80:83], v[144:147]
 s_barrier
 s_add_u32 s15, s14, 393216
 ds_read_b64_tr_b16 a[192:193], v36 offset:16384
 ds_read_b64_tr_b16 a[194:195], v36 offset:18432
 v_cmp_ne_u32 vcc, 1, v47
 v_mfma_f32_16x16x32_bf16 v[144:147], a[48:51], a[88:91], v[144:147]
 s_add_u32 m0, s18, 0
 ds_read_b64_tr_b16 a[224:225], v36 offset:24576
 v_mfma_f32_16x16x32_bf16 v[148:151], a[48:51], a[92:95], v[148:151]
 buffer_load_dwordx4 v8, s[28:31], s15 offen lds
 s_cbranch_vccnz L_b30_s
L_b30_d:
 v_mfma_f32_16x16x32_bf16 v[148:151], a[16:19], a[84:87], v[148:151]
 ds_read_b64_tr_b16 a[226:227], v36 offset:26624
 v_mfma_f32_16x16x32_bf16 v[156:159], a[20:23], a[84:87], v[156:159]
 ds_read_b64_tr_b16 a[196:197], v37 offset:16384
 v_mfma_f32_16x16x32_bf16 v[156:159], a[52:55], a[92:95], v[156:159]
 ds_read_b64_tr_b16 a[198:199], v37 offset:18432
 v_mfma_f32_16x16x32_bf16 v[152:155], a[52:55], a[88:91], v[152:155]
 buffer_load_dwordx4 a[128:131], v1, s[24:27], s12 offen sc1
 v_mfma_f32_16x16x32_bf16 v[152:155], a[20:23], a[80:83], v[152:155]
 ds_read_b64_tr_b16 a[228:229], v37 offset:24576
 v_mfma_f32_16x16x32_bf16 v[160:163], a[24:27], a[80:83], v[160:163]
 ds_read_b64_tr_b16 a[230:231], v37 offset:26624
 v_mfma_f32_16x16x32_bf16 v[160:163], a[56:59], a[88:91], v[160:163]
 ds_read_b64_tr_b16 a[200:201], v38 offset:16384
 ds_read_b64_tr_b16 a[202:203], v38 offset:18432
 v_mfma_f32_16x16x32_bf16 v[164:167], a[56:59], a[92:95], v[164:167]
 s_add_u32 m0, s18, 1024
 ds_read_b64_tr_b16 a[232:233], v38 offset:24576
 v_mfma_f32_16x16x32_bf16 v[164:167], a[24:27], a[84:87], v[164:167]
 buffer_load_dwordx4 v9, s[28:31], s15 offen lds
 v_mfma_f32_16x16x32_bf16 v[172:175], a[28:31], a[84:87], v[172:175]
 ds_read_b64_tr_b16 a[234:235], v38 offset:26624
 v_mfma_f32_16x16x32_bf16 v[172:175], a[60:63], a[92:95], v[172:175]
 ds_read_b64_tr_b16 a[204:205], v39 offset:16384
 v_mfma_f32_16x16x32_bf16 v[168:171], a[60:63], a[88:91], v[168:171]
 ds_read_b64_tr_b16 a[206:207], v39 offset:18432
 v_mfma_f32_16x16x32_bf16 v[168:171], a[28:31], a[80:83], v[168:171]
 buffer_load_dwordx4 a[132:135], v1, s[24:27], s12 offen offset:1024 sc1
 v_mfma_f32_16x16x32_bf16 v[112:115], a[32:35], a[80:83], v[112:115]
 ds_read_b64_tr_b16 a[236:237], v39 offset:24576
 v_mfma_f32_16x16x32_bf16 v[112:115], a[64:67], a[88:91], v[112:115]
 ds_read_b64_tr_b16 a[238:239], v39 offset:26624
 v_mfma_f32_16x16x32_bf16 v[116:119], a[64:67], a[92:95], v[116:119]
 ds_read_b64_tr_b16 a[208:209], v36 offset:20480
 ds_read_b64_tr_b16 a[210:211], v36 offset:22528
 v_mfma_f32_16x16x32_bf16 v[116:119], a[32:35], a[84:87], v[116:119]
 s_add_u32 m0, s18, 2048
 ds_read_b64_tr_b16 a[240:241], v36 offset:28672
 v_mfma_f32_16x16x32_bf16 v[124:127], a[36:39], a[84:87], v[124:127]
 buffer_load_dwordx4 v10, s[28:31], s15 offen lds
 v_mfma_f32_16x16x32_bf16 v[124:127], a[68:71], a[92:95], v[124:127]
 ds_read_b64_tr_b16 a[242:243], v36 offset:30720
 v_mfma_f32_16x16x32_bf16 v[120:123], a[68:71], a[88:91], v[120:123]
 ds_read_b64_tr_b16 a[212:213], v37 offset:20480
 v_mfma_f32_16x16x32_bf16 v[120:123], a[36:39], a[80:83], v[120:123]
 ds_read_b64_tr_b16 a[214:215], v37 offset:22528
 v_mfma_f32_16x16x32_bf16 v[128:131], a[40:43], a[80:83], v[128:131]
 ds_read_b64_tr_b16 a[244:245], v37 offset:28672
 v_mfma_f32_16x16x32_bf16 v[128:131], a[72:75], a[88:91], v[128:131]
 buffer_load_dwordx4 a[136:139], v1, s[24:27], s12 offen offset:2048 sc1
 v_mfma_f32_16x16x32_bf16 v[132:135], a[72:75], a[92:95], v[132:135]
 ds_read_b64_tr_b16 a[246:247], v37 offset:30720
 v_mfma_f32_16x16x32_bf16 v[132:135], a[40:43], a[84:87], v[132:135]
 ds_read_b64_tr_b16 a[216:217], v38 offset:20480
 ds_read_b64_tr_b16 a[218:219], v38 offset:22528
 v_mfma_f32_16x16x32_bf16 v[140:143], a[44:47], a[84:87], v[140:143]
 s_add_u32 m0, s18, 3072
 ds_read_b64_tr_b16 a[248:249], v38 offset:28672
 v_mfma_f32_16x16x32_bf16 v[140:143], a[76:79], a[92:95], v[140:143]
 buffer_load_dwordx4 v11, s[28:31], s15 offen lds
 v_mfma_f32_16x16x32_bf16 v[136:139], a[76:79], a[88:91], v[136:139]
 ds_read_b64_tr_b16 a[250:251], v38 offset:30720
 v_mfma_f32_16x16x32_bf16 v[136:139], a[44:47], a[80:83], v[136:139]
 ds_read_b64_tr_b16 a[220:221], v39 offset:20480
 v_mfma_f32_16x16x32_bf16 v[208:211], v[80:83], a[0:3], 0
 ds_read_b64_tr_b16 a[222:223], v39 offset:22528
 v_mfma_f32_16x16x32_bf16 v[212:215], v[80:83], a[8:11], 0
 ds_read_b64_tr_b16 a[252:253], v39 offset:28672
 v_mfma_f32_16x16x32_bf16 v[216:219], v[84:87], a[0:3], 0
 buffer_load_dwordx4 a[140:143], v1, s[24:27], s12 offen offset:3072 sc1
 v_mfma_f32_16x16x32_bf16 v[220:223], v[84:87], a[8:11], 0
 ds_read_b64_tr_b16 a[254:255], v39 offset:30720
 v_mfma_f32_16x16x32_bf16 v[224:227], v[80:83], a[4:7], 0
 v_mfma_f32_16x16x32_bf16 v[228:231], v[80:83], a[12:15], 0
 v_mfma_f32_16x16x32_bf16 v[232:235], v[84:87], a[4:7], 0
 v_mfma_f32_16x16x32_bf16 v[236:239], v[84:87], a[12:15], 0
 s_add_u32 s12, s12, 4096
 s_waitcnt vmcnt(16) lgkmcnt(0)
 v_mfma_f32_16x16x32_bf16 v[144:147], a[192:195], a[96:99], v[144:147]
 s_barrier
 s_add_u32 s15, s14, 1310720
 ds_read_b64_tr_b16 a[16:17], v36 offset:32768
 ds_read_b64_tr_b16 a[18:19], v36 offset:34816
 v_mfma_f32_16x16x32_bf16 v[144:147], a[224:227], a[104:107], v[144:147]
 s_add_u32 m0, s18, 16384
 ds_read_b64_tr_b16 a[48:49], v36 offset:40960
 ds_read_b64_tr_b16 a[50:51], v36 offset:43008
 v_mfma_f32_16x16x32_bf16 v[148:151], a[224:227], a[108:111], v[148:151]
 buffer_load_dwordx4 v8, s[28:31], s15 offen lds
 v_mfma_f32_16x16x32_bf16 v[148:151], a[192:195], a[100:103], v[148:151]
 ds_read_b64_tr_b16 a[20:21], v37 offset:32768
 v_mfma_f32_16x16x32_bf16 v[156:159], a[196:199], a[100:103], v[156:159]
 ds_read_b64_tr_b16 a[22:23], v37 offset:34816
 ds_read_b64_tr_b16 a[52:53], v37 offset:40960
 v_mfma_f32_16x16x32_bf16 v[156:159], a[228:231], a[108:111], v[156:159]
 buffer_load_dwordx4 a[80:83], v1, s[24:27], s12 offen sc1
 v_mfma_f32_16x16x32_bf16 v[152:155], a[228:231], a[104:107], v[152:155]
 ds_read_b64_tr_b16 a[54:55], v37 offset:43008
 v_mfma_f32_16x16x32_bf16 v[152:155], a[196:199], a[96:99], v[152:155]
 ds_read_b64_tr_b16 a[24:25], v38 offset:32768
 ds_read_b64_tr_b16 a[26:27], v38 offset:34816
 v_mfma_f32_16x16x32_bf16 v[160:163], a[200:203], a[96:99], v[160:163]
 s_add_u32 m0, s18, 17408
 ds_read_b64_tr_b16 a[56:57], v38 offset:40960
 ds_read_b64_tr_b16 a[58:59], v38 offset:43008
 v_mfma_f32_16x16x32_bf16 v[160:163], a[232:235], a[104:107], v[160:163]
 buffer_load_dwordx4 v9, s[28:31], s15 offen lds
 v_mfma_f32_16x16x32_bf16 v[164:167], a[232:235], a[108:111], v[164:167]
 ds_read_b64_tr_b16 a[28:29], v39 offset:32768
 v_mfma_f32_16x16x32_bf16 v[164:167], a[200:203], a[100:103], v[164:167]
 ds_read_b64_tr_b16 a[30:31], v39 offset:34816
 ds_read_b64_tr_b16 a[60:61], v39 offset:40960
 v_mfma_f32_16x16x32_bf16 v[172:175], a[204:207], a[100:103], v[172:175]
 buffer_load_dwordx4 a[84:87], v1, s[24:27], s12 offen offset:1024 sc1
 v_mfma_f32_16x16x32_bf16 v[172:175], a[236:239], a[108:111], v[172:175]
 ds_read_b64_tr_b16 a[62:63], v39 offset:43008
 v_mfma_f32_16x16x32_bf16 v[168:171], a[236:239], a[104:107], v[168:171]
 ds_read_b64_tr_b16 a[32:33], v36 offset:36864
 ds_read_b64_tr_b16 a[34:35], v36 offset:38912
 v_mfma_f32_16x16x32_bf16 v[168:171], a[204:207], a[96:99], v[168:171]
 s_add_u32 m0, s18, 18432
 ds_read_b64_tr_b16 a[64:65], v36 offset:45056
 ds_read_b64_tr_b16 a[66:67], v36 offset:47104
 v_mfma_f32_16x16x32_bf16 v[112:115], a[208:211], a[96:99], v[112:115]
 buffer_load_dwordx4 v10, s[28:31], s15 offen lds
 v_mfma_f32_16x16x32_bf16 v[112:115], a[240:243], a[104:107], v[112:115]
 ds_read_b64_tr_b16 a[36:37], v37 offset:36864
 v_mfma_f32_16x16x32_bf16 v[116:119], a[240:243], a[108:111], v[116:119]
 ds_read_b64_tr_b16 a[38:39], v37 offset:38912
 ds_read_b64_tr_b16 a[68:69], v37 offset:45056
 v_mfma_f32_16x16x32_bf16 v[116:119], a[208:211], a[100:103], v[116:119]
 ds_read_b64_tr_b16 a[70:71], v37 offset:47104
 v_mfma_f32_16x16x32_bf16 v[124:127], a[212:215], a[100:103], v[124:127]
 buffer_load_dwordx4 a[88:91], v1, s[24:27], s12 offen offset:2048 sc1
 v_mfma_f32_16x16x32_bf16 v[124:127], a[244:247], a[108:111], v[124:127]
 ds_read_b64_tr_b16 a[40:41], v38 offset:36864
 ds_read_b64_tr_b16 a[42:43], v38 offset:38912
 v_mfma_f32_16x16x32_bf16 v[120:123], a[244:247], a[104:107], v[120:123]
 s_add_u32 m0, s18, 19456
 ds_read_b64_tr_b16 a[72:73], v38 offset:45056
 ds_read_b64_tr_b16 a[74:75], v38 offset:47104
 v_mfma_f32_16x16x32_bf16 v[120:123], a[212:215], a[96:99], v[120:123]
 buffer_load_dwordx4 v11, s[28:31], s15 offen lds
 v_mfma_f32_16x16x32_bf16 v[128:131], a[216:219], a[96:99], v[128:131]
 ds_read_b64_tr_b16 a[44:45], v39 offset:36864
 v_mfma_f32_16x16x32_bf16 v[128:131], a[248:251], a[104:107], v[128:131]
 ds_read_b64_tr_b16 a[46:47], v39 offset:38912
 ds_read_b64_tr_b16 a[76:77], v39 offset:45056
 v_mfma_f32_16x16x32_bf16 v[132:135], a[248:251], a[108:111], v[132:135]
 ds_read_b64_tr_b16 a[78:79], v39 offset:47104
 v_mfma_f32_16x16x32_bf16 v[132:135], a[216:219], a[100:103], v[132:135]
 buffer_load_dwordx4 a[92:95], v1, s[24:27], s12 offen offset:3072 sc1
 v_mfma_f32_16x16x32_bf16 v[140:143], a[220:223], a[100:103], v[140:143]
 v_mfma_f32_16x16x32_bf16 v[140:143], a[252:255], a[108:111], v[140:143]
 v_mfma_f32_16x16x32_bf16 v[136:139], a[252:255], a[104:107], v[136:139]
 v_mfma_f32_16x16x32_bf16 v[136:139], a[220:223], a[96:99], v[136:139]
 s_add_u32 s12, s12, 4096
 buffer_load_dword v47, v24, s[24:27], s67 offen offset:256 sc1
 s_waitcnt vmcnt(17) lgkmcnt(0)
 v_mfma_f32_16x16x32_bf16 v[144:147], a[16:19], a[112:115], v[144:147]
 s_barrier
 s_add_u32 s15, s14, 2228224
 ds_read_b64_tr_b16 a[192:193], v36 offset:49152
 ds_read_b64_tr_b16 a[194:195], v36 offset:51200
 v_mfma_f32_16x16x32_bf16 v[144:147], a[48:51], a[120:123], v[144:147]
 s_add_u32 m0, s18, 32768
 ds_read_b64_tr_b16 a[224:225], v36 offset:57344
 ds_read_b64_tr_b16 a[226:227], v36 offset:59392
 v_mfma_f32_16x16x32_bf16 v[148:151], a[48:51], a[124:127], v[148:151]
 buffer_load_dwordx4 v8, s[28:31], s15 offen lds
 s_branch L_tp_L_tail0_1_o
L_tp_L_tail0_1:
 s_nop 0
 s_nop 0
 s_branch L_tp_L_tail0_3
L_tp_L_tail0_1_o:
 v_mfma_f32_16x16x32_bf16 v[148:151], a[16:19], a[116:119], v[148:151]
 ds_read_b64_tr_b16 a[196:197], v37 offset:49152
 v_mfma_f32_16x16x32_bf16 v[156:159], a[20:23], a[116:119], v[156:159]
 ds_read_b64_tr_b16 a[198:199], v37 offset:51200
 ds_read_b64_tr_b16 a[228:229], v37 offset:57344
 v_mfma_f32_16x16x32_bf16 v[156:159], a[52:55], a[124:127], v[156:159]
 buffer_load_dwordx4 a[96:99], v1, s[24:27], s12 offen sc1
 v_mfma_f32_16x16x32_bf16 v[152:155], a[52:55], a[120:123], v[152:155]
 ds_read_b64_tr_b16 a[230:231], v37 offset:59392
 v_mfma_f32_16x16x32_bf16 v[152:155], a[20:23], a[112:115], v[152:155]
 ds_read_b64_tr_b16 a[200:201], v38 offset:49152
 ds_read_b64_tr_b16 a[202:203], v38 offset:51200
 v_mfma_f32_16x16x32_bf16 v[160:163], a[24:27], a[112:115], v[160:163]
 s_add_u32 m0, s18, 33792
 ds_read_b64_tr_b16 a[232:233], v38 offset:57344
 ds_read_b64_tr_b16 a[234:235], v38 offset:59392
 v_mfma_f32_16x16x32_bf16 v[160:163], a[56:59], a[120:123], v[160:163]
 buffer_load_dwordx4 v9, s[28:31], s15 offen lds
 v_mfma_f32_16x16x32_bf16 v[164:167], a[56:59], a[124:127], v[164:167]
 ds_read_b64_tr_b16 a[204:205], v39 offset:49152
 v_mfma_f32_16x16x32_bf16 v[164:167], a[24:27], a[116:119], v[164:167]
 ds_read_b64_tr_b16 a[206:207], v39 offset:51200
 ds_read_b64_tr_b16 a[236:237], v39 offset:57344
 v_mfma_f32_16x16x32_bf16 v[172:175], a[28:31], a[116:119], v[172:175]
 buffer_load_dwordx4 a[100:103], v1, s[24:27], s12 offen offset:1024 sc1
 v_mfma_f32_16x16x32_bf16 v[172:175], a[60:63], a[124:127], v[172:175]
 ds_read_b64_tr_b16 a[238:239], v39 offset:59392
 v_mfma_f32_16x16x32_bf16 v[168:171], a[60:63], a[120:123], v[168:171]
 ds_read_b64_tr_b16 a[208:209], v36 offset:53248
 ds_read_b64_tr_b16 a[210:211], v36 offset:55296
 v_mfma_f32_16x16x32_bf16 v[168:171], a[28:31], a[112:115], v[168:171]
 s_add_u32 m0, s18, 34816
 ds_read_b64_tr_b16 a[240:241], v36 offset:61440
 ds_read_b64_tr_b16 a[242:243], v36 offset:63488
 v_mfma_f32_16x16x32_bf16 v[112:115], a[32:35], a[112:115], v[112:115]
 buffer_load_dwordx4 v10, s[28:31], s15 offen lds
 v_mfma_f32_16x16x32_bf16 v[112:115], a[64:67], a[120:123], v[112:115]
 ds_read_b64_tr_b16 a[212:213], v37 offset:53248
 v_mfma_f32_16x16x32_bf16 v[116:119], a[64:67], a[124:127], v[116:119]
 ds_read_b64_tr_b16 a[214:215], v37 offset:55296
 ds_read_b64_tr_b16 a[244:245], v37 offset:61440
 v_mfma_f32_16x16x32_bf16 v[116:119], a[32:35], a[116:119], v[116:119]
 ds_read_b64_tr_b16 a[246:247], v37 offset:63488
 v_mfma_f32_16x16x32_bf16 v[124:127], a[36:39], a[116:119], v[124:127]
 buffer_load_dwordx4 a[104:107], v1, s[24:27], s12 offen offset:2048 sc1
 v_mfma_f32_16x16x32_bf16 v[124:127], a[68:71], a[124:127], v[124:127]
 ds_read_b64_tr_b16 a[216:217], v38 offset:53248
 ds_read_b64_tr_b16 a[218:219], v38 offset:55296
 v_mfma_f32_16x16x32_bf16 v[120:123], a[68:71], a[120:123], v[120:123]
 s_add_u32 m0, s18, 35840
 ds_read_b64_tr_b16 a[248:249], v38 offset:61440
 ds_read_b64_tr_b16 a[250:251], v38 offset:63488
 v_mfma_f32_16x16x32_bf16 v[120:123], a[36:39], a[112:115], v[120:123]
 buffer_load_dwordx4 v11, s[28:31], s15 offen lds
 v_mfma_f32_16x16x32_bf16 v[128:131], a[40:43], a[112:115], v[128:131]
 ds_read_b64_tr_b16 a[220:221], v39 offset:53248
 v_mfma_f32_16x16x32_bf16 v[128:131], a[72:75], a[120:123], v[128:131]
 ds_read_b64_tr_b16 a[222:223], v39 offset:55296
 ds_read_b64_tr_b16 a[252:253], v39 offset:61440
 v_mfma_f32_16x16x32_bf16 v[132:135], a[72:75], a[124:127], v[132:135]
 ds_read_b64_tr_b16 a[254:255], v39 offset:63488
 v_mfma_f32_16x16x32_bf16 v[132:135], a[40:43], a[116:119], v[132:135]
 buffer_load_dwordx4 a[108:111], v1, s[24:27], s12 offen offset:3072 sc1
 v_mfma_f32_16x16x32_bf16 v[140:143], a[44:47], a[116:119], v[140:143]
 v_mfma_f32_16x16x32_bf16 v[140:143], a[76:79], a[124:127], v[140:143]
 v_mfma_f32_16x16x32_bf16 v[136:139], a[76:79], a[120:123], v[136:139]
 v_mfma_f32_16x16x32_bf16 v[136:139], a[44:47], a[112:115], v[136:139]
 s_add_u32 s12, s12, 4096
 s_waitcnt vmcnt(17) lgkmcnt(0)
 v_mfma_f32_16x16x32_bf16 v[144:147], a[192:195], a[128:131], v[144:147]
 s_barrier
 s_add_u32 s15, s14, 3145728
 ds_read_b64_tr_b16 a[16:17], v36 offset:0
 ds_read_b64_tr_b16 a[18:19], v36 offset:2048
 v_mfma_f32_16x16x32_bf16 v[144:147], a[224:227], a[136:139], v[144:147]
 s_add_u32 m0, s18, 49152
 ds_read_b64_tr_b16 a[48:49], v36 offset:8192
 ds_read_b64_tr_b16 a[50:51], v36 offset:10240
 v_mfma_f32_16x16x32_bf16 v[148:151], a[224:227], a[140:143], v[148:151]
 buffer_load_dwordx4 v8, s[28:31], s15 offen lds
 v_mfma_f32_16x16x32_bf16 v[148:151], a[192:195], a[132:135], v[148:151]
 ds_read_b64_tr_b16 a[20:21], v37 offset:0
 v_mfma_f32_16x16x32_bf16 v[156:159], a[196:199], a[132:135], v[156:159]
 ds_read_b64_tr_b16 a[22:23], v37 offset:2048
 ds_read_b64_tr_b16 a[52:53], v37 offset:8192
 v_mfma_f32_16x16x32_bf16 v[156:159], a[228:231], a[140:143], v[156:159]
 buffer_load_dwordx4 a[112:115], v1, s[24:27], s12 offen sc1
 v_mfma_f32_16x16x32_bf16 v[152:155], a[228:231], a[136:139], v[152:155]
 ds_read_b64_tr_b16 a[54:55], v37 offset:10240
 v_mfma_f32_16x16x32_bf16 v[152:155], a[196:199], a[128:131], v[152:155]
 ds_read_b64_tr_b16 a[24:25], v38 offset:0
 ds_read_b64_tr_b16 a[26:27], v38 offset:2048
 v_mfma_f32_16x16x32_bf16 v[160:163], a[200:203], a[128:131], v[160:163]
 s_add_u32 m0, s18, 50176
 ds_read_b64_tr_b16 a[56:57], v38 offset:8192
 ds_read_b64_tr_b16 a[58:59], v38 offset:10240
 v_mfma_f32_16x16x32_bf16 v[160:163], a[232:235], a[136:139], v[160:163]
 buffer_load_dwordx4 v9, s[28:31], s15 offen lds
 v_mfma_f32_16x16x32_bf16 v[164:167], a[232:235], a[140:143], v[164:167]
 ds_read_b64_tr_b16 a[28:29], v39 offset:0
 v_mfma_f32_16x16x32_bf16 v[164:167], a[200:203], a[132:135], v[164:167]
 ds_read_b64_tr_b16 a[30:31], v39 offset:2048
 ds_read_b64_tr_b16 a[60:61], v39 offset:8192
 v_mfma_f32_16x16x32_bf16 v[172:175], a[204:207], a[132:135], v[172:175]
 buffer_load_dwordx4 a[116:119], v1, s[24:27], s12 offen offset:1024 sc1
 v_mfma_f32_16x16x32_bf16 v[172:175], a[236:239], a[140:143], v[172:175]
 ds_read_b64_tr_b16 a[62:63], v39 offset:10240
 v_mfma_f32_16x16x32_bf16 v[168:171], a[236:239], a[136:139], v[168:171]
 ds_read_b64_tr_b16 a[32:33], v36 offset:4096
 ds_read_b64_tr_b16 a[34:35], v36 offset:6144
 v_mfma_f32_16x16x32_bf16 v[168:171], a[204:207], a[128:131], v[168:171]
 s_add_u32 m0, s18, 51200
 ds_read_b64_tr_b16 a[64:65], v36 offset:12288
 ds_read_b64_tr_b16 a[66:67], v36 offset:14336
 v_mfma_f32_16x16x32_bf16 v[112:115], a[208:211], a[128:131], v[112:115]
 buffer_load_dwordx4 v10, s[28:31], s15 offen lds
 v_mfma_f32_16x16x32_bf16 v[112:115], a[240:243], a[136:139], v[112:115]
 ds_read_b64_tr_b16 a[36:37], v37 offset:4096
 v_mfma_f32_16x16x32_bf16 v[116:119], a[240:243], a[140:143], v[116:119]
 ds_read_b64_tr_b16 a[38:39], v37 offset:6144
 ds_read_b64_tr_b16 a[68:69], v37 offset:12288
 v_mfma_f32_16x16x32_bf16 v[116:119], a[208:211], a[132:135], v[116:119]
 ds_read_b64_tr_b16 a[70:71], v37 offset:14336
 v_mfma_f32_16x16x32_bf16 v[124:127], a[212:215], a[132:135], v[124:127]
 buffer_load_dwordx4 a[120:123], v1, s[24:27], s12 offen offset:2048 sc1
 v_mfma_f32_16x16x32_bf16 v[124:127], a[244:247], a[140:143], v[124:127]
 ds_read_b64_tr_b16 a[40:41], v38 offset:4096
 ds_read_b64_tr_b16 a[42:43], v38 offset:6144
 v_mfma_f32_16x16x32_bf16 v[120:123], a[244:247], a[136:139], v[120:123]
 s_add_u32 m0, s18, 52224
 ds_read_b64_tr_b16 a[72:73], v38 offset:12288
 ds_read_b64_tr_b16 a[74:75], v38 offset:14336
 v_mfma_f32_16x16x32_bf16 v[120:123], a[212:215], a[128:131], v[120:123]
 buffer_load_dwordx4 v11, s[28:31], s15 offen lds
 v_mfma_f32_16x16x32_bf16 v[128:131], a[216:219], a[128:131], v[128:131]
 ds_read_b64_tr_b16 a[44:45], v39 offset:4096
 v_mfma_f32_16x16x32_bf16 v[128:131], a[248:251], a[136:139], v[128:131]
 ds_read_b64_tr_b16 a[46:47], v39 offset:6144
 ds_read_b64_tr_b16 a[76:77], v39 offset:12288
 v_mfma_f32_16x16x32_bf16 v[132:135], a[248:251], a[140:143], v[132:135]
 ds_read_b64_tr_b16 a[78:79], v39 offset:14336
 v_mfma_f32_16x16x32_bf16 v[132:135], a[216:219], a[132:135], v[132:135]
 buffer_load_dwordx4 a[124:127], v1, s[24:27], s12 offen offset:3072 sc1
 v_mfma_f32_16x16x32_bf16 v[140:143], a[220:223], a[132:135], v[140:143]
 v_mfma_f32_16x16x32_bf16 v[140:143], a[252:255], a[140:143], v[140:143]
 buffer_load_dword v34, v25, s[24:27], s69 offen offset:256 sc1
 v_mfma_f32_16x16x32_bf16 v[136:139], a[252:255], a[136:139], v[136:139]
 buffer_load_dword v35, off, s[24:27], s55 sc1
 v_mfma_f32_16x16x32_bf16 v[136:139], a[220:223], a[128:131], v[136:139]
 s_add_u32 s12, s12, 4096
 s_waitcnt vmcnt(18) lgkmcnt(0)
 v_mfma_f32_16x16x32_bf16 v[144:147], a[16:19], a[80:83], v[144:147]
 s_barrier
 s_add_u32 s15, s14, 5898240
 ds_read_b64_tr_b16 a[192:193], v36 offset:16384
 ds_read_b64_tr_b16 a[194:195], v36 offset:18432
 v_cmp_ne_u32 vcc, 1, v47
 v_mfma_f32_16x16x32_bf16 v[144:147], a[48:51], a[88:91], v[144:147]
 s_add_u32 m0, s18, 0
 ds_read_b64_tr_b16 a[224:225], v36 offset:24576
 ds_read_b64_tr_b16 a[226:227], v36 offset:26624
 v_mfma_f32_16x16x32_bf16 v[148:151], a[48:51], a[92:95], v[148:151]
 buffer_load_dwordx4 v8, s[28:31], s15 offen lds
 s_cbranch_vccnz L_fx_s
L_fx_d:
 v_mfma_f32_16x16x32_bf16 v[148:151], a[16:19], a[84:87], v[148:151]
 ds_read_b64_tr_b16 a[196:197], v37 offset:16384
 v_mfma_f32_16x16x32_bf16 v[156:159], a[20:23], a[84:87], v[156:159]
 ds_read_b64_tr_b16 a[198:199], v37 offset:18432
 ds_read_b64_tr_b16 a[228:229], v37 offset:24576
 v_mfma_f32_16x16x32_bf16 v[156:159], a[52:55], a[92:95], v[156:159]
 buffer_load_dwordx4 a[128:131], v1, s[24:27], s12 offen sc1
 v_mfma_f32_16x16x32_bf16 v[152:155], a[52:55], a[88:91], v[152:155]
 ds_read_b64_tr_b16 a[230:231], v37 offset:26624
 v_mfma_f32_16x16x32_bf16 v[152:155], a[20:23], a[80:83], v[152:155]
 ds_read_b64_tr_b16 a[200:201], v38 offset:16384
 ds_read_b64_tr_b16 a[202:203], v38 offset:18432
 v_mfma_f32_16x16x32_bf16 v[160:163], a[24:27], a[80:83], v[160:163]
 s_add_u32 m0, s18, 1024
 ds_read_b64_tr_b16 a[232:233], v38 offset:24576
 ds_read_b64_tr_b16 a[234:235], v38 offset:26624
 v_mfma_f32_16x16x32_bf16 v[160:163], a[56:59], a[88:91], v[160:163]
 buffer_load_dwordx4 v9, s[28:31], s15 offen lds
 v_mfma_f32_16x16x32_bf16 v[164:167], a[56:59], a[92:95], v[164:167]
 ds_read_b64_tr_b16 a[204:205], v39 offset:16384
 v_mfma_f32_16x16x32_bf16 v[164:167], a[24:27], a[84:87], v[164:167]
 ds_read_b64_tr_b16 a[206:207], v39 offset:18432
 ds_read_b64_tr_b16 a[236:237], v39 offset:24576
 v_mfma_f32_16x16x32_bf16 v[172:175], a[28:31], a[84:87], v[172:175]
 buffer_load_dwordx4 a[132:135], v1, s[24:27], s12 offen offset:1024 sc1
 v_mfma_f32_16x16x32_bf16 v[172:175], a[60:63], a[92:95], v[172:175]
 ds_read_b64_tr_b16 a[238:239], v39 offset:26624
 v_mfma_f32_16x16x32_bf16 v[168:171], a[60:63], a[88:91], v[168:171]
 ds_read_b64_tr_b16 a[208:209], v36 offset:20480
 ds_read_b64_tr_b16 a[210:211], v36 offset:22528
 v_mfma_f32_16x16x32_bf16 v[168:171], a[28:31], a[80:83], v[168:171]
 s_add_u32 m0, s18, 2048
 ds_read_b64_tr_b16 a[240:241], v36 offset:28672
 ds_read_b64_tr_b16 a[242:243], v36 offset:30720
 v_mfma_f32_16x16x32_bf16 v[112:115], a[32:35], a[80:83], v[112:115]
 buffer_load_dwordx4 v10, s[28:31], s15 offen lds
 v_mfma_f32_16x16x32_bf16 v[112:115], a[64:67], a[88:91], v[112:115]
 ds_read_b64_tr_b16 a[212:213], v37 offset:20480
 v_mfma_f32_16x16x32_bf16 v[116:119], a[64:67], a[92:95], v[116:119]
 ds_read_b64_tr_b16 a[214:215], v37 offset:22528
 ds_read_b64_tr_b16 a[244:245], v37 offset:28672
 v_mfma_f32_16x16x32_bf16 v[116:119], a[32:35], a[84:87], v[116:119]
 ds_read_b64_tr_b16 a[246:247], v37 offset:30720
 v_mfma_f32_16x16x32_bf16 v[124:127], a[36:39], a[84:87], v[124:127]
 buffer_load_dwordx4 a[136:139], v1, s[24:27], s12 offen offset:2048 sc1
 v_mfma_f32_16x16x32_bf16 v[124:127], a[68:71], a[92:95], v[124:127]
 ds_read_b64_tr_b16 a[216:217], v38 offset:20480
 ds_read_b64_tr_b16 a[218:219], v38 offset:22528
 v_mfma_f32_16x16x32_bf16 v[120:123], a[68:71], a[88:91], v[120:123]
 s_add_u32 m0, s18, 3072
 ds_read_b64_tr_b16 a[248:249], v38 offset:28672
 ds_read_b64_tr_b16 a[250:251], v38 offset:30720
 v_mfma_f32_16x16x32_bf16 v[120:123], a[36:39], a[80:83], v[120:123]
 buffer_load_dwordx4 v11, s[28:31], s15 offen lds
 v_mfma_f32_16x16x32_bf16 v[128:131], a[40:43], a[80:83], v[128:131]
 ds_read_b64_tr_b16 a[220:221], v39 offset:20480
 v_mfma_f32_16x16x32_bf16 v[128:131], a[72:75], a[88:91], v[128:131]
 ds_read_b64_tr_b16 a[222:223], v39 offset:22528
 ds_read_b64_tr_b16 a[252:253], v39 offset:28672
 v_mfma_f32_16x16x32_bf16 v[132:135], a[72:75], a[92:95], v[132:135]
 ds_read_b64_tr_b16 a[254:255], v39 offset:30720
 v_mfma_f32_16x16x32_bf16 v[132:135], a[40:43], a[84:87], v[132:135]
 buffer_load_dwordx4 a[140:143], v1, s[24:27], s12 offen offset:3072 sc1
 v_mfma_f32_16x16x32_bf16 v[140:143], a[44:47], a[84:87], v[140:143]
 v_mfma_f32_16x16x32_bf16 v[140:143], a[76:79], a[92:95], v[140:143]
 v_mfma_f32_16x16x32_bf16 v[136:139], a[76:79], a[88:91], v[136:139]
 v_mfma_f32_16x16x32_bf16 v[136:139], a[44:47], a[80:83], v[136:139]
 s_add_u32 s12, s12, 110592
 s_waitcnt vmcnt(18) lgkmcnt(0)
 v_mfma_f32_16x16x32_bf16 v[144:147], a[192:195], a[96:99], v[144:147]
 s_barrier
 s_add_u32 s15, s14, 6815744
 ds_read_b64_tr_b16 a[16:17], v36 offset:32768
 ds_read_b64_tr_b16 a[18:19], v36 offset:34816
 v_mfma_f32_16x16x32_bf16 v[144:147], a[224:227], a[104:107], v[144:147]
 s_add_u32 m0, s18, 16384
 ds_read_b64_tr_b16 a[48:49], v36 offset:40960
 ds_read_b64_tr_b16 a[50:51], v36 offset:43008
 v_mfma_f32_16x16x32_bf16 v[148:151], a[224:227], a[108:111], v[148:151]
 buffer_load_dwordx4 v8, s[28:31], s15 offen lds
 v_mfma_f32_16x16x32_bf16 v[148:151], a[192:195], a[100:103], v[148:151]
 ds_read_b64_tr_b16 a[20:21], v37 offset:32768
 v_mfma_f32_16x16x32_bf16 v[156:159], a[196:199], a[100:103], v[156:159]
 ds_read_b64_tr_b16 a[22:23], v37 offset:34816
 ds_read_b64_tr_b16 a[52:53], v37 offset:40960
 v_mfma_f32_16x16x32_bf16 v[156:159], a[228:231], a[108:111], v[156:159]
 buffer_load_dwordx4 a[80:83], v1, s[24:27], s12 offen sc1
 v_mfma_f32_16x16x32_bf16 v[152:155], a[228:231], a[104:107], v[152:155]
 ds_read_b64_tr_b16 a[54:55], v37 offset:43008
 v_mfma_f32_16x16x32_bf16 v[152:155], a[196:199], a[96:99], v[152:155]
 ds_read_b64_tr_b16 a[24:25], v38 offset:32768
 ds_read_b64_tr_b16 a[26:27], v38 offset:34816
 v_mfma_f32_16x16x32_bf16 v[160:163], a[200:203], a[96:99], v[160:163]
 s_add_u32 m0, s18, 17408
 ds_read_b64_tr_b16 a[56:57], v38 offset:40960
 ds_read_b64_tr_b16 a[58:59], v38 offset:43008
 v_mfma_f32_16x16x32_bf16 v[160:163], a[232:235], a[104:107], v[160:163]
 buffer_load_dwordx4 v9, s[28:31], s15 offen lds
 v_mfma_f32_16x16x32_bf16 v[164:167], a[232:235], a[108:111], v[164:167]
 ds_read_b64_tr_b16 a[28:29], v39 offset:32768
 v_mfma_f32_16x16x32_bf16 v[164:167], a[200:203], a[100:103], v[164:167]
 ds_read_b64_tr_b16 a[30:31], v39 offset:34816
 ds_read_b64_tr_b16 a[60:61], v39 offset:40960
 v_mfma_f32_16x16x32_bf16 v[172:175], a[204:207], a[100:103], v[172:175]
 buffer_load_dwordx4 a[84:87], v1, s[24:27], s12 offen offset:1024 sc1
 v_mfma_f32_16x16x32_bf16 v[172:175], a[236:239], a[108:111], v[172:175]
 ds_read_b64_tr_b16 a[62:63], v39 offset:43008
 v_mfma_f32_16x16x32_bf16 v[168:171], a[236:239], a[104:107], v[168:171]
 ds_read_b64_tr_b16 a[32:33], v36 offset:36864
 ds_read_b64_tr_b16 a[34:35], v36 offset:38912
 v_mfma_f32_16x16x32_bf16 v[168:171], a[204:207], a[96:99], v[168:171]
 s_add_u32 m0, s18, 18432
 ds_read_b64_tr_b16 a[64:65], v36 offset:45056
 ds_read_b64_tr_b16 a[66:67], v36 offset:47104
 v_mfma_f32_16x16x32_bf16 v[112:115], a[208:211], a[96:99], v[112:115]
 buffer_load_dwordx4 v10, s[28:31], s15 offen lds
 v_mfma_f32_16x16x32_bf16 v[112:115], a[240:243], a[104:107], v[112:115]
 ds_read_b64_tr_b16 a[36:37], v37 offset:36864
 v_mfma_f32_16x16x32_bf16 v[116:119], a[240:243], a[108:111], v[116:119]
 ds_read_b64_tr_b16 a[38:39], v37 offset:38912
 ds_read_b64_tr_b16 a[68:69], v37 offset:45056
 v_mfma_f32_16x16x32_bf16 v[116:119], a[208:211], a[100:103], v[116:119]
 ds_read_b64_tr_b16 a[70:71], v37 offset:47104
 v_mfma_f32_16x16x32_bf16 v[124:127], a[212:215], a[100:103], v[124:127]
 buffer_load_dwordx4 a[88:91], v1, s[24:27], s12 offen offset:2048 sc1
 v_mfma_f32_16x16x32_bf16 v[124:127], a[244:247], a[108:111], v[124:127]
 ds_read_b64_tr_b16 a[40:41], v38 offset:36864
 ds_read_b64_tr_b16 a[42:43], v38 offset:38912
 v_mfma_f32_16x16x32_bf16 v[120:123], a[244:247], a[104:107], v[120:123]
 s_add_u32 m0, s18, 19456
 ds_read_b64_tr_b16 a[72:73], v38 offset:45056
 ds_read_b64_tr_b16 a[74:75], v38 offset:47104
 v_mfma_f32_16x16x32_bf16 v[120:123], a[212:215], a[96:99], v[120:123]
 buffer_load_dwordx4 v11, s[28:31], s15 offen lds
 v_mfma_f32_16x16x32_bf16 v[128:131], a[216:219], a[96:99], v[128:131]
 ds_read_b64_tr_b16 a[44:45], v39 offset:36864
 v_mfma_f32_16x16x32_bf16 v[128:131], a[248:251], a[104:107], v[128:131]
 ds_read_b64_tr_b16 a[46:47], v39 offset:38912
 ds_read_b64_tr_b16 a[76:77], v39 offset:45056
 v_mfma_f32_16x16x32_bf16 v[132:135], a[248:251], a[108:111], v[132:135]
 ds_read_b64_tr_b16 a[78:79], v39 offset:47104
 v_mfma_f32_16x16x32_bf16 v[132:135], a[216:219], a[100:103], v[132:135]
 buffer_load_dwordx4 a[92:95], v1, s[24:27], s12 offen offset:3072 sc1
 v_mfma_f32_16x16x32_bf16 v[140:143], a[220:223], a[100:103], v[140:143]
 v_mfma_f32_16x16x32_bf16 v[140:143], a[252:255], a[108:111], v[140:143]
 v_mfma_f32_16x16x32_bf16 v[136:139], a[252:255], a[104:107], v[136:139]
 v_mfma_f32_16x16x32_bf16 v[136:139], a[220:223], a[96:99], v[136:139]
 s_add_u32 s12, s12, 4096
 s_waitcnt vmcnt(16) lgkmcnt(0)
 v_mfma_f32_16x16x32_bf16 v[144:147], a[16:19], a[112:115], v[144:147]
 s_barrier
 s_add_u32 s15, s17, 1048576
 ds_read_b64_tr_b16 a[192:193], v36 offset:49152
 ds_read_b64_tr_b16 a[194:195], v36 offset:51200
 v_or_b32 v4, v35, v34
 v_mfma_f32_16x16x32_bf16 v[144:147], a[48:51], a[120:123], v[144:147]
 s_add_u32 m0, s18, 32768
 ds_read_b64_tr_b16 a[224:225], v36 offset:57344
 ds_read_b64_tr_b16 a[226:227], v36 offset:59392
 v_cmp_ne_u32 vcc, 1, v4
 v_mfma_f32_16x16x32_bf16 v[148:151], a[48:51], a[124:127], v[148:151]
 buffer_load_dwordx4 v8, s[32:35], s15 offen lds
 v_mfma_f32_16x16x32_bf16 v[148:151], a[16:19], a[116:119], v[148:151]
 ds_read_b64_tr_b16 a[196:197], v37 offset:49152
 s_cbranch_vccnz L_of0_s
L_of0_d:
 v_mfma_f32_16x16x32_bf16 v[156:159], a[20:23], a[116:119], v[156:159]
 ds_read_b64_tr_b16 a[198:199], v37 offset:51200
 ds_read_b64_tr_b16 a[228:229], v37 offset:57344
 v_mfma_f32_16x16x32_bf16 v[156:159], a[52:55], a[124:127], v[156:159]
 buffer_load_dwordx4 a[96:99], v1, s[24:27], s12 offen sc1
 v_mfma_f32_16x16x32_bf16 v[152:155], a[52:55], a[120:123], v[152:155]
 ds_read_b64_tr_b16 a[230:231], v37 offset:59392
 v_mfma_f32_16x16x32_bf16 v[152:155], a[20:23], a[112:115], v[152:155]
 ds_read_b64_tr_b16 a[200:201], v38 offset:49152
 ds_read_b64_tr_b16 a[202:203], v38 offset:51200
 v_mfma_f32_16x16x32_bf16 v[160:163], a[24:27], a[112:115], v[160:163]
 s_add_u32 m0, s18, 33792
 ds_read_b64_tr_b16 a[232:233], v38 offset:57344
 ds_read_b64_tr_b16 a[234:235], v38 offset:59392
 v_mfma_f32_16x16x32_bf16 v[160:163], a[56:59], a[120:123], v[160:163]
 buffer_load_dwordx4 v9, s[32:35], s15 offen lds
 v_mfma_f32_16x16x32_bf16 v[164:167], a[56:59], a[124:127], v[164:167]
 ds_read_b64_tr_b16 a[204:205], v39 offset:49152
 v_mfma_f32_16x16x32_bf16 v[164:167], a[24:27], a[116:119], v[164:167]
 ds_read_b64_tr_b16 a[206:207], v39 offset:51200
 ds_read_b64_tr_b16 a[236:237], v39 offset:57344
 v_mfma_f32_16x16x32_bf16 v[172:175], a[28:31], a[116:119], v[172:175]
 buffer_load_dwordx4 a[100:103], v1, s[24:27], s12 offen offset:1024 sc1
 v_mfma_f32_16x16x32_bf16 v[172:175], a[60:63], a[124:127], v[172:175]
 ds_read_b64_tr_b16 a[238:239], v39 offset:59392
 v_mfma_f32_16x16x32_bf16 v[168:171], a[60:63], a[120:123], v[168:171]
 ds_read_b64_tr_b16 a[208:209], v36 offset:53248
 ds_read_b64_tr_b16 a[210:211], v36 offset:55296
 v_mfma_f32_16x16x32_bf16 v[168:171], a[28:31], a[112:115], v[168:171]
 s_add_u32 m0, s18, 34816
 ds_read_b64_tr_b16 a[240:241], v36 offset:61440
 ds_read_b64_tr_b16 a[242:243], v36 offset:63488
 v_mfma_f32_16x16x32_bf16 v[112:115], a[32:35], a[112:115], v[112:115]
 buffer_load_dwordx4 v10, s[32:35], s15 offen lds
 v_mfma_f32_16x16x32_bf16 v[112:115], a[64:67], a[120:123], v[112:115]
 ds_read_b64_tr_b16 a[212:213], v37 offset:53248
 v_mfma_f32_16x16x32_bf16 v[116:119], a[64:67], a[124:127], v[116:119]
 ds_read_b64_tr_b16 a[214:215], v37 offset:55296
 ds_read_b64_tr_b16 a[244:245], v37 offset:61440
 v_mfma_f32_16x16x32_bf16 v[116:119], a[32:35], a[116:119], v[116:119]
 ds_read_b64_tr_b16 a[246:247], v37 offset:63488
 v_mfma_f32_16x16x32_bf16 v[124:127], a[36:39], a[116:119], v[124:127]
 buffer_load_dwordx4 a[104:107], v1, s[24:27], s12 offen offset:2048 sc1
 v_mfma_f32_16x16x32_bf16 v[124:127], a[68:71], a[124:127], v[124:127]
 ds_read_b64_tr_b16 a[216:217], v38 offset:53248
 ds_read_b64_tr_b16 a[218:219], v38 offset:55296
 v_mfma_f32_16x16x32_bf16 v[120:123], a[68:71], a[120:123], v[120:123]
 s_add_u32 m0, s18, 35840
 ds_read_b64_tr_b16 a[248:249], v38 offset:61440
 ds_read_b64_tr_b16 a[250:251], v38 offset:63488
 v_mfma_f32_16x16x32_bf16 v[120:123], a[36:39], a[112:115], v[120:123]
 buffer_load_dwordx4 v11, s[32:35], s15 offen lds
 v_mfma_f32_16x16x32_bf16 v[128:131], a[40:43], a[112:115], v[128:131]
 ds_read_b64_tr_b16 a[220:221], v39 offset:53248
 v_mfma_f32_16x16x32_bf16 v[128:131], a[72:75], a[120:123], v[128:131]
 ds_read_b64_tr_b16 a[222:223], v39 offset:55296
 ds_read_b64_tr_b16 a[252:253], v39 offset:61440
 v_mfma_f32_16x16x32_bf16 v[132:135], a[72:75], a[124:127], v[132:135]
 ds_read_b64_tr_b16 a[254:255], v39 offset:63488
 v_mfma_f32_16x16x32_bf16 v[132:135], a[40:43], a[116:119], v[132:135]
 buffer_load_dwordx4 a[108:111], v1, s[24:27], s12 offen offset:3072 sc1
 v_mfma_f32_16x16x32_bf16 v[140:143], a[44:47], a[116:119], v[140:143]
 v_mfma_f32_16x16x32_bf16 v[140:143], a[76:79], a[124:127], v[140:143]
 v_mfma_f32_16x16x32_bf16 v[136:139], a[76:79], a[120:123], v[136:139]
 v_mfma_f32_16x16x32_bf16 v[136:139], a[44:47], a[112:115], v[136:139]
 s_add_u32 s12, s12, 4096
 s_waitcnt vmcnt(16) lgkmcnt(0)
 v_mfma_f32_16x16x32_bf16 v[144:147], a[192:195], a[128:131], v[144:147]
 s_barrier
 s_add_u32 s15, s17, 1310720
 ds_read_b64_tr_b16 a[16:17], v36 offset:0
 ds_read_b64_tr_b16 a[18:19], v36 offset:2048
 v_mfma_f32_16x16x32_bf16 v[144:147], a[224:227], a[136:139], v[144:147]
 s_add_u32 m0, s18, 49152
 ds_read_b64_tr_b16 a[48:49], v36 offset:8192
 ds_read_b64_tr_b16 a[50:51], v36 offset:10240
 v_mfma_f32_16x16x32_bf16 v[148:151], a[224:227], a[140:143], v[148:151]
 buffer_load_dwordx4 v8, s[32:35], s15 offen lds
 v_mfma_f32_16x16x32_bf16 v[148:151], a[192:195], a[132:135], v[148:151]
 ds_read_b64_tr_b16 a[20:21], v37 offset:0
 ds_read_b64_tr_b16 a[22:23], v37 offset:2048
 v_mfma_f32_16x16x32_bf16 v[156:159], a[196:199], a[132:135], v[156:159]
 buffer_load_dwordx4 a[112:115], v1, s[24:27], s13 offen sc1
 v_mfma_f32_16x16x32_bf16 v[156:159], a[228:231], a[140:143], v[156:159]
 ds_read_b64_tr_b16 a[52:53], v37 offset:8192
 ds_read_b64_tr_b16 a[54:55], v37 offset:10240
 v_mfma_f32_16x16x32_bf16 v[152:155], a[228:231], a[136:139], v[152:155]
 s_add_u32 m0, s18, 50176
 ds_read_b64_tr_b16 a[24:25], v38 offset:0
 v_mfma_f32_16x16x32_bf16 v[152:155], a[196:199], a[128:131], v[152:155]
 buffer_load_dwordx4 v9, s[32:35], s15 offen lds
 v_mfma_f32_16x16x32_bf16 v[160:163], a[200:203], a[128:131], v[160:163]
 ds_read_b64_tr_b16 a[26:27], v38 offset:2048
 ds_read_b64_tr_b16 a[56:57], v38 offset:8192
 v_mfma_f32_16x16x32_bf16 v[160:163], a[232:235], a[136:139], v[160:163]
 buffer_load_dwordx4 a[116:119], v1, s[24:27], s13 offen offset:1024 sc1
 v_mfma_f32_16x16x32_bf16 v[164:167], a[232:235], a[140:143], v[164:167]
 ds_read_b64_tr_b16 a[58:59], v38 offset:10240
 ds_read_b64_tr_b16 a[28:29], v39 offset:0
 v_mfma_f32_16x16x32_bf16 v[164:167], a[200:203], a[132:135], v[164:167]
 ds_read_b64_tr_b16 a[30:31], v39 offset:2048
 ds_read_b64_tr_b16 a[60:61], v39 offset:8192
 v_mfma_f32_16x16x32_bf16 v[172:175], a[204:207], a[132:135], v[172:175]
 buffer_load_dwordx4 a[120:123], v1, s[24:27], s13 offen offset:2048 sc1
 v_mfma_f32_16x16x32_bf16 v[172:175], a[236:239], a[140:143], v[172:175]
 ds_read_b64_tr_b16 a[62:63], v39 offset:10240
 v_mfma_f32_16x16x32_bf16 v[168:171], a[236:239], a[136:139], v[168:171]
 s_add_u32 m0, s18, 51200
 ds_read_b64_tr_b16 a[32:33], v36 offset:4096
 ds_read_b64_tr_b16 a[34:35], v36 offset:6144
 v_mfma_f32_16x16x32_bf16 v[168:171], a[204:207], a[128:131], v[168:171]
 buffer_load_dwordx4 v10, s[32:35], s15 offen lds
 v_mfma_f32_16x16x32_bf16 v[112:115], a[208:211], a[128:131], v[112:115]
 ds_read_b64_tr_b16 a[64:65], v36 offset:12288
 ds_read_b64_tr_b16 a[66:67], v36 offset:14336
 v_mfma_f32_16x16x32_bf16 v[112:115], a[240:243], a[136:139], v[112:115]
 buffer_load_dwordx4 a[124:127], v1, s[24:27], s13 offen offset:3072 sc1
 v_mfma_f32_16x16x32_bf16 v[116:119], a[240:243], a[140:143], v[116:119]
 ds_read_b64_tr_b16 a[36:37], v37 offset:4096
 ds_read_b64_tr_b16 a[38:39], v37 offset:6144
 v_mfma_f32_16x16x32_bf16 v[116:119], a[208:211], a[132:135], v[116:119]
 ds_read_b64_tr_b16 a[68:69], v37 offset:12288
 ds_read_b64_tr_b16 a[70:71], v37 offset:14336
 v_mfma_f32_16x16x32_bf16 v[124:127], a[212:215], a[132:135], v[124:127]
 buffer_load_dwordx4 a[160:163], v40, s[24:27], s13 offen sc1
 v_mfma_f32_16x16x32_bf16 v[124:127], a[244:247], a[140:143], v[124:127]
 ds_read_b64_tr_b16 a[40:41], v38 offset:4096
 v_mfma_f32_16x16x32_bf16 v[120:123], a[244:247], a[136:139], v[120:123]
 s_add_u32 m0, s18, 52224
 ds_read_b64_tr_b16 a[42:43], v38 offset:6144
 ds_read_b64_tr_b16 a[72:73], v38 offset:12288
 v_mfma_f32_16x16x32_bf16 v[120:123], a[212:215], a[128:131], v[120:123]
 buffer_load_dwordx4 v11, s[32:35], s15 offen lds
 v_mfma_f32_16x16x32_bf16 v[128:131], a[216:219], a[128:131], v[128:131]
 ds_read_b64_tr_b16 a[74:75], v38 offset:14336
 ds_read_b64_tr_b16 a[44:45], v39 offset:4096
 v_mfma_f32_16x16x32_bf16 v[128:131], a[248:251], a[136:139], v[128:131]
 buffer_load_dwordx4 a[164:167], v40, s[24:27], s13 offen offset:1024 sc1
 v_mfma_f32_16x16x32_bf16 v[132:135], a[248:251], a[140:143], v[132:135]
 ds_read_b64_tr_b16 a[46:47], v39 offset:6144
 ds_read_b64_tr_b16 a[76:77], v39 offset:12288
 v_mfma_f32_16x16x32_bf16 v[132:135], a[216:219], a[132:135], v[132:135]
 ds_read_b64_tr_b16 a[78:79], v39 offset:14336
 v_mfma_f32_16x16x32_bf16 v[140:143], a[220:223], a[132:135], v[140:143]
 buffer_load_dwordx4 a[168:171], v40, s[24:27], s13 offen offset:2048 sc1
 v_mfma_f32_16x16x32_bf16 v[140:143], a[252:255], a[140:143], v[140:143]
 v_mfma_f32_16x16x32_bf16 v[136:139], a[252:255], a[136:139], v[136:139]
 v_mfma_f32_16x16x32_bf16 v[136:139], a[220:223], a[128:131], v[136:139]
 s_waitcnt vmcnt(19) lgkmcnt(0)
 v_mfma_f32_16x16x32_bf16 v[144:147], a[16:19], a[80:83], v[144:147]
 s_barrier
 ds_read_b64_tr_b16 a[192:193], v36 offset:16384
 ds_read_b64_tr_b16 a[194:195], v36 offset:18432
 v_mfma_f32_16x16x32_bf16 v[144:147], a[48:51], a[88:91], v[144:147]
 ds_read_b64_tr_b16 a[224:225], v36 offset:24576
 ds_read_b64_tr_b16 a[226:227], v36 offset:26624
 v_mfma_f32_16x16x32_bf16 v[148:151], a[48:51], a[92:95], v[148:151]
 buffer_load_dwordx4 a[172:175], v40, s[24:27], s13 offen offset:3072 sc1
 v_mfma_f32_16x16x32_bf16 v[148:151], a[16:19], a[84:87], v[148:151]
 s_add_u32 s13, s13, 8192
 ds_read_b64_tr_b16 a[196:197], v37 offset:16384
 v_mfma_f32_16x16x32_bf16 v[156:159], a[20:23], a[84:87], v[156:159]
 ds_read_b64_tr_b16 a[198:199], v37 offset:18432
 ds_read_b64_tr_b16 a[228:229], v37 offset:24576
 v_mfma_f32_16x16x32_bf16 v[156:159], a[52:55], a[92:95], v[156:159]
 buffer_load_dwordx4 a[128:131], v1, s[24:27], s13 offen sc1
 v_mfma_f32_16x16x32_bf16 v[152:155], a[52:55], a[88:91], v[152:155]
 ds_read_b64_tr_b16 a[230:231], v37 offset:26624
 v_mfma_f32_16x16x32_bf16 v[152:155], a[20:23], a[80:83], v[152:155]
 ds_read_b64_tr_b16 a[200:201], v38 offset:16384
 ds_read_b64_tr_b16 a[202:203], v38 offset:18432
 v_mfma_f32_16x16x32_bf16 v[160:163], a[24:27], a[80:83], v[160:163]
 ds_read_b64_tr_b16 a[232:233], v38 offset:24576
 ds_read_b64_tr_b16 a[234:235], v38 offset:26624
 v_mfma_f32_16x16x32_bf16 v[160:163], a[56:59], a[88:91], v[160:163]
 buffer_load_dwordx4 a[132:135], v1, s[24:27], s13 offen offset:1024 sc1
 v_mfma_f32_16x16x32_bf16 v[164:167], a[56:59], a[92:95], v[164:167]
 ds_read_b64_tr_b16 a[204:205], v39 offset:16384
 v_mfma_f32_16x16x32_bf16 v[164:167], a[24:27], a[84:87], v[164:167]
 ds_read_b64_tr_b16 a[206:207], v39 offset:18432
 ds_read_b64_tr_b16 a[236:237], v39 offset:24576
 v_mfma_f32_16x16x32_bf16 v[172:175], a[28:31], a[84:87], v[172:175]
 buffer_load_dwordx4 a[136:139], v1, s[24:27], s13 offen offset:2048 sc1
 v_mfma_f32_16x16x32_bf16 v[172:175], a[60:63], a[92:95], v[172:175]
 ds_read_b64_tr_b16 a[238:239], v39 offset:26624
 v_mfma_f32_16x16x32_bf16 v[168:171], a[60:63], a[88:91], v[168:171]
 ds_read_b64_tr_b16 a[208:209], v36 offset:20480
 ds_read_b64_tr_b16 a[210:211], v36 offset:22528
 v_mfma_f32_16x16x32_bf16 v[168:171], a[28:31], a[80:83], v[168:171]
 ds_read_b64_tr_b16 a[240:241], v36 offset:28672
 s_branch L_tp_L_tail0_2_o
L_tp_L_tail0_2:
 s_nop 0
 s_nop 0
 s_branch L_tret
L_tp_L_tail0_2_o:
 ds_read_b64_tr_b16 a[242:243], v36 offset:30720
 v_mfma_f32_16x16x32_bf16 v[112:115], a[32:35], a[80:83], v[112:115]
 buffer_load_dwordx4 a[140:143], v1, s[24:27], s13 offen offset:3072 sc1
 v_mfma_f32_16x16x32_bf16 v[112:115], a[64:67], a[88:91], v[112:115]
 ds_read_b64_tr_b16 a[212:213], v37 offset:20480
 v_mfma_f32_16x16x32_bf16 v[116:119], a[64:67], a[92:95], v[116:119]
 ds_read_b64_tr_b16 a[214:215], v37 offset:22528
 ds_read_b64_tr_b16 a[244:245], v37 offset:28672
 v_mfma_f32_16x16x32_bf16 v[116:119], a[32:35], a[84:87], v[116:119]
 ds_read_b64_tr_b16 a[246:247], v37 offset:30720
 v_mfma_f32_16x16x32_bf16 v[124:127], a[36:39], a[84:87], v[124:127]
 buffer_load_dwordx4 a[176:179], v40, s[24:27], s13 offen sc1
 v_mfma_f32_16x16x32_bf16 v[124:127], a[68:71], a[92:95], v[124:127]
 ds_read_b64_tr_b16 a[216:217], v38 offset:20480
 ds_read_b64_tr_b16 a[218:219], v38 offset:22528
 v_mfma_f32_16x16x32_bf16 v[120:123], a[68:71], a[88:91], v[120:123]
 ds_read_b64_tr_b16 a[248:249], v38 offset:28672
 ds_read_b64_tr_b16 a[250:251], v38 offset:30720
 v_mfma_f32_16x16x32_bf16 v[120:123], a[36:39], a[80:83], v[120:123]
 buffer_load_dwordx4 a[180:183], v40, s[24:27], s13 offen offset:1024 sc1
 v_mfma_f32_16x16x32_bf16 v[128:131], a[40:43], a[80:83], v[128:131]
 ds_read_b64_tr_b16 a[220:221], v39 offset:20480
 v_mfma_f32_16x16x32_bf16 v[128:131], a[72:75], a[88:91], v[128:131]
 ds_read_b64_tr_b16 a[222:223], v39 offset:22528
 ds_read_b64_tr_b16 a[252:253], v39 offset:28672
 v_mfma_f32_16x16x32_bf16 v[132:135], a[72:75], a[92:95], v[132:135]
 ds_read_b64_tr_b16 a[254:255], v39 offset:30720
 v_mfma_f32_16x16x32_bf16 v[132:135], a[40:43], a[84:87], v[132:135]
 buffer_load_dwordx4 a[184:187], v40, s[24:27], s13 offen offset:2048 sc1
 v_mfma_f32_16x16x32_bf16 v[140:143], a[44:47], a[84:87], v[140:143]
 v_mfma_f32_16x16x32_bf16 v[140:143], a[76:79], a[92:95], v[140:143]
 v_mfma_f32_16x16x32_bf16 v[136:139], a[76:79], a[88:91], v[136:139]
 v_mfma_f32_16x16x32_bf16 v[136:139], a[44:47], a[80:83], v[136:139]
 v_add_u32 v36, 81920, v36
 v_add_u32 v37, 81920, v37
 v_add_u32 v38, 81920, v38
 v_add_u32 v39, 81920, v39
 s_waitcnt vmcnt(19) lgkmcnt(0)
 v_mfma_f32_16x16x32_bf16 v[112:115], a[208:211], a[96:99], v[112:115]
 s_barrier
 ds_read_b64_tr_b16 a[16:17], v36 offset:0
 ds_read_b64_tr_b16 a[18:19], v36 offset:2048
 v_mfma_f32_16x16x32_bf16 v[112:115], a[240:243], a[104:107], v[112:115]
 ds_read_b64_tr_b16 a[32:33], v36 offset:4096
 v_mfma_f32_16x16x32_bf16 v[116:119], a[240:243], a[108:111], v[116:119]
 buffer_load_dwordx4 a[188:191], v40, s[24:27], s13 offen offset:3072 sc1
 v_mfma_f32_16x16x32_bf16 v[116:119], a[208:211], a[100:103], v[116:119]
 s_add_u32 s13, s13, 8192
 ds_read_b64_tr_b16 a[34:35], v36 offset:6144
 ds_read_b64_tr_b16 a[48:49], v36 offset:8192
 v_mfma_f32_16x16x32_bf16 v[124:127], a[212:215], a[100:103], v[124:127]
 ds_read_b64_tr_b16 a[50:51], v36 offset:10240
 v_mfma_f32_16x16x32_bf16 v[124:127], a[244:247], a[108:111], v[124:127]
 ds_read_b64_tr_b16 a[64:65], v36 offset:12288
 ds_read_b64_tr_b16 a[66:67], v36 offset:14336
 v_mfma_f32_16x16x32_bf16 v[120:123], a[244:247], a[104:107], v[120:123]
 buffer_load_dwordx4 a[80:83], v1, s[24:27], s13 offen sc1
 v_mfma_f32_16x16x32_bf16 v[120:123], a[212:215], a[96:99], v[120:123]
 ds_read_b64_tr_b16 a[20:21], v37 offset:0
 v_mfma_f32_16x16x32_bf16 v[128:131], a[216:219], a[96:99], v[128:131]
 ds_read_b64_tr_b16 a[22:23], v37 offset:2048
 ds_read_b64_tr_b16 a[36:37], v37 offset:4096
 v_mfma_f32_16x16x32_bf16 v[128:131], a[248:251], a[104:107], v[128:131]
 ds_read_b64_tr_b16 a[38:39], v37 offset:6144
 v_mfma_f32_16x16x32_bf16 v[132:135], a[248:251], a[108:111], v[132:135]
 ds_read_b64_tr_b16 a[52:53], v37 offset:8192
 ds_read_b64_tr_b16 a[54:55], v37 offset:10240
 v_mfma_f32_16x16x32_bf16 v[132:135], a[216:219], a[100:103], v[132:135]
 buffer_load_dwordx4 a[84:87], v1, s[24:27], s13 offen offset:1024 sc1
 v_mfma_f32_16x16x32_bf16 v[140:143], a[220:223], a[100:103], v[140:143]
 ds_read_b64_tr_b16 a[68:69], v37 offset:12288
 v_mfma_f32_16x16x32_bf16 v[140:143], a[252:255], a[108:111], v[140:143]
 ds_read_b64_tr_b16 a[70:71], v37 offset:14336
 v_mfma_f32_16x16x32_bf16 v[136:139], a[252:255], a[104:107], v[136:139]
 ds_read_b64_tr_b16 a[24:25], v38 offset:0
 ds_read_b64_tr_b16 a[26:27], v38 offset:2048
 v_mfma_f32_16x16x32_bf16 v[136:139], a[220:223], a[96:99], v[136:139]
 ds_read_b64_tr_b16 a[40:41], v38 offset:4096
 v_mfma_f32_16x16x32_bf16 v[144:147], a[192:195], a[96:99], v[144:147]
 buffer_load_dwordx4 a[88:91], v1, s[24:27], s13 offen offset:2048 sc1
 v_mfma_f32_16x16x32_bf16 v[144:147], a[224:227], a[104:107], v[144:147]
 ds_read_b64_tr_b16 a[42:43], v38 offset:6144
 ds_read_b64_tr_b16 a[56:57], v38 offset:8192
 v_mfma_f32_16x16x32_bf16 v[148:151], a[224:227], a[108:111], v[148:151]
 ds_read_b64_tr_b16 a[58:59], v38 offset:10240
 v_mfma_f32_16x16x32_bf16 v[148:151], a[192:195], a[100:103], v[148:151]
 ds_read_b64_tr_b16 a[72:73], v38 offset:12288
 ds_read_b64_tr_b16 a[74:75], v38 offset:14336
 v_mfma_f32_16x16x32_bf16 v[156:159], a[196:199], a[100:103], v[156:159]
 ds_read_b64_tr_b16 a[28:29], v39 offset:0
 v_cvt_pk_bf16_f32 v80, v112, v113
 v_mfma_f32_16x16x32_bf16 v[156:159], a[228:231], a[108:111], v[156:159]
 buffer_load_dwordx4 a[92:95], v1, s[24:27], s13 offen offset:3072 sc1
 v_cvt_pk_bf16_f32 v81, v114, v115
 v_mfma_f32_16x16x32_bf16 v[152:155], a[228:231], a[104:107], v[152:155]
 ds_read_b64_tr_b16 a[30:31], v39 offset:2048
 ds_read_b64_tr_b16 a[44:45], v39 offset:4096
 v_cvt_pk_bf16_f32 v82, v120, v121
 v_mfma_f32_16x16x32_bf16 v[152:155], a[196:199], a[96:99], v[152:155]
 ds_read_b64_tr_b16 a[46:47], v39 offset:6144
 v_cvt_pk_bf16_f32 v83, v122, v123
 v_mfma_f32_16x16x32_bf16 v[160:163], a[200:203], a[96:99], v[160:163]
 ds_read_b64_tr_b16 a[60:61], v39 offset:8192
 ds_read_b64_tr_b16 a[62:63], v39 offset:10240
 v_mfma_f32_16x16x32_bf16 v[160:163], a[232:235], a[104:107], v[160:163]
 ds_read_b64_tr_b16 a[76:77], v39 offset:12288
 buffer_store_dwordx4 v[80:83], v1, s[24:27], s61 offen sc1
 v_mfma_f32_16x16x32_bf16 v[164:167], a[232:235], a[108:111], v[164:167]
 buffer_load_dwordx4 a[0:3], v40, s[24:27], s13 offen sc1
 v_cvt_pk_bf16_f32 v84, v128, v129
 v_mfma_f32_16x16x32_bf16 v[164:167], a[200:203], a[100:103], v[164:167]
 ds_read_b64_tr_b16 a[78:79], v39 offset:14336
 v_cvt_pk_bf16_f32 v85, v130, v131
 v_mfma_f32_16x16x32_bf16 v[172:175], a[204:207], a[100:103], v[172:175]
 v_cvt_pk_bf16_f32 v86, v136, v137
 v_mfma_f32_16x16x32_bf16 v[172:175], a[236:239], a[108:111], v[172:175]
 v_cvt_pk_bf16_f32 v87, v138, v139
 v_mfma_f32_16x16x32_bf16 v[168:171], a[236:239], a[104:107], v[168:171]
 v_mfma_f32_16x16x32_bf16 v[168:171], a[204:207], a[96:99], v[168:171]
 buffer_store_dwordx4 v[84:87], v1, s[24:27], s61 offen offset:1024 sc1
 s_waitcnt vmcnt(15) lgkmcnt(0)
 v_mfma_f32_16x16x32_bf16 v[176:179], a[16:19], a[112:115], 0
 s_barrier
 ds_read_b64_tr_b16 a[192:193], v36 offset:16384
 ds_read_b64_tr_b16 a[194:195], v36 offset:18432
 v_cvt_pk_bf16_f32 v88, v116, v117
 v_mfma_f32_16x16x32_bf16 v[176:179], a[32:35], a[120:123], v[176:179]
 ds_read_b64_tr_b16 a[208:209], v36 offset:20480
 v_cvt_pk_bf16_f32 v89, v118, v119
 v_mfma_f32_16x16x32_bf16 v[176:179], a[48:51], a[160:163], v[176:179]
 buffer_load_dwordx4 a[4:7], v40, s[24:27], s13 offen offset:1024 sc1
 v_cvt_pk_bf16_f32 v90, v124, v125
 v_mfma_f32_16x16x32_bf16 v[176:179], a[64:67], a[168:171], v[176:179]
 ds_read_b64_tr_b16 a[210:211], v36 offset:22528
 ds_read_b64_tr_b16 a[224:225], v36 offset:24576
 v_cvt_pk_bf16_f32 v91, v126, v127
 v_mfma_f32_16x16x32_bf16 v[180:183], a[64:67], a[172:175], 0
 ds_read_b64_tr_b16 a[226:227], v36 offset:26624
 v_mfma_f32_16x16x32_bf16 v[180:183], a[48:51], a[164:167], v[180:183]
 ds_read_b64_tr_b16 a[240:241], v36 offset:28672
 ds_read_b64_tr_b16 a[242:243], v36 offset:30720
 buffer_store_dwordx4 v[88:91], v1, s[24:27], s61 offen offset:2048 sc1
 v_mfma_f32_16x16x32_bf16 v[180:183], a[32:35], a[124:127], v[180:183]
 buffer_load_dwordx4 a[8:11], v40, s[24:27], s13 offen offset:2048 sc1
 v_cvt_pk_bf16_f32 v92, v132, v133
 v_mfma_f32_16x16x32_bf16 v[180:183], a[16:19], a[116:119], v[180:183]
 ds_read_b64_tr_b16 a[196:197], v37 offset:16384
 v_cvt_pk_bf16_f32 v93, v134, v135
 v_mfma_f32_16x16x32_bf16 v[188:191], a[20:23], a[116:119], 0
 ds_read_b64_tr_b16 a[198:199], v37 offset:18432
 ds_read_b64_tr_b16 a[212:213], v37 offset:20480
 v_cvt_pk_bf16_f32 v94, v140, v141
 v_mfma_f32_16x16x32_bf16 v[188:191], a[36:39], a[124:127], v[188:191]
 ds_read_b64_tr_b16 a[214:215], v37 offset:22528
 v_cvt_pk_bf16_f32 v95, v142, v143
 v_mfma_f32_16x16x32_bf16 v[188:191], a[52:55], a[164:167], v[188:191]
 ds_read_b64_tr_b16 a[228:229], v37 offset:24576
 ds_read_b64_tr_b16 a[230:231], v37 offset:26624
 v_mfma_f32_16x16x32_bf16 v[188:191], a[68:71], a[172:175], v[188:191]
 buffer_load_dwordx4 a[12:15], v40, s[24:27], s13 offen offset:3072 sc1
 buffer_store_dwordx4 v[92:95], v1, s[24:27], s61 offen offset:3072 sc1
 v_mfma_f32_16x16x32_bf16 v[184:187], a[68:71], a[168:171], 0
 s_add_u32 s13, s13, 8192
 ds_read_b64_tr_b16 a[244:245], v37 offset:28672
 v_mfma_f32_16x16x32_bf16 v[184:187], a[52:55], a[160:163], v[184:187]
 ds_read_b64_tr_b16 a[246:247], v37 offset:30720
 v_mfma_f32_16x16x32_bf16 v[184:187], a[36:39], a[120:123], v[184:187]
 ds_read_b64_tr_b16 a[200:201], v38 offset:16384
 ds_read_b64_tr_b16 a[202:203], v38 offset:18432
 v_mfma_f32_16x16x32_bf16 v[184:187], a[20:23], a[112:115], v[184:187]
 ds_read_b64_tr_b16 a[216:217], v38 offset:20480
 v_mfma_f32_16x16x32_bf16 v[192:195], a[24:27], a[112:115], 0
 buffer_load_dwordx4 a[96:99], v1, s[24:27], s13 offen sc1
 v_mfma_f32_16x16x32_bf16 v[192:195], a[40:43], a[120:123], v[192:195]
 ds_read_b64_tr_b16 a[218:219], v38 offset:22528
 ds_read_b64_tr_b16 a[232:233], v38 offset:24576
 v_mfma_f32_16x16x32_bf16 v[192:195], a[56:59], a[160:163], v[192:195]
 ds_read_b64_tr_b16 a[234:235], v38 offset:26624
 v_mfma_f32_16x16x32_bf16 v[192:195], a[72:75], a[168:171], v[192:195]
 ds_read_b64_tr_b16 a[248:249], v38 offset:28672
 ds_read_b64_tr_b16 a[250:251], v38 offset:30720
 v_mfma_f32_16x16x32_bf16 v[196:199], a[72:75], a[172:175], 0
 ds_read_b64_tr_b16 a[204:205], v39 offset:16384
 v_mfma_f32_16x16x32_bf16 v[196:199], a[56:59], a[164:167], v[196:199]
 buffer_load_dwordx4 a[100:103], v1, s[24:27], s13 offen offset:1024 sc1
 v_mfma_f32_16x16x32_bf16 v[196:199], a[40:43], a[124:127], v[196:199]
 ds_read_b64_tr_b16 a[206:207], v39 offset:18432
 ds_read_b64_tr_b16 a[220:221], v39 offset:20480
 v_mfma_f32_16x16x32_bf16 v[196:199], a[24:27], a[116:119], v[196:199]
 ds_read_b64_tr_b16 a[222:223], v39 offset:22528
 v_mfma_f32_16x16x32_bf16 v[204:207], a[28:31], a[116:119], 0
 ds_read_b64_tr_b16 a[236:237], v39 offset:24576
 ds_read_b64_tr_b16 a[238:239], v39 offset:26624
 v_mfma_f32_16x16x32_bf16 v[204:207], a[44:47], a[124:127], v[204:207]
 ds_read_b64_tr_b16 a[252:253], v39 offset:28672
 v_mfma_f32_16x16x32_bf16 v[204:207], a[60:63], a[164:167], v[204:207]
 buffer_load_dwordx4 a[104:107], v1, s[24:27], s13 offen offset:2048 sc1
 v_mfma_f32_16x16x32_bf16 v[204:207], a[76:79], a[172:175], v[204:207]
 ds_read_b64_tr_b16 a[254:255], v39 offset:30720
 v_mfma_f32_16x16x32_bf16 v[200:203], a[76:79], a[168:171], 0
 v_mfma_f32_16x16x32_bf16 v[200:203], a[60:63], a[160:163], v[200:203]
 v_mfma_f32_16x16x32_bf16 v[200:203], a[44:47], a[120:123], v[200:203]
 v_mfma_f32_16x16x32_bf16 v[200:203], a[28:31], a[112:115], v[200:203]
 s_waitcnt vmcnt(15) lgkmcnt(0)
 v_mfma_f32_16x16x32_bf16 v[176:179], a[192:195], a[128:131], v[176:179]
 s_barrier
 ds_read_b64_tr_b16 a[16:17], v36 offset:32768
 ds_read_b64_tr_b16 a[18:19], v36 offset:34816
 v_mfma_f32_16x16x32_bf16 v[176:179], a[208:211], a[136:139], v[176:179]
 ds_read_b64_tr_b16 a[32:33], v36 offset:36864
 ds_read_b64_tr_b16 a[34:35], v36 offset:38912
 v_mfma_f32_16x16x32_bf16 v[176:179], a[224:227], a[176:179], v[176:179]
 buffer_load_dwordx4 a[108:111], v1, s[24:27], s13 offen offset:3072 sc1
 v_mfma_f32_16x16x32_bf16 v[176:179], a[240:243], a[184:187], v[176:179]
 ds_read_b64_tr_b16 a[48:49], v36 offset:40960
 v_mfma_f32_16x16x32_bf16 v[180:183], a[240:243], a[188:191], v[180:183]
 ds_read_b64_tr_b16 a[50:51], v36 offset:43008
 ds_read_b64_tr_b16 a[64:65], v36 offset:45056
 v_mfma_f32_16x16x32_bf16 v[180:183], a[224:227], a[180:183], v[180:183]
 buffer_load_dwordx4 a[144:147], v40, s[24:27], s13 offen sc1
 v_mfma_f32_16x16x32_bf16 v[180:183], a[208:211], a[140:143], v[180:183]
 ds_read_b64_tr_b16 a[66:67], v36 offset:47104
 v_mfma_f32_16x16x32_bf16 v[180:183], a[192:195], a[132:135], v[180:183]
 ds_read_b64_tr_b16 a[20:21], v37 offset:32768
 ds_read_b64_tr_b16 a[22:23], v37 offset:34816
 v_mfma_f32_16x16x32_bf16 v[188:191], a[196:199], a[132:135], v[188:191]
 ds_read_b64_tr_b16 a[36:37], v37 offset:36864
 ds_read_b64_tr_b16 a[38:39], v37 offset:38912
 v_mfma_f32_16x16x32_bf16 v[188:191], a[212:215], a[140:143], v[188:191]
 buffer_load_dwordx4 a[148:151], v40, s[24:27], s13 offen offset:1024 sc1
 v_mfma_f32_16x16x32_bf16 v[188:191], a[228:231], a[180:183], v[188:191]
 ds_read_b64_tr_b16 a[52:53], v37 offset:40960
 v_mfma_f32_16x16x32_bf16 v[188:191], a[244:247], a[188:191], v[188:191]
 ds_read_b64_tr_b16 a[54:55], v37 offset:43008
 ds_read_b64_tr_b16 a[68:69], v37 offset:45056
 v_mfma_f32_16x16x32_bf16 v[184:187], a[244:247], a[184:187], v[184:187]
 buffer_load_dwordx4 a[152:155], v40, s[24:27], s13 offen offset:2048 sc1
 v_mfma_f32_16x16x32_bf16 v[184:187], a[228:231], a[176:179], v[184:187]
 ds_read_b64_tr_b16 a[70:71], v37 offset:47104
 v_mfma_f32_16x16x32_bf16 v[184:187], a[212:215], a[136:139], v[184:187]
 ds_read_b64_tr_b16 a[24:25], v38 offset:32768
 ds_read_b64_tr_b16 a[26:27], v38 offset:34816
 v_mfma_f32_16x16x32_bf16 v[184:187], a[196:199], a[128:131], v[184:187]
 ds_read_b64_tr_b16 a[40:41], v38 offset:36864
 ds_read_b64_tr_b16 a[42:43], v38 offset:38912
 v_mfma_f32_16x16x32_bf16 v[192:195], a[200:203], a[128:131], v[192:195]
 buffer_load_dwordx4 a[156:159], v40, s[24:27], s13 offen offset:3072 sc1
 v_mfma_f32_16x16x32_bf16 v[192:195], a[216:219], a[136:139], v[192:195]
 s_add_u32 s13, s13, 8192
 ds_read_b64_tr_b16 a[56:57], v38 offset:40960
 v_mfma_f32_16x16x32_bf16 v[192:195], a[232:235], a[176:179], v[192:195]
 ds_read_b64_tr_b16 a[58:59], v38 offset:43008
 ds_read_b64_tr_b16 a[72:73], v38 offset:45056
 v_mfma_f32_16x16x32_bf16 v[192:195], a[248:251], a[184:187], v[192:195]
 ds_read_b64_tr_b16 a[74:75], v38 offset:47104
 v_mfma_f32_16x16x32_bf16 v[196:199], a[248:251], a[188:191], v[196:199]
 buffer_load_dwordx4 a[112:115], v1, s[24:27], s13 offen sc1
 v_mfma_f32_16x16x32_bf16 v[196:199], a[232:235], a[180:183], v[196:199]
 ds_read_b64_tr_b16 a[28:29], v39 offset:32768
 ds_read_b64_tr_b16 a[30:31], v39 offset:34816
 v_mfma_f32_16x16x32_bf16 v[196:199], a[216:219], a[140:143], v[196:199]
 ds_read_b64_tr_b16 a[44:45], v39 offset:36864
 ds_read_b64_tr_b16 a[46:47], v39 offset:38912
 v_mfma_f32_16x16x32_bf16 v[196:199], a[200:203], a[132:135], v[196:199]
 buffer_load_dwordx4 a[116:119], v1, s[24:27], s13 offen offset:1024 sc1
 v_mfma_f32_16x16x32_bf16 v[204:207], a[204:207], a[132:135], v[204:207]
 ds_read_b64_tr_b16 a[60:61], v39 offset:40960
 v_mfma_f32_16x16x32_bf16 v[204:207], a[220:223], a[140:143], v[204:207]
 ds_read_b64_tr_b16 a[62:63], v39 offset:43008
 ds_read_b64_tr_b16 a[76:77], v39 offset:45056
 v_mfma_f32_16x16x32_bf16 v[204:207], a[236:239], a[180:183], v[204:207]
 ds_read_b64_tr_b16 a[78:79], v39 offset:47104
 v_mfma_f32_16x16x32_bf16 v[204:207], a[252:255], a[188:191], v[204:207]
 buffer_load_dwordx4 a[120:123], v1, s[24:27], s13 offen offset:2048 sc1
 v_mfma_f32_16x16x32_bf16 v[200:203], a[252:255], a[184:187], v[200:203]
 v_mfma_f32_16x16x32_bf16 v[200:203], a[236:239], a[176:179], v[200:203]
 v_mfma_f32_16x16x32_bf16 v[200:203], a[220:223], a[136:139], v[200:203]
 v_mfma_f32_16x16x32_bf16 v[200:203], a[204:207], a[128:131], v[200:203]
 s_waitcnt vmcnt(12) lgkmcnt(0)
 v_mfma_f32_16x16x32_bf16 v[176:179], a[16:19], a[80:83], v[176:179]
 s_barrier
 s_add_u32 s15, s17, 1572864
 ds_read_b64_tr_b16 a[192:193], v36 offset:49152
 ds_read_b64_tr_b16 a[194:195], v36 offset:51200
 v_mfma_f32_16x16x32_bf16 v[176:179], a[32:35], a[88:91], v[176:179]
 s_add_u32 m0, s18, 0
 ds_read_b64_tr_b16 a[208:209], v36 offset:53248
 ds_read_b64_tr_b16 a[210:211], v36 offset:55296
 v_mfma_f32_16x16x32_bf16 v[176:179], a[48:51], a[0:3], v[176:179]
 buffer_load_dwordx4 v8, s[32:35], s15 offen lds
 v_mfma_f32_16x16x32_bf16 v[176:179], a[64:67], a[8:11], v[176:179]
 ds_read_b64_tr_b16 a[224:225], v36 offset:57344
 ds_read_b64_tr_b16 a[226:227], v36 offset:59392
 v_mfma_f32_16x16x32_bf16 v[180:183], a[64:67], a[12:15], v[180:183]
 buffer_load_dwordx4 a[124:127], v1, s[24:27], s13 offen offset:3072 sc1
 v_mfma_f32_16x16x32_bf16 v[180:183], a[48:51], a[4:7], v[180:183]
 ds_read_b64_tr_b16 a[240:241], v36 offset:61440
 v_mfma_f32_16x16x32_bf16 v[180:183], a[32:35], a[92:95], v[180:183]
 s_add_u32 m0, s18, 1024
 ds_read_b64_tr_b16 a[242:243], v36 offset:63488
 ds_read_b64_tr_b16 a[196:197], v37 offset:49152
 v_mfma_f32_16x16x32_bf16 v[180:183], a[16:19], a[84:87], v[180:183]
 buffer_load_dwordx4 v9, s[32:35], s15 offen lds
 v_mfma_f32_16x16x32_bf16 v[188:191], a[20:23], a[84:87], v[188:191]
 ds_read_b64_tr_b16 a[198:199], v37 offset:51200
 ds_read_b64_tr_b16 a[212:213], v37 offset:53248
 v_mfma_f32_16x16x32_bf16 v[188:191], a[36:39], a[92:95], v[188:191]
 ds_read_b64_tr_b16 a[214:215], v37 offset:55296
 v_mfma_f32_16x16x32_bf16 v[188:191], a[52:55], a[4:7], v[188:191]
 buffer_load_dwordx4 a[160:163], v40, s[24:27], s13 offen sc1
 v_mfma_f32_16x16x32_bf16 v[188:191], a[68:71], a[12:15], v[188:191]
 ds_read_b64_tr_b16 a[228:229], v37 offset:57344
 ds_read_b64_tr_b16 a[230:231], v37 offset:59392
 v_mfma_f32_16x16x32_bf16 v[184:187], a[68:71], a[8:11], v[184:187]
 ds_read_b64_tr_b16 a[244:245], v37 offset:61440
 ds_read_b64_tr_b16 a[246:247], v37 offset:63488
 v_mfma_f32_16x16x32_bf16 v[184:187], a[52:55], a[0:3], v[184:187]
 buffer_load_dwordx4 a[164:167], v40, s[24:27], s13 offen offset:1024 sc1
 v_mfma_f32_16x16x32_bf16 v[184:187], a[36:39], a[88:91], v[184:187]
 ds_read_b64_tr_b16 a[200:201], v38 offset:49152
 v_mfma_f32_16x16x32_bf16 v[184:187], a[20:23], a[80:83], v[184:187]
 s_add_u32 m0, s18, 2048
 ds_read_b64_tr_b16 a[202:203], v38 offset:51200
 ds_read_b64_tr_b16 a[216:217], v38 offset:53248
 v_mfma_f32_16x16x32_bf16 v[192:195], a[24:27], a[80:83], v[192:195]
 buffer_load_dwordx4 v10, s[32:35], s15 offen lds
 v_mfma_f32_16x16x32_bf16 v[192:195], a[40:43], a[88:91], v[192:195]
 ds_read_b64_tr_b16 a[218:219], v38 offset:55296
 ds_read_b64_tr_b16 a[232:233], v38 offset:57344
 v_mfma_f32_16x16x32_bf16 v[192:195], a[56:59], a[0:3], v[192:195]
 ds_read_b64_tr_b16 a[234:235], v38 offset:59392
 v_mfma_f32_16x16x32_bf16 v[192:195], a[72:75], a[8:11], v[192:195]
 buffer_load_dwordx4 a[168:171], v40, s[24:27], s13 offen offset:2048 sc1
 v_mfma_f32_16x16x32_bf16 v[196:199], a[72:75], a[12:15], v[196:199]
 ds_read_b64_tr_b16 a[248:249], v38 offset:61440
 ds_read_b64_tr_b16 a[250:251], v38 offset:63488
 v_mfma_f32_16x16x32_bf16 v[196:199], a[56:59], a[4:7], v[196:199]
 s_add_u32 m0, s18, 3072
 ds_read_b64_tr_b16 a[204:205], v39 offset:49152
 ds_read_b64_tr_b16 a[206:207], v39 offset:51200
 v_mfma_f32_16x16x32_bf16 v[196:199], a[40:43], a[92:95], v[196:199]
 buffer_load_dwordx4 v11, s[32:35], s15 offen lds
 v_mfma_f32_16x16x32_bf16 v[196:199], a[24:27], a[84:87], v[196:199]
 ds_read_b64_tr_b16 a[220:221], v39 offset:53248
 v_mfma_f32_16x16x32_bf16 v[204:207], a[28:31], a[84:87], v[204:207]
 ds_read_b64_tr_b16 a[222:223], v39 offset:55296
 ds_read_b64_tr_b16 a[236:237], v39 offset:57344
 v_mfma_f32_16x16x32_bf16 v[204:207], a[44:47], a[92:95], v[204:207]
 buffer_load_dwordx4 a[172:175], v40, s[24:27], s13 offen offset:3072 sc1
 v_mfma_f32_16x16x32_bf16 v[204:207], a[60:63], a[4:7], v[204:207]
 s_add_u32 s13, s13, 8192
 ds_read_b64_tr_b16 a[238:239], v39 offset:59392
 ds_read_b64_tr_b16 a[252:253], v39 offset:61440
 v_mfma_f32_16x16x32_bf16 v[204:207], a[76:79], a[12:15], v[204:207]
 ds_read_b64_tr_b16 a[254:255], v39 offset:63488
 v_mfma_f32_16x16x32_bf16 v[200:203], a[76:79], a[8:11], v[200:203]
 buffer_load_dwordx4 a[128:131], v1, s[24:27], s13 offen sc1
 v_mfma_f32_16x16x32_bf16 v[200:203], a[60:63], a[0:3], v[200:203]
 v_mfma_f32_16x16x32_bf16 v[200:203], a[44:47], a[88:91], v[200:203]
 v_mfma_f32_16x16x32_bf16 v[200:203], a[28:31], a[80:83], v[200:203]
 v_add_u32 v36, 0xfffec000, v36
 v_add_u32 v37, 0xfffec000, v37
 v_add_u32 v38, 0xfffec000, v38
 v_add_u32 v39, 0xfffec000, v39
 s_waitcnt vmcnt(13) lgkmcnt(0)
 v_mfma_f32_16x16x32_bf16 v[176:179], a[192:195], a[96:99], v[176:179]
 s_barrier
 ds_read_b64_tr_b16 a[16:17], v36 offset:32768
 ds_read_b64_tr_b16 a[18:19], v36 offset:34816
 v_mfma_f32_16x16x32_bf16 v[176:179], a[208:211], a[104:107], v[176:179]
 ds_read_b64_tr_b16 a[32:33], v36 offset:36864
 ds_read_b64_tr_b16 a[34:35], v36 offset:38912
 v_mfma_f32_16x16x32_bf16 v[176:179], a[224:227], a[144:147], v[176:179]
 buffer_load_dwordx4 a[132:135], v1, s[24:27], s13 offen offset:1024 sc1
 v_mfma_f32_16x16x32_bf16 v[176:179], a[240:243], a[152:155], v[176:179]
 ds_read_b64_tr_b16 a[48:49], v36 offset:40960
 v_mfma_f32_16x16x32_bf16 v[180:183], a[240:243], a[156:159], v[180:183]
 ds_read_b64_tr_b16 a[50:51], v36 offset:43008
 ds_read_b64_tr_b16 a[64:65], v36 offset:45056
 v_mfma_f32_16x16x32_bf16 v[180:183], a[224:227], a[148:151], v[180:183]
 buffer_load_dwordx4 a[136:139], v1, s[24:27], s13 offen offset:2048 sc1
 v_mfma_f32_16x16x32_bf16 v[180:183], a[208:211], a[108:111], v[180:183]
 ds_read_b64_tr_b16 a[66:67], v36 offset:47104
 v_mfma_f32_16x16x32_bf16 v[180:183], a[192:195], a[100:103], v[180:183]
 ds_read_b64_tr_b16 a[20:21], v37 offset:32768
 ds_read_b64_tr_b16 a[22:23], v37 offset:34816
 v_mfma_f32_16x16x32_bf16 v[188:191], a[196:199], a[100:103], v[188:191]
 ds_read_b64_tr_b16 a[36:37], v37 offset:36864
 ds_read_b64_tr_b16 a[38:39], v37 offset:38912
 v_mfma_f32_16x16x32_bf16 v[188:191], a[212:215], a[108:111], v[188:191]
 buffer_load_dwordx4 a[140:143], v1, s[24:27], s13 offen offset:3072 sc1
 v_mfma_f32_16x16x32_bf16 v[188:191], a[228:231], a[148:151], v[188:191]
 ds_read_b64_tr_b16 a[52:53], v37 offset:40960
 v_mfma_f32_16x16x32_bf16 v[188:191], a[244:247], a[156:159], v[188:191]
 ds_read_b64_tr_b16 a[54:55], v37 offset:43008
 ds_read_b64_tr_b16 a[68:69], v37 offset:45056
 v_mfma_f32_16x16x32_bf16 v[184:187], a[244:247], a[152:155], v[184:187]
 buffer_load_dwordx4 a[176:179], v40, s[24:27], s13 offen sc1
 v_mfma_f32_16x16x32_bf16 v[184:187], a[228:231], a[144:147], v[184:187]
 ds_read_b64_tr_b16 a[70:71], v37 offset:47104
 v_mfma_f32_16x16x32_bf16 v[184:187], a[212:215], a[104:107], v[184:187]
 ds_read_b64_tr_b16 a[24:25], v38 offset:32768
 ds_read_b64_tr_b16 a[26:27], v38 offset:34816
 v_mfma_f32_16x16x32_bf16 v[184:187], a[196:199], a[96:99], v[184:187]
 ds_read_b64_tr_b16 a[40:41], v38 offset:36864
 ds_read_b64_tr_b16 a[42:43], v38 offset:38912
 v_mfma_f32_16x16x32_bf16 v[192:195], a[200:203], a[96:99], v[192:195]
 buffer_load_dwordx4 a[180:183], v40, s[24:27], s13 offen offset:1024 sc1
 v_mfma_f32_16x16x32_bf16 v[192:195], a[216:219], a[104:107], v[192:195]
 ds_read_b64_tr_b16 a[56:57], v38 offset:40960
 v_mfma_f32_16x16x32_bf16 v[192:195], a[232:235], a[144:147], v[192:195]
 ds_read_b64_tr_b16 a[58:59], v38 offset:43008
 ds_read_b64_tr_b16 a[72:73], v38 offset:45056
 v_mfma_f32_16x16x32_bf16 v[192:195], a[248:251], a[152:155], v[192:195]
 ds_read_b64_tr_b16 a[74:75], v38 offset:47104
 v_mfma_f32_16x16x32_bf16 v[196:199], a[248:251], a[156:159], v[196:199]
 buffer_load_dwordx4 a[184:187], v40, s[24:27], s13 offen offset:2048 sc1
 v_mfma_f32_16x16x32_bf16 v[196:199], a[232:235], a[148:151], v[196:199]
 ds_read_b64_tr_b16 a[28:29], v39 offset:32768
 ds_read_b64_tr_b16 a[30:31], v39 offset:34816
 v_mfma_f32_16x16x32_bf16 v[196:199], a[216:219], a[108:111], v[196:199]
 ds_read_b64_tr_b16 a[44:45], v39 offset:36864
 ds_read_b64_tr_b16 a[46:47], v39 offset:38912
 v_mfma_f32_16x16x32_bf16 v[196:199], a[200:203], a[100:103], v[196:199]
 buffer_load_dwordx4 a[188:191], v40, s[24:27], s13 offen offset:3072 sc1
 v_mfma_f32_16x16x32_bf16 v[204:207], a[204:207], a[100:103], v[204:207]
 s_add_u32 s13, s13, 8192
 ds_read_b64_tr_b16 a[60:61], v39 offset:40960
 v_mfma_f32_16x16x32_bf16 v[204:207], a[220:223], a[108:111], v[204:207]
 ds_read_b64_tr_b16 a[62:63], v39 offset:43008
 ds_read_b64_tr_b16 a[76:77], v39 offset:45056
 v_mfma_f32_16x16x32_bf16 v[204:207], a[236:239], a[148:151], v[204:207]
 ds_read_b64_tr_b16 a[78:79], v39 offset:47104
 v_mfma_f32_16x16x32_bf16 v[204:207], a[252:255], a[156:159], v[204:207]
 buffer_load_dwordx4 a[80:83], v1, s[24:27], s13 offen sc1
 v_mfma_f32_16x16x32_bf16 v[200:203], a[252:255], a[152:155], v[200:203]
 v_mfma_f32_16x16x32_bf16 v[200:203], a[236:239], a[144:147], v[200:203]
 v_mfma_f32_16x16x32_bf16 v[200:203], a[220:223], a[104:107], v[200:203]
 v_mfma_f32_16x16x32_bf16 v[200:203], a[204:207], a[96:99], v[200:203]
 s_waitcnt vmcnt(9) lgkmcnt(0)
 v_mfma_f32_16x16x32_bf16 v[176:179], a[16:19], a[112:115], v[176:179]
 s_barrier
 ds_read_b64_tr_b16 a[192:193], v36 offset:49152
 ds_read_b64_tr_b16 a[194:195], v36 offset:51200
 ds_read_b64_tr_b16 a[208:209], v36 offset:53248
 v_mfma_f32_16x16x32_bf16 v[176:179], a[32:35], a[120:123], v[176:179]
 buffer_load_dwordx4 v[64:67], v1, s[24:27], s65 offen sc1
 v_mfma_f32_16x16x32_bf16 v[176:179], a[48:51], a[160:163], v[176:179]
 buffer_load_dwordx4 v[68:71], v1, s[24:27], s65 offen offset:1024 sc1
 v_mfma_f32_16x16x32_bf16 v[176:179], a[64:67], a[168:171], v[176:179]
 buffer_load_dwordx4 v[72:75], v1, s[24:27], s65 offen offset:2048 sc1
 v_mfma_f32_16x16x32_bf16 v[180:183], a[64:67], a[172:175], v[180:183]
 s_add_u32 s15, s17, 1835008
 buffer_load_dwordx4 v[76:79], v1, s[24:27], s65 offen offset:3072 sc1
 v_mfma_f32_16x16x32_bf16 v[180:183], a[48:51], a[164:167], v[180:183]
 s_add_u32 m0, s18, 16384
 ds_read_b64_tr_b16 a[210:211], v36 offset:55296
 ds_read_b64_tr_b16 a[224:225], v36 offset:57344
 v_mfma_f32_16x16x32_bf16 v[180:183], a[32:35], a[124:127], v[180:183]
 buffer_load_dwordx4 v8, s[32:35], s15 offen lds
 v_mfma_f32_16x16x32_bf16 v[180:183], a[16:19], a[116:119], v[180:183]
 ds_read_b64_tr_b16 a[226:227], v36 offset:59392
 ds_read_b64_tr_b16 a[240:241], v36 offset:61440
 v_mfma_f32_16x16x32_bf16 v[188:191], a[20:23], a[116:119], v[188:191]
 buffer_load_dwordx4 a[84:87], v1, s[24:27], s13 offen offset:1024 sc1
 v_mfma_f32_16x16x32_bf16 v[188:191], a[36:39], a[124:127], v[188:191]
 s_add_u32 m0, s18, 17408
 ds_read_b64_tr_b16 a[242:243], v36 offset:63488
 ds_read_b64_tr_b16 a[196:197], v37 offset:49152
 ds_read_b64_tr_b16 a[198:199], v37 offset:51200
 v_mfma_f32_16x16x32_bf16 v[188:191], a[52:55], a[164:167], v[188:191]
 buffer_load_dwordx4 v9, s[32:35], s15 offen lds
 v_mfma_f32_16x16x32_bf16 v[188:191], a[68:71], a[172:175], v[188:191]
 ds_read_b64_tr_b16 a[212:213], v37 offset:53248
 ds_read_b64_tr_b16 a[214:215], v37 offset:55296
 v_mfma_f32_16x16x32_bf16 v[184:187], a[68:71], a[168:171], v[184:187]
 buffer_load_dwordx4 a[88:91], v1, s[24:27], s13 offen offset:2048 sc1
 v_mfma_f32_16x16x32_bf16 v[184:187], a[52:55], a[160:163], v[184:187]
 ds_read_b64_tr_b16 a[228:229], v37 offset:57344
 ds_read_b64_tr_b16 a[230:231], v37 offset:59392
 v_mfma_f32_16x16x32_bf16 v[184:187], a[36:39], a[120:123], v[184:187]
 ds_read_b64_tr_b16 a[244:245], v37 offset:61440
 ds_read_b64_tr_b16 a[246:247], v37 offset:63488
 v_mfma_f32_16x16x32_bf16 v[184:187], a[20:23], a[112:115], v[184:187]
 buffer_load_dwordx4 a[92:95], v1, s[24:27], s13 offen offset:3072 sc1
 v_mfma_f32_16x16x32_bf16 v[192:195], a[24:27], a[112:115], v[192:195]
 s_add_u32 m0, s18, 18432
 ds_read_b64_tr_b16 a[200:201], v38 offset:49152
 ds_read_b64_tr_b16 a[202:203], v38 offset:51200
 ds_read_b64_tr_b16 a[216:217], v38 offset:53248
 v_mfma_f32_16x16x32_bf16 v[192:195], a[40:43], a[120:123], v[192:195]
 buffer_load_dwordx4 v10, s[32:35], s15 offen lds
 v_mfma_f32_16x16x32_bf16 v[192:195], a[56:59], a[160:163], v[192:195]
 ds_read_b64_tr_b16 a[218:219], v38 offset:55296
 ds_read_b64_tr_b16 a[232:233], v38 offset:57344
 v_mfma_f32_16x16x32_bf16 v[192:195], a[72:75], a[168:171], v[192:195]
 buffer_load_dwordx4 a[0:3], v40, s[24:27], s13 offen sc1
 v_mfma_f32_16x16x32_bf16 v[196:199], a[72:75], a[172:175], v[196:199]
 ds_read_b64_tr_b16 a[234:235], v38 offset:59392
 ds_read_b64_tr_b16 a[248:249], v38 offset:61440
 v_mfma_f32_16x16x32_bf16 v[196:199], a[56:59], a[164:167], v[196:199]
 buffer_load_dwordx4 a[4:7], v40, s[24:27], s13 offen offset:1024 sc1
 v_mfma_f32_16x16x32_bf16 v[196:199], a[40:43], a[124:127], v[196:199]
 ds_read_b64_tr_b16 a[250:251], v38 offset:63488
 ds_read_b64_tr_b16 a[204:205], v39 offset:49152
 ds_read_b64_tr_b16 a[206:207], v39 offset:51200
 v_mfma_f32_16x16x32_bf16 v[196:199], a[24:27], a[116:119], v[196:199]
 s_add_u32 m0, s18, 19456
 ds_read_b64_tr_b16 a[220:221], v39 offset:53248
 ds_read_b64_tr_b16 a[222:223], v39 offset:55296
 v_mfma_f32_16x16x32_bf16 v[204:207], a[28:31], a[116:119], v[204:207]
 buffer_load_dwordx4 v11, s[32:35], s15 offen lds
 v_mfma_f32_16x16x32_bf16 v[204:207], a[44:47], a[124:127], v[204:207]
 ds_read_b64_tr_b16 a[236:237], v39 offset:57344
 ds_read_b64_tr_b16 a[238:239], v39 offset:59392
 v_mfma_f32_16x16x32_bf16 v[204:207], a[60:63], a[164:167], v[204:207]
 buffer_load_dwordx4 a[8:11], v40, s[24:27], s13 offen offset:2048 sc1
 s_branch L_tp_L_tail0_3_o
L_tp_L_tail0_3:
 s_nop 0
 s_branch L_tret
 s_nop 0
L_tp_L_tail0_3_o:
 v_mfma_f32_16x16x32_bf16 v[204:207], a[76:79], a[172:175], v[204:207]
 ds_read_b64_tr_b16 a[252:253], v39 offset:61440
 ds_read_b64_tr_b16 a[254:255], v39 offset:63488
 v_mfma_f32_16x16x32_bf16 v[200:203], a[76:79], a[168:171], v[200:203]
 buffer_load_dwordx4 a[12:15], v40, s[24:27], s13 offen offset:3072 sc1
 v_mfma_f32_16x16x32_bf16 v[200:203], a[60:63], a[160:163], v[200:203]
 s_add_u32 s13, s13, 8192
 v_mfma_f32_16x16x32_bf16 v[200:203], a[44:47], a[120:123], v[200:203]
 v_mfma_f32_16x16x32_bf16 v[200:203], a[28:31], a[112:115], v[200:203]
 s_waitcnt vmcnt(16) lgkmcnt(0)
 v_mfma_f32_16x16x32_bf16 v[176:179], a[192:195], a[128:131], v[176:179]
 s_barrier
 ds_read_b64_tr_b16 a[16:17], v36 offset:0
 ds_read_b64_tr_b16 a[18:19], v36 offset:2048
 v_mfma_f32_16x16x32_bf16 v[176:179], a[208:211], a[136:139], v[176:179]
 ds_read_b64_tr_b16 a[32:33], v36 offset:4096
 ds_read_b64_tr_b16 a[34:35], v36 offset:6144
 v_mfma_f32_16x16x32_bf16 v[176:179], a[224:227], a[176:179], v[176:179]
 buffer_load_dwordx4 a[96:99], v1, s[24:27], s13 offen sc1
 v_mfma_f32_16x16x32_bf16 v[176:179], a[240:243], a[184:187], v[176:179]
 ds_read_b64_tr_b16 a[48:49], v36 offset:8192
 v_mfma_f32_16x16x32_bf16 v[180:183], a[240:243], a[188:191], v[180:183]
 ds_read_b64_tr_b16 a[50:51], v36 offset:10240
 ds_read_b64_tr_b16 a[64:65], v36 offset:12288
 v_mfma_f32_16x16x32_bf16 v[180:183], a[224:227], a[180:183], v[180:183]
 buffer_load_dwordx4 a[100:103], v1, s[24:27], s13 offen offset:1024 sc1
 v_mfma_f32_16x16x32_bf16 v[180:183], a[208:211], a[140:143], v[180:183]
 ds_read_b64_tr_b16 a[66:67], v36 offset:14336
 v_mfma_f32_16x16x32_bf16 v[180:183], a[192:195], a[132:135], v[180:183]
 ds_read_b64_tr_b16 a[20:21], v37 offset:0
 ds_read_b64_tr_b16 a[22:23], v37 offset:2048
 v_mfma_f32_16x16x32_bf16 v[188:191], a[196:199], a[132:135], v[188:191]
 ds_read_b64_tr_b16 a[36:37], v37 offset:4096
 ds_read_b64_tr_b16 a[38:39], v37 offset:6144
 v_mfma_f32_16x16x32_bf16 v[188:191], a[212:215], a[140:143], v[188:191]
 buffer_load_dwordx4 a[104:107], v1, s[24:27], s13 offen offset:2048 sc1
 v_mfma_f32_16x16x32_bf16 v[188:191], a[228:231], a[180:183], v[188:191]
 ds_read_b64_tr_b16 a[52:53], v37 offset:8192
 v_mfma_f32_16x16x32_bf16 v[188:191], a[244:247], a[188:191], v[188:191]
 ds_read_b64_tr_b16 a[54:55], v37 offset:10240
 ds_read_b64_tr_b16 a[68:69], v37 offset:12288
 v_mfma_f32_16x16x32_bf16 v[184:187], a[244:247], a[184:187], v[184:187]
 buffer_load_dwordx4 a[108:111], v1, s[24:27], s13 offen offset:3072 sc1
 v_mfma_f32_16x16x32_bf16 v[184:187], a[228:231], a[176:179], v[184:187]
 ds_read_b64_tr_b16 a[70:71], v37 offset:14336
 v_mfma_f32_16x16x32_bf16 v[184:187], a[212:215], a[136:139], v[184:187]
 ds_read_b64_tr_b16 a[24:25], v38 offset:0
 ds_read_b64_tr_b16 a[26:27], v38 offset:2048
 v_mfma_f32_16x16x32_bf16 v[184:187], a[196:199], a[128:131], v[184:187]
 ds_read_b64_tr_b16 a[40:41], v38 offset:4096
 ds_read_b64_tr_b16 a[42:43], v38 offset:6144
 v_mfma_f32_16x16x32_bf16 v[192:195], a[200:203], a[128:131], v[192:195]
 buffer_load_dwordx4 a[144:147], v40, s[24:27], s13 offen sc1
 v_mfma_f32_16x16x32_bf16 v[192:195], a[216:219], a[136:139], v[192:195]
 ds_read_b64_tr_b16 a[56:57], v38 offset:8192
 v_mfma_f32_16x16x32_bf16 v[192:195], a[232:235], a[176:179], v[192:195]
 ds_read_b64_tr_b16 a[58:59], v38 offset:10240
 ds_read_b64_tr_b16 a[72:73], v38 offset:12288
 v_mfma_f32_16x16x32_bf16 v[192:195], a[248:251], a[184:187], v[192:195]
 ds_read_b64_tr_b16 a[74:75], v38 offset:14336
 v_mfma_f32_16x16x32_bf16 v[196:199], a[248:251], a[188:191], v[196:199]
 buffer_load_dwordx4 a[148:151], v40, s[24:27], s13 offen offset:1024 sc1
 v_mfma_f32_16x16x32_bf16 v[196:199], a[232:235], a[180:183], v[196:199]
 ds_read_b64_tr_b16 a[28:29], v39 offset:0
 ds_read_b64_tr_b16 a[30:31], v39 offset:2048
 v_mfma_f32_16x16x32_bf16 v[196:199], a[216:219], a[140:143], v[196:199]
 ds_read_b64_tr_b16 a[44:45], v39 offset:4096
 ds_read_b64_tr_b16 a[46:47], v39 offset:6144
 v_mfma_f32_16x16x32_bf16 v[196:199], a[200:203], a[132:135], v[196:199]
 buffer_load_dwordx4 a[152:155], v40, s[24:27], s13 offen offset:2048 sc1
 v_mfma_f32_16x16x32_bf16 v[204:207], a[204:207], a[132:135], v[204:207]
 ds_read_b64_tr_b16 a[60:61], v39 offset:8192
 v_mfma_f32_16x16x32_bf16 v[204:207], a[220:223], a[140:143], v[204:207]
 ds_read_b64_tr_b16 a[62:63], v39 offset:10240
 ds_read_b64_tr_b16 a[76:77], v39 offset:12288
 v_mfma_f32_16x16x32_bf16 v[204:207], a[236:239], a[180:183], v[204:207]
 ds_read_b64_tr_b16 a[78:79], v39 offset:14336
 v_mfma_f32_16x16x32_bf16 v[204:207], a[252:255], a[188:191], v[204:207]
 buffer_load_dwordx4 a[156:159], v40, s[24:27], s13 offen offset:3072 sc1
 v_mfma_f32_16x16x32_bf16 v[200:203], a[252:255], a[184:187], v[200:203]
 s_add_u32 s13, s13, 8192
 v_mfma_f32_16x16x32_bf16 v[200:203], a[236:239], a[176:179], v[200:203]
 v_mfma_f32_16x16x32_bf16 v[200:203], a[220:223], a[136:139], v[200:203]
 v_mfma_f32_16x16x32_bf16 v[200:203], a[204:207], a[128:131], v[200:203]
 s_waitcnt vmcnt(8) lgkmcnt(0)
 v_mfma_f32_16x16x32_bf16 v[176:179], a[16:19], a[80:83], v[176:179]
 s_barrier
 ds_read_b64_tr_b16 a[192:193], v36 offset:16384
 v_max3_u32 v4, v64, v65, v66
 v_mfma_f32_16x16x32_bf16 v[176:179], a[32:35], a[88:91], v[176:179]
 s_mov_b32 s6, 0xbfb8aa3b
 ds_read_b64_tr_b16 a[194:195], v36 offset:18432
 v_max3_u32 v5, v67, v68, v69
 v_mfma_f32_16x16x32_bf16 v[176:179], a[48:51], a[0:3], v[176:179]
 ds_read_b64_tr_b16 a[208:209], v36 offset:20480
 v_max3_u32 v4, v4, v70, v71
 v_mfma_f32_16x16x32_bf16 v[176:179], a[64:67], a[8:11], v[176:179]
 ds_read_b64_tr_b16 a[210:211], v36 offset:22528
 v_max3_u32 v5, v5, v72, v73
 v_mfma_f32_16x16x32_bf16 v[180:183], a[64:67], a[12:15], v[180:183]
 ds_read_b64_tr_b16 a[224:225], v36 offset:24576
 v_max3_u32 v4, v4, v74, v75
 v_mfma_f32_16x16x32_bf16 v[180:183], a[48:51], a[4:7], v[180:183]
 ds_read_b64_tr_b16 a[226:227], v36 offset:26624
 v_max3_u32 v5, v5, v76, v77
 v_mfma_f32_16x16x32_bf16 v[180:183], a[32:35], a[92:95], v[180:183]
 ds_read_b64_tr_b16 a[240:241], v36 offset:28672
 v_max3_u32 v4, v4, v78, v79
 v_mfma_f32_16x16x32_bf16 v[180:183], a[16:19], a[84:87], v[180:183]
 ds_read_b64_tr_b16 a[242:243], v36 offset:30720
 v_max_u32 v4, v4, v5
 v_mfma_f32_16x16x32_bf16 v[188:191], a[20:23], a[84:87], v[188:191]
 v_cmp_eq_u32 vcc, -1, v4
 v_mfma_f32_16x16x32_bf16 v[188:191], a[36:39], a[92:95], v[188:191]
 ds_read_b64_tr_b16 a[196:197], v37 offset:16384
 v_mfma_f32_16x16x32_bf16 v[188:191], a[52:55], a[4:7], v[188:191]
 ds_read_b64_tr_b16 a[198:199], v37 offset:18432
 s_cbranch_vccnz L_xb0_s
L_xb0_d:
 v_mfma_f32_16x16x32_bf16 v[144:147], v[14:17], v[64:67], v[144:147]
 ds_read_b64_tr_b16 a[212:213], v37 offset:20480
 v_mfma_f32_16x16x32_bf16 v[152:155], v[12:15], v[64:67], v[152:155]
 ds_read_b64_tr_b16 a[214:215], v37 offset:22528
 v_mfma_f32_16x16x32_bf16 v[148:151], v[14:17], v[72:75], v[148:151]
 ds_read_b64_tr_b16 a[228:229], v37 offset:24576
 v_mfma_f32_16x16x32_bf16 v[156:159], v[12:15], v[72:75], v[156:159]
 ds_read_b64_tr_b16 a[230:231], v37 offset:26624
 v_mfma_f32_16x16x32_bf16 v[160:163], v[14:17], v[68:71], v[160:163]
 ds_read_b64_tr_b16 a[244:245], v37 offset:28672
 v_mfma_f32_16x16x32_bf16 v[168:171], v[12:15], v[68:71], v[168:171]
 ds_read_b64_tr_b16 a[246:247], v37 offset:30720
 v_mfma_f32_16x16x32_bf16 v[164:167], v[14:17], v[76:79], v[164:167]
 v_mfma_f32_16x16x32_bf16 v[172:175], v[12:15], v[76:79], v[172:175]
 ds_read_b64_tr_b16 a[200:201], v38 offset:16384
 v_mfma_f32_16x16x32_bf16 v[188:191], a[68:71], a[12:15], v[188:191]
 ds_read_b64_tr_b16 a[202:203], v38 offset:18432
 v_mul_f32 v112, s6, v144
 v_mul_f32 v113, s6, v145
 v_mfma_f32_16x16x32_bf16 v[184:187], a[68:71], a[8:11], v[184:187]
 ds_read_b64_tr_b16 a[216:217], v38 offset:20480
 v_mul_f32 v114, s6, v146
 v_mul_f32 v115, s6, v147
 v_mfma_f32_16x16x32_bf16 v[184:187], a[52:55], a[0:3], v[184:187]
 ds_read_b64_tr_b16 a[218:219], v38 offset:22528
 v_mul_f32 v120, s6, v152
 v_mul_f32 v121, s6, v153
 v_mfma_f32_16x16x32_bf16 v[184:187], a[36:39], a[88:91], v[184:187]
 ds_read_b64_tr_b16 a[232:233], v38 offset:24576
 v_mul_f32 v122, s6, v154
 v_mul_f32 v123, s6, v155
 v_mfma_f32_16x16x32_bf16 v[184:187], a[20:23], a[80:83], v[184:187]
 ds_read_b64_tr_b16 a[234:235], v38 offset:26624
 v_exp_f32 v112, v112
 v_mfma_f32_16x16x32_bf16 v[192:195], a[24:27], a[80:83], v[192:195]
 ds_read_b64_tr_b16 a[248:249], v38 offset:28672
 v_exp_f32 v113, v113
 v_mfma_f32_16x16x32_bf16 v[192:195], a[40:43], a[88:91], v[192:195]
 ds_read_b64_tr_b16 a[250:251], v38 offset:30720
 v_exp_f32 v114, v114
 v_mfma_f32_16x16x32_bf16 v[192:195], a[56:59], a[0:3], v[192:195]
 v_exp_f32 v115, v115
 v_exp_f32 v120, v120
 v_mfma_f32_16x16x32_bf16 v[192:195], a[72:75], a[8:11], v[192:195]
 ds_read_b64_tr_b16 a[204:205], v39 offset:16384
 v_exp_f32 v121, v121
 v_mfma_f32_16x16x32_bf16 v[196:199], a[72:75], a[12:15], v[196:199]
 ds_read_b64_tr_b16 a[206:207], v39 offset:18432
 v_exp_f32 v122, v122
 v_mfma_f32_16x16x32_bf16 v[196:199], a[56:59], a[4:7], v[196:199]
 ds_read_b64_tr_b16 a[220:221], v39 offset:20480
 v_exp_f32 v123, v123
 v_mfma_f32_16x16x32_bf16 v[196:199], a[40:43], a[92:95], v[196:199]
 ds_read_b64_tr_b16 a[222:223], v39 offset:22528
 v_add_f32 v112, 1.0, v112
 v_add_f32 v113, 1.0, v113
 v_mfma_f32_16x16x32_bf16 v[196:199], a[24:27], a[84:87], v[196:199]
 ds_read_b64_tr_b16 a[236:237], v39 offset:24576
 v_add_f32 v114, 1.0, v114
 v_add_f32 v115, 1.0, v115
 v_mfma_f32_16x16x32_bf16 v[204:207], a[28:31], a[84:87], v[204:207]
 ds_read_b64_tr_b16 a[238:239], v39 offset:26624
 v_add_f32 v120, 1.0, v120
 v_add_f32 v121, 1.0, v121
 v_mfma_f32_16x16x32_bf16 v[204:207], a[44:47], a[92:95], v[204:207]
 ds_read_b64_tr_b16 a[252:253], v39 offset:28672
 v_add_f32 v122, 1.0, v122
 v_add_f32 v123, 1.0, v123
 v_mfma_f32_16x16x32_bf16 v[204:207], a[60:63], a[4:7], v[204:207]
 ds_read_b64_tr_b16 a[254:255], v39 offset:30720
 v_rcp_f32 v112, v112
 v_mfma_f32_16x16x32_bf16 v[204:207], a[76:79], a[12:15], v[204:207]
 v_rcp_f32 v113, v113
 v_rcp_f32 v114, v114
 v_mfma_f32_16x16x32_bf16 v[200:203], a[76:79], a[8:11], v[200:203]
 v_rcp_f32 v115, v115
 v_mfma_f32_16x16x32_bf16 v[200:203], a[60:63], a[0:3], v[200:203]
 v_rcp_f32 v120, v120
 v_rcp_f32 v121, v121
 v_mfma_f32_16x16x32_bf16 v[200:203], a[44:47], a[88:91], v[200:203]
 v_rcp_f32 v122, v122
 v_mfma_f32_16x16x32_bf16 v[200:203], a[28:31], a[80:83], v[200:203]
 v_rcp_f32 v123, v123
 v_mul_f32 v144, v144, v112
 v_mul_f32 v145, v145, v113
 s_waitcnt vmcnt(0) lgkmcnt(0)
 v_mfma_f32_16x16x32_bf16 v[176:179], a[192:195], a[96:99], v[176:179]
 v_mul_f32 v146, v146, v114
 v_mul_f32 v147, v147, v115
 v_mul_f32 v152, v152, v120
 v_mfma_f32_16x16x32_bf16 v[176:179], a[208:211], a[104:107], v[176:179]
 v_mul_f32 v153, v153, v121
 v_mul_f32 v154, v154, v122
 v_mul_f32 v155, v155, v123
 v_mfma_f32_16x16x32_bf16 v[176:179], a[224:227], a[144:147], v[176:179]
 v_mul_f32 v116, s6, v148
 v_mul_f32 v117, s6, v149
 v_mul_f32 v118, s6, v150
 v_mfma_f32_16x16x32_bf16 v[176:179], a[240:243], a[152:155], v[176:179]
 v_mul_f32 v119, s6, v151
 v_mul_f32 v124, s6, v156
 v_mul_f32 v125, s6, v157
 v_mfma_f32_16x16x32_bf16 v[180:183], a[240:243], a[156:159], v[180:183]
 v_mul_f32 v126, s6, v158
 v_mul_f32 v127, s6, v159
 v_exp_f32 v116, v116
 v_mfma_f32_16x16x32_bf16 v[180:183], a[224:227], a[148:151], v[180:183]
 v_exp_f32 v117, v117
 v_mfma_f32_16x16x32_bf16 v[180:183], a[208:211], a[108:111], v[180:183]
 v_exp_f32 v118, v118
 v_exp_f32 v119, v119
 v_mfma_f32_16x16x32_bf16 v[180:183], a[192:195], a[100:103], v[180:183]
 v_exp_f32 v124, v124
 v_mfma_f32_16x16x32_bf16 v[188:191], a[196:199], a[100:103], v[188:191]
 v_exp_f32 v125, v125
 v_exp_f32 v126, v126
 v_mfma_f32_16x16x32_bf16 v[188:191], a[212:215], a[108:111], v[188:191]
 v_exp_f32 v127, v127
 v_add_f32 v116, 1.0, v116
 v_mfma_f32_16x16x32_bf16 v[188:191], a[228:231], a[148:151], v[188:191]
 v_add_f32 v117, 1.0, v117
 v_add_f32 v118, 1.0, v118
 v_add_f32 v119, 1.0, v119
 v_mfma_f32_16x16x32_bf16 v[188:191], a[244:247], a[156:159], v[188:191]
 v_add_f32 v124, 1.0, v124
 v_add_f32 v125, 1.0, v125
 v_add_f32 v126, 1.0, v126
 v_mfma_f32_16x16x32_bf16 v[184:187], a[244:247], a[152:155], v[184:187]
 v_add_f32 v127, 1.0, v127
 v_rcp_f32 v116, v116
 v_mfma_f32_16x16x32_bf16 v[184:187], a[228:231], a[144:147], v[184:187]
 v_rcp_f32 v117, v117
 v_rcp_f32 v118, v118
 v_mfma_f32_16x16x32_bf16 v[184:187], a[212:215], a[104:107], v[184:187]
 v_rcp_f32 v119, v119
 v_mfma_f32_16x16x32_bf16 v[184:187], a[196:199], a[96:99], v[184:187]
 v_rcp_f32 v124, v124
 v_rcp_f32 v125, v125
 v_mfma_f32_16x16x32_bf16 v[192:195], a[200:203], a[96:99], v[192:195]
 v_rcp_f32 v126, v126
 v_mfma_f32_16x16x32_bf16 v[192:195], a[216:219], a[104:107], v[192:195]
 v_rcp_f32 v127, v127
 v_mul_f32 v148, v148, v116
 v_mul_f32 v149, v149, v117
 v_mfma_f32_16x16x32_bf16 v[192:195], a[232:235], a[144:147], v[192:195]
 v_mul_f32 v150, v150, v118
 v_mul_f32 v151, v151, v119
 v_mul_f32 v156, v156, v124
 v_mfma_f32_16x16x32_bf16 v[192:195], a[248:251], a[152:155], v[192:195]
 v_mul_f32 v157, v157, v125
 v_mul_f32 v158, v158, v126
 v_mul_f32 v159, v159, v127
 v_mfma_f32_16x16x32_bf16 v[196:199], a[248:251], a[156:159], v[196:199]
 v_fma_f32 v176, v176, v144, v208
 v_fma_f32 v177, v177, v145, v209
 v_fma_f32 v178, v178, v146, v210
 v_mfma_f32_16x16x32_bf16 v[196:199], a[232:235], a[148:151], v[196:199]
 v_fma_f32 v179, v179, v147, v211
 v_fma_f32 v184, v184, v152, v216
 v_mfma_f32_16x16x32_bf16 v[196:199], a[216:219], a[108:111], v[196:199]
 v_fma_f32 v185, v185, v153, v217
 v_fma_f32 v186, v186, v154, v218
 v_fma_f32 v187, v187, v155, v219
 v_mfma_f32_16x16x32_bf16 v[196:199], a[200:203], a[100:103], v[196:199]
 v_cvt_pk_bf16_f32 v80, v176, v177
 v_cvt_pk_bf16_f32 v81, v178, v179
 v_mfma_f32_16x16x32_bf16 v[204:207], a[204:207], a[100:103], v[204:207]
 v_cvt_pk_bf16_f32 v82, v184, v185
 v_cvt_pk_bf16_f32 v83, v186, v187
 v_fma_f32 v180, v180, v148, v212
 v_mfma_f32_16x16x32_bf16 v[204:207], a[220:223], a[108:111], v[204:207]
 v_fma_f32 v181, v181, v149, v213
 v_fma_f32 v182, v182, v150, v214
 v_mfma_f32_16x16x32_bf16 v[204:207], a[236:239], a[148:151], v[204:207]
 v_fma_f32 v183, v183, v151, v215
 v_fma_f32 v188, v188, v156, v220
 v_fma_f32 v189, v189, v157, v221
 v_mfma_f32_16x16x32_bf16 v[204:207], a[252:255], a[156:159], v[204:207]
 v_fma_f32 v190, v190, v158, v222
 v_fma_f32 v191, v191, v159, v223
 v_mfma_f32_16x16x32_bf16 v[200:203], a[252:255], a[152:155], v[200:203]
 v_cvt_pk_bf16_f32 v88, v180, v181
 v_cvt_pk_bf16_f32 v89, v182, v183
 v_cvt_pk_bf16_f32 v90, v188, v189
 v_mfma_f32_16x16x32_bf16 v[200:203], a[236:239], a[144:147], v[200:203]
 v_cvt_pk_bf16_f32 v91, v190, v191
 v_permlane16_swap_b32 v80, v82
 v_mfma_f32_16x16x32_bf16 v[200:203], a[220:223], a[104:107], v[200:203]
 v_permlane16_swap_b32 v81, v83
 v_permlane16_swap_b32 v88, v90
 v_permlane16_swap_b32 v89, v91
 v_mfma_f32_16x16x32_bf16 v[200:203], a[204:207], a[96:99], v[200:203]
 buffer_store_dwordx4 v[80:83], v42, s[36:39], s19 offen sc1
 buffer_store_dwordx4 v[88:91], v43, s[36:39], s19 offen sc1
 v_pk_mul_f32 v[128:129], v[160:161], s[6:7] op_sel_hi:[1,0]
 v_pk_mul_f32 v[130:131], v[162:163], s[6:7] op_sel_hi:[1,0]
 v_pk_mul_f32 v[136:137], v[168:169], s[6:7] op_sel_hi:[1,0]
 v_pk_mul_f32 v[138:139], v[170:171], s[6:7] op_sel_hi:[1,0]
 v_exp_f32 v128, v128
 v_exp_f32 v129, v129
 v_exp_f32 v130, v130
 v_exp_f32 v131, v131
 v_exp_f32 v136, v136
 v_exp_f32 v137, v137
 v_exp_f32 v138, v138
 v_exp_f32 v139, v139
 v_pk_add_f32 v[128:129], v[128:129], 1.0 op_sel_hi:[1,0]
 v_pk_add_f32 v[130:131], v[130:131], 1.0 op_sel_hi:[1,0]
 v_pk_add_f32 v[136:137], v[136:137], 1.0 op_sel_hi:[1,0]
 v_pk_add_f32 v[138:139], v[138:139], 1.0 op_sel_hi:[1,0]
 v_rcp_f32 v128, v128
 v_rcp_f32 v129, v129
 v_rcp_f32 v130, v130
 v_rcp_f32 v131, v131
 v_rcp_f32 v136, v136
 v_rcp_f32 v137, v137
 v_rcp_f32 v138, v138
 v_rcp_f32 v139, v139
 v_pk_mul_f32 v[160:161], v[160:161], v[128:129]
 v_pk_mul_f32 v[162:163], v[162:163], v[130:131]
 v_pk_mul_f32 v[168:169], v[168:169], v[136:137]
 v_pk_mul_f32 v[170:171], v[170:171], v[138:139]
 v_pk_mul_f32 v[132:133], v[164:165], s[6:7] op_sel_hi:[1,0]
 v_pk_mul_f32 v[134:135], v[166:167], s[6:7] op_sel_hi:[1,0]
 v_pk_mul_f32 v[140:141], v[172:173], s[6:7] op_sel_hi:[1,0]
 v_pk_mul_f32 v[142:143], v[174:175], s[6:7] op_sel_hi:[1,0]
 v_exp_f32 v132, v132
 v_exp_f32 v133, v133
 v_exp_f32 v134, v134
 v_exp_f32 v135, v135
 v_exp_f32 v140, v140
 v_exp_f32 v141, v141
 v_exp_f32 v142, v142
 v_exp_f32 v143, v143
 v_pk_add_f32 v[132:133], v[132:133], 1.0 op_sel_hi:[1,0]
 v_pk_add_f32 v[134:135], v[134:135], 1.0 op_sel_hi:[1,0]
 v_pk_add_f32 v[140:141], v[140:141], 1.0 op_sel_hi:[1,0]
 v_pk_add_f32 v[142:143], v[142:143], 1.0 op_sel_hi:[1,0]
 v_rcp_f32 v132, v132
 v_rcp_f32 v133, v133
 v_rcp_f32 v134, v134
 v_rcp_f32 v135, v135
 v_rcp_f32 v140, v140
 v_rcp_f32 v141, v141
 v_rcp_f32 v142, v142
 v_rcp_f32 v143, v143
 v_pk_mul_f32 v[164:165], v[164:165], v[132:133]
 v_pk_mul_f32 v[166:167], v[166:167], v[134:135]
 v_pk_mul_f32 v[172:173], v[172:173], v[140:141]
 v_pk_mul_f32 v[174:175], v[174:175], v[142:143]
 v_pk_fma_f32 v[192:193], v[192:193], v[160:161], v[224:225]
 v_pk_fma_f32 v[194:195], v[194:195], v[162:163], v[226:227]
 v_pk_fma_f32 v[200:201], v[200:201], v[168:169], v[232:233]
 v_pk_fma_f32 v[202:203], v[202:203], v[170:171], v[234:235]
 v_cvt_pk_bf16_f32 v84, v192, v193
 v_cvt_pk_bf16_f32 v85, v194, v195
 v_cvt_pk_bf16_f32 v86, v200, v201
 v_cvt_pk_bf16_f32 v87, v202, v203
 v_pk_fma_f32 v[196:197], v[196:197], v[164:165], v[228:229]
 v_pk_fma_f32 v[198:199], v[198:199], v[166:167], v[230:231]
 v_pk_fma_f32 v[204:205], v[204:205], v[172:173], v[236:237]
 v_pk_fma_f32 v[206:207], v[206:207], v[174:175], v[238:239]
 v_cvt_pk_bf16_f32 v92, v196, v197
 v_cvt_pk_bf16_f32 v93, v198, v199
 v_cvt_pk_bf16_f32 v94, v204, v205
 v_cvt_pk_bf16_f32 v95, v206, v207
 v_permlane16_swap_b32 v84, v86
 v_permlane16_swap_b32 v85, v87
 buffer_store_dwordx4 v[84:87], v42, s[36:39], s19 offen offset:64 sc1
 v_permlane16_swap_b32 v92, v94
 v_permlane16_swap_b32 v93, v95
 buffer_store_dwordx4 v[92:95], v43, s[36:39], s19 offen offset:64 sc1
L_end0:
 s_endpgm
 .p2align 12
L_tail1:
 s_waitcnt vmcnt(16) lgkmcnt(0)
 v_mfma_f32_16x16x32_bf16 v[144:147], a[16:19], a[80:83], v[144:147]
 s_barrier
 ds_read_b64_tr_b16 a[192:193], v36 offset:16384
 ds_read_b64_tr_b16 a[194:195], v36 offset:18432
 v_mfma_f32_16x16x32_bf16 v[144:147], a[48:51], a[88:91], v[144:147]
 s_mov_b64 exec, 1
 buffer_store_dword v3, off, s[24:27], s66 sc1
 s_mov_b64 exec, -1
 s_branch L_tp_L_tail1_0_o
L_tp_L_tail1_0:
 s_nop 0
 s_branch L_tp_L_tail1_2
 s_nop 0
L_tp_L_tail1_0_o:
 s_add_u32 s15, s14, 2097152
 v_mfma_f32_16x16x32_bf16 v[148:151], a[48:51], a[92:95], v[148:151]
 s_add_u32 m0, s18, 0
 ds_read_b64_tr_b16 a[224:225], v36 offset:24576
 ds_read_b64_tr_b16 a[226:227], v36 offset:26624
 v_mfma_f32_16x16x32_bf16 v[148:151], a[16:19], a[84:87], v[148:151]
 buffer_load_dwordx4 v8, s[28:31], s15 offen lds
 v_mfma_f32_16x16x32_bf16 v[156:159], a[20:23], a[84:87], v[156:159]
 ds_read_b64_tr_b16 a[196:197], v37 offset:16384
 ds_read_b64_tr_b16 a[198:199], v37 offset:18432
 v_mfma_f32_16x16x32_bf16 v[156:159], a[52:55], a[92:95], v[156:159]
 ds_read_b64_tr_b16 a[228:229], v37 offset:24576
 v_mfma_f32_16x16x32_bf16 v[152:155], a[52:55], a[88:91], v[152:155]
 buffer_load_dwordx4 a[128:131], v1, s[24:27], s12 offen sc1
 v_mfma_f32_16x16x32_bf16 v[152:155], a[20:23], a[80:83], v[152:155]
 ds_read_b64_tr_b16 a[230:231], v37 offset:26624
 ds_read_b64_tr_b16 a[200:201], v38 offset:16384
 v_mfma_f32_16x16x32_bf16 v[160:163], a[24:27], a[80:83], v[160:163]
 ds_read_b64_tr_b16 a[202:203], v38 offset:18432
 ds_read_b64_tr_b16 a[232:233], v38 offset:24576
 v_mfma_f32_16x16x32_bf16 v[160:163], a[56:59], a[88:91], v[160:163]
 s_add_u32 m0, s18, 1024
 ds_read_b64_tr_b16 a[234:235], v38 offset:26624
 v_mfma_f32_16x16x32_bf16 v[164:167], a[56:59], a[92:95], v[164:167]
 buffer_load_dwordx4 v9, s[28:31], s15 offen lds
 v_mfma_f32_16x16x32_bf16 v[164:167], a[24:27], a[84:87], v[164:167]
 ds_read_b64_tr_b16 a[204:205], v39 offset:16384
 ds_read_b64_tr_b16 a[206:207], v39 offset:18432
 v_mfma_f32_16x16x32_bf16 v[172:175], a[28:31], a[84:87], v[172:175]
 ds_read_b64_tr_b16 a[236:237], v39 offset:24576
 ds_read_b64_tr_b16 a[238:239], v39 offset:26624
 v_mfma_f32_16x16x32_bf16 v[172:175], a[60:63], a[92:95], v[172:175]
 buffer_load_dwordx4 a[132:135], v1, s[24:27], s12 offen offset:1024 sc1
 v_mfma_f32_16x16x32_bf16 v[168:171], a[60:63], a[88:91], v[168:171]
 ds_read_b64_tr_b16 a[208:209], v36 offset:20480
 v_mfma_f32_16x16x32_bf16 v[168:171], a[28:31], a[80:83], v[168:171]
 ds_read_b64_tr_b16 a[210:211], v36 offset:22528
 ds_read_b64_tr_b16 a[240:241], v36 offset:28672
 v_mfma_f32_16x16x32_bf16 v[112:115], a[32:35], a[80:83], v[112:115]
 s_add_u32 m0, s18, 2048
 ds_read_b64_tr_b16 a[242:243], v36 offset:30720
 ds_read_b64_tr_b16 a[212:213], v37 offset:20480
 v_mfma_f32_16x16x32_bf16 v[112:115], a[64:67], a[88:91], v[112:115]
 buffer_load_dwordx4 v10, s[28:31], s15 offen lds
 v_mfma_f32_16x16x32_bf16 v[116:119], a[64:67], a[92:95], v[116:119]
 ds_read_b64_tr_b16 a[214:215], v37 offset:22528
 v_mfma_f32_16x16x32_bf16 v[116:119], a[32:35], a[84:87], v[116:119]
 ds_read_b64_tr_b16 a[244:245], v37 offset:28672
 ds_read_b64_tr_b16 a[246:247], v37 offset:30720
 v_mfma_f32_16x16x32_bf16 v[124:127], a[36:39], a[84:87], v[124:127]
 buffer_load_dwordx4 a[136:139], v1, s[24:27], s12 offen offset:2048 sc1
 v_mfma_f32_16x16x32_bf16 v[124:127], a[68:71], a[92:95], v[124:127]
 ds_read_b64_tr_b16 a[216:217], v38 offset:20480
 ds_read_b64_tr_b16 a[218:219], v38 offset:22528
 v_mfma_f32_16x16x32_bf16 v[120:123], a[68:71], a[88:91], v[120:123]
 ds_read_b64_tr_b16 a[248:249], v38 offset:28672
 v_mfma_f32_16x16x32_bf16 v[120:123], a[36:39], a[80:83], v[120:123]
 s_add_u32 m0, s18, 3072
 ds_read_b64_tr_b16 a[250:251], v38 offset:30720
 ds_read_b64_tr_b16 a[220:221], v39 offset:20480
 v_mfma_f32_16x16x32_bf16 v[128:131], a[40:43], a[80:83], v[128:131]
 buffer_load_dwordx4 v11, s[28:31], s15 offen lds
 v_mfma_f32_16x16x32_bf16 v[128:131], a[72:75], a[88:91], v[128:131]
 ds_read_b64_tr_b16 a[222:223], v39 offset:22528
 ds_read_b64_tr_b16 a[252:253], v39 offset:28672
 v_mfma_f32_16x16x32_bf16 v[132:135], a[72:75], a[92:95], v[132:135]
 ds_read_b64_tr_b16 a[254:255], v39 offset:30720
 v_mfma_f32_16x16x32_bf16 v[132:135], a[40:43], a[84:87], v[132:135]
 buffer_load_dwordx4 a[140:143], v1, s[24:27], s12 offen offset:3072 sc1
 v_mfma_f32_16x16x32_bf16 v[140:143], a[44:47], a[84:87], v[140:143]
 v_mfma_f32_16x16x32_bf16 v[140:143], a[76:79], a[92:95], v[140:143]
 v_mfma_f32_16x16x32_bf16 v[136:139], a[76:79], a[88:91], v[136:139]
 v_mfma_f32_16x16x32_bf16 v[136:139], a[44:47], a[80:83], v[136:139]
 s_add_u32 s12, s12, 4096
 s_waitcnt vmcnt(17) lgkmcnt(0)
 v_mfma_f32_16x16x32_bf16 v[144:147], a[192:195], a[96:99], v[144:147]
 s_barrier
 s_add_u32 s15, s14, 2490368
 ds_read_b64_tr_b16 a[16:17], v36 offset:32768
 ds_read_b64_tr_b16 a[18:19], v36 offset:34816
 v_mfma_f32_16x16x32_bf16 v[144:147], a[224:227], a[104:107], v[144:147]
 s_add_u32 m0, s18, 16384
 ds_read_b64_tr_b16 a[48:49], v36 offset:40960
 ds_read_b64_tr_b16 a[50:51], v36 offset:43008
 v_mfma_f32_16x16x32_bf16 v[148:151], a[224:227], a[108:111], v[148:151]
 buffer_load_dwordx4 v8, s[28:31], s15 offen lds
 v_mfma_f32_16x16x32_bf16 v[148:151], a[192:195], a[100:103], v[148:151]
 ds_read_b64_tr_b16 a[20:21], v37 offset:32768
 v_mfma_f32_16x16x32_bf16 v[156:159], a[196:199], a[100:103], v[156:159]
 ds_read_b64_tr_b16 a[22:23], v37 offset:34816
 ds_read_b64_tr_b16 a[52:53], v37 offset:40960
 v_mfma_f32_16x16x32_bf16 v[156:159], a[228:231], a[108:111], v[156:159]
 buffer_load_dwordx4 a[80:83], v1, s[24:27], s12 offen sc1
 v_mfma_f32_16x16x32_bf16 v[152:155], a[228:231], a[104:107], v[152:155]
 ds_read_b64_tr_b16 a[54:55], v37 offset:43008
 v_mfma_f32_16x16x32_bf16 v[152:155], a[196:199], a[96:99], v[152:155]
 ds_read_b64_tr_b16 a[24:25], v38 offset:32768
 ds_read_b64_tr_b16 a[26:27], v38 offset:34816
 v_mfma_f32_16x16x32_bf16 v[160:163], a[200:203], a[96:99], v[160:163]
 s_add_u32 m0, s18, 17408
 ds_read_b64_tr_b16 a[56:57], v38 offset:40960
 ds_read_b64_tr_b16 a[58:59], v38 offset:43008
 v_mfma_f32_16x16x32_bf16 v[160:163], a[232:235], a[104:107], v[160:163]
 buffer_load_dwordx4 v9, s[28:31], s15 offen lds
 v_mfma_f32_16x16x32_bf16 v[164:167], a[232:235], a[108:111], v[164:167]
 ds_read_b64_tr_b16 a[28:29], v39 offset:32768
 v_mfma_f32_16x16x32_bf16 v[164:167], a[200:203], a[100:103], v[164:167]
 ds_read_b64_tr_b16 a[30:31], v39 offset:34816
 ds_read_b64_tr_b16 a[60:61], v39 offset:40960
 v_mfma_f32_16x16x32_bf16 v[172:175], a[204:207], a[100:103], v[172:175]
 buffer_load_dwordx4 a[84:87], v1, s[24:27], s12 offen offset:1024 sc1
 v_mfma_f32_16x16x32_bf16 v[172:175], a[236:239], a[108:111], v[172:175]
 ds_read_b64_tr_b16 a[62:63], v39 offset:43008
 v_mfma_f32_16x16x32_bf16 v[168:171], a[236:239], a[104:107], v[168:171]
 ds_read_b64_tr_b16 a[32:33], v36 offset:36864
 ds_read_b64_tr_b16 a[34:35], v36 offset:38912
 v_mfma_f32_16x16x32_bf16 v[168:171], a[204:207], a[96:99], v[168:171]
 s_add_u32 m0, s18, 18432
 ds_read_b64_tr_b16 a[64:65], v36 offset:45056
 ds_read_b64_tr_b16 a[66:67], v36 offset:47104
 v_mfma_f32_16x16x32_bf16 v[112:115], a[208:211], a[96:99], v[112:115]
 buffer_load_dwordx4 v10, s[28:31], s15 offen lds
 v_mfma_f32_16x16x32_bf16 v[112:115], a[240:243], a[104:107], v[112:115]
 ds_read_b64_tr_b16 a[36:37], v37 offset:36864
 v_mfma_f32_16x16x32_bf16 v[116:119], a[240:243], a[108:111], v[116:119]
 ds_read_b64_tr_b16 a[38:39], v37 offset:38912
 ds_read_b64_tr_b16 a[68:69], v37 offset:45056
 v_mfma_f32_16x16x32_bf16 v[116:119], a[208:211], a[100:103], v[116:119]
 ds_read_b64_tr_b16 a[70:71], v37 offset:47104
 v_mfma_f32_16x16x32_bf16 v[124:127], a[212:215], a[100:103], v[124:127]
 buffer_load_dwordx4 a[88:91], v1, s[24:27], s12 offen offset:2048 sc1
 v_mfma_f32_16x16x32_bf16 v[124:127], a[244:247], a[108:111], v[124:127]
 ds_read_b64_tr_b16 a[40:41], v38 offset:36864
 ds_read_b64_tr_b16 a[42:43], v38 offset:38912
 v_mfma_f32_16x16x32_bf16 v[120:123], a[244:247], a[104:107], v[120:123]
 s_add_u32 m0, s18, 19456
 ds_read_b64_tr_b16 a[72:73], v38 offset:45056
 ds_read_b64_tr_b16 a[74:75], v38 offset:47104
 v_mfma_f32_16x16x32_bf16 v[120:123], a[212:215], a[96:99], v[120:123]
 buffer_load_dwordx4 v11, s[28:31], s15 offen lds
 v_mfma_f32_16x16x32_bf16 v[128:131], a[216:219], a[96:99], v[128:131]
 ds_read_b64_tr_b16 a[44:45], v39 offset:36864
 v_mfma_f32_16x16x32_bf16 v[128:131], a[248:251], a[104:107], v[128:131]
 ds_read_b64_tr_b16 a[46:47], v39 offset:38912
 ds_read_b64_tr_b16 a[76:77], v39 offset:45056
 v_mfma_f32_16x16x32_bf16 v[132:135], a[248:251], a[108:111], v[132:135]
 ds_read_b64_tr_b16 a[78:79], v39 offset:47104
 v_mfma_f32_16x16x32_bf16 v[132:135], a[216:219], a[100:103], v[132:135]
 buffer_load_dwordx4 a[92:95], v1, s[24:27], s12 offen offset:3072 sc1
 v_mfma_f32_16x16x32_bf16 v[140:143], a[220:223], a[100:103], v[140:143]
 v_mfma_f32_16x16x32_bf16 v[140:143], a[252:255], a[108:111], v[140:143]
 v_mfma_f32_16x16x32_bf16 v[136:139], a[252:255], a[104:107], v[136:139]
 v_mfma_f32_16x16x32_bf16 v[136:139], a[220:223], a[96:99], v[136:139]
 s_add_u32 s12, s12, 4096
 buffer_load_dword v47, v24, s[24:27], s60 offen offset:256 sc1
 s_waitcnt vmcnt(18) lgkmcnt(0)
 v_mfma_f32_16x16x32_bf16 v[144:147], a[16:19], a[112:115], v[144:147]
 s_barrier
 s_add_u32 s15, s14, 3014656
 ds_read_b64_tr_b16 a[192:193], v36 offset:49152
 ds_read_b64_tr_b16 a[194:195], v36 offset:51200
 v_mfma_f32_16x16x32_bf16 v[144:147], a[48:51], a[120:123], v[144:147]
 s_add_u32 m0, s18, 32768
 ds_read_b64_tr_b16 a[224:225], v36 offset:57344
 ds_read_b64_tr_b16 a[226:227], v36 offset:59392
 v_mfma_f32_16x16x32_bf16 v[148:151], a[48:51], a[124:127], v[148:151]
 buffer_load_dwordx4 v8, s[28:31], s15 offen lds
 v_and_b32 v4, 1, v2
 v_mfma_f32_16x16x32_bf16 v[148:151], a[16:19], a[116:119], v[148:151]
 ds_read_b64_tr_b16 a[196:197], v37 offset:49152
 v_lshlrev_b32 v4, 4, v4
 v_mfma_f32_16x16x32_bf16 v[156:159], a[20:23], a[116:119], v[156:159]
 ds_read_b64_tr_b16 a[198:199], v37 offset:51200
 ds_read_b64_tr_b16 a[228:229], v37 offset:57344
 v_mfma_f32_16x16x32_bf16 v[156:159], a[52:55], a[124:127], v[156:159]
 buffer_load_dwordx4 a[96:99], v1, s[24:27], s12 offen sc1
 v_mov_b32 v5, 0x3f80
 v_mfma_f32_16x16x32_bf16 v[152:155], a[52:55], a[120:123], v[152:155]
 ds_read_b64_tr_b16 a[230:231], v37 offset:59392
 v_lshlrev_b32 v4, v4, v5
 v_mfma_f32_16x16x32_bf16 v[152:155], a[20:23], a[112:115], v[152:155]
 ds_read_b64_tr_b16 a[200:201], v38 offset:49152
 ds_read_b64_tr_b16 a[202:203], v38 offset:51200
 v_mfma_f32_16x16x32_bf16 v[160:163], a[24:27], a[112:115], v[160:163]
 s_add_u32 m0, s18, 33792
 ds_read_b64_tr_b16 a[232:233], v38 offset:57344
 ds_read_b64_tr_b16 a[234:235], v38 offset:59392
 v_mfma_f32_16x16x32_bf16 v[160:163], a[56:59], a[120:123], v[160:163]
 buffer_load_dwordx4 v9, s[28:31], s15 offen lds
 v_lshrrev_b32 v5, 4, v2
 v_mfma_f32_16x16x32_bf16 v[164:167], a[56:59], a[124:127], v[164:167]
 ds_read_b64_tr_b16 a[204:205], v39 offset:49152
 v_bfe_u32 v6, v2, 1, 3
 v_mfma_f32_16x16x32_bf16 v[164:167], a[24:27], a[116:119], v[164:167]
 ds_read_b64_tr_b16 a[206:207], v39 offset:51200
 ds_read_b64_tr_b16 a[236:237], v39 offset:57344
 v_mfma_f32_16x16x32_bf16 v[172:175], a[28:31], a[116:119], v[172:175]
 buffer_load_dwordx4 a[100:103], v1, s[24:27], s12 offen offset:1024 sc1
 v_lshlrev_b32 v7, 1, v5
 v_mfma_f32_16x16x32_bf16 v[172:175], a[60:63], a[124:127], v[172:175]
 ds_read_b64_tr_b16 a[238:239], v39 offset:59392
 v_sub_u32 v6, v6, v7
 v_mfma_f32_16x16x32_bf16 v[168:171], a[60:63], a[120:123], v[168:171]
 ds_read_b64_tr_b16 a[208:209], v36 offset:53248
 ds_read_b64_tr_b16 a[210:211], v36 offset:55296
 v_mfma_f32_16x16x32_bf16 v[168:171], a[28:31], a[112:115], v[168:171]
 s_add_u32 m0, s18, 34816
 ds_read_b64_tr_b16 a[240:241], v36 offset:61440
 ds_read_b64_tr_b16 a[242:243], v36 offset:63488
 v_mfma_f32_16x16x32_bf16 v[112:115], a[32:35], a[112:115], v[112:115]
 buffer_load_dwordx4 v10, s[28:31], s15 offen lds
 v_sub_u32 v7, v6, v7
 v_mfma_f32_16x16x32_bf16 v[112:115], a[64:67], a[120:123], v[112:115]
 ds_read_b64_tr_b16 a[212:213], v37 offset:53248
 v_cmp_eq_u32 vcc, 0, v6
 v_mfma_f32_16x16x32_bf16 v[116:119], a[64:67], a[124:127], v[116:119]
 ds_read_b64_tr_b16 a[214:215], v37 offset:55296
 ds_read_b64_tr_b16 a[244:245], v37 offset:61440
 v_mfma_f32_16x16x32_bf16 v[116:119], a[32:35], a[116:119], v[116:119]
 ds_read_b64_tr_b16 a[246:247], v37 offset:63488
 v_mov_b32 v12, 0
 v_mfma_f32_16x16x32_bf16 v[124:127], a[36:39], a[116:119], v[124:127]
 buffer_load_dwordx4 a[104:107], v1, s[24:27], s12 offen offset:2048 sc1
 v_mov_b32 v16, 0
 v_mfma_f32_16x16x32_bf16 v[124:127], a[68:71], a[124:127], v[124:127]
 ds_read_b64_tr_b16 a[216:217], v38 offset:53248
 ds_read_b64_tr_b16 a[218:219], v38 offset:55296
 v_mfma_f32_16x16x32_bf16 v[120:123], a[68:71], a[120:123], v[120:123]
 s_add_u32 m0, s18, 35840
 ds_read_b64_tr_b16 a[248:249], v38 offset:61440
 ds_read_b64_tr_b16 a[250:251], v38 offset:63488
 v_mfma_f32_16x16x32_bf16 v[120:123], a[36:39], a[112:115], v[120:123]
 buffer_load_dwordx4 v11, s[28:31], s15 offen lds
 v_cndmask_b32 v14, 0, v4, vcc
 v_mfma_f32_16x16x32_bf16 v[128:131], a[40:43], a[112:115], v[128:131]
 ds_read_b64_tr_b16 a[220:221], v39 offset:53248
 v_cmp_eq_u32 vcc, 1, v6
 v_mfma_f32_16x16x32_bf16 v[128:131], a[72:75], a[120:123], v[128:131]
 ds_read_b64_tr_b16 a[222:223], v39 offset:55296
 ds_read_b64_tr_b16 a[252:253], v39 offset:61440
 v_mfma_f32_16x16x32_bf16 v[132:135], a[72:75], a[124:127], v[132:135]
 ds_read_b64_tr_b16 a[254:255], v39 offset:63488
 v_mov_b32 v13, 0
 v_mfma_f32_16x16x32_bf16 v[132:135], a[40:43], a[116:119], v[132:135]
 buffer_load_dwordx4 a[108:111], v1, s[24:27], s12 offen offset:3072 sc1
 v_mov_b32 v17, 0
 v_mfma_f32_16x16x32_bf16 v[140:143], a[44:47], a[116:119], v[140:143]
 v_cndmask_b32 v15, 0, v4, vcc
 v_mfma_f32_16x16x32_bf16 v[140:143], a[76:79], a[124:127], v[140:143]
 v_mfma_f32_16x16x32_bf16 v[136:139], a[76:79], a[120:123], v[136:139]
 v_mfma_f32_16x16x32_bf16 v[136:139], a[44:47], a[112:115], v[136:139]
 s_add_u32 s12, s12, 4096
 s_waitcnt vmcnt(17) lgkmcnt(0)
 v_mfma_f32_16x16x32_bf16 v[144:147], a[192:195], a[128:131], v[144:147]
 s_barrier
 s_add_u32 s15, s14, 3407872
 ds_read_b64_tr_b16 a[16:17], v36 offset:0
 ds_read_b64_tr_b16 a[18:19], v36 offset:2048
 v_mfma_f32_16x16x32_bf16 v[144:147], a[224:227], a[136:139], v[144:147]
 s_add_u32 m0, s18, 49152
 ds_read_b64_tr_b16 a[48:49], v36 offset:8192
 ds_read_b64_tr_b16 a[50:51], v36 offset:10240
 v_cmp_eq_u32 vcc, 0, v7
 v_mfma_f32_16x16x32_bf16 v[148:151], a[224:227], a[140:143], v[148:151]
 buffer_load_dwordx4 v8, s[28:31], s15 offen lds
 v_mfma_f32_16x16x32_bf16 v[148:151], a[192:195], a[132:135], v[148:151]
 ds_read_b64_tr_b16 a[20:21], v37 offset:0
 v_cndmask_b32 v80, 0, v4, vcc
 v_mfma_f32_16x16x32_bf16 v[156:159], a[196:199], a[132:135], v[156:159]
 ds_read_b64_tr_b16 a[22:23], v37 offset:2048
 ds_read_b64_tr_b16 a[52:53], v37 offset:8192
 v_mfma_f32_16x16x32_bf16 v[156:159], a[228:231], a[140:143], v[156:159]
 buffer_load_dwordx4 a[112:115], v1, s[24:27], s12 offen sc1
 v_cmp_eq_u32 vcc, 1, v7
 v_mfma_f32_16x16x32_bf16 v[152:155], a[228:231], a[136:139], v[152:155]
 ds_read_b64_tr_b16 a[54:55], v37 offset:10240
 v_mfma_f32_16x16x32_bf16 v[152:155], a[196:199], a[128:131], v[152:155]
 ds_read_b64_tr_b16 a[24:25], v38 offset:0
 ds_read_b64_tr_b16 a[26:27], v38 offset:2048
 v_cndmask_b32 v81, 0, v4, vcc
 v_mfma_f32_16x16x32_bf16 v[160:163], a[200:203], a[128:131], v[160:163]
 s_add_u32 m0, s18, 50176
 ds_read_b64_tr_b16 a[56:57], v38 offset:8192
 ds_read_b64_tr_b16 a[58:59], v38 offset:10240
 v_mfma_f32_16x16x32_bf16 v[160:163], a[232:235], a[136:139], v[160:163]
 buffer_load_dwordx4 v9, s[28:31], s15 offen lds
 v_cmp_eq_u32 vcc, 2, v7
 v_mfma_f32_16x16x32_bf16 v[164:167], a[232:235], a[140:143], v[164:167]
 ds_read_b64_tr_b16 a[28:29], v39 offset:0
 v_mfma_f32_16x16x32_bf16 v[164:167], a[200:203], a[132:135], v[164:167]
 ds_read_b64_tr_b16 a[30:31], v39 offset:2048
 ds_read_b64_tr_b16 a[60:61], v39 offset:8192
 v_cndmask_b32 v82, 0, v4, vcc
 v_mfma_f32_16x16x32_bf16 v[172:175], a[204:207], a[132:135], v[172:175]
 buffer_load_dwordx4 a[116:119], v1, s[24:27], s12 offen offset:1024 sc1
 v_mfma_f32_16x16x32_bf16 v[172:175], a[236:239], a[140:143], v[172:175]
 ds_read_b64_tr_b16 a[62:63], v39 offset:10240
 v_cmp_eq_u32 vcc, 3, v7
 v_mfma_f32_16x16x32_bf16 v[168:171], a[236:239], a[136:139], v[168:171]
 ds_read_b64_tr_b16 a[32:33], v36 offset:4096
 ds_read_b64_tr_b16 a[34:35], v36 offset:6144
 v_mfma_f32_16x16x32_bf16 v[168:171], a[204:207], a[128:131], v[168:171]
 s_add_u32 m0, s18, 51200
 ds_read_b64_tr_b16 a[64:65], v36 offset:12288
 ds_read_b64_tr_b16 a[66:67], v36 offset:14336
 v_cndmask_b32 v83, 0, v4, vcc
 v_mfma_f32_16x16x32_bf16 v[112:115], a[208:211], a[128:131], v[112:115]
 buffer_load_dwordx4 v10, s[28:31], s15 offen lds
 v_mfma_f32_16x16x32_bf16 v[112:115], a[240:243], a[136:139], v[112:115]
 ds_read_b64_tr_b16 a[36:37], v37 offset:4096
 v_cmp_eq_u32 vcc, -8, v7
 v_mfma_f32_16x16x32_bf16 v[116:119], a[240:243], a[140:143], v[116:119]
 ds_read_b64_tr_b16 a[38:39], v37 offset:6144
 ds_read_b64_tr_b16 a[68:69], v37 offset:12288
 v_mfma_f32_16x16x32_bf16 v[116:119], a[208:211], a[132:135], v[116:119]
 ds_read_b64_tr_b16 a[70:71], v37 offset:14336
 v_cndmask_b32 v84, 0, v4, vcc
 v_mfma_f32_16x16x32_bf16 v[124:127], a[212:215], a[132:135], v[124:127]
 buffer_load_dwordx4 a[120:123], v1, s[24:27], s12 offen offset:2048 sc1
 v_mfma_f32_16x16x32_bf16 v[124:127], a[244:247], a[140:143], v[124:127]
 ds_read_b64_tr_b16 a[40:41], v38 offset:4096
 ds_read_b64_tr_b16 a[42:43], v38 offset:6144
 v_cmp_eq_u32 vcc, -7, v7
 v_mfma_f32_16x16x32_bf16 v[120:123], a[244:247], a[136:139], v[120:123]
 s_add_u32 m0, s18, 52224
 ds_read_b64_tr_b16 a[72:73], v38 offset:12288
 ds_read_b64_tr_b16 a[74:75], v38 offset:14336
 v_mfma_f32_16x16x32_bf16 v[120:123], a[212:215], a[128:131], v[120:123]
 buffer_load_dwordx4 v11, s[28:31], s15 offen lds
 v_cndmask_b32 v85, 0, v4, vcc
 v_mfma_f32_16x16x32_bf16 v[128:131], a[216:219], a[128:131], v[128:131]
 ds_read_b64_tr_b16 a[44:45], v39 offset:4096
 v_mfma_f32_16x16x32_bf16 v[128:131], a[248:251], a[136:139], v[128:131]
 ds_read_b64_tr_b16 a[46:47], v39 offset:6144
 ds_read_b64_tr_b16 a[76:77], v39 offset:12288
 v_cmp_eq_u32 vcc, -6, v7
 v_mfma_f32_16x16x32_bf16 v[132:135], a[248:251], a[140:143], v[132:135]
 ds_read_b64_tr_b16 a[78:79], v39 offset:14336
 v_mfma_f32_16x16x32_bf16 v[132:135], a[216:219], a[132:135], v[132:135]
 buffer_load_dwordx4 a[124:127], v1, s[24:27], s12 offen offset:3072 sc1
 v_cndmask_b32 v86, 0, v4, vcc
 v_mfma_f32_16x16x32_bf16 v[140:143], a[220:223], a[132:135], v[140:143]
 v_mfma_f32_16x16x32_bf16 v[140:143], a[252:255], a[140:143], v[140:143]
 buffer_load_dword v34, v25, s[24:27], s69 offen offset:256 sc1
 v_cmp_eq_u32 vcc, -5, v7
 v_mfma_f32_16x16x32_bf16 v[136:139], a[252:255], a[136:139], v[136:139]
 buffer_load_dword v35, off, s[24:27], s55 sc1
 v_mfma_f32_16x16x32_bf16 v[136:139], a[220:223], a[128:131], v[136:139]
 s_add_u32 s12, s12, 4096
 v_cndmask_b32 v87, 0, v4, vcc
 s_waitcnt vmcnt(18) lgkmcnt(0)
 v_mfma_f32_16x16x32_bf16 v[144:147], a[16:19], a[80:83], v[144:147]
 s_barrier
 s_add_u32 s15, s14, 393216
 ds_read_b64_tr_b16 a[192:193], v36 offset:16384
 ds_read_b64_tr_b16 a[194:195], v36 offset:18432
 v_cmp_ne_u32 vcc, 1, v47
 v_mfma_f32_16x16x32_bf16 v[144:147], a[48:51], a[88:91], v[144:147]
 s_add_u32 m0, s18, 0
 ds_read_b64_tr_b16 a[224:225], v36 offset:24576
 v_mfma_f32_16x16x32_bf16 v[148:151], a[48:51], a[92:95], v[148:151]
 buffer_load_dwordx4 v8, s[28:31], s15 offen lds
 s_cbranch_vccnz L_b31_s
L_b31_d:
 v_mfma_f32_16x16x32_bf16 v[148:151], a[16:19], a[84:87], v[148:151]
 ds_read_b64_tr_b16 a[226:227], v36 offset:26624
 v_mfma_f32_16x16x32_bf16 v[156:159], a[20:23], a[84:87], v[156:159]
 ds_read_b64_tr_b16 a[196:197], v37 offset:16384
 v_mfma_f32_16x16x32_bf16 v[156:159], a[52:55], a[92:95], v[156:159]
 ds_read_b64_tr_b16 a[198:199], v37 offset:18432
 v_mfma_f32_16x16x32_bf16 v[152:155], a[52:55], a[88:91], v[152:155]
 buffer_load_dwordx4 a[128:131], v1, s[24:27], s12 offen sc1
 v_mfma_f32_16x16x32_bf16 v[152:155], a[20:23], a[80:83], v[152:155]
 ds_read_b64_tr_b16 a[228:229], v37 offset:24576
 v_mfma_f32_16x16x32_bf16 v[160:163], a[24:27], a[80:83], v[160:163]
 ds_read_b64_tr_b16 a[230:231], v37 offset:26624
 v_mfma_f32_16x16x32_bf16 v[160:163], a[56:59], a[88:91], v[160:163]
 ds_read_b64_tr_b16 a[200:201], v38 offset:16384
 ds_read_b64_tr_b16 a[202:203], v38 offset:18432
 v_mfma_f32_16x16x32_bf16 v[164:167], a[56:59], a[92:95], v[164:167]
 s_add_u32 m0, s18, 1024
 ds_read_b64_tr_b16 a[232:233], v38 offset:24576
 v_mfma_f32_16x16x32_bf16 v[164:167], a[24:27], a[84:87], v[164:167]
 buffer_load_dwordx4 v9, s[28:31], s15 offen lds
 v_mfma_f32_16x16x32_bf16 v[172:175], a[28:31], a[84:87], v[172:175]
 ds_read_b64_tr_b16 a[234:235], v38 offset:26624
 v_mfma_f32_16x16x32_bf16 v[172:175], a[60:63], a[92:95], v[172:175]
 ds_read_b64_tr_b16 a[204:205], v39 offset:16384
 v_mfma_f32_16x16x32_bf16 v[168:171], a[60:63], a[88:91], v[168:171]
 ds_read_b64_tr_b16 a[206:207], v39 offset:18432
 v_mfma_f32_16x16x32_bf16 v[168:171], a[28:31], a[80:83], v[168:171]
 buffer_load_dwordx4 a[132:135], v1, s[24:27], s12 offen offset:1024 sc1
 v_mfma_f32_16x16x32_bf16 v[112:115], a[32:35], a[80:83], v[112:115]
 ds_read_b64_tr_b16 a[236:237], v39 offset:24576
 v_mfma_f32_16x16x32_bf16 v[112:115], a[64:67], a[88:91], v[112:115]
 ds_read_b64_tr_b16 a[238:239], v39 offset:26624
 v_mfma_f32_16x16x32_bf16 v[116:119], a[64:67], a[92:95], v[116:119]
 ds_read_b64_tr_b16 a[208:209], v36 offset:20480
 ds_read_b64_tr_b16 a[210:211], v36 offset:22528
 v_mfma_f32_16x16x32_bf16 v[116:119], a[32:35], a[84:87], v[116:119]
 s_add_u32 m0, s18, 2048
 ds_read_b64_tr_b16 a[240:241], v36 offset:28672
 v_mfma_f32_16x16x32_bf16 v[124:127], a[36:39], a[84:87], v[124:127]
 buffer_load_dwordx4 v10, s[28:31], s15 offen lds
 v_mfma_f32_16x16x32_bf16 v[124:127], a[68:71], a[92:95], v[124:127]
 ds_read_b64_tr_b16 a[242:243], v36 offset:30720
 v_mfma_f32_16x16x32_bf16 v[120:123], a[68:71], a[88:91], v[120:123]
 ds_read_b64_tr_b16 a[212:213], v37 offset:20480
 v_mfma_f32_16x16x32_bf16 v[120:123], a[36:39], a[80:83], v[120:123]
 ds_read_b64_tr_b16 a[214:215], v37 offset:22528
 v_mfma_f32_16x16x32_bf16 v[128:131], a[40:43], a[80:83], v[128:131]
 ds_read_b64_tr_b16 a[244:245], v37 offset:28672
 v_mfma_f32_16x16x32_bf16 v[128:131], a[72:75], a[88:91], v[128:131]
 buffer_load_dwordx4 a[136:139], v1, s[24:27], s12 offen offset:2048 sc1
 v_mfma_f32_16x16x32_bf16 v[132:135], a[72:75], a[92:95], v[132:135]
 ds_read_b64_tr_b16 a[246:247], v37 offset:30720
 v_mfma_f32_16x16x32_bf16 v[132:135], a[40:43], a[84:87], v[132:135]
 ds_read_b64_tr_b16 a[216:217], v38 offset:20480
 ds_read_b64_tr_b16 a[218:219], v38 offset:22528
 v_mfma_f32_16x16x32_bf16 v[140:143], a[44:47], a[84:87], v[140:143]
 s_add_u32 m0, s18, 3072
 ds_read_b64_tr_b16 a[248:249], v38 offset:28672
 v_mfma_f32_16x16x32_bf16 v[140:143], a[76:79], a[92:95], v[140:143]
 buffer_load_dwordx4 v11, s[28:31], s15 offen lds
 v_mfma_f32_16x16x32_bf16 v[136:139], a[76:79], a[88:91], v[136:139]
 ds_read_b64_tr_b16 a[250:251], v38 offset:30720
 v_mfma_f32_16x16x32_bf16 v[136:139], a[44:47], a[80:83], v[136:139]
 ds_read_b64_tr_b16 a[220:221], v39 offset:20480
 v_mfma_f32_16x16x32_bf16 v[208:211], v[80:83], a[0:3], 0
 ds_read_b64_tr_b16 a[222:223], v39 offset:22528
 v_mfma_f32_16x16x32_bf16 v[212:215], v[80:83], a[8:11], 0
 ds_read_b64_tr_b16 a[252:253], v39 offset:28672
 v_mfma_f32_16x16x32_bf16 v[216:219], v[84:87], a[0:3], 0
 buffer_load_dwordx4 a[140:143], v1, s[24:27], s12 offen offset:3072 sc1
 v_mfma_f32_16x16x32_bf16 v[220:223], v[84:87], a[8:11], 0
 ds_read_b64_tr_b16 a[254:255], v39 offset:30720
 v_mfma_f32_16x16x32_bf16 v[224:227], v[80:83], a[4:7], 0
 v_mfma_f32_16x16x32_bf16 v[228:231], v[80:83], a[12:15], 0
 v_mfma_f32_16x16x32_bf16 v[232:235], v[84:87], a[4:7], 0
 v_mfma_f32_16x16x32_bf16 v[236:239], v[84:87], a[12:15], 0
 s_add_u32 s12, s12, 4096
 s_waitcnt vmcnt(18) lgkmcnt(0)
 v_mfma_f32_16x16x32_bf16 v[144:147], a[192:195], a[96:99], v[144:147]
 s_barrier
 s_add_u32 s15, s14, 1310720
 ds_read_b64_tr_b16 a[16:17], v36 offset:32768
 ds_read_b64_tr_b16 a[18:19], v36 offset:34816
 v_mfma_f32_16x16x32_bf16 v[144:147], a[224:227], a[104:107], v[144:147]
 s_add_u32 m0, s18, 16384
 ds_read_b64_tr_b16 a[48:49], v36 offset:40960
 ds_read_b64_tr_b16 a[50:51], v36 offset:43008
 v_mfma_f32_16x16x32_bf16 v[148:151], a[224:227], a[108:111], v[148:151]
 buffer_load_dwordx4 v8, s[28:31], s15 offen lds
 v_mfma_f32_16x16x32_bf16 v[148:151], a[192:195], a[100:103], v[148:151]
 ds_read_b64_tr_b16 a[20:21], v37 offset:32768
 v_mfma_f32_16x16x32_bf16 v[156:159], a[196:199], a[100:103], v[156:159]
 ds_read_b64_tr_b16 a[22:23], v37 offset:34816
 ds_read_b64_tr_b16 a[52:53], v37 offset:40960
 v_mfma_f32_16x16x32_bf16 v[156:159], a[228:231], a[108:111], v[156:159]
 buffer_load_dwordx4 a[80:83], v1, s[24:27], s12 offen sc1
 v_mfma_f32_16x16x32_bf16 v[152:155], a[228:231], a[104:107], v[152:155]
 ds_read_b64_tr_b16 a[54:55], v37 offset:43008
 v_mfma_f32_16x16x32_bf16 v[152:155], a[196:199], a[96:99], v[152:155]
 ds_read_b64_tr_b16 a[24:25], v38 offset:32768
 ds_read_b64_tr_b16 a[26:27], v38 offset:34816
 v_mfma_f32_16x16x32_bf16 v[160:163], a[200:203], a[96:99], v[160:163]
 s_add_u32 m0, s18, 17408
 ds_read_b64_tr_b16 a[56:57], v38 offset:40960
 ds_read_b64_tr_b16 a[58:59], v38 offset:43008
 v_mfma_f32_16x16x32_bf16 v[160:163], a[232:235], a[104:107], v[160:163]
 buffer_load_dwordx4 v9, s[28:31], s15 offen lds
 v_mfma_f32_16x16x32_bf16 v[164:167], a[232:235], a[108:111], v[164:167]
 ds_read_b64_tr_b16 a[28:29], v39 offset:32768
 v_mfma_f32_16x16x32_bf16 v[164:167], a[200:203], a[100:103], v[164:167]
 ds_read_b64_tr_b16 a[30:31], v39 offset:34816
 ds_read_b64_tr_b16 a[60:61], v39 offset:40960
 v_mfma_f32_16x16x32_bf16 v[172:175], a[204:207], a[100:103], v[172:175]
 buffer_load_dwordx4 a[84:87], v1, s[24:27], s12 offen offset:1024 sc1
 v_mfma_f32_16x16x32_bf16 v[172:175], a[236:239], a[108:111], v[172:175]
 ds_read_b64_tr_b16 a[62:63], v39 offset:43008
 v_mfma_f32_16x16x32_bf16 v[168:171], a[236:239], a[104:107], v[168:171]
 ds_read_b64_tr_b16 a[32:33], v36 offset:36864
 ds_read_b64_tr_b16 a[34:35], v36 offset:38912
 v_mfma_f32_16x16x32_bf16 v[168:171], a[204:207], a[96:99], v[168:171]
 s_add_u32 m0, s18, 18432
 ds_read_b64_tr_b16 a[64:65], v36 offset:45056
 ds_read_b64_tr_b16 a[66:67], v36 offset:47104
 v_mfma_f32_16x16x32_bf16 v[112:115], a[208:211], a[96:99], v[112:115]
 buffer_load_dwordx4 v10, s[28:31], s15 offen lds
 v_mfma_f32_16x16x32_bf16 v[112:115], a[240:243], a[104:107], v[112:115]
 ds_read_b64_tr_b16 a[36:37], v37 offset:36864
 v_mfma_f32_16x16x32_bf16 v[116:119], a[240:243], a[108:111], v[116:119]
 ds_read_b64_tr_b16 a[38:39], v37 offset:38912
 ds_read_b64_tr_b16 a[68:69], v37 offset:45056
 v_mfma_f32_16x16x32_bf16 v[116:119], a[208:211], a[100:103], v[116:119]
 ds_read_b64_tr_b16 a[70:71], v37 offset:47104
 v_mfma_f32_16x16x32_bf16 v[124:127], a[212:215], a[100:103], v[124:127]
 buffer_load_dwordx4 a[88:91], v1, s[24:27], s12 offen offset:2048 sc1
 v_mfma_f32_16x16x32_bf16 v[124:127], a[244:247], a[108:111], v[124:127]
 ds_read_b64_tr_b16 a[40:41], v38 offset:36864
 ds_read_b64_tr_b16 a[42:43], v38 offset:38912
 v_mfma_f32_16x16x32_bf16 v[120:123], a[244:247], a[104:107], v[120:123]
 s_add_u32 m0, s18, 19456
 ds_read_b64_tr_b16 a[72:73], v38 offset:45056
 ds_read_b64_tr_b16 a[74:75], v38 offset:47104
 v_mfma_f32_16x16x32_bf16 v[120:123], a[212:215], a[96:99], v[120:123]
 buffer_load_dwordx4 v11, s[28:31], s15 offen lds
 v_mfma_f32_16x16x32_bf16 v[128:131], a[216:219], a[96:99], v[128:131]
 ds_read_b64_tr_b16 a[44:45], v39 offset:36864
 v_mfma_f32_16x16x32_bf16 v[128:131], a[248:251], a[104:107], v[128:131]
 ds_read_b64_tr_b16 a[46:47], v39 offset:38912
 ds_read_b64_tr_b16 a[76:77], v39 offset:45056
 v_mfma_f32_16x16x32_bf16 v[132:135], a[248:251], a[108:111], v[132:135]
 ds_read_b64_tr_b16 a[78:79], v39 offset:47104
 v_mfma_f32_16x16x32_bf16 v[132:135], a[216:219], a[100:103], v[132:135]
 buffer_load_dwordx4 a[92:95], v1, s[24:27], s12 offen offset:3072 sc1
 v_mfma_f32_16x16x32_bf16 v[140:143], a[220:223], a[100:103], v[140:143]
 v_mfma_f32_16x16x32_bf16 v[140:143], a[252:255], a[108:111], v[140:143]
 v_mfma_f32_16x16x32_bf16 v[136:139], a[252:255], a[104:107], v[136:139]
 v_mfma_f32_16x16x32_bf16 v[136:139], a[220:223], a[96:99], v[136:139]
 s_add_u32 s12, s12, 4096
 s_waitcnt vmcnt(16) lgkmcnt(0)
 v_mfma_f32_16x16x32_bf16 v[144:147], a[16:19], a[112:115], v[144:147]
 s_barrier
 s_add_u32 s15, s17, 1048576
 ds_read_b64_tr_b16 a[192:193], v36 offset:49152
 ds_read_b64_tr_b16 a[194:195], v36 offset:51200
 v_or_b32 v4, v35, v34
 v_mfma_f32_16x16x32_bf16 v[144:147], a[48:51], a[120:123], v[144:147]
 s_add_u32 m0, s18, 32768
 ds_read_b64_tr_b16 a[224:225], v36 offset:57344
 ds_read_b64_tr_b16 a[226:227], v36 offset:59392
 v_cmp_ne_u32 vcc, 1, v4
 v_mfma_f32_16x16x32_bf16 v[148:151], a[48:51], a[124:127], v[148:151]
 buffer_load_dwordx4 v8, s[32:35], s15 offen lds
 s_branch L_tp_L_tail1_1_o
L_tp_L_tail1_1:
 s_nop 0
 s_nop 0
 s_branch L_tp_L_tail1_3
L_tp_L_tail1_1_o:
 v_mfma_f32_16x16x32_bf16 v[148:151], a[16:19], a[116:119], v[148:151]
 ds_read_b64_tr_b16 a[196:197], v37 offset:49152
 s_cbranch_vccnz L_of1_s
L_of1_d:
 v_mfma_f32_16x16x32_bf16 v[156:159], a[20:23], a[116:119], v[156:159]
 ds_read_b64_tr_b16 a[198:199], v37 offset:51200
 ds_read_b64_tr_b16 a[228:229], v37 offset:57344
 v_mfma_f32_16x16x32_bf16 v[156:159], a[52:55], a[124:127], v[156:159]
 buffer_load_dwordx4 a[96:99], v1, s[24:27], s12 offen sc1
 v_mfma_f32_16x16x32_bf16 v[152:155], a[52:55], a[120:123], v[152:155]
 ds_read_b64_tr_b16 a[230:231], v37 offset:59392
 v_mfma_f32_16x16x32_bf16 v[152:155], a[20:23], a[112:115], v[152:155]
 ds_read_b64_tr_b16 a[200:201], v38 offset:49152
 ds_read_b64_tr_b16 a[202:203], v38 offset:51200
 v_mfma_f32_16x16x32_bf16 v[160:163], a[24:27], a[112:115], v[160:163]
 s_add_u32 m0, s18, 33792
 ds_read_b64_tr_b16 a[232:233], v38 offset:57344
 ds_read_b64_tr_b16 a[234:235], v38 offset:59392
 v_mfma_f32_16x16x32_bf16 v[160:163], a[56:59], a[120:123], v[160:163]
 buffer_load_dwordx4 v9, s[32:35], s15 offen lds
 v_mfma_f32_16x16x32_bf16 v[164:167], a[56:59], a[124:127], v[164:167]
 ds_read_b64_tr_b16 a[204:205], v39 offset:49152
 v_mfma_f32_16x16x32_bf16 v[164:167], a[24:27], a[116:119], v[164:167]
 ds_read_b64_tr_b16 a[206:207], v39 offset:51200
 ds_read_b64_tr_b16 a[236:237], v39 offset:57344
 v_mfma_f32_16x16x32_bf16 v[172:175], a[28:31], a[116:119], v[172:175]
 buffer_load_dwordx4 a[100:103], v1, s[24:27], s12 offen offset:1024 sc1
 v_mfma_f32_16x16x32_bf16 v[172:175], a[60:63], a[124:127], v[172:175]
 ds_read_b64_tr_b16 a[238:239], v39 offset:59392
 v_mfma_f32_16x16x32_bf16 v[168:171], a[60:63], a[120:123], v[168:171]
 ds_read_b64_tr_b16 a[208:209], v36 offset:53248
 ds_read_b64_tr_b16 a[210:211], v36 offset:55296
 v_mfma_f32_16x16x32_bf16 v[168:171], a[28:31], a[112:115], v[168:171]
 s_add_u32 m0, s18, 34816
 ds_read_b64_tr_b16 a[240:241], v36 offset:61440
 ds_read_b64_tr_b16 a[242:243], v36 offset:63488
 v_mfma_f32_16x16x32_bf16 v[112:115], a[32:35], a[112:115], v[112:115]
 buffer_load_dwordx4 v10, s[32:35], s15 offen lds
 v_mfma_f32_16x16x32_bf16 v[112:115], a[64:67], a[120:123], v[112:115]
 ds_read_b64_tr_b16 a[212:213], v37 offset:53248
 v_mfma_f32_16x16x32_bf16 v[116:119], a[64:67], a[124:127], v[116:119]
 ds_read_b64_tr_b16 a[214:215], v37 offset:55296
 ds_read_b64_tr_b16 a[244:245], v37 offset:61440
 v_mfma_f32_16x16x32_bf16 v[116:119], a[32:35], a[116:119], v[116:119]
 ds_read_b64_tr_b16 a[246:247], v37 offset:63488
 v_mfma_f32_16x16x32_bf16 v[124:127], a[36:39], a[116:119], v[124:127]
 buffer_load_dwordx4 a[104:107], v1, s[24:27], s12 offen offset:2048 sc1
 v_mfma_f32_16x16x32_bf16 v[124:127], a[68:71], a[124:127], v[124:127]
 ds_read_b64_tr_b16 a[216:217], v38 offset:53248
 ds_read_b64_tr_b16 a[218:219], v38 offset:55296
 v_mfma_f32_16x16x32_bf16 v[120:123], a[68:71], a[120:123], v[120:123]
 s_add_u32 m0, s18, 35840
 ds_read_b64_tr_b16 a[248:249], v38 offset:61440
 ds_read_b64_tr_b16 a[250:251], v38 offset:63488
 v_mfma_f32_16x16x32_bf16 v[120:123], a[36:39], a[112:115], v[120:123]
 buffer_load_dwordx4 v11, s[32:35], s15 offen lds
 v_mfma_f32_16x16x32_bf16 v[128:131], a[40:43], a[112:115], v[128:131]
 ds_read_b64_tr_b16 a[220:221], v39 offset:53248
 v_mfma_f32_16x16x32_bf16 v[128:131], a[72:75], a[120:123], v[128:131]
 ds_read_b64_tr_b16 a[222:223], v39 offset:55296
 ds_read_b64_tr_b16 a[252:253], v39 offset:61440
 v_mfma_f32_16x16x32_bf16 v[132:135], a[72:75], a[124:127], v[132:135]
 ds_read_b64_tr_b16 a[254:255], v39 offset:63488
 v_mfma_f32_16x16x32_bf16 v[132:135], a[40:43], a[116:119], v[132:135]
 buffer_load_dwordx4 a[108:111], v1, s[24:27], s12 offen offset:3072 sc1
 v_mfma_f32_16x16x32_bf16 v[140:143], a[44:47], a[116:119], v[140:143]
 v_mfma_f32_16x16x32_bf16 v[140:143], a[76:79], a[124:127], v[140:143]
 v_mfma_f32_16x16x32_bf16 v[136:139], a[76:79], a[120:123], v[136:139]
 v_mfma_f32_16x16x32_bf16 v[136:139], a[44:47], a[112:115], v[136:139]
 s_add_u32 s12, s12, 4096
 s_waitcnt vmcnt(16) lgkmcnt(0)
 v_mfma_f32_16x16x32_bf16 v[144:147], a[192:195], a[128:131], v[144:147]
 s_barrier
 s_add_u32 s15, s17, 1310720
 ds_read_b64_tr_b16 a[16:17], v36 offset:0
 ds_read_b64_tr_b16 a[18:19], v36 offset:2048
 v_mfma_f32_16x16x32_bf16 v[144:147], a[224:227], a[136:139], v[144:147]
 s_add_u32 m0, s18, 49152
 ds_read_b64_tr_b16 a[48:49], v36 offset:8192
 ds_read_b64_tr_b16 a[50:51], v36 offset:10240
 v_mfma_f32_16x16x32_bf16 v[148:151], a[224:227], a[140:143], v[148:151]
 buffer_load_dwordx4 v8, s[32:35], s15 offen lds
 v_mfma_f32_16x16x32_bf16 v[148:151], a[192:195], a[132:135], v[148:151]
 ds_read_b64_tr_b16 a[20:21], v37 offset:0
 ds_read_b64_tr_b16 a[22:23], v37 offset:2048
 v_mfma_f32_16x16x32_bf16 v[156:159], a[196:199], a[132:135], v[156:159]
 buffer_load_dwordx4 a[112:115], v1, s[24:27], s13 offen sc1
 v_mfma_f32_16x16x32_bf16 v[156:159], a[228:231], a[140:143], v[156:159]
 ds_read_b64_tr_b16 a[52:53], v37 offset:8192
 ds_read_b64_tr_b16 a[54:55], v37 offset:10240
 v_mfma_f32_16x16x32_bf16 v[152:155], a[228:231], a[136:139], v[152:155]
 s_add_u32 m0, s18, 50176
 ds_read_b64_tr_b16 a[24:25], v38 offset:0
 v_mfma_f32_16x16x32_bf16 v[152:155], a[196:199], a[128:131], v[152:155]
 buffer_load_dwordx4 v9, s[32:35], s15 offen lds
 v_mfma_f32_16x16x32_bf16 v[160:163], a[200:203], a[128:131], v[160:163]
 ds_read_b64_tr_b16 a[26:27], v38 offset:2048
 ds_read_b64_tr_b16 a[56:57], v38 offset:8192
 v_mfma_f32_16x16x32_bf16 v[160:163], a[232:235], a[136:139], v[160:163]
 buffer_load_dwordx4 a[116:119], v1, s[24:27], s13 offen offset:1024 sc1
 v_mfma_f32_16x16x32_bf16 v[164:167], a[232:235], a[140:143], v[164:167]
 ds_read_b64_tr_b16 a[58:59], v38 offset:10240
 ds_read_b64_tr_b16 a[28:29], v39 offset:0
 v_mfma_f32_16x16x32_bf16 v[164:167], a[200:203], a[132:135], v[164:167]
 ds_read_b64_tr_b16 a[30:31], v39 offset:2048
 ds_read_b64_tr_b16 a[60:61], v39 offset:8192
 v_mfma_f32_16x16x32_bf16 v[172:175], a[204:207], a[132:135], v[172:175]
 buffer_load_dwordx4 a[120:123], v1, s[24:27], s13 offen offset:2048 sc1
 v_mfma_f32_16x16x32_bf16 v[172:175], a[236:239], a[140:143], v[172:175]
 ds_read_b64_tr_b16 a[62:63], v39 offset:10240
 v_mfma_f32_16x16x32_bf16 v[168:171], a[236:239], a[136:139], v[168:171]
 s_add_u32 m0, s18, 51200
 ds_read_b64_tr_b16 a[32:33], v36 offset:4096
 ds_read_b64_tr_b16 a[34:35], v36 offset:6144
 v_mfma_f32_16x16x32_bf16 v[168:171], a[204:207], a[128:131], v[168:171]
 buffer_load_dwordx4 v10, s[32:35], s15 offen lds
 v_mfma_f32_16x16x32_bf16 v[112:115], a[208:211], a[128:131], v[112:115]
 ds_read_b64_tr_b16 a[64:65], v36 offset:12288
 ds_read_b64_tr_b16 a[66:67], v36 offset:14336
 v_mfma_f32_16x16x32_bf16 v[112:115], a[240:243], a[136:139], v[112:115]
 buffer_load_dwordx4 a[124:127], v1, s[24:27], s13 offen offset:3072 sc1
 v_mfma_f32_16x16x32_bf16 v[116:119], a[240:243], a[140:143], v[116:119]
 ds_read_b64_tr_b16 a[36:37], v37 offset:4096
 ds_read_b64_tr_b16 a[38:39], v37 offset:6144
 v_mfma_f32_16x16x32_bf16 v[116:119], a[208:211], a[132:135], v[116:119]
 ds_read_b64_tr_b16 a[68:69], v37 offset:12288
 ds_read_b64_tr_b16 a[70:71], v37 offset:14336
 v_mfma_f32_16x16x32_bf16 v[124:127], a[212:215], a[132:135], v[124:127]
 buffer_load_dwordx4 a[160:163], v40, s[24:27], s13 offen sc1
 v_mfma_f32_16x16x32_bf16 v[124:127], a[244:247], a[140:143], v[124:127]
 ds_read_b64_tr_b16 a[40:41], v38 offset:4096
 v_mfma_f32_16x16x32_bf16 v[120:123], a[244:247], a[136:139], v[120:123]
 s_add_u32 m0, s18, 52224
 ds_read_b64_tr_b16 a[42:43], v38 offset:6144
 ds_read_b64_tr_b16 a[72:73], v38 offset:12288
 v_mfma_f32_16x16x32_bf16 v[120:123], a[212:215], a[128:131], v[120:123]
 buffer_load_dwordx4 v11, s[32:35], s15 offen lds
 v_mfma_f32_16x16x32_bf16 v[128:131], a[216:219], a[128:131], v[128:131]
 ds_read_b64_tr_b16 a[74:75], v38 offset:14336
 ds_read_b64_tr_b16 a[44:45], v39 offset:4096
 v_mfma_f32_16x16x32_bf16 v[128:131], a[248:251], a[136:139], v[128:131]
 buffer_load_dwordx4 a[164:167], v40, s[24:27], s13 offen offset:1024 sc1
 v_mfma_f32_16x16x32_bf16 v[132:135], a[248:251], a[140:143], v[132:135]
 ds_read_b64_tr_b16 a[46:47], v39 offset:6144
 ds_read_b64_tr_b16 a[76:77], v39 offset:12288
 v_mfma_f32_16x16x32_bf16 v[132:135], a[216:219], a[132:135], v[132:135]
 ds_read_b64_tr_b16 a[78:79], v39 offset:14336
 v_mfma_f32_16x16x32_bf16 v[140:143], a[220:223], a[132:135], v[140:143]
 buffer_load_dwordx4 a[168:171], v40, s[24:27], s13 offen offset:2048 sc1
 v_mfma_f32_16x16x32_bf16 v[140:143], a[252:255], a[140:143], v[140:143]
 v_mfma_f32_16x16x32_bf16 v[136:139], a[252:255], a[136:139], v[136:139]
 v_mfma_f32_16x16x32_bf16 v[136:139], a[220:223], a[128:131], v[136:139]
 s_waitcnt vmcnt(19) lgkmcnt(0)
 v_mfma_f32_16x16x32_bf16 v[144:147], a[16:19], a[80:83], v[144:147]
 s_barrier
 ds_read_b64_tr_b16 a[192:193], v36 offset:16384
 ds_read_b64_tr_b16 a[194:195], v36 offset:18432
 v_mfma_f32_16x16x32_bf16 v[144:147], a[48:51], a[88:91], v[144:147]
 ds_read_b64_tr_b16 a[224:225], v36 offset:24576
 ds_read_b64_tr_b16 a[226:227], v36 offset:26624
 v_mfma_f32_16x16x32_bf16 v[148:151], a[48:51], a[92:95], v[148:151]
 buffer_load_dwordx4 a[172:175], v40, s[24:27], s13 offen offset:3072 sc1
 v_mfma_f32_16x16x32_bf16 v[148:151], a[16:19], a[84:87], v[148:151]
 s_add_u32 s13, s13, 8192
 ds_read_b64_tr_b16 a[196:197], v37 offset:16384
 v_mfma_f32_16x16x32_bf16 v[156:159], a[20:23], a[84:87], v[156:159]
 ds_read_b64_tr_b16 a[198:199], v37 offset:18432
 ds_read_b64_tr_b16 a[228:229], v37 offset:24576
 v_mfma_f32_16x16x32_bf16 v[156:159], a[52:55], a[92:95], v[156:159]
 buffer_load_dwordx4 a[128:131], v1, s[24:27], s13 offen sc1
 v_mfma_f32_16x16x32_bf16 v[152:155], a[52:55], a[88:91], v[152:155]
 ds_read_b64_tr_b16 a[230:231], v37 offset:26624
 v_mfma_f32_16x16x32_bf16 v[152:155], a[20:23], a[80:83], v[152:155]
 ds_read_b64_tr_b16 a[200:201], v38 offset:16384
 ds_read_b64_tr_b16 a[202:203], v38 offset:18432
 v_mfma_f32_16x16x32_bf16 v[160:163], a[24:27], a[80:83], v[160:163]
 ds_read_b64_tr_b16 a[232:233], v38 offset:24576
 ds_read_b64_tr_b16 a[234:235], v38 offset:26624
 v_mfma_f32_16x16x32_bf16 v[160:163], a[56:59], a[88:91], v[160:163]
 buffer_load_dwordx4 a[132:135], v1, s[24:27], s13 offen offset:1024 sc1
 v_mfma_f32_16x16x32_bf16 v[164:167], a[56:59], a[92:95], v[164:167]
 ds_read_b64_tr_b16 a[204:205], v39 offset:16384
 v_mfma_f32_16x16x32_bf16 v[164:167], a[24:27], a[84:87], v[164:167]
 ds_read_b64_tr_b16 a[206:207], v39 offset:18432
 ds_read_b64_tr_b16 a[236:237], v39 offset:24576
 v_mfma_f32_16x16x32_bf16 v[172:175], a[28:31], a[84:87], v[172:175]
 buffer_load_dwordx4 a[136:139], v1, s[24:27], s13 offen offset:2048 sc1
 v_mfma_f32_16x16x32_bf16 v[172:175], a[60:63], a[92:95], v[172:175]
 ds_read_b64_tr_b16 a[238:239], v39 offset:26624
 v_mfma_f32_16x16x32_bf16 v[168:171], a[60:63], a[88:91], v[168:171]
 ds_read_b64_tr_b16 a[208:209], v36 offset:20480
 ds_read_b64_tr_b16 a[210:211], v36 offset:22528
 v_mfma_f32_16x16x32_bf16 v[168:171], a[28:31], a[80:83], v[168:171]
 ds_read_b64_tr_b16 a[240:241], v36 offset:28672
 ds_read_b64_tr_b16 a[242:243], v36 offset:30720
 v_mfma_f32_16x16x32_bf16 v[112:115], a[32:35], a[80:83], v[112:115]
 buffer_load_dwordx4 a[140:143], v1, s[24:27], s13 offen offset:3072 sc1
 v_mfma_f32_16x16x32_bf16 v[112:115], a[64:67], a[88:91], v[112:115]
 ds_read_b64_tr_b16 a[212:213], v37 offset:20480
 v_mfma_f32_16x16x32_bf16 v[116:119], a[64:67], a[92:95], v[116:119]
 ds_read_b64_tr_b16 a[214:215], v37 offset:22528
 ds_read_b64_tr_b16 a[244:245], v37 offset:28672
 v_mfma_f32_16x16x32_bf16 v[116:119], a[32:35], a[84:87], v[116:119]
 ds_read_b64_tr_b16 a[246:247], v37 offset:30720
 v_mfma_f32_16x16x32_bf16 v[124:127], a[36:39], a[84:87], v[124:127]
 buffer_load_dwordx4 a[176:179], v40, s[24:27], s13 offen sc1
 v_mfma_f32_16x16x32_bf16 v[124:127], a[68:71], a[92:95], v[124:127]
 ds_read_b64_tr_b16 a[216:217], v38 offset:20480
 ds_read_b64_tr_b16 a[218:219], v38 offset:22528
 v_mfma_f32_16x16x32_bf16 v[120:123], a[68:71], a[88:91], v[120:123]
 ds_read_b64_tr_b16 a[248:249], v38 offset:28672
 ds_read_b64_tr_b16 a[250:251], v38 offset:30720
 v_mfma_f32_16x16x32_bf16 v[120:123], a[36:39], a[80:83], v[120:123]
 buffer_load_dwordx4 a[180:183], v40, s[24:27], s13 offen offset:1024 sc1
 v_mfma_f32_16x16x32_bf16 v[128:131], a[40:43], a[80:83], v[128:131]
 ds_read_b64_tr_b16 a[220:221], v39 offset:20480
 v_mfma_f32_16x16x32_bf16 v[128:131], a[72:75], a[88:91], v[128:131]
 ds_read_b64_tr_b16 a[222:223], v39 offset:22528
 ds_read_b64_tr_b16 a[252:253], v39 offset:28672
 v_mfma_f32_16x16x32_bf16 v[132:135], a[72:75], a[92:95], v[132:135]
 ds_read_b64_tr_b16 a[254:255], v39 offset:30720
 v_mfma_f32_16x16x32_bf16 v[132:135], a[40:43], a[84:87], v[132:135]
 buffer_load_dwordx4 a[184:187], v40, s[24:27], s13 offen offset:2048 sc1
 v_mfma_f32_16x16x32_bf16 v[140:143], a[44:47], a[84:87], v[140:143]
 v_mfma_f32_16x16x32_bf16 v[140:143], a[76:79], a[92:95], v[140:143]
 v_mfma_f32_16x16x32_bf16 v[136:139], a[76:79], a[88:91], v[136:139]
 v_mfma_f32_16x16x32_bf16 v[136:139], a[44:47], a[80:83], v[136:139]
 v_add_u32 v36, 81920, v36
 v_add_u32 v37, 81920, v37
 v_add_u32 v38, 81920, v38
 v_add_u32 v39, 81920, v39
 s_waitcnt vmcnt(19) lgkmcnt(0)
 v_mfma_f32_16x16x32_bf16 v[112:115], a[208:211], a[96:99], v[112:115]
 s_barrier
 ds_read_b64_tr_b16 a[16:17], v36 offset:0
 ds_read_b64_tr_b16 a[18:19], v36 offset:2048
 v_mfma_f32_16x16x32_bf16 v[112:115], a[240:243], a[104:107], v[112:115]
 ds_read_b64_tr_b16 a[32:33], v36 offset:4096
 v_mfma_f32_16x16x32_bf16 v[116:119], a[240:243], a[108:111], v[116:119]
 buffer_load_dwordx4 a[188:191], v40, s[24:27], s13 offen offset:3072 sc1
 v_mfma_f32_16x16x32_bf16 v[116:119], a[208:211], a[100:103], v[116:119]
 s_add_u32 s13, s13, 8192
 ds_read_b64_tr_b16 a[34:35], v36 offset:6144
 ds_read_b64_tr_b16 a[48:49], v36 offset:8192
 v_mfma_f32_16x16x32_bf16 v[124:127], a[212:215], a[100:103], v[124:127]
 ds_read_b64_tr_b16 a[50:51], v36 offset:10240
 v_mfma_f32_16x16x32_bf16 v[124:127], a[244:247], a[108:111], v[124:127]
 ds_read_b64_tr_b16 a[64:65], v36 offset:12288
 ds_read_b64_tr_b16 a[66:67], v36 offset:14336
 v_mfma_f32_16x16x32_bf16 v[120:123], a[244:247], a[104:107], v[120:123]
 buffer_load_dwordx4 a[80:83], v1, s[24:27], s13 offen sc1
 v_mfma_f32_16x16x32_bf16 v[120:123], a[212:215], a[96:99], v[120:123]
 ds_read_b64_tr_b16 a[20:21], v37 offset:0
 v_mfma_f32_16x16x32_bf16 v[128:131], a[216:219], a[96:99], v[128:131]
 ds_read_b64_tr_b16 a[22:23], v37 offset:2048
 ds_read_b64_tr_b16 a[36:37], v37 offset:4096
 v_mfma_f32_16x16x32_bf16 v[128:131], a[248:251], a[104:107], v[128:131]
 ds_read_b64_tr_b16 a[38:39], v37 offset:6144
 v_mfma_f32_16x16x32_bf16 v[132:135], a[248:251], a[108:111], v[132:135]
 ds_read_b64_tr_b16 a[52:53], v37 offset:8192
 ds_read_b64_tr_b16 a[54:55], v37 offset:10240
 v_mfma_f32_16x16x32_bf16 v[132:135], a[216:219], a[100:103], v[132:135]
 buffer_load_dwordx4 a[84:87], v1, s[24:27], s13 offen offset:1024 sc1
 v_mfma_f32_16x16x32_bf16 v[140:143], a[220:223], a[100:103], v[140:143]
 ds_read_b64_tr_b16 a[68:69], v37 offset:12288
 v_mfma_f32_16x16x32_bf16 v[140:143], a[252:255], a[108:111], v[140:143]
 ds_read_b64_tr_b16 a[70:71], v37 offset:14336
 v_mfma_f32_16x16x32_bf16 v[136:139], a[252:255], a[104:107], v[136:139]
 ds_read_b64_tr_b16 a[24:25], v38 offset:0
 ds_read_b64_tr_b16 a[26:27], v38 offset:2048
 v_mfma_f32_16x16x32_bf16 v[136:139], a[220:223], a[96:99], v[136:139]
 ds_read_b64_tr_b16 a[40:41], v38 offset:4096
 v_mfma_f32_16x16x32_bf16 v[144:147], a[192:195], a[96:99], v[144:147]
 buffer_load_dwordx4 a[88:91], v1, s[24:27], s13 offen offset:2048 sc1
 v_mfma_f32_16x16x32_bf16 v[144:147], a[224:227], a[104:107], v[144:147]
 ds_read_b64_tr_b16 a[42:43], v38 offset:6144
 ds_read_b64_tr_b16 a[56:57], v38 offset:8192
 v_mfma_f32_16x16x32_bf16 v[148:151], a[224:227], a[108:111], v[148:151]
 ds_read_b64_tr_b16 a[58:59], v38 offset:10240
 v_mfma_f32_16x16x32_bf16 v[148:151], a[192:195], a[100:103], v[148:151]
 ds_read_b64_tr_b16 a[72:73], v38 offset:12288
 ds_read_b64_tr_b16 a[74:75], v38 offset:14336
 v_mfma_f32_16x16x32_bf16 v[156:159], a[196:199], a[100:103], v[156:159]
 ds_read_b64_tr_b16 a[28:29], v39 offset:0
 v_cvt_pk_bf16_f32 v80, v112, v113
 v_mfma_f32_16x16x32_bf16 v[156:159], a[228:231], a[108:111], v[156:159]
 buffer_load_dwordx4 a[92:95], v1, s[24:27], s13 offen offset:3072 sc1
 v_cvt_pk_bf16_f32 v81, v114, v115
 v_mfma_f32_16x16x32_bf16 v[152:155], a[228:231], a[104:107], v[152:155]
 ds_read_b64_tr_b16 a[30:31], v39 offset:2048
 ds_read_b64_tr_b16 a[44:45], v39 offset:4096
 v_cvt_pk_bf16_f32 v82, v120, v121
 v_mfma_f32_16x16x32_bf16 v[152:155], a[196:199], a[96:99], v[152:155]
 ds_read_b64_tr_b16 a[46:47], v39 offset:6144
 v_cvt_pk_bf16_f32 v83, v122, v123
 v_mfma_f32_16x16x32_bf16 v[160:163], a[200:203], a[96:99], v[160:163]
 ds_read_b64_tr_b16 a[60:61], v39 offset:8192
 ds_read_b64_tr_b16 a[62:63], v39 offset:10240
 v_mfma_f32_16x16x32_bf16 v[160:163], a[232:235], a[104:107], v[160:163]
 ds_read_b64_tr_b16 a[76:77], v39 offset:12288
 buffer_store_dwordx4 v[80:83], v1, s[24:27], s61 offen sc1
 v_mfma_f32_16x16x32_bf16 v[164:167], a[232:235], a[108:111], v[164:167]
 buffer_load_dwordx4 a[0:3], v40, s[24:27], s13 offen sc1
 v_cvt_pk_bf16_f32 v84, v128, v129
 v_mfma_f32_16x16x32_bf16 v[164:167], a[200:203], a[100:103], v[164:167]
 ds_read_b64_tr_b16 a[78:79], v39 offset:14336
 v_cvt_pk_bf16_f32 v85, v130, v131
 v_mfma_f32_16x16x32_bf16 v[172:175], a[204:207], a[100:103], v[172:175]
 v_cvt_pk_bf16_f32 v86, v136, v137
 v_mfma_f32_16x16x32_bf16 v[172:175], a[236:239], a[108:111], v[172:175]
 v_cvt_pk_bf16_f32 v87, v138, v139
 v_mfma_f32_16x16x32_bf16 v[168:171], a[236:239], a[104:107], v[168:171]
 v_mfma_f32_16x16x32_bf16 v[168:171], a[204:207], a[96:99], v[168:171]
 buffer_store_dwordx4 v[84:87], v1, s[24:27], s61 offen offset:1024 sc1
 s_waitcnt vmcnt(15) lgkmcnt(0)
 v_mfma_f32_16x16x32_bf16 v[176:179], a[16:19], a[112:115], 0
 s_barrier
 ds_read_b64_tr_b16 a[192:193], v36 offset:16384
 ds_read_b64_tr_b16 a[194:195], v36 offset:18432
 v_cvt_pk_bf16_f32 v88, v116, v117
 v_mfma_f32_16x16x32_bf16 v[176:179], a[32:35], a[120:123], v[176:179]
 ds_read_b64_tr_b16 a[208:209], v36 offset:20480
 v_cvt_pk_bf16_f32 v89, v118, v119
 v_mfma_f32_16x16x32_bf16 v[176:179], a[48:51], a[160:163], v[176:179]
 buffer_load_dwordx4 a[4:7], v40, s[24:27], s13 offen offset:1024 sc1
 v_cvt_pk_bf16_f32 v90, v124, v125
 v_mfma_f32_16x16x32_bf16 v[176:179], a[64:67], a[168:171], v[176:179]
 ds_read_b64_tr_b16 a[210:211], v36 offset:22528
 ds_read_b64_tr_b16 a[224:225], v36 offset:24576
 v_cvt_pk_bf16_f32 v91, v126, v127
 v_mfma_f32_16x16x32_bf16 v[180:183], a[64:67], a[172:175], 0
 ds_read_b64_tr_b16 a[226:227], v36 offset:26624
 v_mfma_f32_16x16x32_bf16 v[180:183], a[48:51], a[164:167], v[180:183]
 ds_read_b64_tr_b16 a[240:241], v36 offset:28672
 ds_read_b64_tr_b16 a[242:243], v36 offset:30720
 buffer_store_dwordx4 v[88:91], v1, s[24:27], s61 offen offset:2048 sc1
 v_mfma_f32_16x16x32_bf16 v[180:183], a[32:35], a[124:127], v[180:183]
 buffer_load_dwordx4 a[8:11], v40, s[24:27], s13 offen offset:2048 sc1
 v_cvt_pk_bf16_f32 v92, v132, v133
 v_mfma_f32_16x16x32_bf16 v[180:183], a[16:19], a[116:119], v[180:183]
 ds_read_b64_tr_b16 a[196:197], v37 offset:16384
 v_cvt_pk_bf16_f32 v93, v134, v135
 v_mfma_f32_16x16x32_bf16 v[188:191], a[20:23], a[116:119], 0
 ds_read_b64_tr_b16 a[198:199], v37 offset:18432
 ds_read_b64_tr_b16 a[212:213], v37 offset:20480
 v_cvt_pk_bf16_f32 v94, v140, v141
 v_mfma_f32_16x16x32_bf16 v[188:191], a[36:39], a[124:127], v[188:191]
 ds_read_b64_tr_b16 a[214:215], v37 offset:22528
 v_cvt_pk_bf16_f32 v95, v142, v143
 v_mfma_f32_16x16x32_bf16 v[188:191], a[52:55], a[164:167], v[188:191]
 ds_read_b64_tr_b16 a[228:229], v37 offset:24576
 ds_read_b64_tr_b16 a[230:231], v37 offset:26624
 v_mfma_f32_16x16x32_bf16 v[188:191], a[68:71], a[172:175], v[188:191]
 buffer_load_dwordx4 a[12:15], v40, s[24:27], s13 offen offset:3072 sc1
 buffer_store_dwordx4 v[92:95], v1, s[24:27], s61 offen offset:3072 sc1
 v_mfma_f32_16x16x32_bf16 v[184:187], a[68:71], a[168:171], 0
 s_add_u32 s13, s13, 8192
 ds_read_b64_tr_b16 a[244:245], v37 offset:28672
 v_mfma_f32_16x16x32_bf16 v[184:187], a[52:55], a[160:163], v[184:187]
 ds_read_b64_tr_b16 a[246:247], v37 offset:30720
 v_mfma_f32_16x16x32_bf16 v[184:187], a[36:39], a[120:123], v[184:187]
 ds_read_b64_tr_b16 a[200:201], v38 offset:16384
 ds_read_b64_tr_b16 a[202:203], v38 offset:18432
 v_mfma_f32_16x16x32_bf16 v[184:187], a[20:23], a[112:115], v[184:187]
 ds_read_b64_tr_b16 a[216:217], v38 offset:20480
 v_mfma_f32_16x16x32_bf16 v[192:195], a[24:27], a[112:115], 0
 buffer_load_dwordx4 a[96:99], v1, s[24:27], s13 offen sc1
 v_mfma_f32_16x16x32_bf16 v[192:195], a[40:43], a[120:123], v[192:195]
 ds_read_b64_tr_b16 a[218:219], v38 offset:22528
 ds_read_b64_tr_b16 a[232:233], v38 offset:24576
 v_mfma_f32_16x16x32_bf16 v[192:195], a[56:59], a[160:163], v[192:195]
 ds_read_b64_tr_b16 a[234:235], v38 offset:26624
 v_mfma_f32_16x16x32_bf16 v[192:195], a[72:75], a[168:171], v[192:195]
 ds_read_b64_tr_b16 a[248:249], v38 offset:28672
 ds_read_b64_tr_b16 a[250:251], v38 offset:30720
 v_mfma_f32_16x16x32_bf16 v[196:199], a[72:75], a[172:175], 0
 ds_read_b64_tr_b16 a[204:205], v39 offset:16384
 v_mfma_f32_16x16x32_bf16 v[196:199], a[56:59], a[164:167], v[196:199]
 buffer_load_dwordx4 a[100:103], v1, s[24:27], s13 offen offset:1024 sc1
 v_mfma_f32_16x16x32_bf16 v[196:199], a[40:43], a[124:127], v[196:199]
 ds_read_b64_tr_b16 a[206:207], v39 offset:18432
 ds_read_b64_tr_b16 a[220:221], v39 offset:20480
 v_mfma_f32_16x16x32_bf16 v[196:199], a[24:27], a[116:119], v[196:199]
 ds_read_b64_tr_b16 a[222:223], v39 offset:22528
 v_mfma_f32_16x16x32_bf16 v[204:207], a[28:31], a[116:119], 0
 ds_read_b64_tr_b16 a[236:237], v39 offset:24576
 ds_read_b64_tr_b16 a[238:239], v39 offset:26624
 v_mfma_f32_16x16x32_bf16 v[204:207], a[44:47], a[124:127], v[204:207]
 ds_read_b64_tr_b16 a[252:253], v39 offset:28672
 v_mfma_f32_16x16x32_bf16 v[204:207], a[60:63], a[164:167], v[204:207]
 buffer_load_dwordx4 a[104:107], v1, s[24:27], s13 offen offset:2048 sc1
 v_mfma_f32_16x16x32_bf16 v[204:207], a[76:79], a[172:175], v[204:207]
 ds_read_b64_tr_b16 a[254:255], v39 offset:30720
 v_mfma_f32_16x16x32_bf16 v[200:203], a[76:79], a[168:171], 0
 v_mfma_f32_16x16x32_bf16 v[200:203], a[60:63], a[160:163], v[200:203]
 v_mfma_f32_16x16x32_bf16 v[200:203], a[44:47], a[120:123], v[200:203]
 v_mfma_f32_16x16x32_bf16 v[200:203], a[28:31], a[112:115], v[200:203]
 s_waitcnt vmcnt(15) lgkmcnt(0)
 v_mfma_f32_16x16x32_bf16 v[176:179], a[192:195], a[128:131], v[176:179]
 s_barrier
 ds_read_b64_tr_b16 a[16:17], v36 offset:32768
 ds_read_b64_tr_b16 a[18:19], v36 offset:34816
 v_mfma_f32_16x16x32_bf16 v[176:179], a[208:211], a[136:139], v[176:179]
 ds_read_b64_tr_b16 a[32:33], v36 offset:36864
 ds_read_b64_tr_b16 a[34:35], v36 offset:38912
 v_mfma_f32_16x16x32_bf16 v[176:179], a[224:227], a[176:179], v[176:179]
 buffer_load_dwordx4 a[108:111], v1, s[24:27], s13 offen offset:3072 sc1
 v_mfma_f32_16x16x32_bf16 v[176:179], a[240:243], a[184:187], v[176:179]
 ds_read_b64_tr_b16 a[48:49], v36 offset:40960
 v_mfma_f32_16x16x32_bf16 v[180:183], a[240:243], a[188:191], v[180:183]
 ds_read_b64_tr_b16 a[50:51], v36 offset:43008
 ds_read_b64_tr_b16 a[64:65], v36 offset:45056
 v_mfma_f32_16x16x32_bf16 v[180:183], a[224:227], a[180:183], v[180:183]
 buffer_load_dwordx4 a[144:147], v40, s[24:27], s13 offen sc1
 v_mfma_f32_16x16x32_bf16 v[180:183], a[208:211], a[140:143], v[180:183]
 ds_read_b64_tr_b16 a[66:67], v36 offset:47104
 v_mfma_f32_16x16x32_bf16 v[180:183], a[192:195], a[132:135], v[180:183]
 ds_read_b64_tr_b16 a[20:21], v37 offset:32768
 ds_read_b64_tr_b16 a[22:23], v37 offset:34816
 v_mfma_f32_16x16x32_bf16 v[188:191], a[196:199], a[132:135], v[188:191]
 ds_read_b64_tr_b16 a[36:37], v37 offset:36864
 ds_read_b64_tr_b16 a[38:39], v37 offset:38912
 v_mfma_f32_16x16x32_bf16 v[188:191], a[212:215], a[140:143], v[188:191]
 buffer_load_dwordx4 a[148:151], v40, s[24:27], s13 offen offset:1024 sc1
 v_mfma_f32_16x16x32_bf16 v[188:191], a[228:231], a[180:183], v[188:191]
 ds_read_b64_tr_b16 a[52:53], v37 offset:40960
 v_mfma_f32_16x16x32_bf16 v[188:191], a[244:247], a[188:191], v[188:191]
 ds_read_b64_tr_b16 a[54:55], v37 offset:43008
 ds_read_b64_tr_b16 a[68:69], v37 offset:45056
 v_mfma_f32_16x16x32_bf16 v[184:187], a[244:247], a[184:187], v[184:187]
 buffer_load_dwordx4 a[152:155], v40, s[24:27], s13 offen offset:2048 sc1
 v_mfma_f32_16x16x32_bf16 v[184:187], a[228:231], a[176:179], v[184:187]
 ds_read_b64_tr_b16 a[70:71], v37 offset:47104
 v_mfma_f32_16x16x32_bf16 v[184:187], a[212:215], a[136:139], v[184:187]
 ds_read_b64_tr_b16 a[24:25], v38 offset:32768
 ds_read_b64_tr_b16 a[26:27], v38 offset:34816
 v_mfma_f32_16x16x32_bf16 v[184:187], a[196:199], a[128:131], v[184:187]
 ds_read_b64_tr_b16 a[40:41], v38 offset:36864
 ds_read_b64_tr_b16 a[42:43], v38 offset:38912
 v_mfma_f32_16x16x32_bf16 v[192:195], a[200:203], a[128:131], v[192:195]
 buffer_load_dwordx4 a[156:159], v40, s[24:27], s13 offen offset:3072 sc1
 v_mfma_f32_16x16x32_bf16 v[192:195], a[216:219], a[136:139], v[192:195]
 s_add_u32 s13, s13, 8192
 ds_read_b64_tr_b16 a[56:57], v38 offset:40960
 v_mfma_f32_16x16x32_bf16 v[192:195], a[232:235], a[176:179], v[192:195]
 ds_read_b64_tr_b16 a[58:59], v38 offset:43008
 ds_read_b64_tr_b16 a[72:73], v38 offset:45056
 v_mfma_f32_16x16x32_bf16 v[192:195], a[248:251], a[184:187], v[192:195]
 ds_read_b64_tr_b16 a[74:75], v38 offset:47104
 v_mfma_f32_16x16x32_bf16 v[196:199], a[248:251], a[188:191], v[196:199]
 buffer_load_dwordx4 a[112:115], v1, s[24:27], s13 offen sc1
 v_mfma_f32_16x16x32_bf16 v[196:199], a[232:235], a[180:183], v[196:199]
 ds_read_b64_tr_b16 a[28:29], v39 offset:32768
 ds_read_b64_tr_b16 a[30:31], v39 offset:34816
 v_mfma_f32_16x16x32_bf16 v[196:199], a[216:219], a[140:143], v[196:199]
 ds_read_b64_tr_b16 a[44:45], v39 offset:36864
 ds_read_b64_tr_b16 a[46:47], v39 offset:38912
 v_mfma_f32_16x16x32_bf16 v[196:199], a[200:203], a[132:135], v[196:199]
 buffer_load_dwordx4 a[116:119], v1, s[24:27], s13 offen offset:1024 sc1
 v_mfma_f32_16x16x32_bf16 v[204:207], a[204:207], a[132:135], v[204:207]
 ds_read_b64_tr_b16 a[60:61], v39 offset:40960
 v_mfma_f32_16x16x32_bf16 v[204:207], a[220:223], a[140:143], v[204:207]
 ds_read_b64_tr_b16 a[62:63], v39 offset:43008
 ds_read_b64_tr_b16 a[76:77], v39 offset:45056
 v_mfma_f32_16x16x32_bf16 v[204:207], a[236:239], a[180:183], v[204:207]
 ds_read_b64_tr_b16 a[78:79], v39 offset:47104
 v_mfma_f32_16x16x32_bf16 v[204:207], a[252:255], a[188:191], v[204:207]
 buffer_load_dwordx4 a[120:123], v1, s[24:27], s13 offen offset:2048 sc1
 v_mfma_f32_16x16x32_bf16 v[200:203], a[252:255], a[184:187], v[200:203]
 v_mfma_f32_16x16x32_bf16 v[200:203], a[236:239], a[176:179], v[200:203]
 v_mfma_f32_16x16x32_bf16 v[200:203], a[220:223], a[136:139], v[200:203]
 v_mfma_f32_16x16x32_bf16 v[200:203], a[204:207], a[128:131], v[200:203]
 s_waitcnt vmcnt(12) lgkmcnt(0)
 v_mfma_f32_16x16x32_bf16 v[176:179], a[16:19], a[80:83], v[176:179]
 s_barrier
 s_add_u32 s15, s17, 1572864
 ds_read_b64_tr_b16 a[192:193], v36 offset:49152
 ds_read_b64_tr_b16 a[194:195], v36 offset:51200
 v_mfma_f32_16x16x32_bf16 v[176:179], a[32:35], a[88:91], v[176:179]
 s_add_u32 m0, s18, 0
 ds_read_b64_tr_b16 a[208:209], v36 offset:53248
 ds_read_b64_tr_b16 a[210:211], v36 offset:55296
 v_mfma_f32_16x16x32_bf16 v[176:179], a[48:51], a[0:3], v[176:179]
 buffer_load_dwordx4 v8, s[32:35], s15 offen lds
 v_mfma_f32_16x16x32_bf16 v[176:179], a[64:67], a[8:11], v[176:179]
 ds_read_b64_tr_b16 a[224:225], v36 offset:57344
 ds_read_b64_tr_b16 a[226:227], v36 offset:59392
 v_mfma_f32_16x16x32_bf16 v[180:183], a[64:67], a[12:15], v[180:183]
 buffer_load_dwordx4 a[124:127], v1, s[24:27], s13 offen offset:3072 sc1
 v_mfma_f32_16x16x32_bf16 v[180:183], a[48:51], a[4:7], v[180:183]
 ds_read_b64_tr_b16 a[240:241], v36 offset:61440
 v_mfma_f32_16x16x32_bf16 v[180:183], a[32:35], a[92:95], v[180:183]
 s_add_u32 m0, s18, 1024
 ds_read_b64_tr_b16 a[242:243], v36 offset:63488
 ds_read_b64_tr_b16 a[196:197], v37 offset:49152
 v_mfma_f32_16x16x32_bf16 v[180:183], a[16:19], a[84:87], v[180:183]
 buffer_load_dwordx4 v9, s[32:35], s15 offen lds
 v_mfma_f32_16x16x32_bf16 v[188:191], a[20:23], a[84:87], v[188:191]
 ds_read_b64_tr_b16 a[198:199], v37 offset:51200
 ds_read_b64_tr_b16 a[212:213], v37 offset:53248
 v_mfma_f32_16x16x32_bf16 v[188:191], a[36:39], a[92:95], v[188:191]
 ds_read_b64_tr_b16 a[214:215], v37 offset:55296
 v_mfma_f32_16x16x32_bf16 v[188:191], a[52:55], a[4:7], v[188:191]
 buffer_load_dwordx4 a[160:163], v40, s[24:27], s13 offen sc1
 v_mfma_f32_16x16x32_bf16 v[188:191], a[68:71], a[12:15], v[188:191]
 ds_read_b64_tr_b16 a[228:229], v37 offset:57344
 ds_read_b64_tr_b16 a[230:231], v37 offset:59392
 v_mfma_f32_16x16x32_bf16 v[184:187], a[68:71], a[8:11], v[184:187]
 ds_read_b64_tr_b16 a[244:245], v37 offset:61440
 ds_read_b64_tr_b16 a[246:247], v37 offset:63488
 v_mfma_f32_16x16x32_bf16 v[184:187], a[52:55], a[0:3], v[184:187]
 buffer_load_dwordx4 a[164:167], v40, s[24:27], s13 offen offset:1024 sc1
 v_mfma_f32_16x16x32_bf16 v[184:187], a[36:39], a[88:91], v[184:187]
 ds_read_b64_tr_b16 a[200:201], v38 offset:49152
 v_mfma_f32_16x16x32_bf16 v[184:187], a[20:23], a[80:83], v[184:187]
 s_add_u32 m0, s18, 2048
 ds_read_b64_tr_b16 a[202:203], v38 offset:51200
 ds_read_b64_tr_b16 a[216:217], v38 offset:53248
 s_branch L_tp_L_tail1_2_o
L_tp_L_tail1_2:
 s_nop 0
 s_nop 0
 s_branch L_tret
L_tp_L_tail1_2_o:
 v_mfma_f32_16x16x32_bf16 v[192:195], a[24:27], a[80:83], v[192:195]
 buffer_load_dwordx4 v10, s[32:35], s15 offen lds
 v_mfma_f32_16x16x32_bf16 v[192:195], a[40:43], a[88:91], v[192:195]
 ds_read_b64_tr_b16 a[218:219], v38 offset:55296
 ds_read_b64_tr_b16 a[232:233], v38 offset:57344
 v_mfma_f32_16x16x32_bf16 v[192:195], a[56:59], a[0:3], v[192:195]
 ds_read_b64_tr_b16 a[234:235], v38 offset:59392
 v_mfma_f32_16x16x32_bf16 v[192:195], a[72:75], a[8:11], v[192:195]
 buffer_load_dwordx4 a[168:171], v40, s[24:27], s13 offen offset:2048 sc1
 v_mfma_f32_16x16x32_bf16 v[196:199], a[72:75], a[12:15], v[196:199]
 ds_read_b64_tr_b16 a[248:249], v38 offset:61440
 ds_read_b64_tr_b16 a[250:251], v38 offset:63488
 v_mfma_f32_16x16x32_bf16 v[196:199], a[56:59], a[4:7], v[196:199]
 s_add_u32 m0, s18, 3072
 ds_read_b64_tr_b16 a[204:205], v39 offset:49152
 ds_read_b64_tr_b16 a[206:207], v39 offset:51200
 v_mfma_f32_16x16x32_bf16 v[196:199], a[40:43], a[92:95], v[196:199]
 buffer_load_dwordx4 v11, s[32:35], s15 offen lds
 v_mfma_f32_16x16x32_bf16 v[196:199], a[24:27], a[84:87], v[196:199]
 ds_read_b64_tr_b16 a[220:221], v39 offset:53248
 v_mfma_f32_16x16x32_bf16 v[204:207], a[28:31], a[84:87], v[204:207]
 ds_read_b64_tr_b16 a[222:223], v39 offset:55296
 ds_read_b64_tr_b16 a[236:237], v39 offset:57344
 v_mfma_f32_16x16x32_bf16 v[204:207], a[44:47], a[92:95], v[204:207]
 buffer_load_dwordx4 a[172:175], v40, s[24:27], s13 offen offset:3072 sc1
 v_mfma_f32_16x16x32_bf16 v[204:207], a[60:63], a[4:7], v[204:207]
 s_add_u32 s13, s13, 8192
 ds_read_b64_tr_b16 a[238:239], v39 offset:59392
 ds_read_b64_tr_b16 a[252:253], v39 offset:61440
 v_mfma_f32_16x16x32_bf16 v[204:207], a[76:79], a[12:15], v[204:207]
 ds_read_b64_tr_b16 a[254:255], v39 offset:63488
 v_mfma_f32_16x16x32_bf16 v[200:203], a[76:79], a[8:11], v[200:203]
 buffer_load_dwordx4 a[128:131], v1, s[24:27], s13 offen sc1
 v_mfma_f32_16x16x32_bf16 v[200:203], a[60:63], a[0:3], v[200:203]
 v_mfma_f32_16x16x32_bf16 v[200:203], a[44:47], a[88:91], v[200:203]
 v_mfma_f32_16x16x32_bf16 v[200:203], a[28:31], a[80:83], v[200:203]
 v_add_u32 v36, 0xfffec000, v36
 v_add_u32 v37, 0xfffec000, v37
 v_add_u32 v38, 0xfffec000, v38
 v_add_u32 v39, 0xfffec000, v39
 s_waitcnt vmcnt(13) lgkmcnt(0)
 v_mfma_f32_16x16x32_bf16 v[176:179], a[192:195], a[96:99], v[176:179]
 s_barrier
 ds_read_b64_tr_b16 a[16:17], v36 offset:32768
 ds_read_b64_tr_b16 a[18:19], v36 offset:34816
 v_mfma_f32_16x16x32_bf16 v[176:179], a[208:211], a[104:107], v[176:179]
 ds_read_b64_tr_b16 a[32:33], v36 offset:36864
 ds_read_b64_tr_b16 a[34:35], v36 offset:38912
 v_mfma_f32_16x16x32_bf16 v[176:179], a[224:227], a[144:147], v[176:179]
 buffer_load_dwordx4 a[132:135], v1, s[24:27], s13 offen offset:1024 sc1
 v_mfma_f32_16x16x32_bf16 v[176:179], a[240:243], a[152:155], v[176:179]
 ds_read_b64_tr_b16 a[48:49], v36 offset:40960
 v_mfma_f32_16x16x32_bf16 v[180:183], a[240:243], a[156:159], v[180:183]
 ds_read_b64_tr_b16 a[50:51], v36 offset:43008
 ds_read_b64_tr_b16 a[64:65], v36 offset:45056
 v_mfma_f32_16x16x32_bf16 v[180:183], a[224:227], a[148:151], v[180:183]
 buffer_load_dwordx4 a[136:139], v1, s[24:27], s13 offen offset:2048 sc1
 v_mfma_f32_16x16x32_bf16 v[180:183], a[208:211], a[108:111], v[180:183]
 ds_read_b64_tr_b16 a[66:67], v36 offset:47104
 v_mfma_f32_16x16x32_bf16 v[180:183], a[192:195], a[100:103], v[180:183]
 ds_read_b64_tr_b16 a[20:21], v37 offset:32768
 ds_read_b64_tr_b16 a[22:23], v37 offset:34816
 v_mfma_f32_16x16x32_bf16 v[188:191], a[196:199], a[100:103], v[188:191]
 ds_read_b64_tr_b16 a[36:37], v37 offset:36864
 ds_read_b64_tr_b16 a[38:39], v37 offset:38912
 v_mfma_f32_16x16x32_bf16 v[188:191], a[212:215], a[108:111], v[188:191]
 buffer_load_dwordx4 a[140:143], v1, s[24:27], s13 offen offset:3072 sc1
 v_mfma_f32_16x16x32_bf16 v[188:191], a[228:231], a[148:151], v[188:191]
 ds_read_b64_tr_b16 a[52:53], v37 offset:40960
 v_mfma_f32_16x16x32_bf16 v[188:191], a[244:247], a[156:159], v[188:191]
 ds_read_b64_tr_b16 a[54:55], v37 offset:43008
 ds_read_b64_tr_b16 a[68:69], v37 offset:45056
 v_mfma_f32_16x16x32_bf16 v[184:187], a[244:247], a[152:155], v[184:187]
 buffer_load_dwordx4 a[176:179], v40, s[24:27], s13 offen sc1
 v_mfma_f32_16x16x32_bf16 v[184:187], a[228:231], a[144:147], v[184:187]
 ds_read_b64_tr_b16 a[70:71], v37 offset:47104
 v_mfma_f32_16x16x32_bf16 v[184:187], a[212:215], a[104:107], v[184:187]
 ds_read_b64_tr_b16 a[24:25], v38 offset:32768
 ds_read_b64_tr_b16 a[26:27], v38 offset:34816
 v_mfma_f32_16x16x32_bf16 v[184:187], a[196:199], a[96:99], v[184:187]
 ds_read_b64_tr_b16 a[40:41], v38 offset:36864
 ds_read_b64_tr_b16 a[42:43], v38 offset:38912
 v_mfma_f32_16x16x32_bf16 v[192:195], a[200:203], a[96:99], v[192:195]
 buffer_load_dwordx4 a[180:183], v40, s[24:27], s13 offen offset:1024 sc1
 v_mfma_f32_16x16x32_bf16 v[192:195], a[216:219], a[104:107], v[192:195]
 ds_read_b64_tr_b16 a[56:57], v38 offset:40960
 v_mfma_f32_16x16x32_bf16 v[192:195], a[232:235], a[144:147], v[192:195]
 ds_read_b64_tr_b16 a[58:59], v38 offset:43008
 ds_read_b64_tr_b16 a[72:73], v38 offset:45056
 v_mfma_f32_16x16x32_bf16 v[192:195], a[248:251], a[152:155], v[192:195]
 ds_read_b64_tr_b16 a[74:75], v38 offset:47104
 v_mfma_f32_16x16x32_bf16 v[196:199], a[248:251], a[156:159], v[196:199]
 buffer_load_dwordx4 a[184:187], v40, s[24:27], s13 offen offset:2048 sc1
 v_mfma_f32_16x16x32_bf16 v[196:199], a[232:235], a[148:151], v[196:199]
 ds_read_b64_tr_b16 a[28:29], v39 offset:32768
 ds_read_b64_tr_b16 a[30:31], v39 offset:34816
 v_mfma_f32_16x16x32_bf16 v[196:199], a[216:219], a[108:111], v[196:199]
 ds_read_b64_tr_b16 a[44:45], v39 offset:36864
 ds_read_b64_tr_b16 a[46:47], v39 offset:38912
 v_mfma_f32_16x16x32_bf16 v[196:199], a[200:203], a[100:103], v[196:199]
 buffer_load_dwordx4 a[188:191], v40, s[24:27], s13 offen offset:3072 sc1
 v_mfma_f32_16x16x32_bf16 v[204:207], a[204:207], a[100:103], v[204:207]
 s_add_u32 s13, s13, 8192
 ds_read_b64_tr_b16 a[60:61], v39 offset:40960
 v_mfma_f32_16x16x32_bf16 v[204:207], a[220:223], a[108:111], v[204:207]
 ds_read_b64_tr_b16 a[62:63], v39 offset:43008
 ds_read_b64_tr_b16 a[76:77], v39 offset:45056
 v_mfma_f32_16x16x32_bf16 v[204:207], a[236:239], a[148:151], v[204:207]
 ds_read_b64_tr_b16 a[78:79], v39 offset:47104
 v_mfma_f32_16x16x32_bf16 v[204:207], a[252:255], a[156:159], v[204:207]
 buffer_load_dwordx4 a[80:83], v1, s[24:27], s13 offen sc1
 v_mfma_f32_16x16x32_bf16 v[200:203], a[252:255], a[152:155], v[200:203]
 v_mfma_f32_16x16x32_bf16 v[200:203], a[236:239], a[144:147], v[200:203]
 v_mfma_f32_16x16x32_bf16 v[200:203], a[220:223], a[104:107], v[200:203]
 v_mfma_f32_16x16x32_bf16 v[200:203], a[204:207], a[96:99], v[200:203]
 s_waitcnt vmcnt(9) lgkmcnt(0)
 v_mfma_f32_16x16x32_bf16 v[176:179], a[16:19], a[112:115], v[176:179]
 s_barrier
 ds_read_b64_tr_b16 a[192:193], v36 offset:49152
 ds_read_b64_tr_b16 a[194:195], v36 offset:51200
 ds_read_b64_tr_b16 a[208:209], v36 offset:53248
 v_mfma_f32_16x16x32_bf16 v[176:179], a[32:35], a[120:123], v[176:179]
 buffer_load_dwordx4 v[64:67], v1, s[24:27], s65 offen sc1
 v_mfma_f32_16x16x32_bf16 v[176:179], a[48:51], a[160:163], v[176:179]
 buffer_load_dwordx4 v[68:71], v1, s[24:27], s65 offen offset:1024 sc1
 v_mfma_f32_16x16x32_bf16 v[176:179], a[64:67], a[168:171], v[176:179]
 buffer_load_dwordx4 v[72:75], v1, s[24:27], s65 offen offset:2048 sc1
 v_mfma_f32_16x16x32_bf16 v[180:183], a[64:67], a[172:175], v[180:183]
 s_add_u32 s15, s17, 1835008
 buffer_load_dwordx4 v[76:79], v1, s[24:27], s65 offen offset:3072 sc1
 v_mfma_f32_16x16x32_bf16 v[180:183], a[48:51], a[164:167], v[180:183]
 s_add_u32 m0, s18, 16384
 ds_read_b64_tr_b16 a[210:211], v36 offset:55296
 ds_read_b64_tr_b16 a[224:225], v36 offset:57344
 v_mfma_f32_16x16x32_bf16 v[180:183], a[32:35], a[124:127], v[180:183]
 buffer_load_dwordx4 v8, s[32:35], s15 offen lds
 v_mfma_f32_16x16x32_bf16 v[180:183], a[16:19], a[116:119], v[180:183]
 ds_read_b64_tr_b16 a[226:227], v36 offset:59392
 ds_read_b64_tr_b16 a[240:241], v36 offset:61440
 v_mfma_f32_16x16x32_bf16 v[188:191], a[20:23], a[116:119], v[188:191]
 buffer_load_dwordx4 a[84:87], v1, s[24:27], s13 offen offset:1024 sc1
 v_mfma_f32_16x16x32_bf16 v[188:191], a[36:39], a[124:127], v[188:191]
 s_add_u32 m0, s18, 17408
 ds_read_b64_tr_b16 a[242:243], v36 offset:63488
 ds_read_b64_tr_b16 a[196:197], v37 offset:49152
 ds_read_b64_tr_b16 a[198:199], v37 offset:51200
 v_mfma_f32_16x16x32_bf16 v[188:191], a[52:55], a[164:167], v[188:191]
 buffer_load_dwordx4 v9, s[32:35], s15 offen lds
 v_mfma_f32_16x16x32_bf16 v[188:191], a[68:71], a[172:175], v[188:191]
 ds_read_b64_tr_b16 a[212:213], v37 offset:53248
 ds_read_b64_tr_b16 a[214:215], v37 offset:55296
 v_mfma_f32_16x16x32_bf16 v[184:187], a[68:71], a[168:171], v[184:187]
 buffer_load_dwordx4 a[88:91], v1, s[24:27], s13 offen offset:2048 sc1
 v_mfma_f32_16x16x32_bf16 v[184:187], a[52:55], a[160:163], v[184:187]
 ds_read_b64_tr_b16 a[228:229], v37 offset:57344
 ds_read_b64_tr_b16 a[230:231], v37 offset:59392
 v_mfma_f32_16x16x32_bf16 v[184:187], a[36:39], a[120:123], v[184:187]
 ds_read_b64_tr_b16 a[244:245], v37 offset:61440
 ds_read_b64_tr_b16 a[246:247], v37 offset:63488
 v_mfma_f32_16x16x32_bf16 v[184:187], a[20:23], a[112:115], v[184:187]
 buffer_load_dwordx4 a[92:95], v1, s[24:27], s13 offen offset:3072 sc1
 v_mfma_f32_16x16x32_bf16 v[192:195], a[24:27], a[112:115], v[192:195]
 s_add_u32 m0, s18, 18432
 ds_read_b64_tr_b16 a[200:201], v38 offset:49152
 ds_read_b64_tr_b16 a[202:203], v38 offset:51200
 ds_read_b64_tr_b16 a[216:217], v38 offset:53248
 v_mfma_f32_16x16x32_bf16 v[192:195], a[40:43], a[120:123], v[192:195]
 buffer_load_dwordx4 v10, s[32:35], s15 offen lds
 v_mfma_f32_16x16x32_bf16 v[192:195], a[56:59], a[160:163], v[192:195]
 ds_read_b64_tr_b16 a[218:219], v38 offset:55296
 ds_read_b64_tr_b16 a[232:233], v38 offset:57344
 v_mfma_f32_16x16x32_bf16 v[192:195], a[72:75], a[168:171], v[192:195]
 buffer_load_dwordx4 a[0:3], v40, s[24:27], s13 offen sc1
 v_mfma_f32_16x16x32_bf16 v[196:199], a[72:75], a[172:175], v[196:199]
 ds_read_b64_tr_b16 a[234:235], v38 offset:59392
 ds_read_b64_tr_b16 a[248:249], v38 offset:61440
 v_mfma_f32_16x16x32_bf16 v[196:199], a[56:59], a[164:167], v[196:199]
 buffer_load_dwordx4 a[4:7], v40, s[24:27], s13 offen offset:1024 sc1
 v_mfma_f32_16x16x32_bf16 v[196:199], a[40:43], a[124:127], v[196:199]
 ds_read_b64_tr_b16 a[250:251], v38 offset:63488
 ds_read_b64_tr_b16 a[204:205], v39 offset:49152
 ds_read_b64_tr_b16 a[206:207], v39 offset:51200
 v_mfma_f32_16x16x32_bf16 v[196:199], a[24:27], a[116:119], v[196:199]
 s_add_u32 m0, s18, 19456
 ds_read_b64_tr_b16 a[220:221], v39 offset:53248
 ds_read_b64_tr_b16 a[222:223], v39 offset:55296
 v_mfma_f32_16x16x32_bf16 v[204:207], a[28:31], a[116:119], v[204:207]
 buffer_load_dwordx4 v11, s[32:35], s15 offen lds
 v_mfma_f32_16x16x32_bf16 v[204:207], a[44:47], a[124:127], v[204:207]
 ds_read_b64_tr_b16 a[236:237], v39 offset:57344
 ds_read_b64_tr_b16 a[238:239], v39 offset:59392
 v_mfma_f32_16x16x32_bf16 v[204:207], a[60:63], a[164:167], v[204:207]
 buffer_load_dwordx4 a[8:11], v40, s[24:27], s13 offen offset:2048 sc1
 v_mfma_f32_16x16x32_bf16 v[204:207], a[76:79], a[172:175], v[204:207]
 ds_read_b64_tr_b16 a[252:253], v39 offset:61440
 ds_read_b64_tr_b16 a[254:255], v39 offset:63488
 v_mfma_f32_16x16x32_bf16 v[200:203], a[76:79], a[168:171], v[200:203]
 buffer_load_dwordx4 a[12:15], v40, s[24:27], s13 offen offset:3072 sc1
 v_mfma_f32_16x16x32_bf16 v[200:203], a[60:63], a[160:163], v[200:203]
 s_add_u32 s13, s13, 8192
 v_mfma_f32_16x16x32_bf16 v[200:203], a[44:47], a[120:123], v[200:203]
 v_mfma_f32_16x16x32_bf16 v[200:203], a[28:31], a[112:115], v[200:203]
 s_waitcnt vmcnt(16) lgkmcnt(0)
 v_mfma_f32_16x16x32_bf16 v[176:179], a[192:195], a[128:131], v[176:179]
 s_barrier
 ds_read_b64_tr_b16 a[16:17], v36 offset:0
 ds_read_b64_tr_b16 a[18:19], v36 offset:2048
 v_mfma_f32_16x16x32_bf16 v[176:179], a[208:211], a[136:139], v[176:179]
 ds_read_b64_tr_b16 a[32:33], v36 offset:4096
 ds_read_b64_tr_b16 a[34:35], v36 offset:6144
 v_mfma_f32_16x16x32_bf16 v[176:179], a[224:227], a[176:179], v[176:179]
 buffer_load_dwordx4 a[96:99], v1, s[24:27], s13 offen sc1
 v_mfma_f32_16x16x32_bf16 v[176:179], a[240:243], a[184:187], v[176:179]
 ds_read_b64_tr_b16 a[48:49], v36 offset:8192
 v_mfma_f32_16x16x32_bf16 v[180:183], a[240:243], a[188:191], v[180:183]
 ds_read_b64_tr_b16 a[50:51], v36 offset:10240
 ds_read_b64_tr_b16 a[64:65], v36 offset:12288
 v_mfma_f32_16x16x32_bf16 v[180:183], a[224:227], a[180:183], v[180:183]
 buffer_load_dwordx4 a[100:103], v1, s[24:27], s13 offen offset:1024 sc1
 v_mfma_f32_16x16x32_bf16 v[180:183], a[208:211], a[140:143], v[180:183]
 ds_read_b64_tr_b16 a[66:67], v36 offset:14336
 v_mfma_f32_16x16x32_bf16 v[180:183], a[192:195], a[132:135], v[180:183]
 ds_read_b64_tr_b16 a[20:21], v37 offset:0
 ds_read_b64_tr_b16 a[22:23], v37 offset:2048
 v_mfma_f32_16x16x32_bf16 v[188:191], a[196:199], a[132:135], v[188:191]
 ds_read_b64_tr_b16 a[36:37], v37 offset:4096
 ds_read_b64_tr_b16 a[38:39], v37 offset:6144
 v_mfma_f32_16x16x32_bf16 v[188:191], a[212:215], a[140:143], v[188:191]
 buffer_load_dwordx4 a[104:107], v1, s[24:27], s13 offen offset:2048 sc1
 v_mfma_f32_16x16x32_bf16 v[188:191], a[228:231], a[180:183], v[188:191]
 ds_read_b64_tr_b16 a[52:53], v37 offset:8192
 v_mfma_f32_16x16x32_bf16 v[188:191], a[244:247], a[188:191], v[188:191]
 ds_read_b64_tr_b16 a[54:55], v37 offset:10240
 ds_read_b64_tr_b16 a[68:69], v37 offset:12288
 v_mfma_f32_16x16x32_bf16 v[184:187], a[244:247], a[184:187], v[184:187]
 buffer_load_dwordx4 a[108:111], v1, s[24:27], s13 offen offset:3072 sc1
 v_mfma_f32_16x16x32_bf16 v[184:187], a[228:231], a[176:179], v[184:187]
 ds_read_b64_tr_b16 a[70:71], v37 offset:14336
 v_mfma_f32_16x16x32_bf16 v[184:187], a[212:215], a[136:139], v[184:187]
 ds_read_b64_tr_b16 a[24:25], v38 offset:0
 ds_read_b64_tr_b16 a[26:27], v38 offset:2048
 v_mfma_f32_16x16x32_bf16 v[184:187], a[196:199], a[128:131], v[184:187]
 ds_read_b64_tr_b16 a[40:41], v38 offset:4096
 ds_read_b64_tr_b16 a[42:43], v38 offset:6144
 v_mfma_f32_16x16x32_bf16 v[192:195], a[200:203], a[128:131], v[192:195]
 buffer_load_dwordx4 a[144:147], v40, s[24:27], s13 offen sc1
 v_mfma_f32_16x16x32_bf16 v[192:195], a[216:219], a[136:139], v[192:195]
 ds_read_b64_tr_b16 a[56:57], v38 offset:8192
 v_mfma_f32_16x16x32_bf16 v[192:195], a[232:235], a[176:179], v[192:195]
 ds_read_b64_tr_b16 a[58:59], v38 offset:10240
 ds_read_b64_tr_b16 a[72:73], v38 offset:12288
 v_mfma_f32_16x16x32_bf16 v[192:195], a[248:251], a[184:187], v[192:195]
 ds_read_b64_tr_b16 a[74:75], v38 offset:14336
 v_mfma_f32_16x16x32_bf16 v[196:199], a[248:251], a[188:191], v[196:199]
 buffer_load_dwordx4 a[148:151], v40, s[24:27], s13 offen offset:1024 sc1
 v_mfma_f32_16x16x32_bf16 v[196:199], a[232:235], a[180:183], v[196:199]
 ds_read_b64_tr_b16 a[28:29], v39 offset:0
 ds_read_b64_tr_b16 a[30:31], v39 offset:2048
 v_mfma_f32_16x16x32_bf16 v[196:199], a[216:219], a[140:143], v[196:199]
 ds_read_b64_tr_b16 a[44:45], v39 offset:4096
 ds_read_b64_tr_b16 a[46:47], v39 offset:6144
 v_mfma_f32_16x16x32_bf16 v[196:199], a[200:203], a[132:135], v[196:199]
 buffer_load_dwordx4 a[152:155], v40, s[24:27], s13 offen offset:2048 sc1
 v_mfma_f32_16x16x32_bf16 v[204:207], a[204:207], a[132:135], v[204:207]
 ds_read_b64_tr_b16 a[60:61], v39 offset:8192
 v_mfma_f32_16x16x32_bf16 v[204:207], a[220:223], a[140:143], v[204:207]
 ds_read_b64_tr_b16 a[62:63], v39 offset:10240
 ds_read_b64_tr_b16 a[76:77], v39 offset:12288
 v_mfma_f32_16x16x32_bf16 v[204:207], a[236:239], a[180:183], v[204:207]
 ds_read_b64_tr_b16 a[78:79], v39 offset:14336
 v_mfma_f32_16x16x32_bf16 v[204:207], a[252:255], a[188:191], v[204:207]
 buffer_load_dwordx4 a[156:159], v40, s[24:27], s13 offen offset:3072 sc1
 v_mfma_f32_16x16x32_bf16 v[200:203], a[252:255], a[184:187], v[200:203]
 s_add_u32 s13, s13, 8192
 v_mfma_f32_16x16x32_bf16 v[200:203], a[236:239], a[176:179], v[200:203]
 v_mfma_f32_16x16x32_bf16 v[200:203], a[220:223], a[136:139], v[200:203]
 v_mfma_f32_16x16x32_bf16 v[200:203], a[204:207], a[128:131], v[200:203]
 s_waitcnt vmcnt(8) lgkmcnt(0)
 v_mfma_f32_16x16x32_bf16 v[176:179], a[16:19], a[80:83], v[176:179]
 s_barrier
 ds_read_b64_tr_b16 a[192:193], v36 offset:16384
 v_max3_u32 v4, v64, v65, v66
 v_mfma_f32_16x16x32_bf16 v[176:179], a[32:35], a[88:91], v[176:179]
 s_mov_b32 s6, 0xbfb8aa3b
 ds_read_b64_tr_b16 a[194:195], v36 offset:18432
 v_max3_u32 v5, v67, v68, v69
 v_mfma_f32_16x16x32_bf16 v[176:179], a[48:51], a[0:3], v[176:179]
 ds_read_b64_tr_b16 a[208:209], v36 offset:20480
 v_max3_u32 v4, v4, v70, v71
 v_mfma_f32_16x16x32_bf16 v[176:179], a[64:67], a[8:11], v[176:179]
 ds_read_b64_tr_b16 a[210:211], v36 offset:22528
 v_max3_u32 v5, v5, v72, v73
 v_mfma_f32_16x16x32_bf16 v[180:183], a[64:67], a[12:15], v[180:183]
 ds_read_b64_tr_b16 a[224:225], v36 offset:24576
 v_max3_u32 v4, v4, v74, v75
 v_mfma_f32_16x16x32_bf16 v[180:183], a[48:51], a[4:7], v[180:183]
 ds_read_b64_tr_b16 a[226:227], v36 offset:26624
 v_max3_u32 v5, v5, v76, v77
 v_mfma_f32_16x16x32_bf16 v[180:183], a[32:35], a[92:95], v[180:183]
 ds_read_b64_tr_b16 a[240:241], v36 offset:28672
 v_max3_u32 v4, v4, v78, v79
 v_mfma_f32_16x16x32_bf16 v[180:183], a[16:19], a[84:87], v[180:183]
 ds_read_b64_tr_b16 a[242:243], v36 offset:30720
 v_max_u32 v4, v4, v5
 v_mfma_f32_16x16x32_bf16 v[188:191], a[20:23], a[84:87], v[188:191]
 v_cmp_eq_u32 vcc, -1, v4
 v_mfma_f32_16x16x32_bf16 v[188:191], a[36:39], a[92:95], v[188:191]
 ds_read_b64_tr_b16 a[196:197], v37 offset:16384
 v_mfma_f32_16x16x32_bf16 v[188:191], a[52:55], a[4:7], v[188:191]
 ds_read_b64_tr_b16 a[198:199], v37 offset:18432
 s_cbranch_vccnz L_xb1_s
L_xb1_d:
 v_mfma_f32_16x16x32_bf16 v[144:147], v[14:17], v[64:67], v[144:147]
 ds_read_b64_tr_b16 a[212:213], v37 offset:20480
 v_mfma_f32_16x16x32_bf16 v[152:155], v[12:15], v[64:67], v[152:155]
 ds_read_b64_tr_b16 a[214:215], v37 offset:22528
 v_mfma_f32_16x16x32_bf16 v[148:151], v[14:17], v[72:75], v[148:151]
 ds_read_b64_tr_b16 a[228:229], v37 offset:24576
 v_mfma_f32_16x16x32_bf16 v[156:159], v[12:15], v[72:75], v[156:159]
 ds_read_b64_tr_b16 a[230:231], v37 offset:26624
 v_mfma_f32_16x16x32_bf16 v[160:163], v[14:17], v[68:71], v[160:163]
 ds_read_b64_tr_b16 a[244:245], v37 offset:28672
 v_mfma_f32_16x16x32_bf16 v[168:171], v[12:15], v[68:71], v[168:171]
 ds_read_b64_tr_b16 a[246:247], v37 offset:30720
 v_mfma_f32_16x16x32_bf16 v[164:167], v[14:17], v[76:79], v[164:167]
 v_mfma_f32_16x16x32_bf16 v[172:175], v[12:15], v[76:79], v[172:175]
 ds_read_b64_tr_b16 a[200:201], v38 offset:16384
 v_mfma_f32_16x16x32_bf16 v[188:191], a[68:71], a[12:15], v[188:191]
 ds_read_b64_tr_b16 a[202:203], v38 offset:18432
 v_mul_f32 v112, s6, v144
 v_mul_f32 v113, s6, v145
 v_mfma_f32_16x16x32_bf16 v[184:187], a[68:71], a[8:11], v[184:187]
 ds_read_b64_tr_b16 a[216:217], v38 offset:20480
 v_mul_f32 v114, s6, v146
 v_mul_f32 v115, s6, v147
 v_mfma_f32_16x16x32_bf16 v[184:187], a[52:55], a[0:3], v[184:187]
 ds_read_b64_tr_b16 a[218:219], v38 offset:22528
 v_mul_f32 v120, s6, v152
 v_mul_f32 v121, s6, v153
 v_mfma_f32_16x16x32_bf16 v[184:187], a[36:39], a[88:91], v[184:187]
 ds_read_b64_tr_b16 a[232:233], v38 offset:24576
 v_mul_f32 v122, s6, v154
 v_mul_f32 v123, s6, v155
 v_mfma_f32_16x16x32_bf16 v[184:187], a[20:23], a[80:83], v[184:187]
 ds_read_b64_tr_b16 a[234:235], v38 offset:26624
 v_exp_f32 v112, v112
 v_mfma_f32_16x16x32_bf16 v[192:195], a[24:27], a[80:83], v[192:195]
 ds_read_b64_tr_b16 a[248:249], v38 offset:28672
 v_exp_f32 v113, v113
 v_mfma_f32_16x16x32_bf16 v[192:195], a[40:43], a[88:91], v[192:195]
 ds_read_b64_tr_b16 a[250:251], v38 offset:30720
 v_exp_f32 v114, v114
 v_mfma_f32_16x16x32_bf16 v[192:195], a[56:59], a[0:3], v[192:195]
 v_exp_f32 v115, v115
 v_exp_f32 v120, v120
 v_mfma_f32_16x16x32_bf16 v[192:195], a[72:75], a[8:11], v[192:195]
 ds_read_b64_tr_b16 a[204:205], v39 offset:16384
 v_exp_f32 v121, v121
 v_mfma_f32_16x16x32_bf16 v[196:199], a[72:75], a[12:15], v[196:199]
 ds_read_b64_tr_b16 a[206:207], v39 offset:18432
 v_exp_f32 v122, v122
 v_mfma_f32_16x16x32_bf16 v[196:199], a[56:59], a[4:7], v[196:199]
 ds_read_b64_tr_b16 a[220:221], v39 offset:20480
 v_exp_f32 v123, v123
 v_mfma_f32_16x16x32_bf16 v[196:199], a[40:43], a[92:95], v[196:199]
 ds_read_b64_tr_b16 a[222:223], v39 offset:22528
 v_add_f32 v112, 1.0, v112
 v_add_f32 v113, 1.0, v113
 v_mfma_f32_16x16x32_bf16 v[196:199], a[24:27], a[84:87], v[196:199]
 ds_read_b64_tr_b16 a[236:237], v39 offset:24576
 v_add_f32 v114, 1.0, v114
 v_add_f32 v115, 1.0, v115
 v_mfma_f32_16x16x32_bf16 v[204:207], a[28:31], a[84:87], v[204:207]
 ds_read_b64_tr_b16 a[238:239], v39 offset:26624
 v_add_f32 v120, 1.0, v120
 v_add_f32 v121, 1.0, v121
 v_mfma_f32_16x16x32_bf16 v[204:207], a[44:47], a[92:95], v[204:207]
 ds_read_b64_tr_b16 a[252:253], v39 offset:28672
 v_add_f32 v122, 1.0, v122
 v_add_f32 v123, 1.0, v123
 v_mfma_f32_16x16x32_bf16 v[204:207], a[60:63], a[4:7], v[204:207]
 ds_read_b64_tr_b16 a[254:255], v39 offset:30720
 v_rcp_f32 v112, v112
 v_mfma_f32_16x16x32_bf16 v[204:207], a[76:79], a[12:15], v[204:207]
 v_rcp_f32 v113, v113
 v_rcp_f32 v114, v114
 v_mfma_f32_16x16x32_bf16 v[200:203], a[76:79], a[8:11], v[200:203]
 v_rcp_f32 v115, v115
 v_mfma_f32_16x16x32_bf16 v[200:203], a[60:63], a[0:3], v[200:203]
 v_rcp_f32 v120, v120
 v_rcp_f32 v121, v121
 v_mfma_f32_16x16x32_bf16 v[200:203], a[44:47], a[88:91], v[200:203]
 v_rcp_f32 v122, v122
 v_mfma_f32_16x16x32_bf16 v[200:203], a[28:31], a[80:83], v[200:203]
 v_rcp_f32 v123, v123
 v_mul_f32 v144, v144, v112
 v_mul_f32 v145, v145, v113
 s_waitcnt vmcnt(0) lgkmcnt(0)
 v_mfma_f32_16x16x32_bf16 v[176:179], a[192:195], a[96:99], v[176:179]
 v_mul_f32 v146, v146, v114
 v_mul_f32 v147, v147, v115
 v_mul_f32 v152, v152, v120
 v_mfma_f32_16x16x32_bf16 v[176:179], a[208:211], a[104:107], v[176:179]
 v_mul_f32 v153, v153, v121
 v_mul_f32 v154, v154, v122
 v_mul_f32 v155, v155, v123
 v_mfma_f32_16x16x32_bf16 v[176:179], a[224:227], a[144:147], v[176:179]
 v_mul_f32 v116, s6, v148
 v_mul_f32 v117, s6, v149
 v_mul_f32 v118, s6, v150
 v_mfma_f32_16x16x32_bf16 v[176:179], a[240:243], a[152:155], v[176:179]
 v_mul_f32 v119, s6, v151
 v_mul_f32 v124, s6, v156
 v_mul_f32 v125, s6, v157
 v_mfma_f32_16x16x32_bf16 v[180:183], a[240:243], a[156:159], v[180:183]
 v_mul_f32 v126, s6, v158
 v_mul_f32 v127, s6, v159
 v_exp_f32 v116, v116
 v_mfma_f32_16x16x32_bf16 v[180:183], a[224:227], a[148:151], v[180:183]
 v_exp_f32 v117, v117
 v_mfma_f32_16x16x32_bf16 v[180:183], a[208:211], a[108:111], v[180:183]
 v_exp_f32 v118, v118
 v_exp_f32 v119, v119
 v_mfma_f32_16x16x32_bf16 v[180:183], a[192:195], a[100:103], v[180:183]
 v_exp_f32 v124, v124
 v_mfma_f32_16x16x32_bf16 v[188:191], a[196:199], a[100:103], v[188:191]
 v_exp_f32 v125, v125
 v_exp_f32 v126, v126
 v_mfma_f32_16x16x32_bf16 v[188:191], a[212:215], a[108:111], v[188:191]
 v_exp_f32 v127, v127
 v_add_f32 v116, 1.0, v116
 v_mfma_f32_16x16x32_bf16 v[188:191], a[228:231], a[148:151], v[188:191]
 v_add_f32 v117, 1.0, v117
 v_add_f32 v118, 1.0, v118
 v_add_f32 v119, 1.0, v119
 v_mfma_f32_16x16x32_bf16 v[188:191], a[244:247], a[156:159], v[188:191]
 v_add_f32 v124, 1.0, v124
 v_add_f32 v125, 1.0, v125
 v_add_f32 v126, 1.0, v126
 v_mfma_f32_16x16x32_bf16 v[184:187], a[244:247], a[152:155], v[184:187]
 v_add_f32 v127, 1.0, v127
 v_rcp_f32 v116, v116
 v_mfma_f32_16x16x32_bf16 v[184:187], a[228:231], a[144:147], v[184:187]
 v_rcp_f32 v117, v117
 v_rcp_f32 v118, v118
 v_mfma_f32_16x16x32_bf16 v[184:187], a[212:215], a[104:107], v[184:187]
 v_rcp_f32 v119, v119
 v_mfma_f32_16x16x32_bf16 v[184:187], a[196:199], a[96:99], v[184:187]
 v_rcp_f32 v124, v124
 v_rcp_f32 v125, v125
 v_mfma_f32_16x16x32_bf16 v[192:195], a[200:203], a[96:99], v[192:195]
 v_rcp_f32 v126, v126
 v_mfma_f32_16x16x32_bf16 v[192:195], a[216:219], a[104:107], v[192:195]
 v_rcp_f32 v127, v127
 v_mul_f32 v148, v148, v116
 v_mul_f32 v149, v149, v117
 v_mfma_f32_16x16x32_bf16 v[192:195], a[232:235], a[144:147], v[192:195]
 v_mul_f32 v150, v150, v118
 v_mul_f32 v151, v151, v119
 v_mul_f32 v156, v156, v124
 v_mfma_f32_16x16x32_bf16 v[192:195], a[248:251], a[152:155], v[192:195]
 v_mul_f32 v157, v157, v125
 v_mul_f32 v158, v158, v126
 v_mul_f32 v159, v159, v127
 v_mfma_f32_16x16x32_bf16 v[196:199], a[248:251], a[156:159], v[196:199]
 v_fma_f32 v176, v176, v144, v208
 v_fma_f32 v177, v177, v145, v209
 v_fma_f32 v178, v178, v146, v210
 v_mfma_f32_16x16x32_bf16 v[196:199], a[232:235], a[148:151], v[196:199]
 v_fma_f32 v179, v179, v147, v211
 v_fma_f32 v184, v184, v152, v216
 v_mfma_f32_16x16x32_bf16 v[196:199], a[216:219], a[108:111], v[196:199]
 v_fma_f32 v185, v185, v153, v217
 v_fma_f32 v186, v186, v154, v218
 v_fma_f32 v187, v187, v155, v219
 v_mfma_f32_16x16x32_bf16 v[196:199], a[200:203], a[100:103], v[196:199]
 v_cvt_pk_bf16_f32 v80, v176, v177
 v_cvt_pk_bf16_f32 v81, v178, v179
 v_mfma_f32_16x16x32_bf16 v[204:207], a[204:207], a[100:103], v[204:207]
 v_cvt_pk_bf16_f32 v82, v184, v185
 v_cvt_pk_bf16_f32 v83, v186, v187
 v_fma_f32 v180, v180, v148, v212
 v_mfma_f32_16x16x32_bf16 v[204:207], a[220:223], a[108:111], v[204:207]
 v_fma_f32 v181, v181, v149, v213
 v_fma_f32 v182, v182, v150, v214
 v_mfma_f32_16x16x32_bf16 v[204:207], a[236:239], a[148:151], v[204:207]
 v_fma_f32 v183, v183, v151, v215
 v_fma_f32 v188, v188, v156, v220
 v_fma_f32 v189, v189, v157, v221
 v_mfma_f32_16x16x32_bf16 v[204:207], a[252:255], a[156:159], v[204:207]
 v_fma_f32 v190, v190, v158, v222
 v_fma_f32 v191, v191, v159, v223
 v_mfma_f32_16x16x32_bf16 v[200:203], a[252:255], a[152:155], v[200:203]
 v_cvt_pk_bf16_f32 v88, v180, v181
 v_cvt_pk_bf16_f32 v89, v182, v183
 v_cvt_pk_bf16_f32 v90, v188, v189
 v_mfma_f32_16x16x32_bf16 v[200:203], a[236:239], a[144:147], v[200:203]
 v_cvt_pk_bf16_f32 v91, v190, v191
 v_permlane16_swap_b32 v80, v82
 v_mfma_f32_16x16x32_bf16 v[200:203], a[220:223], a[104:107], v[200:203]
 v_permlane16_swap_b32 v81, v83
 v_permlane16_swap_b32 v88, v90
 v_permlane16_swap_b32 v89, v91
 v_mfma_f32_16x16x32_bf16 v[200:203], a[204:207], a[96:99], v[200:203]
 s_nop 0
 buffer_store_dwordx4 v[80:83], v42, s[36:39], s19 offen sc1
 buffer_store_dwordx4 v[88:91], v43, s[36:39], s19 offen sc1
 v_pk_mul_f32 v[128:129], v[160:161], s[6:7] op_sel_hi:[1,0]
 v_pk_mul_f32 v[130:131], v[162:163], s[6:7] op_sel_hi:[1,0]
 v_pk_mul_f32 v[136:137], v[168:169], s[6:7] op_sel_hi:[1,0]
 v_pk_mul_f32 v[138:139], v[170:171], s[6:7] op_sel_hi:[1,0]
 v_exp_f32 v128, v128
 v_exp_f32 v129, v129
 v_exp_f32 v130, v130
 v_exp_f32 v131, v131
 v_exp_f32 v136, v136
 v_exp_f32 v137, v137
 v_exp_f32 v138, v138
 v_exp_f32 v139, v139
 v_pk_add_f32 v[128:129], v[128:129], 1.0 op_sel_hi:[1,0]
 v_pk_add_f32 v[130:131], v[130:131], 1.0 op_sel_hi:[1,0]
 v_pk_add_f32 v[136:137], v[136:137], 1.0 op_sel_hi:[1,0]
 v_pk_add_f32 v[138:139], v[138:139], 1.0 op_sel_hi:[1,0]
 v_rcp_f32 v128, v128
 v_rcp_f32 v129, v129
 v_rcp_f32 v130, v130
 v_rcp_f32 v131, v131
 v_rcp_f32 v136, v136
 v_rcp_f32 v137, v137
 v_rcp_f32 v138, v138
 v_rcp_f32 v139, v139
 v_pk_mul_f32 v[160:161], v[160:161], v[128:129]
 v_pk_mul_f32 v[162:163], v[162:163], v[130:131]
 v_pk_mul_f32 v[168:169], v[168:169], v[136:137]
 v_pk_mul_f32 v[170:171], v[170:171], v[138:139]
 v_pk_mul_f32 v[132:133], v[164:165], s[6:7] op_sel_hi:[1,0]
 v_pk_mul_f32 v[134:135], v[166:167], s[6:7] op_sel_hi:[1,0]
 v_pk_mul_f32 v[140:141], v[172:173], s[6:7] op_sel_hi:[1,0]
 v_pk_mul_f32 v[142:143], v[174:175], s[6:7] op_sel_hi:[1,0]
 v_exp_f32 v132, v132
 v_exp_f32 v133, v133
 v_exp_f32 v134, v134
 v_exp_f32 v135, v135
 v_exp_f32 v140, v140
 v_exp_f32 v141, v141
 v_exp_f32 v142, v142
 v_exp_f32 v143, v143
 v_pk_add_f32 v[132:133], v[132:133], 1.0 op_sel_hi:[1,0]
 v_pk_add_f32 v[134:135], v[134:135], 1.0 op_sel_hi:[1,0]
 v_pk_add_f32 v[140:141], v[140:141], 1.0 op_sel_hi:[1,0]
 v_pk_add_f32 v[142:143], v[142:143], 1.0 op_sel_hi:[1,0]
 v_rcp_f32 v132, v132
 v_rcp_f32 v133, v133
 v_rcp_f32 v134, v134
 v_rcp_f32 v135, v135
 v_rcp_f32 v140, v140
 v_rcp_f32 v141, v141
 v_rcp_f32 v142, v142
 v_rcp_f32 v143, v143
 v_pk_mul_f32 v[164:165], v[164:165], v[132:133]
 v_pk_mul_f32 v[166:167], v[166:167], v[134:135]
 v_pk_mul_f32 v[172:173], v[172:173], v[140:141]
 v_pk_mul_f32 v[174:175], v[174:175], v[142:143]
 v_pk_fma_f32 v[192:193], v[192:193], v[160:161], v[224:225]
 v_pk_fma_f32 v[194:195], v[194:195], v[162:163], v[226:227]
 v_pk_fma_f32 v[200:201], v[200:201], v[168:169], v[232:233]
 v_pk_fma_f32 v[202:203], v[202:203], v[170:171], v[234:235]
 v_cvt_pk_bf16_f32 v84, v192, v193
 v_cvt_pk_bf16_f32 v85, v194, v195
 v_cvt_pk_bf16_f32 v86, v200, v201
 v_cvt_pk_bf16_f32 v87, v202, v203
 v_pk_fma_f32 v[196:197], v[196:197], v[164:165], v[228:229]
 v_pk_fma_f32 v[198:199], v[198:199], v[166:167], v[230:231]
 v_pk_fma_f32 v[204:205], v[204:205], v[172:173], v[236:237]
 v_pk_fma_f32 v[206:207], v[206:207], v[174:175], v[238:239]
 v_cvt_pk_bf16_f32 v92, v196, v197
 s_branch L_tp_L_tail1_3_o
L_tp_L_tail1_3:
 s_nop 0
 s_branch L_tret
 s_nop 0
L_tp_L_tail1_3_o:
 v_cvt_pk_bf16_f32 v93, v198, v199
 v_cvt_pk_bf16_f32 v94, v204, v205
 v_cvt_pk_bf16_f32 v95, v206, v207
 v_permlane16_swap_b32 v84, v86
 v_permlane16_swap_b32 v85, v87
 buffer_store_dwordx4 v[84:87], v42, s[36:39], s19 offen offset:64 sc1
 v_permlane16_swap_b32 v92, v94
 v_permlane16_swap_b32 v93, v95
 buffer_store_dwordx4 v[92:95], v43, s[36:39], s19 offen offset:64 sc1
L_end1:
 s_endpgm
L_gat:
 s_add_u32 s1, s64, 0
 buffer_load_dwordx4 v[48:51], v1, s[24:27], s1 offen sc1
 s_add_u32 s1, s64, 8192
 buffer_load_dwordx4 v[52:55], v1, s[24:27], s1 offen sc1
 s_add_u32 s1, s64, 262144
 buffer_load_dwordx4 v[56:59], v1, s[24:27], s1 offen sc1
 s_add_u32 s1, s64, 270336
 buffer_load_dwordx4 v[60:63], v1, s[24:27], s1 offen sc1
 s_add_u32 s1, s64, 524288
 buffer_load_dwordx4 v[64:67], v1, s[24:27], s1 offen sc1
 s_add_u32 s1, s64, 532480
 buffer_load_dwordx4 v[68:71], v1, s[24:27], s1 offen sc1
 s_add_u32 s1, s64, 786432
 buffer_load_dwordx4 v[72:75], v1, s[24:27], s1 offen sc1
 s_add_u32 s1, s64, 794624
 buffer_load_dwordx4 v[76:79], v1, s[24:27], s1 offen sc1
 s_add_u32 s1, s64, 32768
 buffer_load_dwordx4 v[80:83], v1, s[24:27], s1 offen sc1
 s_add_u32 s1, s64, 40960
 buffer_load_dwordx4 v[84:87], v1, s[24:27], s1 offen sc1
 s_add_u32 s1, s64, 294912
 buffer_load_dwordx4 v[88:91], v1, s[24:27], s1 offen sc1
 s_add_u32 s1, s64, 303104
 buffer_load_dwordx4 v[92:95], v1, s[24:27], s1 offen sc1
 s_add_u32 s1, s64, 557056
 buffer_load_dwordx4 v[96:99], v1, s[24:27], s1 offen sc1
 s_add_u32 s1, s64, 565248
 buffer_load_dwordx4 v[100:103], v1, s[24:27], s1 offen sc1
 s_add_u32 s1, s64, 819200
 buffer_load_dwordx4 v[104:107], v1, s[24:27], s1 offen sc1
 s_add_u32 s1, s64, 827392
 buffer_load_dwordx4 v[108:111], v1, s[24:27], s1 offen sc1
 s_branch L_gat_d
L_red:
 s_nop 0
 v_max3_u32 v4, v48, v49, v50
 v_max3_u32 v5, v51, v52, v53
 v_max3_u32 v4, v4, v54, v55
 v_max3_u32 v5, v5, v56, v57
 v_max3_u32 v4, v4, v58, v59
 v_max3_u32 v5, v5, v60, v61
 v_max3_u32 v4, v4, v62, v63
 v_max3_u32 v5, v5, v64, v65
 v_max3_u32 v4, v4, v66, v67
 v_max3_u32 v5, v5, v68, v69
 v_max3_u32 v4, v4, v70, v71
 v_max3_u32 v5, v5, v72, v73
 v_max3_u32 v4, v4, v74, v75
 v_max3_u32 v5, v5, v76, v77
 v_max3_u32 v4, v4, v78, v79
 v_max3_u32 v5, v5, v80, v81
 v_max3_u32 v4, v4, v82, v83
 v_max3_u32 v5, v5, v84, v85
 v_max3_u32 v4, v4, v86, v87
 v_max3_u32 v5, v5, v88, v89
 v_max3_u32 v4, v4, v90, v91
 v_max3_u32 v5, v5, v92, v93
 v_max3_u32 v4, v4, v94, v95
 v_max3_u32 v5, v5, v96, v97
 v_max3_u32 v4, v4, v98, v99
 v_max3_u32 v5, v5, v100, v101
 v_max3_u32 v4, v4, v102, v103
 v_max3_u32 v5, v5, v104, v105
 v_max3_u32 v4, v4, v106, v107
 v_max3_u32 v5, v5, v108, v109
 v_max3_u32 v4, v4, v110, v111
 v_max_u32 v4, v4, v5
 v_cmp_eq_u32 vcc, -1, v4
 s_nop 3
 s_cbranch_vccnz L_kvg_s
L_kvg_d:
 v_pk_add_f32 v[48:49], v[48:49], v[80:81]
 v_pk_add_f32 v[50:51], v[50:51], v[82:83]
 v_pk_add_f32 v[52:53], v[52:53], v[84:85]
 v_pk_add_f32 v[54:55], v[54:55], v[86:87]
 v_pk_add_f32 v[56:57], v[56:57], v[88:89]
 v_pk_add_f32 v[58:59], v[58:59], v[90:91]
 v_pk_add_f32 v[60:61], v[60:61], v[92:93]
 v_pk_add_f32 v[62:63], v[62:63], v[94:95]
 v_pk_add_f32 v[64:65], v[64:65], v[96:97]
 v_pk_add_f32 v[66:67], v[66:67], v[98:99]
 v_pk_add_f32 v[68:69], v[68:69], v[100:101]
 v_pk_add_f32 v[70:71], v[70:71], v[102:103]
 v_pk_add_f32 v[72:73], v[72:73], v[104:105]
 v_pk_add_f32 v[74:75], v[74:75], v[106:107]
 v_pk_add_f32 v[76:77], v[76:77], v[108:109]
 v_pk_add_f32 v[78:79], v[78:79], v[110:111]
 v_pk_add_f32 v[48:49], v[48:49], v[64:65]
 v_pk_add_f32 v[50:51], v[50:51], v[66:67]
 v_pk_add_f32 v[52:53], v[52:53], v[68:69]
 v_pk_add_f32 v[54:55], v[54:55], v[70:71]
 v_pk_add_f32 v[56:57], v[56:57], v[72:73]
 v_pk_add_f32 v[58:59], v[58:59], v[74:75]
 v_pk_add_f32 v[60:61], v[60:61], v[76:77]
 v_pk_add_f32 v[62:63], v[62:63], v[78:79]
 v_pk_add_f32 v[48:49], v[48:49], v[56:57]
 v_pk_add_f32 v[50:51], v[50:51], v[58:59]
 v_pk_add_f32 v[52:53], v[52:53], v[60:61]
 v_pk_add_f32 v[54:55], v[54:55], v[62:63]
 v_cvt_pk_bf16_f32 v48, v48, v49
 v_cvt_pk_bf16_f32 v49, v50, v51
 v_cvt_pk_bf16_f32 v50, v52, v53
 v_cvt_pk_bf16_f32 v51, v54, v55
 buffer_store_dwordx4 v[48:51], v1, s[24:27], s54 offen offset:1024 sc1
 s_branch L_red_d
L_kvg_s:
 s_mov_b32 s0, 0
 s_branch L_kvg_r
L_kvg_l:
 s_sleep 8
L_kvg_r:
 s_add_u32 s1, s64, 0
 s_nop 0
 buffer_load_dwordx4 v[48:51], v1, s[24:27], s1 offen sc1
 s_add_u32 s1, s64, 8192
 buffer_load_dwordx4 v[52:55], v1, s[24:27], s1 offen sc1
 s_add_u32 s1, s64, 262144
 buffer_load_dwordx4 v[56:59], v1, s[24:27], s1 offen sc1
 s_add_u32 s1, s64, 270336
 buffer_load_dwordx4 v[60:63], v1, s[24:27], s1 offen sc1
 s_add_u32 s1, s64, 524288
 buffer_load_dwordx4 v[64:67], v1, s[24:27], s1 offen sc1
 s_add_u32 s1, s64, 532480
 buffer_load_dwordx4 v[68:71], v1, s[24:27], s1 offen sc1
 s_add_u32 s1, s64, 786432
 buffer_load_dwordx4 v[72:75], v1, s[24:27], s1 offen sc1
 s_add_u32 s1, s64, 794624
 buffer_load_dwordx4 v[76:79], v1, s[24:27], s1 offen sc1
 s_add_u32 s1, s64, 32768
 buffer_load_dwordx4 v[80:83], v1, s[24:27], s1 offen sc1
 s_add_u32 s1, s64, 40960
 buffer_load_dwordx4 v[84:87], v1, s[24:27], s1 offen sc1
 s_add_u32 s1, s64, 294912
 buffer_load_dwordx4 v[88:91], v1, s[24:27], s1 offen sc1
 s_add_u32 s1, s64, 303104
 buffer_load_dwordx4 v[92:95], v1, s[24:27], s1 offen sc1
 s_add_u32 s1, s64, 557056
 buffer_load_dwordx4 v[96:99], v1, s[24:27], s1 offen sc1
 s_add_u32 s1, s64, 565248
 buffer_load_dwordx4 v[100:103], v1, s[24:27], s1 offen sc1
 s_add_u32 s1, s64, 819200
 buffer_load_dwordx4 v[104:107], v1, s[24:27], s1 offen sc1
 s_add_u32 s1, s64, 827392
 buffer_load_dwordx4 v[108:111], v1, s[24:27], s1 offen sc1
 s_waitcnt vmcnt(0)
 s_nop 0
 v_max3_u32 v4, v48, v49, v50
 v_max3_u32 v5, v51, v52, v53
 v_max3_u32 v4, v4, v54, v55
 v_max3_u32 v5, v5, v56, v57
 v_max3_u32 v4, v4, v58, v59
 v_max3_u32 v5, v5, v60, v61
 v_max3_u32 v4, v4, v62, v63
 v_max3_u32 v5, v5, v64, v65
 v_max3_u32 v4, v4, v66, v67
 v_max3_u32 v5, v5, v68, v69
 v_max3_u32 v4, v4, v70, v71
 v_max3_u32 v5, v5, v72, v73
 v_max3_u32 v4, v4, v74, v75
 v_max3_u32 v5, v5, v76, v77
 v_max3_u32 v4, v4, v78, v79
 v_max3_u32 v5, v5, v80, v81
 v_max3_u32 v4, v4, v82, v83
 v_max3_u32 v5, v5, v84, v85
 v_max3_u32 v4, v4, v86, v87
 v_max3_u32 v5, v5, v88, v89
 v_max3_u32 v4, v4, v90, v91
 v_max3_u32 v5, v5, v92, v93
 v_max3_u32 v4, v4, v94, v95
 v_max3_u32 v5, v5, v96, v97
 v_max3_u32 v4, v4, v98, v99
 v_max3_u32 v5, v5, v100, v101
 v_max3_u32 v4, v4, v102, v103
 v_max3_u32 v5, v5, v104, v105
 v_max3_u32 v4, v4, v106, v107
 v_max3_u32 v5, v5, v108, v109
 v_max3_u32 v4, v4, v110, v111
 v_max_u32 v4, v4, v5
 v_cmp_eq_u32 vcc, -1, v4
 s_add_u32 s0, s0, 1
 s_cmp_ge_u32 s0, 524288
 s_cbranch_scc1 L_kvg_d
 s_nop 1
 s_cbranch_vccnz L_kvg_l
 s_branch L_kvg_d
L_b30_s:
 s_mov_b32 s0, 0
 s_branch L_b30_r
L_b30_l:
 s_sleep 8
L_b30_r:
 buffer_load_dword v47, v24, s[24:27], s60 offen offset:256 sc1
 s_waitcnt vmcnt(0)
 v_cmp_ne_u32 vcc, 1, v47
 s_add_u32 s0, s0, 1
 s_cmp_ge_u32 s0, 524288
 s_cbranch_scc1 L_b30_d
 s_nop 1
 s_cbranch_vccnz L_b30_l
 s_branch L_b30_d
L_fx_s:
 s_mov_b32 s0, 0
 s_branch L_fx_r
L_fx_l:
 s_sleep 8
L_fx_r:
 buffer_load_dword v47, v24, s[24:27], s67 offen offset:256 sc1
 s_waitcnt vmcnt(0)
 v_cmp_ne_u32 vcc, 1, v47
 s_add_u32 s0, s0, 1
 s_cmp_ge_u32 s0, 524288
 s_cbranch_scc1 L_fx_d
 s_nop 1
 s_cbranch_vccnz L_fx_l
 s_branch L_fx_d
L_of0_s:
 s_mov_b32 s0, 0
 s_branch L_of0_r
L_of0_l:
 s_sleep 8
L_of0_r:
 buffer_load_dword v34, v25, s[24:27], s69 offen offset:256 sc1
 buffer_load_dword v35, off, s[24:27], s55 sc1
 s_waitcnt vmcnt(0)
 v_or_b32 v4, v35, v34
 v_cmp_ne_u32 vcc, 1, v4
 s_add_u32 s0, s0, 1
 s_cmp_ge_u32 s0, 524288
 s_cbranch_scc1 L_of0_d
 s_nop 1
 s_cbranch_vccnz L_of0_l
 s_branch L_of0_d
L_xb0_s:
 s_mov_b32 s0, 0
 s_branch L_xb0_r
L_xb0_l:
 s_sleep 8
L_xb0_r:
 buffer_load_dwordx4 v[64:67], v1, s[24:27], s65 offen sc1
 buffer_load_dwordx4 v[68:71], v1, s[24:27], s65 offen offset:1024 sc1
 buffer_load_dwordx4 v[72:75], v1, s[24:27], s65 offen offset:2048 sc1
 buffer_load_dwordx4 v[76:79], v1, s[24:27], s65 offen offset:3072 sc1
 s_waitcnt vmcnt(0)
 v_max3_u32 v4, v64, v65, v66
 v_max3_u32 v5, v67, v68, v69
 v_max3_u32 v4, v4, v70, v71
 v_max3_u32 v5, v5, v72, v73
 v_max3_u32 v4, v4, v74, v75
 v_max3_u32 v5, v5, v76, v77
 v_max3_u32 v4, v4, v78, v79
 v_max_u32 v4, v4, v5
 v_cmp_eq_u32 vcc, -1, v4
 s_add_u32 s0, s0, 1
 s_cmp_ge_u32 s0, 524288
 s_cbranch_scc1 L_xb0_d
 s_nop 1
 s_cbranch_vccnz L_xb0_l
 s_branch L_xb0_d
L_b31_s:
 s_mov_b32 s0, 0
 s_branch L_b31_r
L_b31_l:
 s_sleep 8
L_b31_r:
 buffer_load_dword v47, v24, s[24:27], s60 offen offset:256 sc1
 s_waitcnt vmcnt(0)
 v_cmp_ne_u32 vcc, 1, v47
 s_add_u32 s0, s0, 1
 s_cmp_ge_u32 s0, 524288
 s_cbranch_scc1 L_b31_d
 s_nop 1
 s_cbranch_vccnz L_b31_l
 s_branch L_b31_d
L_of1_s:
 s_mov_b32 s0, 0
 s_branch L_of1_r
L_of1_l:
 s_sleep 8
L_of1_r:
 buffer_load_dword v34, v25, s[24:27], s69 offen offset:256 sc1
 buffer_load_dword v35, off, s[24:27], s55 sc1
 s_waitcnt vmcnt(0)
 v_or_b32 v4, v35, v34
 v_cmp_ne_u32 vcc, 1, v4
 s_add_u32 s0, s0, 1
 s_cmp_ge_u32 s0, 524288
 s_cbranch_scc1 L_of1_d
 s_nop 1
 s_cbranch_vccnz L_of1_l
 s_branch L_of1_d
L_xb1_s:
 s_mov_b32 s0, 0
 s_branch L_xb1_r
L_xb1_l:
 s_sleep 8
L_xb1_r:
 buffer_load_dwordx4 v[64:67], v1, s[24:27], s65 offen sc1
 buffer_load_dwordx4 v[68:71], v1, s[24:27], s65 offen offset:1024 sc1
 buffer_load_dwordx4 v[72:75], v1, s[24:27], s65 offen offset:2048 sc1
 buffer_load_dwordx4 v[76:79], v1, s[24:27], s65 offen offset:3072 sc1
 s_waitcnt vmcnt(0)
 v_max3_u32 v4, v64, v65, v66
 v_max3_u32 v5, v67, v68, v69
 v_max3_u32 v4, v4, v70, v71
 v_max3_u32 v5, v5, v72, v73
 v_max3_u32 v4, v4, v74, v75
 v_max3_u32 v5, v5, v76, v77
 v_max3_u32 v4, v4, v78, v79
 v_max_u32 v4, v4, v5
 v_cmp_eq_u32 vcc, -1, v4
 s_add_u32 s0, s0, 1
 s_cmp_ge_u32 s0, 524288
 s_cbranch_scc1 L_xb1_d
 s_nop 1
 s_cbranch_vccnz L_xb1_l
 s_branch L_xb1_d
L_cend:
 s_endpgm
 s_endpgm
 s_endpgm
 s_endpgm
 s_endpgm
 s_endpgm
 s_endpgm
 s_endpgm
 s_endpgm
 s_endpgm
 s_endpgm
 s_endpgm
 s_endpgm
 s_endpgm
 s_endpgm
 s_endpgm
 s_endpgm
 s_endpgm
 s_endpgm
 s_endpgm
 s_endpgm
 s_endpgm
 s_endpgm
 s_endpgm
 s_endpgm
 s_endpgm
 s_endpgm
 s_endpgm
 s_endpgm
 s_endpgm
 s_endpgm
 s_endpgm
.section .rodata,"a"
.p2align 6
.amdhsa_kernel recurrent_scan__linear_attn_block__geglu_ffn__prompt_kernel
  .amdhsa_next_free_vgpr 512
  .amdhsa_next_free_sgpr 102
  .amdhsa_accum_offset 256
  .amdhsa_group_segment_fixed_size 0
  .amdhsa_kernarg_size 80
  .amdhsa_user_sgpr_count 2
  .amdhsa_user_sgpr_kernarg_segment_ptr 1
  .amdhsa_system_sgpr_workgroup_id_x 1
  .amdhsa_float_denorm_mode_32 3
.end_amdhsa_kernel
```
